```python
import torch

def _softmax(x, axis=-1):
    return torch.softmax(x, dim=axis)
def _gelu(x):
    return torch.nn.functional.gelu(x, approximate="tanh")
def _silu(x):
    return torch.nn.functional.silu(x)
def _sigmoid(x):
    return torch.sigmoid(x)
def _layernorm(x, axis=-1, eps=1e-5):
    m = x.mean(dim=axis, keepdim=True)
    v = x.var(dim=axis, keepdim=True, unbiased=False)
    return (x - m) / torch.sqrt(v + eps)
def _scatter_add(tgt, idx, src, axis=0):
    return tgt.clone().index_add_(axis, idx, src)
def _segment_sum(src, seg, n):
    out = torch.zeros((n,) + src.shape[1:], dtype=src.dtype)
    return out.index_add_(0, seg, src)
def _pad(x, pw):
    flat = tuple(v for pair in reversed(pw) for v in pair)
    return torch.nn.functional.pad(x, flat)

kernel_name = 'concat_heads__mha_block_cached__mha_block_cached__near_ridge'

def setup_inputs():

    _w = (lambda a: (lambda t: t.to(torch.bfloat16) if t.is_floating_point() else t)(torch.as_tensor(a)))
    def _A_setup():
        B, Sq, D = 8, 240, 576
        H, Sk, Dh = 32, 1024, 128
        return {
            "x": _w((lambda *s: torch.randn(*s, dtype=torch.bfloat16) * 0.8)(B, Sq, D)),
            "k_cache": _w((lambda *s: torch.randn(*s, dtype=torch.bfloat16) * 0.8)(B, H, Sk, Dh)),
            "v_cache": _w((lambda *s: torch.randn(*s, dtype=torch.bfloat16) * 0.05)(B, H, Sk, Dh)),
            "wq": _w((lambda *s: torch.randn(*s, dtype=torch.bfloat16) * 0.8)(D, H * Dh) * (D ** -0.5)),
            "wo": _w((lambda *s: torch.randn(*s, dtype=torch.bfloat16) * 0.05)(H * Dh, D) * ((H * Dh) ** -0.5)),
        }
    _A_in = _A_setup()

    def _B_setup():
        B, Sq, D = 8, 240, 576
        H, Sk, Dh = 32, 1024, 128
        return {
            "x": _w((lambda *s: torch.randn(*s, dtype=torch.bfloat16) * 0.8)(B, Sq, D)),
            "k_cache": _w((lambda *s: torch.randn(*s, dtype=torch.bfloat16) * 0.8)(B, H, Sk, Dh)),
            "v_cache": _w((lambda *s: torch.randn(*s, dtype=torch.bfloat16) * 0.05)(B, H, Sk, Dh)),
            "wq": _w((lambda *s: torch.randn(*s, dtype=torch.bfloat16) * 0.8)(D, H * Dh) * (D ** -0.5)),
            "wo": _w((lambda *s: torch.randn(*s, dtype=torch.bfloat16) * 0.05)(H * Dh, D) * ((H * Dh) ** -0.5)),
        }
    _B_in = _B_setup()

    return {
        "A_x": _A_in["x"],
        "A_k_cache": _A_in["k_cache"],
        "A_v_cache": _A_in["v_cache"],
        "A_wq": _A_in["wq"],
        "A_wo": _A_in["wo"],
        "B_x": _B_in["x"],
        "B_k_cache": _B_in["k_cache"],
        "B_v_cache": _B_in["v_cache"],
        "B_wq": _B_in["wq"],
        "B_wo": _B_in["wo"],
    }

def reference(A_x, A_k_cache, A_v_cache, A_wq, A_wo, B_x, B_k_cache, B_v_cache, B_wq, B_wo):
    def _A_ref(x, k_cache, v_cache, wq, wo):
        B, Sq, D = x.shape
        H, Dh = 32, 128
        q = (lambda x, *d: x.permute(*d))((x @ wq).reshape(B, Sq, H, Dh), 0, 2, 1, 3)
        scores = torch.einsum("bhqd,bhkd->bhqk", q, k_cache) * (Dh ** -0.5)
        p = _softmax(scores, axis=-1)
        o = torch.einsum("bhqk,bhkd->bhqd", p, v_cache)
        return (lambda x, *d: x.permute(*d))(o, 0, 2, 1, 3).reshape(B, Sq, H * Dh) @ wo

    def _B_ref(x, k_cache, v_cache, wq, wo):
        B, Sq, D = x.shape
        H, Dh = 32, 128
        q = (lambda x, *d: x.permute(*d))((x @ wq).reshape(B, Sq, H, Dh), 0, 2, 1, 3)
        scores = torch.einsum("bhqd,bhkd->bhqk", q, k_cache) * (Dh ** -0.5)
        p = _softmax(scores, axis=-1)
        o = torch.einsum("bhqk,bhkd->bhqd", p, v_cache)
        return (lambda x, *d: x.permute(*d))(o, 0, 2, 1, 3).reshape(B, Sq, H * Dh) @ wo

    a = _A_ref(A_x, A_k_cache, A_v_cache, A_wq, A_wo)
    b = _B_ref(B_x, B_k_cache, B_v_cache, B_wq, B_wo)
    return torch.concatenate([a, b], axis=-1)
```

```asm
; @launch grid=(256,1,1) block=(256,1,1) lds=163840
.amdgcn_target "amdgcn-amd-amdhsa--gfx950"
.text
.globl concat_heads__mha_block_cached__mha_block_cached__near_ridge_kernel
.p2align 8
.type concat_heads__mha_block_cached__mha_block_cached__near_ridge_kernel,@function
concat_heads__mha_block_cached__mha_block_cached__near_ridge_kernel:
s_cmp_lt_u32 s2, 256
s_cbranch_scc1 L_work
s_endpgm
L_work:
s_load_dwordx16 s[48:63], s[0:1], 0
s_load_dwordx4 s[64:67], s[0:1], 64
s_load_dwordx2 s[100:101], s[0:1], 96
s_load_dwordx4 s[76:79], s[0:1], 80
s_mov_b32 s97, s2
s_and_b32 s3, s2, 7
s_lshr_b32 s2, s2, 3
s_getpc_b64 s[94:95]
L_pc:
s_sub_u32 s94, s94, L_pc-concat_heads__mha_block_cached__mha_block_cached__near_ridge_kernel
s_subb_u32 s95, s95, 0
v_mul_u32_u24 v76, 40, v0
v_lshrrev_b32 v76, 8, v76
s_lshr_b32 s70, s97, 3
s_mul_i32 s70, s70, 40
v_add_u32 v76, s70, v76
v_lshlrev_b32 v76, 7, v76
v_min_u32 v76, L_codeend-concat_heads__mha_block_cached__mha_block_cached__near_ridge_kernel-4, v76
v_mov_b32 v77, s95
v_add_co_u32 v76, vcc, s94, v76
s_nop 1
v_addc_co_u32 v77, vcc, 0, v77, vcc
global_load_dword v4, v[76:77], off
v_lshrrev_b32 v1, 6, v0
s_bfe_u32 s68, s3, 65536
s_lshl_b32 s68, s68, 2
s_and_b32 s69, s2, 3
s_add_u32 s68, s68, s69
v_readfirstlane_b32 s32, v1
s_bfe_u32 s69, s3, 65537
s_lshl_b32 s69, s69, 3
s_lshr_b32 s70, s2, 2
s_add_u32 s69, s69, s70
s_lshr_b32 s3, s3, 2
s_lshl_b32 s33, s32, 12
s_lshl_b32 s42, s32, 13
s_mov_b32 s44, 1040356334
s_mov_b32 s45, 1040356334
s_mov_b32 s37, 0
s_mov_b32 s38, 0
v_and_b32 v108, 63, v0
v_lshrrev_b32 v112, 4, v108
v_lshrrev_b32 v113, 3, v108
v_and_b32 v114, 7, v108
s_lshl_b32 s46, s32, 6
v_add_u32 v109, s46, v113
v_mul_u32_u24 v109, 1152, v109
v_xor_b32 v110, 0, v112
v_xor_b32 v110, v110, v114
v_lshl_add_u32 v110, v110, 4, v109
v_add_u32 v20, 0, v110
v_xor_b32 v110, 4, v112
v_xor_b32 v110, v110, v114
v_lshl_add_u32 v110, v110, 4, v109
v_add_u32 v21, 8192, v110
v_xor_b32 v110, 0, v112
v_xor_b32 v110, v110, v114
v_lshl_add_u32 v110, v110, 4, v109
v_add_u32 v22, 16384, v110
v_xor_b32 v110, 4, v112
v_xor_b32 v110, v110, v114
v_lshl_add_u32 v110, v110, 4, v109
v_add_u32 v23, 24576, v110
s_and_b32 s46, s32, 1
s_lshl_b32 s46, s46, 18
s_lshr_b32 s47, s32, 1
s_lshl_b32 s47, s47, 7
s_add_u32 s46, s46, s47
v_lshlrev_b32 v109, 13, v113
v_add_u32 v109, s46, v109
v_lshrrev_b32 v110, 2, v114
v_xor_b32 v110, v110, v112
v_and_b32 v110, 1, v110
v_lshl_add_u32 v109, v110, 6, v109
v_and_b32 v110, 3, v114
v_lshl_add_u32 v109, v110, 4, v109
v_add_u32 v24, 0, v109
v_add_u32 v25, 64512, v109
v_add_u32 v26, 129024, v109
v_add_u32 v27, 193536, v109
s_mov_b32 s39, 0
s_mov_b32 s40, 36864
s_mov_b32 s41, 0
s_mov_b32 s34, 0
s_mov_b32 s36, 0
s_cmp_eq_u32 s3, 0
s_waitcnt lgkmcnt(0)
s_cselect_b64 s[48:49], s[48:49], s[58:59]
s_cselect_b64 s[50:51], s[50:51], s[60:61]
s_cselect_b64 s[52:53], s[52:53], s[62:63]
s_cselect_b64 s[54:55], s[54:55], s[64:65]
s_cselect_b64 s[56:57], s[56:57], s[66:67]
s_mul_i32 s71, s68, 276480
s_add_u32 s4, s48, s71
s_addc_u32 s5, s49, 0
s_mov_b32 s6, 276480
s_mov_b32 s7, 0x20000
s_lshl_b32 s71, s69, 9
s_add_u32 s8, s54, s71
s_addc_u32 s9, s55, 0
s_sub_u32 s10, 4718592, s71
s_mov_b32 s11, 0x20000
L_srdok:
s_add_u32 m0, s42, 81920
s_nop 0
buffer_load_dwordx4 v20, s[4:7], s39 offen offset:0 lds
buffer_load_dwordx4 v21, s[4:7], s39 offen offset:1024 lds
buffer_load_dwordx4 v22, s[4:7], s39 offen offset:2048 lds
buffer_load_dwordx4 v23, s[4:7], s39 offen offset:3072 lds
s_add_u32 m0, s42, 86016
s_nop 0
buffer_load_dwordx4 v20, s[4:7], s40 offen offset:0 lds
buffer_load_dwordx4 v21, s[4:7], s40 offen offset:1024 lds
buffer_load_dwordx4 v22, s[4:7], s40 offen offset:2048 lds
buffer_load_dwordx4 v23, s[4:7], s40 offen offset:3072 lds
s_add_u32 s39, s39, 128
s_add_u32 s40, s40, 128
s_add_u32 m0, s33, 49152
s_nop 0
buffer_load_dwordx4 v24, s[8:11], s41 offen offset:0 lds
buffer_load_dwordx4 v25, s[8:11], s41 offen offset:1024 lds
buffer_load_dwordx4 v26, s[8:11], s41 offen offset:2048 lds
buffer_load_dwordx4 v27, s[8:11], s41 offen offset:3072 lds
s_add_u32 s41, s41, 256
s_lshl_b32 s71, s68, 4
s_add_u32 s71, s71, s69
s_lshl_b32 s70, s71, 19
s_add_u32 s12, s50, s70
s_addc_u32 s13, s51, 0
s_mov_b32 s14, 524288
s_mov_b32 s15, 0x20000
s_add_u32 s16, s52, s70
s_addc_u32 s17, s53, 0
s_mov_b32 s18, 524288
s_mov_b32 s19, 0x20000
s_mul_i32 s70, s3, 15728640
s_add_u32 s20, s100, s70
s_addc_u32 s21, s101, 0
s_mov_b32 s22, 15728640
s_mov_b32 s23, 0x20000
s_mul_i32 s70, s71, 36864
s_add_u32 s24, s56, s70
s_addc_u32 s25, s57, 0
s_mov_b32 s26, 36864
s_mov_b32 s27, 0x20000
s_mul_i32 s71, s3, 4718592
s_add_u32 s70, s70, s71
s_add_u32 s70, s70, 31457280
s_add_u32 s28, s100, s70
s_addc_u32 s29, s101, 0
s_mov_b32 s30, 36864
s_mov_b32 s31, 0x20000
s_mul_i32 s62, s69, 983040
s_mul_i32 s63, s68, 15360
s_add_u32 s48, s100, 40894464
s_addc_u32 s49, s101, 0
s_mov_b32 s50, 24576
s_mov_b32 s51, 0x20000
s_mov_b64 s[52:53], s[78:79]
s_mov_b32 s54, 256
s_mov_b32 s55, 0x20000
s_mov_b64 s[84:85], s[48:49]
s_mov_b32 s87, 0x20000
s_mov_b64 s[88:89], s[78:79]
s_mov_b32 s91, 0x20000
s_lshl_b32 s70, s3, 3
s_add_u32 s70, s70, s68
s_lshl_b32 s60, s70, 2
s_lshr_b32 s71, s69, 2
s_add_u32 s60, s60, s71
s_lshl_b32 s60, s60, 7
s_lshr_b32 s61, s70, 1
s_lshl_b32 s61, s61, 7
s_add_u32 s61, s61, 8192
s_and_b32 s70, s97, 1
s_mul_i32 s70, s70, 30
s_add_u32 s2, s2, s70
s_cmp_eq_u32 s70, 0
s_cselect_b32 s71, 30, 60
s_cmp_ge_u32 s2, s71
s_cselect_b32 s67, 1, 0
s_mul_i32 s68, s2, 43
s_lshr_b32 s68, s68, 8
s_mul_i32 s69, s68, 6
s_sub_u32 s69, s2, s69
s_bfe_u32 s70, s97, 0x10001
s_mul_i32 s70, s70, 10
s_add_u32 s68, s68, s70
s_mul_i32 s92, s69, 0
s_add_u32 s92, s92, s68
s_and_b32 s92, s92, 3
s_mul_i32 s79, s68, 103
s_lshr_b32 s79, s79, 8
s_mul_i32 s78, s68, 96
s_add_u32 s78, s78, 95
s_mul_i32 s78, s78, 4370
s_lshr_b32 s78, s78, 20
s_lshl_b32 s70, s3, 3
s_add_u32 s78, s78, s70
s_add_u32 s79, s79, s70
s_lshl_b32 s78, s78, 2
s_lshl_b32 s79, s79, 2
s_add_u32 s78, s78, s32
s_add_u32 s79, s79, s32
s_lshl_b32 s78, s78, 7
s_lshl_b32 s79, s79, 7
s_mul_i32 s70, s3, 15728640
s_mul_i32 s71, s68, 6144
s_add_u32 s70, s70, s71
s_add_u32 s56, s100, s70
s_addc_u32 s57, s101, 0
s_sub_u32 s58, 15728640, s71
s_mov_b32 s59, 0x20000
s_mul_i32 s70, s3, 4718592
s_mul_i32 s71, s69, 6144
s_add_u32 s70, s70, s71
s_add_u32 s70, s70, 31457280
s_add_u32 s80, s100, s70
s_addc_u32 s81, s101, 0
s_sub_u32 s82, 4718592, s71
s_mov_b32 s83, 0x20000
s_cmp_eq_u32 s67, 1
s_cselect_b32 s58, 0, s58
s_cselect_b32 s82, 0, s82
s_mov_b32 s100, s58
s_mov_b32 s101, s82
s_lshr_b32 s70, s32, 1
s_mul_i32 s70, s70, 110592
s_mul_i32 s66, s68, 221184
s_add_u32 s66, s66, s70
s_mul_i32 s70, s3, 1152
s_add_u32 s66, s66, s70
s_mul_i32 s70, s69, 192
s_add_u32 s66, s66, s70
s_and_b32 s70, s32, 1
s_mul_i32 s70, s70, 96
s_add_u32 s66, s66, s70
s_lshl_b32 s70, s3, 2
s_add_u32 s70, s70, s32
s_lshl_b32 s70, s70, 7
s_add_u32 s70, s70, 8192
v_and_b32 v1, 1, v0
v_mov_b32 v13, s78
v_mov_b32 v2, s79
v_cmp_eq_u32 vcc, 1, v1
v_and_b32 v1, 2, v0
v_mov_b32 v3, s70
v_cndmask_b32 v13, v13, v2, vcc
v_cmp_eq_u32 vcc, 2, v1
v_add_u32 v11, 16384, v13
v_mov_b32 v12, 4
v_cndmask_b32 v11, v11, v3, vcc
v_mov_b32 v3, 32
v_cndmask_b32 v12, v12, v3, vcc
s_mov_b32 s78, 0
L_late:
s_or_b32 s70, s97, s37
s_cmp_eq_u32 s70, 0
s_cselect_b32 s86, 24576, 0
s_cselect_b32 s90, 4, 0
s_mov_b32 s43, s62
s_mov_b32 s79, 0
s_mov_b32 s58, s100
s_mov_b32 s82, s101
s_mul_i32 s98, s32, 3932160
s_mul_i32 s99, s32, 1179648
s_lshr_b32 s68, s97, 3
s_mul_i32 s68, s68, 1
s_mul_i32 s70, s68, 5042
s_lshr_b32 s70, s70, 16
s_mul_i32 s70, s70, 13
s_sub_u32 s68, s68, s70
s_lshl_b32 s68, s68, 14
s_lshl_b32 s69, s32, 11
v_and_b32 v108, 63, v0
v_lshrrev_b32 v112, 4, v108
v_lshrrev_b32 v113, 3, v108
v_and_b32 v114, 7, v108
v_and_b32 v115, 15, v108
v_lshrrev_b32 v116, 2, v115
v_and_b32 v117, 3, v108
v_lshlrev_b32 v103, 4, v108
s_add_u32 s71, s63, s33
v_add_u32 v100, s71, v103
s_lshl_b32 s70, s32, 11
v_lshlrev_b32 v109, 8, v112
v_add_u32 v109, s70, v109
s_and_b32 s70, s32, 1
s_lshl_b32 s70, s70, 3
v_xor_b32 v110, v115, v112
v_xor_b32 v110, s70, v110
v_lshl_add_u32 v96, v110, 4, v109
v_xor_b32 v97, 64, v96
v_lshlrev_b32 v110, 1, v112
v_xor_b32 v111, v110, v115
v_lshl_add_u32 v98, v111, 4, v109
v_xor_b32 v99, 128, v98
v_mul_u32_u24 v109, 1152, v113
v_lshl_add_u32 v109, v114, 4, v109
s_lshl_b32 s70, s32, 7
v_add_u32 v101, s70, v109
v_lshrrev_b32 v109, 1, v108
v_mul_u32_u24 v109, 1152, v109
v_and_b32 v110, 1, v108
v_lshl_add_u32 v109, v110, 4, v109
s_lshl_b32 s70, s32, 5
s_add_u32 s70, s70, 1024
v_add_u32 v102, s70, v109
v_xor_b32 v110, v112, v115
v_lshlrev_b32 v110, 4, v110
v_lshl_add_u32 v84, v115, 8, v110
v_xor_b32 v85, 64, v84
v_xor_b32 v86, 128, v84
v_xor_b32 v87, 192, v84
v_lshl_add_u32 v110, v112, 2, v116
v_lshlrev_b32 v109, 8, v110
v_and_b32 v110, 7, v110
v_lshl_add_u32 v109, v110, 5, v109
v_lshl_add_u32 v109, v117, 3, v109
v_add_u32 v88, 0x10000, v109
v_xor_b32 v89, 32, v88
v_xor_b32 v90, 64, v88
v_xor_b32 v91, 96, v88
v_xor_b32 v92, 128, v88
v_xor_b32 v93, 160, v88
v_xor_b32 v94, 192, v88
v_xor_b32 v95, 224, v88
v_lshrrev_b32 v74, 2, v108
v_lshlrev_b32 v74, 7, v74
v_lshl_add_u32 v74, s32, 11, v74
v_lshl_add_u32 v110, v112, 2, v116
v_lshlrev_b32 v109, 7, v110
v_lshl_add_u32 v109, v117, 3, v109
s_lshr_b32 s70, s32, 1
s_lshl_b32 s70, s70, 16
s_and_b32 s71, s32, 1
s_lshl_b32 s64, s71, 13
s_add_u32 s64, s64, s70
s_lshl_b32 s65, s71, 10
s_add_u32 s65, s65, s70
s_add_u32 s65, s65, 47104
v_add_u32 v105, s64, v109
v_lshlrev_b32 v109, 3, v108
v_add_u32 v10, s65, v109
v_mov_b32 v104, 1
s_and_b32 s70, s32, 1
s_mul_i32 s70, s70, 3072
s_sub_u32 s71, 3072, s70
v_add_u32 v2, s70, v103
v_add_u32 v3, s71, v103
s_lshr_b32 s70, s32, 1
s_mul_i32 s70, s70, 3072
s_sub_u32 s71, 3072, s70
v_add_u32 v8, s70, v103
v_add_u32 v9, s71, v103
v_and_b32 v115, 15, v108
v_lshrrev_b32 v116, 2, v115
v_and_b32 v117, 3, v108
v_lshlrev_b32 v109, 7, v115
v_add_u32 v109, s42, v109
v_add_u32 v109, 16384, v109
v_lshrrev_b32 v111, 1, v115
v_xor_b32 v110, 0, v112
v_xor_b32 v110, v110, v111
v_lshl_add_u32 v16, v110, 4, v109
v_add_u32 v18, 65536, v16
v_xor_b32 v110, 4, v112
v_xor_b32 v110, v110, v111
v_lshl_add_u32 v17, v110, 4, v109
v_add_u32 v19, 65536, v17
v_lshl_add_u32 v109, v112, 3, v116
v_lshlrev_b32 v109, 7, v109
v_lshl_add_u32 v109, v117, 4, v109
v_add_u32 v109, 49152, v109
v_lshrrev_b32 v111, 1, v116
v_xor_b32 v110, 0, v111
v_lshl_add_u32 v28, v110, 6, v109
v_add_u32 v30, 65536, v28
v_xor_b32 v110, 1, v111
v_lshl_add_u32 v29, v110, 6, v109
v_add_u32 v31, 65536, v29
s_add_u32 m0, s33, 114688
s_nop 0
buffer_load_dwordx4 v24, s[8:11], s41 offen offset:0 lds
buffer_load_dwordx4 v25, s[8:11], s41 offen offset:1024 lds
buffer_load_dwordx4 v26, s[8:11], s41 offen offset:2048 lds
buffer_load_dwordx4 v27, s[8:11], s41 offen offset:3072 lds
s_add_u32 s41, s41, 524032
s_add_u32 m0, s42, 16384
s_nop 0
buffer_load_dwordx4 v20, s[4:7], s39 offen offset:0 lds
buffer_load_dwordx4 v21, s[4:7], s39 offen offset:1024 lds
buffer_load_dwordx4 v22, s[4:7], s39 offen offset:2048 lds
buffer_load_dwordx4 v23, s[4:7], s39 offen offset:3072 lds
s_add_u32 m0, s42, 20480
s_nop 0
buffer_load_dwordx4 v20, s[4:7], s40 offen offset:0 lds
buffer_load_dwordx4 v21, s[4:7], s40 offen offset:1024 lds
buffer_load_dwordx4 v22, s[4:7], s40 offen offset:2048 lds
buffer_load_dwordx4 v23, s[4:7], s40 offen offset:3072 lds
s_add_u32 s39, s39, 128
s_add_u32 s40, s40, 128
s_cmp_eq_u32 s32, 3
s_cbranch_scc1 L_begin3
L_begin4:
s_waitcnt vmcnt(12)
s_barrier
ds_read_b128 a[0:3], v18 offset:0
ds_read_b128 a[4:7], v19 offset:0
ds_read_b128 a[8:11], v18 offset:2048
ds_read_b128 a[12:15], v19 offset:2048
ds_read_b128 a[16:19], v18 offset:4096
ds_read_b128 a[20:23], v19 offset:4096
ds_read_b128 a[24:27], v18 offset:6144
ds_read_b128 a[28:31], v19 offset:6144
ds_read_b64_tr_b16 a[64:65], v28 offset:0
ds_read_b64_tr_b16 a[66:67], v28 offset:512
ds_read_b64_tr_b16 a[68:69], v28 offset:4096
ds_read_b64_tr_b16 a[70:71], v28 offset:4608
ds_read_b64_tr_b16 a[72:73], v28 offset:8
ds_read_b64_tr_b16 a[74:75], v28 offset:520
ds_read_b64_tr_b16 a[76:77], v28 offset:4104
ds_read_b64_tr_b16 a[78:79], v28 offset:4616
ds_read_b64_tr_b16 a[80:81], v29 offset:0
ds_read_b64_tr_b16 a[82:83], v29 offset:512
ds_read_b64_tr_b16 a[84:85], v29 offset:4096
s_waitcnt lgkmcnt(7)
v_mfma_f32_16x16x32_bf16 v[128:131], a[64:67], a[0:3], 0
ds_read_b64_tr_b16 a[86:87], v29 offset:4608
s_add_u32 m0, s33, 131072
v_mfma_f32_16x16x32_bf16 v[128:131], a[68:71], a[4:7], v[128:131]
buffer_load_dwordx4 v24, s[8:11], s41 offen offset:0 lds
v_mfma_f32_16x16x32_bf16 v[160:163], a[64:67], a[8:11], 0
v_mfma_f32_16x16x32_bf16 v[160:163], a[68:71], a[12:15], v[160:163]
buffer_load_dwordx4 v25, s[8:11], s41 offen offset:1024 lds
v_mfma_f32_16x16x32_bf16 v[192:195], a[64:67], a[16:19], 0
v_mfma_f32_16x16x32_bf16 v[192:195], a[68:71], a[20:23], v[192:195]
ds_read_b64_tr_b16 a[88:89], v29 offset:8
buffer_load_dwordx4 v26, s[8:11], s41 offen offset:2048 lds
v_mfma_f32_16x16x32_bf16 v[224:227], a[64:67], a[24:27], 0
ds_read_b64_tr_b16 a[90:91], v29 offset:520
v_mfma_f32_16x16x32_bf16 v[224:227], a[68:71], a[28:31], v[224:227]
ds_read_b64_tr_b16 a[92:93], v29 offset:4104
s_waitcnt lgkmcnt(7)
buffer_load_dwordx4 v27, s[8:11], s41 offen offset:3072 lds
v_mfma_f32_16x16x32_bf16 v[132:135], a[72:75], a[0:3], 0
ds_read_b64_tr_b16 a[94:95], v29 offset:4616
s_add_u32 s41, s41, 256
s_add_u32 m0, s33, 147456
v_mfma_f32_16x16x32_bf16 v[132:135], a[76:79], a[4:7], v[132:135]
buffer_load_dwordx4 v24, s[8:11], s41 offen offset:0 lds
v_mfma_f32_16x16x32_bf16 v[164:167], a[72:75], a[8:11], 0
v_mfma_f32_16x16x32_bf16 v[164:167], a[76:79], a[12:15], v[164:167]
buffer_load_dwordx4 v25, s[8:11], s41 offen offset:1024 lds
v_mfma_f32_16x16x32_bf16 v[196:199], a[72:75], a[16:19], 0
ds_read_b64_tr_b16 a[64:65], v28 offset:8192
v_mfma_f32_16x16x32_bf16 v[196:199], a[76:79], a[20:23], v[196:199]
ds_read_b64_tr_b16 a[66:67], v28 offset:8704
buffer_load_dwordx4 v26, s[8:11], s41 offen offset:2048 lds
v_mfma_f32_16x16x32_bf16 v[228:231], a[72:75], a[24:27], 0
ds_read_b64_tr_b16 a[68:69], v28 offset:12288
v_mfma_f32_16x16x32_bf16 v[228:231], a[76:79], a[28:31], v[228:231]
ds_read_b64_tr_b16 a[70:71], v28 offset:12800
s_waitcnt lgkmcnt(8)
buffer_load_dwordx4 v27, s[8:11], s41 offen offset:3072 lds
v_mfma_f32_16x16x32_bf16 v[136:139], a[80:83], a[0:3], 0
s_add_u32 s41, s41, 524032
s_add_u32 m0, s42, 81920
v_mfma_f32_16x16x32_bf16 v[136:139], a[84:87], a[4:7], v[136:139]
buffer_load_dwordx4 v20, s[4:7], s39 offen offset:0 lds
v_mfma_f32_16x16x32_bf16 v[168:171], a[80:83], a[8:11], 0
v_mfma_f32_16x16x32_bf16 v[168:171], a[84:87], a[12:15], v[168:171]
ds_read_b64_tr_b16 a[72:73], v28 offset:8200
buffer_load_dwordx4 v21, s[4:7], s39 offen offset:1024 lds
v_mfma_f32_16x16x32_bf16 v[200:203], a[80:83], a[16:19], 0
ds_read_b64_tr_b16 a[74:75], v28 offset:8712
v_mfma_f32_16x16x32_bf16 v[200:203], a[84:87], a[20:23], v[200:203]
ds_read_b64_tr_b16 a[76:77], v28 offset:12296
buffer_load_dwordx4 v22, s[4:7], s39 offen offset:2048 lds
v_mfma_f32_16x16x32_bf16 v[232:235], a[80:83], a[24:27], 0
ds_read_b64_tr_b16 a[78:79], v28 offset:12808
v_mfma_f32_16x16x32_bf16 v[232:235], a[84:87], a[28:31], v[232:235]
s_waitcnt lgkmcnt(8)
buffer_load_dwordx4 v23, s[4:7], s39 offen offset:3072 lds
v_mfma_f32_16x16x32_bf16 v[140:143], a[88:91], a[0:3], 0
s_add_u32 m0, s42, 86016
v_mfma_f32_16x16x32_bf16 v[140:143], a[92:95], a[4:7], v[140:143]
buffer_load_dwordx4 v20, s[4:7], s40 offen offset:0 lds
v_mfma_f32_16x16x32_bf16 v[172:175], a[88:91], a[8:11], 0
ds_read_b64_tr_b16 a[80:81], v29 offset:8192
v_mfma_f32_16x16x32_bf16 v[172:175], a[92:95], a[12:15], v[172:175]
ds_read_b64_tr_b16 a[82:83], v29 offset:8704
buffer_load_dwordx4 v21, s[4:7], s40 offen offset:1024 lds
v_mfma_f32_16x16x32_bf16 v[204:207], a[88:91], a[16:19], 0
ds_read_b64_tr_b16 a[84:85], v29 offset:12288
v_mfma_f32_16x16x32_bf16 v[204:207], a[92:95], a[20:23], v[204:207]
ds_read_b64_tr_b16 a[86:87], v29 offset:12800
buffer_load_dwordx4 v22, s[4:7], s40 offen offset:2048 lds
v_mfma_f32_16x16x32_bf16 v[236:239], a[88:91], a[24:27], 0
v_mfma_f32_16x16x32_bf16 v[236:239], a[92:95], a[28:31], v[236:239]
s_waitcnt lgkmcnt(8)
buffer_load_dwordx4 v23, s[4:7], s40 offen offset:3072 lds
v_mfma_f32_16x16x32_bf16 v[144:147], a[64:67], a[0:3], 0
s_add_u32 s39, s39, 128
s_add_u32 s40, s40, 128
v_mfma_f32_16x16x32_bf16 v[144:147], a[68:71], a[4:7], v[144:147]
ds_read_b64_tr_b16 a[88:89], v29 offset:8200
v_mfma_f32_16x16x32_bf16 v[176:179], a[64:67], a[8:11], 0
ds_read_b64_tr_b16 a[90:91], v29 offset:8712
v_mfma_f32_16x16x32_bf16 v[176:179], a[68:71], a[12:15], v[176:179]
ds_read_b64_tr_b16 a[92:93], v29 offset:12296
v_mfma_f32_16x16x32_bf16 v[208:211], a[64:67], a[16:19], 0
ds_read_b64_tr_b16 a[94:95], v29 offset:12808
v_mfma_f32_16x16x32_bf16 v[208:211], a[68:71], a[20:23], v[208:211]
v_mfma_f32_16x16x32_bf16 v[240:243], a[64:67], a[24:27], 0
v_mfma_f32_16x16x32_bf16 v[240:243], a[68:71], a[28:31], v[240:243]
s_waitcnt lgkmcnt(8)
v_mfma_f32_16x16x32_bf16 v[148:151], a[72:75], a[0:3], 0
v_mfma_f32_16x16x32_bf16 v[148:151], a[76:79], a[4:7], v[148:151]
v_mfma_f32_16x16x32_bf16 v[180:183], a[72:75], a[8:11], 0
v_mfma_f32_16x16x32_bf16 v[180:183], a[76:79], a[12:15], v[180:183]
s_waitcnt vmcnt(16) lgkmcnt(0)
v_mfma_f32_16x16x32_bf16 v[212:215], a[72:75], a[16:19], 0
s_barrier
v_mfma_f32_16x16x32_bf16 v[212:215], a[76:79], a[20:23], v[212:215]
ds_read_b64_tr_b16 a[64:65], v30 offset:0
s_add_u32 m0, s33, 49152
v_mfma_f32_16x16x32_bf16 v[244:247], a[72:75], a[24:27], 0
ds_read_b64_tr_b16 a[66:67], v30 offset:512
buffer_load_dwordx4 v24, s[8:11], s41 offen offset:0 lds
v_mfma_f32_16x16x32_bf16 v[244:247], a[76:79], a[28:31], v[244:247]
ds_read_b64_tr_b16 a[68:69], v30 offset:4096
v_mfma_f32_16x16x32_bf16 v[152:155], a[80:83], a[0:3], 0
ds_read_b64_tr_b16 a[70:71], v30 offset:4608
v_mfma_f32_16x16x32_bf16 v[152:155], a[84:87], a[4:7], v[152:155]
v_mfma_f32_16x16x32_bf16 v[184:187], a[80:83], a[8:11], 0
v_mfma_f32_16x16x32_bf16 v[184:187], a[84:87], a[12:15], v[184:187]
buffer_load_dwordx4 v25, s[8:11], s41 offen offset:1024 lds
v_mfma_f32_16x16x32_bf16 v[216:219], a[80:83], a[16:19], 0
v_mfma_f32_16x16x32_bf16 v[216:219], a[84:87], a[20:23], v[216:219]
ds_read_b64_tr_b16 a[72:73], v30 offset:8
v_mfma_f32_16x16x32_bf16 v[248:251], a[80:83], a[24:27], 0
ds_read_b64_tr_b16 a[74:75], v30 offset:520
v_mfma_f32_16x16x32_bf16 v[248:251], a[84:87], a[28:31], v[248:251]
ds_read_b64_tr_b16 a[76:77], v30 offset:4104
v_mfma_f32_16x16x32_bf16 v[156:159], a[88:91], a[0:3], 0
ds_read_b64_tr_b16 a[78:79], v30 offset:4616
buffer_load_dwordx4 v26, s[8:11], s41 offen offset:2048 lds
v_mfma_f32_16x16x32_bf16 v[156:159], a[92:95], a[4:7], v[156:159]
v_mfma_f32_16x16x32_bf16 v[188:191], a[88:91], a[8:11], 0
v_mfma_f32_16x16x32_bf16 v[188:191], a[92:95], a[12:15], v[188:191]
v_mfma_f32_16x16x32_bf16 v[220:223], a[88:91], a[16:19], 0
v_mfma_f32_16x16x32_bf16 v[220:223], a[92:95], a[20:23], v[220:223]
ds_read_b64_tr_b16 a[80:81], v31 offset:0
buffer_load_dwordx4 v27, s[8:11], s41 offen offset:3072 lds
v_mfma_f32_16x16x32_bf16 v[252:255], a[88:91], a[24:27], 0
ds_read_b64_tr_b16 a[82:83], v31 offset:512
s_add_u32 s41, s41, 256
v_mfma_f32_16x16x32_bf16 v[252:255], a[92:95], a[28:31], v[252:255]
ds_read_b64_tr_b16 a[84:85], v31 offset:4096
s_waitcnt lgkmcnt(7)
v_mfma_f32_16x16x32_bf16 a[128:131], a[64:67], a[0:3], 0
ds_read_b64_tr_b16 a[86:87], v31 offset:4608
v_mfma_f32_16x16x32_bf16 a[128:131], a[68:71], a[4:7], a[128:131]
v_mfma_f32_16x16x32_bf16 a[160:163], a[64:67], a[8:11], 0
v_mfma_f32_16x16x32_bf16 a[160:163], a[68:71], a[12:15], a[160:163]
v_mfma_f32_16x16x32_bf16 a[192:195], a[64:67], a[16:19], 0
v_mfma_f32_16x16x32_bf16 a[192:195], a[68:71], a[20:23], a[192:195]
ds_read_b64_tr_b16 a[88:89], v31 offset:8
v_mfma_f32_16x16x32_bf16 a[224:227], a[64:67], a[24:27], 0
ds_read_b64_tr_b16 a[90:91], v31 offset:520
v_mfma_f32_16x16x32_bf16 a[224:227], a[68:71], a[28:31], a[224:227]
ds_read_b64_tr_b16 a[92:93], v31 offset:4104
s_waitcnt lgkmcnt(7)
v_mfma_f32_16x16x32_bf16 a[132:135], a[72:75], a[0:3], 0
ds_read_b64_tr_b16 a[94:95], v31 offset:4616
v_mfma_f32_16x16x32_bf16 a[132:135], a[76:79], a[4:7], a[132:135]
ds_read_b128 a[32:35], v16 offset:0
v_mfma_f32_16x16x32_bf16 a[164:167], a[72:75], a[8:11], 0
ds_read_b128 a[36:39], v17 offset:0
v_mfma_f32_16x16x32_bf16 a[164:167], a[76:79], a[12:15], a[164:167]
s_add_u32 m0, s64, 0
s_mov_b32 s46, 0
v_mfma_f32_16x16x32_bf16 a[196:199], a[72:75], a[16:19], 0
ds_read_b64_tr_b16 a[64:65], v30 offset:8192
buffer_load_dwordx4 v101, s[24:27], s46 offen offset:0 lds
v_mfma_f32_16x16x32_bf16 a[196:199], a[76:79], a[20:23], a[196:199]
ds_read_b64_tr_b16 a[66:67], v30 offset:8704
v_mfma_f32_16x16x32_bf16 a[228:231], a[72:75], a[24:27], 0
ds_read_b64_tr_b16 a[68:69], v30 offset:12288
v_mfma_f32_16x16x32_bf16 a[228:231], a[76:79], a[28:31], a[228:231]
ds_read_b64_tr_b16 a[70:71], v30 offset:12800
s_waitcnt lgkmcnt(10)
v_mfma_f32_16x16x32_bf16 a[136:139], a[80:83], a[0:3], 0
ds_read_b128 a[40:43], v16 offset:2048
v_mfma_f32_16x16x32_bf16 a[136:139], a[84:87], a[4:7], a[136:139]
ds_read_b128 a[44:47], v17 offset:2048
v_mfma_f32_16x16x32_bf16 a[168:171], a[80:83], a[8:11], 0
v_mfma_f32_16x16x32_bf16 a[168:171], a[84:87], a[12:15], a[168:171]
ds_read_b64_tr_b16 a[72:73], v30 offset:8200
v_mfma_f32_16x16x32_bf16 a[200:203], a[80:83], a[16:19], 0
ds_read_b64_tr_b16 a[74:75], v30 offset:8712
v_mfma_f32_16x16x32_bf16 a[200:203], a[84:87], a[20:23], a[200:203]
ds_read_b64_tr_b16 a[76:77], v30 offset:12296
v_mfma_f32_16x16x32_bf16 a[232:235], a[80:83], a[24:27], 0
ds_read_b64_tr_b16 a[78:79], v30 offset:12808
v_mfma_f32_16x16x32_bf16 a[232:235], a[84:87], a[28:31], a[232:235]
ds_read_b128 a[48:51], v16 offset:4096
s_waitcnt lgkmcnt(13)
v_mfma_f32_16x16x32_bf16 a[140:143], a[88:91], a[0:3], 0
ds_read_b128 a[52:55], v17 offset:4096
v_mfma_f32_16x16x32_bf16 a[140:143], a[92:95], a[4:7], a[140:143]
v_mfma_f32_16x16x32_bf16 a[172:175], a[88:91], a[8:11], 0
ds_read_b64_tr_b16 a[80:81], v31 offset:8192
v_mfma_f32_16x16x32_bf16 a[172:175], a[92:95], a[12:15], a[172:175]
ds_read_b64_tr_b16 a[82:83], v31 offset:8704
v_mfma_f32_16x16x32_bf16 a[204:207], a[88:91], a[16:19], 0
ds_read_b64_tr_b16 a[84:85], v31 offset:12288
v_mfma_f32_16x16x32_bf16 a[204:207], a[92:95], a[20:23], a[204:207]
ds_read_b64_tr_b16 a[86:87], v31 offset:12800
v_mfma_f32_16x16x32_bf16 a[236:239], a[88:91], a[24:27], 0
ds_read_b128 a[56:59], v16 offset:6144
v_mfma_f32_16x16x32_bf16 a[236:239], a[92:95], a[28:31], a[236:239]
ds_read_b128 a[60:63], v17 offset:6144
s_waitcnt lgkmcnt(14)
s_add_u32 m0, s64, 0
s_mov_b32 s46, 8192
v_mfma_f32_16x16x32_bf16 a[144:147], a[64:67], a[0:3], 0
buffer_load_dwordx4 v101, s[24:27], s46 offen offset:1024 lds
v_mfma_f32_16x16x32_bf16 a[144:147], a[68:71], a[4:7], a[144:147]
ds_read_b64_tr_b16 a[88:89], v31 offset:8200
v_mfma_f32_16x16x32_bf16 a[176:179], a[64:67], a[8:11], 0
ds_read_b64_tr_b16 a[90:91], v31 offset:8712
v_mfma_f32_16x16x32_bf16 a[176:179], a[68:71], a[12:15], a[176:179]
ds_read_b64_tr_b16 a[92:93], v31 offset:12296
v_mfma_f32_16x16x32_bf16 a[208:211], a[64:67], a[16:19], 0
ds_read_b64_tr_b16 a[94:95], v31 offset:12808
v_mfma_f32_16x16x32_bf16 a[208:211], a[68:71], a[20:23], a[208:211]
v_mfma_f32_16x16x32_bf16 a[240:243], a[64:67], a[24:27], 0
v_mfma_f32_16x16x32_bf16 a[240:243], a[68:71], a[28:31], a[240:243]
s_waitcnt lgkmcnt(12)
v_mfma_f32_16x16x32_bf16 a[148:151], a[72:75], a[0:3], 0
v_mfma_f32_16x16x32_bf16 a[148:151], a[76:79], a[4:7], a[148:151]
v_mfma_f32_16x16x32_bf16 a[180:183], a[72:75], a[8:11], 0
v_mfma_f32_16x16x32_bf16 a[180:183], a[76:79], a[12:15], a[180:183]
s_waitcnt vmcnt(18) lgkmcnt(0)
v_mfma_f32_16x16x32_bf16 a[212:215], a[72:75], a[16:19], 0
s_barrier
v_mfma_f32_16x16x32_bf16 a[212:215], a[76:79], a[20:23], a[212:215]
ds_read_b64_tr_b16 a[64:65], v30 offset:16384
s_add_u32 m0, s33, 114688
v_mfma_f32_16x16x32_bf16 a[244:247], a[72:75], a[24:27], 0
ds_read_b64_tr_b16 a[66:67], v30 offset:16896
buffer_load_dwordx4 v24, s[8:11], s41 offen offset:0 lds
v_mfma_f32_16x16x32_bf16 a[244:247], a[76:79], a[28:31], a[244:247]
ds_read_b64_tr_b16 a[68:69], v30 offset:20480
v_mfma_f32_16x16x32_bf16 a[152:155], a[80:83], a[0:3], 0
ds_read_b64_tr_b16 a[70:71], v30 offset:20992
v_mfma_f32_16x16x32_bf16 a[152:155], a[84:87], a[4:7], a[152:155]
v_mfma_f32_16x16x32_bf16 a[184:187], a[80:83], a[8:11], 0
v_mfma_f32_16x16x32_bf16 a[184:187], a[84:87], a[12:15], a[184:187]
buffer_load_dwordx4 v25, s[8:11], s41 offen offset:1024 lds
v_mfma_f32_16x16x32_bf16 a[216:219], a[80:83], a[16:19], 0
v_mfma_f32_16x16x32_bf16 a[216:219], a[84:87], a[20:23], a[216:219]
ds_read_b64_tr_b16 a[72:73], v30 offset:16392
v_mfma_f32_16x16x32_bf16 a[248:251], a[80:83], a[24:27], 0
ds_read_b64_tr_b16 a[74:75], v30 offset:16904
v_mfma_f32_16x16x32_bf16 a[248:251], a[84:87], a[28:31], a[248:251]
ds_read_b64_tr_b16 a[76:77], v30 offset:20488
v_mfma_f32_16x16x32_bf16 a[156:159], a[88:91], a[0:3], 0
ds_read_b64_tr_b16 a[78:79], v30 offset:21000
buffer_load_dwordx4 v26, s[8:11], s41 offen offset:2048 lds
v_mfma_f32_16x16x32_bf16 a[156:159], a[92:95], a[4:7], a[156:159]
v_mfma_f32_16x16x32_bf16 a[188:191], a[88:91], a[8:11], 0
v_mfma_f32_16x16x32_bf16 a[188:191], a[92:95], a[12:15], a[188:191]
v_mfma_f32_16x16x32_bf16 a[220:223], a[88:91], a[16:19], 0
v_mfma_f32_16x16x32_bf16 a[220:223], a[92:95], a[20:23], a[220:223]
ds_read_b64_tr_b16 a[80:81], v31 offset:16384
buffer_load_dwordx4 v27, s[8:11], s41 offen offset:3072 lds
v_mfma_f32_16x16x32_bf16 a[252:255], a[88:91], a[24:27], 0
ds_read_b64_tr_b16 a[82:83], v31 offset:16896
s_add_u32 s41, s41, 524032
v_mfma_f32_16x16x32_bf16 a[252:255], a[92:95], a[28:31], a[252:255]
ds_read_b64_tr_b16 a[84:85], v31 offset:20480
s_waitcnt lgkmcnt(7)
v_mfma_f32_16x16x32_bf16 v[128:131], a[64:67], a[32:35], v[128:131]
ds_read_b64_tr_b16 a[86:87], v31 offset:20992
v_mfma_f32_16x16x32_bf16 v[128:131], a[68:71], a[36:39], v[128:131]
s_add_u32 m0, s42, 16384
v_mfma_f32_16x16x32_bf16 v[160:163], a[64:67], a[40:43], v[160:163]
buffer_load_dwordx4 v20, s[4:7], s39 offen offset:0 lds
v_mfma_f32_16x16x32_bf16 v[160:163], a[68:71], a[44:47], v[160:163]
v_mfma_f32_16x16x32_bf16 v[192:195], a[64:67], a[48:51], v[192:195]
v_mfma_f32_16x16x32_bf16 v[192:195], a[68:71], a[52:55], v[192:195]
ds_read_b64_tr_b16 a[88:89], v31 offset:16392
v_mfma_f32_16x16x32_bf16 v[224:227], a[64:67], a[56:59], v[224:227]
ds_read_b64_tr_b16 a[90:91], v31 offset:16904
v_mfma_f32_16x16x32_bf16 v[224:227], a[68:71], a[60:63], v[224:227]
ds_read_b64_tr_b16 a[92:93], v31 offset:20488
s_waitcnt lgkmcnt(7)
buffer_load_dwordx4 v21, s[4:7], s39 offen offset:1024 lds
v_mfma_f32_16x16x32_bf16 v[132:135], a[72:75], a[32:35], v[132:135]
ds_read_b64_tr_b16 a[94:95], v31 offset:21000
v_mfma_f32_16x16x32_bf16 v[132:135], a[76:79], a[36:39], v[132:135]
v_mfma_f32_16x16x32_bf16 v[164:167], a[72:75], a[40:43], v[164:167]
v_mfma_f32_16x16x32_bf16 v[164:167], a[76:79], a[44:47], v[164:167]
v_mfma_f32_16x16x32_bf16 v[196:199], a[72:75], a[48:51], v[196:199]
ds_read_b64_tr_b16 a[64:65], v30 offset:24576
buffer_load_dwordx4 v22, s[4:7], s39 offen offset:2048 lds
v_mfma_f32_16x16x32_bf16 v[196:199], a[76:79], a[52:55], v[196:199]
ds_read_b64_tr_b16 a[66:67], v30 offset:25088
v_mfma_f32_16x16x32_bf16 v[228:231], a[72:75], a[56:59], v[228:231]
ds_read_b64_tr_b16 a[68:69], v30 offset:28672
v_mfma_f32_16x16x32_bf16 v[228:231], a[76:79], a[60:63], v[228:231]
ds_read_b64_tr_b16 a[70:71], v30 offset:29184
s_waitcnt lgkmcnt(8)
v_mfma_f32_16x16x32_bf16 v[136:139], a[80:83], a[32:35], v[136:139]
v_mfma_f32_16x16x32_bf16 v[136:139], a[84:87], a[36:39], v[136:139]
buffer_load_dwordx4 v23, s[4:7], s39 offen offset:3072 lds
v_mfma_f32_16x16x32_bf16 v[168:171], a[80:83], a[40:43], v[168:171]
v_mfma_f32_16x16x32_bf16 v[168:171], a[84:87], a[44:47], v[168:171]
ds_read_b64_tr_b16 a[72:73], v30 offset:24584
v_mfma_f32_16x16x32_bf16 v[200:203], a[80:83], a[48:51], v[200:203]
ds_read_b64_tr_b16 a[74:75], v30 offset:25096
v_mfma_f32_16x16x32_bf16 v[200:203], a[84:87], a[52:55], v[200:203]
ds_read_b64_tr_b16 a[76:77], v30 offset:28680
s_add_u32 m0, s42, 20480
v_mfma_f32_16x16x32_bf16 v[232:235], a[80:83], a[56:59], v[232:235]
ds_read_b64_tr_b16 a[78:79], v30 offset:29192
buffer_load_dwordx4 v20, s[4:7], s40 offen offset:0 lds
v_mfma_f32_16x16x32_bf16 v[232:235], a[84:87], a[60:63], v[232:235]
s_waitcnt lgkmcnt(8)
v_mfma_f32_16x16x32_bf16 v[140:143], a[88:91], a[32:35], v[140:143]
v_mfma_f32_16x16x32_bf16 v[140:143], a[92:95], a[36:39], v[140:143]
v_mfma_f32_16x16x32_bf16 v[172:175], a[88:91], a[40:43], v[172:175]
ds_read_b64_tr_b16 a[80:81], v31 offset:24576
v_mfma_f32_16x16x32_bf16 v[172:175], a[92:95], a[44:47], v[172:175]
ds_read_b64_tr_b16 a[82:83], v31 offset:25088
buffer_load_dwordx4 v21, s[4:7], s40 offen offset:1024 lds
v_mfma_f32_16x16x32_bf16 v[204:207], a[88:91], a[48:51], v[204:207]
ds_read_b64_tr_b16 a[84:85], v31 offset:28672
v_mfma_f32_16x16x32_bf16 v[204:207], a[92:95], a[52:55], v[204:207]
ds_read_b64_tr_b16 a[86:87], v31 offset:29184
v_mfma_f32_16x16x32_bf16 v[236:239], a[88:91], a[56:59], v[236:239]
v_mfma_f32_16x16x32_bf16 v[236:239], a[92:95], a[60:63], v[236:239]
s_waitcnt lgkmcnt(8)
v_mfma_f32_16x16x32_bf16 v[144:147], a[64:67], a[32:35], v[144:147]
buffer_load_dwordx4 v22, s[4:7], s40 offen offset:2048 lds
v_mfma_f32_16x16x32_bf16 v[144:147], a[68:71], a[36:39], v[144:147]
ds_read_b64_tr_b16 a[88:89], v31 offset:24584
v_mfma_f32_16x16x32_bf16 v[176:179], a[64:67], a[40:43], v[176:179]
ds_read_b64_tr_b16 a[90:91], v31 offset:25096
v_mfma_f32_16x16x32_bf16 v[176:179], a[68:71], a[44:47], v[176:179]
ds_read_b64_tr_b16 a[92:93], v31 offset:28680
v_mfma_f32_16x16x32_bf16 v[208:211], a[64:67], a[48:51], v[208:211]
ds_read_b64_tr_b16 a[94:95], v31 offset:29192
v_mfma_f32_16x16x32_bf16 v[208:211], a[68:71], a[52:55], v[208:211]
buffer_load_dwordx4 v23, s[4:7], s40 offen offset:3072 lds
v_mfma_f32_16x16x32_bf16 v[240:243], a[64:67], a[56:59], v[240:243]
s_add_u32 s39, s39, 128
s_add_u32 s40, s40, 128
s_add_u32 m0, s64, 0
s_mov_b32 s46, 16384
v_mfma_f32_16x16x32_bf16 v[240:243], a[68:71], a[60:63], v[240:243]
s_waitcnt lgkmcnt(8)
buffer_load_dwordx4 v101, s[24:27], s46 offen offset:2048 lds
v_mfma_f32_16x16x32_bf16 v[148:151], a[72:75], a[32:35], v[148:151]
v_mfma_f32_16x16x32_bf16 v[148:151], a[76:79], a[36:39], v[148:151]
s_add_u32 m0, s64, 0
s_mov_b32 s46, 24576
v_mfma_f32_16x16x32_bf16 v[180:183], a[72:75], a[40:43], v[180:183]
buffer_load_dwordx4 v101, s[24:27], s46 offen offset:3072 lds
v_mfma_f32_16x16x32_bf16 v[180:183], a[76:79], a[44:47], v[180:183]
s_waitcnt vmcnt(20) lgkmcnt(0)
v_mfma_f32_16x16x32_bf16 v[212:215], a[72:75], a[48:51], v[212:215]
s_barrier
v_mfma_f32_16x16x32_bf16 v[212:215], a[76:79], a[52:55], v[212:215]
ds_read_b64_tr_b16 a[64:65], v30 offset:32768
s_add_u32 m0, s33, 131072
v_mfma_f32_16x16x32_bf16 v[244:247], a[72:75], a[56:59], v[244:247]
ds_read_b64_tr_b16 a[66:67], v30 offset:33280
buffer_load_dwordx4 v24, s[8:11], s41 offen offset:0 lds
v_mfma_f32_16x16x32_bf16 v[244:247], a[76:79], a[60:63], v[244:247]
ds_read_b64_tr_b16 a[68:69], v30 offset:36864
v_mfma_f32_16x16x32_bf16 v[152:155], a[80:83], a[32:35], v[152:155]
ds_read_b64_tr_b16 a[70:71], v30 offset:37376
v_mfma_f32_16x16x32_bf16 v[152:155], a[84:87], a[36:39], v[152:155]
v_mfma_f32_16x16x32_bf16 v[184:187], a[80:83], a[40:43], v[184:187]
v_mfma_f32_16x16x32_bf16 v[184:187], a[84:87], a[44:47], v[184:187]
buffer_load_dwordx4 v25, s[8:11], s41 offen offset:1024 lds
v_mfma_f32_16x16x32_bf16 v[216:219], a[80:83], a[48:51], v[216:219]
v_mfma_f32_16x16x32_bf16 v[216:219], a[84:87], a[52:55], v[216:219]
ds_read_b64_tr_b16 a[72:73], v30 offset:32776
v_mfma_f32_16x16x32_bf16 v[248:251], a[80:83], a[56:59], v[248:251]
ds_read_b64_tr_b16 a[74:75], v30 offset:33288
v_mfma_f32_16x16x32_bf16 v[248:251], a[84:87], a[60:63], v[248:251]
ds_read_b64_tr_b16 a[76:77], v30 offset:36872
v_mfma_f32_16x16x32_bf16 v[156:159], a[88:91], a[32:35], v[156:159]
ds_read_b64_tr_b16 a[78:79], v30 offset:37384
buffer_load_dwordx4 v26, s[8:11], s41 offen offset:2048 lds
v_mfma_f32_16x16x32_bf16 v[156:159], a[92:95], a[36:39], v[156:159]
v_mfma_f32_16x16x32_bf16 v[188:191], a[88:91], a[40:43], v[188:191]
v_mfma_f32_16x16x32_bf16 v[188:191], a[92:95], a[44:47], v[188:191]
v_mfma_f32_16x16x32_bf16 v[220:223], a[88:91], a[48:51], v[220:223]
v_mfma_f32_16x16x32_bf16 v[220:223], a[92:95], a[52:55], v[220:223]
ds_read_b64_tr_b16 a[80:81], v31 offset:32768
buffer_load_dwordx4 v27, s[8:11], s41 offen offset:3072 lds
v_mfma_f32_16x16x32_bf16 v[252:255], a[88:91], a[56:59], v[252:255]
ds_read_b64_tr_b16 a[82:83], v31 offset:33280
s_add_u32 s41, s41, 256
v_mfma_f32_16x16x32_bf16 v[252:255], a[92:95], a[60:63], v[252:255]
ds_read_b64_tr_b16 a[84:85], v31 offset:36864
s_waitcnt lgkmcnt(7)
v_mfma_f32_16x16x32_bf16 a[128:131], a[64:67], a[32:35], a[128:131]
ds_read_b64_tr_b16 a[86:87], v31 offset:37376
v_mfma_f32_16x16x32_bf16 a[128:131], a[68:71], a[36:39], a[128:131]
v_mfma_f32_16x16x32_bf16 a[160:163], a[64:67], a[40:43], a[160:163]
v_mfma_f32_16x16x32_bf16 a[160:163], a[68:71], a[44:47], a[160:163]
v_mfma_f32_16x16x32_bf16 a[192:195], a[64:67], a[48:51], a[192:195]
v_mfma_f32_16x16x32_bf16 a[192:195], a[68:71], a[52:55], a[192:195]
ds_read_b64_tr_b16 a[88:89], v31 offset:32776
v_mfma_f32_16x16x32_bf16 a[224:227], a[64:67], a[56:59], a[224:227]
ds_read_b64_tr_b16 a[90:91], v31 offset:33288
v_mfma_f32_16x16x32_bf16 a[224:227], a[68:71], a[60:63], a[224:227]
ds_read_b64_tr_b16 a[92:93], v31 offset:36872
s_waitcnt lgkmcnt(7)
v_mfma_f32_16x16x32_bf16 a[132:135], a[72:75], a[32:35], a[132:135]
ds_read_b64_tr_b16 a[94:95], v31 offset:37384
v_mfma_f32_16x16x32_bf16 a[132:135], a[76:79], a[36:39], a[132:135]
ds_read_b128 a[0:3], v18 offset:0
v_mfma_f32_16x16x32_bf16 a[164:167], a[72:75], a[40:43], a[164:167]
ds_read_b128 a[4:7], v19 offset:0
v_mfma_f32_16x16x32_bf16 a[164:167], a[76:79], a[44:47], a[164:167]
s_add_u32 m0, s64, 4096
s_mov_b32 s46, 512
v_mfma_f32_16x16x32_bf16 a[196:199], a[72:75], a[48:51], a[196:199]
ds_read_b64_tr_b16 a[64:65], v30 offset:40960
buffer_load_dwordx4 v101, s[24:27], s46 offen offset:0 lds
v_mfma_f32_16x16x32_bf16 a[196:199], a[76:79], a[52:55], a[196:199]
ds_read_b64_tr_b16 a[66:67], v30 offset:41472
v_mfma_f32_16x16x32_bf16 a[228:231], a[72:75], a[56:59], a[228:231]
ds_read_b64_tr_b16 a[68:69], v30 offset:45056
v_mfma_f32_16x16x32_bf16 a[228:231], a[76:79], a[60:63], a[228:231]
ds_read_b64_tr_b16 a[70:71], v30 offset:45568
s_waitcnt lgkmcnt(10)
v_mfma_f32_16x16x32_bf16 a[136:139], a[80:83], a[32:35], a[136:139]
ds_read_b128 a[8:11], v18 offset:2048
v_mfma_f32_16x16x32_bf16 a[136:139], a[84:87], a[36:39], a[136:139]
ds_read_b128 a[12:15], v19 offset:2048
v_mfma_f32_16x16x32_bf16 a[168:171], a[80:83], a[40:43], a[168:171]
v_mfma_f32_16x16x32_bf16 a[168:171], a[84:87], a[44:47], a[168:171]
ds_read_b64_tr_b16 a[72:73], v30 offset:40968
v_mfma_f32_16x16x32_bf16 a[200:203], a[80:83], a[48:51], a[200:203]
ds_read_b64_tr_b16 a[74:75], v30 offset:41480
v_mfma_f32_16x16x32_bf16 a[200:203], a[84:87], a[52:55], a[200:203]
ds_read_b64_tr_b16 a[76:77], v30 offset:45064
v_mfma_f32_16x16x32_bf16 a[232:235], a[80:83], a[56:59], a[232:235]
ds_read_b64_tr_b16 a[78:79], v30 offset:45576
v_mfma_f32_16x16x32_bf16 a[232:235], a[84:87], a[60:63], a[232:235]
ds_read_b128 a[16:19], v18 offset:4096
s_waitcnt lgkmcnt(13)
v_mfma_f32_16x16x32_bf16 a[140:143], a[88:91], a[32:35], a[140:143]
ds_read_b128 a[20:23], v19 offset:4096
v_mfma_f32_16x16x32_bf16 a[140:143], a[92:95], a[36:39], a[140:143]
v_mfma_f32_16x16x32_bf16 a[172:175], a[88:91], a[40:43], a[172:175]
ds_read_b64_tr_b16 a[80:81], v31 offset:40960
v_mfma_f32_16x16x32_bf16 a[172:175], a[92:95], a[44:47], a[172:175]
ds_read_b64_tr_b16 a[82:83], v31 offset:41472
v_mfma_f32_16x16x32_bf16 a[204:207], a[88:91], a[48:51], a[204:207]
ds_read_b64_tr_b16 a[84:85], v31 offset:45056
v_mfma_f32_16x16x32_bf16 a[204:207], a[92:95], a[52:55], a[204:207]
ds_read_b64_tr_b16 a[86:87], v31 offset:45568
v_mfma_f32_16x16x32_bf16 a[236:239], a[88:91], a[56:59], a[236:239]
ds_read_b128 a[24:27], v18 offset:6144
v_mfma_f32_16x16x32_bf16 a[236:239], a[92:95], a[60:63], a[236:239]
ds_read_b128 a[28:31], v19 offset:6144
s_waitcnt lgkmcnt(14)
s_add_u32 m0, s64, 4096
s_mov_b32 s46, 8704
v_mfma_f32_16x16x32_bf16 a[144:147], a[64:67], a[32:35], a[144:147]
buffer_load_dwordx4 v101, s[24:27], s46 offen offset:1024 lds
v_mfma_f32_16x16x32_bf16 a[144:147], a[68:71], a[36:39], a[144:147]
ds_read_b64_tr_b16 a[88:89], v31 offset:40968
v_mfma_f32_16x16x32_bf16 a[176:179], a[64:67], a[40:43], a[176:179]
ds_read_b64_tr_b16 a[90:91], v31 offset:41480
v_mfma_f32_16x16x32_bf16 a[176:179], a[68:71], a[44:47], a[176:179]
ds_read_b64_tr_b16 a[92:93], v31 offset:45064
v_mfma_f32_16x16x32_bf16 a[208:211], a[64:67], a[48:51], a[208:211]
ds_read_b64_tr_b16 a[94:95], v31 offset:45576
v_mfma_f32_16x16x32_bf16 a[208:211], a[68:71], a[52:55], a[208:211]
v_mfma_f32_16x16x32_bf16 a[240:243], a[64:67], a[56:59], a[240:243]
v_mfma_f32_16x16x32_bf16 a[240:243], a[68:71], a[60:63], a[240:243]
s_waitcnt lgkmcnt(12)
v_mfma_f32_16x16x32_bf16 a[148:151], a[72:75], a[32:35], a[148:151]
v_mfma_f32_16x16x32_bf16 a[148:151], a[76:79], a[36:39], a[148:151]
v_mfma_f32_16x16x32_bf16 a[180:183], a[72:75], a[40:43], a[180:183]
v_mfma_f32_16x16x32_bf16 a[180:183], a[76:79], a[44:47], a[180:183]
s_waitcnt vmcnt(22) lgkmcnt(0)
v_mfma_f32_16x16x32_bf16 a[212:215], a[72:75], a[48:51], a[212:215]
s_barrier
v_mfma_f32_16x16x32_bf16 a[212:215], a[76:79], a[52:55], a[212:215]
ds_read_b64_tr_b16 a[64:65], v28 offset:0
s_add_u32 m0, s33, 147456
v_mfma_f32_16x16x32_bf16 a[244:247], a[72:75], a[56:59], a[244:247]
ds_read_b64_tr_b16 a[66:67], v28 offset:512
buffer_load_dwordx4 v24, s[8:11], s41 offen offset:0 lds
v_mfma_f32_16x16x32_bf16 a[244:247], a[76:79], a[60:63], a[244:247]
ds_read_b64_tr_b16 a[68:69], v28 offset:4096
v_mfma_f32_16x16x32_bf16 a[152:155], a[80:83], a[32:35], a[152:155]
ds_read_b64_tr_b16 a[70:71], v28 offset:4608
v_mfma_f32_16x16x32_bf16 a[152:155], a[84:87], a[36:39], a[152:155]
v_mfma_f32_16x16x32_bf16 a[184:187], a[80:83], a[40:43], a[184:187]
v_mfma_f32_16x16x32_bf16 a[184:187], a[84:87], a[44:47], a[184:187]
buffer_load_dwordx4 v25, s[8:11], s41 offen offset:1024 lds
v_mfma_f32_16x16x32_bf16 a[216:219], a[80:83], a[48:51], a[216:219]
v_mfma_f32_16x16x32_bf16 a[216:219], a[84:87], a[52:55], a[216:219]
ds_read_b64_tr_b16 a[72:73], v28 offset:8
v_mfma_f32_16x16x32_bf16 a[248:251], a[80:83], a[56:59], a[248:251]
ds_read_b64_tr_b16 a[74:75], v28 offset:520
v_mfma_f32_16x16x32_bf16 a[248:251], a[84:87], a[60:63], a[248:251]
ds_read_b64_tr_b16 a[76:77], v28 offset:4104
v_mfma_f32_16x16x32_bf16 a[156:159], a[88:91], a[32:35], a[156:159]
ds_read_b64_tr_b16 a[78:79], v28 offset:4616
buffer_load_dwordx4 v26, s[8:11], s41 offen offset:2048 lds
v_mfma_f32_16x16x32_bf16 a[156:159], a[92:95], a[36:39], a[156:159]
v_mfma_f32_16x16x32_bf16 a[188:191], a[88:91], a[40:43], a[188:191]
v_mfma_f32_16x16x32_bf16 a[188:191], a[92:95], a[44:47], a[188:191]
v_mfma_f32_16x16x32_bf16 a[220:223], a[88:91], a[48:51], a[220:223]
v_mfma_f32_16x16x32_bf16 a[220:223], a[92:95], a[52:55], a[220:223]
ds_read_b64_tr_b16 a[80:81], v29 offset:0
buffer_load_dwordx4 v27, s[8:11], s41 offen offset:3072 lds
v_mfma_f32_16x16x32_bf16 a[252:255], a[88:91], a[56:59], a[252:255]
ds_read_b64_tr_b16 a[82:83], v29 offset:512
s_add_u32 s41, s41, 524032
v_mfma_f32_16x16x32_bf16 a[252:255], a[92:95], a[60:63], a[252:255]
ds_read_b64_tr_b16 a[84:85], v29 offset:4096
s_waitcnt lgkmcnt(7)
v_mfma_f32_16x16x32_bf16 v[128:131], a[64:67], a[0:3], v[128:131]
ds_read_b64_tr_b16 a[86:87], v29 offset:4608
v_mfma_f32_16x16x32_bf16 v[128:131], a[68:71], a[4:7], v[128:131]
s_add_u32 m0, s42, 81920
v_mfma_f32_16x16x32_bf16 v[160:163], a[64:67], a[8:11], v[160:163]
buffer_load_dwordx4 v20, s[4:7], s39 offen offset:0 lds
v_mfma_f32_16x16x32_bf16 v[160:163], a[68:71], a[12:15], v[160:163]
v_mfma_f32_16x16x32_bf16 v[192:195], a[64:67], a[16:19], v[192:195]
v_mfma_f32_16x16x32_bf16 v[192:195], a[68:71], a[20:23], v[192:195]
ds_read_b64_tr_b16 a[88:89], v29 offset:8
v_mfma_f32_16x16x32_bf16 v[224:227], a[64:67], a[24:27], v[224:227]
ds_read_b64_tr_b16 a[90:91], v29 offset:520
v_mfma_f32_16x16x32_bf16 v[224:227], a[68:71], a[28:31], v[224:227]
ds_read_b64_tr_b16 a[92:93], v29 offset:4104
s_waitcnt lgkmcnt(7)
buffer_load_dwordx4 v21, s[4:7], s39 offen offset:1024 lds
v_mfma_f32_16x16x32_bf16 v[132:135], a[72:75], a[0:3], v[132:135]
ds_read_b64_tr_b16 a[94:95], v29 offset:4616
v_mfma_f32_16x16x32_bf16 v[132:135], a[76:79], a[4:7], v[132:135]
v_mfma_f32_16x16x32_bf16 v[164:167], a[72:75], a[8:11], v[164:167]
v_mfma_f32_16x16x32_bf16 v[164:167], a[76:79], a[12:15], v[164:167]
v_mfma_f32_16x16x32_bf16 v[196:199], a[72:75], a[16:19], v[196:199]
ds_read_b64_tr_b16 a[64:65], v28 offset:8192
buffer_load_dwordx4 v22, s[4:7], s39 offen offset:2048 lds
v_mfma_f32_16x16x32_bf16 v[196:199], a[76:79], a[20:23], v[196:199]
ds_read_b64_tr_b16 a[66:67], v28 offset:8704
v_mfma_f32_16x16x32_bf16 v[228:231], a[72:75], a[24:27], v[228:231]
ds_read_b64_tr_b16 a[68:69], v28 offset:12288
v_mfma_f32_16x16x32_bf16 v[228:231], a[76:79], a[28:31], v[228:231]
ds_read_b64_tr_b16 a[70:71], v28 offset:12800
s_waitcnt lgkmcnt(8)
v_mfma_f32_16x16x32_bf16 v[136:139], a[80:83], a[0:3], v[136:139]
v_mfma_f32_16x16x32_bf16 v[136:139], a[84:87], a[4:7], v[136:139]
buffer_load_dwordx4 v23, s[4:7], s39 offen offset:3072 lds
v_mfma_f32_16x16x32_bf16 v[168:171], a[80:83], a[8:11], v[168:171]
v_mfma_f32_16x16x32_bf16 v[168:171], a[84:87], a[12:15], v[168:171]
ds_read_b64_tr_b16 a[72:73], v28 offset:8200
v_mfma_f32_16x16x32_bf16 v[200:203], a[80:83], a[16:19], v[200:203]
ds_read_b64_tr_b16 a[74:75], v28 offset:8712
v_mfma_f32_16x16x32_bf16 v[200:203], a[84:87], a[20:23], v[200:203]
ds_read_b64_tr_b16 a[76:77], v28 offset:12296
s_add_u32 m0, s42, 86016
v_mfma_f32_16x16x32_bf16 v[232:235], a[80:83], a[24:27], v[232:235]
ds_read_b64_tr_b16 a[78:79], v28 offset:12808
buffer_load_dwordx4 v20, s[4:7], s40 offen offset:0 lds
v_mfma_f32_16x16x32_bf16 v[232:235], a[84:87], a[28:31], v[232:235]
s_waitcnt lgkmcnt(8)
v_mfma_f32_16x16x32_bf16 v[140:143], a[88:91], a[0:3], v[140:143]
v_mfma_f32_16x16x32_bf16 v[140:143], a[92:95], a[4:7], v[140:143]
v_mfma_f32_16x16x32_bf16 v[172:175], a[88:91], a[8:11], v[172:175]
ds_read_b64_tr_b16 a[80:81], v29 offset:8192
v_mfma_f32_16x16x32_bf16 v[172:175], a[92:95], a[12:15], v[172:175]
ds_read_b64_tr_b16 a[82:83], v29 offset:8704
buffer_load_dwordx4 v21, s[4:7], s40 offen offset:1024 lds
v_mfma_f32_16x16x32_bf16 v[204:207], a[88:91], a[16:19], v[204:207]
ds_read_b64_tr_b16 a[84:85], v29 offset:12288
v_mfma_f32_16x16x32_bf16 v[204:207], a[92:95], a[20:23], v[204:207]
ds_read_b64_tr_b16 a[86:87], v29 offset:12800
v_mfma_f32_16x16x32_bf16 v[236:239], a[88:91], a[24:27], v[236:239]
v_mfma_f32_16x16x32_bf16 v[236:239], a[92:95], a[28:31], v[236:239]
s_waitcnt lgkmcnt(8)
v_mfma_f32_16x16x32_bf16 v[144:147], a[64:67], a[0:3], v[144:147]
buffer_load_dwordx4 v22, s[4:7], s40 offen offset:2048 lds
v_mfma_f32_16x16x32_bf16 v[144:147], a[68:71], a[4:7], v[144:147]
ds_read_b64_tr_b16 a[88:89], v29 offset:8200
v_mfma_f32_16x16x32_bf16 v[176:179], a[64:67], a[8:11], v[176:179]
ds_read_b64_tr_b16 a[90:91], v29 offset:8712
v_mfma_f32_16x16x32_bf16 v[176:179], a[68:71], a[12:15], v[176:179]
ds_read_b64_tr_b16 a[92:93], v29 offset:12296
v_mfma_f32_16x16x32_bf16 v[208:211], a[64:67], a[16:19], v[208:211]
ds_read_b64_tr_b16 a[94:95], v29 offset:12808
v_mfma_f32_16x16x32_bf16 v[208:211], a[68:71], a[20:23], v[208:211]
buffer_load_dwordx4 v23, s[4:7], s40 offen offset:3072 lds
v_mfma_f32_16x16x32_bf16 v[240:243], a[64:67], a[24:27], v[240:243]
s_add_u32 s39, s39, 128
s_add_u32 s40, s40, 128
s_add_u32 m0, s64, 4096
s_mov_b32 s46, 16896
v_mfma_f32_16x16x32_bf16 v[240:243], a[68:71], a[28:31], v[240:243]
s_waitcnt lgkmcnt(8)
buffer_load_dwordx4 v101, s[24:27], s46 offen offset:2048 lds
v_mfma_f32_16x16x32_bf16 v[148:151], a[72:75], a[0:3], v[148:151]
v_mfma_f32_16x16x32_bf16 v[148:151], a[76:79], a[4:7], v[148:151]
s_add_u32 m0, s64, 4096
s_mov_b32 s46, 25088
v_mfma_f32_16x16x32_bf16 v[180:183], a[72:75], a[8:11], v[180:183]
buffer_load_dwordx4 v101, s[24:27], s46 offen offset:3072 lds
v_mfma_f32_16x16x32_bf16 v[180:183], a[76:79], a[12:15], v[180:183]
s_waitcnt vmcnt(22) lgkmcnt(0)
v_mfma_f32_16x16x32_bf16 v[212:215], a[72:75], a[16:19], v[212:215]
s_barrier
v_mfma_f32_16x16x32_bf16 v[212:215], a[76:79], a[20:23], v[212:215]
ds_read_b64_tr_b16 a[64:65], v30 offset:0
s_add_u32 m0, s33, 49152
v_mfma_f32_16x16x32_bf16 v[244:247], a[72:75], a[24:27], v[244:247]
ds_read_b64_tr_b16 a[66:67], v30 offset:512
buffer_load_dwordx4 v24, s[8:11], s41 offen offset:0 lds
v_mfma_f32_16x16x32_bf16 v[244:247], a[76:79], a[28:31], v[244:247]
ds_read_b64_tr_b16 a[68:69], v30 offset:4096
v_mfma_f32_16x16x32_bf16 v[152:155], a[80:83], a[0:3], v[152:155]
ds_read_b64_tr_b16 a[70:71], v30 offset:4608
v_mfma_f32_16x16x32_bf16 v[152:155], a[84:87], a[4:7], v[152:155]
v_mfma_f32_16x16x32_bf16 v[184:187], a[80:83], a[8:11], v[184:187]
v_mfma_f32_16x16x32_bf16 v[184:187], a[84:87], a[12:15], v[184:187]
buffer_load_dwordx4 v25, s[8:11], s41 offen offset:1024 lds
v_mfma_f32_16x16x32_bf16 v[216:219], a[80:83], a[16:19], v[216:219]
v_mfma_f32_16x16x32_bf16 v[216:219], a[84:87], a[20:23], v[216:219]
ds_read_b64_tr_b16 a[72:73], v30 offset:8
v_mfma_f32_16x16x32_bf16 v[248:251], a[80:83], a[24:27], v[248:251]
ds_read_b64_tr_b16 a[74:75], v30 offset:520
v_mfma_f32_16x16x32_bf16 v[248:251], a[84:87], a[28:31], v[248:251]
ds_read_b64_tr_b16 a[76:77], v30 offset:4104
v_mfma_f32_16x16x32_bf16 v[156:159], a[88:91], a[0:3], v[156:159]
ds_read_b64_tr_b16 a[78:79], v30 offset:4616
buffer_load_dwordx4 v26, s[8:11], s41 offen offset:2048 lds
v_mfma_f32_16x16x32_bf16 v[156:159], a[92:95], a[4:7], v[156:159]
v_mfma_f32_16x16x32_bf16 v[188:191], a[88:91], a[8:11], v[188:191]
v_mfma_f32_16x16x32_bf16 v[188:191], a[92:95], a[12:15], v[188:191]
v_mfma_f32_16x16x32_bf16 v[220:223], a[88:91], a[16:19], v[220:223]
v_mfma_f32_16x16x32_bf16 v[220:223], a[92:95], a[20:23], v[220:223]
ds_read_b64_tr_b16 a[80:81], v31 offset:0
buffer_load_dwordx4 v27, s[8:11], s41 offen offset:3072 lds
v_mfma_f32_16x16x32_bf16 v[252:255], a[88:91], a[24:27], v[252:255]
ds_read_b64_tr_b16 a[82:83], v31 offset:512
s_add_u32 s41, s41, 256
v_mfma_f32_16x16x32_bf16 v[252:255], a[92:95], a[28:31], v[252:255]
ds_read_b64_tr_b16 a[84:85], v31 offset:4096
s_waitcnt lgkmcnt(7)
v_mfma_f32_16x16x32_bf16 a[128:131], a[64:67], a[0:3], a[128:131]
ds_read_b64_tr_b16 a[86:87], v31 offset:4608
v_mfma_f32_16x16x32_bf16 a[128:131], a[68:71], a[4:7], a[128:131]
v_mfma_f32_16x16x32_bf16 a[160:163], a[64:67], a[8:11], a[160:163]
v_mfma_f32_16x16x32_bf16 a[160:163], a[68:71], a[12:15], a[160:163]
v_mfma_f32_16x16x32_bf16 a[192:195], a[64:67], a[16:19], a[192:195]
v_mfma_f32_16x16x32_bf16 a[192:195], a[68:71], a[20:23], a[192:195]
ds_read_b64_tr_b16 a[88:89], v31 offset:8
v_mfma_f32_16x16x32_bf16 a[224:227], a[64:67], a[24:27], a[224:227]
ds_read_b64_tr_b16 a[90:91], v31 offset:520
v_mfma_f32_16x16x32_bf16 a[224:227], a[68:71], a[28:31], a[224:227]
ds_read_b64_tr_b16 a[92:93], v31 offset:4104
s_waitcnt lgkmcnt(7)
v_mfma_f32_16x16x32_bf16 a[132:135], a[72:75], a[0:3], a[132:135]
ds_read_b64_tr_b16 a[94:95], v31 offset:4616
v_mfma_f32_16x16x32_bf16 a[132:135], a[76:79], a[4:7], a[132:135]
ds_read_b128 a[32:35], v16 offset:0
v_mfma_f32_16x16x32_bf16 a[164:167], a[72:75], a[8:11], a[164:167]
ds_read_b128 a[36:39], v17 offset:0
v_mfma_f32_16x16x32_bf16 a[164:167], a[76:79], a[12:15], a[164:167]
s_mov_b32 m0, s65
v_mfma_f32_16x16x32_bf16 a[196:199], a[72:75], a[16:19], a[196:199]
ds_read_b64_tr_b16 a[64:65], v30 offset:8192
buffer_load_dwordx4 v102, s[24:27], 0 offen offset:0 lds
v_mfma_f32_16x16x32_bf16 a[196:199], a[76:79], a[20:23], a[196:199]
ds_read_b64_tr_b16 a[66:67], v30 offset:8704
v_mfma_f32_16x16x32_bf16 a[228:231], a[72:75], a[24:27], a[228:231]
ds_read_b64_tr_b16 a[68:69], v30 offset:12288
v_mfma_f32_16x16x32_bf16 a[228:231], a[76:79], a[28:31], a[228:231]
ds_read_b64_tr_b16 a[70:71], v30 offset:12800
s_waitcnt lgkmcnt(10)
v_mfma_f32_16x16x32_bf16 a[136:139], a[80:83], a[0:3], a[136:139]
ds_read_b128 a[40:43], v16 offset:2048
v_mfma_f32_16x16x32_bf16 a[136:139], a[84:87], a[4:7], a[136:139]
ds_read_b128 a[44:47], v17 offset:2048
v_mfma_f32_16x16x32_bf16 a[168:171], a[80:83], a[8:11], a[168:171]
v_mfma_f32_16x16x32_bf16 a[168:171], a[84:87], a[12:15], a[168:171]
ds_read_b64_tr_b16 a[72:73], v30 offset:8200
v_mfma_f32_16x16x32_bf16 a[200:203], a[80:83], a[16:19], a[200:203]
ds_read_b64_tr_b16 a[74:75], v30 offset:8712
v_mfma_f32_16x16x32_bf16 a[200:203], a[84:87], a[20:23], a[200:203]
ds_read_b64_tr_b16 a[76:77], v30 offset:12296
v_mfma_f32_16x16x32_bf16 a[232:235], a[80:83], a[24:27], a[232:235]
ds_read_b64_tr_b16 a[78:79], v30 offset:12808
v_mfma_f32_16x16x32_bf16 a[232:235], a[84:87], a[28:31], a[232:235]
ds_read_b128 a[48:51], v16 offset:4096
s_waitcnt lgkmcnt(13)
v_mfma_f32_16x16x32_bf16 a[140:143], a[88:91], a[0:3], a[140:143]
ds_read_b128 a[52:55], v17 offset:4096
v_mfma_f32_16x16x32_bf16 a[140:143], a[92:95], a[4:7], a[140:143]
v_mfma_f32_16x16x32_bf16 a[172:175], a[88:91], a[8:11], a[172:175]
ds_read_b64_tr_b16 a[80:81], v31 offset:8192
v_mfma_f32_16x16x32_bf16 a[172:175], a[92:95], a[12:15], a[172:175]
ds_read_b64_tr_b16 a[82:83], v31 offset:8704
v_mfma_f32_16x16x32_bf16 a[204:207], a[88:91], a[16:19], a[204:207]
ds_read_b64_tr_b16 a[84:85], v31 offset:12288
v_mfma_f32_16x16x32_bf16 a[204:207], a[92:95], a[20:23], a[204:207]
ds_read_b64_tr_b16 a[86:87], v31 offset:12800
v_mfma_f32_16x16x32_bf16 a[236:239], a[88:91], a[24:27], a[236:239]
ds_read_b128 a[56:59], v16 offset:6144
v_mfma_f32_16x16x32_bf16 a[236:239], a[92:95], a[28:31], a[236:239]
ds_read_b128 a[60:63], v17 offset:6144
s_waitcnt lgkmcnt(14)
v_mfma_f32_16x16x32_bf16 a[144:147], a[64:67], a[0:3], a[144:147]
v_mfma_f32_16x16x32_bf16 a[144:147], a[68:71], a[4:7], a[144:147]
ds_read_b64_tr_b16 a[88:89], v31 offset:8200
v_mfma_f32_16x16x32_bf16 a[176:179], a[64:67], a[8:11], a[176:179]
ds_read_b64_tr_b16 a[90:91], v31 offset:8712
v_mfma_f32_16x16x32_bf16 a[176:179], a[68:71], a[12:15], a[176:179]
ds_read_b64_tr_b16 a[92:93], v31 offset:12296
v_mfma_f32_16x16x32_bf16 a[208:211], a[64:67], a[16:19], a[208:211]
ds_read_b64_tr_b16 a[94:95], v31 offset:12808
v_mfma_f32_16x16x32_bf16 a[208:211], a[68:71], a[20:23], a[208:211]
v_mfma_f32_16x16x32_bf16 a[240:243], a[64:67], a[24:27], a[240:243]
v_mfma_f32_16x16x32_bf16 a[240:243], a[68:71], a[28:31], a[240:243]
s_waitcnt lgkmcnt(12)
v_mfma_f32_16x16x32_bf16 a[148:151], a[72:75], a[0:3], a[148:151]
v_mfma_f32_16x16x32_bf16 a[148:151], a[76:79], a[4:7], a[148:151]
v_mfma_f32_16x16x32_bf16 a[180:183], a[72:75], a[8:11], a[180:183]
v_mfma_f32_16x16x32_bf16 a[180:183], a[76:79], a[12:15], a[180:183]
s_waitcnt vmcnt(21) lgkmcnt(0)
v_mfma_f32_16x16x32_bf16 a[212:215], a[72:75], a[16:19], a[212:215]
s_barrier
v_mfma_f32_16x16x32_bf16 a[212:215], a[76:79], a[20:23], a[212:215]
ds_read_b64_tr_b16 a[64:65], v30 offset:16384
s_add_u32 m0, s33, 114688
v_mfma_f32_16x16x32_bf16 a[244:247], a[72:75], a[24:27], a[244:247]
ds_read_b64_tr_b16 a[66:67], v30 offset:16896
buffer_load_dwordx4 v24, s[8:11], s41 offen offset:0 lds
v_mfma_f32_16x16x32_bf16 a[244:247], a[76:79], a[28:31], a[244:247]
ds_read_b64_tr_b16 a[68:69], v30 offset:20480
v_mfma_f32_16x16x32_bf16 a[152:155], a[80:83], a[0:3], a[152:155]
ds_read_b64_tr_b16 a[70:71], v30 offset:20992
v_mfma_f32_16x16x32_bf16 a[152:155], a[84:87], a[4:7], a[152:155]
v_mfma_f32_16x16x32_bf16 a[184:187], a[80:83], a[8:11], a[184:187]
v_mfma_f32_16x16x32_bf16 a[184:187], a[84:87], a[12:15], a[184:187]
buffer_load_dwordx4 v25, s[8:11], s41 offen offset:1024 lds
v_mfma_f32_16x16x32_bf16 a[216:219], a[80:83], a[16:19], a[216:219]
v_mfma_f32_16x16x32_bf16 a[216:219], a[84:87], a[20:23], a[216:219]
ds_read_b64_tr_b16 a[72:73], v30 offset:16392
v_mfma_f32_16x16x32_bf16 a[248:251], a[80:83], a[24:27], a[248:251]
ds_read_b64_tr_b16 a[74:75], v30 offset:16904
v_mfma_f32_16x16x32_bf16 a[248:251], a[84:87], a[28:31], a[248:251]
ds_read_b64_tr_b16 a[76:77], v30 offset:20488
v_mfma_f32_16x16x32_bf16 a[156:159], a[88:91], a[0:3], a[156:159]
ds_read_b64_tr_b16 a[78:79], v30 offset:21000
buffer_load_dwordx4 v26, s[8:11], s41 offen offset:2048 lds
v_mfma_f32_16x16x32_bf16 a[156:159], a[92:95], a[4:7], a[156:159]
v_mfma_f32_16x16x32_bf16 a[188:191], a[88:91], a[8:11], a[188:191]
v_mfma_f32_16x16x32_bf16 a[188:191], a[92:95], a[12:15], a[188:191]
v_mfma_f32_16x16x32_bf16 a[220:223], a[88:91], a[16:19], a[220:223]
v_mfma_f32_16x16x32_bf16 a[220:223], a[92:95], a[20:23], a[220:223]
ds_read_b64_tr_b16 a[80:81], v31 offset:16384
buffer_load_dwordx4 v27, s[8:11], s41 offen offset:3072 lds
v_mfma_f32_16x16x32_bf16 a[252:255], a[88:91], a[24:27], a[252:255]
ds_read_b64_tr_b16 a[82:83], v31 offset:16896
s_add_u32 s41, s41, 524032
v_mfma_f32_16x16x32_bf16 a[252:255], a[92:95], a[28:31], a[252:255]
ds_read_b64_tr_b16 a[84:85], v31 offset:20480
s_waitcnt lgkmcnt(7)
v_mfma_f32_16x16x32_bf16 v[128:131], a[64:67], a[32:35], v[128:131]
ds_read_b64_tr_b16 a[86:87], v31 offset:20992
v_mfma_f32_16x16x32_bf16 v[128:131], a[68:71], a[36:39], v[128:131]
s_add_u32 m0, s42, 16384
v_mfma_f32_16x16x32_bf16 v[160:163], a[64:67], a[40:43], v[160:163]
buffer_load_dwordx4 v20, s[4:7], s39 offen offset:0 lds
v_mfma_f32_16x16x32_bf16 v[160:163], a[68:71], a[44:47], v[160:163]
v_mfma_f32_16x16x32_bf16 v[192:195], a[64:67], a[48:51], v[192:195]
v_mfma_f32_16x16x32_bf16 v[192:195], a[68:71], a[52:55], v[192:195]
ds_read_b64_tr_b16 a[88:89], v31 offset:16392
v_mfma_f32_16x16x32_bf16 v[224:227], a[64:67], a[56:59], v[224:227]
ds_read_b64_tr_b16 a[90:91], v31 offset:16904
v_mfma_f32_16x16x32_bf16 v[224:227], a[68:71], a[60:63], v[224:227]
ds_read_b64_tr_b16 a[92:93], v31 offset:20488
s_waitcnt lgkmcnt(7)
buffer_load_dwordx4 v21, s[4:7], s39 offen offset:1024 lds
v_mfma_f32_16x16x32_bf16 v[132:135], a[72:75], a[32:35], v[132:135]
ds_read_b64_tr_b16 a[94:95], v31 offset:21000
v_mfma_f32_16x16x32_bf16 v[132:135], a[76:79], a[36:39], v[132:135]
v_mfma_f32_16x16x32_bf16 v[164:167], a[72:75], a[40:43], v[164:167]
v_mfma_f32_16x16x32_bf16 v[164:167], a[76:79], a[44:47], v[164:167]
v_mfma_f32_16x16x32_bf16 v[196:199], a[72:75], a[48:51], v[196:199]
ds_read_b64_tr_b16 a[64:65], v30 offset:24576
buffer_load_dwordx4 v22, s[4:7], s39 offen offset:2048 lds
v_mfma_f32_16x16x32_bf16 v[196:199], a[76:79], a[52:55], v[196:199]
ds_read_b64_tr_b16 a[66:67], v30 offset:25088
v_mfma_f32_16x16x32_bf16 v[228:231], a[72:75], a[56:59], v[228:231]
ds_read_b64_tr_b16 a[68:69], v30 offset:28672
v_mfma_f32_16x16x32_bf16 v[228:231], a[76:79], a[60:63], v[228:231]
ds_read_b64_tr_b16 a[70:71], v30 offset:29184
s_waitcnt lgkmcnt(8)
v_mfma_f32_16x16x32_bf16 v[136:139], a[80:83], a[32:35], v[136:139]
v_mfma_f32_16x16x32_bf16 v[136:139], a[84:87], a[36:39], v[136:139]
buffer_load_dwordx4 v23, s[4:7], s39 offen offset:3072 lds
v_mfma_f32_16x16x32_bf16 v[168:171], a[80:83], a[40:43], v[168:171]
v_mfma_f32_16x16x32_bf16 v[168:171], a[84:87], a[44:47], v[168:171]
ds_read_b64_tr_b16 a[72:73], v30 offset:24584
v_mfma_f32_16x16x32_bf16 v[200:203], a[80:83], a[48:51], v[200:203]
ds_read_b64_tr_b16 a[74:75], v30 offset:25096
v_mfma_f32_16x16x32_bf16 v[200:203], a[84:87], a[52:55], v[200:203]
ds_read_b64_tr_b16 a[76:77], v30 offset:28680
s_add_u32 m0, s42, 20480
v_mfma_f32_16x16x32_bf16 v[232:235], a[80:83], a[56:59], v[232:235]
ds_read_b64_tr_b16 a[78:79], v30 offset:29192
buffer_load_dwordx4 v20, s[4:7], s40 offen offset:0 lds
v_mfma_f32_16x16x32_bf16 v[232:235], a[84:87], a[60:63], v[232:235]
s_waitcnt lgkmcnt(8)
v_mfma_f32_16x16x32_bf16 v[140:143], a[88:91], a[32:35], v[140:143]
v_mfma_f32_16x16x32_bf16 v[140:143], a[92:95], a[36:39], v[140:143]
v_mfma_f32_16x16x32_bf16 v[172:175], a[88:91], a[40:43], v[172:175]
ds_read_b64_tr_b16 a[80:81], v31 offset:24576
v_mfma_f32_16x16x32_bf16 v[172:175], a[92:95], a[44:47], v[172:175]
ds_read_b64_tr_b16 a[82:83], v31 offset:25088
buffer_load_dwordx4 v21, s[4:7], s40 offen offset:1024 lds
v_mfma_f32_16x16x32_bf16 v[204:207], a[88:91], a[48:51], v[204:207]
ds_read_b64_tr_b16 a[84:85], v31 offset:28672
v_mfma_f32_16x16x32_bf16 v[204:207], a[92:95], a[52:55], v[204:207]
ds_read_b64_tr_b16 a[86:87], v31 offset:29184
v_mfma_f32_16x16x32_bf16 v[236:239], a[88:91], a[56:59], v[236:239]
v_mfma_f32_16x16x32_bf16 v[236:239], a[92:95], a[60:63], v[236:239]
s_waitcnt lgkmcnt(8)
v_mfma_f32_16x16x32_bf16 v[144:147], a[64:67], a[32:35], v[144:147]
buffer_load_dwordx4 v22, s[4:7], s40 offen offset:2048 lds
v_mfma_f32_16x16x32_bf16 v[144:147], a[68:71], a[36:39], v[144:147]
ds_read_b64_tr_b16 a[88:89], v31 offset:24584
v_mfma_f32_16x16x32_bf16 v[176:179], a[64:67], a[40:43], v[176:179]
ds_read_b64_tr_b16 a[90:91], v31 offset:25096
v_mfma_f32_16x16x32_bf16 v[176:179], a[68:71], a[44:47], v[176:179]
ds_read_b64_tr_b16 a[92:93], v31 offset:28680
v_mfma_f32_16x16x32_bf16 v[208:211], a[64:67], a[48:51], v[208:211]
ds_read_b64_tr_b16 a[94:95], v31 offset:29192
v_mfma_f32_16x16x32_bf16 v[208:211], a[68:71], a[52:55], v[208:211]
buffer_load_dwordx4 v23, s[4:7], s40 offen offset:3072 lds
v_mfma_f32_16x16x32_bf16 v[240:243], a[64:67], a[56:59], v[240:243]
s_add_u32 s39, s39, 128
s_add_u32 s40, s40, 128
v_mfma_f32_16x16x32_bf16 v[240:243], a[68:71], a[60:63], v[240:243]
s_waitcnt lgkmcnt(8)
v_mfma_f32_16x16x32_bf16 v[148:151], a[72:75], a[32:35], v[148:151]
v_mfma_f32_16x16x32_bf16 v[148:151], a[76:79], a[36:39], v[148:151]
v_mfma_f32_16x16x32_bf16 v[180:183], a[72:75], a[40:43], v[180:183]
v_mfma_f32_16x16x32_bf16 v[180:183], a[76:79], a[44:47], v[180:183]
s_waitcnt vmcnt(19) lgkmcnt(0)
v_mfma_f32_16x16x32_bf16 v[212:215], a[72:75], a[48:51], v[212:215]
s_barrier
v_mfma_f32_16x16x32_bf16 v[212:215], a[76:79], a[52:55], v[212:215]
ds_read_b64_tr_b16 a[64:65], v30 offset:32768
s_add_u32 m0, s33, 131072
v_mfma_f32_16x16x32_bf16 v[244:247], a[72:75], a[56:59], v[244:247]
ds_read_b64_tr_b16 a[66:67], v30 offset:33280
buffer_load_dwordx4 v24, s[8:11], s41 offen offset:0 lds
v_mfma_f32_16x16x32_bf16 v[244:247], a[76:79], a[60:63], v[244:247]
ds_read_b64_tr_b16 a[68:69], v30 offset:36864
v_mfma_f32_16x16x32_bf16 v[152:155], a[80:83], a[32:35], v[152:155]
ds_read_b64_tr_b16 a[70:71], v30 offset:37376
v_mfma_f32_16x16x32_bf16 v[152:155], a[84:87], a[36:39], v[152:155]
v_mfma_f32_16x16x32_bf16 v[184:187], a[80:83], a[40:43], v[184:187]
v_mfma_f32_16x16x32_bf16 v[184:187], a[84:87], a[44:47], v[184:187]
buffer_load_dwordx4 v25, s[8:11], s41 offen offset:1024 lds
v_mfma_f32_16x16x32_bf16 v[216:219], a[80:83], a[48:51], v[216:219]
v_mfma_f32_16x16x32_bf16 v[216:219], a[84:87], a[52:55], v[216:219]
ds_read_b64_tr_b16 a[72:73], v30 offset:32776
v_mfma_f32_16x16x32_bf16 v[248:251], a[80:83], a[56:59], v[248:251]
ds_read_b64_tr_b16 a[74:75], v30 offset:33288
v_mfma_f32_16x16x32_bf16 v[248:251], a[84:87], a[60:63], v[248:251]
ds_read_b64_tr_b16 a[76:77], v30 offset:36872
v_mfma_f32_16x16x32_bf16 v[156:159], a[88:91], a[32:35], v[156:159]
ds_read_b64_tr_b16 a[78:79], v30 offset:37384
buffer_load_dwordx4 v26, s[8:11], s41 offen offset:2048 lds
v_mfma_f32_16x16x32_bf16 v[156:159], a[92:95], a[36:39], v[156:159]
v_mfma_f32_16x16x32_bf16 v[188:191], a[88:91], a[40:43], v[188:191]
v_mfma_f32_16x16x32_bf16 v[188:191], a[92:95], a[44:47], v[188:191]
v_mfma_f32_16x16x32_bf16 v[220:223], a[88:91], a[48:51], v[220:223]
v_mfma_f32_16x16x32_bf16 v[220:223], a[92:95], a[52:55], v[220:223]
ds_read_b64_tr_b16 a[80:81], v31 offset:32768
buffer_load_dwordx4 v27, s[8:11], s41 offen offset:3072 lds
v_mfma_f32_16x16x32_bf16 v[252:255], a[88:91], a[56:59], v[252:255]
ds_read_b64_tr_b16 a[82:83], v31 offset:33280
s_add_u32 s41, s41, 256
v_mfma_f32_16x16x32_bf16 v[252:255], a[92:95], a[60:63], v[252:255]
ds_read_b64_tr_b16 a[84:85], v31 offset:36864
s_waitcnt lgkmcnt(7)
v_mfma_f32_16x16x32_bf16 a[128:131], a[64:67], a[32:35], a[128:131]
ds_read_b64_tr_b16 a[86:87], v31 offset:37376
v_mfma_f32_16x16x32_bf16 a[128:131], a[68:71], a[36:39], a[128:131]
v_mfma_f32_16x16x32_bf16 a[160:163], a[64:67], a[40:43], a[160:163]
v_mfma_f32_16x16x32_bf16 a[160:163], a[68:71], a[44:47], a[160:163]
v_mfma_f32_16x16x32_bf16 a[192:195], a[64:67], a[48:51], a[192:195]
v_mfma_f32_16x16x32_bf16 a[192:195], a[68:71], a[52:55], a[192:195]
ds_read_b64_tr_b16 a[88:89], v31 offset:32776
v_mfma_f32_16x16x32_bf16 a[224:227], a[64:67], a[56:59], a[224:227]
ds_read_b64_tr_b16 a[90:91], v31 offset:33288
v_mfma_f32_16x16x32_bf16 a[224:227], a[68:71], a[60:63], a[224:227]
ds_read_b64_tr_b16 a[92:93], v31 offset:36872
s_waitcnt lgkmcnt(7)
v_mfma_f32_16x16x32_bf16 a[132:135], a[72:75], a[32:35], a[132:135]
ds_read_b64_tr_b16 a[94:95], v31 offset:37384
v_mfma_f32_16x16x32_bf16 a[132:135], a[76:79], a[36:39], a[132:135]
ds_read_b128 a[0:3], v18 offset:0
v_mfma_f32_16x16x32_bf16 a[164:167], a[72:75], a[40:43], a[164:167]
ds_read_b128 a[4:7], v19 offset:0
v_mfma_f32_16x16x32_bf16 a[164:167], a[76:79], a[44:47], a[164:167]
v_mfma_f32_16x16x32_bf16 a[196:199], a[72:75], a[48:51], a[196:199]
ds_read_b64_tr_b16 a[64:65], v30 offset:40960
v_mfma_f32_16x16x32_bf16 a[196:199], a[76:79], a[52:55], a[196:199]
ds_read_b64_tr_b16 a[66:67], v30 offset:41472
v_mfma_f32_16x16x32_bf16 a[228:231], a[72:75], a[56:59], a[228:231]
ds_read_b64_tr_b16 a[68:69], v30 offset:45056
v_mfma_f32_16x16x32_bf16 a[228:231], a[76:79], a[60:63], a[228:231]
ds_read_b64_tr_b16 a[70:71], v30 offset:45568
s_waitcnt lgkmcnt(10)
v_mfma_f32_16x16x32_bf16 a[136:139], a[80:83], a[32:35], a[136:139]
ds_read_b128 a[8:11], v18 offset:2048
v_mfma_f32_16x16x32_bf16 a[136:139], a[84:87], a[36:39], a[136:139]
ds_read_b128 a[12:15], v19 offset:2048
v_mfma_f32_16x16x32_bf16 a[168:171], a[80:83], a[40:43], a[168:171]
v_mfma_f32_16x16x32_bf16 a[168:171], a[84:87], a[44:47], a[168:171]
ds_read_b64_tr_b16 a[72:73], v30 offset:40968
v_mfma_f32_16x16x32_bf16 a[200:203], a[80:83], a[48:51], a[200:203]
ds_read_b64_tr_b16 a[74:75], v30 offset:41480
v_mfma_f32_16x16x32_bf16 a[200:203], a[84:87], a[52:55], a[200:203]
ds_read_b64_tr_b16 a[76:77], v30 offset:45064
v_mfma_f32_16x16x32_bf16 a[232:235], a[80:83], a[56:59], a[232:235]
ds_read_b64_tr_b16 a[78:79], v30 offset:45576
v_mfma_f32_16x16x32_bf16 a[232:235], a[84:87], a[60:63], a[232:235]
ds_read_b128 a[16:19], v18 offset:4096
s_waitcnt lgkmcnt(13)
v_mfma_f32_16x16x32_bf16 a[140:143], a[88:91], a[32:35], a[140:143]
ds_read_b128 a[20:23], v19 offset:4096
v_mfma_f32_16x16x32_bf16 a[140:143], a[92:95], a[36:39], a[140:143]
v_mfma_f32_16x16x32_bf16 a[172:175], a[88:91], a[40:43], a[172:175]
ds_read_b64_tr_b16 a[80:81], v31 offset:40960
v_mfma_f32_16x16x32_bf16 a[172:175], a[92:95], a[44:47], a[172:175]
ds_read_b64_tr_b16 a[82:83], v31 offset:41472
v_mfma_f32_16x16x32_bf16 a[204:207], a[88:91], a[48:51], a[204:207]
ds_read_b64_tr_b16 a[84:85], v31 offset:45056
v_mfma_f32_16x16x32_bf16 a[204:207], a[92:95], a[52:55], a[204:207]
ds_read_b64_tr_b16 a[86:87], v31 offset:45568
v_mfma_f32_16x16x32_bf16 a[236:239], a[88:91], a[56:59], a[236:239]
ds_read_b128 a[24:27], v18 offset:6144
v_mfma_f32_16x16x32_bf16 a[236:239], a[92:95], a[60:63], a[236:239]
ds_read_b128 a[28:31], v19 offset:6144
s_waitcnt lgkmcnt(14)
v_mfma_f32_16x16x32_bf16 a[144:147], a[64:67], a[32:35], a[144:147]
v_mfma_f32_16x16x32_bf16 a[144:147], a[68:71], a[36:39], a[144:147]
ds_read_b64_tr_b16 a[88:89], v31 offset:40968
v_mfma_f32_16x16x32_bf16 a[176:179], a[64:67], a[40:43], a[176:179]
ds_read_b64_tr_b16 a[90:91], v31 offset:41480
v_mfma_f32_16x16x32_bf16 a[176:179], a[68:71], a[44:47], a[176:179]
ds_read_b64_tr_b16 a[92:93], v31 offset:45064
v_mfma_f32_16x16x32_bf16 a[208:211], a[64:67], a[48:51], a[208:211]
ds_read_b64_tr_b16 a[94:95], v31 offset:45576
v_mfma_f32_16x16x32_bf16 a[208:211], a[68:71], a[52:55], a[208:211]
v_mfma_f32_16x16x32_bf16 a[240:243], a[64:67], a[56:59], a[240:243]
v_mfma_f32_16x16x32_bf16 a[240:243], a[68:71], a[60:63], a[240:243]
s_waitcnt lgkmcnt(12)
v_mfma_f32_16x16x32_bf16 a[148:151], a[72:75], a[32:35], a[148:151]
v_mfma_f32_16x16x32_bf16 a[148:151], a[76:79], a[36:39], a[148:151]
v_mfma_f32_16x16x32_bf16 a[180:183], a[72:75], a[40:43], a[180:183]
v_mfma_f32_16x16x32_bf16 a[180:183], a[76:79], a[44:47], a[180:183]
s_waitcnt vmcnt(17) lgkmcnt(0)
v_mfma_f32_16x16x32_bf16 a[212:215], a[72:75], a[48:51], a[212:215]
s_barrier
v_mfma_f32_16x16x32_bf16 a[212:215], a[76:79], a[52:55], a[212:215]
ds_read_b64_tr_b16 a[64:65], v28 offset:0
s_add_u32 m0, s33, 147456
v_mfma_f32_16x16x32_bf16 a[244:247], a[72:75], a[56:59], a[244:247]
ds_read_b64_tr_b16 a[66:67], v28 offset:512
buffer_load_dwordx4 v24, s[8:11], s41 offen offset:0 lds
v_mfma_f32_16x16x32_bf16 a[244:247], a[76:79], a[60:63], a[244:247]
ds_read_b64_tr_b16 a[68:69], v28 offset:4096
v_mfma_f32_16x16x32_bf16 a[152:155], a[80:83], a[32:35], a[152:155]
ds_read_b64_tr_b16 a[70:71], v28 offset:4608
v_mfma_f32_16x16x32_bf16 a[152:155], a[84:87], a[36:39], a[152:155]
v_mfma_f32_16x16x32_bf16 a[184:187], a[80:83], a[40:43], a[184:187]
v_mfma_f32_16x16x32_bf16 a[184:187], a[84:87], a[44:47], a[184:187]
buffer_load_dwordx4 v25, s[8:11], s41 offen offset:1024 lds
v_mfma_f32_16x16x32_bf16 a[216:219], a[80:83], a[48:51], a[216:219]
v_mfma_f32_16x16x32_bf16 a[216:219], a[84:87], a[52:55], a[216:219]
ds_read_b64_tr_b16 a[72:73], v28 offset:8
v_mfma_f32_16x16x32_bf16 a[248:251], a[80:83], a[56:59], a[248:251]
ds_read_b64_tr_b16 a[74:75], v28 offset:520
v_mfma_f32_16x16x32_bf16 a[248:251], a[84:87], a[60:63], a[248:251]
ds_read_b64_tr_b16 a[76:77], v28 offset:4104
v_mfma_f32_16x16x32_bf16 a[156:159], a[88:91], a[32:35], a[156:159]
ds_read_b64_tr_b16 a[78:79], v28 offset:4616
buffer_load_dwordx4 v26, s[8:11], s41 offen offset:2048 lds
v_mfma_f32_16x16x32_bf16 a[156:159], a[92:95], a[36:39], a[156:159]
v_mfma_f32_16x16x32_bf16 a[188:191], a[88:91], a[40:43], a[188:191]
v_mfma_f32_16x16x32_bf16 a[188:191], a[92:95], a[44:47], a[188:191]
v_mfma_f32_16x16x32_bf16 a[220:223], a[88:91], a[48:51], a[220:223]
v_mfma_f32_16x16x32_bf16 a[220:223], a[92:95], a[52:55], a[220:223]
ds_read_b64_tr_b16 a[80:81], v29 offset:0
buffer_load_dwordx4 v27, s[8:11], s41 offen offset:3072 lds
v_mfma_f32_16x16x32_bf16 a[252:255], a[88:91], a[56:59], a[252:255]
ds_read_b64_tr_b16 a[82:83], v29 offset:512
s_add_u32 s41, s41, 524032
v_mfma_f32_16x16x32_bf16 a[252:255], a[92:95], a[60:63], a[252:255]
ds_read_b64_tr_b16 a[84:85], v29 offset:4096
s_waitcnt lgkmcnt(7)
v_mfma_f32_16x16x32_bf16 v[128:131], a[64:67], a[0:3], v[128:131]
ds_read_b64_tr_b16 a[86:87], v29 offset:4608
v_mfma_f32_16x16x32_bf16 v[128:131], a[68:71], a[4:7], v[128:131]
s_add_u32 m0, s42, 81920
v_mfma_f32_16x16x32_bf16 v[160:163], a[64:67], a[8:11], v[160:163]
buffer_load_dwordx4 v20, s[4:7], s39 offen offset:0 lds
v_mfma_f32_16x16x32_bf16 v[160:163], a[68:71], a[12:15], v[160:163]
v_mfma_f32_16x16x32_bf16 v[192:195], a[64:67], a[16:19], v[192:195]
v_mfma_f32_16x16x32_bf16 v[192:195], a[68:71], a[20:23], v[192:195]
ds_read_b64_tr_b16 a[88:89], v29 offset:8
v_mfma_f32_16x16x32_bf16 v[224:227], a[64:67], a[24:27], v[224:227]
ds_read_b64_tr_b16 a[90:91], v29 offset:520
v_mfma_f32_16x16x32_bf16 v[224:227], a[68:71], a[28:31], v[224:227]
ds_read_b64_tr_b16 a[92:93], v29 offset:4104
s_waitcnt lgkmcnt(7)
buffer_load_dwordx4 v21, s[4:7], s39 offen offset:1024 lds
v_mfma_f32_16x16x32_bf16 v[132:135], a[72:75], a[0:3], v[132:135]
ds_read_b64_tr_b16 a[94:95], v29 offset:4616
v_mfma_f32_16x16x32_bf16 v[132:135], a[76:79], a[4:7], v[132:135]
v_mfma_f32_16x16x32_bf16 v[164:167], a[72:75], a[8:11], v[164:167]
v_mfma_f32_16x16x32_bf16 v[164:167], a[76:79], a[12:15], v[164:167]
v_mfma_f32_16x16x32_bf16 v[196:199], a[72:75], a[16:19], v[196:199]
ds_read_b64_tr_b16 a[64:65], v28 offset:8192
buffer_load_dwordx4 v22, s[4:7], s39 offen offset:2048 lds
v_mfma_f32_16x16x32_bf16 v[196:199], a[76:79], a[20:23], v[196:199]
ds_read_b64_tr_b16 a[66:67], v28 offset:8704
v_mfma_f32_16x16x32_bf16 v[228:231], a[72:75], a[24:27], v[228:231]
ds_read_b64_tr_b16 a[68:69], v28 offset:12288
v_mfma_f32_16x16x32_bf16 v[228:231], a[76:79], a[28:31], v[228:231]
ds_read_b64_tr_b16 a[70:71], v28 offset:12800
s_waitcnt lgkmcnt(8)
v_mfma_f32_16x16x32_bf16 v[136:139], a[80:83], a[0:3], v[136:139]
v_mfma_f32_16x16x32_bf16 v[136:139], a[84:87], a[4:7], v[136:139]
buffer_load_dwordx4 v23, s[4:7], s39 offen offset:3072 lds
v_mfma_f32_16x16x32_bf16 v[168:171], a[80:83], a[8:11], v[168:171]
v_mfma_f32_16x16x32_bf16 v[168:171], a[84:87], a[12:15], v[168:171]
ds_read_b64_tr_b16 a[72:73], v28 offset:8200
v_mfma_f32_16x16x32_bf16 v[200:203], a[80:83], a[16:19], v[200:203]
ds_read_b64_tr_b16 a[74:75], v28 offset:8712
v_mfma_f32_16x16x32_bf16 v[200:203], a[84:87], a[20:23], v[200:203]
ds_read_b64_tr_b16 a[76:77], v28 offset:12296
s_add_u32 m0, s42, 86016
v_mfma_f32_16x16x32_bf16 v[232:235], a[80:83], a[24:27], v[232:235]
ds_read_b64_tr_b16 a[78:79], v28 offset:12808
buffer_load_dwordx4 v20, s[4:7], s40 offen offset:0 lds
v_mfma_f32_16x16x32_bf16 v[232:235], a[84:87], a[28:31], v[232:235]
s_waitcnt lgkmcnt(8)
v_mfma_f32_16x16x32_bf16 v[140:143], a[88:91], a[0:3], v[140:143]
v_mfma_f32_16x16x32_bf16 v[140:143], a[92:95], a[4:7], v[140:143]
v_mfma_f32_16x16x32_bf16 v[172:175], a[88:91], a[8:11], v[172:175]
ds_read_b64_tr_b16 a[80:81], v29 offset:8192
v_mfma_f32_16x16x32_bf16 v[172:175], a[92:95], a[12:15], v[172:175]
ds_read_b64_tr_b16 a[82:83], v29 offset:8704
buffer_load_dwordx4 v21, s[4:7], s40 offen offset:1024 lds
v_mfma_f32_16x16x32_bf16 v[204:207], a[88:91], a[16:19], v[204:207]
ds_read_b64_tr_b16 a[84:85], v29 offset:12288
v_mfma_f32_16x16x32_bf16 v[204:207], a[92:95], a[20:23], v[204:207]
ds_read_b64_tr_b16 a[86:87], v29 offset:12800
v_mfma_f32_16x16x32_bf16 v[236:239], a[88:91], a[24:27], v[236:239]
v_mfma_f32_16x16x32_bf16 v[236:239], a[92:95], a[28:31], v[236:239]
s_waitcnt lgkmcnt(8)
v_mfma_f32_16x16x32_bf16 v[144:147], a[64:67], a[0:3], v[144:147]
buffer_load_dwordx4 v22, s[4:7], s40 offen offset:2048 lds
v_mfma_f32_16x16x32_bf16 v[144:147], a[68:71], a[4:7], v[144:147]
ds_read_b64_tr_b16 a[88:89], v29 offset:8200
v_mfma_f32_16x16x32_bf16 v[176:179], a[64:67], a[8:11], v[176:179]
ds_read_b64_tr_b16 a[90:91], v29 offset:8712
v_mfma_f32_16x16x32_bf16 v[176:179], a[68:71], a[12:15], v[176:179]
ds_read_b64_tr_b16 a[92:93], v29 offset:12296
v_mfma_f32_16x16x32_bf16 v[208:211], a[64:67], a[16:19], v[208:211]
ds_read_b64_tr_b16 a[94:95], v29 offset:12808
v_mfma_f32_16x16x32_bf16 v[208:211], a[68:71], a[20:23], v[208:211]
buffer_load_dwordx4 v23, s[4:7], s40 offen offset:3072 lds
v_mfma_f32_16x16x32_bf16 v[240:243], a[64:67], a[24:27], v[240:243]
s_add_u32 s39, s39, 128
s_add_u32 s40, s40, 128
v_mfma_f32_16x16x32_bf16 v[240:243], a[68:71], a[28:31], v[240:243]
s_waitcnt lgkmcnt(8)
v_mfma_f32_16x16x32_bf16 v[148:151], a[72:75], a[0:3], v[148:151]
v_mfma_f32_16x16x32_bf16 v[148:151], a[76:79], a[4:7], v[148:151]
v_mfma_f32_16x16x32_bf16 v[180:183], a[72:75], a[8:11], v[180:183]
v_mfma_f32_16x16x32_bf16 v[180:183], a[76:79], a[12:15], v[180:183]
s_waitcnt vmcnt(16) lgkmcnt(0)
v_mfma_f32_16x16x32_bf16 v[212:215], a[72:75], a[16:19], v[212:215]
s_barrier
s_waitcnt vmcnt(28)
v_mfma_f32_16x16x32_bf16 v[212:215], a[76:79], a[20:23], v[212:215]
ds_read_b64_tr_b16 a[64:65], v30 offset:0
s_add_u32 m0, s33, 49152
v_mfma_f32_16x16x32_bf16 v[244:247], a[72:75], a[24:27], v[244:247]
ds_read_b64_tr_b16 a[66:67], v30 offset:512
buffer_load_dwordx4 v24, s[8:11], s41 offen offset:0 lds
v_mfma_f32_16x16x32_bf16 v[244:247], a[76:79], a[28:31], v[244:247]
ds_read_b64_tr_b16 a[68:69], v30 offset:4096
v_mfma_f32_16x16x32_bf16 v[152:155], a[80:83], a[0:3], v[152:155]
ds_read_b64_tr_b16 a[70:71], v30 offset:4608
v_mfma_f32_16x16x32_bf16 v[152:155], a[84:87], a[4:7], v[152:155]
ds_read_b64_tr_b16 v[32:33], v105 offset:0
v_mfma_f32_16x16x32_bf16 v[184:187], a[80:83], a[8:11], v[184:187]
ds_read_b64_tr_b16 v[34:35], v105 offset:2048
v_mfma_f32_16x16x32_bf16 v[184:187], a[84:87], a[12:15], v[184:187]
ds_read_b64_tr_b16 v[36:37], v105 offset:32
buffer_load_dwordx4 v25, s[8:11], s41 offen offset:1024 lds
v_mfma_f32_16x16x32_bf16 v[216:219], a[80:83], a[16:19], v[216:219]
ds_read_b64_tr_b16 v[38:39], v105 offset:2080
v_mfma_f32_16x16x32_bf16 v[216:219], a[84:87], a[20:23], v[216:219]
ds_read_b64_tr_b16 a[72:73], v30 offset:8
v_mfma_f32_16x16x32_bf16 v[248:251], a[80:83], a[24:27], v[248:251]
ds_read_b64_tr_b16 a[74:75], v30 offset:520
v_mfma_f32_16x16x32_bf16 v[248:251], a[84:87], a[28:31], v[248:251]
ds_read_b64_tr_b16 a[76:77], v30 offset:4104
v_mfma_f32_16x16x32_bf16 v[156:159], a[88:91], a[0:3], v[156:159]
ds_read_b64_tr_b16 a[78:79], v30 offset:4616
buffer_load_dwordx4 v26, s[8:11], s41 offen offset:2048 lds
v_mfma_f32_16x16x32_bf16 v[156:159], a[92:95], a[4:7], v[156:159]
ds_read_b64_tr_b16 v[40:41], v105 offset:64
v_mfma_f32_16x16x32_bf16 v[188:191], a[88:91], a[8:11], v[188:191]
ds_read_b64_tr_b16 v[42:43], v105 offset:2112
v_mfma_f32_16x16x32_bf16 v[188:191], a[92:95], a[12:15], v[188:191]
ds_read_b64_tr_b16 v[44:45], v105 offset:96
v_mfma_f32_16x16x32_bf16 v[220:223], a[88:91], a[16:19], v[220:223]
ds_read_b64_tr_b16 v[46:47], v105 offset:2144
v_mfma_f32_16x16x32_bf16 v[220:223], a[92:95], a[20:23], v[220:223]
ds_read_b64_tr_b16 a[80:81], v31 offset:0
buffer_load_dwordx4 v27, s[8:11], s41 offen offset:3072 lds
v_mfma_f32_16x16x32_bf16 v[252:255], a[88:91], a[24:27], v[252:255]
ds_read_b64_tr_b16 a[82:83], v31 offset:512
s_add_u32 s41, s41, 256
v_mfma_f32_16x16x32_bf16 v[252:255], a[92:95], a[28:31], v[252:255]
ds_read_b64_tr_b16 a[84:85], v31 offset:4096
s_waitcnt lgkmcnt(15)
v_mfma_f32_16x16x32_bf16 a[128:131], a[64:67], a[0:3], a[128:131]
ds_read_b64_tr_b16 a[86:87], v31 offset:4608
v_mfma_f32_16x16x32_bf16 a[128:131], a[68:71], a[4:7], a[128:131]
ds_read_b64_tr_b16 v[48:49], v105 offset:4096
v_mfma_f32_16x16x32_bf16 a[160:163], a[64:67], a[8:11], a[160:163]
ds_read_b64_tr_b16 v[50:51], v105 offset:6144
v_mfma_f32_16x16x32_bf16 a[160:163], a[68:71], a[12:15], a[160:163]
ds_read_b64_tr_b16 v[52:53], v105 offset:4128
v_mfma_f32_16x16x32_bf16 a[192:195], a[64:67], a[16:19], a[192:195]
ds_read_b64_tr_b16 v[54:55], v105 offset:6176
v_mfma_f32_16x16x32_bf16 a[192:195], a[68:71], a[20:23], a[192:195]
ds_read_b64_tr_b16 a[88:89], v31 offset:8
v_mfma_f32_16x16x32_bf16 a[224:227], a[64:67], a[24:27], a[224:227]
ds_read_b64_tr_b16 a[90:91], v31 offset:520
v_mfma_f32_16x16x32_bf16 a[224:227], a[68:71], a[28:31], a[224:227]
ds_read_b64_tr_b16 a[92:93], v31 offset:4104
s_waitcnt lgkmcnt(15)
v_mfma_f32_16x16x32_bf16 a[132:135], a[72:75], a[0:3], a[132:135]
ds_read_b64_tr_b16 a[94:95], v31 offset:4616
v_mfma_f32_16x16x32_bf16 a[132:135], a[76:79], a[4:7], a[132:135]
ds_read_b128 a[32:35], v16 offset:0
v_mfma_f32_16x16x32_bf16 a[164:167], a[72:75], a[8:11], a[164:167]
ds_read_b128 a[36:39], v17 offset:0
v_mfma_f32_16x16x32_bf16 a[164:167], a[76:79], a[12:15], a[164:167]
ds_read_b64_tr_b16 v[56:57], v105 offset:4160
v_mfma_f32_16x16x32_bf16 a[196:199], a[72:75], a[16:19], a[196:199]
ds_read_b64_tr_b16 a[64:65], v30 offset:8192
v_mfma_f32_16x16x32_bf16 a[196:199], a[76:79], a[20:23], a[196:199]
ds_read_b64_tr_b16 a[66:67], v30 offset:8704
v_mfma_f32_16x16x32_bf16 a[228:231], a[72:75], a[24:27], a[228:231]
ds_read_b64_tr_b16 a[68:69], v30 offset:12288
v_mfma_f32_16x16x32_bf16 a[228:231], a[76:79], a[28:31], a[228:231]
ds_read_b64_tr_b16 a[70:71], v30 offset:12800
s_waitcnt lgkmcnt(15)
v_mfma_f32_16x16x32_bf16 a[136:139], a[80:83], a[0:3], a[136:139]
ds_read_b128 a[40:43], v16 offset:2048
v_mfma_f32_16x16x32_bf16 a[136:139], a[84:87], a[4:7], a[136:139]
ds_read_b128 a[44:47], v17 offset:2048
v_mfma_f32_16x16x32_bf16 a[168:171], a[80:83], a[8:11], a[168:171]
ds_read_b64_tr_b16 v[58:59], v105 offset:6208
v_mfma_f32_16x16x32_bf16 a[168:171], a[84:87], a[12:15], a[168:171]
ds_read_b64_tr_b16 a[72:73], v30 offset:8200
v_mfma_f32_16x16x32_bf16 a[200:203], a[80:83], a[16:19], a[200:203]
ds_read_b64_tr_b16 a[74:75], v30 offset:8712
v_mfma_f32_16x16x32_bf16 a[200:203], a[84:87], a[20:23], a[200:203]
ds_read_b64_tr_b16 a[76:77], v30 offset:12296
v_mfma_f32_16x16x32_bf16 a[232:235], a[80:83], a[24:27], a[232:235]
ds_read_b64_tr_b16 a[78:79], v30 offset:12808
v_mfma_f32_16x16x32_bf16 a[232:235], a[84:87], a[28:31], a[232:235]
ds_read_b128 a[48:51], v16 offset:4096
s_waitcnt lgkmcnt(15)
v_mfma_f32_16x16x32_bf16 a[140:143], a[88:91], a[0:3], a[140:143]
ds_read_b128 a[52:55], v17 offset:4096
v_mfma_f32_16x16x32_bf16 a[140:143], a[92:95], a[4:7], a[140:143]
ds_read_b64_tr_b16 v[60:61], v105 offset:4192
v_mfma_f32_16x16x32_bf16 a[172:175], a[88:91], a[8:11], a[172:175]
ds_read_b64_tr_b16 a[80:81], v31 offset:8192
v_mfma_f32_16x16x32_bf16 a[172:175], a[92:95], a[12:15], a[172:175]
ds_read_b64_tr_b16 a[82:83], v31 offset:8704
v_mfma_f32_16x16x32_bf16 a[204:207], a[88:91], a[16:19], a[204:207]
ds_read_b64_tr_b16 a[84:85], v31 offset:12288
v_mfma_f32_16x16x32_bf16 a[204:207], a[92:95], a[20:23], a[204:207]
ds_read_b64_tr_b16 a[86:87], v31 offset:12800
v_mfma_f32_16x16x32_bf16 a[236:239], a[88:91], a[24:27], a[236:239]
ds_read_b128 a[56:59], v16 offset:6144
v_mfma_f32_16x16x32_bf16 a[236:239], a[92:95], a[28:31], a[236:239]
ds_read_b128 a[60:63], v17 offset:6144
s_waitcnt lgkmcnt(15)
v_mfma_f32_16x16x32_bf16 a[144:147], a[64:67], a[0:3], a[144:147]
v_mfma_f32_16x16x32_bf16 a[144:147], a[68:71], a[4:7], a[144:147]
ds_read_b64_tr_b16 a[88:89], v31 offset:8200
v_mfma_f32_16x16x32_bf16 a[176:179], a[64:67], a[8:11], a[176:179]
ds_read_b64_tr_b16 a[90:91], v31 offset:8712
v_mfma_f32_16x16x32_bf16 a[176:179], a[68:71], a[12:15], a[176:179]
ds_read_b64_tr_b16 a[92:93], v31 offset:12296
v_mfma_f32_16x16x32_bf16 a[208:211], a[64:67], a[16:19], a[208:211]
ds_read_b64_tr_b16 a[94:95], v31 offset:12808
v_mfma_f32_16x16x32_bf16 a[208:211], a[68:71], a[20:23], a[208:211]
ds_read_b64_tr_b16 v[62:63], v105 offset:6240
v_mfma_f32_16x16x32_bf16 a[240:243], a[64:67], a[24:27], a[240:243]
ds_read_b64_tr_b16 v[64:65], v10 offset:0
v_mfma_f32_16x16x32_bf16 a[240:243], a[68:71], a[28:31], a[240:243]
s_waitcnt lgkmcnt(15)
ds_read_b64_tr_b16 v[66:67], v10 offset:512
v_mfma_f32_16x16x32_bf16 a[148:151], a[72:75], a[0:3], a[148:151]
v_mfma_f32_16x16x32_bf16 a[148:151], a[76:79], a[4:7], a[148:151]
v_mfma_f32_16x16x32_bf16 a[180:183], a[72:75], a[8:11], a[180:183]
v_mfma_f32_16x16x32_bf16 a[180:183], a[76:79], a[12:15], a[180:183]
s_waitcnt vmcnt(16) lgkmcnt(0)
v_mfma_f32_16x16x32_bf16 a[212:215], a[72:75], a[16:19], a[212:215]
s_barrier
v_mfma_f32_16x16x32_bf16 a[212:215], a[76:79], a[20:23], a[212:215]
ds_read_b64_tr_b16 a[64:65], v30 offset:16384
s_add_u32 m0, s33, 114688
v_mfma_f32_16x16x32_bf16 a[244:247], a[72:75], a[24:27], a[244:247]
ds_read_b64_tr_b16 a[66:67], v30 offset:16896
buffer_load_dwordx4 v24, s[8:11], s41 offen offset:0 lds
v_mfma_f32_16x16x32_bf16 a[244:247], a[76:79], a[28:31], a[244:247]
ds_read_b64_tr_b16 a[68:69], v30 offset:20480
v_mfma_f32_16x16x32_bf16 a[152:155], a[80:83], a[0:3], a[152:155]
ds_read_b64_tr_b16 a[70:71], v30 offset:20992
v_mfma_f32_16x16x32_bf16 a[152:155], a[84:87], a[4:7], a[152:155]
v_mfma_f32_16x16x32_bf16 a[184:187], a[80:83], a[8:11], a[184:187]
v_mfma_f32_16x16x32_bf16 a[184:187], a[84:87], a[12:15], a[184:187]
buffer_load_dwordx4 v25, s[8:11], s41 offen offset:1024 lds
v_mfma_f32_16x16x32_bf16 a[216:219], a[80:83], a[16:19], a[216:219]
v_mfma_f32_16x16x32_bf16 a[216:219], a[84:87], a[20:23], a[216:219]
ds_read_b64_tr_b16 a[72:73], v30 offset:16392
v_mfma_f32_16x16x32_bf16 a[248:251], a[80:83], a[24:27], a[248:251]
ds_read_b64_tr_b16 a[74:75], v30 offset:16904
v_mfma_f32_16x16x32_bf16 a[248:251], a[84:87], a[28:31], a[248:251]
ds_read_b64_tr_b16 a[76:77], v30 offset:20488
v_mfma_f32_16x16x32_bf16 a[156:159], a[88:91], a[0:3], a[156:159]
ds_read_b64_tr_b16 a[78:79], v30 offset:21000
buffer_load_dwordx4 v26, s[8:11], s41 offen offset:2048 lds
v_mfma_f32_16x16x32_bf16 a[156:159], a[92:95], a[4:7], a[156:159]
v_mfma_f32_16x16x32_bf16 a[188:191], a[88:91], a[8:11], a[188:191]
v_mfma_f32_16x16x32_bf16 a[188:191], a[92:95], a[12:15], a[188:191]
v_mfma_f32_16x16x32_bf16 a[220:223], a[88:91], a[16:19], a[220:223]
v_mfma_f32_16x16x32_bf16 a[220:223], a[92:95], a[20:23], a[220:223]
ds_read_b64_tr_b16 a[80:81], v31 offset:16384
buffer_load_dwordx4 v27, s[8:11], s41 offen offset:3072 lds
v_mfma_f32_16x16x32_bf16 a[252:255], a[88:91], a[24:27], a[252:255]
ds_read_b64_tr_b16 a[82:83], v31 offset:16896
s_add_u32 s41, s41, 524032
v_mfma_f32_16x16x32_bf16 a[252:255], a[92:95], a[28:31], a[252:255]
ds_read_b64_tr_b16 a[84:85], v31 offset:20480
s_waitcnt lgkmcnt(7)
v_mfma_f32_16x16x32_bf16 v[128:131], a[64:67], a[32:35], v[128:131]
ds_read_b64_tr_b16 a[86:87], v31 offset:20992
v_mfma_f32_16x16x32_bf16 v[128:131], a[68:71], a[36:39], v[128:131]
s_add_u32 m0, s42, 16384
v_mfma_f32_16x16x32_bf16 v[160:163], a[64:67], a[40:43], v[160:163]
buffer_load_dwordx4 v20, s[4:7], s39 offen offset:0 lds
v_mfma_f32_16x16x32_bf16 v[160:163], a[68:71], a[44:47], v[160:163]
v_mfma_f32_16x16x32_bf16 v[192:195], a[64:67], a[48:51], v[192:195]
v_mfma_f32_16x16x32_bf16 v[192:195], a[68:71], a[52:55], v[192:195]
ds_read_b64_tr_b16 a[88:89], v31 offset:16392
v_mfma_f32_16x16x32_bf16 v[224:227], a[64:67], a[56:59], v[224:227]
ds_read_b64_tr_b16 a[90:91], v31 offset:16904
v_mfma_f32_16x16x32_bf16 v[224:227], a[68:71], a[60:63], v[224:227]
ds_read_b64_tr_b16 a[92:93], v31 offset:20488
s_waitcnt lgkmcnt(7)
buffer_load_dwordx4 v21, s[4:7], s39 offen offset:1024 lds
v_mfma_f32_16x16x32_bf16 v[132:135], a[72:75], a[32:35], v[132:135]
ds_read_b64_tr_b16 a[94:95], v31 offset:21000
v_mfma_f32_16x16x32_bf16 v[132:135], a[76:79], a[36:39], v[132:135]
v_mfma_f32_16x16x32_bf16 v[164:167], a[72:75], a[40:43], v[164:167]
v_mfma_f32_16x16x32_bf16 v[164:167], a[76:79], a[44:47], v[164:167]
v_mfma_f32_16x16x32_bf16 v[196:199], a[72:75], a[48:51], v[196:199]
ds_read_b64_tr_b16 a[64:65], v30 offset:24576
buffer_load_dwordx4 v22, s[4:7], s39 offen offset:2048 lds
v_mfma_f32_16x16x32_bf16 v[196:199], a[76:79], a[52:55], v[196:199]
ds_read_b64_tr_b16 a[66:67], v30 offset:25088
v_mfma_f32_16x16x32_bf16 v[228:231], a[72:75], a[56:59], v[228:231]
ds_read_b64_tr_b16 a[68:69], v30 offset:28672
v_mfma_f32_16x16x32_bf16 v[228:231], a[76:79], a[60:63], v[228:231]
ds_read_b64_tr_b16 a[70:71], v30 offset:29184
s_waitcnt lgkmcnt(8)
v_mfma_f32_16x16x32_bf16 v[136:139], a[80:83], a[32:35], v[136:139]
v_mfma_f32_16x16x32_bf16 v[136:139], a[84:87], a[36:39], v[136:139]
buffer_load_dwordx4 v23, s[4:7], s39 offen offset:3072 lds
v_mfma_f32_16x16x32_bf16 v[168:171], a[80:83], a[40:43], v[168:171]
v_mfma_f32_16x16x32_bf16 v[168:171], a[84:87], a[44:47], v[168:171]
ds_read_b64_tr_b16 a[72:73], v30 offset:24584
v_mfma_f32_16x16x32_bf16 v[200:203], a[80:83], a[48:51], v[200:203]
ds_read_b64_tr_b16 a[74:75], v30 offset:25096
v_mfma_f32_16x16x32_bf16 v[200:203], a[84:87], a[52:55], v[200:203]
ds_read_b64_tr_b16 a[76:77], v30 offset:28680
s_add_u32 m0, s42, 20480
v_mfma_f32_16x16x32_bf16 v[232:235], a[80:83], a[56:59], v[232:235]
ds_read_b64_tr_b16 a[78:79], v30 offset:29192
buffer_load_dwordx4 v20, s[4:7], s40 offen offset:0 lds
v_mfma_f32_16x16x32_bf16 v[232:235], a[84:87], a[60:63], v[232:235]
s_waitcnt lgkmcnt(8)
v_mfma_f32_16x16x32_bf16 v[140:143], a[88:91], a[32:35], v[140:143]
v_mfma_f32_16x16x32_bf16 v[140:143], a[92:95], a[36:39], v[140:143]
v_mfma_f32_16x16x32_bf16 v[172:175], a[88:91], a[40:43], v[172:175]
ds_read_b64_tr_b16 a[80:81], v31 offset:24576
v_mfma_f32_16x16x32_bf16 v[172:175], a[92:95], a[44:47], v[172:175]
ds_read_b64_tr_b16 a[82:83], v31 offset:25088
buffer_load_dwordx4 v21, s[4:7], s40 offen offset:1024 lds
v_mfma_f32_16x16x32_bf16 v[204:207], a[88:91], a[48:51], v[204:207]
ds_read_b64_tr_b16 a[84:85], v31 offset:28672
v_mfma_f32_16x16x32_bf16 v[204:207], a[92:95], a[52:55], v[204:207]
ds_read_b64_tr_b16 a[86:87], v31 offset:29184
v_mfma_f32_16x16x32_bf16 v[236:239], a[88:91], a[56:59], v[236:239]
v_mfma_f32_16x16x32_bf16 v[236:239], a[92:95], a[60:63], v[236:239]
s_waitcnt lgkmcnt(8)
v_mfma_f32_16x16x32_bf16 v[144:147], a[64:67], a[32:35], v[144:147]
buffer_load_dwordx4 v22, s[4:7], s40 offen offset:2048 lds
v_mfma_f32_16x16x32_bf16 v[144:147], a[68:71], a[36:39], v[144:147]
ds_read_b64_tr_b16 a[88:89], v31 offset:24584
v_mfma_f32_16x16x32_bf16 v[176:179], a[64:67], a[40:43], v[176:179]
ds_read_b64_tr_b16 a[90:91], v31 offset:25096
v_mfma_f32_16x16x32_bf16 v[176:179], a[68:71], a[44:47], v[176:179]
ds_read_b64_tr_b16 a[92:93], v31 offset:28680
v_mfma_f32_16x16x32_bf16 v[208:211], a[64:67], a[48:51], v[208:211]
ds_read_b64_tr_b16 a[94:95], v31 offset:29192
v_mfma_f32_16x16x32_bf16 v[208:211], a[68:71], a[52:55], v[208:211]
buffer_load_dwordx4 v23, s[4:7], s40 offen offset:3072 lds
v_mfma_f32_16x16x32_bf16 v[240:243], a[64:67], a[56:59], v[240:243]
s_add_u32 s39, s39, 128
s_add_u32 s40, s40, 128
s_add_u32 m0, s69, 0
s_mov_b32 s46, 0
v_mfma_f32_16x16x32_bf16 v[240:243], a[68:71], a[60:63], v[240:243]
s_waitcnt lgkmcnt(8)
buffer_load_dwordx4 v96, s[12:15], s46 offen offset:0 nt lds
v_mfma_f32_16x16x32_bf16 v[148:151], a[72:75], a[32:35], v[148:151]
v_mfma_f32_16x16x32_bf16 v[148:151], a[76:79], a[36:39], v[148:151]
s_add_u32 m0, s69, 0
s_mov_b32 s46, 0
v_mfma_f32_16x16x32_bf16 v[180:183], a[72:75], a[40:43], v[180:183]
buffer_load_dwordx4 v97, s[12:15], s46 offen offset:1024 nt lds
v_mfma_f32_16x16x32_bf16 v[180:183], a[76:79], a[44:47], v[180:183]
s_waitcnt vmcnt(18) lgkmcnt(0)
v_mfma_f32_16x16x32_bf16 v[212:215], a[72:75], a[48:51], v[212:215]
s_barrier
v_mfma_f32_16x16x32_bf16 v[212:215], a[76:79], a[52:55], v[212:215]
ds_read_b64_tr_b16 a[64:65], v30 offset:32768
s_add_u32 m0, s33, 131072
v_mfma_f32_16x16x32_bf16 v[244:247], a[72:75], a[56:59], v[244:247]
ds_read_b64_tr_b16 a[66:67], v30 offset:33280
buffer_load_dwordx4 v24, s[8:11], s41 offen offset:0 lds
v_mfma_f32_16x16x32_bf16 v[244:247], a[76:79], a[60:63], v[244:247]
ds_read_b64_tr_b16 a[68:69], v30 offset:36864
v_mfma_f32_16x16x32_bf16 v[152:155], a[80:83], a[32:35], v[152:155]
ds_read_b64_tr_b16 a[70:71], v30 offset:37376
v_mfma_f32_16x16x32_bf16 v[152:155], a[84:87], a[36:39], v[152:155]
v_mfma_f32_16x16x32_bf16 v[184:187], a[80:83], a[40:43], v[184:187]
v_mfma_f32_16x16x32_bf16 v[184:187], a[84:87], a[44:47], v[184:187]
buffer_load_dwordx4 v25, s[8:11], s41 offen offset:1024 lds
v_mfma_f32_16x16x32_bf16 v[216:219], a[80:83], a[48:51], v[216:219]
v_mfma_f32_16x16x32_bf16 v[216:219], a[84:87], a[52:55], v[216:219]
ds_read_b64_tr_b16 a[72:73], v30 offset:32776
v_mfma_f32_16x16x32_bf16 v[248:251], a[80:83], a[56:59], v[248:251]
ds_read_b64_tr_b16 a[74:75], v30 offset:33288
v_mfma_f32_16x16x32_bf16 v[248:251], a[84:87], a[60:63], v[248:251]
ds_read_b64_tr_b16 a[76:77], v30 offset:36872
v_mfma_f32_16x16x32_bf16 v[156:159], a[88:91], a[32:35], v[156:159]
ds_read_b64_tr_b16 a[78:79], v30 offset:37384
buffer_load_dwordx4 v26, s[8:11], s41 offen offset:2048 lds
v_mfma_f32_16x16x32_bf16 v[156:159], a[92:95], a[36:39], v[156:159]
v_mfma_f32_16x16x32_bf16 v[188:191], a[88:91], a[40:43], v[188:191]
v_mfma_f32_16x16x32_bf16 v[188:191], a[92:95], a[44:47], v[188:191]
v_mfma_f32_16x16x32_bf16 v[220:223], a[88:91], a[48:51], v[220:223]
v_mfma_f32_16x16x32_bf16 v[220:223], a[92:95], a[52:55], v[220:223]
ds_read_b64_tr_b16 a[80:81], v31 offset:32768
buffer_load_dwordx4 v27, s[8:11], s41 offen offset:3072 lds
v_mfma_f32_16x16x32_bf16 v[252:255], a[88:91], a[56:59], v[252:255]
ds_read_b64_tr_b16 a[82:83], v31 offset:33280
s_add_u32 s41, s41, 256
v_mfma_f32_16x16x32_bf16 v[252:255], a[92:95], a[60:63], v[252:255]
ds_read_b64_tr_b16 a[84:85], v31 offset:36864
s_waitcnt lgkmcnt(7)
v_mfma_f32_16x16x32_bf16 a[128:131], a[64:67], a[32:35], a[128:131]
ds_read_b64_tr_b16 a[86:87], v31 offset:37376
v_mfma_f32_16x16x32_bf16 a[128:131], a[68:71], a[36:39], a[128:131]
v_mfma_f32_16x16x32_bf16 a[160:163], a[64:67], a[40:43], a[160:163]
v_mfma_f32_16x16x32_bf16 a[160:163], a[68:71], a[44:47], a[160:163]
v_mfma_f32_16x16x32_bf16 a[192:195], a[64:67], a[48:51], a[192:195]
v_mfma_f32_16x16x32_bf16 a[192:195], a[68:71], a[52:55], a[192:195]
ds_read_b64_tr_b16 a[88:89], v31 offset:32776
v_mfma_f32_16x16x32_bf16 a[224:227], a[64:67], a[56:59], a[224:227]
ds_read_b64_tr_b16 a[90:91], v31 offset:33288
v_mfma_f32_16x16x32_bf16 a[224:227], a[68:71], a[60:63], a[224:227]
ds_read_b64_tr_b16 a[92:93], v31 offset:36872
s_waitcnt lgkmcnt(7)
v_mfma_f32_16x16x32_bf16 a[132:135], a[72:75], a[32:35], a[132:135]
ds_read_b64_tr_b16 a[94:95], v31 offset:37384
v_mfma_f32_16x16x32_bf16 a[132:135], a[76:79], a[36:39], a[132:135]
ds_read_b128 a[0:3], v18 offset:0
v_mfma_f32_16x16x32_bf16 a[164:167], a[72:75], a[40:43], a[164:167]
ds_read_b128 a[4:7], v19 offset:0
v_mfma_f32_16x16x32_bf16 a[164:167], a[76:79], a[44:47], a[164:167]
s_add_u32 m0, s69, 65536
s_mov_b32 s46, 0
v_mfma_f32_16x16x32_bf16 a[196:199], a[72:75], a[48:51], a[196:199]
ds_read_b64_tr_b16 a[64:65], v30 offset:40960
buffer_load_dwordx4 v98, s[16:19], s46 offen offset:0 nt lds
v_mfma_f32_16x16x32_bf16 a[196:199], a[76:79], a[52:55], a[196:199]
ds_read_b64_tr_b16 a[66:67], v30 offset:41472
v_mfma_f32_16x16x32_bf16 a[228:231], a[72:75], a[56:59], a[228:231]
ds_read_b64_tr_b16 a[68:69], v30 offset:45056
v_mfma_f32_16x16x32_bf16 a[228:231], a[76:79], a[60:63], a[228:231]
ds_read_b64_tr_b16 a[70:71], v30 offset:45568
s_waitcnt lgkmcnt(10)
v_mfma_f32_16x16x32_bf16 a[136:139], a[80:83], a[32:35], a[136:139]
ds_read_b128 a[8:11], v18 offset:2048
v_mfma_f32_16x16x32_bf16 a[136:139], a[84:87], a[36:39], a[136:139]
ds_read_b128 a[12:15], v19 offset:2048
v_mfma_f32_16x16x32_bf16 a[168:171], a[80:83], a[40:43], a[168:171]
v_mfma_f32_16x16x32_bf16 a[168:171], a[84:87], a[44:47], a[168:171]
ds_read_b64_tr_b16 a[72:73], v30 offset:40968
v_mfma_f32_16x16x32_bf16 a[200:203], a[80:83], a[48:51], a[200:203]
ds_read_b64_tr_b16 a[74:75], v30 offset:41480
v_mfma_f32_16x16x32_bf16 a[200:203], a[84:87], a[52:55], a[200:203]
ds_read_b64_tr_b16 a[76:77], v30 offset:45064
v_mfma_f32_16x16x32_bf16 a[232:235], a[80:83], a[56:59], a[232:235]
ds_read_b64_tr_b16 a[78:79], v30 offset:45576
v_mfma_f32_16x16x32_bf16 a[232:235], a[84:87], a[60:63], a[232:235]
ds_read_b128 a[16:19], v18 offset:4096
s_waitcnt lgkmcnt(13)
v_mfma_f32_16x16x32_bf16 a[140:143], a[88:91], a[32:35], a[140:143]
ds_read_b128 a[20:23], v19 offset:4096
v_mfma_f32_16x16x32_bf16 a[140:143], a[92:95], a[36:39], a[140:143]
v_mfma_f32_16x16x32_bf16 a[172:175], a[88:91], a[40:43], a[172:175]
ds_read_b64_tr_b16 a[80:81], v31 offset:40960
v_mfma_f32_16x16x32_bf16 a[172:175], a[92:95], a[44:47], a[172:175]
ds_read_b64_tr_b16 a[82:83], v31 offset:41472
v_mfma_f32_16x16x32_bf16 a[204:207], a[88:91], a[48:51], a[204:207]
ds_read_b64_tr_b16 a[84:85], v31 offset:45056
v_mfma_f32_16x16x32_bf16 a[204:207], a[92:95], a[52:55], a[204:207]
ds_read_b64_tr_b16 a[86:87], v31 offset:45568
v_mfma_f32_16x16x32_bf16 a[236:239], a[88:91], a[56:59], a[236:239]
ds_read_b128 a[24:27], v18 offset:6144
v_mfma_f32_16x16x32_bf16 a[236:239], a[92:95], a[60:63], a[236:239]
ds_read_b128 a[28:31], v19 offset:6144
s_waitcnt lgkmcnt(14)
s_add_u32 m0, s69, 65536
s_mov_b32 s46, 0
v_mfma_f32_16x16x32_bf16 a[144:147], a[64:67], a[32:35], a[144:147]
buffer_load_dwordx4 v99, s[16:19], s46 offen offset:1024 nt lds
v_mfma_f32_16x16x32_bf16 a[144:147], a[68:71], a[36:39], a[144:147]
ds_read_b64_tr_b16 a[88:89], v31 offset:40968
v_mfma_f32_16x16x32_bf16 a[176:179], a[64:67], a[40:43], a[176:179]
ds_read_b64_tr_b16 a[90:91], v31 offset:41480
v_mfma_f32_16x16x32_bf16 a[176:179], a[68:71], a[44:47], a[176:179]
ds_read_b64_tr_b16 a[92:93], v31 offset:45064
v_mfma_f32_16x16x32_bf16 a[208:211], a[64:67], a[48:51], a[208:211]
ds_read_b64_tr_b16 a[94:95], v31 offset:45576
v_mfma_f32_16x16x32_bf16 a[208:211], a[68:71], a[52:55], a[208:211]
v_mfma_f32_16x16x32_bf16 a[240:243], a[64:67], a[56:59], a[240:243]
v_mfma_f32_16x16x32_bf16 a[240:243], a[68:71], a[60:63], a[240:243]
s_waitcnt lgkmcnt(12)
v_mfma_f32_16x16x32_bf16 a[148:151], a[72:75], a[32:35], a[148:151]
v_mfma_f32_16x16x32_bf16 a[148:151], a[76:79], a[36:39], a[148:151]
v_mfma_f32_16x16x32_bf16 a[180:183], a[72:75], a[40:43], a[180:183]
v_mfma_f32_16x16x32_bf16 a[180:183], a[76:79], a[44:47], a[180:183]
s_waitcnt vmcnt(20) lgkmcnt(0)
v_mfma_f32_16x16x32_bf16 a[212:215], a[72:75], a[48:51], a[212:215]
s_barrier
v_mfma_f32_16x16x32_bf16 a[212:215], a[76:79], a[52:55], a[212:215]
ds_read_b64_tr_b16 a[64:65], v28 offset:0
s_add_u32 m0, s33, 147456
v_mfma_f32_16x16x32_bf16 a[244:247], a[72:75], a[56:59], a[244:247]
ds_read_b64_tr_b16 a[66:67], v28 offset:512
buffer_load_dwordx4 v24, s[8:11], s41 offen offset:0 lds
v_mfma_f32_16x16x32_bf16 a[244:247], a[76:79], a[60:63], a[244:247]
ds_read_b64_tr_b16 a[68:69], v28 offset:4096
v_mfma_f32_16x16x32_bf16 a[152:155], a[80:83], a[32:35], a[152:155]
ds_read_b64_tr_b16 a[70:71], v28 offset:4608
v_mfma_f32_16x16x32_bf16 a[152:155], a[84:87], a[36:39], a[152:155]
v_mfma_f32_16x16x32_bf16 a[184:187], a[80:83], a[40:43], a[184:187]
v_mfma_f32_16x16x32_bf16 a[184:187], a[84:87], a[44:47], a[184:187]
buffer_load_dwordx4 v25, s[8:11], s41 offen offset:1024 lds
v_mfma_f32_16x16x32_bf16 a[216:219], a[80:83], a[48:51], a[216:219]
v_mfma_f32_16x16x32_bf16 a[216:219], a[84:87], a[52:55], a[216:219]
ds_read_b64_tr_b16 a[72:73], v28 offset:8
v_mfma_f32_16x16x32_bf16 a[248:251], a[80:83], a[56:59], a[248:251]
ds_read_b64_tr_b16 a[74:75], v28 offset:520
v_mfma_f32_16x16x32_bf16 a[248:251], a[84:87], a[60:63], a[248:251]
ds_read_b64_tr_b16 a[76:77], v28 offset:4104
v_mfma_f32_16x16x32_bf16 a[156:159], a[88:91], a[32:35], a[156:159]
ds_read_b64_tr_b16 a[78:79], v28 offset:4616
buffer_load_dwordx4 v26, s[8:11], s41 offen offset:2048 lds
v_mfma_f32_16x16x32_bf16 a[156:159], a[92:95], a[36:39], a[156:159]
v_mfma_f32_16x16x32_bf16 a[188:191], a[88:91], a[40:43], a[188:191]
v_mfma_f32_16x16x32_bf16 a[188:191], a[92:95], a[44:47], a[188:191]
v_mfma_f32_16x16x32_bf16 a[220:223], a[88:91], a[48:51], a[220:223]
v_mfma_f32_16x16x32_bf16 a[220:223], a[92:95], a[52:55], a[220:223]
ds_read_b64_tr_b16 a[80:81], v29 offset:0
buffer_load_dwordx4 v27, s[8:11], s41 offen offset:3072 lds
v_mfma_f32_16x16x32_bf16 a[252:255], a[88:91], a[56:59], a[252:255]
ds_read_b64_tr_b16 a[82:83], v29 offset:512
s_add_u32 s41, s41, 524032
v_mfma_f32_16x16x32_bf16 a[252:255], a[92:95], a[60:63], a[252:255]
ds_read_b64_tr_b16 a[84:85], v29 offset:4096
s_waitcnt lgkmcnt(7)
v_mfma_f32_16x16x32_bf16 v[128:131], a[64:67], a[0:3], v[128:131]
ds_read_b64_tr_b16 a[86:87], v29 offset:4608
v_mfma_f32_16x16x32_bf16 v[128:131], a[68:71], a[4:7], v[128:131]
s_add_u32 m0, s42, 81920
v_mfma_f32_16x16x32_bf16 v[160:163], a[64:67], a[8:11], v[160:163]
buffer_load_dwordx4 v20, s[4:7], s39 offen offset:0 lds
v_mfma_f32_16x16x32_bf16 v[160:163], a[68:71], a[12:15], v[160:163]
v_mfma_f32_16x16x32_bf16 v[192:195], a[64:67], a[16:19], v[192:195]
v_mfma_f32_16x16x32_bf16 v[192:195], a[68:71], a[20:23], v[192:195]
ds_read_b64_tr_b16 a[88:89], v29 offset:8
v_mfma_f32_16x16x32_bf16 v[224:227], a[64:67], a[24:27], v[224:227]
ds_read_b64_tr_b16 a[90:91], v29 offset:520
v_mfma_f32_16x16x32_bf16 v[224:227], a[68:71], a[28:31], v[224:227]
ds_read_b64_tr_b16 a[92:93], v29 offset:4104
s_waitcnt lgkmcnt(7)
buffer_load_dwordx4 v21, s[4:7], s39 offen offset:1024 lds
v_mfma_f32_16x16x32_bf16 v[132:135], a[72:75], a[0:3], v[132:135]
ds_read_b64_tr_b16 a[94:95], v29 offset:4616
v_mfma_f32_16x16x32_bf16 v[132:135], a[76:79], a[4:7], v[132:135]
v_mfma_f32_16x16x32_bf16 v[164:167], a[72:75], a[8:11], v[164:167]
v_mfma_f32_16x16x32_bf16 v[164:167], a[76:79], a[12:15], v[164:167]
v_mfma_f32_16x16x32_bf16 v[196:199], a[72:75], a[16:19], v[196:199]
ds_read_b64_tr_b16 a[64:65], v28 offset:8192
buffer_load_dwordx4 v22, s[4:7], s39 offen offset:2048 lds
v_mfma_f32_16x16x32_bf16 v[196:199], a[76:79], a[20:23], v[196:199]
ds_read_b64_tr_b16 a[66:67], v28 offset:8704
v_mfma_f32_16x16x32_bf16 v[228:231], a[72:75], a[24:27], v[228:231]
ds_read_b64_tr_b16 a[68:69], v28 offset:12288
v_mfma_f32_16x16x32_bf16 v[228:231], a[76:79], a[28:31], v[228:231]
ds_read_b64_tr_b16 a[70:71], v28 offset:12800
s_waitcnt lgkmcnt(8)
v_mfma_f32_16x16x32_bf16 v[136:139], a[80:83], a[0:3], v[136:139]
v_mfma_f32_16x16x32_bf16 v[136:139], a[84:87], a[4:7], v[136:139]
buffer_load_dwordx4 v23, s[4:7], s39 offen offset:3072 lds
v_mfma_f32_16x16x32_bf16 v[168:171], a[80:83], a[8:11], v[168:171]
v_mfma_f32_16x16x32_bf16 v[168:171], a[84:87], a[12:15], v[168:171]
ds_read_b64_tr_b16 a[72:73], v28 offset:8200
v_mfma_f32_16x16x32_bf16 v[200:203], a[80:83], a[16:19], v[200:203]
ds_read_b64_tr_b16 a[74:75], v28 offset:8712
v_mfma_f32_16x16x32_bf16 v[200:203], a[84:87], a[20:23], v[200:203]
ds_read_b64_tr_b16 a[76:77], v28 offset:12296
s_add_u32 m0, s42, 86016
v_mfma_f32_16x16x32_bf16 v[232:235], a[80:83], a[24:27], v[232:235]
ds_read_b64_tr_b16 a[78:79], v28 offset:12808
buffer_load_dwordx4 v20, s[4:7], s40 offen offset:0 lds
v_mfma_f32_16x16x32_bf16 v[232:235], a[84:87], a[28:31], v[232:235]
s_waitcnt lgkmcnt(8)
v_mfma_f32_16x16x32_bf16 v[140:143], a[88:91], a[0:3], v[140:143]
v_mfma_f32_16x16x32_bf16 v[140:143], a[92:95], a[4:7], v[140:143]
v_mfma_f32_16x16x32_bf16 v[172:175], a[88:91], a[8:11], v[172:175]
ds_read_b64_tr_b16 a[80:81], v29 offset:8192
v_mfma_f32_16x16x32_bf16 v[172:175], a[92:95], a[12:15], v[172:175]
ds_read_b64_tr_b16 a[82:83], v29 offset:8704
buffer_load_dwordx4 v21, s[4:7], s40 offen offset:1024 lds
v_mfma_f32_16x16x32_bf16 v[204:207], a[88:91], a[16:19], v[204:207]
ds_read_b64_tr_b16 a[84:85], v29 offset:12288
v_mfma_f32_16x16x32_bf16 v[204:207], a[92:95], a[20:23], v[204:207]
ds_read_b64_tr_b16 a[86:87], v29 offset:12800
v_mfma_f32_16x16x32_bf16 v[236:239], a[88:91], a[24:27], v[236:239]
v_mfma_f32_16x16x32_bf16 v[236:239], a[92:95], a[28:31], v[236:239]
s_waitcnt lgkmcnt(8)
v_mfma_f32_16x16x32_bf16 v[144:147], a[64:67], a[0:3], v[144:147]
buffer_load_dwordx4 v22, s[4:7], s40 offen offset:2048 lds
v_mfma_f32_16x16x32_bf16 v[144:147], a[68:71], a[4:7], v[144:147]
ds_read_b64_tr_b16 a[88:89], v29 offset:8200
v_mfma_f32_16x16x32_bf16 v[176:179], a[64:67], a[8:11], v[176:179]
ds_read_b64_tr_b16 a[90:91], v29 offset:8712
v_mfma_f32_16x16x32_bf16 v[176:179], a[68:71], a[12:15], v[176:179]
ds_read_b64_tr_b16 a[92:93], v29 offset:12296
v_mfma_f32_16x16x32_bf16 v[208:211], a[64:67], a[16:19], v[208:211]
ds_read_b64_tr_b16 a[94:95], v29 offset:12808
v_mfma_f32_16x16x32_bf16 v[208:211], a[68:71], a[20:23], v[208:211]
buffer_load_dwordx4 v23, s[4:7], s40 offen offset:3072 lds
v_mfma_f32_16x16x32_bf16 v[240:243], a[64:67], a[24:27], v[240:243]
s_add_u32 s39, s39, 128
s_add_u32 s40, s40, 128
s_add_u32 m0, s69, 8192
s_mov_b32 s46, 8192
v_mfma_f32_16x16x32_bf16 v[240:243], a[68:71], a[28:31], v[240:243]
s_waitcnt lgkmcnt(8)
buffer_load_dwordx4 v96, s[12:15], s46 offen offset:0 nt lds
v_mfma_f32_16x16x32_bf16 v[148:151], a[72:75], a[0:3], v[148:151]
v_mfma_f32_16x16x32_bf16 v[148:151], a[76:79], a[4:7], v[148:151]
s_add_u32 m0, s69, 8192
s_mov_b32 s46, 8192
v_mfma_f32_16x16x32_bf16 v[180:183], a[72:75], a[8:11], v[180:183]
buffer_load_dwordx4 v97, s[12:15], s46 offen offset:1024 nt lds
v_mfma_f32_16x16x32_bf16 v[180:183], a[76:79], a[12:15], v[180:183]
s_waitcnt vmcnt(22) lgkmcnt(0)
v_mfma_f32_16x16x32_bf16 v[212:215], a[72:75], a[16:19], v[212:215]
s_barrier
v_mfma_f32_16x16x32_bf16 v[212:215], a[76:79], a[20:23], v[212:215]
ds_read_b64_tr_b16 a[64:65], v30 offset:0
s_add_u32 m0, s33, 49152
v_mfma_f32_16x16x32_bf16 v[244:247], a[72:75], a[24:27], v[244:247]
ds_read_b64_tr_b16 a[66:67], v30 offset:512
buffer_load_dwordx4 v24, s[8:11], s41 offen offset:0 lds
v_mfma_f32_16x16x32_bf16 v[244:247], a[76:79], a[28:31], v[244:247]
ds_read_b64_tr_b16 a[68:69], v30 offset:4096
v_mfma_f32_16x16x32_bf16 v[152:155], a[80:83], a[0:3], v[152:155]
ds_read_b64_tr_b16 a[70:71], v30 offset:4608
v_mfma_f32_16x16x32_bf16 v[152:155], a[84:87], a[4:7], v[152:155]
v_mfma_f32_16x16x32_bf16 v[184:187], a[80:83], a[8:11], v[184:187]
v_mfma_f32_16x16x32_bf16 v[184:187], a[84:87], a[12:15], v[184:187]
buffer_load_dwordx4 v25, s[8:11], s41 offen offset:1024 lds
v_mfma_f32_16x16x32_bf16 v[216:219], a[80:83], a[16:19], v[216:219]
v_mfma_f32_16x16x32_bf16 v[216:219], a[84:87], a[20:23], v[216:219]
ds_read_b64_tr_b16 a[72:73], v30 offset:8
v_mfma_f32_16x16x32_bf16 v[248:251], a[80:83], a[24:27], v[248:251]
ds_read_b64_tr_b16 a[74:75], v30 offset:520
v_mfma_f32_16x16x32_bf16 v[248:251], a[84:87], a[28:31], v[248:251]
ds_read_b64_tr_b16 a[76:77], v30 offset:4104
v_mfma_f32_16x16x32_bf16 v[156:159], a[88:91], a[0:3], v[156:159]
ds_read_b64_tr_b16 a[78:79], v30 offset:4616
buffer_load_dwordx4 v26, s[8:11], s41 offen offset:2048 lds
v_mfma_f32_16x16x32_bf16 v[156:159], a[92:95], a[4:7], v[156:159]
v_mfma_f32_16x16x32_bf16 v[188:191], a[88:91], a[8:11], v[188:191]
v_mfma_f32_16x16x32_bf16 v[188:191], a[92:95], a[12:15], v[188:191]
v_mfma_f32_16x16x32_bf16 v[220:223], a[88:91], a[16:19], v[220:223]
v_mfma_f32_16x16x32_bf16 v[220:223], a[92:95], a[20:23], v[220:223]
ds_read_b64_tr_b16 a[80:81], v31 offset:0
buffer_load_dwordx4 v27, s[8:11], s41 offen offset:3072 lds
v_mfma_f32_16x16x32_bf16 v[252:255], a[88:91], a[24:27], v[252:255]
ds_read_b64_tr_b16 a[82:83], v31 offset:512
s_add_u32 s41, s41, 256
v_mfma_f32_16x16x32_bf16 v[252:255], a[92:95], a[28:31], v[252:255]
ds_read_b64_tr_b16 a[84:85], v31 offset:4096
s_waitcnt lgkmcnt(7)
v_mfma_f32_16x16x32_bf16 a[128:131], a[64:67], a[0:3], a[128:131]
ds_read_b64_tr_b16 a[86:87], v31 offset:4608
v_mfma_f32_16x16x32_bf16 a[128:131], a[68:71], a[4:7], a[128:131]
v_mfma_f32_16x16x32_bf16 a[160:163], a[64:67], a[8:11], a[160:163]
v_mfma_f32_16x16x32_bf16 a[160:163], a[68:71], a[12:15], a[160:163]
v_mfma_f32_16x16x32_bf16 a[192:195], a[64:67], a[16:19], a[192:195]
v_mfma_f32_16x16x32_bf16 a[192:195], a[68:71], a[20:23], a[192:195]
ds_read_b64_tr_b16 a[88:89], v31 offset:8
v_mfma_f32_16x16x32_bf16 a[224:227], a[64:67], a[24:27], a[224:227]
ds_read_b64_tr_b16 a[90:91], v31 offset:520
v_mfma_f32_16x16x32_bf16 a[224:227], a[68:71], a[28:31], a[224:227]
ds_read_b64_tr_b16 a[92:93], v31 offset:4104
s_waitcnt lgkmcnt(7)
v_mfma_f32_16x16x32_bf16 a[132:135], a[72:75], a[0:3], a[132:135]
ds_read_b64_tr_b16 a[94:95], v31 offset:4616
v_mfma_f32_16x16x32_bf16 a[132:135], a[76:79], a[4:7], a[132:135]
ds_read_b128 a[32:35], v16 offset:0
v_mfma_f32_16x16x32_bf16 a[164:167], a[72:75], a[8:11], a[164:167]
ds_read_b128 a[36:39], v17 offset:0
v_mfma_f32_16x16x32_bf16 a[164:167], a[76:79], a[12:15], a[164:167]
s_add_u32 m0, s69, 73728
s_mov_b32 s46, 8192
v_mfma_f32_16x16x32_bf16 a[196:199], a[72:75], a[16:19], a[196:199]
ds_read_b64_tr_b16 a[64:65], v30 offset:8192
buffer_load_dwordx4 v98, s[16:19], s46 offen offset:0 nt lds
v_mfma_f32_16x16x32_bf16 a[196:199], a[76:79], a[20:23], a[196:199]
ds_read_b64_tr_b16 a[66:67], v30 offset:8704
v_mfma_f32_16x16x32_bf16 a[228:231], a[72:75], a[24:27], a[228:231]
ds_read_b64_tr_b16 a[68:69], v30 offset:12288
v_mfma_f32_16x16x32_bf16 a[228:231], a[76:79], a[28:31], a[228:231]
ds_read_b64_tr_b16 a[70:71], v30 offset:12800
s_waitcnt lgkmcnt(10)
v_mfma_f32_16x16x32_bf16 a[136:139], a[80:83], a[0:3], a[136:139]
ds_read_b128 a[40:43], v16 offset:2048
v_mfma_f32_16x16x32_bf16 a[136:139], a[84:87], a[4:7], a[136:139]
ds_read_b128 a[44:47], v17 offset:2048
v_mfma_f32_16x16x32_bf16 a[168:171], a[80:83], a[8:11], a[168:171]
v_mfma_f32_16x16x32_bf16 a[168:171], a[84:87], a[12:15], a[168:171]
ds_read_b64_tr_b16 a[72:73], v30 offset:8200
v_mfma_f32_16x16x32_bf16 a[200:203], a[80:83], a[16:19], a[200:203]
ds_read_b64_tr_b16 a[74:75], v30 offset:8712
v_mfma_f32_16x16x32_bf16 a[200:203], a[84:87], a[20:23], a[200:203]
ds_read_b64_tr_b16 a[76:77], v30 offset:12296
v_mfma_f32_16x16x32_bf16 a[232:235], a[80:83], a[24:27], a[232:235]
ds_read_b64_tr_b16 a[78:79], v30 offset:12808
v_mfma_f32_16x16x32_bf16 a[232:235], a[84:87], a[28:31], a[232:235]
ds_read_b128 a[48:51], v16 offset:4096
s_waitcnt lgkmcnt(13)
v_mfma_f32_16x16x32_bf16 a[140:143], a[88:91], a[0:3], a[140:143]
ds_read_b128 a[52:55], v17 offset:4096
v_mfma_f32_16x16x32_bf16 a[140:143], a[92:95], a[4:7], a[140:143]
v_mfma_f32_16x16x32_bf16 a[172:175], a[88:91], a[8:11], a[172:175]
ds_read_b64_tr_b16 a[80:81], v31 offset:8192
v_mfma_f32_16x16x32_bf16 a[172:175], a[92:95], a[12:15], a[172:175]
ds_read_b64_tr_b16 a[82:83], v31 offset:8704
v_mfma_f32_16x16x32_bf16 a[204:207], a[88:91], a[16:19], a[204:207]
ds_read_b64_tr_b16 a[84:85], v31 offset:12288
v_mfma_f32_16x16x32_bf16 a[204:207], a[92:95], a[20:23], a[204:207]
ds_read_b64_tr_b16 a[86:87], v31 offset:12800
v_mfma_f32_16x16x32_bf16 a[236:239], a[88:91], a[24:27], a[236:239]
ds_read_b128 a[56:59], v16 offset:6144
v_mfma_f32_16x16x32_bf16 a[236:239], a[92:95], a[28:31], a[236:239]
ds_read_b128 a[60:63], v17 offset:6144
s_waitcnt lgkmcnt(14)
s_add_u32 m0, s69, 73728
s_mov_b32 s46, 8192
v_mfma_f32_16x16x32_bf16 a[144:147], a[64:67], a[0:3], a[144:147]
buffer_load_dwordx4 v99, s[16:19], s46 offen offset:1024 nt lds
v_mfma_f32_16x16x32_bf16 a[144:147], a[68:71], a[4:7], a[144:147]
ds_read_b64_tr_b16 a[88:89], v31 offset:8200
v_mfma_f32_16x16x32_bf16 a[176:179], a[64:67], a[8:11], a[176:179]
ds_read_b64_tr_b16 a[90:91], v31 offset:8712
v_mfma_f32_16x16x32_bf16 a[176:179], a[68:71], a[12:15], a[176:179]
ds_read_b64_tr_b16 a[92:93], v31 offset:12296
v_mfma_f32_16x16x32_bf16 a[208:211], a[64:67], a[16:19], a[208:211]
ds_read_b64_tr_b16 a[94:95], v31 offset:12808
v_mfma_f32_16x16x32_bf16 a[208:211], a[68:71], a[20:23], a[208:211]
v_mfma_f32_16x16x32_bf16 a[240:243], a[64:67], a[24:27], a[240:243]
v_mfma_f32_16x16x32_bf16 a[240:243], a[68:71], a[28:31], a[240:243]
s_waitcnt lgkmcnt(12)
v_mfma_f32_16x16x32_bf16 a[148:151], a[72:75], a[0:3], a[148:151]
v_mfma_f32_16x16x32_bf16 a[148:151], a[76:79], a[4:7], a[148:151]
global_load_dword v1, v[76:77], off
v_mfma_f32_16x16x32_bf16 a[180:183], a[72:75], a[8:11], a[180:183]
v_mfma_f32_16x16x32_bf16 a[180:183], a[76:79], a[12:15], a[180:183]
s_waitcnt vmcnt(23) lgkmcnt(0)
v_mfma_f32_16x16x32_bf16 a[212:215], a[72:75], a[16:19], a[212:215]
s_barrier
v_mfma_f32_16x16x32_bf16 a[212:215], a[76:79], a[20:23], a[212:215]
ds_read_b64_tr_b16 a[64:65], v30 offset:16384
s_add_u32 m0, s33, 114688
v_mfma_f32_16x16x32_bf16 a[244:247], a[72:75], a[24:27], a[244:247]
ds_read_b64_tr_b16 a[66:67], v30 offset:16896
buffer_load_dwordx4 v24, s[8:11], s41 offen offset:0 lds
v_mfma_f32_16x16x32_bf16 a[244:247], a[76:79], a[28:31], a[244:247]
ds_read_b64_tr_b16 a[68:69], v30 offset:20480
v_mfma_f32_16x16x32_bf16 a[152:155], a[80:83], a[0:3], a[152:155]
ds_read_b64_tr_b16 a[70:71], v30 offset:20992
v_mfma_f32_16x16x32_bf16 a[152:155], a[84:87], a[4:7], a[152:155]
v_mfma_f32_16x16x32_bf16 a[184:187], a[80:83], a[8:11], a[184:187]
v_mfma_f32_16x16x32_bf16 a[184:187], a[84:87], a[12:15], a[184:187]
buffer_load_dwordx4 v25, s[8:11], s41 offen offset:1024 lds
v_mfma_f32_16x16x32_bf16 a[216:219], a[80:83], a[16:19], a[216:219]
v_mfma_f32_16x16x32_bf16 a[216:219], a[84:87], a[20:23], a[216:219]
ds_read_b64_tr_b16 a[72:73], v30 offset:16392
v_mfma_f32_16x16x32_bf16 a[248:251], a[80:83], a[24:27], a[248:251]
ds_read_b64_tr_b16 a[74:75], v30 offset:16904
v_mfma_f32_16x16x32_bf16 a[248:251], a[84:87], a[28:31], a[248:251]
ds_read_b64_tr_b16 a[76:77], v30 offset:20488
v_mfma_f32_16x16x32_bf16 a[156:159], a[88:91], a[0:3], a[156:159]
ds_read_b64_tr_b16 a[78:79], v30 offset:21000
buffer_load_dwordx4 v26, s[8:11], s41 offen offset:2048 lds
v_mfma_f32_16x16x32_bf16 a[156:159], a[92:95], a[4:7], a[156:159]
v_mfma_f32_16x16x32_bf16 a[188:191], a[88:91], a[8:11], a[188:191]
v_mfma_f32_16x16x32_bf16 a[188:191], a[92:95], a[12:15], a[188:191]
v_mfma_f32_16x16x32_bf16 a[220:223], a[88:91], a[16:19], a[220:223]
v_mfma_f32_16x16x32_bf16 a[220:223], a[92:95], a[20:23], a[220:223]
ds_read_b64_tr_b16 a[80:81], v31 offset:16384
buffer_load_dwordx4 v27, s[8:11], s41 offen offset:3072 lds
v_mfma_f32_16x16x32_bf16 a[252:255], a[88:91], a[24:27], a[252:255]
ds_read_b64_tr_b16 a[82:83], v31 offset:16896
s_mov_b32 s34, 16384
s_add_u32 s41, s41, 524032
v_mfma_f32_16x16x32_bf16 a[252:255], a[92:95], a[28:31], a[252:255]
ds_read_b64_tr_b16 a[84:85], v31 offset:20480
s_waitcnt lgkmcnt(7)
v_mfma_f32_16x16x32_bf16 v[128:131], a[64:67], a[32:35], v[128:131]
ds_read_b64_tr_b16 a[86:87], v31 offset:20992
v_mfma_f32_16x16x32_bf16 v[128:131], a[68:71], a[36:39], v[128:131]
s_add_u32 s46, s34, 0
s_add_u32 m0, s69, 16384
v_mfma_f32_16x16x32_bf16 v[160:163], a[64:67], a[40:43], v[160:163]
buffer_load_dwordx4 v96, s[12:15], s46 offen offset:0 nt lds
v_mfma_f32_16x16x32_bf16 v[160:163], a[68:71], a[44:47], v[160:163]
v_mfma_f32_16x16x32_bf16 v[192:195], a[64:67], a[48:51], v[192:195]
v_mfma_f32_16x16x32_bf16 v[192:195], a[68:71], a[52:55], v[192:195]
ds_read_b64_tr_b16 a[88:89], v31 offset:16392
v_mfma_f32_16x16x32_bf16 v[224:227], a[64:67], a[56:59], v[224:227]
ds_read_b64_tr_b16 a[90:91], v31 offset:16904
v_mfma_f32_16x16x32_bf16 v[224:227], a[68:71], a[60:63], v[224:227]
ds_read_b64_tr_b16 a[92:93], v31 offset:20488
s_waitcnt lgkmcnt(7)
buffer_load_dwordx4 v97, s[12:15], s46 offen offset:1024 nt lds
v_mfma_f32_16x16x32_bf16 v[132:135], a[72:75], a[32:35], v[132:135]
ds_read_b64_tr_b16 a[94:95], v31 offset:21000
v_mfma_f32_16x16x32_bf16 v[132:135], a[76:79], a[36:39], v[132:135]
v_mfma_f32_16x16x32_bf16 v[164:167], a[72:75], a[40:43], v[164:167]
v_mfma_f32_16x16x32_bf16 v[164:167], a[76:79], a[44:47], v[164:167]
s_add_u32 s46, s34, 8192
s_add_u32 m0, s69, 24576
v_mfma_f32_16x16x32_bf16 v[196:199], a[72:75], a[48:51], v[196:199]
ds_read_b64_tr_b16 a[64:65], v30 offset:24576
buffer_load_dwordx4 v96, s[12:15], s46 offen offset:0 nt lds
v_mfma_f32_16x16x32_bf16 v[196:199], a[76:79], a[52:55], v[196:199]
ds_read_b64_tr_b16 a[66:67], v30 offset:25088
v_mfma_f32_16x16x32_bf16 v[228:231], a[72:75], a[56:59], v[228:231]
ds_read_b64_tr_b16 a[68:69], v30 offset:28672
v_mfma_f32_16x16x32_bf16 v[228:231], a[76:79], a[60:63], v[228:231]
ds_read_b64_tr_b16 a[70:71], v30 offset:29184
s_waitcnt lgkmcnt(8)
v_mfma_f32_16x16x32_bf16 v[136:139], a[80:83], a[32:35], v[136:139]
v_mfma_f32_16x16x32_bf16 v[136:139], a[84:87], a[36:39], v[136:139]
buffer_load_dwordx4 v97, s[12:15], s46 offen offset:1024 nt lds
v_mfma_f32_16x16x32_bf16 v[168:171], a[80:83], a[40:43], v[168:171]
v_mfma_f32_16x16x32_bf16 v[168:171], a[84:87], a[44:47], v[168:171]
ds_read_b64_tr_b16 a[72:73], v30 offset:24584
v_mfma_f32_16x16x32_bf16 v[200:203], a[80:83], a[48:51], v[200:203]
ds_read_b64_tr_b16 a[74:75], v30 offset:25096
v_mfma_f32_16x16x32_bf16 v[200:203], a[84:87], a[52:55], v[200:203]
ds_read_b64_tr_b16 a[76:77], v30 offset:28680
s_add_u32 s46, s34, 16384
s_add_u32 m0, s69, 32768
v_mfma_f32_16x16x32_bf16 v[232:235], a[80:83], a[56:59], v[232:235]
ds_read_b64_tr_b16 a[78:79], v30 offset:29192
buffer_load_dwordx4 v96, s[12:15], s46 offen offset:0 nt lds
v_mfma_f32_16x16x32_bf16 v[232:235], a[84:87], a[60:63], v[232:235]
s_waitcnt lgkmcnt(8)
v_mfma_f32_16x16x32_bf16 v[140:143], a[88:91], a[32:35], v[140:143]
v_mfma_f32_16x16x32_bf16 v[140:143], a[92:95], a[36:39], v[140:143]
v_mfma_f32_16x16x32_bf16 v[172:175], a[88:91], a[40:43], v[172:175]
ds_read_b64_tr_b16 a[80:81], v31 offset:24576
v_mfma_f32_16x16x32_bf16 v[172:175], a[92:95], a[44:47], v[172:175]
ds_read_b64_tr_b16 a[82:83], v31 offset:25088
buffer_load_dwordx4 v97, s[12:15], s46 offen offset:1024 nt lds
v_mfma_f32_16x16x32_bf16 v[204:207], a[88:91], a[48:51], v[204:207]
ds_read_b64_tr_b16 a[84:85], v31 offset:28672
v_mfma_f32_16x16x32_bf16 v[204:207], a[92:95], a[52:55], v[204:207]
ds_read_b64_tr_b16 a[86:87], v31 offset:29184
v_mfma_f32_16x16x32_bf16 v[236:239], a[88:91], a[56:59], v[236:239]
v_mfma_f32_16x16x32_bf16 v[236:239], a[92:95], a[60:63], v[236:239]
s_waitcnt lgkmcnt(8)
s_add_u32 s46, s34, 24576
s_add_u32 m0, s69, 40960
v_mfma_f32_16x16x32_bf16 v[144:147], a[64:67], a[32:35], v[144:147]
buffer_load_dwordx4 v96, s[12:15], s46 offen offset:0 nt lds
v_mfma_f32_16x16x32_bf16 v[144:147], a[68:71], a[36:39], v[144:147]
ds_read_b64_tr_b16 a[88:89], v31 offset:24584
v_mfma_f32_16x16x32_bf16 v[176:179], a[64:67], a[40:43], v[176:179]
ds_read_b64_tr_b16 a[90:91], v31 offset:25096
v_mfma_f32_16x16x32_bf16 v[176:179], a[68:71], a[44:47], v[176:179]
ds_read_b64_tr_b16 a[92:93], v31 offset:28680
v_mfma_f32_16x16x32_bf16 v[208:211], a[64:67], a[48:51], v[208:211]
ds_read_b64_tr_b16 a[94:95], v31 offset:29192
v_mfma_f32_16x16x32_bf16 v[208:211], a[68:71], a[52:55], v[208:211]
buffer_load_dwordx4 v97, s[12:15], s46 offen offset:1024 nt lds
v_mfma_f32_16x16x32_bf16 v[240:243], a[64:67], a[56:59], v[240:243]
v_mfma_f32_16x16x32_bf16 v[240:243], a[68:71], a[60:63], v[240:243]
s_waitcnt lgkmcnt(8)
v_mfma_f32_16x16x32_bf16 v[148:151], a[72:75], a[32:35], v[148:151]
v_mfma_f32_16x16x32_bf16 v[148:151], a[76:79], a[36:39], v[148:151]
v_mfma_f32_16x16x32_bf16 v[180:183], a[72:75], a[40:43], v[180:183]
v_mfma_f32_16x16x32_bf16 v[180:183], a[76:79], a[44:47], v[180:183]
s_waitcnt vmcnt(21) lgkmcnt(0)
v_mfma_f32_16x16x32_bf16 v[212:215], a[72:75], a[48:51], v[212:215]
s_barrier
v_mfma_f32_16x16x32_bf16 v[212:215], a[76:79], a[52:55], v[212:215]
ds_read_b64_tr_b16 a[64:65], v30 offset:32768
v_mfma_f32_16x16x32_bf16 v[244:247], a[72:75], a[56:59], v[244:247]
ds_read_b64_tr_b16 a[66:67], v30 offset:33280
v_mfma_f32_16x16x32_bf16 v[244:247], a[76:79], a[60:63], v[244:247]
ds_read_b64_tr_b16 a[68:69], v30 offset:36864
v_mfma_f32_16x16x32_bf16 v[152:155], a[80:83], a[32:35], v[152:155]
ds_read_b64_tr_b16 a[70:71], v30 offset:37376
v_mfma_f32_16x16x32_bf16 v[152:155], a[84:87], a[36:39], v[152:155]
v_mfma_f32_16x16x32_bf16 v[184:187], a[80:83], a[40:43], v[184:187]
v_mfma_f32_16x16x32_bf16 v[184:187], a[84:87], a[44:47], v[184:187]
v_mfma_f32_16x16x32_bf16 v[216:219], a[80:83], a[48:51], v[216:219]
v_mfma_f32_16x16x32_bf16 v[216:219], a[84:87], a[52:55], v[216:219]
ds_read_b64_tr_b16 a[72:73], v30 offset:32776
v_mfma_f32_16x16x32_bf16 v[248:251], a[80:83], a[56:59], v[248:251]
ds_read_b64_tr_b16 a[74:75], v30 offset:33288
v_mfma_f32_16x16x32_bf16 v[248:251], a[84:87], a[60:63], v[248:251]
ds_read_b64_tr_b16 a[76:77], v30 offset:36872
v_mfma_f32_16x16x32_bf16 v[156:159], a[88:91], a[32:35], v[156:159]
ds_read_b64_tr_b16 a[78:79], v30 offset:37384
v_mfma_f32_16x16x32_bf16 v[156:159], a[92:95], a[36:39], v[156:159]
v_mfma_f32_16x16x32_bf16 v[188:191], a[88:91], a[40:43], v[188:191]
v_mfma_f32_16x16x32_bf16 v[188:191], a[92:95], a[44:47], v[188:191]
v_mfma_f32_16x16x32_bf16 v[220:223], a[88:91], a[48:51], v[220:223]
v_mfma_f32_16x16x32_bf16 v[220:223], a[92:95], a[52:55], v[220:223]
ds_read_b64_tr_b16 a[80:81], v31 offset:32768
v_mfma_f32_16x16x32_bf16 v[252:255], a[88:91], a[56:59], v[252:255]
ds_read_b64_tr_b16 a[82:83], v31 offset:33280
v_mfma_f32_16x16x32_bf16 v[252:255], a[92:95], a[60:63], v[252:255]
ds_read_b64_tr_b16 a[84:85], v31 offset:36864
s_waitcnt lgkmcnt(7)
v_mfma_f32_16x16x32_bf16 a[128:131], a[64:67], a[32:35], a[128:131]
ds_read_b64_tr_b16 a[86:87], v31 offset:37376
v_mfma_f32_16x16x32_bf16 a[128:131], a[68:71], a[36:39], a[128:131]
v_mfma_f32_16x16x32_bf16 a[160:163], a[64:67], a[40:43], a[160:163]
v_mfma_f32_16x16x32_bf16 a[160:163], a[68:71], a[44:47], a[160:163]
v_mfma_f32_16x16x32_bf16 a[192:195], a[64:67], a[48:51], a[192:195]
v_mfma_f32_16x16x32_bf16 a[192:195], a[68:71], a[52:55], a[192:195]
ds_read_b64_tr_b16 a[88:89], v31 offset:32776
v_mfma_f32_16x16x32_bf16 a[224:227], a[64:67], a[56:59], a[224:227]
ds_read_b64_tr_b16 a[90:91], v31 offset:33288
v_mfma_f32_16x16x32_bf16 a[224:227], a[68:71], a[60:63], a[224:227]
ds_read_b64_tr_b16 a[92:93], v31 offset:36872
s_waitcnt lgkmcnt(7)
v_mfma_f32_16x16x32_bf16 a[132:135], a[72:75], a[32:35], a[132:135]
ds_read_b64_tr_b16 a[94:95], v31 offset:37384
v_mfma_f32_16x16x32_bf16 a[132:135], a[76:79], a[36:39], a[132:135]
ds_read_b128 a[0:3], v18 offset:0
v_mfma_f32_16x16x32_bf16 a[164:167], a[72:75], a[40:43], a[164:167]
ds_read_b128 a[4:7], v19 offset:0
v_mfma_f32_16x16x32_bf16 a[164:167], a[76:79], a[44:47], a[164:167]
v_mfma_f32_16x16x32_bf16 a[196:199], a[72:75], a[48:51], a[196:199]
ds_read_b64_tr_b16 a[64:65], v30 offset:40960
v_mfma_f32_16x16x32_bf16 a[196:199], a[76:79], a[52:55], a[196:199]
ds_read_b64_tr_b16 a[66:67], v30 offset:41472
v_mfma_f32_16x16x32_bf16 a[228:231], a[72:75], a[56:59], a[228:231]
ds_read_b64_tr_b16 a[68:69], v30 offset:45056
v_mfma_f32_16x16x32_bf16 a[228:231], a[76:79], a[60:63], a[228:231]
ds_read_b64_tr_b16 a[70:71], v30 offset:45568
s_waitcnt lgkmcnt(10)
v_mfma_f32_16x16x32_bf16 a[136:139], a[80:83], a[32:35], a[136:139]
ds_read_b128 a[8:11], v18 offset:2048
v_mfma_f32_16x16x32_bf16 a[136:139], a[84:87], a[36:39], a[136:139]
ds_read_b128 a[12:15], v19 offset:2048
v_mfma_f32_16x16x32_bf16 a[168:171], a[80:83], a[40:43], a[168:171]
v_mfma_f32_16x16x32_bf16 a[168:171], a[84:87], a[44:47], a[168:171]
ds_read_b64_tr_b16 a[72:73], v30 offset:40968
v_mfma_f32_16x16x32_bf16 a[200:203], a[80:83], a[48:51], a[200:203]
ds_read_b64_tr_b16 a[74:75], v30 offset:41480
v_mfma_f32_16x16x32_bf16 a[200:203], a[84:87], a[52:55], a[200:203]
ds_read_b64_tr_b16 a[76:77], v30 offset:45064
v_mfma_f32_16x16x32_bf16 a[232:235], a[80:83], a[56:59], a[232:235]
ds_read_b64_tr_b16 a[78:79], v30 offset:45576
v_mfma_f32_16x16x32_bf16 a[232:235], a[84:87], a[60:63], a[232:235]
ds_read_b128 a[16:19], v18 offset:4096
s_waitcnt lgkmcnt(13)
v_mfma_f32_16x16x32_bf16 a[140:143], a[88:91], a[32:35], a[140:143]
ds_read_b128 a[20:23], v19 offset:4096
v_mfma_f32_16x16x32_bf16 a[140:143], a[92:95], a[36:39], a[140:143]
v_mfma_f32_16x16x32_bf16 a[172:175], a[88:91], a[40:43], a[172:175]
ds_read_b64_tr_b16 a[80:81], v31 offset:40960
v_mfma_f32_16x16x32_bf16 a[172:175], a[92:95], a[44:47], a[172:175]
ds_read_b64_tr_b16 a[82:83], v31 offset:41472
v_mfma_f32_16x16x32_bf16 a[204:207], a[88:91], a[48:51], a[204:207]
ds_read_b64_tr_b16 a[84:85], v31 offset:45056
v_mfma_f32_16x16x32_bf16 a[204:207], a[92:95], a[52:55], a[204:207]
ds_read_b64_tr_b16 a[86:87], v31 offset:45568
v_mfma_f32_16x16x32_bf16 a[236:239], a[88:91], a[56:59], a[236:239]
ds_read_b128 a[24:27], v18 offset:6144
v_mfma_f32_16x16x32_bf16 a[236:239], a[92:95], a[60:63], a[236:239]
ds_read_b128 a[28:31], v19 offset:6144
s_waitcnt lgkmcnt(14)
v_mfma_f32_16x16x32_bf16 a[144:147], a[64:67], a[32:35], a[144:147]
v_mfma_f32_16x16x32_bf16 a[144:147], a[68:71], a[36:39], a[144:147]
ds_read_b64_tr_b16 a[88:89], v31 offset:40968
v_mfma_f32_16x16x32_bf16 a[176:179], a[64:67], a[40:43], a[176:179]
ds_read_b64_tr_b16 a[90:91], v31 offset:41480
v_mfma_f32_16x16x32_bf16 a[176:179], a[68:71], a[44:47], a[176:179]
ds_read_b64_tr_b16 a[92:93], v31 offset:45064
v_mfma_f32_16x16x32_bf16 a[208:211], a[64:67], a[48:51], a[208:211]
ds_read_b64_tr_b16 a[94:95], v31 offset:45576
v_mfma_f32_16x16x32_bf16 a[208:211], a[68:71], a[52:55], a[208:211]
v_mfma_f32_16x16x32_bf16 a[240:243], a[64:67], a[56:59], a[240:243]
v_mfma_f32_16x16x32_bf16 a[240:243], a[68:71], a[60:63], a[240:243]
s_waitcnt lgkmcnt(12)
v_mfma_f32_16x16x32_bf16 a[148:151], a[72:75], a[32:35], a[148:151]
v_mfma_f32_16x16x32_bf16 a[148:151], a[76:79], a[36:39], a[148:151]
v_mfma_f32_16x16x32_bf16 a[180:183], a[72:75], a[40:43], a[180:183]
v_mfma_f32_16x16x32_bf16 a[180:183], a[76:79], a[44:47], a[180:183]
s_waitcnt vmcnt(15) lgkmcnt(0)
v_mfma_f32_16x16x32_bf16 a[212:215], a[72:75], a[48:51], a[212:215]
s_barrier
v_mfma_f32_16x16x32_bf16 a[212:215], a[76:79], a[52:55], a[212:215]
ds_read_b64_tr_b16 a[64:65], v28 offset:0
v_mfma_f32_16x16x32_bf16 a[244:247], a[72:75], a[56:59], a[244:247]
ds_read_b64_tr_b16 a[66:67], v28 offset:512
v_mfma_f32_16x16x32_bf16 a[244:247], a[76:79], a[60:63], a[244:247]
ds_read_b64_tr_b16 a[68:69], v28 offset:4096
v_mfma_f32_16x16x32_bf16 a[152:155], a[80:83], a[32:35], a[152:155]
ds_read_b64_tr_b16 a[70:71], v28 offset:4608
v_mfma_f32_16x16x32_bf16 a[152:155], a[84:87], a[36:39], a[152:155]
v_mfma_f32_16x16x32_bf16 a[184:187], a[80:83], a[40:43], a[184:187]
v_mfma_f32_16x16x32_bf16 a[184:187], a[84:87], a[44:47], a[184:187]
v_mfma_f32_16x16x32_bf16 a[216:219], a[80:83], a[48:51], a[216:219]
v_mfma_f32_16x16x32_bf16 a[216:219], a[84:87], a[52:55], a[216:219]
ds_read_b64_tr_b16 a[72:73], v28 offset:8
v_mfma_f32_16x16x32_bf16 a[248:251], a[80:83], a[56:59], a[248:251]
ds_read_b64_tr_b16 a[74:75], v28 offset:520
v_mfma_f32_16x16x32_bf16 a[248:251], a[84:87], a[60:63], a[248:251]
ds_read_b64_tr_b16 a[76:77], v28 offset:4104
v_mfma_f32_16x16x32_bf16 a[156:159], a[88:91], a[32:35], a[156:159]
ds_read_b64_tr_b16 a[78:79], v28 offset:4616
v_mfma_f32_16x16x32_bf16 a[156:159], a[92:95], a[36:39], a[156:159]
v_mfma_f32_16x16x32_bf16 a[188:191], a[88:91], a[40:43], a[188:191]
v_mfma_f32_16x16x32_bf16 a[188:191], a[92:95], a[44:47], a[188:191]
v_mfma_f32_16x16x32_bf16 a[220:223], a[88:91], a[48:51], a[220:223]
v_mfma_f32_16x16x32_bf16 a[220:223], a[92:95], a[52:55], a[220:223]
ds_read_b64_tr_b16 a[80:81], v29 offset:0
v_mfma_f32_16x16x32_bf16 a[252:255], a[88:91], a[56:59], a[252:255]
ds_read_b64_tr_b16 a[82:83], v29 offset:512
v_mfma_f32_16x16x32_bf16 a[252:255], a[92:95], a[60:63], a[252:255]
ds_read_b64_tr_b16 a[84:85], v29 offset:4096
s_waitcnt lgkmcnt(7)
v_mfma_f32_16x16x32_bf16 v[128:131], a[64:67], a[0:3], v[128:131]
ds_read_b64_tr_b16 a[86:87], v29 offset:4608
v_mfma_f32_16x16x32_bf16 v[128:131], a[68:71], a[4:7], v[128:131]
s_add_u32 s46, s34, 0
s_add_u32 m0, s69, 81920
v_mfma_f32_16x16x32_bf16 v[160:163], a[64:67], a[8:11], v[160:163]
buffer_load_dwordx4 v98, s[16:19], s46 offen offset:0 nt lds
v_mfma_f32_16x16x32_bf16 v[160:163], a[68:71], a[12:15], v[160:163]
v_mfma_f32_16x16x32_bf16 v[192:195], a[64:67], a[16:19], v[192:195]
v_mfma_f32_16x16x32_bf16 v[192:195], a[68:71], a[20:23], v[192:195]
ds_read_b64_tr_b16 a[88:89], v29 offset:8
v_mfma_f32_16x16x32_bf16 v[224:227], a[64:67], a[24:27], v[224:227]
ds_read_b64_tr_b16 a[90:91], v29 offset:520
v_mfma_f32_16x16x32_bf16 v[224:227], a[68:71], a[28:31], v[224:227]
ds_read_b64_tr_b16 a[92:93], v29 offset:4104
s_waitcnt lgkmcnt(7)
buffer_load_dwordx4 v99, s[16:19], s46 offen offset:1024 nt lds
v_mfma_f32_16x16x32_bf16 v[132:135], a[72:75], a[0:3], v[132:135]
ds_read_b64_tr_b16 a[94:95], v29 offset:4616
v_mfma_f32_16x16x32_bf16 v[132:135], a[76:79], a[4:7], v[132:135]
v_mfma_f32_16x16x32_bf16 v[164:167], a[72:75], a[8:11], v[164:167]
v_mfma_f32_16x16x32_bf16 v[164:167], a[76:79], a[12:15], v[164:167]
s_add_u32 s46, s34, 8192
s_add_u32 m0, s69, 90112
v_mfma_f32_16x16x32_bf16 v[196:199], a[72:75], a[16:19], v[196:199]
ds_read_b64_tr_b16 a[64:65], v28 offset:8192
buffer_load_dwordx4 v98, s[16:19], s46 offen offset:0 nt lds
v_mfma_f32_16x16x32_bf16 v[196:199], a[76:79], a[20:23], v[196:199]
ds_read_b64_tr_b16 a[66:67], v28 offset:8704
v_mfma_f32_16x16x32_bf16 v[228:231], a[72:75], a[24:27], v[228:231]
ds_read_b64_tr_b16 a[68:69], v28 offset:12288
v_mfma_f32_16x16x32_bf16 v[228:231], a[76:79], a[28:31], v[228:231]
ds_read_b64_tr_b16 a[70:71], v28 offset:12800
s_waitcnt lgkmcnt(8)
v_mfma_f32_16x16x32_bf16 v[136:139], a[80:83], a[0:3], v[136:139]
v_mfma_f32_16x16x32_bf16 v[136:139], a[84:87], a[4:7], v[136:139]
buffer_load_dwordx4 v99, s[16:19], s46 offen offset:1024 nt lds
v_mfma_f32_16x16x32_bf16 v[168:171], a[80:83], a[8:11], v[168:171]
v_mfma_f32_16x16x32_bf16 v[168:171], a[84:87], a[12:15], v[168:171]
ds_read_b64_tr_b16 a[72:73], v28 offset:8200
v_mfma_f32_16x16x32_bf16 v[200:203], a[80:83], a[16:19], v[200:203]
ds_read_b64_tr_b16 a[74:75], v28 offset:8712
v_mul_f32 v128, s44, v128
v_mul_f32 v129, s44, v129
v_mfma_f32_16x16x32_bf16 v[200:203], a[84:87], a[20:23], v[200:203]
ds_read_b64_tr_b16 a[76:77], v28 offset:12296
s_add_u32 s46, s34, 16384
s_add_u32 m0, s69, 98304
v_mul_f32 v130, s44, v130
v_mul_f32 v131, s44, v131
v_mfma_f32_16x16x32_bf16 v[232:235], a[80:83], a[24:27], v[232:235]
ds_read_b64_tr_b16 a[78:79], v28 offset:12808
buffer_load_dwordx4 v98, s[16:19], s46 offen offset:0 nt lds
v_mul_f32 v132, s44, v132
v_mul_f32 v133, s44, v133
v_mfma_f32_16x16x32_bf16 v[232:235], a[84:87], a[28:31], v[232:235]
s_waitcnt lgkmcnt(8)
v_mul_f32 v134, s44, v134
v_mul_f32 v135, s44, v135
v_mfma_f32_16x16x32_bf16 v[140:143], a[88:91], a[0:3], v[140:143]
v_cvt_pk_bf16_f32 v128, v128, v129
v_cvt_pk_bf16_f32 v130, v130, v131
v_mfma_f32_16x16x32_bf16 v[140:143], a[92:95], a[4:7], v[140:143]
v_cvt_pk_bf16_f32 v132, v132, v133
v_cvt_pk_bf16_f32 v134, v134, v135
v_mfma_f32_16x16x32_bf16 v[172:175], a[88:91], a[8:11], v[172:175]
ds_read_b64_tr_b16 a[80:81], v29 offset:8192
v_accvgpr_write_b32 a32, v128
v_accvgpr_write_b32 a33, v130
v_mfma_f32_16x16x32_bf16 v[172:175], a[92:95], a[12:15], v[172:175]
ds_read_b64_tr_b16 a[82:83], v29 offset:8704
buffer_load_dwordx4 v99, s[16:19], s46 offen offset:1024 nt lds
v_accvgpr_write_b32 a34, v132
v_accvgpr_write_b32 a35, v134
v_mfma_f32_16x16x32_bf16 v[204:207], a[88:91], a[16:19], v[204:207]
ds_read_b64_tr_b16 a[84:85], v29 offset:12288
v_mul_f32 v160, s44, v160
v_mul_f32 v161, s44, v161
v_mfma_f32_16x16x32_bf16 v[204:207], a[92:95], a[20:23], v[204:207]
ds_read_b64_tr_b16 a[86:87], v29 offset:12800
v_mul_f32 v162, s44, v162
v_mul_f32 v163, s44, v163
v_mfma_f32_16x16x32_bf16 v[236:239], a[88:91], a[24:27], v[236:239]
v_mul_f32 v164, s44, v164
v_mul_f32 v165, s44, v165
v_mfma_f32_16x16x32_bf16 v[236:239], a[92:95], a[28:31], v[236:239]
s_waitcnt lgkmcnt(8)
s_add_u32 s46, s34, 24576
s_add_u32 m0, s69, 106496
v_mul_f32 v166, s44, v166
v_mul_f32 v167, s44, v167
v_mfma_f32_16x16x32_bf16 v[144:147], a[64:67], a[0:3], v[144:147]
buffer_load_dwordx4 v98, s[16:19], s46 offen offset:0 nt lds
v_cvt_pk_bf16_f32 v160, v160, v161
v_cvt_pk_bf16_f32 v162, v162, v163
v_mfma_f32_16x16x32_bf16 v[144:147], a[68:71], a[4:7], v[144:147]
ds_read_b64_tr_b16 a[88:89], v29 offset:8200
v_cvt_pk_bf16_f32 v164, v164, v165
v_cvt_pk_bf16_f32 v166, v166, v167
v_mfma_f32_16x16x32_bf16 v[176:179], a[64:67], a[8:11], v[176:179]
ds_read_b64_tr_b16 a[90:91], v29 offset:8712
v_accvgpr_write_b32 a48, v160
v_accvgpr_write_b32 a49, v162
v_mfma_f32_16x16x32_bf16 v[176:179], a[68:71], a[12:15], v[176:179]
ds_read_b64_tr_b16 a[92:93], v29 offset:12296
v_accvgpr_write_b32 a50, v164
v_accvgpr_write_b32 a51, v166
v_mfma_f32_16x16x32_bf16 v[208:211], a[64:67], a[16:19], v[208:211]
ds_read_b64_tr_b16 a[94:95], v29 offset:12808
v_mul_f32 v192, s44, v192
v_mul_f32 v193, s44, v193
v_mfma_f32_16x16x32_bf16 v[208:211], a[68:71], a[20:23], v[208:211]
buffer_load_dwordx4 v99, s[16:19], s46 offen offset:1024 nt lds
v_mul_f32 v194, s44, v194
v_mul_f32 v195, s44, v195
v_mfma_f32_16x16x32_bf16 v[240:243], a[64:67], a[24:27], v[240:243]
s_add_u32 s34, s34, 32768
v_mul_f32 v196, s44, v196
v_mul_f32 v197, s44, v197
v_mfma_f32_16x16x32_bf16 v[240:243], a[68:71], a[28:31], v[240:243]
s_waitcnt lgkmcnt(8)
v_mul_f32 v198, s44, v198
v_mul_f32 v199, s44, v199
v_mfma_f32_16x16x32_bf16 v[148:151], a[72:75], a[0:3], v[148:151]
v_cvt_pk_bf16_f32 v192, v192, v193
v_cvt_pk_bf16_f32 v194, v194, v195
v_mfma_f32_16x16x32_bf16 v[148:151], a[76:79], a[4:7], v[148:151]
v_cvt_pk_bf16_f32 v196, v196, v197
v_cvt_pk_bf16_f32 v198, v198, v199
v_mfma_f32_16x16x32_bf16 v[180:183], a[72:75], a[8:11], v[180:183]
v_accvgpr_write_b32 a96, v192
v_accvgpr_write_b32 a97, v194
v_mfma_f32_16x16x32_bf16 v[180:183], a[76:79], a[12:15], v[180:183]
s_waitcnt vmcnt(16) lgkmcnt(0)
v_accvgpr_write_b32 a98, v196
v_accvgpr_write_b32 a99, v198
v_mfma_f32_16x16x32_bf16 v[212:215], a[72:75], a[16:19], v[212:215]
s_barrier
v_mul_f32 v224, s44, v224
v_mul_f32 v225, s44, v225
v_mfma_f32_16x16x32_bf16 v[212:215], a[76:79], a[20:23], v[212:215]
ds_read_b64_tr_b16 a[64:65], v30 offset:0
v_mul_f32 v226, s44, v226
v_mul_f32 v227, s44, v227
v_mfma_f32_16x16x32_bf16 v[244:247], a[72:75], a[24:27], v[244:247]
ds_read_b64_tr_b16 a[66:67], v30 offset:512
v_mul_f32 v228, s44, v228
v_mul_f32 v229, s44, v229
v_mfma_f32_16x16x32_bf16 v[244:247], a[76:79], a[28:31], v[244:247]
ds_read_b64_tr_b16 a[68:69], v30 offset:4096
v_mul_f32 v230, s44, v230
v_mul_f32 v231, s44, v231
v_mfma_f32_16x16x32_bf16 v[152:155], a[80:83], a[0:3], v[152:155]
ds_read_b64_tr_b16 a[70:71], v30 offset:4608
v_cvt_pk_bf16_f32 v224, v224, v225
v_cvt_pk_bf16_f32 v226, v226, v227
v_mfma_f32_16x16x32_bf16 v[152:155], a[84:87], a[4:7], v[152:155]
v_cvt_pk_bf16_f32 v228, v228, v229
v_cvt_pk_bf16_f32 v230, v230, v231
v_mfma_f32_16x16x32_bf16 v[184:187], a[80:83], a[8:11], v[184:187]
v_accvgpr_write_b32 a112, v224
v_accvgpr_write_b32 a113, v226
v_mfma_f32_16x16x32_bf16 v[184:187], a[84:87], a[12:15], v[184:187]
v_accvgpr_write_b32 a114, v228
v_accvgpr_write_b32 a115, v230
v_mfma_f32_16x16x32_bf16 v[216:219], a[80:83], a[16:19], v[216:219]
v_mul_f32 v136, s44, v136
v_mul_f32 v137, s44, v137
v_mfma_f32_16x16x32_bf16 v[216:219], a[84:87], a[20:23], v[216:219]
ds_read_b64_tr_b16 a[72:73], v30 offset:8
v_mul_f32 v138, s44, v138
v_mul_f32 v139, s44, v139
v_mfma_f32_16x16x32_bf16 v[248:251], a[80:83], a[24:27], v[248:251]
ds_read_b64_tr_b16 a[74:75], v30 offset:520
v_mul_f32 v140, s44, v140
v_mul_f32 v141, s44, v141
v_mfma_f32_16x16x32_bf16 v[248:251], a[84:87], a[28:31], v[248:251]
ds_read_b64_tr_b16 a[76:77], v30 offset:4104
v_mul_f32 v142, s44, v142
v_mul_f32 v143, s44, v143
v_mfma_f32_16x16x32_bf16 v[156:159], a[88:91], a[0:3], v[156:159]
ds_read_b64_tr_b16 a[78:79], v30 offset:4616
v_cvt_pk_bf16_f32 v136, v136, v137
v_cvt_pk_bf16_f32 v138, v138, v139
v_mfma_f32_16x16x32_bf16 v[156:159], a[92:95], a[4:7], v[156:159]
v_cvt_pk_bf16_f32 v140, v140, v141
v_cvt_pk_bf16_f32 v142, v142, v143
v_mfma_f32_16x16x32_bf16 v[188:191], a[88:91], a[8:11], v[188:191]
v_accvgpr_write_b32 a36, v136
v_accvgpr_write_b32 a37, v138
v_mfma_f32_16x16x32_bf16 v[188:191], a[92:95], a[12:15], v[188:191]
v_accvgpr_write_b32 a38, v140
v_accvgpr_write_b32 a39, v142
v_mfma_f32_16x16x32_bf16 v[220:223], a[88:91], a[16:19], v[220:223]
v_mul_f32 v168, s44, v168
v_mul_f32 v169, s44, v169
v_mfma_f32_16x16x32_bf16 v[220:223], a[92:95], a[20:23], v[220:223]
ds_read_b64_tr_b16 a[80:81], v31 offset:0
v_mul_f32 v170, s44, v170
v_mul_f32 v171, s44, v171
v_mfma_f32_16x16x32_bf16 v[252:255], a[88:91], a[24:27], v[252:255]
ds_read_b64_tr_b16 a[82:83], v31 offset:512
v_mul_f32 v172, s44, v172
v_mul_f32 v173, s44, v173
v_mfma_f32_16x16x32_bf16 v[252:255], a[92:95], a[28:31], v[252:255]
ds_read_b64_tr_b16 a[84:85], v31 offset:4096
s_waitcnt lgkmcnt(7)
v_mul_f32 v174, s44, v174
v_mul_f32 v175, s44, v175
v_mfma_f32_16x16x32_bf16 a[128:131], a[64:67], a[0:3], a[128:131]
ds_read_b64_tr_b16 a[86:87], v31 offset:4608
v_cvt_pk_bf16_f32 v168, v168, v169
v_cvt_pk_bf16_f32 v170, v170, v171
v_mfma_f32_16x16x32_bf16 a[128:131], a[68:71], a[4:7], a[128:131]
v_cvt_pk_bf16_f32 v172, v172, v173
v_cvt_pk_bf16_f32 v174, v174, v175
v_mfma_f32_16x16x32_bf16 a[160:163], a[64:67], a[8:11], a[160:163]
v_accvgpr_write_b32 a52, v168
v_accvgpr_write_b32 a53, v170
v_mfma_f32_16x16x32_bf16 a[160:163], a[68:71], a[12:15], a[160:163]
s_add_u32 m0, s69, 49152
v_accvgpr_write_b32 a54, v172
v_accvgpr_write_b32 a55, v174
v_mfma_f32_16x16x32_bf16 a[192:195], a[64:67], a[16:19], a[192:195]
buffer_load_dwordx4 v96, s[12:15], s34 offen offset:0 nt lds
v_mul_f32 v200, s44, v200
v_mul_f32 v201, s44, v201
v_mfma_f32_16x16x32_bf16 a[192:195], a[68:71], a[20:23], a[192:195]
ds_read_b64_tr_b16 a[88:89], v31 offset:8
v_mul_f32 v202, s44, v202
v_mul_f32 v203, s44, v203
v_mfma_f32_16x16x32_bf16 a[224:227], a[64:67], a[24:27], a[224:227]
ds_read_b64_tr_b16 a[90:91], v31 offset:520
v_mul_f32 v204, s44, v204
v_mul_f32 v205, s44, v205
v_mfma_f32_16x16x32_bf16 a[224:227], a[68:71], a[28:31], a[224:227]
ds_read_b64_tr_b16 a[92:93], v31 offset:4104
s_waitcnt lgkmcnt(7)
v_mul_f32 v206, s44, v206
v_mul_f32 v207, s44, v207
v_mfma_f32_16x16x32_bf16 a[132:135], a[72:75], a[0:3], a[132:135]
ds_read_b64_tr_b16 a[94:95], v31 offset:4616
v_cvt_pk_bf16_f32 v200, v200, v201
v_cvt_pk_bf16_f32 v202, v202, v203
v_mfma_f32_16x16x32_bf16 a[132:135], a[76:79], a[4:7], a[132:135]
v_cvt_pk_bf16_f32 v204, v204, v205
v_cvt_pk_bf16_f32 v206, v206, v207
v_mfma_f32_16x16x32_bf16 a[164:167], a[72:75], a[8:11], a[164:167]
v_accvgpr_write_b32 a100, v200
v_accvgpr_write_b32 a101, v202
v_mfma_f32_16x16x32_bf16 a[164:167], a[76:79], a[12:15], a[164:167]
v_accvgpr_write_b32 a102, v204
v_accvgpr_write_b32 a103, v206
v_mfma_f32_16x16x32_bf16 a[196:199], a[72:75], a[16:19], a[196:199]
ds_read_b64_tr_b16 a[64:65], v30 offset:8192
v_mul_f32 v232, s44, v232
v_mul_f32 v233, s44, v233
v_mfma_f32_16x16x32_bf16 a[196:199], a[76:79], a[20:23], a[196:199]
ds_read_b64_tr_b16 a[66:67], v30 offset:8704
buffer_load_dwordx4 v97, s[12:15], s34 offen offset:1024 nt lds
v_mul_f32 v234, s44, v234
v_mul_f32 v235, s44, v235
v_mfma_f32_16x16x32_bf16 a[228:231], a[72:75], a[24:27], a[228:231]
ds_read_b64_tr_b16 a[68:69], v30 offset:12288
v_mul_f32 v236, s44, v236
v_mul_f32 v237, s44, v237
v_mfma_f32_16x16x32_bf16 a[228:231], a[76:79], a[28:31], a[228:231]
ds_read_b64_tr_b16 a[70:71], v30 offset:12800
s_waitcnt lgkmcnt(8)
v_mul_f32 v238, s44, v238
v_mul_f32 v239, s44, v239
v_mfma_f32_16x16x32_bf16 a[136:139], a[80:83], a[0:3], a[136:139]
v_cvt_pk_bf16_f32 v232, v232, v233
v_cvt_pk_bf16_f32 v234, v234, v235
v_mfma_f32_16x16x32_bf16 a[136:139], a[84:87], a[4:7], a[136:139]
v_cvt_pk_bf16_f32 v236, v236, v237
v_cvt_pk_bf16_f32 v238, v238, v239
v_mfma_f32_16x16x32_bf16 a[168:171], a[80:83], a[8:11], a[168:171]
v_accvgpr_write_b32 a116, v232
v_accvgpr_write_b32 a117, v234
v_mfma_f32_16x16x32_bf16 a[168:171], a[84:87], a[12:15], a[168:171]
ds_read_b64_tr_b16 a[72:73], v30 offset:8200
v_accvgpr_write_b32 a118, v236
v_accvgpr_write_b32 a119, v238
v_mfma_f32_16x16x32_bf16 a[200:203], a[80:83], a[16:19], a[200:203]
ds_read_b64_tr_b16 a[74:75], v30 offset:8712
v_mul_f32 v144, s44, v144
v_mul_f32 v145, s44, v145
v_mfma_f32_16x16x32_bf16 a[200:203], a[84:87], a[20:23], a[200:203]
ds_read_b64_tr_b16 a[76:77], v30 offset:12296
s_add_u32 s46, s34, 8192
s_add_u32 m0, s69, 57344
v_mul_f32 v146, s44, v146
v_mul_f32 v147, s44, v147
v_mfma_f32_16x16x32_bf16 a[232:235], a[80:83], a[24:27], a[232:235]
ds_read_b64_tr_b16 a[78:79], v30 offset:12808
buffer_load_dwordx4 v96, s[12:15], s46 offen offset:0 nt lds
v_mul_f32 v148, s44, v148
v_mul_f32 v149, s44, v149
v_mfma_f32_16x16x32_bf16 a[232:235], a[84:87], a[28:31], a[232:235]
s_waitcnt lgkmcnt(8)
v_mul_f32 v150, s44, v150
v_mul_f32 v151, s44, v151
v_mfma_f32_16x16x32_bf16 a[140:143], a[88:91], a[0:3], a[140:143]
v_cvt_pk_bf16_f32 v144, v144, v145
v_cvt_pk_bf16_f32 v146, v146, v147
v_mfma_f32_16x16x32_bf16 a[140:143], a[92:95], a[4:7], a[140:143]
v_cvt_pk_bf16_f32 v148, v148, v149
v_cvt_pk_bf16_f32 v150, v150, v151
v_mfma_f32_16x16x32_bf16 a[172:175], a[88:91], a[8:11], a[172:175]
ds_read_b64_tr_b16 a[80:81], v31 offset:8192
v_accvgpr_write_b32 a40, v144
v_accvgpr_write_b32 a41, v146
v_mfma_f32_16x16x32_bf16 a[172:175], a[92:95], a[12:15], a[172:175]
ds_read_b64_tr_b16 a[82:83], v31 offset:8704
v_accvgpr_write_b32 a42, v148
v_accvgpr_write_b32 a43, v150
v_mfma_f32_16x16x32_bf16 a[204:207], a[88:91], a[16:19], a[204:207]
ds_read_b64_tr_b16 a[84:85], v31 offset:12288
v_mul_f32 v176, s44, v176
v_mul_f32 v177, s44, v177
v_mfma_f32_16x16x32_bf16 a[204:207], a[92:95], a[20:23], a[204:207]
ds_read_b64_tr_b16 a[86:87], v31 offset:12800
v_mul_f32 v178, s44, v178
v_mul_f32 v179, s44, v179
v_mfma_f32_16x16x32_bf16 a[236:239], a[88:91], a[24:27], a[236:239]
v_mul_f32 v180, s44, v180
v_mul_f32 v181, s44, v181
v_mfma_f32_16x16x32_bf16 a[236:239], a[92:95], a[28:31], a[236:239]
s_waitcnt lgkmcnt(8)
buffer_load_dwordx4 v97, s[12:15], s46 offen offset:1024 nt lds
v_mul_f32 v182, s44, v182
v_mul_f32 v183, s44, v183
v_mfma_f32_16x16x32_bf16 a[144:147], a[64:67], a[0:3], a[144:147]
v_cvt_pk_bf16_f32 v176, v176, v177
v_cvt_pk_bf16_f32 v178, v178, v179
v_mfma_f32_16x16x32_bf16 a[144:147], a[68:71], a[4:7], a[144:147]
ds_read_b64_tr_b16 a[88:89], v31 offset:8200
v_cvt_pk_bf16_f32 v180, v180, v181
v_cvt_pk_bf16_f32 v182, v182, v183
v_mfma_f32_16x16x32_bf16 a[176:179], a[64:67], a[8:11], a[176:179]
ds_read_b64_tr_b16 a[90:91], v31 offset:8712
v_accvgpr_write_b32 a56, v176
v_accvgpr_write_b32 a57, v178
v_mfma_f32_16x16x32_bf16 a[176:179], a[68:71], a[12:15], a[176:179]
ds_read_b64_tr_b16 a[92:93], v31 offset:12296
v_accvgpr_write_b32 a58, v180
v_accvgpr_write_b32 a59, v182
v_mfma_f32_16x16x32_bf16 a[208:211], a[64:67], a[16:19], a[208:211]
ds_read_b64_tr_b16 a[94:95], v31 offset:12808
s_mov_b32 s39, 0
v_mov_b32 v101, 138272
v_mov_b32 v80, 0
v_mul_f32 v208, s44, v208
v_mul_f32 v209, s44, v209
v_mfma_f32_16x16x32_bf16 a[208:211], a[68:71], a[20:23], a[208:211]
v_lshl_add_u32 v1, s32, 2, v101
v_mul_f32 v210, s44, v210
v_mul_f32 v211, s44, v211
v_mfma_f32_16x16x32_bf16 a[240:243], a[64:67], a[24:27], a[240:243]
v_mul_f32 v212, s44, v212
v_mul_f32 v213, s44, v213
v_mfma_f32_16x16x32_bf16 a[240:243], a[68:71], a[28:31], a[240:243]
s_waitcnt lgkmcnt(8)
ds_write_b32 v1, v80
v_mul_f32 v214, s44, v214
v_mul_f32 v215, s44, v215
v_mfma_f32_16x16x32_bf16 a[148:151], a[72:75], a[0:3], a[148:151]
v_cvt_pk_bf16_f32 v208, v208, v209
v_cvt_pk_bf16_f32 v210, v210, v211
v_mfma_f32_16x16x32_bf16 a[148:151], a[76:79], a[4:7], a[148:151]
v_cvt_pk_bf16_f32 v212, v212, v213
v_cvt_pk_bf16_f32 v214, v214, v215
v_mfma_f32_16x16x32_bf16 a[180:183], a[72:75], a[8:11], a[180:183]
v_accvgpr_write_b32 a104, v208
v_accvgpr_write_b32 a105, v210
v_mfma_f32_16x16x32_bf16 a[180:183], a[76:79], a[12:15], a[180:183]
s_waitcnt vmcnt(25) lgkmcnt(0)
v_accvgpr_write_b32 a106, v212
v_accvgpr_write_b32 a107, v214
v_mfma_f32_16x16x32_bf16 a[212:215], a[72:75], a[16:19], a[212:215]
s_barrier
v_mul_f32 v240, s44, v240
v_mul_f32 v241, s44, v241
v_mfma_f32_16x16x32_bf16 a[212:215], a[76:79], a[20:23], a[212:215]
v_mul_f32 v242, s44, v242
v_mul_f32 v243, s44, v243
v_mfma_f32_16x16x32_bf16 a[244:247], a[72:75], a[24:27], a[244:247]
s_add_u32 m0, s69, 114688
v_mul_f32 v244, s44, v244
v_mul_f32 v245, s44, v245
v_mfma_f32_16x16x32_bf16 a[244:247], a[76:79], a[28:31], a[244:247]
buffer_load_dwordx4 v98, s[16:19], s34 offen offset:0 nt lds
v_mul_f32 v246, s44, v246
v_mul_f32 v247, s44, v247
v_mfma_f32_16x16x32_bf16 a[152:155], a[80:83], a[0:3], a[152:155]
v_cvt_pk_bf16_f32 v240, v240, v241
v_cvt_pk_bf16_f32 v242, v242, v243
v_mfma_f32_16x16x32_bf16 a[152:155], a[84:87], a[4:7], a[152:155]
v_cvt_pk_bf16_f32 v244, v244, v245
v_cvt_pk_bf16_f32 v246, v246, v247
v_mfma_f32_16x16x32_bf16 a[184:187], a[80:83], a[8:11], a[184:187]
v_accvgpr_write_b32 a120, v240
v_accvgpr_write_b32 a121, v242
v_mfma_f32_16x16x32_bf16 a[184:187], a[84:87], a[12:15], a[184:187]
buffer_load_dwordx4 v99, s[16:19], s34 offen offset:1024 nt lds
v_accvgpr_write_b32 a122, v244
v_accvgpr_write_b32 a123, v246
v_mfma_f32_16x16x32_bf16 a[216:219], a[80:83], a[16:19], a[216:219]
v_mul_f32 v152, s44, v152
v_mul_f32 v153, s44, v153
v_mfma_f32_16x16x32_bf16 a[216:219], a[84:87], a[20:23], a[216:219]
v_mul_f32 v154, s44, v154
v_mul_f32 v155, s44, v155
v_mfma_f32_16x16x32_bf16 a[248:251], a[80:83], a[24:27], a[248:251]
s_add_u32 m0, s69, 122880
v_mul_f32 v156, s44, v156
v_mul_f32 v157, s44, v157
v_mfma_f32_16x16x32_bf16 a[248:251], a[84:87], a[28:31], a[248:251]
buffer_load_dwordx4 v98, s[16:19], s46 offen offset:0 nt lds
v_mul_f32 v158, s44, v158
v_mul_f32 v159, s44, v159
v_mfma_f32_16x16x32_bf16 a[156:159], a[88:91], a[0:3], a[156:159]
v_cvt_pk_bf16_f32 v152, v152, v153
v_cvt_pk_bf16_f32 v154, v154, v155
v_mfma_f32_16x16x32_bf16 a[156:159], a[92:95], a[4:7], a[156:159]
v_cvt_pk_bf16_f32 v156, v156, v157
v_cvt_pk_bf16_f32 v158, v158, v159
v_mfma_f32_16x16x32_bf16 a[188:191], a[88:91], a[8:11], a[188:191]
v_accvgpr_write_b32 a44, v152
v_accvgpr_write_b32 a45, v154
v_mfma_f32_16x16x32_bf16 a[188:191], a[92:95], a[12:15], a[188:191]
buffer_load_dwordx4 v99, s[16:19], s46 offen offset:1024 nt lds
v_accvgpr_write_b32 a46, v156
v_accvgpr_write_b32 a47, v158
v_mfma_f32_16x16x32_bf16 a[220:223], a[88:91], a[16:19], a[220:223]
s_add_u32 s34, s34, 16384
v_mul_f32 v184, s44, v184
v_mul_f32 v185, s44, v185
v_mfma_f32_16x16x32_bf16 a[220:223], a[92:95], a[20:23], a[220:223]
v_mul_f32 v186, s44, v186
v_mul_f32 v187, s44, v187
v_mfma_f32_16x16x32_bf16 a[252:255], a[88:91], a[24:27], a[252:255]
v_mul_f32 v188, s44, v188
v_mul_f32 v189, s44, v189
v_mfma_f32_16x16x32_bf16 a[252:255], a[92:95], a[28:31], a[252:255]
v_mul_f32 v190, s44, v190
v_mul_f32 v191, s44, v191
ds_read_b128 a[0:3], v84 offset:0
ds_read_b128 a[4:7], v85 offset:0
ds_read_b128 a[8:11], v86 offset:0
ds_read_b128 a[12:15], v87 offset:0
ds_read_b128 a[16:19], v84 offset:4096
ds_read_b128 a[20:23], v85 offset:4096
ds_read_b128 a[24:27], v86 offset:4096
ds_read_b128 a[28:31], v87 offset:4096
v_cvt_pk_bf16_f32 v184, v184, v185
v_cvt_pk_bf16_f32 v186, v186, v187
v_cvt_pk_bf16_f32 v188, v188, v189
v_cvt_pk_bf16_f32 v190, v190, v191
v_accvgpr_write_b32 a60, v184
v_accvgpr_write_b32 a61, v186
v_accvgpr_write_b32 a62, v188
v_accvgpr_write_b32 a63, v190
v_mul_f32 v216, s44, v216
v_mul_f32 v217, s44, v217
v_mul_f32 v218, s44, v218
v_mul_f32 v219, s44, v219
v_mul_f32 v220, s44, v220
v_mul_f32 v221, s44, v221
v_mul_f32 v222, s44, v222
v_mul_f32 v223, s44, v223
v_cvt_pk_bf16_f32 v216, v216, v217
v_cvt_pk_bf16_f32 v218, v218, v219
v_cvt_pk_bf16_f32 v220, v220, v221
v_cvt_pk_bf16_f32 v222, v222, v223
v_accvgpr_write_b32 a108, v216
v_accvgpr_write_b32 a109, v218
v_accvgpr_write_b32 a110, v220
v_accvgpr_write_b32 a111, v222
v_mul_f32 v248, s44, v248
v_mul_f32 v249, s44, v249
v_mul_f32 v250, s44, v250
v_mul_f32 v251, s44, v251
v_mul_f32 v252, s44, v252
v_mul_f32 v253, s44, v253
v_mul_f32 v254, s44, v254
v_mul_f32 v255, s44, v255
v_cvt_pk_bf16_f32 v248, v248, v249
v_cvt_pk_bf16_f32 v250, v250, v251
v_cvt_pk_bf16_f32 v252, v252, v253
v_cvt_pk_bf16_f32 v254, v254, v255
v_accvgpr_write_b32 a124, v248
v_accvgpr_write_b32 a125, v250
v_accvgpr_write_b32 a126, v252
v_accvgpr_write_b32 a127, v254
v_and_b32 v4, 3, v0
v_mov_b32 v5, 0x3f803f80
v_cmp_eq_u32 vcc, 0, v4
s_nop 1
v_cndmask_b32 v124, 0, v5, vcc
v_cndmask_b32 v125, 0, v5, vcc
v_cndmask_b32 v126, 0, v5, vcc
v_cndmask_b32 v127, 0, v5, vcc
s_waitcnt lgkmcnt(0)
v_mov_b32 v192, v32
v_mov_b32 v193, v33
v_mov_b32 v194, v34
v_mov_b32 v195, v35
v_mov_b32 v196, v36
v_mov_b32 v197, v37
v_mov_b32 v198, v38
v_mov_b32 v199, v39
v_mfma_f32_16x16x32_bf16 v[16:19], a[0:3], a[32:35], 0
v_mov_b32 v200, v40
v_mov_b32 v201, v41
v_mov_b32 v202, v42
v_mov_b32 v203, v43
v_mfma_f32_16x16x32_bf16 v[16:19], a[4:7], a[36:39], v[16:19]
v_mov_b32 v204, v44
v_mov_b32 v205, v45
v_mov_b32 v206, v46
v_mov_b32 v207, v47
v_mfma_f32_16x16x32_bf16 v[16:19], a[8:11], a[40:43], v[16:19]
v_mov_b32 v208, v48
v_mov_b32 v209, v49
v_mov_b32 v210, v50
v_mov_b32 v211, v51
v_mfma_f32_16x16x32_bf16 v[16:19], a[12:15], a[44:47], v[16:19]
v_mov_b32 v212, v52
v_mov_b32 v213, v53
v_mov_b32 v214, v54
v_mov_b32 v215, v55
v_mfma_f32_16x16x32_bf16 v[24:27], a[0:3], a[48:51], 0
v_mov_b32 v216, v56
v_mov_b32 v217, v57
v_mov_b32 v218, v58
v_mov_b32 v219, v59
v_mfma_f32_16x16x32_bf16 v[24:27], a[4:7], a[52:55], v[24:27]
v_mov_b32 v220, v60
v_mov_b32 v221, v61
v_mov_b32 v222, v62
v_mov_b32 v223, v63
v_mfma_f32_16x16x32_bf16 v[24:27], a[8:11], a[56:59], v[24:27]
v_mov_b32 v224, v64
v_mov_b32 v225, v65
v_mov_b32 v226, v66
v_mov_b32 v227, v67
v_mfma_f32_16x16x32_bf16 v[24:27], a[12:15], a[60:63], v[24:27]
v_mfma_f32_16x16x32_bf16 v[32:35], a[0:3], a[96:99], 0
v_mfma_f32_16x16x32_bf16 v[32:35], a[4:7], a[100:103], v[32:35]
v_mfma_f32_16x16x32_bf16 v[32:35], a[8:11], a[104:107], v[32:35]
v_mfma_f32_16x16x32_bf16 v[32:35], a[12:15], a[108:111], v[32:35]
v_mfma_f32_16x16x32_bf16 v[40:43], a[0:3], a[112:115], 0
v_mfma_f32_16x16x32_bf16 v[40:43], a[4:7], a[116:119], v[40:43]
v_mfma_f32_16x16x32_bf16 v[40:43], a[8:11], a[120:123], v[40:43]
v_mfma_f32_16x16x32_bf16 v[40:43], a[12:15], a[124:127], v[40:43]
v_max3_f32 v16, v16, v17, v18
v_max3_f32 v24, v24, v25, v26
s_nop 1
v_max3_f32 v32, v32, v33, v34
s_nop 2
v_max3_f32 v40, v40, v41, v42
v_max_f32 v16, v16, v19
v_max_f32 v24, v24, v27
v_max_f32 v32, v32, v35
v_max_f32 v40, v40, v43
v_mov_b32 v108, v16
v_mov_b32 v109, v24
v_mov_b32 v110, v32
v_mov_b32 v111, v40
v_permlane32_swap_b32 v16, v108
v_permlane32_swap_b32 v24, v109
v_permlane32_swap_b32 v32, v110
v_permlane32_swap_b32 v40, v111
v_max_f32 v16, v16, v108
v_max_f32 v24, v24, v109
v_max_f32 v32, v32, v110
v_max_f32 v40, v40, v111
v_mov_b32 v108, v16
v_mov_b32 v109, v24
v_mov_b32 v110, v32
v_mov_b32 v111, v40
v_permlane16_swap_b32 v16, v108
v_permlane16_swap_b32 v24, v109
v_permlane16_swap_b32 v32, v110
v_permlane16_swap_b32 v40, v111
v_max_f32 v16, v16, v108
v_max_f32 v24, v24, v109
v_max_f32 v32, v32, v110
v_max_f32 v40, v40, v111
v_sub_f32 v64, 0, v16
v_sub_f32 v65, 0, v16
v_sub_f32 v66, 0, v16
v_sub_f32 v67, 0, v16
v_sub_f32 v68, 0, v24
v_sub_f32 v69, 0, v24
v_sub_f32 v70, 0, v24
v_sub_f32 v71, 0, v24
v_sub_f32 v72, 0, v32
v_sub_f32 v73, 0, v32
v_sub_f32 v74, 0, v32
v_sub_f32 v75, 0, v32
v_sub_f32 v76, 0, v40
v_sub_f32 v77, 0, v40
v_sub_f32 v78, 0, v40
v_sub_f32 v79, 0, v40
s_cmp_lg_u32 s37, 0
s_cbranch_scc1 L_maxpass4
L_maxdone04:
v_mfma_f32_16x16x32_bf16 v[16:19], a[0:3], a[32:35], v[64:67]
v_accvgpr_read_b32 v4, a128
v_accvgpr_read_b32 v5, a129
v_accvgpr_read_b32 v6, a130
v_mfma_f32_16x16x32_bf16 v[16:19], a[4:7], a[36:39], v[16:19]
v_accvgpr_read_b32 v7, a131
v_mul_f32 v4, s44, v4
v_mfma_f32_16x16x32_bf16 v[16:19], a[8:11], a[40:43], v[16:19]
v_mul_f32 v5, s44, v5
v_mul_f32 v6, s44, v6
v_mul_f32 v7, s44, v7
v_mfma_f32_16x16x32_bf16 v[16:19], a[12:15], a[44:47], v[16:19]
v_cvt_pk_bf16_f32 v4, v4, v5
v_cvt_pk_bf16_f32 v6, v6, v7
v_mfma_f32_16x16x32_bf16 v[20:23], a[16:19], a[32:35], v[64:67]
v_accvgpr_write_b32 a128, v4
v_accvgpr_write_b32 a129, v6
v_mfma_f32_16x16x32_bf16 v[20:23], a[20:23], a[36:39], v[20:23]
v_accvgpr_read_b32 v4, a132
v_accvgpr_read_b32 v5, a133
v_accvgpr_read_b32 v6, a134
v_mfma_f32_16x16x32_bf16 v[20:23], a[24:27], a[40:43], v[20:23]
v_accvgpr_read_b32 v7, a135
v_mul_f32 v4, s44, v4
v_mfma_f32_16x16x32_bf16 v[20:23], a[28:31], a[44:47], v[20:23]
v_mul_f32 v5, s44, v5
v_mul_f32 v6, s44, v6
v_mul_f32 v7, s44, v7
v_mfma_f32_16x16x32_bf16 v[24:27], a[0:3], a[48:51], v[68:71]
v_cvt_pk_bf16_f32 v4, v4, v5
v_cvt_pk_bf16_f32 v6, v6, v7
v_mfma_f32_16x16x32_bf16 v[24:27], a[4:7], a[52:55], v[24:27]
v_exp_f32 v16, v16
v_mfma_f32_16x16x32_bf16 v[24:27], a[8:11], a[56:59], v[24:27]
v_exp_f32 v17, v17
v_accvgpr_write_b32 a130, v4
v_mfma_f32_16x16x32_bf16 v[24:27], a[12:15], a[60:63], v[24:27]
v_cvt_pk_bf16_f32 v48, v16, v17
v_accvgpr_write_b32 a131, v6
v_mfma_f32_16x16x32_bf16 v[28:31], a[16:19], a[48:51], v[68:71]
v_exp_f32 v18, v18
v_mfma_f32_16x16x32_bf16 v[28:31], a[20:23], a[52:55], v[28:31]
v_exp_f32 v19, v19
v_accvgpr_read_b32 v4, a136
v_mfma_f32_16x16x32_bf16 v[28:31], a[24:27], a[56:59], v[28:31]
v_exp_f32 v20, v20
v_mfma_f32_16x16x32_bf16 v[28:31], a[28:31], a[60:63], v[28:31]
v_exp_f32 v21, v21
v_accvgpr_read_b32 v5, a137
v_exp_f32 v22, v22
v_cvt_pk_bf16_f32 v49, v18, v19
v_exp_f32 v23, v23
v_exp_f32 v24, v24
v_exp_f32 v25, v25
v_exp_f32 v26, v26
v_exp_f32 v27, v27
v_cvt_pk_bf16_f32 v50, v20, v21
v_exp_f32 v28, v28
v_exp_f32 v29, v29
ds_read_b64_tr_b16 a[64:65], v88 offset:0
v_cvt_pk_bf16_f32 v51, v22, v23
ds_read_b64_tr_b16 a[66:67], v88 offset:4096
v_cvt_pk_bf16_f32 v52, v24, v25
ds_read_b64_tr_b16 a[68:69], v89 offset:0
v_cvt_pk_bf16_f32 v53, v26, v27
ds_read_b64_tr_b16 a[70:71], v89 offset:4096
v_cvt_pk_bf16_f32 v54, v28, v29
ds_read_b64_tr_b16 a[72:73], v90 offset:0
ds_read_b64_tr_b16 a[74:75], v90 offset:4096
ds_read_b64_tr_b16 a[76:77], v91 offset:0
ds_read_b64_tr_b16 a[78:79], v91 offset:4096
v_mfma_f32_16x16x32_bf16 v[32:35], a[0:3], a[96:99], v[72:75]
ds_read_b64_tr_b16 a[80:81], v92 offset:0
v_accvgpr_read_b32 v6, a138
v_mfma_f32_16x16x32_bf16 v[32:35], a[4:7], a[100:103], v[32:35]
ds_read_b64_tr_b16 a[82:83], v92 offset:4096
v_accvgpr_read_b32 v7, a139
v_mfma_f32_16x16x32_bf16 v[32:35], a[8:11], a[104:107], v[32:35]
ds_read_b64_tr_b16 a[84:85], v93 offset:0
v_mul_f32 v4, s44, v4
v_mul_f32 v5, s44, v5
v_mfma_f32_16x16x32_bf16 v[32:35], a[12:15], a[108:111], v[32:35]
ds_read_b64_tr_b16 a[86:87], v93 offset:4096
s_add_u32 s47, s33, 0
v_mul_f32 v6, s44, v6
v_mfma_f32_16x16x32_bf16 v[36:39], a[16:19], a[96:99], v[72:75]
ds_read_b64_tr_b16 a[88:89], v94 offset:0
buffer_store_dwordx4 v[192:195], v103, s[28:31], s47 offen offset:0 sc1
v_mfma_f32_16x16x32_bf16 v[36:39], a[20:23], a[100:103], v[36:39]
ds_read_b64_tr_b16 a[90:91], v94 offset:4096
v_mul_f32 v7, s44, v7
v_cvt_pk_bf16_f32 v4, v4, v5
v_mfma_f32_16x16x32_bf16 v[36:39], a[24:27], a[104:107], v[36:39]
ds_read_b64_tr_b16 a[92:93], v95 offset:0
v_cvt_pk_bf16_f32 v6, v6, v7
v_mfma_f32_16x16x32_bf16 v[36:39], a[28:31], a[108:111], v[36:39]
ds_read_b64_tr_b16 a[94:95], v95 offset:4096
v_accvgpr_write_b32 a132, v4
v_accvgpr_write_b32 a133, v6
v_mfma_f32_16x16x32_bf16 v[40:43], a[0:3], a[112:115], v[76:79]
v_exp_f32 v30, v30
v_mfma_f32_16x16x32_bf16 v[40:43], a[4:7], a[116:119], v[40:43]
s_add_u32 s47, s33, 0
v_exp_f32 v31, v31
v_mfma_f32_16x16x32_bf16 v[40:43], a[8:11], a[120:123], v[40:43]
buffer_store_dwordx4 v[196:199], v103, s[28:31], s47 offen offset:1024 sc1
v_exp_f32 v32, v32
v_accvgpr_read_b32 v4, a140
v_mfma_f32_16x16x32_bf16 v[40:43], a[12:15], a[124:127], v[40:43]
v_exp_f32 v33, v33
v_mfma_f32_16x16x32_bf16 v[44:47], a[16:19], a[112:115], v[76:79]
v_exp_f32 v34, v34
v_accvgpr_read_b32 v5, a141
v_mfma_f32_16x16x32_bf16 v[44:47], a[20:23], a[116:119], v[44:47]
v_exp_f32 v35, v35
v_mfma_f32_16x16x32_bf16 v[44:47], a[24:27], a[120:123], v[44:47]
v_exp_f32 v36, v36
v_mfma_f32_16x16x32_bf16 v[44:47], a[28:31], a[124:127], v[44:47]
s_waitcnt lgkmcnt(0)
s_add_u32 s47, s33, 0
v_exp_f32 v37, v37
v_accvgpr_read_b32 v6, a142
v_mfma_f32_16x16x32_bf16 v[128:131], a[64:67], v[48:51], 0
ds_read_b128 a[0:3], v84 offset:8192
buffer_store_dwordx4 v[200:203], v103, s[28:31], s47 offen offset:2048 sc1
v_cvt_pk_bf16_f32 v55, v30, v31
v_mfma_f32_16x16x32_bf16 v[132:135], a[68:71], v[48:51], 0
ds_read_b128 a[4:7], v85 offset:8192
v_cvt_pk_bf16_f32 v56, v32, v33
v_mfma_f32_16x16x32_bf16 v[136:139], a[72:75], v[48:51], 0
ds_read_b128 a[8:11], v86 offset:8192
v_cvt_pk_bf16_f32 v57, v34, v35
v_accvgpr_read_b32 v7, a143
v_mfma_f32_16x16x32_bf16 v[140:143], a[76:79], v[48:51], 0
ds_read_b128 a[12:15], v87 offset:8192
v_cvt_pk_bf16_f32 v58, v36, v37
v_mfma_f32_16x16x32_bf16 v[144:147], a[80:83], v[48:51], 0
ds_read_b128 a[16:19], v84 offset:12288
v_mul_f32 v4, s44, v4
v_mul_f32 v5, s44, v5
v_mfma_f32_16x16x32_bf16 v[148:151], a[84:87], v[48:51], 0
ds_read_b128 a[20:23], v85 offset:12288
s_add_u32 s47, s33, 0
v_mul_f32 v6, s44, v6
v_mfma_f32_16x16x32_bf16 v[152:155], a[88:91], v[48:51], 0
ds_read_b128 a[24:27], v86 offset:12288
buffer_store_dwordx4 v[204:207], v103, s[28:31], s47 offen offset:3072 sc1
v_mfma_f32_16x16x32_bf16 v[156:159], a[92:95], v[48:51], 0
ds_read_b128 a[28:31], v87 offset:12288
v_mul_f32 v7, s44, v7
v_cvt_pk_bf16_f32 v4, v4, v5
v_mfma_f32_16x16x32_bf16 v[108:111], v[124:127], v[48:51], 0
v_exp_f32 v38, v38
v_mfma_f32_16x16x32_bf16 v[160:163], a[64:67], v[52:55], 0
v_exp_f32 v39, v39
v_mfma_f32_16x16x32_bf16 v[164:167], a[68:71], v[52:55], 0
v_exp_f32 v40, v40
v_cvt_pk_bf16_f32 v6, v6, v7
v_mfma_f32_16x16x32_bf16 v[168:171], a[72:75], v[52:55], 0
s_add_u32 s47, s33, 16384
v_exp_f32 v41, v41
v_mfma_f32_16x16x32_bf16 v[172:175], a[76:79], v[52:55], 0
buffer_store_dwordx4 v[208:211], v103, s[28:31], s47 offen offset:0 sc1
v_exp_f32 v42, v42
v_accvgpr_write_b32 a134, v4
v_mfma_f32_16x16x32_bf16 v[176:179], a[80:83], v[52:55], 0
v_exp_f32 v43, v43
v_mfma_f32_16x16x32_bf16 v[180:183], a[84:87], v[52:55], 0
v_exp_f32 v44, v44
v_mfma_f32_16x16x32_bf16 v[184:187], a[88:91], v[52:55], 0
v_exp_f32 v45, v45
v_accvgpr_write_b32 a135, v6
v_mfma_f32_16x16x32_bf16 v[188:191], a[92:95], v[52:55], 0
v_exp_f32 v46, v46
v_mfma_f32_16x16x32_bf16 v[112:115], v[124:127], v[52:55], 0
s_waitcnt lgkmcnt(0)
v_exp_f32 v47, v47
v_mfma_f32_16x16x32_bf16 v[16:19], a[0:3], a[32:35], v[64:67]
v_cvt_pk_bf16_f32 v59, v38, v39
v_cvt_pk_bf16_f32 v60, v40, v41
v_accvgpr_read_b32 v4, a144
v_mfma_f32_16x16x32_bf16 v[16:19], a[4:7], a[36:39], v[16:19]
s_add_u32 s47, s33, 16384
v_cvt_pk_bf16_f32 v61, v42, v43
v_cvt_pk_bf16_f32 v62, v44, v45
v_mfma_f32_16x16x32_bf16 v[16:19], a[8:11], a[40:43], v[16:19]
buffer_store_dwordx4 v[212:215], v103, s[28:31], s47 offen offset:1024 sc1
v_cvt_pk_bf16_f32 v63, v46, v47
v_accvgpr_read_b32 v5, a145
v_mfma_f32_16x16x32_bf16 v[16:19], a[12:15], a[44:47], v[16:19]
v_accvgpr_read_b32 v6, a146
v_accvgpr_read_b32 v7, a147
v_mfma_f32_16x16x32_bf16 v[20:23], a[16:19], a[32:35], v[64:67]
v_mul_f32 v4, s44, v4
v_mul_f32 v5, s44, v5
v_mfma_f32_16x16x32_bf16 v[20:23], a[20:23], a[36:39], v[20:23]
s_add_u32 s39, s39, 1
s_add_u32 s47, s33, 16384
v_mul_f32 v6, s44, v6
v_mul_f32 v7, s44, v7
v_cvt_pk_bf16_f32 v4, v4, v5
v_mfma_f32_16x16x32_bf16 v[20:23], a[24:27], a[40:43], v[20:23]
buffer_store_dwordx4 v[216:219], v103, s[28:31], s47 offen offset:2048 sc1
v_mov_b32 v80, s39
v_mfma_f32_16x16x32_bf16 v[20:23], a[28:31], a[44:47], v[20:23]
v_cvt_pk_bf16_f32 v6, v6, v7
v_accvgpr_write_b32 a136, v4
v_mfma_f32_16x16x32_bf16 v[24:27], a[0:3], a[48:51], v[68:71]
s_waitcnt vmcnt(19)
ds_write_b32 v1, v80
v_accvgpr_write_b32 a137, v6
v_accvgpr_read_b32 v4, a148
v_mfma_f32_16x16x32_bf16 v[24:27], a[4:7], a[52:55], v[24:27]
s_add_u32 s47, s33, 16384
v_exp_f32 v16, v16
v_mfma_f32_16x16x32_bf16 v[24:27], a[8:11], a[56:59], v[24:27]
buffer_store_dwordx4 v[220:223], v103, s[28:31], s47 offen offset:3072 sc1
v_exp_f32 v17, v17
v_mfma_f32_16x16x32_bf16 v[24:27], a[12:15], a[60:63], v[24:27]
v_cvt_pk_bf16_f32 v48, v16, v17
v_accvgpr_read_b32 v5, a149
v_accvgpr_read_b32 v6, a150
v_mfma_f32_16x16x32_bf16 v[28:31], a[16:19], a[48:51], v[68:71]
v_exp_f32 v18, v18
v_mfma_f32_16x16x32_bf16 v[28:31], a[20:23], a[52:55], v[28:31]
v_exp_f32 v19, v19
v_mfma_f32_16x16x32_bf16 v[28:31], a[24:27], a[56:59], v[28:31]
s_lshl_b32 s47, s32, 10
v_exp_f32 v20, v20
v_accvgpr_read_b32 v7, a151
v_mfma_f32_16x16x32_bf16 v[28:31], a[28:31], a[60:63], v[28:31]
s_add_u32 s47, s47, 32768
v_exp_f32 v21, v21
v_mfma_f32_16x16x32_bf16 v[192:195], a[64:67], v[56:59], 0
buffer_store_dwordx4 v[224:227], v103, s[28:31], s47 offen offset:0 sc1
v_exp_f32 v22, v22
v_mfma_f32_16x16x32_bf16 v[196:199], a[68:71], v[56:59], 0
v_cvt_pk_bf16_f32 v49, v18, v19
v_mul_f32 v4, s44, v4
v_mul_f32 v5, s44, v5
v_mfma_f32_16x16x32_bf16 v[200:203], a[72:75], v[56:59], 0
v_exp_f32 v23, v23
v_mfma_f32_16x16x32_bf16 v[204:207], a[76:79], v[56:59], 0
v_exp_f32 v24, v24
v_mul_f32 v6, s44, v6
v_mfma_f32_16x16x32_bf16 v[208:211], a[80:83], v[56:59], 0
v_exp_f32 v25, v25
v_mfma_f32_16x16x32_bf16 v[212:215], a[84:87], v[56:59], 0
v_exp_f32 v26, v26
v_mfma_f32_16x16x32_bf16 v[216:219], a[88:91], v[56:59], 0
v_exp_f32 v27, v27
v_mul_f32 v7, s44, v7
v_mfma_f32_16x16x32_bf16 v[220:223], a[92:95], v[56:59], 0
v_cvt_pk_bf16_f32 v50, v20, v21
v_cvt_pk_bf16_f32 v4, v4, v5
v_mfma_f32_16x16x32_bf16 v[116:119], v[124:127], v[56:59], 0
v_exp_f32 v28, v28
v_mfma_f32_16x16x32_bf16 v[224:227], a[64:67], v[60:63], 0
v_exp_f32 v29, v29
v_cvt_pk_bf16_f32 v6, v6, v7
v_mfma_f32_16x16x32_bf16 v[228:231], a[68:71], v[60:63], 0
ds_read_b64_tr_b16 a[64:65], v88 offset:8192
v_cvt_pk_bf16_f32 v51, v22, v23
v_mfma_f32_16x16x32_bf16 v[232:235], a[72:75], v[60:63], 0
ds_read_b64_tr_b16 a[66:67], v88 offset:12288
v_cvt_pk_bf16_f32 v52, v24, v25
v_mfma_f32_16x16x32_bf16 v[236:239], a[76:79], v[60:63], 0
ds_read_b64_tr_b16 a[68:69], v89 offset:8192
v_cvt_pk_bf16_f32 v53, v26, v27
v_accvgpr_write_b32 a138, v4
v_mfma_f32_16x16x32_bf16 v[240:243], a[80:83], v[60:63], 0
ds_read_b64_tr_b16 a[70:71], v89 offset:12288
v_cvt_pk_bf16_f32 v54, v28, v29
v_mfma_f32_16x16x32_bf16 v[244:247], a[84:87], v[60:63], 0
ds_read_b64_tr_b16 a[72:73], v90 offset:8192
v_accvgpr_write_b32 a139, v6
v_mfma_f32_16x16x32_bf16 v[248:251], a[88:91], v[60:63], 0
ds_read_b64_tr_b16 a[74:75], v90 offset:12288
v_accvgpr_read_b32 v4, a152
v_accvgpr_read_b32 v5, a153
v_mfma_f32_16x16x32_bf16 v[252:255], a[92:95], v[60:63], 0
ds_read_b64_tr_b16 a[76:77], v91 offset:8192
v_accvgpr_read_b32 v6, a154
v_mfma_f32_16x16x32_bf16 v[120:123], v[124:127], v[60:63], 0
ds_read_b64_tr_b16 a[78:79], v91 offset:12288
v_accvgpr_read_b32 v7, a155
v_mfma_f32_16x16x32_bf16 v[32:35], a[0:3], a[96:99], v[72:75]
ds_read_b64_tr_b16 a[80:81], v92 offset:8192
v_mul_f32 v4, s44, v4
v_mul_f32 v5, s44, v5
v_mfma_f32_16x16x32_bf16 v[32:35], a[4:7], a[100:103], v[32:35]
ds_read_b64_tr_b16 a[82:83], v92 offset:12288
ds_read_b128 v[80:83], v101
v_mfma_f32_16x16x32_bf16 v[32:35], a[8:11], a[104:107], v[32:35]
ds_read_b64_tr_b16 a[84:85], v93 offset:8192
v_mul_f32 v6, s44, v6
v_mul_f32 v7, s44, v7
v_mfma_f32_16x16x32_bf16 v[32:35], a[12:15], a[108:111], v[32:35]
ds_read_b64_tr_b16 a[86:87], v93 offset:12288
v_cvt_pk_bf16_f32 v4, v4, v5
v_mfma_f32_16x16x32_bf16 v[36:39], a[16:19], a[96:99], v[72:75]
s_waitcnt lgkmcnt(2)
ds_read_b64_tr_b16 a[88:89], v94 offset:8192
v_min3_u32 v80, v80, v81, v82
v_mfma_f32_16x16x32_bf16 v[36:39], a[20:23], a[100:103], v[36:39]
ds_read_b64_tr_b16 a[90:91], v94 offset:12288
v_min_u32 v80, v80, v83
v_cvt_pk_bf16_f32 v6, v6, v7
v_mfma_f32_16x16x32_bf16 v[36:39], a[24:27], a[104:107], v[36:39]
ds_read_b64_tr_b16 a[92:93], v95 offset:8192
v_cmp_gt_u32 vcc, s39, v80
v_mfma_f32_16x16x32_bf16 v[36:39], a[28:31], a[108:111], v[36:39]
s_cbranch_vccnz L_fs1_4
L_fr1_4:
ds_read_b64_tr_b16 a[94:95], v95 offset:12288
v_accvgpr_write_b32 a140, v4
v_mfma_f32_16x16x32_bf16 v[40:43], a[0:3], a[112:115], v[76:79]
v_exp_f32 v30, v30
v_accvgpr_write_b32 a141, v6
v_mfma_f32_16x16x32_bf16 v[40:43], a[4:7], a[116:119], v[40:43]
v_exp_f32 v31, v31
v_mfma_f32_16x16x32_bf16 v[40:43], a[8:11], a[120:123], v[40:43]
v_exp_f32 v32, v32
v_mfma_f32_16x16x32_bf16 v[40:43], a[12:15], a[124:127], v[40:43]
v_exp_f32 v33, v33
v_accvgpr_read_b32 v4, a156
v_mfma_f32_16x16x32_bf16 v[44:47], a[16:19], a[112:115], v[76:79]
v_exp_f32 v34, v34
v_mfma_f32_16x16x32_bf16 v[44:47], a[20:23], a[116:119], v[44:47]
v_exp_f32 v35, v35
v_mfma_f32_16x16x32_bf16 v[44:47], a[24:27], a[120:123], v[44:47]
v_exp_f32 v36, v36
v_accvgpr_read_b32 v5, a157
v_mfma_f32_16x16x32_bf16 v[44:47], a[28:31], a[124:127], v[44:47]
s_waitcnt lgkmcnt(0)
v_exp_f32 v37, v37
v_mfma_f32_16x16x32_bf16 v[128:131], a[64:67], v[48:51], v[128:131]
ds_read_b128 a[0:3], v84 offset:16384
v_cvt_pk_bf16_f32 v55, v30, v31
v_mfma_f32_16x16x32_bf16 v[132:135], a[68:71], v[48:51], v[132:135]
ds_read_b128 a[4:7], v85 offset:16384
v_cvt_pk_bf16_f32 v56, v32, v33
v_accvgpr_read_b32 v6, a158
v_mfma_f32_16x16x32_bf16 v[136:139], a[72:75], v[48:51], v[136:139]
ds_read_b128 a[8:11], v86 offset:16384
v_cvt_pk_bf16_f32 v57, v34, v35
v_mfma_f32_16x16x32_bf16 v[140:143], a[76:79], v[48:51], v[140:143]
ds_read_b128 a[12:15], v87 offset:16384
v_cvt_pk_bf16_f32 v58, v36, v37
v_accvgpr_read_b32 v7, a159
v_mfma_f32_16x16x32_bf16 v[144:147], a[80:83], v[48:51], v[144:147]
ds_read_b128 a[16:19], v84 offset:20480
v_mul_f32 v4, s44, v4
v_mfma_f32_16x16x32_bf16 v[148:151], a[84:87], v[48:51], v[148:151]
ds_read_b128 a[20:23], v85 offset:20480
v_mul_f32 v5, s44, v5
v_mfma_f32_16x16x32_bf16 v[152:155], a[88:91], v[48:51], v[152:155]
ds_read_b128 a[24:27], v86 offset:20480
v_mul_f32 v6, s44, v6
v_mul_f32 v7, s44, v7
v_mfma_f32_16x16x32_bf16 v[156:159], a[92:95], v[48:51], v[156:159]
ds_read_b128 a[28:31], v87 offset:20480
v_cvt_pk_bf16_f32 v4, v4, v5
v_mfma_f32_16x16x32_bf16 v[108:111], v[124:127], v[48:51], v[108:111]
v_exp_f32 v38, v38
v_mfma_f32_16x16x32_bf16 v[160:163], a[64:67], v[52:55], v[160:163]
v_exp_f32 v39, v39
v_cvt_pk_bf16_f32 v6, v6, v7
v_mfma_f32_16x16x32_bf16 v[164:167], a[68:71], v[52:55], v[164:167]
v_exp_f32 v40, v40
v_mfma_f32_16x16x32_bf16 v[168:171], a[72:75], v[52:55], v[168:171]
v_exp_f32 v41, v41
v_mfma_f32_16x16x32_bf16 v[172:175], a[76:79], v[52:55], v[172:175]
v_exp_f32 v42, v42
v_accvgpr_write_b32 a142, v4
v_mfma_f32_16x16x32_bf16 v[176:179], a[80:83], v[52:55], v[176:179]
v_exp_f32 v43, v43
v_mfma_f32_16x16x32_bf16 v[180:183], a[84:87], v[52:55], v[180:183]
v_exp_f32 v44, v44
v_mfma_f32_16x16x32_bf16 v[184:187], a[88:91], v[52:55], v[184:187]
v_exp_f32 v45, v45
v_accvgpr_write_b32 a143, v6
v_mfma_f32_16x16x32_bf16 v[188:191], a[92:95], v[52:55], v[188:191]
v_exp_f32 v46, v46
v_mfma_f32_16x16x32_bf16 v[112:115], v[124:127], v[52:55], v[112:115]
s_waitcnt lgkmcnt(0)
v_exp_f32 v47, v47
v_mfma_f32_16x16x32_bf16 v[16:19], a[0:3], a[32:35], v[64:67]
v_cvt_pk_bf16_f32 v59, v38, v39
v_cvt_pk_bf16_f32 v60, v40, v41
v_accvgpr_read_b32 v4, a160
v_mfma_f32_16x16x32_bf16 v[16:19], a[4:7], a[36:39], v[16:19]
v_cvt_pk_bf16_f32 v61, v42, v43
v_cvt_pk_bf16_f32 v62, v44, v45
v_mfma_f32_16x16x32_bf16 v[16:19], a[8:11], a[40:43], v[16:19]
v_cvt_pk_bf16_f32 v63, v46, v47
v_accvgpr_read_b32 v5, a161
v_mfma_f32_16x16x32_bf16 v[16:19], a[12:15], a[44:47], v[16:19]
v_accvgpr_read_b32 v6, a162
v_accvgpr_read_b32 v7, a163
v_mfma_f32_16x16x32_bf16 v[20:23], a[16:19], a[32:35], v[64:67]
v_mul_f32 v4, s44, v4
v_mul_f32 v5, s44, v5
v_mul_f32 v6, s44, v6
v_mfma_f32_16x16x32_bf16 v[20:23], a[20:23], a[36:39], v[20:23]
v_mul_f32 v7, s44, v7
v_cvt_pk_bf16_f32 v4, v4, v5
v_mfma_f32_16x16x32_bf16 v[20:23], a[24:27], a[40:43], v[20:23]
v_cvt_pk_bf16_f32 v6, v6, v7
v_accvgpr_write_b32 a144, v4
v_mfma_f32_16x16x32_bf16 v[20:23], a[28:31], a[44:47], v[20:23]
v_accvgpr_write_b32 a145, v6
v_accvgpr_read_b32 v4, a164
v_mfma_f32_16x16x32_bf16 v[24:27], a[0:3], a[48:51], v[68:71]
v_accvgpr_read_b32 v5, a165
v_accvgpr_read_b32 v6, a166
v_accvgpr_read_b32 v7, a167
v_mfma_f32_16x16x32_bf16 v[24:27], a[4:7], a[52:55], v[24:27]
v_exp_f32 v16, v16
v_mfma_f32_16x16x32_bf16 v[24:27], a[8:11], a[56:59], v[24:27]
v_exp_f32 v17, v17
v_mfma_f32_16x16x32_bf16 v[24:27], a[12:15], a[60:63], v[24:27]
v_cvt_pk_bf16_f32 v48, v16, v17
v_mul_f32 v4, s44, v4
v_mfma_f32_16x16x32_bf16 v[28:31], a[16:19], a[48:51], v[68:71]
v_exp_f32 v18, v18
v_mul_f32 v5, s44, v5
v_mfma_f32_16x16x32_bf16 v[28:31], a[20:23], a[52:55], v[28:31]
v_exp_f32 v19, v19
v_mfma_f32_16x16x32_bf16 v[28:31], a[24:27], a[56:59], v[28:31]
v_exp_f32 v20, v20
v_mfma_f32_16x16x32_bf16 v[28:31], a[28:31], a[60:63], v[28:31]
v_exp_f32 v21, v21
v_mfma_f32_16x16x32_bf16 v[192:195], a[64:67], v[56:59], v[192:195]
v_exp_f32 v22, v22
v_mfma_f32_16x16x32_bf16 v[196:199], a[68:71], v[56:59], v[196:199]
v_cvt_pk_bf16_f32 v49, v18, v19
v_mul_f32 v6, s44, v6
v_mul_f32 v7, s44, v7
v_mfma_f32_16x16x32_bf16 v[200:203], a[72:75], v[56:59], v[200:203]
v_exp_f32 v23, v23
v_mfma_f32_16x16x32_bf16 v[204:207], a[76:79], v[56:59], v[204:207]
v_exp_f32 v24, v24
v_mfma_f32_16x16x32_bf16 v[208:211], a[80:83], v[56:59], v[208:211]
v_exp_f32 v25, v25
v_mfma_f32_16x16x32_bf16 v[212:215], a[84:87], v[56:59], v[212:215]
v_exp_f32 v26, v26
v_cvt_pk_bf16_f32 v4, v4, v5
v_mfma_f32_16x16x32_bf16 v[216:219], a[88:91], v[56:59], v[216:219]
v_exp_f32 v27, v27
v_mfma_f32_16x16x32_bf16 v[220:223], a[92:95], v[56:59], v[220:223]
v_cvt_pk_bf16_f32 v50, v20, v21
v_cvt_pk_bf16_f32 v6, v6, v7
v_mfma_f32_16x16x32_bf16 v[116:119], v[124:127], v[56:59], v[116:119]
v_exp_f32 v28, v28
v_mfma_f32_16x16x32_bf16 v[224:227], a[64:67], v[60:63], v[224:227]
v_exp_f32 v29, v29
v_accvgpr_write_b32 a146, v4
v_mfma_f32_16x16x32_bf16 v[228:231], a[68:71], v[60:63], v[228:231]
ds_read_b64_tr_b16 a[64:65], v88 offset:16384
v_cvt_pk_bf16_f32 v51, v22, v23
v_mfma_f32_16x16x32_bf16 v[232:235], a[72:75], v[60:63], v[232:235]
ds_read_b64_tr_b16 a[66:67], v88 offset:20480
v_cvt_pk_bf16_f32 v52, v24, v25
v_mfma_f32_16x16x32_bf16 v[236:239], a[76:79], v[60:63], v[236:239]
ds_read_b64_tr_b16 a[68:69], v89 offset:16384
v_cvt_pk_bf16_f32 v53, v26, v27
v_mfma_f32_16x16x32_bf16 v[240:243], a[80:83], v[60:63], v[240:243]
ds_read_b64_tr_b16 a[70:71], v89 offset:20480
v_cvt_pk_bf16_f32 v54, v28, v29
v_accvgpr_write_b32 a147, v6
v_mfma_f32_16x16x32_bf16 v[244:247], a[84:87], v[60:63], v[244:247]
ds_read_b64_tr_b16 a[72:73], v90 offset:16384
v_accvgpr_read_b32 v4, a168
v_mfma_f32_16x16x32_bf16 v[248:251], a[88:91], v[60:63], v[248:251]
ds_read_b64_tr_b16 a[74:75], v90 offset:20480
v_accvgpr_read_b32 v5, a169
v_mfma_f32_16x16x32_bf16 v[252:255], a[92:95], v[60:63], v[252:255]
ds_read_b64_tr_b16 a[76:77], v91 offset:16384
v_accvgpr_read_b32 v6, a170
v_mfma_f32_16x16x32_bf16 v[120:123], v[124:127], v[60:63], v[120:123]
ds_read_b64_tr_b16 a[78:79], v91 offset:20480
v_accvgpr_read_b32 v7, a171
v_mfma_f32_16x16x32_bf16 v[32:35], a[0:3], a[96:99], v[72:75]
ds_read_b64_tr_b16 a[80:81], v92 offset:16384
v_mul_f32 v4, s44, v4
v_mul_f32 v5, s44, v5
v_mfma_f32_16x16x32_bf16 v[32:35], a[4:7], a[100:103], v[32:35]
ds_read_b64_tr_b16 a[82:83], v92 offset:20480
v_mul_f32 v6, s44, v6
v_mfma_f32_16x16x32_bf16 v[32:35], a[8:11], a[104:107], v[32:35]
ds_read_b64_tr_b16 a[84:85], v93 offset:16384
v_mul_f32 v7, s44, v7
v_mfma_f32_16x16x32_bf16 v[32:35], a[12:15], a[108:111], v[32:35]
ds_read_b64_tr_b16 a[86:87], v93 offset:20480
v_cvt_pk_bf16_f32 v4, v4, v5
v_mfma_f32_16x16x32_bf16 v[36:39], a[16:19], a[96:99], v[72:75]
ds_read_b64_tr_b16 a[88:89], v94 offset:16384
v_cvt_pk_bf16_f32 v6, v6, v7
v_accvgpr_write_b32 a148, v4
v_mfma_f32_16x16x32_bf16 v[36:39], a[20:23], a[100:103], v[36:39]
ds_read_b64_tr_b16 a[90:91], v94 offset:20480
v_accvgpr_write_b32 a149, v6
v_mfma_f32_16x16x32_bf16 v[36:39], a[24:27], a[104:107], v[36:39]
ds_read_b64_tr_b16 a[92:93], v95 offset:16384
v_accvgpr_read_b32 v4, a172
v_mfma_f32_16x16x32_bf16 v[36:39], a[28:31], a[108:111], v[36:39]
ds_read_b64_tr_b16 a[94:95], v95 offset:20480
v_accvgpr_read_b32 v5, a173
v_mfma_f32_16x16x32_bf16 v[40:43], a[0:3], a[112:115], v[76:79]
v_exp_f32 v30, v30
v_accvgpr_read_b32 v6, a174
v_mfma_f32_16x16x32_bf16 v[40:43], a[4:7], a[116:119], v[40:43]
v_exp_f32 v31, v31
v_mfma_f32_16x16x32_bf16 v[40:43], a[8:11], a[120:123], v[40:43]
v_exp_f32 v32, v32
v_mfma_f32_16x16x32_bf16 v[40:43], a[12:15], a[124:127], v[40:43]
v_exp_f32 v33, v33
v_mfma_f32_16x16x32_bf16 v[44:47], a[16:19], a[112:115], v[76:79]
v_exp_f32 v34, v34
v_accvgpr_read_b32 v7, a175
v_mfma_f32_16x16x32_bf16 v[44:47], a[20:23], a[116:119], v[44:47]
v_exp_f32 v35, v35
v_mfma_f32_16x16x32_bf16 v[44:47], a[24:27], a[120:123], v[44:47]
v_exp_f32 v36, v36
v_mfma_f32_16x16x32_bf16 v[44:47], a[28:31], a[124:127], v[44:47]
s_waitcnt lgkmcnt(0)
v_exp_f32 v37, v37
v_mfma_f32_16x16x32_bf16 v[128:131], a[64:67], v[48:51], v[128:131]
ds_read_b128 a[0:3], v84 offset:24576
v_cvt_pk_bf16_f32 v55, v30, v31
v_mfma_f32_16x16x32_bf16 v[132:135], a[68:71], v[48:51], v[132:135]
ds_read_b128 a[4:7], v85 offset:24576
v_cvt_pk_bf16_f32 v56, v32, v33
v_mul_f32 v4, s44, v4
v_mfma_f32_16x16x32_bf16 v[136:139], a[72:75], v[48:51], v[136:139]
ds_read_b128 a[8:11], v86 offset:24576
v_cvt_pk_bf16_f32 v57, v34, v35
v_mfma_f32_16x16x32_bf16 v[140:143], a[76:79], v[48:51], v[140:143]
ds_read_b128 a[12:15], v87 offset:24576
v_cvt_pk_bf16_f32 v58, v36, v37
v_mfma_f32_16x16x32_bf16 v[144:147], a[80:83], v[48:51], v[144:147]
ds_read_b128 a[16:19], v84 offset:28672
v_mul_f32 v5, s44, v5
v_mfma_f32_16x16x32_bf16 v[148:151], a[84:87], v[48:51], v[148:151]
ds_read_b128 a[20:23], v85 offset:28672
v_mul_f32 v6, s44, v6
v_mul_f32 v7, s44, v7
v_mfma_f32_16x16x32_bf16 v[152:155], a[88:91], v[48:51], v[152:155]
ds_read_b128 a[24:27], v86 offset:28672
v_cvt_pk_bf16_f32 v4, v4, v5
v_mfma_f32_16x16x32_bf16 v[156:159], a[92:95], v[48:51], v[156:159]
ds_read_b128 a[28:31], v87 offset:28672
v_cvt_pk_bf16_f32 v6, v6, v7
v_mfma_f32_16x16x32_bf16 v[108:111], v[124:127], v[48:51], v[108:111]
v_exp_f32 v38, v38
v_mfma_f32_16x16x32_bf16 v[160:163], a[64:67], v[52:55], v[160:163]
v_exp_f32 v39, v39
v_accvgpr_write_b32 a150, v4
v_mfma_f32_16x16x32_bf16 v[164:167], a[68:71], v[52:55], v[164:167]
v_exp_f32 v40, v40
v_mfma_f32_16x16x32_bf16 v[168:171], a[72:75], v[52:55], v[168:171]
v_exp_f32 v41, v41
v_mfma_f32_16x16x32_bf16 v[172:175], a[76:79], v[52:55], v[172:175]
v_exp_f32 v42, v42
v_mfma_f32_16x16x32_bf16 v[176:179], a[80:83], v[52:55], v[176:179]
v_exp_f32 v43, v43
v_accvgpr_write_b32 a151, v6
v_mfma_f32_16x16x32_bf16 v[180:183], a[84:87], v[52:55], v[180:183]
v_exp_f32 v44, v44
v_mfma_f32_16x16x32_bf16 v[184:187], a[88:91], v[52:55], v[184:187]
v_exp_f32 v45, v45
v_mfma_f32_16x16x32_bf16 v[188:191], a[92:95], v[52:55], v[188:191]
v_exp_f32 v46, v46
v_mfma_f32_16x16x32_bf16 v[112:115], v[124:127], v[52:55], v[112:115]
s_waitcnt lgkmcnt(0)
v_exp_f32 v47, v47
v_mfma_f32_16x16x32_bf16 v[16:19], a[0:3], a[32:35], v[64:67]
v_cvt_pk_bf16_f32 v59, v38, v39
v_cvt_pk_bf16_f32 v60, v40, v41
v_accvgpr_read_b32 v4, a176
v_mfma_f32_16x16x32_bf16 v[16:19], a[4:7], a[36:39], v[16:19]
v_cvt_pk_bf16_f32 v61, v42, v43
v_cvt_pk_bf16_f32 v62, v44, v45
v_mfma_f32_16x16x32_bf16 v[16:19], a[8:11], a[40:43], v[16:19]
v_cvt_pk_bf16_f32 v63, v46, v47
v_accvgpr_read_b32 v5, a177
v_mfma_f32_16x16x32_bf16 v[16:19], a[12:15], a[44:47], v[16:19]
v_accvgpr_read_b32 v6, a178
v_accvgpr_read_b32 v7, a179
v_mul_f32 v4, s44, v4
v_mfma_f32_16x16x32_bf16 v[20:23], a[16:19], a[32:35], v[64:67]
v_mul_f32 v5, s44, v5
v_mul_f32 v6, s44, v6
v_mfma_f32_16x16x32_bf16 v[20:23], a[20:23], a[36:39], v[20:23]
s_add_u32 s39, s39, 1
v_mul_f32 v7, s44, v7
v_cvt_pk_bf16_f32 v4, v4, v5
v_mfma_f32_16x16x32_bf16 v[20:23], a[24:27], a[40:43], v[20:23]
v_mov_b32 v80, s39
v_cvt_pk_bf16_f32 v6, v6, v7
v_accvgpr_write_b32 a152, v4
v_mfma_f32_16x16x32_bf16 v[20:23], a[28:31], a[44:47], v[20:23]
v_accvgpr_write_b32 a153, v6
v_accvgpr_read_b32 v4, a180
v_mfma_f32_16x16x32_bf16 v[24:27], a[0:3], a[48:51], v[68:71]
s_waitcnt vmcnt(17)
ds_write_b32 v1, v80
v_accvgpr_read_b32 v5, a181
v_mfma_f32_16x16x32_bf16 v[24:27], a[4:7], a[52:55], v[24:27]
v_exp_f32 v16, v16
v_accvgpr_read_b32 v6, a182
v_mfma_f32_16x16x32_bf16 v[24:27], a[8:11], a[56:59], v[24:27]
v_exp_f32 v17, v17
v_mfma_f32_16x16x32_bf16 v[24:27], a[12:15], a[60:63], v[24:27]
v_cvt_pk_bf16_f32 v48, v16, v17
v_accvgpr_read_b32 v7, a183
v_mfma_f32_16x16x32_bf16 v[28:31], a[16:19], a[48:51], v[68:71]
v_exp_f32 v18, v18
v_mul_f32 v4, s44, v4
v_mfma_f32_16x16x32_bf16 v[28:31], a[20:23], a[52:55], v[28:31]
v_exp_f32 v19, v19
v_mfma_f32_16x16x32_bf16 v[28:31], a[24:27], a[56:59], v[28:31]
v_exp_f32 v20, v20
v_mfma_f32_16x16x32_bf16 v[28:31], a[28:31], a[60:63], v[28:31]
v_exp_f32 v21, v21
v_mul_f32 v5, s44, v5
v_mfma_f32_16x16x32_bf16 v[192:195], a[64:67], v[56:59], v[192:195]
v_exp_f32 v22, v22
v_mfma_f32_16x16x32_bf16 v[196:199], a[68:71], v[56:59], v[196:199]
v_cvt_pk_bf16_f32 v49, v18, v19
v_mul_f32 v6, s44, v6
v_mfma_f32_16x16x32_bf16 v[200:203], a[72:75], v[56:59], v[200:203]
v_exp_f32 v23, v23
v_mul_f32 v7, s44, v7
v_mfma_f32_16x16x32_bf16 v[204:207], a[76:79], v[56:59], v[204:207]
v_exp_f32 v24, v24
v_mfma_f32_16x16x32_bf16 v[208:211], a[80:83], v[56:59], v[208:211]
v_exp_f32 v25, v25
v_mfma_f32_16x16x32_bf16 v[212:215], a[84:87], v[56:59], v[212:215]
v_exp_f32 v26, v26
v_cvt_pk_bf16_f32 v4, v4, v5
v_mfma_f32_16x16x32_bf16 v[216:219], a[88:91], v[56:59], v[216:219]
v_exp_f32 v27, v27
v_mfma_f32_16x16x32_bf16 v[220:223], a[92:95], v[56:59], v[220:223]
v_cvt_pk_bf16_f32 v50, v20, v21
v_cvt_pk_bf16_f32 v6, v6, v7
v_mfma_f32_16x16x32_bf16 v[116:119], v[124:127], v[56:59], v[116:119]
v_exp_f32 v28, v28
v_accvgpr_write_b32 a154, v4
v_mfma_f32_16x16x32_bf16 v[224:227], a[64:67], v[60:63], v[224:227]
v_exp_f32 v29, v29
v_mfma_f32_16x16x32_bf16 v[228:231], a[68:71], v[60:63], v[228:231]
ds_read_b64_tr_b16 a[64:65], v88 offset:24576
v_cvt_pk_bf16_f32 v51, v22, v23
v_mfma_f32_16x16x32_bf16 v[232:235], a[72:75], v[60:63], v[232:235]
ds_read_b64_tr_b16 a[66:67], v88 offset:28672
v_cvt_pk_bf16_f32 v52, v24, v25
v_accvgpr_write_b32 a155, v6
v_mfma_f32_16x16x32_bf16 v[236:239], a[76:79], v[60:63], v[236:239]
ds_read_b64_tr_b16 a[68:69], v89 offset:24576
v_cvt_pk_bf16_f32 v53, v26, v27
v_mfma_f32_16x16x32_bf16 v[240:243], a[80:83], v[60:63], v[240:243]
ds_read_b64_tr_b16 a[70:71], v89 offset:28672
v_cvt_pk_bf16_f32 v54, v28, v29
v_mfma_f32_16x16x32_bf16 v[244:247], a[84:87], v[60:63], v[244:247]
ds_read_b64_tr_b16 a[72:73], v90 offset:24576
v_accvgpr_read_b32 v4, a184
v_accvgpr_read_b32 v5, a185
v_mfma_f32_16x16x32_bf16 v[248:251], a[88:91], v[60:63], v[248:251]
ds_read_b64_tr_b16 a[74:75], v90 offset:28672
v_accvgpr_read_b32 v6, a186
v_mfma_f32_16x16x32_bf16 v[252:255], a[92:95], v[60:63], v[252:255]
ds_read_b64_tr_b16 a[76:77], v91 offset:24576
v_accvgpr_read_b32 v7, a187
v_mfma_f32_16x16x32_bf16 v[120:123], v[124:127], v[60:63], v[120:123]
ds_read_b64_tr_b16 a[78:79], v91 offset:28672
v_mul_f32 v4, s44, v4
v_mfma_f32_16x16x32_bf16 v[32:35], a[0:3], a[96:99], v[72:75]
ds_read_b64_tr_b16 a[80:81], v92 offset:24576
v_mul_f32 v5, s44, v5
v_mul_f32 v6, s44, v6
v_mfma_f32_16x16x32_bf16 v[32:35], a[4:7], a[100:103], v[32:35]
ds_read_b64_tr_b16 a[82:83], v92 offset:28672
ds_read_b128 v[80:83], v101
v_mfma_f32_16x16x32_bf16 v[32:35], a[8:11], a[104:107], v[32:35]
ds_read_b64_tr_b16 a[84:85], v93 offset:24576
v_mul_f32 v7, s44, v7
v_mfma_f32_16x16x32_bf16 v[32:35], a[12:15], a[108:111], v[32:35]
ds_read_b64_tr_b16 a[86:87], v93 offset:28672
v_cvt_pk_bf16_f32 v4, v4, v5
v_cvt_pk_bf16_f32 v6, v6, v7
v_mfma_f32_16x16x32_bf16 v[36:39], a[16:19], a[96:99], v[72:75]
s_waitcnt lgkmcnt(2)
ds_read_b64_tr_b16 a[88:89], v94 offset:24576
v_min3_u32 v80, v80, v81, v82
v_mfma_f32_16x16x32_bf16 v[36:39], a[20:23], a[100:103], v[36:39]
ds_read_b64_tr_b16 a[90:91], v94 offset:28672
v_min_u32 v80, v80, v83
v_mfma_f32_16x16x32_bf16 v[36:39], a[24:27], a[104:107], v[36:39]
ds_read_b64_tr_b16 a[92:93], v95 offset:24576
v_cmp_gt_u32 vcc, s39, v80
v_accvgpr_write_b32 a156, v4
v_mfma_f32_16x16x32_bf16 v[36:39], a[28:31], a[108:111], v[36:39]
s_cbranch_vccnz L_fs3_4
L_fr3_4:
ds_read_b64_tr_b16 a[94:95], v95 offset:28672
v_accvgpr_write_b32 a157, v6
v_mfma_f32_16x16x32_bf16 v[40:43], a[0:3], a[112:115], v[76:79]
v_exp_f32 v30, v30
v_mfma_f32_16x16x32_bf16 v[40:43], a[4:7], a[116:119], v[40:43]
v_exp_f32 v31, v31
v_accvgpr_read_b32 v4, a188
v_mfma_f32_16x16x32_bf16 v[40:43], a[8:11], a[120:123], v[40:43]
v_exp_f32 v32, v32
v_mfma_f32_16x16x32_bf16 v[40:43], a[12:15], a[124:127], v[40:43]
v_exp_f32 v33, v33
v_mfma_f32_16x16x32_bf16 v[44:47], a[16:19], a[112:115], v[76:79]
v_exp_f32 v34, v34
v_accvgpr_read_b32 v5, a189
v_mfma_f32_16x16x32_bf16 v[44:47], a[20:23], a[116:119], v[44:47]
v_exp_f32 v35, v35
v_mfma_f32_16x16x32_bf16 v[44:47], a[24:27], a[120:123], v[44:47]
v_exp_f32 v36, v36
v_mfma_f32_16x16x32_bf16 v[44:47], a[28:31], a[124:127], v[44:47]
s_waitcnt lgkmcnt(0)
v_exp_f32 v37, v37
v_accvgpr_read_b32 v6, a190
v_mfma_f32_16x16x32_bf16 v[128:131], a[64:67], v[48:51], v[128:131]
ds_read_b128 a[0:3], v84 offset:32768
v_cvt_pk_bf16_f32 v55, v30, v31
v_mfma_f32_16x16x32_bf16 v[132:135], a[68:71], v[48:51], v[132:135]
ds_read_b128 a[4:7], v85 offset:32768
v_cvt_pk_bf16_f32 v56, v32, v33
v_mfma_f32_16x16x32_bf16 v[136:139], a[72:75], v[48:51], v[136:139]
ds_read_b128 a[8:11], v86 offset:32768
v_cvt_pk_bf16_f32 v57, v34, v35
v_accvgpr_read_b32 v7, a191
v_mfma_f32_16x16x32_bf16 v[140:143], a[76:79], v[48:51], v[140:143]
ds_read_b128 a[12:15], v87 offset:32768
v_cvt_pk_bf16_f32 v58, v36, v37
v_mfma_f32_16x16x32_bf16 v[144:147], a[80:83], v[48:51], v[144:147]
ds_read_b128 a[16:19], v84 offset:36864
v_mul_f32 v4, s44, v4
v_mfma_f32_16x16x32_bf16 v[148:151], a[84:87], v[48:51], v[148:151]
ds_read_b128 a[20:23], v85 offset:36864
v_mul_f32 v5, s44, v5
v_mul_f32 v6, s44, v6
v_mfma_f32_16x16x32_bf16 v[152:155], a[88:91], v[48:51], v[152:155]
ds_read_b128 a[24:27], v86 offset:36864
v_mul_f32 v7, s44, v7
v_mfma_f32_16x16x32_bf16 v[156:159], a[92:95], v[48:51], v[156:159]
ds_read_b128 a[28:31], v87 offset:36864
v_cvt_pk_bf16_f32 v4, v4, v5
v_mfma_f32_16x16x32_bf16 v[108:111], v[124:127], v[48:51], v[108:111]
v_exp_f32 v38, v38
v_cvt_pk_bf16_f32 v6, v6, v7
v_mfma_f32_16x16x32_bf16 v[160:163], a[64:67], v[52:55], v[160:163]
v_exp_f32 v39, v39
v_mfma_f32_16x16x32_bf16 v[164:167], a[68:71], v[52:55], v[164:167]
v_exp_f32 v40, v40
v_mfma_f32_16x16x32_bf16 v[168:171], a[72:75], v[52:55], v[168:171]
v_exp_f32 v41, v41
v_accvgpr_write_b32 a158, v4
v_mfma_f32_16x16x32_bf16 v[172:175], a[76:79], v[52:55], v[172:175]
v_exp_f32 v42, v42
v_mfma_f32_16x16x32_bf16 v[176:179], a[80:83], v[52:55], v[176:179]
v_exp_f32 v43, v43
v_mfma_f32_16x16x32_bf16 v[180:183], a[84:87], v[52:55], v[180:183]
v_exp_f32 v44, v44
v_accvgpr_write_b32 a159, v6
v_mfma_f32_16x16x32_bf16 v[184:187], a[88:91], v[52:55], v[184:187]
v_exp_f32 v45, v45
v_mfma_f32_16x16x32_bf16 v[188:191], a[92:95], v[52:55], v[188:191]
v_exp_f32 v46, v46
v_mfma_f32_16x16x32_bf16 v[112:115], v[124:127], v[52:55], v[112:115]
s_waitcnt lgkmcnt(0)
v_exp_f32 v47, v47
v_mfma_f32_16x16x32_bf16 v[16:19], a[0:3], a[32:35], v[64:67]
v_cvt_pk_bf16_f32 v59, v38, v39
v_cvt_pk_bf16_f32 v60, v40, v41
v_accvgpr_read_b32 v4, a192
v_mfma_f32_16x16x32_bf16 v[16:19], a[4:7], a[36:39], v[16:19]
v_cvt_pk_bf16_f32 v61, v42, v43
v_cvt_pk_bf16_f32 v62, v44, v45
v_mfma_f32_16x16x32_bf16 v[16:19], a[8:11], a[40:43], v[16:19]
v_cvt_pk_bf16_f32 v63, v46, v47
v_accvgpr_read_b32 v5, a193
v_mfma_f32_16x16x32_bf16 v[16:19], a[12:15], a[44:47], v[16:19]
v_accvgpr_read_b32 v6, a194
v_accvgpr_read_b32 v7, a195
v_mfma_f32_16x16x32_bf16 v[20:23], a[16:19], a[32:35], v[64:67]
v_mul_f32 v4, s44, v4
v_mul_f32 v5, s44, v5
v_mul_f32 v6, s44, v6
v_mfma_f32_16x16x32_bf16 v[20:23], a[20:23], a[36:39], v[20:23]
v_mul_f32 v7, s44, v7
v_cvt_pk_bf16_f32 v4, v4, v5
v_mfma_f32_16x16x32_bf16 v[20:23], a[24:27], a[40:43], v[20:23]
v_cvt_pk_bf16_f32 v6, v6, v7
v_accvgpr_write_b32 a160, v4
v_mfma_f32_16x16x32_bf16 v[20:23], a[28:31], a[44:47], v[20:23]
v_accvgpr_write_b32 a161, v6
v_accvgpr_read_b32 v4, a196
v_mfma_f32_16x16x32_bf16 v[24:27], a[0:3], a[48:51], v[68:71]
v_accvgpr_read_b32 v5, a197
v_accvgpr_read_b32 v6, a198
v_accvgpr_read_b32 v7, a199
v_mfma_f32_16x16x32_bf16 v[24:27], a[4:7], a[52:55], v[24:27]
v_exp_f32 v16, v16
v_mfma_f32_16x16x32_bf16 v[24:27], a[8:11], a[56:59], v[24:27]
v_exp_f32 v17, v17
v_mfma_f32_16x16x32_bf16 v[24:27], a[12:15], a[60:63], v[24:27]
v_cvt_pk_bf16_f32 v48, v16, v17
v_mul_f32 v4, s44, v4
v_mfma_f32_16x16x32_bf16 v[28:31], a[16:19], a[48:51], v[68:71]
v_exp_f32 v18, v18
v_mul_f32 v5, s44, v5
v_mfma_f32_16x16x32_bf16 v[28:31], a[20:23], a[52:55], v[28:31]
v_exp_f32 v19, v19
v_mfma_f32_16x16x32_bf16 v[28:31], a[24:27], a[56:59], v[28:31]
v_exp_f32 v20, v20
v_mfma_f32_16x16x32_bf16 v[28:31], a[28:31], a[60:63], v[28:31]
v_exp_f32 v21, v21
v_mfma_f32_16x16x32_bf16 v[192:195], a[64:67], v[56:59], v[192:195]
v_exp_f32 v22, v22
v_mfma_f32_16x16x32_bf16 v[196:199], a[68:71], v[56:59], v[196:199]
v_cvt_pk_bf16_f32 v49, v18, v19
v_mul_f32 v6, s44, v6
v_mul_f32 v7, s44, v7
v_mfma_f32_16x16x32_bf16 v[200:203], a[72:75], v[56:59], v[200:203]
v_exp_f32 v23, v23
v_mfma_f32_16x16x32_bf16 v[204:207], a[76:79], v[56:59], v[204:207]
v_exp_f32 v24, v24
v_mfma_f32_16x16x32_bf16 v[208:211], a[80:83], v[56:59], v[208:211]
v_exp_f32 v25, v25
v_mfma_f32_16x16x32_bf16 v[212:215], a[84:87], v[56:59], v[212:215]
v_exp_f32 v26, v26
v_cvt_pk_bf16_f32 v4, v4, v5
v_mfma_f32_16x16x32_bf16 v[216:219], a[88:91], v[56:59], v[216:219]
v_exp_f32 v27, v27
v_mfma_f32_16x16x32_bf16 v[220:223], a[92:95], v[56:59], v[220:223]
v_cvt_pk_bf16_f32 v50, v20, v21
v_cvt_pk_bf16_f32 v6, v6, v7
v_mfma_f32_16x16x32_bf16 v[116:119], v[124:127], v[56:59], v[116:119]
v_exp_f32 v28, v28
v_mfma_f32_16x16x32_bf16 v[224:227], a[64:67], v[60:63], v[224:227]
v_exp_f32 v29, v29
v_accvgpr_write_b32 a162, v4
v_mfma_f32_16x16x32_bf16 v[228:231], a[68:71], v[60:63], v[228:231]
ds_read_b64_tr_b16 a[64:65], v88 offset:32768
v_cvt_pk_bf16_f32 v51, v22, v23
v_mfma_f32_16x16x32_bf16 v[232:235], a[72:75], v[60:63], v[232:235]
ds_read_b64_tr_b16 a[66:67], v88 offset:36864
v_cvt_pk_bf16_f32 v52, v24, v25
v_mfma_f32_16x16x32_bf16 v[236:239], a[76:79], v[60:63], v[236:239]
ds_read_b64_tr_b16 a[68:69], v89 offset:32768
v_cvt_pk_bf16_f32 v53, v26, v27
v_mfma_f32_16x16x32_bf16 v[240:243], a[80:83], v[60:63], v[240:243]
ds_read_b64_tr_b16 a[70:71], v89 offset:36864
v_cvt_pk_bf16_f32 v54, v28, v29
v_accvgpr_write_b32 a163, v6
v_mfma_f32_16x16x32_bf16 v[244:247], a[84:87], v[60:63], v[244:247]
ds_read_b64_tr_b16 a[72:73], v90 offset:32768
v_accvgpr_read_b32 v4, a200
v_mfma_f32_16x16x32_bf16 v[248:251], a[88:91], v[60:63], v[248:251]
ds_read_b64_tr_b16 a[74:75], v90 offset:36864
v_accvgpr_read_b32 v5, a201
v_mfma_f32_16x16x32_bf16 v[252:255], a[92:95], v[60:63], v[252:255]
ds_read_b64_tr_b16 a[76:77], v91 offset:32768
v_accvgpr_read_b32 v6, a202
v_mfma_f32_16x16x32_bf16 v[120:123], v[124:127], v[60:63], v[120:123]
ds_read_b64_tr_b16 a[78:79], v91 offset:36864
v_accvgpr_read_b32 v7, a203
v_mfma_f32_16x16x32_bf16 v[32:35], a[0:3], a[96:99], v[72:75]
ds_read_b64_tr_b16 a[80:81], v92 offset:32768
v_mul_f32 v4, s44, v4
v_mul_f32 v5, s44, v5
v_mfma_f32_16x16x32_bf16 v[32:35], a[4:7], a[100:103], v[32:35]
ds_read_b64_tr_b16 a[82:83], v92 offset:36864
v_mul_f32 v6, s44, v6
v_mfma_f32_16x16x32_bf16 v[32:35], a[8:11], a[104:107], v[32:35]
ds_read_b64_tr_b16 a[84:85], v93 offset:32768
v_mul_f32 v7, s44, v7
v_mfma_f32_16x16x32_bf16 v[32:35], a[12:15], a[108:111], v[32:35]
ds_read_b64_tr_b16 a[86:87], v93 offset:36864
v_cvt_pk_bf16_f32 v4, v4, v5
v_mfma_f32_16x16x32_bf16 v[36:39], a[16:19], a[96:99], v[72:75]
ds_read_b64_tr_b16 a[88:89], v94 offset:32768
v_cvt_pk_bf16_f32 v6, v6, v7
v_accvgpr_write_b32 a164, v4
v_mfma_f32_16x16x32_bf16 v[36:39], a[20:23], a[100:103], v[36:39]
ds_read_b64_tr_b16 a[90:91], v94 offset:36864
v_accvgpr_write_b32 a165, v6
v_mfma_f32_16x16x32_bf16 v[36:39], a[24:27], a[104:107], v[36:39]
ds_read_b64_tr_b16 a[92:93], v95 offset:32768
v_accvgpr_read_b32 v4, a204
v_mfma_f32_16x16x32_bf16 v[36:39], a[28:31], a[108:111], v[36:39]
ds_read_b64_tr_b16 a[94:95], v95 offset:36864
v_accvgpr_read_b32 v5, a205
v_mfma_f32_16x16x32_bf16 v[40:43], a[0:3], a[112:115], v[76:79]
v_exp_f32 v30, v30
v_accvgpr_read_b32 v6, a206
v_mfma_f32_16x16x32_bf16 v[40:43], a[4:7], a[116:119], v[40:43]
v_exp_f32 v31, v31
v_mfma_f32_16x16x32_bf16 v[40:43], a[8:11], a[120:123], v[40:43]
v_exp_f32 v32, v32
v_mfma_f32_16x16x32_bf16 v[40:43], a[12:15], a[124:127], v[40:43]
v_exp_f32 v33, v33
v_mfma_f32_16x16x32_bf16 v[44:47], a[16:19], a[112:115], v[76:79]
v_exp_f32 v34, v34
v_accvgpr_read_b32 v7, a207
v_mfma_f32_16x16x32_bf16 v[44:47], a[20:23], a[116:119], v[44:47]
v_exp_f32 v35, v35
v_mfma_f32_16x16x32_bf16 v[44:47], a[24:27], a[120:123], v[44:47]
v_exp_f32 v36, v36
v_mfma_f32_16x16x32_bf16 v[44:47], a[28:31], a[124:127], v[44:47]
s_waitcnt lgkmcnt(0)
v_exp_f32 v37, v37
v_mfma_f32_16x16x32_bf16 v[128:131], a[64:67], v[48:51], v[128:131]
ds_read_b128 a[0:3], v84 offset:40960
v_cvt_pk_bf16_f32 v55, v30, v31
v_mfma_f32_16x16x32_bf16 v[132:135], a[68:71], v[48:51], v[132:135]
ds_read_b128 a[4:7], v85 offset:40960
v_cvt_pk_bf16_f32 v56, v32, v33
v_mul_f32 v4, s44, v4
v_mfma_f32_16x16x32_bf16 v[136:139], a[72:75], v[48:51], v[136:139]
ds_read_b128 a[8:11], v86 offset:40960
v_cvt_pk_bf16_f32 v57, v34, v35
v_mfma_f32_16x16x32_bf16 v[140:143], a[76:79], v[48:51], v[140:143]
ds_read_b128 a[12:15], v87 offset:40960
v_cvt_pk_bf16_f32 v58, v36, v37
v_mfma_f32_16x16x32_bf16 v[144:147], a[80:83], v[48:51], v[144:147]
ds_read_b128 a[16:19], v84 offset:45056
v_mul_f32 v5, s44, v5
v_mfma_f32_16x16x32_bf16 v[148:151], a[84:87], v[48:51], v[148:151]
ds_read_b128 a[20:23], v85 offset:45056
v_mul_f32 v6, s44, v6
v_mul_f32 v7, s44, v7
v_mfma_f32_16x16x32_bf16 v[152:155], a[88:91], v[48:51], v[152:155]
ds_read_b128 a[24:27], v86 offset:45056
v_cvt_pk_bf16_f32 v4, v4, v5
v_mfma_f32_16x16x32_bf16 v[156:159], a[92:95], v[48:51], v[156:159]
ds_read_b128 a[28:31], v87 offset:45056
v_cvt_pk_bf16_f32 v6, v6, v7
v_mfma_f32_16x16x32_bf16 v[108:111], v[124:127], v[48:51], v[108:111]
v_exp_f32 v38, v38
v_mfma_f32_16x16x32_bf16 v[160:163], a[64:67], v[52:55], v[160:163]
v_exp_f32 v39, v39
v_accvgpr_write_b32 a166, v4
v_mfma_f32_16x16x32_bf16 v[164:167], a[68:71], v[52:55], v[164:167]
v_exp_f32 v40, v40
v_mfma_f32_16x16x32_bf16 v[168:171], a[72:75], v[52:55], v[168:171]
v_exp_f32 v41, v41
v_mfma_f32_16x16x32_bf16 v[172:175], a[76:79], v[52:55], v[172:175]
v_exp_f32 v42, v42
v_mfma_f32_16x16x32_bf16 v[176:179], a[80:83], v[52:55], v[176:179]
v_exp_f32 v43, v43
v_accvgpr_write_b32 a167, v6
v_mfma_f32_16x16x32_bf16 v[180:183], a[84:87], v[52:55], v[180:183]
v_exp_f32 v44, v44
v_mfma_f32_16x16x32_bf16 v[184:187], a[88:91], v[52:55], v[184:187]
v_exp_f32 v45, v45
v_mfma_f32_16x16x32_bf16 v[188:191], a[92:95], v[52:55], v[188:191]
v_exp_f32 v46, v46
v_mfma_f32_16x16x32_bf16 v[112:115], v[124:127], v[52:55], v[112:115]
s_waitcnt lgkmcnt(0)
v_exp_f32 v47, v47
v_mfma_f32_16x16x32_bf16 v[16:19], a[0:3], a[32:35], v[64:67]
v_cvt_pk_bf16_f32 v59, v38, v39
v_cvt_pk_bf16_f32 v60, v40, v41
v_accvgpr_read_b32 v4, a208
v_mfma_f32_16x16x32_bf16 v[16:19], a[4:7], a[36:39], v[16:19]
v_cvt_pk_bf16_f32 v61, v42, v43
v_cvt_pk_bf16_f32 v62, v44, v45
v_mfma_f32_16x16x32_bf16 v[16:19], a[8:11], a[40:43], v[16:19]
v_cvt_pk_bf16_f32 v63, v46, v47
v_accvgpr_read_b32 v5, a209
v_mfma_f32_16x16x32_bf16 v[16:19], a[12:15], a[44:47], v[16:19]
v_accvgpr_read_b32 v6, a210
v_accvgpr_read_b32 v7, a211
v_mul_f32 v4, s44, v4
v_mfma_f32_16x16x32_bf16 v[20:23], a[16:19], a[32:35], v[64:67]
v_mul_f32 v5, s44, v5
v_mul_f32 v6, s44, v6
v_mfma_f32_16x16x32_bf16 v[20:23], a[20:23], a[36:39], v[20:23]
s_add_u32 s39, s39, 1
v_mul_f32 v7, s44, v7
v_cvt_pk_bf16_f32 v4, v4, v5
v_mfma_f32_16x16x32_bf16 v[20:23], a[24:27], a[40:43], v[20:23]
v_mov_b32 v80, s39
v_cvt_pk_bf16_f32 v6, v6, v7
v_accvgpr_write_b32 a168, v4
v_mfma_f32_16x16x32_bf16 v[20:23], a[28:31], a[44:47], v[20:23]
v_accvgpr_write_b32 a169, v6
v_accvgpr_read_b32 v4, a212
v_mfma_f32_16x16x32_bf16 v[24:27], a[0:3], a[48:51], v[68:71]
s_waitcnt vmcnt(9)
ds_write_b32 v1, v80
v_accvgpr_read_b32 v5, a213
v_mfma_f32_16x16x32_bf16 v[24:27], a[4:7], a[52:55], v[24:27]
v_exp_f32 v16, v16
v_accvgpr_read_b32 v6, a214
v_mfma_f32_16x16x32_bf16 v[24:27], a[8:11], a[56:59], v[24:27]
v_exp_f32 v17, v17
v_mfma_f32_16x16x32_bf16 v[24:27], a[12:15], a[60:63], v[24:27]
v_cvt_pk_bf16_f32 v48, v16, v17
v_accvgpr_read_b32 v7, a215
v_mfma_f32_16x16x32_bf16 v[28:31], a[16:19], a[48:51], v[68:71]
v_exp_f32 v18, v18
v_mul_f32 v4, s44, v4
v_mfma_f32_16x16x32_bf16 v[28:31], a[20:23], a[52:55], v[28:31]
v_exp_f32 v19, v19
v_mfma_f32_16x16x32_bf16 v[28:31], a[24:27], a[56:59], v[28:31]
v_exp_f32 v20, v20
v_mfma_f32_16x16x32_bf16 v[28:31], a[28:31], a[60:63], v[28:31]
v_exp_f32 v21, v21
v_mul_f32 v5, s44, v5
v_mfma_f32_16x16x32_bf16 v[192:195], a[64:67], v[56:59], v[192:195]
v_exp_f32 v22, v22
v_mfma_f32_16x16x32_bf16 v[196:199], a[68:71], v[56:59], v[196:199]
v_cvt_pk_bf16_f32 v49, v18, v19
v_mul_f32 v6, s44, v6
v_mfma_f32_16x16x32_bf16 v[200:203], a[72:75], v[56:59], v[200:203]
v_exp_f32 v23, v23
v_mul_f32 v7, s44, v7
v_mfma_f32_16x16x32_bf16 v[204:207], a[76:79], v[56:59], v[204:207]
v_exp_f32 v24, v24
v_mfma_f32_16x16x32_bf16 v[208:211], a[80:83], v[56:59], v[208:211]
v_exp_f32 v25, v25
v_mfma_f32_16x16x32_bf16 v[212:215], a[84:87], v[56:59], v[212:215]
v_exp_f32 v26, v26
v_cvt_pk_bf16_f32 v4, v4, v5
v_mfma_f32_16x16x32_bf16 v[216:219], a[88:91], v[56:59], v[216:219]
v_exp_f32 v27, v27
v_mfma_f32_16x16x32_bf16 v[220:223], a[92:95], v[56:59], v[220:223]
v_cvt_pk_bf16_f32 v50, v20, v21
v_cvt_pk_bf16_f32 v6, v6, v7
v_mfma_f32_16x16x32_bf16 v[116:119], v[124:127], v[56:59], v[116:119]
v_exp_f32 v28, v28
v_accvgpr_write_b32 a170, v4
v_mfma_f32_16x16x32_bf16 v[224:227], a[64:67], v[60:63], v[224:227]
v_exp_f32 v29, v29
v_mfma_f32_16x16x32_bf16 v[228:231], a[68:71], v[60:63], v[228:231]
ds_read_b64_tr_b16 a[64:65], v88 offset:40960
v_cvt_pk_bf16_f32 v51, v22, v23
v_mfma_f32_16x16x32_bf16 v[232:235], a[72:75], v[60:63], v[232:235]
ds_read_b64_tr_b16 a[66:67], v88 offset:45056
v_cvt_pk_bf16_f32 v52, v24, v25
v_accvgpr_write_b32 a171, v6
v_mfma_f32_16x16x32_bf16 v[236:239], a[76:79], v[60:63], v[236:239]
ds_read_b64_tr_b16 a[68:69], v89 offset:40960
v_cvt_pk_bf16_f32 v53, v26, v27
v_mfma_f32_16x16x32_bf16 v[240:243], a[80:83], v[60:63], v[240:243]
ds_read_b64_tr_b16 a[70:71], v89 offset:45056
v_cvt_pk_bf16_f32 v54, v28, v29
v_mfma_f32_16x16x32_bf16 v[244:247], a[84:87], v[60:63], v[244:247]
ds_read_b64_tr_b16 a[72:73], v90 offset:40960
v_accvgpr_read_b32 v4, a216
v_accvgpr_read_b32 v5, a217
v_mfma_f32_16x16x32_bf16 v[248:251], a[88:91], v[60:63], v[248:251]
ds_read_b64_tr_b16 a[74:75], v90 offset:45056
v_accvgpr_read_b32 v6, a218
v_mfma_f32_16x16x32_bf16 v[252:255], a[92:95], v[60:63], v[252:255]
ds_read_b64_tr_b16 a[76:77], v91 offset:40960
v_accvgpr_read_b32 v7, a219
v_mfma_f32_16x16x32_bf16 v[120:123], v[124:127], v[60:63], v[120:123]
ds_read_b64_tr_b16 a[78:79], v91 offset:45056
v_mul_f32 v4, s44, v4
v_mfma_f32_16x16x32_bf16 v[32:35], a[0:3], a[96:99], v[72:75]
ds_read_b64_tr_b16 a[80:81], v92 offset:40960
v_mul_f32 v5, s44, v5
v_mul_f32 v6, s44, v6
v_mfma_f32_16x16x32_bf16 v[32:35], a[4:7], a[100:103], v[32:35]
ds_read_b64_tr_b16 a[82:83], v92 offset:45056
ds_read_b128 v[80:83], v101
v_mfma_f32_16x16x32_bf16 v[32:35], a[8:11], a[104:107], v[32:35]
ds_read_b64_tr_b16 a[84:85], v93 offset:40960
v_mul_f32 v7, s44, v7
v_mfma_f32_16x16x32_bf16 v[32:35], a[12:15], a[108:111], v[32:35]
ds_read_b64_tr_b16 a[86:87], v93 offset:45056
v_cvt_pk_bf16_f32 v4, v4, v5
v_cvt_pk_bf16_f32 v6, v6, v7
v_mfma_f32_16x16x32_bf16 v[36:39], a[16:19], a[96:99], v[72:75]
s_waitcnt lgkmcnt(2)
ds_read_b64_tr_b16 a[88:89], v94 offset:40960
v_min3_u32 v80, v80, v81, v82
v_mfma_f32_16x16x32_bf16 v[36:39], a[20:23], a[100:103], v[36:39]
ds_read_b64_tr_b16 a[90:91], v94 offset:45056
v_min_u32 v80, v80, v83
v_mfma_f32_16x16x32_bf16 v[36:39], a[24:27], a[104:107], v[36:39]
ds_read_b64_tr_b16 a[92:93], v95 offset:40960
v_cmp_gt_u32 vcc, s39, v80
v_accvgpr_write_b32 a172, v4
v_mfma_f32_16x16x32_bf16 v[36:39], a[28:31], a[108:111], v[36:39]
s_cbranch_vccnz L_fs5_4
L_fr5_4:
ds_read_b64_tr_b16 a[94:95], v95 offset:45056
v_accvgpr_write_b32 a173, v6
v_mfma_f32_16x16x32_bf16 v[40:43], a[0:3], a[112:115], v[76:79]
v_exp_f32 v30, v30
v_mfma_f32_16x16x32_bf16 v[40:43], a[4:7], a[116:119], v[40:43]
v_exp_f32 v31, v31
v_accvgpr_read_b32 v4, a220
v_mfma_f32_16x16x32_bf16 v[40:43], a[8:11], a[120:123], v[40:43]
v_exp_f32 v32, v32
v_mfma_f32_16x16x32_bf16 v[40:43], a[12:15], a[124:127], v[40:43]
v_exp_f32 v33, v33
v_mfma_f32_16x16x32_bf16 v[44:47], a[16:19], a[112:115], v[76:79]
v_exp_f32 v34, v34
v_accvgpr_read_b32 v5, a221
v_mfma_f32_16x16x32_bf16 v[44:47], a[20:23], a[116:119], v[44:47]
v_exp_f32 v35, v35
v_mfma_f32_16x16x32_bf16 v[44:47], a[24:27], a[120:123], v[44:47]
v_exp_f32 v36, v36
v_mfma_f32_16x16x32_bf16 v[44:47], a[28:31], a[124:127], v[44:47]
s_waitcnt lgkmcnt(0)
v_exp_f32 v37, v37
v_accvgpr_read_b32 v6, a222
v_mfma_f32_16x16x32_bf16 v[128:131], a[64:67], v[48:51], v[128:131]
ds_read_b128 a[0:3], v84 offset:49152
v_cvt_pk_bf16_f32 v55, v30, v31
v_mfma_f32_16x16x32_bf16 v[132:135], a[68:71], v[48:51], v[132:135]
ds_read_b128 a[4:7], v85 offset:49152
v_cvt_pk_bf16_f32 v56, v32, v33
v_mfma_f32_16x16x32_bf16 v[136:139], a[72:75], v[48:51], v[136:139]
ds_read_b128 a[8:11], v86 offset:49152
v_cvt_pk_bf16_f32 v57, v34, v35
v_accvgpr_read_b32 v7, a223
v_mfma_f32_16x16x32_bf16 v[140:143], a[76:79], v[48:51], v[140:143]
ds_read_b128 a[12:15], v87 offset:49152
v_cvt_pk_bf16_f32 v58, v36, v37
v_mfma_f32_16x16x32_bf16 v[144:147], a[80:83], v[48:51], v[144:147]
ds_read_b128 a[16:19], v84 offset:53248
v_mul_f32 v4, s44, v4
v_mfma_f32_16x16x32_bf16 v[148:151], a[84:87], v[48:51], v[148:151]
ds_read_b128 a[20:23], v85 offset:53248
v_mul_f32 v5, s44, v5
v_mul_f32 v6, s44, v6
v_mfma_f32_16x16x32_bf16 v[152:155], a[88:91], v[48:51], v[152:155]
ds_read_b128 a[24:27], v86 offset:53248
v_mul_f32 v7, s44, v7
v_mfma_f32_16x16x32_bf16 v[156:159], a[92:95], v[48:51], v[156:159]
ds_read_b128 a[28:31], v87 offset:53248
v_cvt_pk_bf16_f32 v4, v4, v5
v_mfma_f32_16x16x32_bf16 v[108:111], v[124:127], v[48:51], v[108:111]
v_exp_f32 v38, v38
v_cvt_pk_bf16_f32 v6, v6, v7
v_mfma_f32_16x16x32_bf16 v[160:163], a[64:67], v[52:55], v[160:163]
v_exp_f32 v39, v39
v_mfma_f32_16x16x32_bf16 v[164:167], a[68:71], v[52:55], v[164:167]
v_exp_f32 v40, v40
v_mfma_f32_16x16x32_bf16 v[168:171], a[72:75], v[52:55], v[168:171]
v_exp_f32 v41, v41
v_accvgpr_write_b32 a174, v4
v_mfma_f32_16x16x32_bf16 v[172:175], a[76:79], v[52:55], v[172:175]
v_exp_f32 v42, v42
v_mfma_f32_16x16x32_bf16 v[176:179], a[80:83], v[52:55], v[176:179]
v_exp_f32 v43, v43
v_mfma_f32_16x16x32_bf16 v[180:183], a[84:87], v[52:55], v[180:183]
v_exp_f32 v44, v44
v_accvgpr_write_b32 a175, v6
v_mfma_f32_16x16x32_bf16 v[184:187], a[88:91], v[52:55], v[184:187]
v_exp_f32 v45, v45
v_mfma_f32_16x16x32_bf16 v[188:191], a[92:95], v[52:55], v[188:191]
v_exp_f32 v46, v46
v_mfma_f32_16x16x32_bf16 v[112:115], v[124:127], v[52:55], v[112:115]
s_waitcnt lgkmcnt(0)
v_exp_f32 v47, v47
v_mfma_f32_16x16x32_bf16 v[16:19], a[0:3], a[32:35], v[64:67]
v_cvt_pk_bf16_f32 v59, v38, v39
v_cvt_pk_bf16_f32 v60, v40, v41
v_accvgpr_read_b32 v4, a224
v_mfma_f32_16x16x32_bf16 v[16:19], a[4:7], a[36:39], v[16:19]
v_cvt_pk_bf16_f32 v61, v42, v43
v_cvt_pk_bf16_f32 v62, v44, v45
v_mfma_f32_16x16x32_bf16 v[16:19], a[8:11], a[40:43], v[16:19]
v_cvt_pk_bf16_f32 v63, v46, v47
v_accvgpr_read_b32 v5, a225
v_mfma_f32_16x16x32_bf16 v[16:19], a[12:15], a[44:47], v[16:19]
v_accvgpr_read_b32 v6, a226
v_accvgpr_read_b32 v7, a227
v_mfma_f32_16x16x32_bf16 v[20:23], a[16:19], a[32:35], v[64:67]
v_mul_f32 v4, s44, v4
v_mul_f32 v5, s44, v5
v_mul_f32 v6, s44, v6
v_mfma_f32_16x16x32_bf16 v[20:23], a[20:23], a[36:39], v[20:23]
v_mul_f32 v7, s44, v7
v_cvt_pk_bf16_f32 v4, v4, v5
v_mfma_f32_16x16x32_bf16 v[20:23], a[24:27], a[40:43], v[20:23]
v_cvt_pk_bf16_f32 v6, v6, v7
v_accvgpr_write_b32 a176, v4
v_mfma_f32_16x16x32_bf16 v[20:23], a[28:31], a[44:47], v[20:23]
v_accvgpr_write_b32 a177, v6
v_accvgpr_read_b32 v4, a228
v_mfma_f32_16x16x32_bf16 v[24:27], a[0:3], a[48:51], v[68:71]
v_accvgpr_read_b32 v5, a229
v_accvgpr_read_b32 v6, a230
v_accvgpr_read_b32 v7, a231
v_mfma_f32_16x16x32_bf16 v[24:27], a[4:7], a[52:55], v[24:27]
v_exp_f32 v16, v16
v_mfma_f32_16x16x32_bf16 v[24:27], a[8:11], a[56:59], v[24:27]
v_exp_f32 v17, v17
v_mfma_f32_16x16x32_bf16 v[24:27], a[12:15], a[60:63], v[24:27]
v_cvt_pk_bf16_f32 v48, v16, v17
v_mul_f32 v4, s44, v4
v_mfma_f32_16x16x32_bf16 v[28:31], a[16:19], a[48:51], v[68:71]
v_exp_f32 v18, v18
v_mul_f32 v5, s44, v5
v_mfma_f32_16x16x32_bf16 v[28:31], a[20:23], a[52:55], v[28:31]
v_exp_f32 v19, v19
v_mfma_f32_16x16x32_bf16 v[28:31], a[24:27], a[56:59], v[28:31]
v_exp_f32 v20, v20
v_mfma_f32_16x16x32_bf16 v[28:31], a[28:31], a[60:63], v[28:31]
v_exp_f32 v21, v21
v_mfma_f32_16x16x32_bf16 v[192:195], a[64:67], v[56:59], v[192:195]
v_exp_f32 v22, v22
v_mfma_f32_16x16x32_bf16 v[196:199], a[68:71], v[56:59], v[196:199]
v_cvt_pk_bf16_f32 v49, v18, v19
v_mul_f32 v6, s44, v6
v_mul_f32 v7, s44, v7
v_mfma_f32_16x16x32_bf16 v[200:203], a[72:75], v[56:59], v[200:203]
v_exp_f32 v23, v23
v_mfma_f32_16x16x32_bf16 v[204:207], a[76:79], v[56:59], v[204:207]
v_exp_f32 v24, v24
v_mfma_f32_16x16x32_bf16 v[208:211], a[80:83], v[56:59], v[208:211]
v_exp_f32 v25, v25
v_mfma_f32_16x16x32_bf16 v[212:215], a[84:87], v[56:59], v[212:215]
v_exp_f32 v26, v26
v_cvt_pk_bf16_f32 v4, v4, v5
v_mfma_f32_16x16x32_bf16 v[216:219], a[88:91], v[56:59], v[216:219]
v_exp_f32 v27, v27
v_mfma_f32_16x16x32_bf16 v[220:223], a[92:95], v[56:59], v[220:223]
v_cvt_pk_bf16_f32 v50, v20, v21
v_cvt_pk_bf16_f32 v6, v6, v7
v_mfma_f32_16x16x32_bf16 v[116:119], v[124:127], v[56:59], v[116:119]
v_exp_f32 v28, v28
v_mfma_f32_16x16x32_bf16 v[224:227], a[64:67], v[60:63], v[224:227]
v_exp_f32 v29, v29
v_accvgpr_write_b32 a178, v4
v_mfma_f32_16x16x32_bf16 v[228:231], a[68:71], v[60:63], v[228:231]
ds_read_b64_tr_b16 a[64:65], v88 offset:49152
v_cvt_pk_bf16_f32 v51, v22, v23
v_mfma_f32_16x16x32_bf16 v[232:235], a[72:75], v[60:63], v[232:235]
ds_read_b64_tr_b16 a[66:67], v88 offset:53248
v_cvt_pk_bf16_f32 v52, v24, v25
v_mfma_f32_16x16x32_bf16 v[236:239], a[76:79], v[60:63], v[236:239]
ds_read_b64_tr_b16 a[68:69], v89 offset:49152
v_cvt_pk_bf16_f32 v53, v26, v27
v_mfma_f32_16x16x32_bf16 v[240:243], a[80:83], v[60:63], v[240:243]
ds_read_b64_tr_b16 a[70:71], v89 offset:53248
v_cvt_pk_bf16_f32 v54, v28, v29
v_accvgpr_write_b32 a179, v6
v_mfma_f32_16x16x32_bf16 v[244:247], a[84:87], v[60:63], v[244:247]
ds_read_b64_tr_b16 a[72:73], v90 offset:49152
v_accvgpr_read_b32 v4, a232
v_mfma_f32_16x16x32_bf16 v[248:251], a[88:91], v[60:63], v[248:251]
ds_read_b64_tr_b16 a[74:75], v90 offset:53248
v_accvgpr_read_b32 v5, a233
v_mfma_f32_16x16x32_bf16 v[252:255], a[92:95], v[60:63], v[252:255]
ds_read_b64_tr_b16 a[76:77], v91 offset:49152
v_accvgpr_read_b32 v6, a234
v_mfma_f32_16x16x32_bf16 v[120:123], v[124:127], v[60:63], v[120:123]
ds_read_b64_tr_b16 a[78:79], v91 offset:53248
v_accvgpr_read_b32 v7, a235
v_mfma_f32_16x16x32_bf16 v[32:35], a[0:3], a[96:99], v[72:75]
ds_read_b64_tr_b16 a[80:81], v92 offset:49152
v_mul_f32 v4, s44, v4
v_mul_f32 v5, s44, v5
v_mfma_f32_16x16x32_bf16 v[32:35], a[4:7], a[100:103], v[32:35]
ds_read_b64_tr_b16 a[82:83], v92 offset:53248
v_mul_f32 v6, s44, v6
v_mfma_f32_16x16x32_bf16 v[32:35], a[8:11], a[104:107], v[32:35]
ds_read_b64_tr_b16 a[84:85], v93 offset:49152
v_mul_f32 v7, s44, v7
v_mfma_f32_16x16x32_bf16 v[32:35], a[12:15], a[108:111], v[32:35]
ds_read_b64_tr_b16 a[86:87], v93 offset:53248
v_cvt_pk_bf16_f32 v4, v4, v5
v_mfma_f32_16x16x32_bf16 v[36:39], a[16:19], a[96:99], v[72:75]
ds_read_b64_tr_b16 a[88:89], v94 offset:49152
v_cvt_pk_bf16_f32 v6, v6, v7
v_accvgpr_write_b32 a180, v4
v_mfma_f32_16x16x32_bf16 v[36:39], a[20:23], a[100:103], v[36:39]
ds_read_b64_tr_b16 a[90:91], v94 offset:53248
v_accvgpr_write_b32 a181, v6
v_mfma_f32_16x16x32_bf16 v[36:39], a[24:27], a[104:107], v[36:39]
ds_read_b64_tr_b16 a[92:93], v95 offset:49152
v_accvgpr_read_b32 v4, a236
v_mfma_f32_16x16x32_bf16 v[36:39], a[28:31], a[108:111], v[36:39]
ds_read_b64_tr_b16 a[94:95], v95 offset:53248
v_accvgpr_read_b32 v5, a237
v_mfma_f32_16x16x32_bf16 v[40:43], a[0:3], a[112:115], v[76:79]
v_exp_f32 v30, v30
v_accvgpr_read_b32 v6, a238
v_mfma_f32_16x16x32_bf16 v[40:43], a[4:7], a[116:119], v[40:43]
v_exp_f32 v31, v31
v_mfma_f32_16x16x32_bf16 v[40:43], a[8:11], a[120:123], v[40:43]
v_exp_f32 v32, v32
v_mfma_f32_16x16x32_bf16 v[40:43], a[12:15], a[124:127], v[40:43]
v_exp_f32 v33, v33
v_mfma_f32_16x16x32_bf16 v[44:47], a[16:19], a[112:115], v[76:79]
v_exp_f32 v34, v34
v_accvgpr_read_b32 v7, a239
v_mfma_f32_16x16x32_bf16 v[44:47], a[20:23], a[116:119], v[44:47]
v_exp_f32 v35, v35
v_mfma_f32_16x16x32_bf16 v[44:47], a[24:27], a[120:123], v[44:47]
v_exp_f32 v36, v36
v_mfma_f32_16x16x32_bf16 v[44:47], a[28:31], a[124:127], v[44:47]
s_waitcnt lgkmcnt(0)
v_exp_f32 v37, v37
v_mfma_f32_16x16x32_bf16 v[128:131], a[64:67], v[48:51], v[128:131]
ds_read_b128 a[0:3], v84 offset:57344
v_cvt_pk_bf16_f32 v55, v30, v31
v_mfma_f32_16x16x32_bf16 v[132:135], a[68:71], v[48:51], v[132:135]
ds_read_b128 a[4:7], v85 offset:57344
v_cvt_pk_bf16_f32 v56, v32, v33
v_mul_f32 v4, s44, v4
v_mfma_f32_16x16x32_bf16 v[136:139], a[72:75], v[48:51], v[136:139]
ds_read_b128 a[8:11], v86 offset:57344
v_cvt_pk_bf16_f32 v57, v34, v35
v_mfma_f32_16x16x32_bf16 v[140:143], a[76:79], v[48:51], v[140:143]
ds_read_b128 a[12:15], v87 offset:57344
v_cvt_pk_bf16_f32 v58, v36, v37
v_mfma_f32_16x16x32_bf16 v[144:147], a[80:83], v[48:51], v[144:147]
ds_read_b128 a[16:19], v84 offset:61440
v_mul_f32 v5, s44, v5
v_mfma_f32_16x16x32_bf16 v[148:151], a[84:87], v[48:51], v[148:151]
ds_read_b128 a[20:23], v85 offset:61440
v_mul_f32 v6, s44, v6
v_mul_f32 v7, s44, v7
v_mfma_f32_16x16x32_bf16 v[152:155], a[88:91], v[48:51], v[152:155]
ds_read_b128 a[24:27], v86 offset:61440
v_cvt_pk_bf16_f32 v4, v4, v5
v_mfma_f32_16x16x32_bf16 v[156:159], a[92:95], v[48:51], v[156:159]
ds_read_b128 a[28:31], v87 offset:61440
v_cvt_pk_bf16_f32 v6, v6, v7
v_mfma_f32_16x16x32_bf16 v[108:111], v[124:127], v[48:51], v[108:111]
v_exp_f32 v38, v38
v_mfma_f32_16x16x32_bf16 v[160:163], a[64:67], v[52:55], v[160:163]
v_exp_f32 v39, v39
v_accvgpr_write_b32 a182, v4
v_mfma_f32_16x16x32_bf16 v[164:167], a[68:71], v[52:55], v[164:167]
v_exp_f32 v40, v40
v_mfma_f32_16x16x32_bf16 v[168:171], a[72:75], v[52:55], v[168:171]
v_exp_f32 v41, v41
v_mfma_f32_16x16x32_bf16 v[172:175], a[76:79], v[52:55], v[172:175]
v_exp_f32 v42, v42
v_mfma_f32_16x16x32_bf16 v[176:179], a[80:83], v[52:55], v[176:179]
v_exp_f32 v43, v43
v_accvgpr_write_b32 a183, v6
v_mfma_f32_16x16x32_bf16 v[180:183], a[84:87], v[52:55], v[180:183]
v_exp_f32 v44, v44
v_mfma_f32_16x16x32_bf16 v[184:187], a[88:91], v[52:55], v[184:187]
v_exp_f32 v45, v45
v_mfma_f32_16x16x32_bf16 v[188:191], a[92:95], v[52:55], v[188:191]
v_exp_f32 v46, v46
v_mfma_f32_16x16x32_bf16 v[112:115], v[124:127], v[52:55], v[112:115]
s_waitcnt lgkmcnt(0)
v_exp_f32 v47, v47
v_mfma_f32_16x16x32_bf16 v[16:19], a[0:3], a[32:35], v[64:67]
v_cvt_pk_bf16_f32 v59, v38, v39
v_cvt_pk_bf16_f32 v60, v40, v41
v_accvgpr_read_b32 v4, a240
v_mfma_f32_16x16x32_bf16 v[16:19], a[4:7], a[36:39], v[16:19]
v_cvt_pk_bf16_f32 v61, v42, v43
v_cvt_pk_bf16_f32 v62, v44, v45
v_mfma_f32_16x16x32_bf16 v[16:19], a[8:11], a[40:43], v[16:19]
v_cvt_pk_bf16_f32 v63, v46, v47
v_accvgpr_read_b32 v5, a241
v_mfma_f32_16x16x32_bf16 v[16:19], a[12:15], a[44:47], v[16:19]
v_accvgpr_read_b32 v6, a242
v_accvgpr_read_b32 v7, a243
v_mul_f32 v4, s44, v4
v_mfma_f32_16x16x32_bf16 v[20:23], a[16:19], a[32:35], v[64:67]
v_mul_f32 v5, s44, v5
v_mul_f32 v6, s44, v6
v_mfma_f32_16x16x32_bf16 v[20:23], a[20:23], a[36:39], v[20:23]
s_add_u32 s39, s39, 1
v_mul_f32 v7, s44, v7
v_cvt_pk_bf16_f32 v4, v4, v5
v_mfma_f32_16x16x32_bf16 v[20:23], a[24:27], a[40:43], v[20:23]
v_mov_b32 v80, s39
v_cvt_pk_bf16_f32 v6, v6, v7
v_accvgpr_write_b32 a184, v4
v_mfma_f32_16x16x32_bf16 v[20:23], a[28:31], a[44:47], v[20:23]
v_accvgpr_write_b32 a185, v6
v_accvgpr_read_b32 v4, a244
v_mfma_f32_16x16x32_bf16 v[24:27], a[0:3], a[48:51], v[68:71]
s_waitcnt vmcnt(63)
ds_write_b32 v1, v80
v_accvgpr_read_b32 v5, a245
v_mfma_f32_16x16x32_bf16 v[24:27], a[4:7], a[52:55], v[24:27]
v_exp_f32 v16, v16
v_accvgpr_read_b32 v6, a246
v_mfma_f32_16x16x32_bf16 v[24:27], a[8:11], a[56:59], v[24:27]
v_exp_f32 v17, v17
v_mfma_f32_16x16x32_bf16 v[24:27], a[12:15], a[60:63], v[24:27]
v_cvt_pk_bf16_f32 v48, v16, v17
v_accvgpr_read_b32 v7, a247
v_mfma_f32_16x16x32_bf16 v[28:31], a[16:19], a[48:51], v[68:71]
v_exp_f32 v18, v18
v_mul_f32 v4, s44, v4
v_mfma_f32_16x16x32_bf16 v[28:31], a[20:23], a[52:55], v[28:31]
v_exp_f32 v19, v19
v_mfma_f32_16x16x32_bf16 v[28:31], a[24:27], a[56:59], v[28:31]
v_exp_f32 v20, v20
v_mfma_f32_16x16x32_bf16 v[28:31], a[28:31], a[60:63], v[28:31]
v_exp_f32 v21, v21
v_mul_f32 v5, s44, v5
v_mfma_f32_16x16x32_bf16 v[192:195], a[64:67], v[56:59], v[192:195]
v_exp_f32 v22, v22
v_mfma_f32_16x16x32_bf16 v[196:199], a[68:71], v[56:59], v[196:199]
v_cvt_pk_bf16_f32 v49, v18, v19
v_mul_f32 v6, s44, v6
v_mfma_f32_16x16x32_bf16 v[200:203], a[72:75], v[56:59], v[200:203]
v_exp_f32 v23, v23
v_mul_f32 v7, s44, v7
v_mfma_f32_16x16x32_bf16 v[204:207], a[76:79], v[56:59], v[204:207]
v_exp_f32 v24, v24
v_mfma_f32_16x16x32_bf16 v[208:211], a[80:83], v[56:59], v[208:211]
v_exp_f32 v25, v25
v_mfma_f32_16x16x32_bf16 v[212:215], a[84:87], v[56:59], v[212:215]
v_exp_f32 v26, v26
v_cvt_pk_bf16_f32 v4, v4, v5
v_mfma_f32_16x16x32_bf16 v[216:219], a[88:91], v[56:59], v[216:219]
v_exp_f32 v27, v27
v_mfma_f32_16x16x32_bf16 v[220:223], a[92:95], v[56:59], v[220:223]
v_cvt_pk_bf16_f32 v50, v20, v21
v_cvt_pk_bf16_f32 v6, v6, v7
v_mfma_f32_16x16x32_bf16 v[116:119], v[124:127], v[56:59], v[116:119]
v_exp_f32 v28, v28
v_accvgpr_write_b32 a186, v4
v_mfma_f32_16x16x32_bf16 v[224:227], a[64:67], v[60:63], v[224:227]
v_exp_f32 v29, v29
v_mfma_f32_16x16x32_bf16 v[228:231], a[68:71], v[60:63], v[228:231]
ds_read_b64_tr_b16 a[64:65], v88 offset:57344
v_cvt_pk_bf16_f32 v51, v22, v23
v_mfma_f32_16x16x32_bf16 v[232:235], a[72:75], v[60:63], v[232:235]
ds_read_b64_tr_b16 a[66:67], v88 offset:61440
v_cvt_pk_bf16_f32 v52, v24, v25
v_accvgpr_write_b32 a187, v6
v_mfma_f32_16x16x32_bf16 v[236:239], a[76:79], v[60:63], v[236:239]
ds_read_b64_tr_b16 a[68:69], v89 offset:57344
v_cvt_pk_bf16_f32 v53, v26, v27
v_mfma_f32_16x16x32_bf16 v[240:243], a[80:83], v[60:63], v[240:243]
ds_read_b64_tr_b16 a[70:71], v89 offset:61440
v_cvt_pk_bf16_f32 v54, v28, v29
v_mfma_f32_16x16x32_bf16 v[244:247], a[84:87], v[60:63], v[244:247]
ds_read_b64_tr_b16 a[72:73], v90 offset:57344
v_accvgpr_read_b32 v4, a248
v_accvgpr_read_b32 v5, a249
v_mfma_f32_16x16x32_bf16 v[248:251], a[88:91], v[60:63], v[248:251]
ds_read_b64_tr_b16 a[74:75], v90 offset:61440
v_accvgpr_read_b32 v6, a250
v_mfma_f32_16x16x32_bf16 v[252:255], a[92:95], v[60:63], v[252:255]
ds_read_b64_tr_b16 a[76:77], v91 offset:57344
v_accvgpr_read_b32 v7, a251
v_mfma_f32_16x16x32_bf16 v[120:123], v[124:127], v[60:63], v[120:123]
ds_read_b64_tr_b16 a[78:79], v91 offset:61440
v_mul_f32 v4, s44, v4
v_mfma_f32_16x16x32_bf16 v[32:35], a[0:3], a[96:99], v[72:75]
ds_read_b64_tr_b16 a[80:81], v92 offset:57344
v_mul_f32 v5, s44, v5
v_mul_f32 v6, s44, v6
v_mfma_f32_16x16x32_bf16 v[32:35], a[4:7], a[100:103], v[32:35]
ds_read_b64_tr_b16 a[82:83], v92 offset:61440
ds_read_b128 v[80:83], v101
v_mfma_f32_16x16x32_bf16 v[32:35], a[8:11], a[104:107], v[32:35]
ds_read_b64_tr_b16 a[84:85], v93 offset:57344
v_mul_f32 v7, s44, v7
v_mfma_f32_16x16x32_bf16 v[32:35], a[12:15], a[108:111], v[32:35]
ds_read_b64_tr_b16 a[86:87], v93 offset:61440
v_cvt_pk_bf16_f32 v4, v4, v5
v_cvt_pk_bf16_f32 v6, v6, v7
v_mfma_f32_16x16x32_bf16 v[36:39], a[16:19], a[96:99], v[72:75]
s_waitcnt lgkmcnt(2)
ds_read_b64_tr_b16 a[88:89], v94 offset:57344
v_min3_u32 v80, v80, v81, v82
v_mfma_f32_16x16x32_bf16 v[36:39], a[20:23], a[100:103], v[36:39]
ds_read_b64_tr_b16 a[90:91], v94 offset:61440
v_min_u32 v80, v80, v83
v_mfma_f32_16x16x32_bf16 v[36:39], a[24:27], a[104:107], v[36:39]
ds_read_b64_tr_b16 a[92:93], v95 offset:57344
v_cmp_gt_u32 vcc, s39, v80
v_accvgpr_write_b32 a188, v4
v_mfma_f32_16x16x32_bf16 v[36:39], a[28:31], a[108:111], v[36:39]
s_cbranch_vccnz L_fs7_4
L_fr7_4:
ds_read_b64_tr_b16 a[94:95], v95 offset:61440
v_accvgpr_write_b32 a189, v6
v_mfma_f32_16x16x32_bf16 v[40:43], a[0:3], a[112:115], v[76:79]
v_exp_f32 v30, v30
v_mfma_f32_16x16x32_bf16 v[40:43], a[4:7], a[116:119], v[40:43]
v_exp_f32 v31, v31
v_accvgpr_read_b32 v4, a252
v_mfma_f32_16x16x32_bf16 v[40:43], a[8:11], a[120:123], v[40:43]
v_exp_f32 v32, v32
v_mfma_f32_16x16x32_bf16 v[40:43], a[12:15], a[124:127], v[40:43]
v_exp_f32 v33, v33
v_mfma_f32_16x16x32_bf16 v[44:47], a[16:19], a[112:115], v[76:79]
v_exp_f32 v34, v34
v_accvgpr_read_b32 v5, a253
v_mfma_f32_16x16x32_bf16 v[44:47], a[20:23], a[116:119], v[44:47]
v_exp_f32 v35, v35
v_mfma_f32_16x16x32_bf16 v[44:47], a[24:27], a[120:123], v[44:47]
v_exp_f32 v36, v36
v_mfma_f32_16x16x32_bf16 v[44:47], a[28:31], a[124:127], v[44:47]
s_waitcnt lgkmcnt(0)
v_exp_f32 v37, v37
v_accvgpr_read_b32 v6, a254
v_mfma_f32_16x16x32_bf16 v[128:131], a[64:67], v[48:51], v[128:131]
ds_read_b128 a[0:3], v84 offset:0
v_cvt_pk_bf16_f32 v55, v30, v31
v_mfma_f32_16x16x32_bf16 v[132:135], a[68:71], v[48:51], v[132:135]
ds_read_b128 a[4:7], v85 offset:0
v_cvt_pk_bf16_f32 v56, v32, v33
v_mfma_f32_16x16x32_bf16 v[136:139], a[72:75], v[48:51], v[136:139]
ds_read_b128 a[8:11], v86 offset:0
v_cvt_pk_bf16_f32 v57, v34, v35
v_accvgpr_read_b32 v7, a255
v_mfma_f32_16x16x32_bf16 v[140:143], a[76:79], v[48:51], v[140:143]
ds_read_b128 a[12:15], v87 offset:0
v_cvt_pk_bf16_f32 v58, v36, v37
v_mfma_f32_16x16x32_bf16 v[144:147], a[80:83], v[48:51], v[144:147]
ds_read_b128 a[16:19], v84 offset:4096
v_mul_f32 v4, s44, v4
v_mfma_f32_16x16x32_bf16 v[148:151], a[84:87], v[48:51], v[148:151]
ds_read_b128 a[20:23], v85 offset:4096
v_mul_f32 v5, s44, v5
v_mul_f32 v6, s44, v6
v_mfma_f32_16x16x32_bf16 v[152:155], a[88:91], v[48:51], v[152:155]
ds_read_b128 a[24:27], v86 offset:4096
v_mul_f32 v7, s44, v7
v_mfma_f32_16x16x32_bf16 v[156:159], a[92:95], v[48:51], v[156:159]
ds_read_b128 a[28:31], v87 offset:4096
v_cvt_pk_bf16_f32 v4, v4, v5
v_mfma_f32_16x16x32_bf16 v[108:111], v[124:127], v[48:51], v[108:111]
v_exp_f32 v38, v38
v_cvt_pk_bf16_f32 v6, v6, v7
v_mfma_f32_16x16x32_bf16 v[160:163], a[64:67], v[52:55], v[160:163]
v_exp_f32 v39, v39
v_mfma_f32_16x16x32_bf16 v[164:167], a[68:71], v[52:55], v[164:167]
v_exp_f32 v40, v40
v_mfma_f32_16x16x32_bf16 v[168:171], a[72:75], v[52:55], v[168:171]
v_exp_f32 v41, v41
v_accvgpr_write_b32 a190, v4
v_mfma_f32_16x16x32_bf16 v[172:175], a[76:79], v[52:55], v[172:175]
v_exp_f32 v42, v42
v_mfma_f32_16x16x32_bf16 v[176:179], a[80:83], v[52:55], v[176:179]
v_exp_f32 v43, v43
v_mfma_f32_16x16x32_bf16 v[180:183], a[84:87], v[52:55], v[180:183]
v_exp_f32 v44, v44
v_accvgpr_write_b32 a191, v6
v_mfma_f32_16x16x32_bf16 v[184:187], a[88:91], v[52:55], v[184:187]
v_exp_f32 v45, v45
v_mfma_f32_16x16x32_bf16 v[188:191], a[92:95], v[52:55], v[188:191]
v_exp_f32 v46, v46
v_mfma_f32_16x16x32_bf16 v[112:115], v[124:127], v[52:55], v[112:115]
s_waitcnt lgkmcnt(0)
v_exp_f32 v47, v47
L_atin4:
s_mov_b32 s35, 0
.p2align 3
L_at4:
v_mfma_f32_16x16x32_bf16 v[16:19], a[0:3], a[32:35], v[64:67]
v_cvt_pk_bf16_f32 v59, v38, v39
v_cvt_pk_bf16_f32 v60, v40, v41
v_mfma_f32_16x16x32_bf16 v[16:19], a[4:7], a[36:39], v[16:19]
v_cvt_pk_bf16_f32 v61, v42, v43
v_cvt_pk_bf16_f32 v62, v44, v45
v_mfma_f32_16x16x32_bf16 v[16:19], a[8:11], a[40:43], v[16:19]
v_cvt_pk_bf16_f32 v63, v46, v47
v_mfma_f32_16x16x32_bf16 v[16:19], a[12:15], a[44:47], v[16:19]
v_mfma_f32_16x16x32_bf16 v[20:23], a[16:19], a[32:35], v[64:67]
v_mfma_f32_16x16x32_bf16 v[20:23], a[20:23], a[36:39], v[20:23]
v_mfma_f32_16x16x32_bf16 v[20:23], a[24:27], a[40:43], v[20:23]
v_mfma_f32_16x16x32_bf16 v[20:23], a[28:31], a[44:47], v[20:23]
v_mfma_f32_16x16x32_bf16 v[24:27], a[0:3], a[48:51], v[68:71]
v_mfma_f32_16x16x32_bf16 v[24:27], a[4:7], a[52:55], v[24:27]
s_nop 1
v_exp_f32 v16, v16
v_mfma_f32_16x16x32_bf16 v[24:27], a[8:11], a[56:59], v[24:27]
v_exp_f32 v17, v17
v_mfma_f32_16x16x32_bf16 v[24:27], a[12:15], a[60:63], v[24:27]
v_cvt_pk_bf16_f32 v48, v16, v17
v_mfma_f32_16x16x32_bf16 v[28:31], a[16:19], a[48:51], v[68:71]
v_exp_f32 v18, v18
v_mfma_f32_16x16x32_bf16 v[28:31], a[20:23], a[52:55], v[28:31]
v_exp_f32 v19, v19
v_mfma_f32_16x16x32_bf16 v[28:31], a[24:27], a[56:59], v[28:31]
v_exp_f32 v20, v20
v_mfma_f32_16x16x32_bf16 v[28:31], a[28:31], a[60:63], v[28:31]
v_exp_f32 v21, v21
v_mfma_f32_16x16x32_bf16 v[192:195], a[64:67], v[56:59], v[192:195]
v_exp_f32 v22, v22
v_mfma_f32_16x16x32_bf16 v[196:199], a[68:71], v[56:59], v[196:199]
v_cvt_pk_bf16_f32 v49, v18, v19
v_mfma_f32_16x16x32_bf16 v[200:203], a[72:75], v[56:59], v[200:203]
v_exp_f32 v23, v23
v_mfma_f32_16x16x32_bf16 v[204:207], a[76:79], v[56:59], v[204:207]
v_exp_f32 v24, v24
v_mfma_f32_16x16x32_bf16 v[208:211], a[80:83], v[56:59], v[208:211]
v_exp_f32 v25, v25
v_mfma_f32_16x16x32_bf16 v[212:215], a[84:87], v[56:59], v[212:215]
v_exp_f32 v26, v26
v_mfma_f32_16x16x32_bf16 v[216:219], a[88:91], v[56:59], v[216:219]
v_exp_f32 v27, v27
v_mfma_f32_16x16x32_bf16 v[220:223], a[92:95], v[56:59], v[220:223]
v_cvt_pk_bf16_f32 v50, v20, v21
v_mfma_f32_16x16x32_bf16 v[116:119], v[124:127], v[56:59], v[116:119]
v_exp_f32 v28, v28
v_mfma_f32_16x16x32_bf16 v[224:227], a[64:67], v[60:63], v[224:227]
v_exp_f32 v29, v29
v_mfma_f32_16x16x32_bf16 v[228:231], a[68:71], v[60:63], v[228:231]
ds_read_b64_tr_b16 a[64:65], v88 offset:0
v_cvt_pk_bf16_f32 v51, v22, v23
v_mfma_f32_16x16x32_bf16 v[232:235], a[72:75], v[60:63], v[232:235]
ds_read_b64_tr_b16 a[66:67], v88 offset:4096
v_cvt_pk_bf16_f32 v52, v24, v25
v_mfma_f32_16x16x32_bf16 v[236:239], a[76:79], v[60:63], v[236:239]
ds_read_b64_tr_b16 a[68:69], v89 offset:0
v_cvt_pk_bf16_f32 v53, v26, v27
v_mfma_f32_16x16x32_bf16 v[240:243], a[80:83], v[60:63], v[240:243]
ds_read_b64_tr_b16 a[70:71], v89 offset:4096
v_cvt_pk_bf16_f32 v54, v28, v29
v_mfma_f32_16x16x32_bf16 v[244:247], a[84:87], v[60:63], v[244:247]
ds_read_b64_tr_b16 a[72:73], v90 offset:0
v_mfma_f32_16x16x32_bf16 v[248:251], a[88:91], v[60:63], v[248:251]
ds_read_b64_tr_b16 a[74:75], v90 offset:4096
v_mfma_f32_16x16x32_bf16 v[252:255], a[92:95], v[60:63], v[252:255]
ds_read_b64_tr_b16 a[76:77], v91 offset:0
v_mfma_f32_16x16x32_bf16 v[120:123], v[124:127], v[60:63], v[120:123]
ds_read_b64_tr_b16 a[78:79], v91 offset:4096
v_mfma_f32_16x16x32_bf16 v[32:35], a[0:3], a[96:99], v[72:75]
ds_read_b64_tr_b16 a[80:81], v92 offset:0
v_mfma_f32_16x16x32_bf16 v[32:35], a[4:7], a[100:103], v[32:35]
ds_read_b64_tr_b16 a[82:83], v92 offset:4096
v_mfma_f32_16x16x32_bf16 v[32:35], a[8:11], a[104:107], v[32:35]
ds_read_b64_tr_b16 a[84:85], v93 offset:0
v_mfma_f32_16x16x32_bf16 v[32:35], a[12:15], a[108:111], v[32:35]
ds_read_b64_tr_b16 a[86:87], v93 offset:4096
v_mfma_f32_16x16x32_bf16 v[36:39], a[16:19], a[96:99], v[72:75]
ds_read_b64_tr_b16 a[88:89], v94 offset:0
v_mfma_f32_16x16x32_bf16 v[36:39], a[20:23], a[100:103], v[36:39]
ds_read_b64_tr_b16 a[90:91], v94 offset:4096
v_mfma_f32_16x16x32_bf16 v[36:39], a[24:27], a[104:107], v[36:39]
ds_read_b64_tr_b16 a[92:93], v95 offset:0
v_mfma_f32_16x16x32_bf16 v[36:39], a[28:31], a[108:111], v[36:39]
ds_read_b64_tr_b16 a[94:95], v95 offset:4096
v_mfma_f32_16x16x32_bf16 v[40:43], a[0:3], a[112:115], v[76:79]
v_exp_f32 v30, v30
v_mfma_f32_16x16x32_bf16 v[40:43], a[4:7], a[116:119], v[40:43]
v_exp_f32 v31, v31
v_mfma_f32_16x16x32_bf16 v[40:43], a[8:11], a[120:123], v[40:43]
v_exp_f32 v32, v32
v_mfma_f32_16x16x32_bf16 v[40:43], a[12:15], a[124:127], v[40:43]
v_exp_f32 v33, v33
v_mfma_f32_16x16x32_bf16 v[44:47], a[16:19], a[112:115], v[76:79]
v_exp_f32 v34, v34
v_mfma_f32_16x16x32_bf16 v[44:47], a[20:23], a[116:119], v[44:47]
v_exp_f32 v35, v35
v_mfma_f32_16x16x32_bf16 v[44:47], a[24:27], a[120:123], v[44:47]
v_exp_f32 v36, v36
v_mfma_f32_16x16x32_bf16 v[44:47], a[28:31], a[124:127], v[44:47]
s_waitcnt lgkmcnt(0)
v_exp_f32 v37, v37
v_mfma_f32_16x16x32_bf16 v[128:131], a[64:67], v[48:51], v[128:131]
ds_read_b128 a[0:3], v84 offset:8192
v_cvt_pk_bf16_f32 v55, v30, v31
v_mfma_f32_16x16x32_bf16 v[132:135], a[68:71], v[48:51], v[132:135]
ds_read_b128 a[4:7], v85 offset:8192
v_cvt_pk_bf16_f32 v56, v32, v33
v_mfma_f32_16x16x32_bf16 v[136:139], a[72:75], v[48:51], v[136:139]
ds_read_b128 a[8:11], v86 offset:8192
v_cvt_pk_bf16_f32 v57, v34, v35
v_mfma_f32_16x16x32_bf16 v[140:143], a[76:79], v[48:51], v[140:143]
ds_read_b128 a[12:15], v87 offset:8192
v_cvt_pk_bf16_f32 v58, v36, v37
v_mfma_f32_16x16x32_bf16 v[144:147], a[80:83], v[48:51], v[144:147]
ds_read_b128 a[16:19], v84 offset:12288
v_mfma_f32_16x16x32_bf16 v[148:151], a[84:87], v[48:51], v[148:151]
ds_read_b128 a[20:23], v85 offset:12288
v_mfma_f32_16x16x32_bf16 v[152:155], a[88:91], v[48:51], v[152:155]
ds_read_b128 a[24:27], v86 offset:12288
v_mfma_f32_16x16x32_bf16 v[156:159], a[92:95], v[48:51], v[156:159]
ds_read_b128 a[28:31], v87 offset:12288
v_mfma_f32_16x16x32_bf16 v[108:111], v[124:127], v[48:51], v[108:111]
v_exp_f32 v38, v38
v_mfma_f32_16x16x32_bf16 v[160:163], a[64:67], v[52:55], v[160:163]
v_exp_f32 v39, v39
v_mfma_f32_16x16x32_bf16 v[164:167], a[68:71], v[52:55], v[164:167]
v_exp_f32 v40, v40
v_mfma_f32_16x16x32_bf16 v[168:171], a[72:75], v[52:55], v[168:171]
v_exp_f32 v41, v41
v_mfma_f32_16x16x32_bf16 v[172:175], a[76:79], v[52:55], v[172:175]
v_exp_f32 v42, v42
v_mfma_f32_16x16x32_bf16 v[176:179], a[80:83], v[52:55], v[176:179]
v_exp_f32 v43, v43
v_mfma_f32_16x16x32_bf16 v[180:183], a[84:87], v[52:55], v[180:183]
v_exp_f32 v44, v44
v_mfma_f32_16x16x32_bf16 v[184:187], a[88:91], v[52:55], v[184:187]
v_exp_f32 v45, v45
v_mfma_f32_16x16x32_bf16 v[188:191], a[92:95], v[52:55], v[188:191]
v_exp_f32 v46, v46
v_mfma_f32_16x16x32_bf16 v[112:115], v[124:127], v[52:55], v[112:115]
s_waitcnt lgkmcnt(0)
v_exp_f32 v47, v47
v_mfma_f32_16x16x32_bf16 v[16:19], a[0:3], a[32:35], v[64:67]
v_cvt_pk_bf16_f32 v59, v38, v39
v_cvt_pk_bf16_f32 v60, v40, v41
v_mfma_f32_16x16x32_bf16 v[16:19], a[4:7], a[36:39], v[16:19]
v_cvt_pk_bf16_f32 v61, v42, v43
v_cvt_pk_bf16_f32 v62, v44, v45
v_mfma_f32_16x16x32_bf16 v[16:19], a[8:11], a[40:43], v[16:19]
v_cvt_pk_bf16_f32 v63, v46, v47
v_mfma_f32_16x16x32_bf16 v[16:19], a[12:15], a[44:47], v[16:19]
v_mfma_f32_16x16x32_bf16 v[20:23], a[16:19], a[32:35], v[64:67]
v_mfma_f32_16x16x32_bf16 v[20:23], a[20:23], a[36:39], v[20:23]
s_add_u32 s39, s39, 1
v_mfma_f32_16x16x32_bf16 v[20:23], a[24:27], a[40:43], v[20:23]
v_mov_b32 v80, s39
v_mfma_f32_16x16x32_bf16 v[20:23], a[28:31], a[44:47], v[20:23]
v_mfma_f32_16x16x32_bf16 v[24:27], a[0:3], a[48:51], v[68:71]
s_waitcnt vmcnt(63)
ds_write_b32 v1, v80
v_mfma_f32_16x16x32_bf16 v[24:27], a[4:7], a[52:55], v[24:27]
v_exp_f32 v16, v16
v_mfma_f32_16x16x32_bf16 v[24:27], a[8:11], a[56:59], v[24:27]
v_exp_f32 v17, v17
v_mfma_f32_16x16x32_bf16 v[24:27], a[12:15], a[60:63], v[24:27]
v_cvt_pk_bf16_f32 v48, v16, v17
v_mfma_f32_16x16x32_bf16 v[28:31], a[16:19], a[48:51], v[68:71]
v_exp_f32 v18, v18
v_mfma_f32_16x16x32_bf16 v[28:31], a[20:23], a[52:55], v[28:31]
v_exp_f32 v19, v19
v_mfma_f32_16x16x32_bf16 v[28:31], a[24:27], a[56:59], v[28:31]
v_exp_f32 v20, v20
v_mfma_f32_16x16x32_bf16 v[28:31], a[28:31], a[60:63], v[28:31]
v_exp_f32 v21, v21
v_mfma_f32_16x16x32_bf16 v[192:195], a[64:67], v[56:59], v[192:195]
v_exp_f32 v22, v22
v_mfma_f32_16x16x32_bf16 v[196:199], a[68:71], v[56:59], v[196:199]
v_cvt_pk_bf16_f32 v49, v18, v19
v_mfma_f32_16x16x32_bf16 v[200:203], a[72:75], v[56:59], v[200:203]
v_exp_f32 v23, v23
v_mfma_f32_16x16x32_bf16 v[204:207], a[76:79], v[56:59], v[204:207]
v_exp_f32 v24, v24
v_mfma_f32_16x16x32_bf16 v[208:211], a[80:83], v[56:59], v[208:211]
v_exp_f32 v25, v25
v_mfma_f32_16x16x32_bf16 v[212:215], a[84:87], v[56:59], v[212:215]
v_exp_f32 v26, v26
v_mfma_f32_16x16x32_bf16 v[216:219], a[88:91], v[56:59], v[216:219]
v_exp_f32 v27, v27
v_mfma_f32_16x16x32_bf16 v[220:223], a[92:95], v[56:59], v[220:223]
v_cvt_pk_bf16_f32 v50, v20, v21
v_mfma_f32_16x16x32_bf16 v[116:119], v[124:127], v[56:59], v[116:119]
v_exp_f32 v28, v28
v_mfma_f32_16x16x32_bf16 v[224:227], a[64:67], v[60:63], v[224:227]
v_exp_f32 v29, v29
v_mfma_f32_16x16x32_bf16 v[228:231], a[68:71], v[60:63], v[228:231]
ds_read_b64_tr_b16 a[64:65], v88 offset:8192
v_cvt_pk_bf16_f32 v51, v22, v23
v_mfma_f32_16x16x32_bf16 v[232:235], a[72:75], v[60:63], v[232:235]
ds_read_b64_tr_b16 a[66:67], v88 offset:12288
v_cvt_pk_bf16_f32 v52, v24, v25
v_mfma_f32_16x16x32_bf16 v[236:239], a[76:79], v[60:63], v[236:239]
ds_read_b64_tr_b16 a[68:69], v89 offset:8192
v_cvt_pk_bf16_f32 v53, v26, v27
v_mfma_f32_16x16x32_bf16 v[240:243], a[80:83], v[60:63], v[240:243]
ds_read_b64_tr_b16 a[70:71], v89 offset:12288
v_cvt_pk_bf16_f32 v54, v28, v29
v_mfma_f32_16x16x32_bf16 v[244:247], a[84:87], v[60:63], v[244:247]
ds_read_b64_tr_b16 a[72:73], v90 offset:8192
v_mfma_f32_16x16x32_bf16 v[248:251], a[88:91], v[60:63], v[248:251]
ds_read_b64_tr_b16 a[74:75], v90 offset:12288
v_mfma_f32_16x16x32_bf16 v[252:255], a[92:95], v[60:63], v[252:255]
ds_read_b64_tr_b16 a[76:77], v91 offset:8192
v_mfma_f32_16x16x32_bf16 v[120:123], v[124:127], v[60:63], v[120:123]
ds_read_b64_tr_b16 a[78:79], v91 offset:12288
v_mfma_f32_16x16x32_bf16 v[32:35], a[0:3], a[96:99], v[72:75]
ds_read_b64_tr_b16 a[80:81], v92 offset:8192
v_mfma_f32_16x16x32_bf16 v[32:35], a[4:7], a[100:103], v[32:35]
ds_read_b64_tr_b16 a[82:83], v92 offset:12288
ds_read_b128 v[80:83], v101
v_mfma_f32_16x16x32_bf16 v[32:35], a[8:11], a[104:107], v[32:35]
ds_read_b64_tr_b16 a[84:85], v93 offset:8192
v_mfma_f32_16x16x32_bf16 v[32:35], a[12:15], a[108:111], v[32:35]
ds_read_b64_tr_b16 a[86:87], v93 offset:12288
v_mfma_f32_16x16x32_bf16 v[36:39], a[16:19], a[96:99], v[72:75]
s_waitcnt lgkmcnt(2)
ds_read_b64_tr_b16 a[88:89], v94 offset:8192
v_min3_u32 v80, v80, v81, v82
v_mfma_f32_16x16x32_bf16 v[36:39], a[20:23], a[100:103], v[36:39]
ds_read_b64_tr_b16 a[90:91], v94 offset:12288
v_min_u32 v80, v80, v83
v_mfma_f32_16x16x32_bf16 v[36:39], a[24:27], a[104:107], v[36:39]
ds_read_b64_tr_b16 a[92:93], v95 offset:8192
v_cmp_gt_u32 vcc, s39, v80
v_mfma_f32_16x16x32_bf16 v[36:39], a[28:31], a[108:111], v[36:39]
s_cbranch_vccnz L_fs9_4
L_fr9_4:
ds_read_b64_tr_b16 a[94:95], v95 offset:12288
v_mfma_f32_16x16x32_bf16 v[40:43], a[0:3], a[112:115], v[76:79]
v_exp_f32 v30, v30
v_mfma_f32_16x16x32_bf16 v[40:43], a[4:7], a[116:119], v[40:43]
v_exp_f32 v31, v31
v_mfma_f32_16x16x32_bf16 v[40:43], a[8:11], a[120:123], v[40:43]
v_exp_f32 v32, v32
v_mfma_f32_16x16x32_bf16 v[40:43], a[12:15], a[124:127], v[40:43]
v_exp_f32 v33, v33
v_mfma_f32_16x16x32_bf16 v[44:47], a[16:19], a[112:115], v[76:79]
v_exp_f32 v34, v34
v_mfma_f32_16x16x32_bf16 v[44:47], a[20:23], a[116:119], v[44:47]
v_exp_f32 v35, v35
v_mfma_f32_16x16x32_bf16 v[44:47], a[24:27], a[120:123], v[44:47]
v_exp_f32 v36, v36
v_mfma_f32_16x16x32_bf16 v[44:47], a[28:31], a[124:127], v[44:47]
s_waitcnt lgkmcnt(0)
v_exp_f32 v37, v37
v_mfma_f32_16x16x32_bf16 v[128:131], a[64:67], v[48:51], v[128:131]
ds_read_b128 a[0:3], v84 offset:16384
v_cvt_pk_bf16_f32 v55, v30, v31
v_mfma_f32_16x16x32_bf16 v[132:135], a[68:71], v[48:51], v[132:135]
ds_read_b128 a[4:7], v85 offset:16384
v_cvt_pk_bf16_f32 v56, v32, v33
v_mfma_f32_16x16x32_bf16 v[136:139], a[72:75], v[48:51], v[136:139]
ds_read_b128 a[8:11], v86 offset:16384
v_cvt_pk_bf16_f32 v57, v34, v35
v_mfma_f32_16x16x32_bf16 v[140:143], a[76:79], v[48:51], v[140:143]
ds_read_b128 a[12:15], v87 offset:16384
v_cvt_pk_bf16_f32 v58, v36, v37
v_mfma_f32_16x16x32_bf16 v[144:147], a[80:83], v[48:51], v[144:147]
ds_read_b128 a[16:19], v84 offset:20480
v_mfma_f32_16x16x32_bf16 v[148:151], a[84:87], v[48:51], v[148:151]
ds_read_b128 a[20:23], v85 offset:20480
v_mfma_f32_16x16x32_bf16 v[152:155], a[88:91], v[48:51], v[152:155]
ds_read_b128 a[24:27], v86 offset:20480
v_mfma_f32_16x16x32_bf16 v[156:159], a[92:95], v[48:51], v[156:159]
ds_read_b128 a[28:31], v87 offset:20480
v_mfma_f32_16x16x32_bf16 v[108:111], v[124:127], v[48:51], v[108:111]
v_exp_f32 v38, v38
v_mfma_f32_16x16x32_bf16 v[160:163], a[64:67], v[52:55], v[160:163]
v_exp_f32 v39, v39
v_mfma_f32_16x16x32_bf16 v[164:167], a[68:71], v[52:55], v[164:167]
v_exp_f32 v40, v40
v_mfma_f32_16x16x32_bf16 v[168:171], a[72:75], v[52:55], v[168:171]
v_exp_f32 v41, v41
v_mfma_f32_16x16x32_bf16 v[172:175], a[76:79], v[52:55], v[172:175]
v_exp_f32 v42, v42
v_mfma_f32_16x16x32_bf16 v[176:179], a[80:83], v[52:55], v[176:179]
v_exp_f32 v43, v43
v_mfma_f32_16x16x32_bf16 v[180:183], a[84:87], v[52:55], v[180:183]
v_exp_f32 v44, v44
v_mfma_f32_16x16x32_bf16 v[184:187], a[88:91], v[52:55], v[184:187]
v_exp_f32 v45, v45
v_mfma_f32_16x16x32_bf16 v[188:191], a[92:95], v[52:55], v[188:191]
v_exp_f32 v46, v46
v_mfma_f32_16x16x32_bf16 v[112:115], v[124:127], v[52:55], v[112:115]
s_waitcnt lgkmcnt(0)
v_exp_f32 v47, v47
v_mfma_f32_16x16x32_bf16 v[16:19], a[0:3], a[32:35], v[64:67]
v_cvt_pk_bf16_f32 v59, v38, v39
v_cvt_pk_bf16_f32 v60, v40, v41
v_mfma_f32_16x16x32_bf16 v[16:19], a[4:7], a[36:39], v[16:19]
v_cvt_pk_bf16_f32 v61, v42, v43
v_cvt_pk_bf16_f32 v62, v44, v45
v_mfma_f32_16x16x32_bf16 v[16:19], a[8:11], a[40:43], v[16:19]
v_cvt_pk_bf16_f32 v63, v46, v47
v_mfma_f32_16x16x32_bf16 v[16:19], a[12:15], a[44:47], v[16:19]
v_mfma_f32_16x16x32_bf16 v[20:23], a[16:19], a[32:35], v[64:67]
v_mfma_f32_16x16x32_bf16 v[20:23], a[20:23], a[36:39], v[20:23]
v_mfma_f32_16x16x32_bf16 v[20:23], a[24:27], a[40:43], v[20:23]
v_mfma_f32_16x16x32_bf16 v[20:23], a[28:31], a[44:47], v[20:23]
v_mfma_f32_16x16x32_bf16 v[24:27], a[0:3], a[48:51], v[68:71]
v_mfma_f32_16x16x32_bf16 v[24:27], a[4:7], a[52:55], v[24:27]
s_nop 1
v_exp_f32 v16, v16
v_mfma_f32_16x16x32_bf16 v[24:27], a[8:11], a[56:59], v[24:27]
v_exp_f32 v17, v17
v_mfma_f32_16x16x32_bf16 v[24:27], a[12:15], a[60:63], v[24:27]
v_cvt_pk_bf16_f32 v48, v16, v17
v_mfma_f32_16x16x32_bf16 v[28:31], a[16:19], a[48:51], v[68:71]
v_exp_f32 v18, v18
v_mfma_f32_16x16x32_bf16 v[28:31], a[20:23], a[52:55], v[28:31]
v_exp_f32 v19, v19
v_mfma_f32_16x16x32_bf16 v[28:31], a[24:27], a[56:59], v[28:31]
v_exp_f32 v20, v20
v_mfma_f32_16x16x32_bf16 v[28:31], a[28:31], a[60:63], v[28:31]
v_exp_f32 v21, v21
v_mfma_f32_16x16x32_bf16 v[192:195], a[64:67], v[56:59], v[192:195]
v_exp_f32 v22, v22
v_mfma_f32_16x16x32_bf16 v[196:199], a[68:71], v[56:59], v[196:199]
v_cvt_pk_bf16_f32 v49, v18, v19
v_mfma_f32_16x16x32_bf16 v[200:203], a[72:75], v[56:59], v[200:203]
v_exp_f32 v23, v23
v_mfma_f32_16x16x32_bf16 v[204:207], a[76:79], v[56:59], v[204:207]
v_exp_f32 v24, v24
v_mfma_f32_16x16x32_bf16 v[208:211], a[80:83], v[56:59], v[208:211]
v_exp_f32 v25, v25
v_mfma_f32_16x16x32_bf16 v[212:215], a[84:87], v[56:59], v[212:215]
v_exp_f32 v26, v26
v_mfma_f32_16x16x32_bf16 v[216:219], a[88:91], v[56:59], v[216:219]
v_exp_f32 v27, v27
v_mfma_f32_16x16x32_bf16 v[220:223], a[92:95], v[56:59], v[220:223]
v_cvt_pk_bf16_f32 v50, v20, v21
v_mfma_f32_16x16x32_bf16 v[116:119], v[124:127], v[56:59], v[116:119]
v_exp_f32 v28, v28
v_mfma_f32_16x16x32_bf16 v[224:227], a[64:67], v[60:63], v[224:227]
v_exp_f32 v29, v29
v_mfma_f32_16x16x32_bf16 v[228:231], a[68:71], v[60:63], v[228:231]
ds_read_b64_tr_b16 a[64:65], v88 offset:16384
v_cvt_pk_bf16_f32 v51, v22, v23
v_mfma_f32_16x16x32_bf16 v[232:235], a[72:75], v[60:63], v[232:235]
ds_read_b64_tr_b16 a[66:67], v88 offset:20480
v_cvt_pk_bf16_f32 v52, v24, v25
v_mfma_f32_16x16x32_bf16 v[236:239], a[76:79], v[60:63], v[236:239]
ds_read_b64_tr_b16 a[68:69], v89 offset:16384
v_cvt_pk_bf16_f32 v53, v26, v27
v_mfma_f32_16x16x32_bf16 v[240:243], a[80:83], v[60:63], v[240:243]
ds_read_b64_tr_b16 a[70:71], v89 offset:20480
v_cvt_pk_bf16_f32 v54, v28, v29
v_mfma_f32_16x16x32_bf16 v[244:247], a[84:87], v[60:63], v[244:247]
ds_read_b64_tr_b16 a[72:73], v90 offset:16384
v_mfma_f32_16x16x32_bf16 v[248:251], a[88:91], v[60:63], v[248:251]
ds_read_b64_tr_b16 a[74:75], v90 offset:20480
v_mfma_f32_16x16x32_bf16 v[252:255], a[92:95], v[60:63], v[252:255]
ds_read_b64_tr_b16 a[76:77], v91 offset:16384
v_mfma_f32_16x16x32_bf16 v[120:123], v[124:127], v[60:63], v[120:123]
ds_read_b64_tr_b16 a[78:79], v91 offset:20480
v_mfma_f32_16x16x32_bf16 v[32:35], a[0:3], a[96:99], v[72:75]
ds_read_b64_tr_b16 a[80:81], v92 offset:16384
v_mfma_f32_16x16x32_bf16 v[32:35], a[4:7], a[100:103], v[32:35]
ds_read_b64_tr_b16 a[82:83], v92 offset:20480
v_mfma_f32_16x16x32_bf16 v[32:35], a[8:11], a[104:107], v[32:35]
ds_read_b64_tr_b16 a[84:85], v93 offset:16384
v_mfma_f32_16x16x32_bf16 v[32:35], a[12:15], a[108:111], v[32:35]
ds_read_b64_tr_b16 a[86:87], v93 offset:20480
v_mfma_f32_16x16x32_bf16 v[36:39], a[16:19], a[96:99], v[72:75]
ds_read_b64_tr_b16 a[88:89], v94 offset:16384
v_mfma_f32_16x16x32_bf16 v[36:39], a[20:23], a[100:103], v[36:39]
ds_read_b64_tr_b16 a[90:91], v94 offset:20480
v_mfma_f32_16x16x32_bf16 v[36:39], a[24:27], a[104:107], v[36:39]
ds_read_b64_tr_b16 a[92:93], v95 offset:16384
v_mfma_f32_16x16x32_bf16 v[36:39], a[28:31], a[108:111], v[36:39]
ds_read_b64_tr_b16 a[94:95], v95 offset:20480
v_mfma_f32_16x16x32_bf16 v[40:43], a[0:3], a[112:115], v[76:79]
v_exp_f32 v30, v30
v_mfma_f32_16x16x32_bf16 v[40:43], a[4:7], a[116:119], v[40:43]
v_exp_f32 v31, v31
v_mfma_f32_16x16x32_bf16 v[40:43], a[8:11], a[120:123], v[40:43]
v_exp_f32 v32, v32
v_mfma_f32_16x16x32_bf16 v[40:43], a[12:15], a[124:127], v[40:43]
v_exp_f32 v33, v33
v_mfma_f32_16x16x32_bf16 v[44:47], a[16:19], a[112:115], v[76:79]
v_exp_f32 v34, v34
v_mfma_f32_16x16x32_bf16 v[44:47], a[20:23], a[116:119], v[44:47]
v_exp_f32 v35, v35
v_mfma_f32_16x16x32_bf16 v[44:47], a[24:27], a[120:123], v[44:47]
v_exp_f32 v36, v36
v_mfma_f32_16x16x32_bf16 v[44:47], a[28:31], a[124:127], v[44:47]
s_waitcnt lgkmcnt(0)
v_exp_f32 v37, v37
v_mfma_f32_16x16x32_bf16 v[128:131], a[64:67], v[48:51], v[128:131]
ds_read_b128 a[0:3], v84 offset:24576
v_cvt_pk_bf16_f32 v55, v30, v31
v_mfma_f32_16x16x32_bf16 v[132:135], a[68:71], v[48:51], v[132:135]
ds_read_b128 a[4:7], v85 offset:24576
v_cvt_pk_bf16_f32 v56, v32, v33
v_mfma_f32_16x16x32_bf16 v[136:139], a[72:75], v[48:51], v[136:139]
ds_read_b128 a[8:11], v86 offset:24576
v_cvt_pk_bf16_f32 v57, v34, v35
v_mfma_f32_16x16x32_bf16 v[140:143], a[76:79], v[48:51], v[140:143]
ds_read_b128 a[12:15], v87 offset:24576
v_cvt_pk_bf16_f32 v58, v36, v37
v_mfma_f32_16x16x32_bf16 v[144:147], a[80:83], v[48:51], v[144:147]
ds_read_b128 a[16:19], v84 offset:28672
v_mfma_f32_16x16x32_bf16 v[148:151], a[84:87], v[48:51], v[148:151]
ds_read_b128 a[20:23], v85 offset:28672
v_mfma_f32_16x16x32_bf16 v[152:155], a[88:91], v[48:51], v[152:155]
ds_read_b128 a[24:27], v86 offset:28672
v_mfma_f32_16x16x32_bf16 v[156:159], a[92:95], v[48:51], v[156:159]
ds_read_b128 a[28:31], v87 offset:28672
v_mfma_f32_16x16x32_bf16 v[108:111], v[124:127], v[48:51], v[108:111]
v_exp_f32 v38, v38
v_mfma_f32_16x16x32_bf16 v[160:163], a[64:67], v[52:55], v[160:163]
v_exp_f32 v39, v39
v_mfma_f32_16x16x32_bf16 v[164:167], a[68:71], v[52:55], v[164:167]
v_exp_f32 v40, v40
v_mfma_f32_16x16x32_bf16 v[168:171], a[72:75], v[52:55], v[168:171]
v_exp_f32 v41, v41
v_mfma_f32_16x16x32_bf16 v[172:175], a[76:79], v[52:55], v[172:175]
v_exp_f32 v42, v42
v_mfma_f32_16x16x32_bf16 v[176:179], a[80:83], v[52:55], v[176:179]
v_exp_f32 v43, v43
v_mfma_f32_16x16x32_bf16 v[180:183], a[84:87], v[52:55], v[180:183]
v_exp_f32 v44, v44
v_mfma_f32_16x16x32_bf16 v[184:187], a[88:91], v[52:55], v[184:187]
v_exp_f32 v45, v45
v_mfma_f32_16x16x32_bf16 v[188:191], a[92:95], v[52:55], v[188:191]
v_exp_f32 v46, v46
v_mfma_f32_16x16x32_bf16 v[112:115], v[124:127], v[52:55], v[112:115]
s_waitcnt lgkmcnt(0)
v_exp_f32 v47, v47
v_mfma_f32_16x16x32_bf16 v[16:19], a[0:3], a[32:35], v[64:67]
v_cvt_pk_bf16_f32 v59, v38, v39
v_cvt_pk_bf16_f32 v60, v40, v41
v_mfma_f32_16x16x32_bf16 v[16:19], a[4:7], a[36:39], v[16:19]
v_cvt_pk_bf16_f32 v61, v42, v43
v_cvt_pk_bf16_f32 v62, v44, v45
v_mfma_f32_16x16x32_bf16 v[16:19], a[8:11], a[40:43], v[16:19]
v_cvt_pk_bf16_f32 v63, v46, v47
v_mfma_f32_16x16x32_bf16 v[16:19], a[12:15], a[44:47], v[16:19]
v_mfma_f32_16x16x32_bf16 v[20:23], a[16:19], a[32:35], v[64:67]
v_mfma_f32_16x16x32_bf16 v[20:23], a[20:23], a[36:39], v[20:23]
s_add_u32 s39, s39, 1
v_mfma_f32_16x16x32_bf16 v[20:23], a[24:27], a[40:43], v[20:23]
v_mov_b32 v80, s39
v_mfma_f32_16x16x32_bf16 v[20:23], a[28:31], a[44:47], v[20:23]
v_mfma_f32_16x16x32_bf16 v[24:27], a[0:3], a[48:51], v[68:71]
s_waitcnt vmcnt(0)
ds_write_b32 v1, v80
v_mfma_f32_16x16x32_bf16 v[24:27], a[4:7], a[52:55], v[24:27]
v_exp_f32 v16, v16
v_mfma_f32_16x16x32_bf16 v[24:27], a[8:11], a[56:59], v[24:27]
v_exp_f32 v17, v17
v_mfma_f32_16x16x32_bf16 v[24:27], a[12:15], a[60:63], v[24:27]
v_cvt_pk_bf16_f32 v48, v16, v17
v_mfma_f32_16x16x32_bf16 v[28:31], a[16:19], a[48:51], v[68:71]
v_exp_f32 v18, v18
v_mfma_f32_16x16x32_bf16 v[28:31], a[20:23], a[52:55], v[28:31]
v_exp_f32 v19, v19
v_mfma_f32_16x16x32_bf16 v[28:31], a[24:27], a[56:59], v[28:31]
v_exp_f32 v20, v20
v_mfma_f32_16x16x32_bf16 v[28:31], a[28:31], a[60:63], v[28:31]
v_exp_f32 v21, v21
v_mfma_f32_16x16x32_bf16 v[192:195], a[64:67], v[56:59], v[192:195]
v_exp_f32 v22, v22
v_mfma_f32_16x16x32_bf16 v[196:199], a[68:71], v[56:59], v[196:199]
v_cvt_pk_bf16_f32 v49, v18, v19
v_mfma_f32_16x16x32_bf16 v[200:203], a[72:75], v[56:59], v[200:203]
v_exp_f32 v23, v23
v_mfma_f32_16x16x32_bf16 v[204:207], a[76:79], v[56:59], v[204:207]
v_exp_f32 v24, v24
v_mfma_f32_16x16x32_bf16 v[208:211], a[80:83], v[56:59], v[208:211]
v_exp_f32 v25, v25
v_mfma_f32_16x16x32_bf16 v[212:215], a[84:87], v[56:59], v[212:215]
v_exp_f32 v26, v26
v_mfma_f32_16x16x32_bf16 v[216:219], a[88:91], v[56:59], v[216:219]
v_exp_f32 v27, v27
v_mfma_f32_16x16x32_bf16 v[220:223], a[92:95], v[56:59], v[220:223]
v_cvt_pk_bf16_f32 v50, v20, v21
v_mfma_f32_16x16x32_bf16 v[116:119], v[124:127], v[56:59], v[116:119]
v_exp_f32 v28, v28
v_mfma_f32_16x16x32_bf16 v[224:227], a[64:67], v[60:63], v[224:227]
v_exp_f32 v29, v29
v_mfma_f32_16x16x32_bf16 v[228:231], a[68:71], v[60:63], v[228:231]
ds_read_b64_tr_b16 a[64:65], v88 offset:24576
v_cvt_pk_bf16_f32 v51, v22, v23
v_mfma_f32_16x16x32_bf16 v[232:235], a[72:75], v[60:63], v[232:235]
ds_read_b64_tr_b16 a[66:67], v88 offset:28672
v_cvt_pk_bf16_f32 v52, v24, v25
v_mfma_f32_16x16x32_bf16 v[236:239], a[76:79], v[60:63], v[236:239]
ds_read_b64_tr_b16 a[68:69], v89 offset:24576
v_cvt_pk_bf16_f32 v53, v26, v27
v_mfma_f32_16x16x32_bf16 v[240:243], a[80:83], v[60:63], v[240:243]
ds_read_b64_tr_b16 a[70:71], v89 offset:28672
v_cvt_pk_bf16_f32 v54, v28, v29
v_mfma_f32_16x16x32_bf16 v[244:247], a[84:87], v[60:63], v[244:247]
ds_read_b64_tr_b16 a[72:73], v90 offset:24576
v_mfma_f32_16x16x32_bf16 v[248:251], a[88:91], v[60:63], v[248:251]
ds_read_b64_tr_b16 a[74:75], v90 offset:28672
v_mfma_f32_16x16x32_bf16 v[252:255], a[92:95], v[60:63], v[252:255]
ds_read_b64_tr_b16 a[76:77], v91 offset:24576
v_mfma_f32_16x16x32_bf16 v[120:123], v[124:127], v[60:63], v[120:123]
ds_read_b64_tr_b16 a[78:79], v91 offset:28672
v_mfma_f32_16x16x32_bf16 v[32:35], a[0:3], a[96:99], v[72:75]
ds_read_b64_tr_b16 a[80:81], v92 offset:24576
v_mfma_f32_16x16x32_bf16 v[32:35], a[4:7], a[100:103], v[32:35]
ds_read_b64_tr_b16 a[82:83], v92 offset:28672
ds_read_b128 v[80:83], v101
v_mfma_f32_16x16x32_bf16 v[32:35], a[8:11], a[104:107], v[32:35]
ds_read_b64_tr_b16 a[84:85], v93 offset:24576
v_mfma_f32_16x16x32_bf16 v[32:35], a[12:15], a[108:111], v[32:35]
ds_read_b64_tr_b16 a[86:87], v93 offset:28672
v_mfma_f32_16x16x32_bf16 v[36:39], a[16:19], a[96:99], v[72:75]
s_waitcnt lgkmcnt(2)
ds_read_b64_tr_b16 a[88:89], v94 offset:24576
v_min3_u32 v80, v80, v81, v82
v_mfma_f32_16x16x32_bf16 v[36:39], a[20:23], a[100:103], v[36:39]
ds_read_b64_tr_b16 a[90:91], v94 offset:28672
v_min_u32 v80, v80, v83
v_mfma_f32_16x16x32_bf16 v[36:39], a[24:27], a[104:107], v[36:39]
ds_read_b64_tr_b16 a[92:93], v95 offset:24576
v_cmp_gt_u32 vcc, s39, v80
v_mfma_f32_16x16x32_bf16 v[36:39], a[28:31], a[108:111], v[36:39]
s_cbranch_vccnz L_fs11_4
L_fr11_4:
ds_read_b64_tr_b16 a[94:95], v95 offset:28672
v_mfma_f32_16x16x32_bf16 v[40:43], a[0:3], a[112:115], v[76:79]
v_exp_f32 v30, v30
v_mfma_f32_16x16x32_bf16 v[40:43], a[4:7], a[116:119], v[40:43]
v_exp_f32 v31, v31
v_mfma_f32_16x16x32_bf16 v[40:43], a[8:11], a[120:123], v[40:43]
v_exp_f32 v32, v32
v_mfma_f32_16x16x32_bf16 v[40:43], a[12:15], a[124:127], v[40:43]
v_exp_f32 v33, v33
v_mfma_f32_16x16x32_bf16 v[44:47], a[16:19], a[112:115], v[76:79]
v_exp_f32 v34, v34
v_mfma_f32_16x16x32_bf16 v[44:47], a[20:23], a[116:119], v[44:47]
v_exp_f32 v35, v35
v_mfma_f32_16x16x32_bf16 v[44:47], a[24:27], a[120:123], v[44:47]
v_exp_f32 v36, v36
v_mfma_f32_16x16x32_bf16 v[44:47], a[28:31], a[124:127], v[44:47]
s_waitcnt lgkmcnt(0)
v_exp_f32 v37, v37
v_mfma_f32_16x16x32_bf16 v[128:131], a[64:67], v[48:51], v[128:131]
ds_read_b128 a[0:3], v84 offset:32768
v_cvt_pk_bf16_f32 v55, v30, v31
v_mfma_f32_16x16x32_bf16 v[132:135], a[68:71], v[48:51], v[132:135]
ds_read_b128 a[4:7], v85 offset:32768
v_cvt_pk_bf16_f32 v56, v32, v33
v_mfma_f32_16x16x32_bf16 v[136:139], a[72:75], v[48:51], v[136:139]
ds_read_b128 a[8:11], v86 offset:32768
v_cvt_pk_bf16_f32 v57, v34, v35
v_mfma_f32_16x16x32_bf16 v[140:143], a[76:79], v[48:51], v[140:143]
ds_read_b128 a[12:15], v87 offset:32768
v_cvt_pk_bf16_f32 v58, v36, v37
v_mfma_f32_16x16x32_bf16 v[144:147], a[80:83], v[48:51], v[144:147]
ds_read_b128 a[16:19], v84 offset:36864
v_mfma_f32_16x16x32_bf16 v[148:151], a[84:87], v[48:51], v[148:151]
ds_read_b128 a[20:23], v85 offset:36864
v_mfma_f32_16x16x32_bf16 v[152:155], a[88:91], v[48:51], v[152:155]
ds_read_b128 a[24:27], v86 offset:36864
v_mfma_f32_16x16x32_bf16 v[156:159], a[92:95], v[48:51], v[156:159]
ds_read_b128 a[28:31], v87 offset:36864
v_mfma_f32_16x16x32_bf16 v[108:111], v[124:127], v[48:51], v[108:111]
v_exp_f32 v38, v38
v_mfma_f32_16x16x32_bf16 v[160:163], a[64:67], v[52:55], v[160:163]
v_exp_f32 v39, v39
v_mfma_f32_16x16x32_bf16 v[164:167], a[68:71], v[52:55], v[164:167]
v_exp_f32 v40, v40
v_mfma_f32_16x16x32_bf16 v[168:171], a[72:75], v[52:55], v[168:171]
v_exp_f32 v41, v41
v_mfma_f32_16x16x32_bf16 v[172:175], a[76:79], v[52:55], v[172:175]
v_exp_f32 v42, v42
v_mfma_f32_16x16x32_bf16 v[176:179], a[80:83], v[52:55], v[176:179]
v_exp_f32 v43, v43
v_mfma_f32_16x16x32_bf16 v[180:183], a[84:87], v[52:55], v[180:183]
v_exp_f32 v44, v44
v_mfma_f32_16x16x32_bf16 v[184:187], a[88:91], v[52:55], v[184:187]
v_exp_f32 v45, v45
v_mfma_f32_16x16x32_bf16 v[188:191], a[92:95], v[52:55], v[188:191]
v_exp_f32 v46, v46
v_mfma_f32_16x16x32_bf16 v[112:115], v[124:127], v[52:55], v[112:115]
s_waitcnt lgkmcnt(0)
v_exp_f32 v47, v47
v_mfma_f32_16x16x32_bf16 v[16:19], a[0:3], a[32:35], v[64:67]
v_cvt_pk_bf16_f32 v59, v38, v39
v_cvt_pk_bf16_f32 v60, v40, v41
v_mfma_f32_16x16x32_bf16 v[16:19], a[4:7], a[36:39], v[16:19]
v_cvt_pk_bf16_f32 v61, v42, v43
v_cvt_pk_bf16_f32 v62, v44, v45
v_mfma_f32_16x16x32_bf16 v[16:19], a[8:11], a[40:43], v[16:19]
v_cvt_pk_bf16_f32 v63, v46, v47
v_mfma_f32_16x16x32_bf16 v[16:19], a[12:15], a[44:47], v[16:19]
v_mfma_f32_16x16x32_bf16 v[20:23], a[16:19], a[32:35], v[64:67]
v_mfma_f32_16x16x32_bf16 v[20:23], a[20:23], a[36:39], v[20:23]
v_mfma_f32_16x16x32_bf16 v[20:23], a[24:27], a[40:43], v[20:23]
v_mfma_f32_16x16x32_bf16 v[20:23], a[28:31], a[44:47], v[20:23]
v_mfma_f32_16x16x32_bf16 v[24:27], a[0:3], a[48:51], v[68:71]
v_mfma_f32_16x16x32_bf16 v[24:27], a[4:7], a[52:55], v[24:27]
s_nop 1
v_exp_f32 v16, v16
v_mfma_f32_16x16x32_bf16 v[24:27], a[8:11], a[56:59], v[24:27]
v_exp_f32 v17, v17
v_mfma_f32_16x16x32_bf16 v[24:27], a[12:15], a[60:63], v[24:27]
v_cvt_pk_bf16_f32 v48, v16, v17
v_mfma_f32_16x16x32_bf16 v[28:31], a[16:19], a[48:51], v[68:71]
v_exp_f32 v18, v18
v_mfma_f32_16x16x32_bf16 v[28:31], a[20:23], a[52:55], v[28:31]
v_exp_f32 v19, v19
v_mfma_f32_16x16x32_bf16 v[28:31], a[24:27], a[56:59], v[28:31]
v_exp_f32 v20, v20
v_mfma_f32_16x16x32_bf16 v[28:31], a[28:31], a[60:63], v[28:31]
v_exp_f32 v21, v21
v_mfma_f32_16x16x32_bf16 v[192:195], a[64:67], v[56:59], v[192:195]
v_exp_f32 v22, v22
v_mfma_f32_16x16x32_bf16 v[196:199], a[68:71], v[56:59], v[196:199]
v_cvt_pk_bf16_f32 v49, v18, v19
v_mfma_f32_16x16x32_bf16 v[200:203], a[72:75], v[56:59], v[200:203]
v_exp_f32 v23, v23
v_mfma_f32_16x16x32_bf16 v[204:207], a[76:79], v[56:59], v[204:207]
v_exp_f32 v24, v24
v_mfma_f32_16x16x32_bf16 v[208:211], a[80:83], v[56:59], v[208:211]
v_exp_f32 v25, v25
v_mfma_f32_16x16x32_bf16 v[212:215], a[84:87], v[56:59], v[212:215]
v_exp_f32 v26, v26
v_mfma_f32_16x16x32_bf16 v[216:219], a[88:91], v[56:59], v[216:219]
v_exp_f32 v27, v27
v_mfma_f32_16x16x32_bf16 v[220:223], a[92:95], v[56:59], v[220:223]
v_cvt_pk_bf16_f32 v50, v20, v21
v_mfma_f32_16x16x32_bf16 v[116:119], v[124:127], v[56:59], v[116:119]
v_exp_f32 v28, v28
v_mfma_f32_16x16x32_bf16 v[224:227], a[64:67], v[60:63], v[224:227]
v_exp_f32 v29, v29
v_mfma_f32_16x16x32_bf16 v[228:231], a[68:71], v[60:63], v[228:231]
ds_read_b64_tr_b16 a[64:65], v88 offset:32768
v_cvt_pk_bf16_f32 v51, v22, v23
v_mfma_f32_16x16x32_bf16 v[232:235], a[72:75], v[60:63], v[232:235]
ds_read_b64_tr_b16 a[66:67], v88 offset:36864
v_cvt_pk_bf16_f32 v52, v24, v25
v_mfma_f32_16x16x32_bf16 v[236:239], a[76:79], v[60:63], v[236:239]
ds_read_b64_tr_b16 a[68:69], v89 offset:32768
v_cvt_pk_bf16_f32 v53, v26, v27
v_mfma_f32_16x16x32_bf16 v[240:243], a[80:83], v[60:63], v[240:243]
ds_read_b64_tr_b16 a[70:71], v89 offset:36864
v_cvt_pk_bf16_f32 v54, v28, v29
v_mfma_f32_16x16x32_bf16 v[244:247], a[84:87], v[60:63], v[244:247]
ds_read_b64_tr_b16 a[72:73], v90 offset:32768
v_mfma_f32_16x16x32_bf16 v[248:251], a[88:91], v[60:63], v[248:251]
ds_read_b64_tr_b16 a[74:75], v90 offset:36864
v_mfma_f32_16x16x32_bf16 v[252:255], a[92:95], v[60:63], v[252:255]
ds_read_b64_tr_b16 a[76:77], v91 offset:32768
v_mfma_f32_16x16x32_bf16 v[120:123], v[124:127], v[60:63], v[120:123]
ds_read_b64_tr_b16 a[78:79], v91 offset:36864
v_mfma_f32_16x16x32_bf16 v[32:35], a[0:3], a[96:99], v[72:75]
ds_read_b64_tr_b16 a[80:81], v92 offset:32768
v_mfma_f32_16x16x32_bf16 v[32:35], a[4:7], a[100:103], v[32:35]
ds_read_b64_tr_b16 a[82:83], v92 offset:36864
v_mfma_f32_16x16x32_bf16 v[32:35], a[8:11], a[104:107], v[32:35]
ds_read_b64_tr_b16 a[84:85], v93 offset:32768
v_mfma_f32_16x16x32_bf16 v[32:35], a[12:15], a[108:111], v[32:35]
ds_read_b64_tr_b16 a[86:87], v93 offset:36864
v_mfma_f32_16x16x32_bf16 v[36:39], a[16:19], a[96:99], v[72:75]
ds_read_b64_tr_b16 a[88:89], v94 offset:32768
v_mfma_f32_16x16x32_bf16 v[36:39], a[20:23], a[100:103], v[36:39]
ds_read_b64_tr_b16 a[90:91], v94 offset:36864
v_mfma_f32_16x16x32_bf16 v[36:39], a[24:27], a[104:107], v[36:39]
ds_read_b64_tr_b16 a[92:93], v95 offset:32768
v_mfma_f32_16x16x32_bf16 v[36:39], a[28:31], a[108:111], v[36:39]
ds_read_b64_tr_b16 a[94:95], v95 offset:36864
v_mfma_f32_16x16x32_bf16 v[40:43], a[0:3], a[112:115], v[76:79]
v_exp_f32 v30, v30
v_mfma_f32_16x16x32_bf16 v[40:43], a[4:7], a[116:119], v[40:43]
v_exp_f32 v31, v31
v_mfma_f32_16x16x32_bf16 v[40:43], a[8:11], a[120:123], v[40:43]
v_exp_f32 v32, v32
v_mfma_f32_16x16x32_bf16 v[40:43], a[12:15], a[124:127], v[40:43]
v_exp_f32 v33, v33
v_mfma_f32_16x16x32_bf16 v[44:47], a[16:19], a[112:115], v[76:79]
v_exp_f32 v34, v34
v_mfma_f32_16x16x32_bf16 v[44:47], a[20:23], a[116:119], v[44:47]
v_exp_f32 v35, v35
v_mfma_f32_16x16x32_bf16 v[44:47], a[24:27], a[120:123], v[44:47]
v_exp_f32 v36, v36
v_mfma_f32_16x16x32_bf16 v[44:47], a[28:31], a[124:127], v[44:47]
s_waitcnt lgkmcnt(0)
v_exp_f32 v37, v37
v_mfma_f32_16x16x32_bf16 v[128:131], a[64:67], v[48:51], v[128:131]
ds_read_b128 a[0:3], v84 offset:40960
v_cvt_pk_bf16_f32 v55, v30, v31
v_mfma_f32_16x16x32_bf16 v[132:135], a[68:71], v[48:51], v[132:135]
ds_read_b128 a[4:7], v85 offset:40960
v_cvt_pk_bf16_f32 v56, v32, v33
v_mfma_f32_16x16x32_bf16 v[136:139], a[72:75], v[48:51], v[136:139]
ds_read_b128 a[8:11], v86 offset:40960
v_cvt_pk_bf16_f32 v57, v34, v35
v_mfma_f32_16x16x32_bf16 v[140:143], a[76:79], v[48:51], v[140:143]
ds_read_b128 a[12:15], v87 offset:40960
v_cvt_pk_bf16_f32 v58, v36, v37
v_mfma_f32_16x16x32_bf16 v[144:147], a[80:83], v[48:51], v[144:147]
ds_read_b128 a[16:19], v84 offset:45056
v_mfma_f32_16x16x32_bf16 v[148:151], a[84:87], v[48:51], v[148:151]
ds_read_b128 a[20:23], v85 offset:45056
v_mfma_f32_16x16x32_bf16 v[152:155], a[88:91], v[48:51], v[152:155]
ds_read_b128 a[24:27], v86 offset:45056
v_mfma_f32_16x16x32_bf16 v[156:159], a[92:95], v[48:51], v[156:159]
ds_read_b128 a[28:31], v87 offset:45056
v_mfma_f32_16x16x32_bf16 v[108:111], v[124:127], v[48:51], v[108:111]
v_exp_f32 v38, v38
v_mfma_f32_16x16x32_bf16 v[160:163], a[64:67], v[52:55], v[160:163]
v_exp_f32 v39, v39
v_mfma_f32_16x16x32_bf16 v[164:167], a[68:71], v[52:55], v[164:167]
v_exp_f32 v40, v40
v_mfma_f32_16x16x32_bf16 v[168:171], a[72:75], v[52:55], v[168:171]
v_exp_f32 v41, v41
v_mfma_f32_16x16x32_bf16 v[172:175], a[76:79], v[52:55], v[172:175]
v_exp_f32 v42, v42
v_mfma_f32_16x16x32_bf16 v[176:179], a[80:83], v[52:55], v[176:179]
v_exp_f32 v43, v43
v_mfma_f32_16x16x32_bf16 v[180:183], a[84:87], v[52:55], v[180:183]
v_exp_f32 v44, v44
v_mfma_f32_16x16x32_bf16 v[184:187], a[88:91], v[52:55], v[184:187]
v_exp_f32 v45, v45
v_mfma_f32_16x16x32_bf16 v[188:191], a[92:95], v[52:55], v[188:191]
v_exp_f32 v46, v46
v_mfma_f32_16x16x32_bf16 v[112:115], v[124:127], v[52:55], v[112:115]
s_waitcnt lgkmcnt(0)
v_exp_f32 v47, v47
v_mfma_f32_16x16x32_bf16 v[16:19], a[0:3], a[32:35], v[64:67]
v_cvt_pk_bf16_f32 v59, v38, v39
v_cvt_pk_bf16_f32 v60, v40, v41
v_mfma_f32_16x16x32_bf16 v[16:19], a[4:7], a[36:39], v[16:19]
v_cvt_pk_bf16_f32 v61, v42, v43
v_cvt_pk_bf16_f32 v62, v44, v45
v_mfma_f32_16x16x32_bf16 v[16:19], a[8:11], a[40:43], v[16:19]
v_cvt_pk_bf16_f32 v63, v46, v47
v_mfma_f32_16x16x32_bf16 v[16:19], a[12:15], a[44:47], v[16:19]
v_mfma_f32_16x16x32_bf16 v[20:23], a[16:19], a[32:35], v[64:67]
v_mfma_f32_16x16x32_bf16 v[20:23], a[20:23], a[36:39], v[20:23]
s_add_u32 s39, s39, 1
v_mfma_f32_16x16x32_bf16 v[20:23], a[24:27], a[40:43], v[20:23]
v_mov_b32 v80, s39
v_mfma_f32_16x16x32_bf16 v[20:23], a[28:31], a[44:47], v[20:23]
v_mfma_f32_16x16x32_bf16 v[24:27], a[0:3], a[48:51], v[68:71]
s_waitcnt vmcnt(63)
ds_write_b32 v1, v80
v_mfma_f32_16x16x32_bf16 v[24:27], a[4:7], a[52:55], v[24:27]
v_exp_f32 v16, v16
v_mfma_f32_16x16x32_bf16 v[24:27], a[8:11], a[56:59], v[24:27]
v_exp_f32 v17, v17
v_mfma_f32_16x16x32_bf16 v[24:27], a[12:15], a[60:63], v[24:27]
v_cvt_pk_bf16_f32 v48, v16, v17
v_mfma_f32_16x16x32_bf16 v[28:31], a[16:19], a[48:51], v[68:71]
v_exp_f32 v18, v18
v_mfma_f32_16x16x32_bf16 v[28:31], a[20:23], a[52:55], v[28:31]
v_exp_f32 v19, v19
v_mfma_f32_16x16x32_bf16 v[28:31], a[24:27], a[56:59], v[28:31]
v_exp_f32 v20, v20
v_mfma_f32_16x16x32_bf16 v[28:31], a[28:31], a[60:63], v[28:31]
v_exp_f32 v21, v21
v_mfma_f32_16x16x32_bf16 v[192:195], a[64:67], v[56:59], v[192:195]
v_exp_f32 v22, v22
v_mfma_f32_16x16x32_bf16 v[196:199], a[68:71], v[56:59], v[196:199]
v_cvt_pk_bf16_f32 v49, v18, v19
v_mfma_f32_16x16x32_bf16 v[200:203], a[72:75], v[56:59], v[200:203]
v_exp_f32 v23, v23
v_mfma_f32_16x16x32_bf16 v[204:207], a[76:79], v[56:59], v[204:207]
v_exp_f32 v24, v24
v_mfma_f32_16x16x32_bf16 v[208:211], a[80:83], v[56:59], v[208:211]
v_exp_f32 v25, v25
v_mfma_f32_16x16x32_bf16 v[212:215], a[84:87], v[56:59], v[212:215]
v_exp_f32 v26, v26
v_mfma_f32_16x16x32_bf16 v[216:219], a[88:91], v[56:59], v[216:219]
v_exp_f32 v27, v27
v_mfma_f32_16x16x32_bf16 v[220:223], a[92:95], v[56:59], v[220:223]
v_cvt_pk_bf16_f32 v50, v20, v21
v_mfma_f32_16x16x32_bf16 v[116:119], v[124:127], v[56:59], v[116:119]
v_exp_f32 v28, v28
v_mfma_f32_16x16x32_bf16 v[224:227], a[64:67], v[60:63], v[224:227]
v_exp_f32 v29, v29
v_mfma_f32_16x16x32_bf16 v[228:231], a[68:71], v[60:63], v[228:231]
ds_read_b64_tr_b16 a[64:65], v88 offset:40960
v_cvt_pk_bf16_f32 v51, v22, v23
v_mfma_f32_16x16x32_bf16 v[232:235], a[72:75], v[60:63], v[232:235]
ds_read_b64_tr_b16 a[66:67], v88 offset:45056
v_cvt_pk_bf16_f32 v52, v24, v25
v_mfma_f32_16x16x32_bf16 v[236:239], a[76:79], v[60:63], v[236:239]
ds_read_b64_tr_b16 a[68:69], v89 offset:40960
v_cvt_pk_bf16_f32 v53, v26, v27
v_mfma_f32_16x16x32_bf16 v[240:243], a[80:83], v[60:63], v[240:243]
ds_read_b64_tr_b16 a[70:71], v89 offset:45056
v_cvt_pk_bf16_f32 v54, v28, v29
v_mfma_f32_16x16x32_bf16 v[244:247], a[84:87], v[60:63], v[244:247]
ds_read_b64_tr_b16 a[72:73], v90 offset:40960
v_mfma_f32_16x16x32_bf16 v[248:251], a[88:91], v[60:63], v[248:251]
ds_read_b64_tr_b16 a[74:75], v90 offset:45056
v_mfma_f32_16x16x32_bf16 v[252:255], a[92:95], v[60:63], v[252:255]
ds_read_b64_tr_b16 a[76:77], v91 offset:40960
v_mfma_f32_16x16x32_bf16 v[120:123], v[124:127], v[60:63], v[120:123]
ds_read_b64_tr_b16 a[78:79], v91 offset:45056
v_mfma_f32_16x16x32_bf16 v[32:35], a[0:3], a[96:99], v[72:75]
ds_read_b64_tr_b16 a[80:81], v92 offset:40960
v_mfma_f32_16x16x32_bf16 v[32:35], a[4:7], a[100:103], v[32:35]
ds_read_b64_tr_b16 a[82:83], v92 offset:45056
ds_read_b128 v[80:83], v101
v_mfma_f32_16x16x32_bf16 v[32:35], a[8:11], a[104:107], v[32:35]
ds_read_b64_tr_b16 a[84:85], v93 offset:40960
v_mfma_f32_16x16x32_bf16 v[32:35], a[12:15], a[108:111], v[32:35]
ds_read_b64_tr_b16 a[86:87], v93 offset:45056
v_mfma_f32_16x16x32_bf16 v[36:39], a[16:19], a[96:99], v[72:75]
s_waitcnt lgkmcnt(2)
ds_read_b64_tr_b16 a[88:89], v94 offset:40960
v_min3_u32 v80, v80, v81, v82
v_mfma_f32_16x16x32_bf16 v[36:39], a[20:23], a[100:103], v[36:39]
ds_read_b64_tr_b16 a[90:91], v94 offset:45056
v_min_u32 v80, v80, v83
v_mfma_f32_16x16x32_bf16 v[36:39], a[24:27], a[104:107], v[36:39]
ds_read_b64_tr_b16 a[92:93], v95 offset:40960
v_cmp_gt_u32 vcc, s39, v80
v_mfma_f32_16x16x32_bf16 v[36:39], a[28:31], a[108:111], v[36:39]
s_cbranch_vccnz L_fs13_4
L_fr13_4:
ds_read_b64_tr_b16 a[94:95], v95 offset:45056
v_mfma_f32_16x16x32_bf16 v[40:43], a[0:3], a[112:115], v[76:79]
v_exp_f32 v30, v30
v_mfma_f32_16x16x32_bf16 v[40:43], a[4:7], a[116:119], v[40:43]
v_exp_f32 v31, v31
v_mfma_f32_16x16x32_bf16 v[40:43], a[8:11], a[120:123], v[40:43]
v_exp_f32 v32, v32
v_mfma_f32_16x16x32_bf16 v[40:43], a[12:15], a[124:127], v[40:43]
v_exp_f32 v33, v33
v_mfma_f32_16x16x32_bf16 v[44:47], a[16:19], a[112:115], v[76:79]
v_exp_f32 v34, v34
v_mfma_f32_16x16x32_bf16 v[44:47], a[20:23], a[116:119], v[44:47]
v_exp_f32 v35, v35
v_mfma_f32_16x16x32_bf16 v[44:47], a[24:27], a[120:123], v[44:47]
v_exp_f32 v36, v36
v_mfma_f32_16x16x32_bf16 v[44:47], a[28:31], a[124:127], v[44:47]
s_waitcnt lgkmcnt(0)
v_exp_f32 v37, v37
v_mfma_f32_16x16x32_bf16 v[128:131], a[64:67], v[48:51], v[128:131]
ds_read_b128 a[0:3], v84 offset:49152
v_cvt_pk_bf16_f32 v55, v30, v31
v_mfma_f32_16x16x32_bf16 v[132:135], a[68:71], v[48:51], v[132:135]
ds_read_b128 a[4:7], v85 offset:49152
v_cvt_pk_bf16_f32 v56, v32, v33
v_mfma_f32_16x16x32_bf16 v[136:139], a[72:75], v[48:51], v[136:139]
ds_read_b128 a[8:11], v86 offset:49152
v_cvt_pk_bf16_f32 v57, v34, v35
v_mfma_f32_16x16x32_bf16 v[140:143], a[76:79], v[48:51], v[140:143]
ds_read_b128 a[12:15], v87 offset:49152
v_cvt_pk_bf16_f32 v58, v36, v37
v_mfma_f32_16x16x32_bf16 v[144:147], a[80:83], v[48:51], v[144:147]
ds_read_b128 a[16:19], v84 offset:53248
v_mfma_f32_16x16x32_bf16 v[148:151], a[84:87], v[48:51], v[148:151]
ds_read_b128 a[20:23], v85 offset:53248
v_mfma_f32_16x16x32_bf16 v[152:155], a[88:91], v[48:51], v[152:155]
ds_read_b128 a[24:27], v86 offset:53248
v_mfma_f32_16x16x32_bf16 v[156:159], a[92:95], v[48:51], v[156:159]
ds_read_b128 a[28:31], v87 offset:53248
v_mfma_f32_16x16x32_bf16 v[108:111], v[124:127], v[48:51], v[108:111]
v_exp_f32 v38, v38
v_mfma_f32_16x16x32_bf16 v[160:163], a[64:67], v[52:55], v[160:163]
v_exp_f32 v39, v39
v_mfma_f32_16x16x32_bf16 v[164:167], a[68:71], v[52:55], v[164:167]
v_exp_f32 v40, v40
v_mfma_f32_16x16x32_bf16 v[168:171], a[72:75], v[52:55], v[168:171]
v_exp_f32 v41, v41
v_mfma_f32_16x16x32_bf16 v[172:175], a[76:79], v[52:55], v[172:175]
v_exp_f32 v42, v42
v_mfma_f32_16x16x32_bf16 v[176:179], a[80:83], v[52:55], v[176:179]
v_exp_f32 v43, v43
v_mfma_f32_16x16x32_bf16 v[180:183], a[84:87], v[52:55], v[180:183]
v_exp_f32 v44, v44
v_mfma_f32_16x16x32_bf16 v[184:187], a[88:91], v[52:55], v[184:187]
v_exp_f32 v45, v45
v_mfma_f32_16x16x32_bf16 v[188:191], a[92:95], v[52:55], v[188:191]
v_exp_f32 v46, v46
v_mfma_f32_16x16x32_bf16 v[112:115], v[124:127], v[52:55], v[112:115]
s_waitcnt lgkmcnt(0)
v_exp_f32 v47, v47
v_mfma_f32_16x16x32_bf16 v[16:19], a[0:3], a[32:35], v[64:67]
v_cvt_pk_bf16_f32 v59, v38, v39
v_cvt_pk_bf16_f32 v60, v40, v41
v_mfma_f32_16x16x32_bf16 v[16:19], a[4:7], a[36:39], v[16:19]
v_cvt_pk_bf16_f32 v61, v42, v43
v_cvt_pk_bf16_f32 v62, v44, v45
v_mfma_f32_16x16x32_bf16 v[16:19], a[8:11], a[40:43], v[16:19]
v_cvt_pk_bf16_f32 v63, v46, v47
v_mfma_f32_16x16x32_bf16 v[16:19], a[12:15], a[44:47], v[16:19]
v_mfma_f32_16x16x32_bf16 v[20:23], a[16:19], a[32:35], v[64:67]
v_mfma_f32_16x16x32_bf16 v[20:23], a[20:23], a[36:39], v[20:23]
v_mfma_f32_16x16x32_bf16 v[20:23], a[24:27], a[40:43], v[20:23]
v_mfma_f32_16x16x32_bf16 v[20:23], a[28:31], a[44:47], v[20:23]
v_mfma_f32_16x16x32_bf16 v[24:27], a[0:3], a[48:51], v[68:71]
v_mfma_f32_16x16x32_bf16 v[24:27], a[4:7], a[52:55], v[24:27]
s_nop 1
v_exp_f32 v16, v16
v_mfma_f32_16x16x32_bf16 v[24:27], a[8:11], a[56:59], v[24:27]
v_exp_f32 v17, v17
v_mfma_f32_16x16x32_bf16 v[24:27], a[12:15], a[60:63], v[24:27]
v_cvt_pk_bf16_f32 v48, v16, v17
v_mfma_f32_16x16x32_bf16 v[28:31], a[16:19], a[48:51], v[68:71]
v_exp_f32 v18, v18
v_mfma_f32_16x16x32_bf16 v[28:31], a[20:23], a[52:55], v[28:31]
v_exp_f32 v19, v19
v_mfma_f32_16x16x32_bf16 v[28:31], a[24:27], a[56:59], v[28:31]
v_exp_f32 v20, v20
v_mfma_f32_16x16x32_bf16 v[28:31], a[28:31], a[60:63], v[28:31]
v_exp_f32 v21, v21
v_mfma_f32_16x16x32_bf16 v[192:195], a[64:67], v[56:59], v[192:195]
v_exp_f32 v22, v22
v_mfma_f32_16x16x32_bf16 v[196:199], a[68:71], v[56:59], v[196:199]
v_cvt_pk_bf16_f32 v49, v18, v19
v_mfma_f32_16x16x32_bf16 v[200:203], a[72:75], v[56:59], v[200:203]
v_exp_f32 v23, v23
v_mfma_f32_16x16x32_bf16 v[204:207], a[76:79], v[56:59], v[204:207]
v_exp_f32 v24, v24
v_mfma_f32_16x16x32_bf16 v[208:211], a[80:83], v[56:59], v[208:211]
v_exp_f32 v25, v25
v_mfma_f32_16x16x32_bf16 v[212:215], a[84:87], v[56:59], v[212:215]
v_exp_f32 v26, v26
v_mfma_f32_16x16x32_bf16 v[216:219], a[88:91], v[56:59], v[216:219]
v_exp_f32 v27, v27
v_mfma_f32_16x16x32_bf16 v[220:223], a[92:95], v[56:59], v[220:223]
v_cvt_pk_bf16_f32 v50, v20, v21
v_mfma_f32_16x16x32_bf16 v[116:119], v[124:127], v[56:59], v[116:119]
v_exp_f32 v28, v28
v_mfma_f32_16x16x32_bf16 v[224:227], a[64:67], v[60:63], v[224:227]
v_exp_f32 v29, v29
v_mfma_f32_16x16x32_bf16 v[228:231], a[68:71], v[60:63], v[228:231]
ds_read_b64_tr_b16 a[64:65], v88 offset:49152
v_cvt_pk_bf16_f32 v51, v22, v23
v_mfma_f32_16x16x32_bf16 v[232:235], a[72:75], v[60:63], v[232:235]
ds_read_b64_tr_b16 a[66:67], v88 offset:53248
v_cvt_pk_bf16_f32 v52, v24, v25
v_mfma_f32_16x16x32_bf16 v[236:239], a[76:79], v[60:63], v[236:239]
ds_read_b64_tr_b16 a[68:69], v89 offset:49152
v_cvt_pk_bf16_f32 v53, v26, v27
v_mfma_f32_16x16x32_bf16 v[240:243], a[80:83], v[60:63], v[240:243]
ds_read_b64_tr_b16 a[70:71], v89 offset:53248
v_cvt_pk_bf16_f32 v54, v28, v29
v_mfma_f32_16x16x32_bf16 v[244:247], a[84:87], v[60:63], v[244:247]
ds_read_b64_tr_b16 a[72:73], v90 offset:49152
v_mfma_f32_16x16x32_bf16 v[248:251], a[88:91], v[60:63], v[248:251]
ds_read_b64_tr_b16 a[74:75], v90 offset:53248
v_mfma_f32_16x16x32_bf16 v[252:255], a[92:95], v[60:63], v[252:255]
ds_read_b64_tr_b16 a[76:77], v91 offset:49152
v_mfma_f32_16x16x32_bf16 v[120:123], v[124:127], v[60:63], v[120:123]
ds_read_b64_tr_b16 a[78:79], v91 offset:53248
v_mfma_f32_16x16x32_bf16 v[32:35], a[0:3], a[96:99], v[72:75]
ds_read_b64_tr_b16 a[80:81], v92 offset:49152
v_mfma_f32_16x16x32_bf16 v[32:35], a[4:7], a[100:103], v[32:35]
ds_read_b64_tr_b16 a[82:83], v92 offset:53248
v_mfma_f32_16x16x32_bf16 v[32:35], a[8:11], a[104:107], v[32:35]
ds_read_b64_tr_b16 a[84:85], v93 offset:49152
v_mfma_f32_16x16x32_bf16 v[32:35], a[12:15], a[108:111], v[32:35]
ds_read_b64_tr_b16 a[86:87], v93 offset:53248
v_mfma_f32_16x16x32_bf16 v[36:39], a[16:19], a[96:99], v[72:75]
ds_read_b64_tr_b16 a[88:89], v94 offset:49152
v_mfma_f32_16x16x32_bf16 v[36:39], a[20:23], a[100:103], v[36:39]
ds_read_b64_tr_b16 a[90:91], v94 offset:53248
v_mfma_f32_16x16x32_bf16 v[36:39], a[24:27], a[104:107], v[36:39]
ds_read_b64_tr_b16 a[92:93], v95 offset:49152
v_mfma_f32_16x16x32_bf16 v[36:39], a[28:31], a[108:111], v[36:39]
ds_read_b64_tr_b16 a[94:95], v95 offset:53248
v_mfma_f32_16x16x32_bf16 v[40:43], a[0:3], a[112:115], v[76:79]
v_exp_f32 v30, v30
v_mfma_f32_16x16x32_bf16 v[40:43], a[4:7], a[116:119], v[40:43]
v_exp_f32 v31, v31
v_mfma_f32_16x16x32_bf16 v[40:43], a[8:11], a[120:123], v[40:43]
v_exp_f32 v32, v32
v_mfma_f32_16x16x32_bf16 v[40:43], a[12:15], a[124:127], v[40:43]
v_exp_f32 v33, v33
v_mfma_f32_16x16x32_bf16 v[44:47], a[16:19], a[112:115], v[76:79]
v_exp_f32 v34, v34
v_mfma_f32_16x16x32_bf16 v[44:47], a[20:23], a[116:119], v[44:47]
v_exp_f32 v35, v35
v_mfma_f32_16x16x32_bf16 v[44:47], a[24:27], a[120:123], v[44:47]
v_exp_f32 v36, v36
v_mfma_f32_16x16x32_bf16 v[44:47], a[28:31], a[124:127], v[44:47]
s_waitcnt lgkmcnt(0)
v_exp_f32 v37, v37
v_mfma_f32_16x16x32_bf16 v[128:131], a[64:67], v[48:51], v[128:131]
ds_read_b128 a[0:3], v84 offset:57344
v_cvt_pk_bf16_f32 v55, v30, v31
v_mfma_f32_16x16x32_bf16 v[132:135], a[68:71], v[48:51], v[132:135]
ds_read_b128 a[4:7], v85 offset:57344
v_cvt_pk_bf16_f32 v56, v32, v33
v_mfma_f32_16x16x32_bf16 v[136:139], a[72:75], v[48:51], v[136:139]
ds_read_b128 a[8:11], v86 offset:57344
v_cvt_pk_bf16_f32 v57, v34, v35
v_mfma_f32_16x16x32_bf16 v[140:143], a[76:79], v[48:51], v[140:143]
ds_read_b128 a[12:15], v87 offset:57344
v_cvt_pk_bf16_f32 v58, v36, v37
v_mfma_f32_16x16x32_bf16 v[144:147], a[80:83], v[48:51], v[144:147]
ds_read_b128 a[16:19], v84 offset:61440
v_mfma_f32_16x16x32_bf16 v[148:151], a[84:87], v[48:51], v[148:151]
ds_read_b128 a[20:23], v85 offset:61440
v_mfma_f32_16x16x32_bf16 v[152:155], a[88:91], v[48:51], v[152:155]
ds_read_b128 a[24:27], v86 offset:61440
v_mfma_f32_16x16x32_bf16 v[156:159], a[92:95], v[48:51], v[156:159]
ds_read_b128 a[28:31], v87 offset:61440
v_mfma_f32_16x16x32_bf16 v[108:111], v[124:127], v[48:51], v[108:111]
v_exp_f32 v38, v38
v_mfma_f32_16x16x32_bf16 v[160:163], a[64:67], v[52:55], v[160:163]
v_exp_f32 v39, v39
v_mfma_f32_16x16x32_bf16 v[164:167], a[68:71], v[52:55], v[164:167]
v_exp_f32 v40, v40
v_mfma_f32_16x16x32_bf16 v[168:171], a[72:75], v[52:55], v[168:171]
v_exp_f32 v41, v41
v_mfma_f32_16x16x32_bf16 v[172:175], a[76:79], v[52:55], v[172:175]
v_exp_f32 v42, v42
v_mfma_f32_16x16x32_bf16 v[176:179], a[80:83], v[52:55], v[176:179]
v_exp_f32 v43, v43
v_mfma_f32_16x16x32_bf16 v[180:183], a[84:87], v[52:55], v[180:183]
v_exp_f32 v44, v44
v_mfma_f32_16x16x32_bf16 v[184:187], a[88:91], v[52:55], v[184:187]
v_exp_f32 v45, v45
v_mfma_f32_16x16x32_bf16 v[188:191], a[92:95], v[52:55], v[188:191]
v_exp_f32 v46, v46
v_mfma_f32_16x16x32_bf16 v[112:115], v[124:127], v[52:55], v[112:115]
s_waitcnt lgkmcnt(0)
v_exp_f32 v47, v47
v_mfma_f32_16x16x32_bf16 v[16:19], a[0:3], a[32:35], v[64:67]
v_cvt_pk_bf16_f32 v59, v38, v39
v_cvt_pk_bf16_f32 v60, v40, v41
v_mfma_f32_16x16x32_bf16 v[16:19], a[4:7], a[36:39], v[16:19]
v_cvt_pk_bf16_f32 v61, v42, v43
v_cvt_pk_bf16_f32 v62, v44, v45
v_mfma_f32_16x16x32_bf16 v[16:19], a[8:11], a[40:43], v[16:19]
v_cvt_pk_bf16_f32 v63, v46, v47
v_mfma_f32_16x16x32_bf16 v[16:19], a[12:15], a[44:47], v[16:19]
v_mfma_f32_16x16x32_bf16 v[20:23], a[16:19], a[32:35], v[64:67]
v_mfma_f32_16x16x32_bf16 v[20:23], a[20:23], a[36:39], v[20:23]
s_add_u32 s39, s39, 1
v_mfma_f32_16x16x32_bf16 v[20:23], a[24:27], a[40:43], v[20:23]
v_mov_b32 v80, s39
v_mfma_f32_16x16x32_bf16 v[20:23], a[28:31], a[44:47], v[20:23]
v_mfma_f32_16x16x32_bf16 v[24:27], a[0:3], a[48:51], v[68:71]
s_waitcnt vmcnt(63)
ds_write_b32 v1, v80
v_mfma_f32_16x16x32_bf16 v[24:27], a[4:7], a[52:55], v[24:27]
v_exp_f32 v16, v16
v_mfma_f32_16x16x32_bf16 v[24:27], a[8:11], a[56:59], v[24:27]
v_exp_f32 v17, v17
v_mfma_f32_16x16x32_bf16 v[24:27], a[12:15], a[60:63], v[24:27]
v_cvt_pk_bf16_f32 v48, v16, v17
v_mfma_f32_16x16x32_bf16 v[28:31], a[16:19], a[48:51], v[68:71]
v_exp_f32 v18, v18
v_mfma_f32_16x16x32_bf16 v[28:31], a[20:23], a[52:55], v[28:31]
v_exp_f32 v19, v19
v_mfma_f32_16x16x32_bf16 v[28:31], a[24:27], a[56:59], v[28:31]
v_exp_f32 v20, v20
v_mfma_f32_16x16x32_bf16 v[28:31], a[28:31], a[60:63], v[28:31]
v_exp_f32 v21, v21
v_mfma_f32_16x16x32_bf16 v[192:195], a[64:67], v[56:59], v[192:195]
v_exp_f32 v22, v22
v_mfma_f32_16x16x32_bf16 v[196:199], a[68:71], v[56:59], v[196:199]
v_cvt_pk_bf16_f32 v49, v18, v19
v_mfma_f32_16x16x32_bf16 v[200:203], a[72:75], v[56:59], v[200:203]
v_exp_f32 v23, v23
v_mfma_f32_16x16x32_bf16 v[204:207], a[76:79], v[56:59], v[204:207]
v_exp_f32 v24, v24
v_mfma_f32_16x16x32_bf16 v[208:211], a[80:83], v[56:59], v[208:211]
v_exp_f32 v25, v25
v_mfma_f32_16x16x32_bf16 v[212:215], a[84:87], v[56:59], v[212:215]
v_exp_f32 v26, v26
v_mfma_f32_16x16x32_bf16 v[216:219], a[88:91], v[56:59], v[216:219]
v_exp_f32 v27, v27
v_mfma_f32_16x16x32_bf16 v[220:223], a[92:95], v[56:59], v[220:223]
v_cvt_pk_bf16_f32 v50, v20, v21
v_mfma_f32_16x16x32_bf16 v[116:119], v[124:127], v[56:59], v[116:119]
v_exp_f32 v28, v28
v_mfma_f32_16x16x32_bf16 v[224:227], a[64:67], v[60:63], v[224:227]
v_exp_f32 v29, v29
v_mfma_f32_16x16x32_bf16 v[228:231], a[68:71], v[60:63], v[228:231]
ds_read_b64_tr_b16 a[64:65], v88 offset:57344
v_cvt_pk_bf16_f32 v51, v22, v23
v_mfma_f32_16x16x32_bf16 v[232:235], a[72:75], v[60:63], v[232:235]
ds_read_b64_tr_b16 a[66:67], v88 offset:61440
v_cvt_pk_bf16_f32 v52, v24, v25
v_mfma_f32_16x16x32_bf16 v[236:239], a[76:79], v[60:63], v[236:239]
ds_read_b64_tr_b16 a[68:69], v89 offset:57344
v_cvt_pk_bf16_f32 v53, v26, v27
v_mfma_f32_16x16x32_bf16 v[240:243], a[80:83], v[60:63], v[240:243]
ds_read_b64_tr_b16 a[70:71], v89 offset:61440
v_cvt_pk_bf16_f32 v54, v28, v29
v_mfma_f32_16x16x32_bf16 v[244:247], a[84:87], v[60:63], v[244:247]
ds_read_b64_tr_b16 a[72:73], v90 offset:57344
v_mfma_f32_16x16x32_bf16 v[248:251], a[88:91], v[60:63], v[248:251]
ds_read_b64_tr_b16 a[74:75], v90 offset:61440
v_mfma_f32_16x16x32_bf16 v[252:255], a[92:95], v[60:63], v[252:255]
ds_read_b64_tr_b16 a[76:77], v91 offset:57344
v_mfma_f32_16x16x32_bf16 v[120:123], v[124:127], v[60:63], v[120:123]
ds_read_b64_tr_b16 a[78:79], v91 offset:61440
v_mfma_f32_16x16x32_bf16 v[32:35], a[0:3], a[96:99], v[72:75]
ds_read_b64_tr_b16 a[80:81], v92 offset:57344
v_mfma_f32_16x16x32_bf16 v[32:35], a[4:7], a[100:103], v[32:35]
ds_read_b64_tr_b16 a[82:83], v92 offset:61440
ds_read_b128 v[80:83], v101
v_mfma_f32_16x16x32_bf16 v[32:35], a[8:11], a[104:107], v[32:35]
ds_read_b64_tr_b16 a[84:85], v93 offset:57344
v_mfma_f32_16x16x32_bf16 v[32:35], a[12:15], a[108:111], v[32:35]
ds_read_b64_tr_b16 a[86:87], v93 offset:61440
v_mfma_f32_16x16x32_bf16 v[36:39], a[16:19], a[96:99], v[72:75]
s_waitcnt lgkmcnt(2)
ds_read_b64_tr_b16 a[88:89], v94 offset:57344
v_min3_u32 v80, v80, v81, v82
v_mfma_f32_16x16x32_bf16 v[36:39], a[20:23], a[100:103], v[36:39]
ds_read_b64_tr_b16 a[90:91], v94 offset:61440
v_min_u32 v80, v80, v83
v_mfma_f32_16x16x32_bf16 v[36:39], a[24:27], a[104:107], v[36:39]
ds_read_b64_tr_b16 a[92:93], v95 offset:57344
v_cmp_gt_u32 vcc, s39, v80
v_mfma_f32_16x16x32_bf16 v[36:39], a[28:31], a[108:111], v[36:39]
s_cbranch_vccnz L_fs15_4
L_fr15_4:
ds_read_b64_tr_b16 a[94:95], v95 offset:61440
v_mfma_f32_16x16x32_bf16 v[40:43], a[0:3], a[112:115], v[76:79]
v_exp_f32 v30, v30
v_mfma_f32_16x16x32_bf16 v[40:43], a[4:7], a[116:119], v[40:43]
v_exp_f32 v31, v31
v_mfma_f32_16x16x32_bf16 v[40:43], a[8:11], a[120:123], v[40:43]
v_exp_f32 v32, v32
v_mfma_f32_16x16x32_bf16 v[40:43], a[12:15], a[124:127], v[40:43]
v_exp_f32 v33, v33
v_mfma_f32_16x16x32_bf16 v[44:47], a[16:19], a[112:115], v[76:79]
v_exp_f32 v34, v34
v_mfma_f32_16x16x32_bf16 v[44:47], a[20:23], a[116:119], v[44:47]
v_exp_f32 v35, v35
v_mfma_f32_16x16x32_bf16 v[44:47], a[24:27], a[120:123], v[44:47]
v_exp_f32 v36, v36
v_mfma_f32_16x16x32_bf16 v[44:47], a[28:31], a[124:127], v[44:47]
s_waitcnt lgkmcnt(0)
v_exp_f32 v37, v37
v_mfma_f32_16x16x32_bf16 v[128:131], a[64:67], v[48:51], v[128:131]
ds_read_b128 a[0:3], v84 offset:0
v_cvt_pk_bf16_f32 v55, v30, v31
v_mfma_f32_16x16x32_bf16 v[132:135], a[68:71], v[48:51], v[132:135]
ds_read_b128 a[4:7], v85 offset:0
v_cvt_pk_bf16_f32 v56, v32, v33
v_mfma_f32_16x16x32_bf16 v[136:139], a[72:75], v[48:51], v[136:139]
ds_read_b128 a[8:11], v86 offset:0
v_cvt_pk_bf16_f32 v57, v34, v35
v_mfma_f32_16x16x32_bf16 v[140:143], a[76:79], v[48:51], v[140:143]
ds_read_b128 a[12:15], v87 offset:0
v_cvt_pk_bf16_f32 v58, v36, v37
v_mfma_f32_16x16x32_bf16 v[144:147], a[80:83], v[48:51], v[144:147]
ds_read_b128 a[16:19], v84 offset:4096
v_mfma_f32_16x16x32_bf16 v[148:151], a[84:87], v[48:51], v[148:151]
ds_read_b128 a[20:23], v85 offset:4096
v_mfma_f32_16x16x32_bf16 v[152:155], a[88:91], v[48:51], v[152:155]
ds_read_b128 a[24:27], v86 offset:4096
v_mfma_f32_16x16x32_bf16 v[156:159], a[92:95], v[48:51], v[156:159]
ds_read_b128 a[28:31], v87 offset:4096
v_mfma_f32_16x16x32_bf16 v[108:111], v[124:127], v[48:51], v[108:111]
v_exp_f32 v38, v38
v_mfma_f32_16x16x32_bf16 v[160:163], a[64:67], v[52:55], v[160:163]
v_exp_f32 v39, v39
v_mfma_f32_16x16x32_bf16 v[164:167], a[68:71], v[52:55], v[164:167]
v_exp_f32 v40, v40
v_mfma_f32_16x16x32_bf16 v[168:171], a[72:75], v[52:55], v[168:171]
v_exp_f32 v41, v41
v_mfma_f32_16x16x32_bf16 v[172:175], a[76:79], v[52:55], v[172:175]
s_add_u32 s35, s35, 1
v_exp_f32 v42, v42
v_mfma_f32_16x16x32_bf16 v[176:179], a[80:83], v[52:55], v[176:179]
v_exp_f32 v43, v43
v_mfma_f32_16x16x32_bf16 v[180:183], a[84:87], v[52:55], v[180:183]
s_add_u32 s46, s35, s36
v_exp_f32 v44, v44
v_mfma_f32_16x16x32_bf16 v[184:187], a[88:91], v[52:55], v[184:187]
v_exp_f32 v45, v45
v_mfma_f32_16x16x32_bf16 v[188:191], a[92:95], v[52:55], v[188:191]
s_cmp_lt_u32 s46, 3
v_exp_f32 v46, v46
v_mfma_f32_16x16x32_bf16 v[112:115], v[124:127], v[52:55], v[112:115]
s_waitcnt lgkmcnt(0)
v_exp_f32 v47, v47
s_cbranch_scc1 L_at4
L_atx4:
s_cmp_lg_u32 s36, 0
s_cbranch_scc1 L_fin4
s_add_u32 s47, s34, 8192
s_nop 0
v_cvt_pk_bf16_f32 v59, v38, v39
s_nop 1
v_mfma_f32_16x16x32_bf16 v[192:195], a[64:67], v[56:59], v[192:195]
v_cvt_pk_bf16_f32 v60, v40, v41
v_cvt_pk_bf16_f32 v61, v42, v43
v_mfma_f32_16x16x32_bf16 v[196:199], a[68:71], v[56:59], v[196:199]
v_cvt_pk_bf16_f32 v62, v44, v45
v_cvt_pk_bf16_f32 v63, v46, v47
v_mfma_f32_16x16x32_bf16 v[200:203], a[72:75], v[56:59], v[200:203]
v_cmp_ngt_f32 vcc, 1317011456, v108
v_rcp_f32 v80, v108
v_mfma_f32_16x16x32_bf16 v[204:207], a[76:79], v[56:59], v[204:207]
s_nop 1
s_or_b32 s38, s38, vcc_lo
s_or_b32 s38, s38, vcc_hi
v_mfma_f32_16x16x32_bf16 v[208:211], a[80:83], v[56:59], v[208:211]
v_cmp_ngt_f32 vcc, 1317011456, v112
v_rcp_f32 v81, v112
v_mfma_f32_16x16x32_bf16 v[212:215], a[84:87], v[56:59], v[212:215]
s_nop 1
s_or_b32 s38, s38, vcc_lo
s_or_b32 s38, s38, vcc_hi
v_mfma_f32_16x16x32_bf16 v[216:219], a[88:91], v[56:59], v[216:219]
v_mul_f32 v128, v128, v80
v_mul_f32 v129, v129, v80
v_mfma_f32_16x16x32_bf16 v[220:223], a[92:95], v[56:59], v[220:223]
v_mul_f32 v130, v130, v80
v_mul_f32 v131, v131, v80
v_mfma_f32_16x16x32_bf16 v[116:119], v[124:127], v[56:59], v[116:119]
v_mul_f32 v132, v132, v80
v_mul_f32 v133, v133, v80
v_mfma_f32_16x16x32_bf16 v[224:227], a[64:67], v[60:63], v[224:227]
v_mul_f32 v134, v134, v80
v_mul_f32 v135, v135, v80
v_mfma_f32_16x16x32_bf16 v[228:231], a[68:71], v[60:63], v[228:231]
v_cvt_pk_bf16_f32 v48, v128, v129
v_cvt_pk_bf16_f32 v49, v130, v131
v_mfma_f32_16x16x32_bf16 v[232:235], a[72:75], v[60:63], v[232:235]
v_cvt_pk_bf16_f32 v50, v132, v133
v_cvt_pk_bf16_f32 v51, v134, v135
v_mfma_f32_16x16x32_bf16 v[236:239], a[76:79], v[60:63], v[236:239]
s_add_u32 s46, s43, 0
buffer_store_dwordx4 v[48:51], v100, s[20:23], s46 offen offset:0 sc1
v_mfma_f32_16x16x32_bf16 v[240:243], a[80:83], v[60:63], v[240:243]
v_mul_f32 v136, v136, v80
v_mul_f32 v137, v137, v80
v_mfma_f32_16x16x32_bf16 v[244:247], a[84:87], v[60:63], v[244:247]
v_mul_f32 v138, v138, v80
v_mul_f32 v139, v139, v80
v_mfma_f32_16x16x32_bf16 v[248:251], a[88:91], v[60:63], v[248:251]
v_mul_f32 v140, v140, v80
v_mul_f32 v141, v141, v80
v_mfma_f32_16x16x32_bf16 v[252:255], a[92:95], v[60:63], v[252:255]
v_mul_f32 v142, v142, v80
v_mul_f32 v143, v143, v80
v_mfma_f32_16x16x32_bf16 v[120:123], v[124:127], v[60:63], v[120:123]
v_cvt_pk_bf16_f32 v52, v136, v137
v_cvt_pk_bf16_f32 v53, v138, v139
s_waitcnt vmcnt(24)
v_cvt_pk_bf16_f32 v54, v140, v141
v_cmp_ngt_f32 vcc, 1317011456, v116
v_cvt_pk_bf16_f32 v55, v142, v143
s_add_u32 s46, s43, 122880
v_rcp_f32 v82, v116
buffer_store_dwordx4 v[52:55], v100, s[20:23], s46 offen offset:0 sc1
v_mul_f32 v144, v144, v80
s_or_b32 s38, s38, vcc_lo
v_mul_f32 v145, v145, v80
v_mul_f32 v146, v146, v80
s_or_b32 s38, s38, vcc_hi
v_mul_f32 v147, v147, v80
v_mul_f32 v148, v148, v80
v_cmp_ngt_f32 vcc, 1317011456, v120
v_mul_f32 v149, v149, v80
v_mul_f32 v150, v150, v80
v_rcp_f32 v83, v120
v_mul_f32 v151, v151, v80
v_cvt_pk_bf16_f32 v48, v144, v145
s_or_b32 s38, s38, vcc_lo
v_cvt_pk_bf16_f32 v49, v146, v147
v_cvt_pk_bf16_f32 v50, v148, v149
s_or_b32 s38, s38, vcc_hi
v_cvt_pk_bf16_f32 v51, v150, v151
s_add_u32 s46, s43, 245760
buffer_store_dwordx4 v[48:51], v100, s[20:23], s46 offen offset:0 sc1
v_mul_f32 v152, v152, v80
v_mul_f32 v153, v153, v80
v_mul_f32 v154, v154, v80
v_mul_f32 v155, v155, v80
v_mul_f32 v156, v156, v80
v_mul_f32 v157, v157, v80
v_mul_f32 v158, v158, v80
v_mul_f32 v159, v159, v80
v_cvt_pk_bf16_f32 v52, v152, v153
v_cvt_pk_bf16_f32 v53, v154, v155
v_cvt_pk_bf16_f32 v54, v156, v157
v_cvt_pk_bf16_f32 v55, v158, v159
s_add_u32 s46, s43, 368640
buffer_store_dwordx4 v[52:55], v100, s[20:23], s46 offen offset:0 sc1
v_accvgpr_mov_b32 a32, a128
v_accvgpr_mov_b32 a33, a129
v_accvgpr_mov_b32 a34, a130
v_accvgpr_mov_b32 a35, a131
v_accvgpr_mov_b32 a36, a132
v_accvgpr_mov_b32 a37, a133
v_accvgpr_mov_b32 a38, a134
v_accvgpr_mov_b32 a39, a135
v_accvgpr_mov_b32 a40, a136
v_accvgpr_mov_b32 a41, a137
v_accvgpr_mov_b32 a42, a138
v_accvgpr_mov_b32 a43, a139
v_accvgpr_mov_b32 a44, a140
v_accvgpr_mov_b32 a45, a141
v_accvgpr_mov_b32 a46, a142
v_accvgpr_mov_b32 a47, a143
v_accvgpr_mov_b32 a48, a144
v_accvgpr_mov_b32 a49, a145
v_accvgpr_mov_b32 a50, a146
v_accvgpr_mov_b32 a51, a147
v_accvgpr_mov_b32 a52, a148
v_accvgpr_mov_b32 a53, a149
v_accvgpr_mov_b32 a54, a150
v_accvgpr_mov_b32 a55, a151
v_accvgpr_mov_b32 a56, a152
v_accvgpr_mov_b32 a57, a153
v_accvgpr_mov_b32 a58, a154
v_accvgpr_mov_b32 a59, a155
v_accvgpr_mov_b32 a60, a156
v_accvgpr_mov_b32 a61, a157
v_accvgpr_mov_b32 a62, a158
v_accvgpr_mov_b32 a63, a159
v_accvgpr_mov_b32 a96, a160
v_accvgpr_mov_b32 a97, a161
v_accvgpr_mov_b32 a98, a162
v_accvgpr_mov_b32 a99, a163
v_accvgpr_mov_b32 a100, a164
v_accvgpr_mov_b32 a101, a165
v_accvgpr_mov_b32 a102, a166
v_accvgpr_mov_b32 a103, a167
v_accvgpr_mov_b32 a104, a168
v_accvgpr_mov_b32 a105, a169
v_accvgpr_mov_b32 a106, a170
v_accvgpr_mov_b32 a107, a171
v_accvgpr_mov_b32 a108, a172
v_accvgpr_mov_b32 a109, a173
v_accvgpr_mov_b32 a110, a174
v_accvgpr_mov_b32 a111, a175
v_accvgpr_mov_b32 a112, a176
v_accvgpr_mov_b32 a113, a177
v_accvgpr_mov_b32 a114, a178
v_accvgpr_mov_b32 a115, a179
v_accvgpr_mov_b32 a116, a180
v_accvgpr_mov_b32 a117, a181
v_accvgpr_mov_b32 a118, a182
v_accvgpr_mov_b32 a119, a183
v_accvgpr_mov_b32 a120, a184
v_accvgpr_mov_b32 a121, a185
v_accvgpr_mov_b32 a122, a186
v_accvgpr_mov_b32 a123, a187
v_accvgpr_mov_b32 a124, a188
v_accvgpr_mov_b32 a125, a189
v_accvgpr_mov_b32 a126, a190
v_accvgpr_mov_b32 a127, a191
v_mfma_f32_16x16x32_bf16 v[16:19], a[0:3], a[32:35], 0
v_mul_f32 v160, v160, v81
v_mul_f32 v161, v161, v81
v_mul_f32 v162, v162, v81
v_mfma_f32_16x16x32_bf16 v[16:19], a[4:7], a[36:39], v[16:19]
v_mul_f32 v163, v163, v81
v_mul_f32 v164, v164, v81
v_mul_f32 v165, v165, v81
v_mfma_f32_16x16x32_bf16 v[16:19], a[8:11], a[40:43], v[16:19]
v_mul_f32 v166, v166, v81
v_mul_f32 v167, v167, v81
v_cvt_pk_bf16_f32 v48, v160, v161
v_mfma_f32_16x16x32_bf16 v[16:19], a[12:15], a[44:47], v[16:19]
v_cvt_pk_bf16_f32 v49, v162, v163
v_cvt_pk_bf16_f32 v50, v164, v165
v_cvt_pk_bf16_f32 v51, v166, v167
v_mfma_f32_16x16x32_bf16 v[24:27], a[0:3], a[48:51], 0
s_add_u32 s46, s43, 0
buffer_store_dwordx4 v[48:51], v100, s[20:23], s46 offen offset:1024 sc1
v_mul_f32 v168, v168, v81
v_mfma_f32_16x16x32_bf16 v[24:27], a[4:7], a[52:55], v[24:27]
v_mul_f32 v169, v169, v81
v_mul_f32 v170, v170, v81
v_mul_f32 v171, v171, v81
v_mfma_f32_16x16x32_bf16 v[24:27], a[8:11], a[56:59], v[24:27]
v_mul_f32 v172, v172, v81
v_mul_f32 v173, v173, v81
v_mul_f32 v174, v174, v81
v_mfma_f32_16x16x32_bf16 v[24:27], a[12:15], a[60:63], v[24:27]
v_mul_f32 v175, v175, v81
v_cvt_pk_bf16_f32 v52, v168, v169
v_cvt_pk_bf16_f32 v53, v170, v171
v_mfma_f32_16x16x32_bf16 v[32:35], a[0:3], a[96:99], 0
v_cvt_pk_bf16_f32 v54, v172, v173
v_cvt_pk_bf16_f32 v55, v174, v175
s_add_u32 s46, s43, 122880
v_mfma_f32_16x16x32_bf16 v[32:35], a[4:7], a[100:103], v[32:35]
buffer_store_dwordx4 v[52:55], v100, s[20:23], s46 offen offset:1024 sc1
v_mul_f32 v176, v176, v81
v_mul_f32 v177, v177, v81
v_mfma_f32_16x16x32_bf16 v[32:35], a[8:11], a[104:107], v[32:35]
v_mul_f32 v178, v178, v81
v_mul_f32 v179, v179, v81
v_mul_f32 v180, v180, v81
v_mfma_f32_16x16x32_bf16 v[32:35], a[12:15], a[108:111], v[32:35]
v_mul_f32 v181, v181, v81
v_mul_f32 v182, v182, v81
v_mul_f32 v183, v183, v81
v_mfma_f32_16x16x32_bf16 v[40:43], a[0:3], a[112:115], 0
v_cvt_pk_bf16_f32 v48, v176, v177
v_cvt_pk_bf16_f32 v49, v178, v179
v_cvt_pk_bf16_f32 v50, v180, v181
v_mfma_f32_16x16x32_bf16 v[40:43], a[4:7], a[116:119], v[40:43]
v_cvt_pk_bf16_f32 v51, v182, v183
s_add_u32 s46, s43, 245760
buffer_store_dwordx4 v[48:51], v100, s[20:23], s46 offen offset:1024 sc1
v_mfma_f32_16x16x32_bf16 v[40:43], a[8:11], a[120:123], v[40:43]
v_mul_f32 v184, v184, v81
v_mul_f32 v185, v185, v81
v_mul_f32 v186, v186, v81
v_mfma_f32_16x16x32_bf16 v[40:43], a[12:15], a[124:127], v[40:43]
v_mul_f32 v187, v187, v81
v_mul_f32 v188, v188, v81
v_mul_f32 v189, v189, v81
v_mul_f32 v190, v190, v81
v_mul_f32 v191, v191, v81
v_cvt_pk_bf16_f32 v52, v184, v185
v_cvt_pk_bf16_f32 v53, v186, v187
v_cvt_pk_bf16_f32 v54, v188, v189
v_cvt_pk_bf16_f32 v55, v190, v191
s_add_u32 s46, s43, 368640
buffer_store_dwordx4 v[52:55], v100, s[20:23], s46 offen offset:1024 sc1
v_max3_f32 v16, v16, v17, v18
v_max3_f32 v24, v24, v25, v26
v_max3_f32 v32, v32, v33, v34
v_max3_f32 v40, v40, v41, v42
v_max_f32 v16, v16, v19
v_max_f32 v24, v24, v27
v_max_f32 v32, v32, v35
v_max_f32 v40, v40, v43
v_mov_b32 v108, v16
v_mov_b32 v109, v24
v_mov_b32 v110, v32
v_mov_b32 v111, v40
v_permlane32_swap_b32 v16, v108
v_permlane32_swap_b32 v24, v109
v_permlane32_swap_b32 v32, v110
v_permlane32_swap_b32 v40, v111
v_max_f32 v16, v16, v108
v_max_f32 v24, v24, v109
v_max_f32 v32, v32, v110
v_max_f32 v40, v40, v111
v_mov_b32 v108, v16
v_mov_b32 v109, v24
v_mov_b32 v110, v32
v_mov_b32 v111, v40
v_permlane16_swap_b32 v16, v108
v_permlane16_swap_b32 v24, v109
v_permlane16_swap_b32 v32, v110
v_permlane16_swap_b32 v40, v111
v_max_f32 v16, v16, v108
v_max_f32 v24, v24, v109
v_max_f32 v32, v32, v110
v_max_f32 v40, v40, v111
v_sub_f32 v64, 0, v16
v_sub_f32 v65, 0, v16
v_sub_f32 v66, 0, v16
v_sub_f32 v67, 0, v16
v_sub_f32 v68, 0, v24
v_sub_f32 v69, 0, v24
v_sub_f32 v70, 0, v24
v_sub_f32 v71, 0, v24
v_sub_f32 v72, 0, v32
v_sub_f32 v73, 0, v32
v_sub_f32 v74, 0, v32
v_sub_f32 v75, 0, v32
v_sub_f32 v76, 0, v40
v_sub_f32 v77, 0, v40
v_sub_f32 v78, 0, v40
v_sub_f32 v79, 0, v40
v_mov_b32 v4, s38
s_lshl_b32 s46, s32, 2
s_add_u32 s46, s46, 138240
v_mov_b32 v5, s46
ds_write_b32 v5, v4
s_mov_b32 s41, s43
s_add_u32 s43, s43, 491520
s_mov_b32 s36, 1
s_cmp_lg_u32 s37, 0
s_cbranch_scc1 L_maxpass4
L_maxdone14:
v_mfma_f32_16x16x32_bf16 v[16:19], a[0:3], a[32:35], v[64:67]
v_mul_f32 v192, v192, v82
v_mul_f32 v193, v193, v82
v_mul_f32 v194, v194, v82
v_mul_f32 v195, v195, v82
v_mfma_f32_16x16x32_bf16 v[16:19], a[4:7], a[36:39], v[16:19]
v_mul_f32 v196, v196, v82
v_mul_f32 v197, v197, v82
v_mul_f32 v198, v198, v82
v_mfma_f32_16x16x32_bf16 v[16:19], a[8:11], a[40:43], v[16:19]
v_mul_f32 v199, v199, v82
v_cvt_pk_bf16_f32 v192, v192, v193
v_cvt_pk_bf16_f32 v193, v194, v195
v_mfma_f32_16x16x32_bf16 v[16:19], a[12:15], a[44:47], v[16:19]
v_cvt_pk_bf16_f32 v194, v196, v197
v_cvt_pk_bf16_f32 v195, v198, v199
s_add_u32 s47, s41, 0
buffer_store_dwordx4 v[192:195], v100, s[20:23], s47 offen offset:2048 sc1
v_mul_f32 v200, v200, v82
v_mul_f32 v201, v201, v82
v_mfma_f32_16x16x32_bf16 v[20:23], a[16:19], a[32:35], v[64:67]
v_mul_f32 v202, v202, v82
v_mul_f32 v203, v203, v82
v_mul_f32 v204, v204, v82
v_mfma_f32_16x16x32_bf16 v[20:23], a[20:23], a[36:39], v[20:23]
v_mul_f32 v205, v205, v82
v_mul_f32 v206, v206, v82
v_mul_f32 v207, v207, v82
v_mfma_f32_16x16x32_bf16 v[20:23], a[24:27], a[40:43], v[20:23]
v_cvt_pk_bf16_f32 v200, v200, v201
v_cvt_pk_bf16_f32 v201, v202, v203
v_cvt_pk_bf16_f32 v202, v204, v205
v_cvt_pk_bf16_f32 v203, v206, v207
s_add_u32 s47, s41, 122880
buffer_store_dwordx4 v[200:203], v100, s[20:23], s47 offen offset:2048 sc1
v_mfma_f32_16x16x32_bf16 v[20:23], a[28:31], a[44:47], v[20:23]
v_mul_f32 v208, v208, v82
v_mul_f32 v209, v209, v82
v_mul_f32 v210, v210, v82
v_mfma_f32_16x16x32_bf16 v[24:27], a[0:3], a[48:51], v[68:71]
v_mul_f32 v211, v211, v82
v_mul_f32 v212, v212, v82
v_mul_f32 v213, v213, v82
v_mfma_f32_16x16x32_bf16 v[24:27], a[4:7], a[52:55], v[24:27]
v_exp_f32 v16, v16
v_mul_f32 v214, v214, v82
v_mfma_f32_16x16x32_bf16 v[24:27], a[8:11], a[56:59], v[24:27]
v_exp_f32 v17, v17
v_mul_f32 v215, v215, v82
v_cvt_pk_bf16_f32 v208, v208, v209
v_mfma_f32_16x16x32_bf16 v[24:27], a[12:15], a[60:63], v[24:27]
v_cvt_pk_bf16_f32 v48, v16, v17
v_cvt_pk_bf16_f32 v209, v210, v211
v_cvt_pk_bf16_f32 v210, v212, v213
v_mfma_f32_16x16x32_bf16 v[28:31], a[16:19], a[48:51], v[68:71]
v_exp_f32 v18, v18
v_cvt_pk_bf16_f32 v211, v214, v215
s_add_u32 s47, s41, 245760
buffer_store_dwordx4 v[208:211], v100, s[20:23], s47 offen offset:2048 sc1
v_mfma_f32_16x16x32_bf16 v[28:31], a[20:23], a[52:55], v[28:31]
v_exp_f32 v19, v19
v_mul_f32 v216, v216, v82
v_mul_f32 v217, v217, v82
v_mfma_f32_16x16x32_bf16 v[28:31], a[24:27], a[56:59], v[28:31]
v_exp_f32 v20, v20
v_mul_f32 v218, v218, v82
v_mfma_f32_16x16x32_bf16 v[28:31], a[28:31], a[60:63], v[28:31]
v_exp_f32 v21, v21
v_mul_f32 v219, v219, v82
v_exp_f32 v22, v22
v_cvt_pk_bf16_f32 v49, v18, v19
v_exp_f32 v23, v23
v_exp_f32 v24, v24
v_exp_f32 v25, v25
v_exp_f32 v26, v26
v_exp_f32 v27, v27
v_cvt_pk_bf16_f32 v50, v20, v21
v_exp_f32 v28, v28
v_exp_f32 v29, v29
ds_read_b64_tr_b16 a[64:65], v88 offset:0
v_cvt_pk_bf16_f32 v51, v22, v23
ds_read_b64_tr_b16 a[66:67], v88 offset:4096
v_cvt_pk_bf16_f32 v52, v24, v25
ds_read_b64_tr_b16 a[68:69], v89 offset:0
v_cvt_pk_bf16_f32 v53, v26, v27
ds_read_b64_tr_b16 a[70:71], v89 offset:4096
v_cvt_pk_bf16_f32 v54, v28, v29
ds_read_b64_tr_b16 a[72:73], v90 offset:0
ds_read_b64_tr_b16 a[74:75], v90 offset:4096
ds_read_b64_tr_b16 a[76:77], v91 offset:0
ds_read_b64_tr_b16 a[78:79], v91 offset:4096
v_mfma_f32_16x16x32_bf16 v[32:35], a[0:3], a[96:99], v[72:75]
ds_read_b64_tr_b16 a[80:81], v92 offset:0
v_mul_f32 v220, v220, v82
v_mul_f32 v221, v221, v82
v_mul_f32 v222, v222, v82
v_mfma_f32_16x16x32_bf16 v[32:35], a[4:7], a[100:103], v[32:35]
ds_read_b64_tr_b16 a[82:83], v92 offset:4096
v_mul_f32 v223, v223, v82
v_cvt_pk_bf16_f32 v216, v216, v217
v_mfma_f32_16x16x32_bf16 v[32:35], a[8:11], a[104:107], v[32:35]
ds_read_b64_tr_b16 a[84:85], v93 offset:0
v_cvt_pk_bf16_f32 v217, v218, v219
v_cvt_pk_bf16_f32 v218, v220, v221
v_mfma_f32_16x16x32_bf16 v[32:35], a[12:15], a[108:111], v[32:35]
ds_read_b64_tr_b16 a[86:87], v93 offset:4096
v_cvt_pk_bf16_f32 v219, v222, v223
s_add_u32 s47, s41, 368640
buffer_store_dwordx4 v[216:219], v100, s[20:23], s47 offen offset:2048 sc1
v_mul_f32 v224, v224, v83
v_mfma_f32_16x16x32_bf16 v[36:39], a[16:19], a[96:99], v[72:75]
ds_read_b64_tr_b16 a[88:89], v94 offset:0
v_mul_f32 v225, v225, v83
v_mul_f32 v226, v226, v83
v_mul_f32 v227, v227, v83
v_mfma_f32_16x16x32_bf16 v[36:39], a[20:23], a[100:103], v[36:39]
ds_read_b64_tr_b16 a[90:91], v94 offset:4096
v_mul_f32 v228, v228, v83
v_mul_f32 v229, v229, v83
v_mfma_f32_16x16x32_bf16 v[36:39], a[24:27], a[104:107], v[36:39]
ds_read_b64_tr_b16 a[92:93], v95 offset:0
v_mul_f32 v230, v230, v83
v_mul_f32 v231, v231, v83
v_mfma_f32_16x16x32_bf16 v[36:39], a[28:31], a[108:111], v[36:39]
ds_read_b64_tr_b16 a[94:95], v95 offset:4096
v_cvt_pk_bf16_f32 v224, v224, v225
v_cvt_pk_bf16_f32 v225, v226, v227
v_cvt_pk_bf16_f32 v226, v228, v229
v_mfma_f32_16x16x32_bf16 v[40:43], a[0:3], a[112:115], v[76:79]
v_exp_f32 v30, v30
v_cvt_pk_bf16_f32 v227, v230, v231
s_add_u32 s47, s41, 0
buffer_store_dwordx4 v[224:227], v100, s[20:23], s47 offen offset:3072 sc1
v_mfma_f32_16x16x32_bf16 v[40:43], a[4:7], a[116:119], v[40:43]
v_exp_f32 v31, v31
v_mul_f32 v232, v232, v83
v_mfma_f32_16x16x32_bf16 v[40:43], a[8:11], a[120:123], v[40:43]
v_exp_f32 v32, v32
v_mul_f32 v233, v233, v83
v_mul_f32 v234, v234, v83
v_mfma_f32_16x16x32_bf16 v[40:43], a[12:15], a[124:127], v[40:43]
v_exp_f32 v33, v33
v_mul_f32 v235, v235, v83
v_mfma_f32_16x16x32_bf16 v[44:47], a[16:19], a[112:115], v[76:79]
v_exp_f32 v34, v34
v_mul_f32 v236, v236, v83
v_mfma_f32_16x16x32_bf16 v[44:47], a[20:23], a[116:119], v[44:47]
v_exp_f32 v35, v35
v_mul_f32 v237, v237, v83
v_mfma_f32_16x16x32_bf16 v[44:47], a[24:27], a[120:123], v[44:47]
v_exp_f32 v36, v36
v_mul_f32 v238, v238, v83
v_mul_f32 v239, v239, v83
v_mfma_f32_16x16x32_bf16 v[44:47], a[28:31], a[124:127], v[44:47]
s_waitcnt lgkmcnt(0)
v_exp_f32 v37, v37
v_cvt_pk_bf16_f32 v232, v232, v233
v_mfma_f32_16x16x32_bf16 v[128:131], a[64:67], v[48:51], 0
ds_read_b128 a[0:3], v84 offset:8192
v_cvt_pk_bf16_f32 v55, v30, v31
v_cvt_pk_bf16_f32 v233, v234, v235
v_mfma_f32_16x16x32_bf16 v[132:135], a[68:71], v[48:51], 0
ds_read_b128 a[4:7], v85 offset:8192
v_cvt_pk_bf16_f32 v56, v32, v33
v_cvt_pk_bf16_f32 v234, v236, v237
v_cvt_pk_bf16_f32 v235, v238, v239
s_add_u32 s47, s41, 122880
buffer_store_dwordx4 v[232:235], v100, s[20:23], s47 offen offset:3072 sc1
v_mfma_f32_16x16x32_bf16 v[136:139], a[72:75], v[48:51], 0
ds_read_b128 a[8:11], v86 offset:8192
v_cvt_pk_bf16_f32 v57, v34, v35
v_mul_f32 v240, v240, v83
v_mfma_f32_16x16x32_bf16 v[140:143], a[76:79], v[48:51], 0
ds_read_b128 a[12:15], v87 offset:8192
v_cvt_pk_bf16_f32 v58, v36, v37
v_mul_f32 v241, v241, v83
v_mfma_f32_16x16x32_bf16 v[144:147], a[80:83], v[48:51], 0
ds_read_b128 a[16:19], v84 offset:12288
v_mul_f32 v242, v242, v83
v_mul_f32 v243, v243, v83
v_mul_f32 v244, v244, v83
v_mfma_f32_16x16x32_bf16 v[148:151], a[84:87], v[48:51], 0
ds_read_b128 a[20:23], v85 offset:12288
v_mul_f32 v245, v245, v83
v_mul_f32 v246, v246, v83
v_mfma_f32_16x16x32_bf16 v[152:155], a[88:91], v[48:51], 0
ds_read_b128 a[24:27], v86 offset:12288
v_mul_f32 v247, v247, v83
v_cvt_pk_bf16_f32 v240, v240, v241
v_mfma_f32_16x16x32_bf16 v[156:159], a[92:95], v[48:51], 0
ds_read_b128 a[28:31], v87 offset:12288
v_cvt_pk_bf16_f32 v241, v242, v243
v_cvt_pk_bf16_f32 v242, v244, v245
v_mfma_f32_16x16x32_bf16 v[108:111], v[124:127], v[48:51], 0
v_exp_f32 v38, v38
v_cvt_pk_bf16_f32 v243, v246, v247
s_add_u32 s47, s41, 245760
buffer_store_dwordx4 v[240:243], v100, s[20:23], s47 offen offset:3072 sc1
v_mul_f32 v248, v248, v83
v_mfma_f32_16x16x32_bf16 v[160:163], a[64:67], v[52:55], 0
v_exp_f32 v39, v39
v_mul_f32 v249, v249, v83
v_mfma_f32_16x16x32_bf16 v[164:167], a[68:71], v[52:55], 0
v_exp_f32 v40, v40
v_mul_f32 v250, v250, v83
v_mfma_f32_16x16x32_bf16 v[168:171], a[72:75], v[52:55], 0
v_exp_f32 v41, v41
v_mul_f32 v251, v251, v83
v_mul_f32 v252, v252, v83
v_mfma_f32_16x16x32_bf16 v[172:175], a[76:79], v[52:55], 0
v_exp_f32 v42, v42
v_mul_f32 v253, v253, v83
v_mfma_f32_16x16x32_bf16 v[176:179], a[80:83], v[52:55], 0
v_exp_f32 v43, v43
v_mul_f32 v254, v254, v83
v_mfma_f32_16x16x32_bf16 v[180:183], a[84:87], v[52:55], 0
v_exp_f32 v44, v44
v_mul_f32 v255, v255, v83
v_cvt_pk_bf16_f32 v248, v248, v249
v_mfma_f32_16x16x32_bf16 v[184:187], a[88:91], v[52:55], 0
v_exp_f32 v45, v45
v_cvt_pk_bf16_f32 v249, v250, v251
v_mfma_f32_16x16x32_bf16 v[188:191], a[92:95], v[52:55], 0
v_exp_f32 v46, v46
v_cvt_pk_bf16_f32 v250, v252, v253
v_mfma_f32_16x16x32_bf16 v[112:115], v[124:127], v[52:55], 0
s_waitcnt lgkmcnt(0)
v_exp_f32 v47, v47
v_cvt_pk_bf16_f32 v251, v254, v255
s_add_u32 s47, s41, 368640
buffer_store_dwordx4 v[248:251], v100, s[20:23], s47 offen offset:3072 sc1
v_mfma_f32_16x16x32_bf16 v[16:19], a[0:3], a[32:35], v[64:67]
v_cvt_pk_bf16_f32 v59, v38, v39
v_cvt_pk_bf16_f32 v60, v40, v41
v_mfma_f32_16x16x32_bf16 v[16:19], a[4:7], a[36:39], v[16:19]
v_cvt_pk_bf16_f32 v61, v42, v43
v_cvt_pk_bf16_f32 v62, v44, v45
v_mfma_f32_16x16x32_bf16 v[16:19], a[8:11], a[40:43], v[16:19]
v_cvt_pk_bf16_f32 v63, v46, v47
v_mfma_f32_16x16x32_bf16 v[16:19], a[12:15], a[44:47], v[16:19]
v_mfma_f32_16x16x32_bf16 v[20:23], a[16:19], a[32:35], v[64:67]
v_mfma_f32_16x16x32_bf16 v[20:23], a[20:23], a[36:39], v[20:23]
s_add_u32 s39, s39, 1
v_mfma_f32_16x16x32_bf16 v[20:23], a[24:27], a[40:43], v[20:23]
v_mov_b32 v80, s39
v_mfma_f32_16x16x32_bf16 v[20:23], a[28:31], a[44:47], v[20:23]
v_mfma_f32_16x16x32_bf16 v[24:27], a[0:3], a[48:51], v[68:71]
s_waitcnt vmcnt(63)
ds_write_b32 v1, v80
v_mfma_f32_16x16x32_bf16 v[24:27], a[4:7], a[52:55], v[24:27]
v_exp_f32 v16, v16
v_mfma_f32_16x16x32_bf16 v[24:27], a[8:11], a[56:59], v[24:27]
v_exp_f32 v17, v17
v_mfma_f32_16x16x32_bf16 v[24:27], a[12:15], a[60:63], v[24:27]
v_cvt_pk_bf16_f32 v48, v16, v17
v_mfma_f32_16x16x32_bf16 v[28:31], a[16:19], a[48:51], v[68:71]
v_exp_f32 v18, v18
v_mfma_f32_16x16x32_bf16 v[28:31], a[20:23], a[52:55], v[28:31]
v_exp_f32 v19, v19
v_mfma_f32_16x16x32_bf16 v[28:31], a[24:27], a[56:59], v[28:31]
v_exp_f32 v20, v20
v_mfma_f32_16x16x32_bf16 v[28:31], a[28:31], a[60:63], v[28:31]
v_exp_f32 v21, v21
v_mfma_f32_16x16x32_bf16 v[192:195], a[64:67], v[56:59], 0
v_exp_f32 v22, v22
v_mfma_f32_16x16x32_bf16 v[196:199], a[68:71], v[56:59], 0
v_cvt_pk_bf16_f32 v49, v18, v19
v_mfma_f32_16x16x32_bf16 v[200:203], a[72:75], v[56:59], 0
v_exp_f32 v23, v23
v_mfma_f32_16x16x32_bf16 v[204:207], a[76:79], v[56:59], 0
v_exp_f32 v24, v24
v_mfma_f32_16x16x32_bf16 v[208:211], a[80:83], v[56:59], 0
v_exp_f32 v25, v25
v_mfma_f32_16x16x32_bf16 v[212:215], a[84:87], v[56:59], 0
v_exp_f32 v26, v26
v_mfma_f32_16x16x32_bf16 v[216:219], a[88:91], v[56:59], 0
v_exp_f32 v27, v27
v_mfma_f32_16x16x32_bf16 v[220:223], a[92:95], v[56:59], 0
v_cvt_pk_bf16_f32 v50, v20, v21
v_mfma_f32_16x16x32_bf16 v[116:119], v[124:127], v[56:59], 0
v_exp_f32 v28, v28
v_mfma_f32_16x16x32_bf16 v[224:227], a[64:67], v[60:63], 0
v_exp_f32 v29, v29
v_mfma_f32_16x16x32_bf16 v[228:231], a[68:71], v[60:63], 0
ds_read_b64_tr_b16 a[64:65], v88 offset:8192
v_cvt_pk_bf16_f32 v51, v22, v23
v_mfma_f32_16x16x32_bf16 v[232:235], a[72:75], v[60:63], 0
ds_read_b64_tr_b16 a[66:67], v88 offset:12288
v_cvt_pk_bf16_f32 v52, v24, v25
v_mfma_f32_16x16x32_bf16 v[236:239], a[76:79], v[60:63], 0
ds_read_b64_tr_b16 a[68:69], v89 offset:8192
v_cvt_pk_bf16_f32 v53, v26, v27
v_mfma_f32_16x16x32_bf16 v[240:243], a[80:83], v[60:63], 0
ds_read_b64_tr_b16 a[70:71], v89 offset:12288
v_cvt_pk_bf16_f32 v54, v28, v29
v_mfma_f32_16x16x32_bf16 v[244:247], a[84:87], v[60:63], 0
ds_read_b64_tr_b16 a[72:73], v90 offset:8192
v_mfma_f32_16x16x32_bf16 v[248:251], a[88:91], v[60:63], 0
ds_read_b64_tr_b16 a[74:75], v90 offset:12288
v_mfma_f32_16x16x32_bf16 v[252:255], a[92:95], v[60:63], 0
ds_read_b64_tr_b16 a[76:77], v91 offset:8192
v_mfma_f32_16x16x32_bf16 v[120:123], v[124:127], v[60:63], 0
ds_read_b64_tr_b16 a[78:79], v91 offset:12288
v_mfma_f32_16x16x32_bf16 v[32:35], a[0:3], a[96:99], v[72:75]
ds_read_b64_tr_b16 a[80:81], v92 offset:8192
v_mfma_f32_16x16x32_bf16 v[32:35], a[4:7], a[100:103], v[32:35]
ds_read_b64_tr_b16 a[82:83], v92 offset:12288
ds_read_b128 v[80:83], v101
v_mfma_f32_16x16x32_bf16 v[32:35], a[8:11], a[104:107], v[32:35]
ds_read_b64_tr_b16 a[84:85], v93 offset:8192
v_mfma_f32_16x16x32_bf16 v[32:35], a[12:15], a[108:111], v[32:35]
ds_read_b64_tr_b16 a[86:87], v93 offset:12288
v_mfma_f32_16x16x32_bf16 v[36:39], a[16:19], a[96:99], v[72:75]
s_waitcnt lgkmcnt(2)
ds_read_b64_tr_b16 a[88:89], v94 offset:8192
v_min3_u32 v80, v80, v81, v82
v_mfma_f32_16x16x32_bf16 v[36:39], a[20:23], a[100:103], v[36:39]
ds_read_b64_tr_b16 a[90:91], v94 offset:12288
v_min_u32 v80, v80, v83
v_mfma_f32_16x16x32_bf16 v[36:39], a[24:27], a[104:107], v[36:39]
ds_read_b64_tr_b16 a[92:93], v95 offset:8192
v_cmp_gt_u32 vcc, s39, v80
v_mfma_f32_16x16x32_bf16 v[36:39], a[28:31], a[108:111], v[36:39]
s_cbranch_vccnz L_fs33_4
L_fr33_4:
ds_read_b64_tr_b16 a[94:95], v95 offset:12288
v_mfma_f32_16x16x32_bf16 v[40:43], a[0:3], a[112:115], v[76:79]
v_exp_f32 v30, v30
v_mfma_f32_16x16x32_bf16 v[40:43], a[4:7], a[116:119], v[40:43]
v_exp_f32 v31, v31
v_mfma_f32_16x16x32_bf16 v[40:43], a[8:11], a[120:123], v[40:43]
v_exp_f32 v32, v32
v_mfma_f32_16x16x32_bf16 v[40:43], a[12:15], a[124:127], v[40:43]
v_exp_f32 v33, v33
v_mfma_f32_16x16x32_bf16 v[44:47], a[16:19], a[112:115], v[76:79]
v_exp_f32 v34, v34
v_mfma_f32_16x16x32_bf16 v[44:47], a[20:23], a[116:119], v[44:47]
v_exp_f32 v35, v35
v_mfma_f32_16x16x32_bf16 v[44:47], a[24:27], a[120:123], v[44:47]
v_exp_f32 v36, v36
v_mfma_f32_16x16x32_bf16 v[44:47], a[28:31], a[124:127], v[44:47]
s_waitcnt lgkmcnt(0)
v_exp_f32 v37, v37
v_mfma_f32_16x16x32_bf16 v[128:131], a[64:67], v[48:51], v[128:131]
ds_read_b128 a[0:3], v84 offset:16384
v_cvt_pk_bf16_f32 v55, v30, v31
v_mfma_f32_16x16x32_bf16 v[132:135], a[68:71], v[48:51], v[132:135]
ds_read_b128 a[4:7], v85 offset:16384
v_cvt_pk_bf16_f32 v56, v32, v33
v_mfma_f32_16x16x32_bf16 v[136:139], a[72:75], v[48:51], v[136:139]
ds_read_b128 a[8:11], v86 offset:16384
v_cvt_pk_bf16_f32 v57, v34, v35
v_mfma_f32_16x16x32_bf16 v[140:143], a[76:79], v[48:51], v[140:143]
ds_read_b128 a[12:15], v87 offset:16384
v_cvt_pk_bf16_f32 v58, v36, v37
v_mfma_f32_16x16x32_bf16 v[144:147], a[80:83], v[48:51], v[144:147]
ds_read_b128 a[16:19], v84 offset:20480
v_mfma_f32_16x16x32_bf16 v[148:151], a[84:87], v[48:51], v[148:151]
ds_read_b128 a[20:23], v85 offset:20480
v_mfma_f32_16x16x32_bf16 v[152:155], a[88:91], v[48:51], v[152:155]
ds_read_b128 a[24:27], v86 offset:20480
v_mfma_f32_16x16x32_bf16 v[156:159], a[92:95], v[48:51], v[156:159]
ds_read_b128 a[28:31], v87 offset:20480
v_mfma_f32_16x16x32_bf16 v[108:111], v[124:127], v[48:51], v[108:111]
v_exp_f32 v38, v38
v_mfma_f32_16x16x32_bf16 v[160:163], a[64:67], v[52:55], v[160:163]
v_exp_f32 v39, v39
v_mfma_f32_16x16x32_bf16 v[164:167], a[68:71], v[52:55], v[164:167]
v_exp_f32 v40, v40
v_mfma_f32_16x16x32_bf16 v[168:171], a[72:75], v[52:55], v[168:171]
v_exp_f32 v41, v41
v_mfma_f32_16x16x32_bf16 v[172:175], a[76:79], v[52:55], v[172:175]
v_exp_f32 v42, v42
v_mfma_f32_16x16x32_bf16 v[176:179], a[80:83], v[52:55], v[176:179]
v_exp_f32 v43, v43
v_mfma_f32_16x16x32_bf16 v[180:183], a[84:87], v[52:55], v[180:183]
v_exp_f32 v44, v44
v_mfma_f32_16x16x32_bf16 v[184:187], a[88:91], v[52:55], v[184:187]
v_exp_f32 v45, v45
v_mfma_f32_16x16x32_bf16 v[188:191], a[92:95], v[52:55], v[188:191]
v_exp_f32 v46, v46
v_mfma_f32_16x16x32_bf16 v[112:115], v[124:127], v[52:55], v[112:115]
s_waitcnt lgkmcnt(0)
v_exp_f32 v47, v47
v_mfma_f32_16x16x32_bf16 v[16:19], a[0:3], a[32:35], v[64:67]
v_cvt_pk_bf16_f32 v59, v38, v39
v_cvt_pk_bf16_f32 v60, v40, v41
v_mfma_f32_16x16x32_bf16 v[16:19], a[4:7], a[36:39], v[16:19]
v_cvt_pk_bf16_f32 v61, v42, v43
v_cvt_pk_bf16_f32 v62, v44, v45
v_mfma_f32_16x16x32_bf16 v[16:19], a[8:11], a[40:43], v[16:19]
v_cvt_pk_bf16_f32 v63, v46, v47
v_mfma_f32_16x16x32_bf16 v[16:19], a[12:15], a[44:47], v[16:19]
v_mfma_f32_16x16x32_bf16 v[20:23], a[16:19], a[32:35], v[64:67]
v_mfma_f32_16x16x32_bf16 v[20:23], a[20:23], a[36:39], v[20:23]
v_mfma_f32_16x16x32_bf16 v[20:23], a[24:27], a[40:43], v[20:23]
v_mfma_f32_16x16x32_bf16 v[20:23], a[28:31], a[44:47], v[20:23]
v_mfma_f32_16x16x32_bf16 v[24:27], a[0:3], a[48:51], v[68:71]
v_mfma_f32_16x16x32_bf16 v[24:27], a[4:7], a[52:55], v[24:27]
s_nop 1
v_exp_f32 v16, v16
v_mfma_f32_16x16x32_bf16 v[24:27], a[8:11], a[56:59], v[24:27]
v_exp_f32 v17, v17
v_mfma_f32_16x16x32_bf16 v[24:27], a[12:15], a[60:63], v[24:27]
v_cvt_pk_bf16_f32 v48, v16, v17
v_mfma_f32_16x16x32_bf16 v[28:31], a[16:19], a[48:51], v[68:71]
v_exp_f32 v18, v18
v_mfma_f32_16x16x32_bf16 v[28:31], a[20:23], a[52:55], v[28:31]
v_exp_f32 v19, v19
v_mfma_f32_16x16x32_bf16 v[28:31], a[24:27], a[56:59], v[28:31]
v_exp_f32 v20, v20
v_mfma_f32_16x16x32_bf16 v[28:31], a[28:31], a[60:63], v[28:31]
v_exp_f32 v21, v21
v_mfma_f32_16x16x32_bf16 v[192:195], a[64:67], v[56:59], v[192:195]
v_exp_f32 v22, v22
v_mfma_f32_16x16x32_bf16 v[196:199], a[68:71], v[56:59], v[196:199]
v_cvt_pk_bf16_f32 v49, v18, v19
v_mfma_f32_16x16x32_bf16 v[200:203], a[72:75], v[56:59], v[200:203]
v_exp_f32 v23, v23
v_mfma_f32_16x16x32_bf16 v[204:207], a[76:79], v[56:59], v[204:207]
v_exp_f32 v24, v24
v_mfma_f32_16x16x32_bf16 v[208:211], a[80:83], v[56:59], v[208:211]
v_exp_f32 v25, v25
v_mfma_f32_16x16x32_bf16 v[212:215], a[84:87], v[56:59], v[212:215]
v_exp_f32 v26, v26
v_mfma_f32_16x16x32_bf16 v[216:219], a[88:91], v[56:59], v[216:219]
v_exp_f32 v27, v27
v_mfma_f32_16x16x32_bf16 v[220:223], a[92:95], v[56:59], v[220:223]
v_cvt_pk_bf16_f32 v50, v20, v21
v_mfma_f32_16x16x32_bf16 v[116:119], v[124:127], v[56:59], v[116:119]
v_exp_f32 v28, v28
v_mfma_f32_16x16x32_bf16 v[224:227], a[64:67], v[60:63], v[224:227]
v_exp_f32 v29, v29
v_mfma_f32_16x16x32_bf16 v[228:231], a[68:71], v[60:63], v[228:231]
ds_read_b64_tr_b16 a[64:65], v88 offset:16384
v_cvt_pk_bf16_f32 v51, v22, v23
v_mfma_f32_16x16x32_bf16 v[232:235], a[72:75], v[60:63], v[232:235]
ds_read_b64_tr_b16 a[66:67], v88 offset:20480
v_cvt_pk_bf16_f32 v52, v24, v25
v_mfma_f32_16x16x32_bf16 v[236:239], a[76:79], v[60:63], v[236:239]
ds_read_b64_tr_b16 a[68:69], v89 offset:16384
v_cvt_pk_bf16_f32 v53, v26, v27
v_mfma_f32_16x16x32_bf16 v[240:243], a[80:83], v[60:63], v[240:243]
ds_read_b64_tr_b16 a[70:71], v89 offset:20480
v_cvt_pk_bf16_f32 v54, v28, v29
v_mfma_f32_16x16x32_bf16 v[244:247], a[84:87], v[60:63], v[244:247]
ds_read_b64_tr_b16 a[72:73], v90 offset:16384
v_mfma_f32_16x16x32_bf16 v[248:251], a[88:91], v[60:63], v[248:251]
ds_read_b64_tr_b16 a[74:75], v90 offset:20480
v_mfma_f32_16x16x32_bf16 v[252:255], a[92:95], v[60:63], v[252:255]
ds_read_b64_tr_b16 a[76:77], v91 offset:16384
v_mfma_f32_16x16x32_bf16 v[120:123], v[124:127], v[60:63], v[120:123]
ds_read_b64_tr_b16 a[78:79], v91 offset:20480
v_mfma_f32_16x16x32_bf16 v[32:35], a[0:3], a[96:99], v[72:75]
ds_read_b64_tr_b16 a[80:81], v92 offset:16384
v_mfma_f32_16x16x32_bf16 v[32:35], a[4:7], a[100:103], v[32:35]
ds_read_b64_tr_b16 a[82:83], v92 offset:20480
v_mfma_f32_16x16x32_bf16 v[32:35], a[8:11], a[104:107], v[32:35]
ds_read_b64_tr_b16 a[84:85], v93 offset:16384
v_mfma_f32_16x16x32_bf16 v[32:35], a[12:15], a[108:111], v[32:35]
ds_read_b64_tr_b16 a[86:87], v93 offset:20480
v_mfma_f32_16x16x32_bf16 v[36:39], a[16:19], a[96:99], v[72:75]
ds_read_b64_tr_b16 a[88:89], v94 offset:16384
v_mfma_f32_16x16x32_bf16 v[36:39], a[20:23], a[100:103], v[36:39]
ds_read_b64_tr_b16 a[90:91], v94 offset:20480
v_mfma_f32_16x16x32_bf16 v[36:39], a[24:27], a[104:107], v[36:39]
ds_read_b64_tr_b16 a[92:93], v95 offset:16384
v_mfma_f32_16x16x32_bf16 v[36:39], a[28:31], a[108:111], v[36:39]
ds_read_b64_tr_b16 a[94:95], v95 offset:20480
v_mfma_f32_16x16x32_bf16 v[40:43], a[0:3], a[112:115], v[76:79]
v_exp_f32 v30, v30
v_mfma_f32_16x16x32_bf16 v[40:43], a[4:7], a[116:119], v[40:43]
v_exp_f32 v31, v31
v_mfma_f32_16x16x32_bf16 v[40:43], a[8:11], a[120:123], v[40:43]
v_exp_f32 v32, v32
v_mfma_f32_16x16x32_bf16 v[40:43], a[12:15], a[124:127], v[40:43]
v_exp_f32 v33, v33
v_mfma_f32_16x16x32_bf16 v[44:47], a[16:19], a[112:115], v[76:79]
v_exp_f32 v34, v34
v_mfma_f32_16x16x32_bf16 v[44:47], a[20:23], a[116:119], v[44:47]
v_exp_f32 v35, v35
v_mfma_f32_16x16x32_bf16 v[44:47], a[24:27], a[120:123], v[44:47]
v_exp_f32 v36, v36
v_mfma_f32_16x16x32_bf16 v[44:47], a[28:31], a[124:127], v[44:47]
s_waitcnt lgkmcnt(0)
v_exp_f32 v37, v37
v_mfma_f32_16x16x32_bf16 v[128:131], a[64:67], v[48:51], v[128:131]
ds_read_b128 a[0:3], v84 offset:24576
v_cvt_pk_bf16_f32 v55, v30, v31
v_mfma_f32_16x16x32_bf16 v[132:135], a[68:71], v[48:51], v[132:135]
ds_read_b128 a[4:7], v85 offset:24576
v_cvt_pk_bf16_f32 v56, v32, v33
v_mfma_f32_16x16x32_bf16 v[136:139], a[72:75], v[48:51], v[136:139]
ds_read_b128 a[8:11], v86 offset:24576
v_cvt_pk_bf16_f32 v57, v34, v35
v_mfma_f32_16x16x32_bf16 v[140:143], a[76:79], v[48:51], v[140:143]
ds_read_b128 a[12:15], v87 offset:24576
v_cvt_pk_bf16_f32 v58, v36, v37
v_mfma_f32_16x16x32_bf16 v[144:147], a[80:83], v[48:51], v[144:147]
ds_read_b128 a[16:19], v84 offset:28672
v_mfma_f32_16x16x32_bf16 v[148:151], a[84:87], v[48:51], v[148:151]
ds_read_b128 a[20:23], v85 offset:28672
v_mfma_f32_16x16x32_bf16 v[152:155], a[88:91], v[48:51], v[152:155]
ds_read_b128 a[24:27], v86 offset:28672
v_mfma_f32_16x16x32_bf16 v[156:159], a[92:95], v[48:51], v[156:159]
ds_read_b128 a[28:31], v87 offset:28672
v_mfma_f32_16x16x32_bf16 v[108:111], v[124:127], v[48:51], v[108:111]
v_exp_f32 v38, v38
v_mfma_f32_16x16x32_bf16 v[160:163], a[64:67], v[52:55], v[160:163]
v_exp_f32 v39, v39
v_mfma_f32_16x16x32_bf16 v[164:167], a[68:71], v[52:55], v[164:167]
v_exp_f32 v40, v40
v_mfma_f32_16x16x32_bf16 v[168:171], a[72:75], v[52:55], v[168:171]
v_exp_f32 v41, v41
v_mfma_f32_16x16x32_bf16 v[172:175], a[76:79], v[52:55], v[172:175]
v_exp_f32 v42, v42
v_mfma_f32_16x16x32_bf16 v[176:179], a[80:83], v[52:55], v[176:179]
v_exp_f32 v43, v43
v_mfma_f32_16x16x32_bf16 v[180:183], a[84:87], v[52:55], v[180:183]
v_exp_f32 v44, v44
v_mfma_f32_16x16x32_bf16 v[184:187], a[88:91], v[52:55], v[184:187]
v_exp_f32 v45, v45
v_mfma_f32_16x16x32_bf16 v[188:191], a[92:95], v[52:55], v[188:191]
v_exp_f32 v46, v46
v_mfma_f32_16x16x32_bf16 v[112:115], v[124:127], v[52:55], v[112:115]
s_waitcnt lgkmcnt(0)
v_exp_f32 v47, v47
v_mfma_f32_16x16x32_bf16 v[16:19], a[0:3], a[32:35], v[64:67]
v_cvt_pk_bf16_f32 v59, v38, v39
v_cvt_pk_bf16_f32 v60, v40, v41
v_mfma_f32_16x16x32_bf16 v[16:19], a[4:7], a[36:39], v[16:19]
v_cvt_pk_bf16_f32 v61, v42, v43
v_cvt_pk_bf16_f32 v62, v44, v45
v_mfma_f32_16x16x32_bf16 v[16:19], a[8:11], a[40:43], v[16:19]
v_cvt_pk_bf16_f32 v63, v46, v47
v_mfma_f32_16x16x32_bf16 v[16:19], a[12:15], a[44:47], v[16:19]
v_mfma_f32_16x16x32_bf16 v[20:23], a[16:19], a[32:35], v[64:67]
v_mfma_f32_16x16x32_bf16 v[20:23], a[20:23], a[36:39], v[20:23]
s_add_u32 s39, s39, 1
v_mfma_f32_16x16x32_bf16 v[20:23], a[24:27], a[40:43], v[20:23]
v_mov_b32 v80, s39
v_mfma_f32_16x16x32_bf16 v[20:23], a[28:31], a[44:47], v[20:23]
v_mfma_f32_16x16x32_bf16 v[24:27], a[0:3], a[48:51], v[68:71]
s_waitcnt vmcnt(63)
ds_write_b32 v1, v80
v_mfma_f32_16x16x32_bf16 v[24:27], a[4:7], a[52:55], v[24:27]
v_exp_f32 v16, v16
v_mfma_f32_16x16x32_bf16 v[24:27], a[8:11], a[56:59], v[24:27]
v_exp_f32 v17, v17
v_mfma_f32_16x16x32_bf16 v[24:27], a[12:15], a[60:63], v[24:27]
v_cvt_pk_bf16_f32 v48, v16, v17
v_mfma_f32_16x16x32_bf16 v[28:31], a[16:19], a[48:51], v[68:71]
v_exp_f32 v18, v18
v_mfma_f32_16x16x32_bf16 v[28:31], a[20:23], a[52:55], v[28:31]
v_exp_f32 v19, v19
v_mfma_f32_16x16x32_bf16 v[28:31], a[24:27], a[56:59], v[28:31]
v_exp_f32 v20, v20
v_mfma_f32_16x16x32_bf16 v[28:31], a[28:31], a[60:63], v[28:31]
v_exp_f32 v21, v21
v_mfma_f32_16x16x32_bf16 v[192:195], a[64:67], v[56:59], v[192:195]
v_exp_f32 v22, v22
v_mfma_f32_16x16x32_bf16 v[196:199], a[68:71], v[56:59], v[196:199]
v_cvt_pk_bf16_f32 v49, v18, v19
v_mfma_f32_16x16x32_bf16 v[200:203], a[72:75], v[56:59], v[200:203]
v_exp_f32 v23, v23
v_mfma_f32_16x16x32_bf16 v[204:207], a[76:79], v[56:59], v[204:207]
v_exp_f32 v24, v24
v_mfma_f32_16x16x32_bf16 v[208:211], a[80:83], v[56:59], v[208:211]
v_exp_f32 v25, v25
v_mfma_f32_16x16x32_bf16 v[212:215], a[84:87], v[56:59], v[212:215]
v_exp_f32 v26, v26
v_mfma_f32_16x16x32_bf16 v[216:219], a[88:91], v[56:59], v[216:219]
v_exp_f32 v27, v27
v_mfma_f32_16x16x32_bf16 v[220:223], a[92:95], v[56:59], v[220:223]
v_cvt_pk_bf16_f32 v50, v20, v21
v_mfma_f32_16x16x32_bf16 v[116:119], v[124:127], v[56:59], v[116:119]
v_exp_f32 v28, v28
v_mfma_f32_16x16x32_bf16 v[224:227], a[64:67], v[60:63], v[224:227]
v_exp_f32 v29, v29
v_mfma_f32_16x16x32_bf16 v[228:231], a[68:71], v[60:63], v[228:231]
ds_read_b64_tr_b16 a[64:65], v88 offset:24576
v_cvt_pk_bf16_f32 v51, v22, v23
v_mfma_f32_16x16x32_bf16 v[232:235], a[72:75], v[60:63], v[232:235]
ds_read_b64_tr_b16 a[66:67], v88 offset:28672
v_cvt_pk_bf16_f32 v52, v24, v25
v_mfma_f32_16x16x32_bf16 v[236:239], a[76:79], v[60:63], v[236:239]
ds_read_b64_tr_b16 a[68:69], v89 offset:24576
v_cvt_pk_bf16_f32 v53, v26, v27
v_mfma_f32_16x16x32_bf16 v[240:243], a[80:83], v[60:63], v[240:243]
ds_read_b64_tr_b16 a[70:71], v89 offset:28672
v_cvt_pk_bf16_f32 v54, v28, v29
v_mfma_f32_16x16x32_bf16 v[244:247], a[84:87], v[60:63], v[244:247]
ds_read_b64_tr_b16 a[72:73], v90 offset:24576
v_mfma_f32_16x16x32_bf16 v[248:251], a[88:91], v[60:63], v[248:251]
ds_read_b64_tr_b16 a[74:75], v90 offset:28672
v_mfma_f32_16x16x32_bf16 v[252:255], a[92:95], v[60:63], v[252:255]
ds_read_b64_tr_b16 a[76:77], v91 offset:24576
v_mfma_f32_16x16x32_bf16 v[120:123], v[124:127], v[60:63], v[120:123]
ds_read_b64_tr_b16 a[78:79], v91 offset:28672
v_mfma_f32_16x16x32_bf16 v[32:35], a[0:3], a[96:99], v[72:75]
ds_read_b64_tr_b16 a[80:81], v92 offset:24576
v_mfma_f32_16x16x32_bf16 v[32:35], a[4:7], a[100:103], v[32:35]
ds_read_b64_tr_b16 a[82:83], v92 offset:28672
ds_read_b128 v[80:83], v101
v_mfma_f32_16x16x32_bf16 v[32:35], a[8:11], a[104:107], v[32:35]
ds_read_b64_tr_b16 a[84:85], v93 offset:24576
v_mfma_f32_16x16x32_bf16 v[32:35], a[12:15], a[108:111], v[32:35]
ds_read_b64_tr_b16 a[86:87], v93 offset:28672
v_mfma_f32_16x16x32_bf16 v[36:39], a[16:19], a[96:99], v[72:75]
s_waitcnt lgkmcnt(2)
ds_read_b64_tr_b16 a[88:89], v94 offset:24576
v_min3_u32 v80, v80, v81, v82
v_mfma_f32_16x16x32_bf16 v[36:39], a[20:23], a[100:103], v[36:39]
ds_read_b64_tr_b16 a[90:91], v94 offset:28672
v_min_u32 v80, v80, v83
v_mfma_f32_16x16x32_bf16 v[36:39], a[24:27], a[104:107], v[36:39]
ds_read_b64_tr_b16 a[92:93], v95 offset:24576
v_cmp_gt_u32 vcc, s39, v80
v_mfma_f32_16x16x32_bf16 v[36:39], a[28:31], a[108:111], v[36:39]
s_cbranch_vccnz L_fs35_4
L_fr35_4:
ds_read_b64_tr_b16 a[94:95], v95 offset:28672
v_mfma_f32_16x16x32_bf16 v[40:43], a[0:3], a[112:115], v[76:79]
v_exp_f32 v30, v30
v_mfma_f32_16x16x32_bf16 v[40:43], a[4:7], a[116:119], v[40:43]
v_exp_f32 v31, v31
v_mfma_f32_16x16x32_bf16 v[40:43], a[8:11], a[120:123], v[40:43]
v_exp_f32 v32, v32
v_mfma_f32_16x16x32_bf16 v[40:43], a[12:15], a[124:127], v[40:43]
v_exp_f32 v33, v33
v_mfma_f32_16x16x32_bf16 v[44:47], a[16:19], a[112:115], v[76:79]
v_exp_f32 v34, v34
v_mfma_f32_16x16x32_bf16 v[44:47], a[20:23], a[116:119], v[44:47]
v_exp_f32 v35, v35
v_mfma_f32_16x16x32_bf16 v[44:47], a[24:27], a[120:123], v[44:47]
v_exp_f32 v36, v36
v_mfma_f32_16x16x32_bf16 v[44:47], a[28:31], a[124:127], v[44:47]
s_waitcnt lgkmcnt(0)
v_exp_f32 v37, v37
v_mfma_f32_16x16x32_bf16 v[128:131], a[64:67], v[48:51], v[128:131]
ds_read_b128 a[0:3], v84 offset:32768
v_cvt_pk_bf16_f32 v55, v30, v31
v_mfma_f32_16x16x32_bf16 v[132:135], a[68:71], v[48:51], v[132:135]
ds_read_b128 a[4:7], v85 offset:32768
v_cvt_pk_bf16_f32 v56, v32, v33
v_mfma_f32_16x16x32_bf16 v[136:139], a[72:75], v[48:51], v[136:139]
ds_read_b128 a[8:11], v86 offset:32768
v_cvt_pk_bf16_f32 v57, v34, v35
v_mfma_f32_16x16x32_bf16 v[140:143], a[76:79], v[48:51], v[140:143]
ds_read_b128 a[12:15], v87 offset:32768
v_cvt_pk_bf16_f32 v58, v36, v37
v_mfma_f32_16x16x32_bf16 v[144:147], a[80:83], v[48:51], v[144:147]
ds_read_b128 a[16:19], v84 offset:36864
v_mfma_f32_16x16x32_bf16 v[148:151], a[84:87], v[48:51], v[148:151]
ds_read_b128 a[20:23], v85 offset:36864
v_mfma_f32_16x16x32_bf16 v[152:155], a[88:91], v[48:51], v[152:155]
ds_read_b128 a[24:27], v86 offset:36864
v_mfma_f32_16x16x32_bf16 v[156:159], a[92:95], v[48:51], v[156:159]
ds_read_b128 a[28:31], v87 offset:36864
v_mfma_f32_16x16x32_bf16 v[108:111], v[124:127], v[48:51], v[108:111]
v_exp_f32 v38, v38
v_mfma_f32_16x16x32_bf16 v[160:163], a[64:67], v[52:55], v[160:163]
v_exp_f32 v39, v39
v_mfma_f32_16x16x32_bf16 v[164:167], a[68:71], v[52:55], v[164:167]
v_exp_f32 v40, v40
v_mfma_f32_16x16x32_bf16 v[168:171], a[72:75], v[52:55], v[168:171]
v_exp_f32 v41, v41
v_mfma_f32_16x16x32_bf16 v[172:175], a[76:79], v[52:55], v[172:175]
v_exp_f32 v42, v42
v_mfma_f32_16x16x32_bf16 v[176:179], a[80:83], v[52:55], v[176:179]
v_exp_f32 v43, v43
v_mfma_f32_16x16x32_bf16 v[180:183], a[84:87], v[52:55], v[180:183]
v_exp_f32 v44, v44
v_mfma_f32_16x16x32_bf16 v[184:187], a[88:91], v[52:55], v[184:187]
v_exp_f32 v45, v45
v_mfma_f32_16x16x32_bf16 v[188:191], a[92:95], v[52:55], v[188:191]
v_exp_f32 v46, v46
v_mfma_f32_16x16x32_bf16 v[112:115], v[124:127], v[52:55], v[112:115]
s_waitcnt lgkmcnt(0)
v_exp_f32 v47, v47
v_mfma_f32_16x16x32_bf16 v[16:19], a[0:3], a[32:35], v[64:67]
v_cvt_pk_bf16_f32 v59, v38, v39
v_cvt_pk_bf16_f32 v60, v40, v41
v_mfma_f32_16x16x32_bf16 v[16:19], a[4:7], a[36:39], v[16:19]
v_cvt_pk_bf16_f32 v61, v42, v43
v_cvt_pk_bf16_f32 v62, v44, v45
v_mfma_f32_16x16x32_bf16 v[16:19], a[8:11], a[40:43], v[16:19]
v_cvt_pk_bf16_f32 v63, v46, v47
v_mfma_f32_16x16x32_bf16 v[16:19], a[12:15], a[44:47], v[16:19]
v_mfma_f32_16x16x32_bf16 v[20:23], a[16:19], a[32:35], v[64:67]
v_mfma_f32_16x16x32_bf16 v[20:23], a[20:23], a[36:39], v[20:23]
v_mfma_f32_16x16x32_bf16 v[20:23], a[24:27], a[40:43], v[20:23]
v_mfma_f32_16x16x32_bf16 v[20:23], a[28:31], a[44:47], v[20:23]
v_mfma_f32_16x16x32_bf16 v[24:27], a[0:3], a[48:51], v[68:71]
v_mfma_f32_16x16x32_bf16 v[24:27], a[4:7], a[52:55], v[24:27]
s_nop 1
v_exp_f32 v16, v16
v_mfma_f32_16x16x32_bf16 v[24:27], a[8:11], a[56:59], v[24:27]
v_exp_f32 v17, v17
v_mfma_f32_16x16x32_bf16 v[24:27], a[12:15], a[60:63], v[24:27]
v_cvt_pk_bf16_f32 v48, v16, v17
v_mfma_f32_16x16x32_bf16 v[28:31], a[16:19], a[48:51], v[68:71]
v_exp_f32 v18, v18
v_mfma_f32_16x16x32_bf16 v[28:31], a[20:23], a[52:55], v[28:31]
v_exp_f32 v19, v19
v_mfma_f32_16x16x32_bf16 v[28:31], a[24:27], a[56:59], v[28:31]
v_exp_f32 v20, v20
v_mfma_f32_16x16x32_bf16 v[28:31], a[28:31], a[60:63], v[28:31]
v_exp_f32 v21, v21
v_mfma_f32_16x16x32_bf16 v[192:195], a[64:67], v[56:59], v[192:195]
v_exp_f32 v22, v22
v_mfma_f32_16x16x32_bf16 v[196:199], a[68:71], v[56:59], v[196:199]
v_cvt_pk_bf16_f32 v49, v18, v19
v_mfma_f32_16x16x32_bf16 v[200:203], a[72:75], v[56:59], v[200:203]
v_exp_f32 v23, v23
v_mfma_f32_16x16x32_bf16 v[204:207], a[76:79], v[56:59], v[204:207]
v_exp_f32 v24, v24
v_mfma_f32_16x16x32_bf16 v[208:211], a[80:83], v[56:59], v[208:211]
v_exp_f32 v25, v25
v_mfma_f32_16x16x32_bf16 v[212:215], a[84:87], v[56:59], v[212:215]
v_exp_f32 v26, v26
v_mfma_f32_16x16x32_bf16 v[216:219], a[88:91], v[56:59], v[216:219]
v_exp_f32 v27, v27
v_mfma_f32_16x16x32_bf16 v[220:223], a[92:95], v[56:59], v[220:223]
v_cvt_pk_bf16_f32 v50, v20, v21
v_mfma_f32_16x16x32_bf16 v[116:119], v[124:127], v[56:59], v[116:119]
v_exp_f32 v28, v28
v_mfma_f32_16x16x32_bf16 v[224:227], a[64:67], v[60:63], v[224:227]
v_exp_f32 v29, v29
v_mfma_f32_16x16x32_bf16 v[228:231], a[68:71], v[60:63], v[228:231]
ds_read_b64_tr_b16 a[64:65], v88 offset:32768
v_cvt_pk_bf16_f32 v51, v22, v23
v_mfma_f32_16x16x32_bf16 v[232:235], a[72:75], v[60:63], v[232:235]
ds_read_b64_tr_b16 a[66:67], v88 offset:36864
v_cvt_pk_bf16_f32 v52, v24, v25
v_mfma_f32_16x16x32_bf16 v[236:239], a[76:79], v[60:63], v[236:239]
ds_read_b64_tr_b16 a[68:69], v89 offset:32768
v_cvt_pk_bf16_f32 v53, v26, v27
v_mfma_f32_16x16x32_bf16 v[240:243], a[80:83], v[60:63], v[240:243]
ds_read_b64_tr_b16 a[70:71], v89 offset:36864
v_cvt_pk_bf16_f32 v54, v28, v29
v_mfma_f32_16x16x32_bf16 v[244:247], a[84:87], v[60:63], v[244:247]
ds_read_b64_tr_b16 a[72:73], v90 offset:32768
v_mfma_f32_16x16x32_bf16 v[248:251], a[88:91], v[60:63], v[248:251]
ds_read_b64_tr_b16 a[74:75], v90 offset:36864
v_mfma_f32_16x16x32_bf16 v[252:255], a[92:95], v[60:63], v[252:255]
ds_read_b64_tr_b16 a[76:77], v91 offset:32768
v_mfma_f32_16x16x32_bf16 v[120:123], v[124:127], v[60:63], v[120:123]
ds_read_b64_tr_b16 a[78:79], v91 offset:36864
v_mfma_f32_16x16x32_bf16 v[32:35], a[0:3], a[96:99], v[72:75]
ds_read_b64_tr_b16 a[80:81], v92 offset:32768
v_mfma_f32_16x16x32_bf16 v[32:35], a[4:7], a[100:103], v[32:35]
ds_read_b64_tr_b16 a[82:83], v92 offset:36864
v_mfma_f32_16x16x32_bf16 v[32:35], a[8:11], a[104:107], v[32:35]
ds_read_b64_tr_b16 a[84:85], v93 offset:32768
v_mfma_f32_16x16x32_bf16 v[32:35], a[12:15], a[108:111], v[32:35]
ds_read_b64_tr_b16 a[86:87], v93 offset:36864
v_mfma_f32_16x16x32_bf16 v[36:39], a[16:19], a[96:99], v[72:75]
ds_read_b64_tr_b16 a[88:89], v94 offset:32768
v_mfma_f32_16x16x32_bf16 v[36:39], a[20:23], a[100:103], v[36:39]
ds_read_b64_tr_b16 a[90:91], v94 offset:36864
v_mfma_f32_16x16x32_bf16 v[36:39], a[24:27], a[104:107], v[36:39]
ds_read_b64_tr_b16 a[92:93], v95 offset:32768
v_mfma_f32_16x16x32_bf16 v[36:39], a[28:31], a[108:111], v[36:39]
ds_read_b64_tr_b16 a[94:95], v95 offset:36864
v_mfma_f32_16x16x32_bf16 v[40:43], a[0:3], a[112:115], v[76:79]
v_exp_f32 v30, v30
v_mfma_f32_16x16x32_bf16 v[40:43], a[4:7], a[116:119], v[40:43]
v_exp_f32 v31, v31
v_mfma_f32_16x16x32_bf16 v[40:43], a[8:11], a[120:123], v[40:43]
v_exp_f32 v32, v32
v_mfma_f32_16x16x32_bf16 v[40:43], a[12:15], a[124:127], v[40:43]
v_exp_f32 v33, v33
v_mfma_f32_16x16x32_bf16 v[44:47], a[16:19], a[112:115], v[76:79]
v_exp_f32 v34, v34
v_mfma_f32_16x16x32_bf16 v[44:47], a[20:23], a[116:119], v[44:47]
v_exp_f32 v35, v35
v_mfma_f32_16x16x32_bf16 v[44:47], a[24:27], a[120:123], v[44:47]
v_exp_f32 v36, v36
v_mfma_f32_16x16x32_bf16 v[44:47], a[28:31], a[124:127], v[44:47]
s_waitcnt lgkmcnt(0)
v_exp_f32 v37, v37
v_mfma_f32_16x16x32_bf16 v[128:131], a[64:67], v[48:51], v[128:131]
ds_read_b128 a[0:3], v84 offset:40960
v_cvt_pk_bf16_f32 v55, v30, v31
v_mfma_f32_16x16x32_bf16 v[132:135], a[68:71], v[48:51], v[132:135]
ds_read_b128 a[4:7], v85 offset:40960
v_cvt_pk_bf16_f32 v56, v32, v33
v_mfma_f32_16x16x32_bf16 v[136:139], a[72:75], v[48:51], v[136:139]
ds_read_b128 a[8:11], v86 offset:40960
v_cvt_pk_bf16_f32 v57, v34, v35
v_mfma_f32_16x16x32_bf16 v[140:143], a[76:79], v[48:51], v[140:143]
ds_read_b128 a[12:15], v87 offset:40960
v_cvt_pk_bf16_f32 v58, v36, v37
v_mfma_f32_16x16x32_bf16 v[144:147], a[80:83], v[48:51], v[144:147]
ds_read_b128 a[16:19], v84 offset:45056
v_mfma_f32_16x16x32_bf16 v[148:151], a[84:87], v[48:51], v[148:151]
ds_read_b128 a[20:23], v85 offset:45056
v_mfma_f32_16x16x32_bf16 v[152:155], a[88:91], v[48:51], v[152:155]
ds_read_b128 a[24:27], v86 offset:45056
v_mfma_f32_16x16x32_bf16 v[156:159], a[92:95], v[48:51], v[156:159]
ds_read_b128 a[28:31], v87 offset:45056
v_mfma_f32_16x16x32_bf16 v[108:111], v[124:127], v[48:51], v[108:111]
v_exp_f32 v38, v38
v_mfma_f32_16x16x32_bf16 v[160:163], a[64:67], v[52:55], v[160:163]
v_exp_f32 v39, v39
v_mfma_f32_16x16x32_bf16 v[164:167], a[68:71], v[52:55], v[164:167]
v_exp_f32 v40, v40
v_mfma_f32_16x16x32_bf16 v[168:171], a[72:75], v[52:55], v[168:171]
v_exp_f32 v41, v41
v_mfma_f32_16x16x32_bf16 v[172:175], a[76:79], v[52:55], v[172:175]
v_exp_f32 v42, v42
v_mfma_f32_16x16x32_bf16 v[176:179], a[80:83], v[52:55], v[176:179]
v_exp_f32 v43, v43
v_mfma_f32_16x16x32_bf16 v[180:183], a[84:87], v[52:55], v[180:183]
v_exp_f32 v44, v44
v_mfma_f32_16x16x32_bf16 v[184:187], a[88:91], v[52:55], v[184:187]
v_exp_f32 v45, v45
v_mfma_f32_16x16x32_bf16 v[188:191], a[92:95], v[52:55], v[188:191]
v_exp_f32 v46, v46
v_mfma_f32_16x16x32_bf16 v[112:115], v[124:127], v[52:55], v[112:115]
s_waitcnt lgkmcnt(0)
v_exp_f32 v47, v47
v_mfma_f32_16x16x32_bf16 v[16:19], a[0:3], a[32:35], v[64:67]
v_cvt_pk_bf16_f32 v59, v38, v39
v_cvt_pk_bf16_f32 v60, v40, v41
v_mfma_f32_16x16x32_bf16 v[16:19], a[4:7], a[36:39], v[16:19]
v_cvt_pk_bf16_f32 v61, v42, v43
v_cvt_pk_bf16_f32 v62, v44, v45
v_mfma_f32_16x16x32_bf16 v[16:19], a[8:11], a[40:43], v[16:19]
v_cvt_pk_bf16_f32 v63, v46, v47
v_mfma_f32_16x16x32_bf16 v[16:19], a[12:15], a[44:47], v[16:19]
v_mfma_f32_16x16x32_bf16 v[20:23], a[16:19], a[32:35], v[64:67]
v_mfma_f32_16x16x32_bf16 v[20:23], a[20:23], a[36:39], v[20:23]
s_add_u32 s39, s39, 1
v_mfma_f32_16x16x32_bf16 v[20:23], a[24:27], a[40:43], v[20:23]
v_mov_b32 v80, s39
v_mfma_f32_16x16x32_bf16 v[20:23], a[28:31], a[44:47], v[20:23]
v_mfma_f32_16x16x32_bf16 v[24:27], a[0:3], a[48:51], v[68:71]
s_waitcnt vmcnt(63)
ds_write_b32 v1, v80
v_mfma_f32_16x16x32_bf16 v[24:27], a[4:7], a[52:55], v[24:27]
v_exp_f32 v16, v16
v_mfma_f32_16x16x32_bf16 v[24:27], a[8:11], a[56:59], v[24:27]
v_exp_f32 v17, v17
v_mfma_f32_16x16x32_bf16 v[24:27], a[12:15], a[60:63], v[24:27]
v_cvt_pk_bf16_f32 v48, v16, v17
v_mfma_f32_16x16x32_bf16 v[28:31], a[16:19], a[48:51], v[68:71]
v_exp_f32 v18, v18
v_mfma_f32_16x16x32_bf16 v[28:31], a[20:23], a[52:55], v[28:31]
v_exp_f32 v19, v19
v_mfma_f32_16x16x32_bf16 v[28:31], a[24:27], a[56:59], v[28:31]
v_exp_f32 v20, v20
v_mfma_f32_16x16x32_bf16 v[28:31], a[28:31], a[60:63], v[28:31]
v_exp_f32 v21, v21
v_mfma_f32_16x16x32_bf16 v[192:195], a[64:67], v[56:59], v[192:195]
v_exp_f32 v22, v22
v_mfma_f32_16x16x32_bf16 v[196:199], a[68:71], v[56:59], v[196:199]
v_cvt_pk_bf16_f32 v49, v18, v19
v_mfma_f32_16x16x32_bf16 v[200:203], a[72:75], v[56:59], v[200:203]
v_exp_f32 v23, v23
v_mfma_f32_16x16x32_bf16 v[204:207], a[76:79], v[56:59], v[204:207]
v_exp_f32 v24, v24
v_mfma_f32_16x16x32_bf16 v[208:211], a[80:83], v[56:59], v[208:211]
v_exp_f32 v25, v25
v_mfma_f32_16x16x32_bf16 v[212:215], a[84:87], v[56:59], v[212:215]
v_exp_f32 v26, v26
v_mfma_f32_16x16x32_bf16 v[216:219], a[88:91], v[56:59], v[216:219]
v_exp_f32 v27, v27
v_mfma_f32_16x16x32_bf16 v[220:223], a[92:95], v[56:59], v[220:223]
v_cvt_pk_bf16_f32 v50, v20, v21
v_mfma_f32_16x16x32_bf16 v[116:119], v[124:127], v[56:59], v[116:119]
v_exp_f32 v28, v28
v_mfma_f32_16x16x32_bf16 v[224:227], a[64:67], v[60:63], v[224:227]
v_exp_f32 v29, v29
v_mfma_f32_16x16x32_bf16 v[228:231], a[68:71], v[60:63], v[228:231]
ds_read_b64_tr_b16 a[64:65], v88 offset:40960
v_cvt_pk_bf16_f32 v51, v22, v23
v_mfma_f32_16x16x32_bf16 v[232:235], a[72:75], v[60:63], v[232:235]
ds_read_b64_tr_b16 a[66:67], v88 offset:45056
v_cvt_pk_bf16_f32 v52, v24, v25
v_mfma_f32_16x16x32_bf16 v[236:239], a[76:79], v[60:63], v[236:239]
ds_read_b64_tr_b16 a[68:69], v89 offset:40960
v_cvt_pk_bf16_f32 v53, v26, v27
v_mfma_f32_16x16x32_bf16 v[240:243], a[80:83], v[60:63], v[240:243]
ds_read_b64_tr_b16 a[70:71], v89 offset:45056
v_cvt_pk_bf16_f32 v54, v28, v29
v_mfma_f32_16x16x32_bf16 v[244:247], a[84:87], v[60:63], v[244:247]
ds_read_b64_tr_b16 a[72:73], v90 offset:40960
v_mfma_f32_16x16x32_bf16 v[248:251], a[88:91], v[60:63], v[248:251]
ds_read_b64_tr_b16 a[74:75], v90 offset:45056
v_mfma_f32_16x16x32_bf16 v[252:255], a[92:95], v[60:63], v[252:255]
ds_read_b64_tr_b16 a[76:77], v91 offset:40960
v_mfma_f32_16x16x32_bf16 v[120:123], v[124:127], v[60:63], v[120:123]
ds_read_b64_tr_b16 a[78:79], v91 offset:45056
v_mfma_f32_16x16x32_bf16 v[32:35], a[0:3], a[96:99], v[72:75]
ds_read_b64_tr_b16 a[80:81], v92 offset:40960
v_mfma_f32_16x16x32_bf16 v[32:35], a[4:7], a[100:103], v[32:35]
ds_read_b64_tr_b16 a[82:83], v92 offset:45056
ds_read_b128 v[80:83], v101
v_mfma_f32_16x16x32_bf16 v[32:35], a[8:11], a[104:107], v[32:35]
ds_read_b64_tr_b16 a[84:85], v93 offset:40960
v_mfma_f32_16x16x32_bf16 v[32:35], a[12:15], a[108:111], v[32:35]
ds_read_b64_tr_b16 a[86:87], v93 offset:45056
v_mfma_f32_16x16x32_bf16 v[36:39], a[16:19], a[96:99], v[72:75]
s_waitcnt lgkmcnt(2)
ds_read_b64_tr_b16 a[88:89], v94 offset:40960
v_min3_u32 v80, v80, v81, v82
v_mfma_f32_16x16x32_bf16 v[36:39], a[20:23], a[100:103], v[36:39]
ds_read_b64_tr_b16 a[90:91], v94 offset:45056
v_min_u32 v80, v80, v83
v_mfma_f32_16x16x32_bf16 v[36:39], a[24:27], a[104:107], v[36:39]
ds_read_b64_tr_b16 a[92:93], v95 offset:40960
v_cmp_gt_u32 vcc, s39, v80
v_mfma_f32_16x16x32_bf16 v[36:39], a[28:31], a[108:111], v[36:39]
s_cbranch_vccnz L_fs37_4
L_fr37_4:
ds_read_b64_tr_b16 a[94:95], v95 offset:45056
v_mfma_f32_16x16x32_bf16 v[40:43], a[0:3], a[112:115], v[76:79]
v_exp_f32 v30, v30
v_mfma_f32_16x16x32_bf16 v[40:43], a[4:7], a[116:119], v[40:43]
v_exp_f32 v31, v31
v_mfma_f32_16x16x32_bf16 v[40:43], a[8:11], a[120:123], v[40:43]
v_exp_f32 v32, v32
v_mfma_f32_16x16x32_bf16 v[40:43], a[12:15], a[124:127], v[40:43]
v_exp_f32 v33, v33
v_mfma_f32_16x16x32_bf16 v[44:47], a[16:19], a[112:115], v[76:79]
v_exp_f32 v34, v34
v_mfma_f32_16x16x32_bf16 v[44:47], a[20:23], a[116:119], v[44:47]
v_exp_f32 v35, v35
v_mfma_f32_16x16x32_bf16 v[44:47], a[24:27], a[120:123], v[44:47]
v_exp_f32 v36, v36
v_mfma_f32_16x16x32_bf16 v[44:47], a[28:31], a[124:127], v[44:47]
s_waitcnt lgkmcnt(0)
v_exp_f32 v37, v37
v_mfma_f32_16x16x32_bf16 v[128:131], a[64:67], v[48:51], v[128:131]
ds_read_b128 a[0:3], v84 offset:49152
v_cvt_pk_bf16_f32 v55, v30, v31
v_mfma_f32_16x16x32_bf16 v[132:135], a[68:71], v[48:51], v[132:135]
ds_read_b128 a[4:7], v85 offset:49152
v_cvt_pk_bf16_f32 v56, v32, v33
v_mfma_f32_16x16x32_bf16 v[136:139], a[72:75], v[48:51], v[136:139]
ds_read_b128 a[8:11], v86 offset:49152
v_cvt_pk_bf16_f32 v57, v34, v35
v_mfma_f32_16x16x32_bf16 v[140:143], a[76:79], v[48:51], v[140:143]
ds_read_b128 a[12:15], v87 offset:49152
v_cvt_pk_bf16_f32 v58, v36, v37
v_mfma_f32_16x16x32_bf16 v[144:147], a[80:83], v[48:51], v[144:147]
ds_read_b128 a[16:19], v84 offset:53248
v_mfma_f32_16x16x32_bf16 v[148:151], a[84:87], v[48:51], v[148:151]
ds_read_b128 a[20:23], v85 offset:53248
v_mfma_f32_16x16x32_bf16 v[152:155], a[88:91], v[48:51], v[152:155]
ds_read_b128 a[24:27], v86 offset:53248
v_mfma_f32_16x16x32_bf16 v[156:159], a[92:95], v[48:51], v[156:159]
ds_read_b128 a[28:31], v87 offset:53248
v_mfma_f32_16x16x32_bf16 v[108:111], v[124:127], v[48:51], v[108:111]
v_exp_f32 v38, v38
v_mfma_f32_16x16x32_bf16 v[160:163], a[64:67], v[52:55], v[160:163]
v_exp_f32 v39, v39
v_mfma_f32_16x16x32_bf16 v[164:167], a[68:71], v[52:55], v[164:167]
v_exp_f32 v40, v40
v_mfma_f32_16x16x32_bf16 v[168:171], a[72:75], v[52:55], v[168:171]
v_exp_f32 v41, v41
v_mfma_f32_16x16x32_bf16 v[172:175], a[76:79], v[52:55], v[172:175]
v_exp_f32 v42, v42
v_mfma_f32_16x16x32_bf16 v[176:179], a[80:83], v[52:55], v[176:179]
v_exp_f32 v43, v43
v_mfma_f32_16x16x32_bf16 v[180:183], a[84:87], v[52:55], v[180:183]
v_exp_f32 v44, v44
v_mfma_f32_16x16x32_bf16 v[184:187], a[88:91], v[52:55], v[184:187]
v_exp_f32 v45, v45
v_mfma_f32_16x16x32_bf16 v[188:191], a[92:95], v[52:55], v[188:191]
v_exp_f32 v46, v46
v_mfma_f32_16x16x32_bf16 v[112:115], v[124:127], v[52:55], v[112:115]
s_waitcnt lgkmcnt(0)
v_exp_f32 v47, v47
v_mfma_f32_16x16x32_bf16 v[16:19], a[0:3], a[32:35], v[64:67]
v_cvt_pk_bf16_f32 v59, v38, v39
v_cvt_pk_bf16_f32 v60, v40, v41
v_mfma_f32_16x16x32_bf16 v[16:19], a[4:7], a[36:39], v[16:19]
v_cvt_pk_bf16_f32 v61, v42, v43
v_cvt_pk_bf16_f32 v62, v44, v45
v_mfma_f32_16x16x32_bf16 v[16:19], a[8:11], a[40:43], v[16:19]
v_cvt_pk_bf16_f32 v63, v46, v47
v_mfma_f32_16x16x32_bf16 v[16:19], a[12:15], a[44:47], v[16:19]
v_mfma_f32_16x16x32_bf16 v[20:23], a[16:19], a[32:35], v[64:67]
v_mfma_f32_16x16x32_bf16 v[20:23], a[20:23], a[36:39], v[20:23]
v_mfma_f32_16x16x32_bf16 v[20:23], a[24:27], a[40:43], v[20:23]
v_mfma_f32_16x16x32_bf16 v[20:23], a[28:31], a[44:47], v[20:23]
v_mfma_f32_16x16x32_bf16 v[24:27], a[0:3], a[48:51], v[68:71]
v_mfma_f32_16x16x32_bf16 v[24:27], a[4:7], a[52:55], v[24:27]
s_nop 1
v_exp_f32 v16, v16
v_mfma_f32_16x16x32_bf16 v[24:27], a[8:11], a[56:59], v[24:27]
v_exp_f32 v17, v17
v_mfma_f32_16x16x32_bf16 v[24:27], a[12:15], a[60:63], v[24:27]
v_cvt_pk_bf16_f32 v48, v16, v17
v_mfma_f32_16x16x32_bf16 v[28:31], a[16:19], a[48:51], v[68:71]
v_exp_f32 v18, v18
v_mfma_f32_16x16x32_bf16 v[28:31], a[20:23], a[52:55], v[28:31]
v_exp_f32 v19, v19
v_mfma_f32_16x16x32_bf16 v[28:31], a[24:27], a[56:59], v[28:31]
v_exp_f32 v20, v20
v_mfma_f32_16x16x32_bf16 v[28:31], a[28:31], a[60:63], v[28:31]
v_exp_f32 v21, v21
v_mfma_f32_16x16x32_bf16 v[192:195], a[64:67], v[56:59], v[192:195]
v_exp_f32 v22, v22
v_mfma_f32_16x16x32_bf16 v[196:199], a[68:71], v[56:59], v[196:199]
v_cvt_pk_bf16_f32 v49, v18, v19
v_mfma_f32_16x16x32_bf16 v[200:203], a[72:75], v[56:59], v[200:203]
v_exp_f32 v23, v23
v_mfma_f32_16x16x32_bf16 v[204:207], a[76:79], v[56:59], v[204:207]
v_exp_f32 v24, v24
v_mfma_f32_16x16x32_bf16 v[208:211], a[80:83], v[56:59], v[208:211]
v_exp_f32 v25, v25
v_mfma_f32_16x16x32_bf16 v[212:215], a[84:87], v[56:59], v[212:215]
v_exp_f32 v26, v26
v_mfma_f32_16x16x32_bf16 v[216:219], a[88:91], v[56:59], v[216:219]
v_exp_f32 v27, v27
v_mfma_f32_16x16x32_bf16 v[220:223], a[92:95], v[56:59], v[220:223]
v_cvt_pk_bf16_f32 v50, v20, v21
v_mfma_f32_16x16x32_bf16 v[116:119], v[124:127], v[56:59], v[116:119]
v_exp_f32 v28, v28
v_mfma_f32_16x16x32_bf16 v[224:227], a[64:67], v[60:63], v[224:227]
v_exp_f32 v29, v29
v_mfma_f32_16x16x32_bf16 v[228:231], a[68:71], v[60:63], v[228:231]
ds_read_b64_tr_b16 a[64:65], v88 offset:49152
v_cvt_pk_bf16_f32 v51, v22, v23
v_mfma_f32_16x16x32_bf16 v[232:235], a[72:75], v[60:63], v[232:235]
ds_read_b64_tr_b16 a[66:67], v88 offset:53248
v_cvt_pk_bf16_f32 v52, v24, v25
v_mfma_f32_16x16x32_bf16 v[236:239], a[76:79], v[60:63], v[236:239]
ds_read_b64_tr_b16 a[68:69], v89 offset:49152
v_cvt_pk_bf16_f32 v53, v26, v27
v_mfma_f32_16x16x32_bf16 v[240:243], a[80:83], v[60:63], v[240:243]
ds_read_b64_tr_b16 a[70:71], v89 offset:53248
v_cvt_pk_bf16_f32 v54, v28, v29
v_mfma_f32_16x16x32_bf16 v[244:247], a[84:87], v[60:63], v[244:247]
ds_read_b64_tr_b16 a[72:73], v90 offset:49152
v_mfma_f32_16x16x32_bf16 v[248:251], a[88:91], v[60:63], v[248:251]
ds_read_b64_tr_b16 a[74:75], v90 offset:53248
v_mfma_f32_16x16x32_bf16 v[252:255], a[92:95], v[60:63], v[252:255]
ds_read_b64_tr_b16 a[76:77], v91 offset:49152
v_mfma_f32_16x16x32_bf16 v[120:123], v[124:127], v[60:63], v[120:123]
ds_read_b64_tr_b16 a[78:79], v91 offset:53248
v_mfma_f32_16x16x32_bf16 v[32:35], a[0:3], a[96:99], v[72:75]
ds_read_b64_tr_b16 a[80:81], v92 offset:49152
v_mfma_f32_16x16x32_bf16 v[32:35], a[4:7], a[100:103], v[32:35]
ds_read_b64_tr_b16 a[82:83], v92 offset:53248
v_mfma_f32_16x16x32_bf16 v[32:35], a[8:11], a[104:107], v[32:35]
ds_read_b64_tr_b16 a[84:85], v93 offset:49152
v_mfma_f32_16x16x32_bf16 v[32:35], a[12:15], a[108:111], v[32:35]
ds_read_b64_tr_b16 a[86:87], v93 offset:53248
v_mfma_f32_16x16x32_bf16 v[36:39], a[16:19], a[96:99], v[72:75]
ds_read_b64_tr_b16 a[88:89], v94 offset:49152
v_mfma_f32_16x16x32_bf16 v[36:39], a[20:23], a[100:103], v[36:39]
ds_read_b64_tr_b16 a[90:91], v94 offset:53248
v_mfma_f32_16x16x32_bf16 v[36:39], a[24:27], a[104:107], v[36:39]
ds_read_b64_tr_b16 a[92:93], v95 offset:49152
v_mfma_f32_16x16x32_bf16 v[36:39], a[28:31], a[108:111], v[36:39]
ds_read_b64_tr_b16 a[94:95], v95 offset:53248
v_mfma_f32_16x16x32_bf16 v[40:43], a[0:3], a[112:115], v[76:79]
v_exp_f32 v30, v30
v_mfma_f32_16x16x32_bf16 v[40:43], a[4:7], a[116:119], v[40:43]
v_exp_f32 v31, v31
v_mfma_f32_16x16x32_bf16 v[40:43], a[8:11], a[120:123], v[40:43]
v_exp_f32 v32, v32
v_mfma_f32_16x16x32_bf16 v[40:43], a[12:15], a[124:127], v[40:43]
v_exp_f32 v33, v33
v_mfma_f32_16x16x32_bf16 v[44:47], a[16:19], a[112:115], v[76:79]
v_exp_f32 v34, v34
v_mfma_f32_16x16x32_bf16 v[44:47], a[20:23], a[116:119], v[44:47]
v_exp_f32 v35, v35
v_mfma_f32_16x16x32_bf16 v[44:47], a[24:27], a[120:123], v[44:47]
v_exp_f32 v36, v36
v_mfma_f32_16x16x32_bf16 v[44:47], a[28:31], a[124:127], v[44:47]
s_waitcnt lgkmcnt(0)
v_exp_f32 v37, v37
v_mfma_f32_16x16x32_bf16 v[128:131], a[64:67], v[48:51], v[128:131]
ds_read_b128 a[0:3], v84 offset:57344
v_cvt_pk_bf16_f32 v55, v30, v31
v_mfma_f32_16x16x32_bf16 v[132:135], a[68:71], v[48:51], v[132:135]
ds_read_b128 a[4:7], v85 offset:57344
v_cvt_pk_bf16_f32 v56, v32, v33
v_mfma_f32_16x16x32_bf16 v[136:139], a[72:75], v[48:51], v[136:139]
ds_read_b128 a[8:11], v86 offset:57344
v_cvt_pk_bf16_f32 v57, v34, v35
v_mfma_f32_16x16x32_bf16 v[140:143], a[76:79], v[48:51], v[140:143]
ds_read_b128 a[12:15], v87 offset:57344
v_cvt_pk_bf16_f32 v58, v36, v37
v_mfma_f32_16x16x32_bf16 v[144:147], a[80:83], v[48:51], v[144:147]
ds_read_b128 a[16:19], v84 offset:61440
v_mfma_f32_16x16x32_bf16 v[148:151], a[84:87], v[48:51], v[148:151]
ds_read_b128 a[20:23], v85 offset:61440
v_mfma_f32_16x16x32_bf16 v[152:155], a[88:91], v[48:51], v[152:155]
ds_read_b128 a[24:27], v86 offset:61440
v_mfma_f32_16x16x32_bf16 v[156:159], a[92:95], v[48:51], v[156:159]
ds_read_b128 a[28:31], v87 offset:61440
v_mfma_f32_16x16x32_bf16 v[108:111], v[124:127], v[48:51], v[108:111]
v_exp_f32 v38, v38
v_mfma_f32_16x16x32_bf16 v[160:163], a[64:67], v[52:55], v[160:163]
v_exp_f32 v39, v39
v_mfma_f32_16x16x32_bf16 v[164:167], a[68:71], v[52:55], v[164:167]
v_exp_f32 v40, v40
v_mfma_f32_16x16x32_bf16 v[168:171], a[72:75], v[52:55], v[168:171]
v_exp_f32 v41, v41
v_mfma_f32_16x16x32_bf16 v[172:175], a[76:79], v[52:55], v[172:175]
v_exp_f32 v42, v42
v_mfma_f32_16x16x32_bf16 v[176:179], a[80:83], v[52:55], v[176:179]
v_exp_f32 v43, v43
v_mfma_f32_16x16x32_bf16 v[180:183], a[84:87], v[52:55], v[180:183]
v_exp_f32 v44, v44
v_mfma_f32_16x16x32_bf16 v[184:187], a[88:91], v[52:55], v[184:187]
v_exp_f32 v45, v45
v_mfma_f32_16x16x32_bf16 v[188:191], a[92:95], v[52:55], v[188:191]
v_exp_f32 v46, v46
v_mfma_f32_16x16x32_bf16 v[112:115], v[124:127], v[52:55], v[112:115]
s_waitcnt lgkmcnt(0)
v_exp_f32 v47, v47
v_mfma_f32_16x16x32_bf16 v[16:19], a[0:3], a[32:35], v[64:67]
v_cvt_pk_bf16_f32 v59, v38, v39
v_cvt_pk_bf16_f32 v60, v40, v41
v_mfma_f32_16x16x32_bf16 v[16:19], a[4:7], a[36:39], v[16:19]
v_cvt_pk_bf16_f32 v61, v42, v43
v_cvt_pk_bf16_f32 v62, v44, v45
v_mfma_f32_16x16x32_bf16 v[16:19], a[8:11], a[40:43], v[16:19]
v_cvt_pk_bf16_f32 v63, v46, v47
v_mfma_f32_16x16x32_bf16 v[16:19], a[12:15], a[44:47], v[16:19]
v_mfma_f32_16x16x32_bf16 v[20:23], a[16:19], a[32:35], v[64:67]
v_mfma_f32_16x16x32_bf16 v[20:23], a[20:23], a[36:39], v[20:23]
s_add_u32 s39, s39, 1
v_mfma_f32_16x16x32_bf16 v[20:23], a[24:27], a[40:43], v[20:23]
v_mov_b32 v80, s39
v_mfma_f32_16x16x32_bf16 v[20:23], a[28:31], a[44:47], v[20:23]
v_mfma_f32_16x16x32_bf16 v[24:27], a[0:3], a[48:51], v[68:71]
s_waitcnt vmcnt(63)
ds_write_b32 v1, v80
v_mfma_f32_16x16x32_bf16 v[24:27], a[4:7], a[52:55], v[24:27]
v_exp_f32 v16, v16
v_mfma_f32_16x16x32_bf16 v[24:27], a[8:11], a[56:59], v[24:27]
v_exp_f32 v17, v17
v_mfma_f32_16x16x32_bf16 v[24:27], a[12:15], a[60:63], v[24:27]
v_cvt_pk_bf16_f32 v48, v16, v17
v_mfma_f32_16x16x32_bf16 v[28:31], a[16:19], a[48:51], v[68:71]
v_exp_f32 v18, v18
v_mfma_f32_16x16x32_bf16 v[28:31], a[20:23], a[52:55], v[28:31]
v_exp_f32 v19, v19
v_mfma_f32_16x16x32_bf16 v[28:31], a[24:27], a[56:59], v[28:31]
v_exp_f32 v20, v20
v_mfma_f32_16x16x32_bf16 v[28:31], a[28:31], a[60:63], v[28:31]
v_exp_f32 v21, v21
v_mfma_f32_16x16x32_bf16 v[192:195], a[64:67], v[56:59], v[192:195]
v_exp_f32 v22, v22
v_mfma_f32_16x16x32_bf16 v[196:199], a[68:71], v[56:59], v[196:199]
v_cvt_pk_bf16_f32 v49, v18, v19
v_mfma_f32_16x16x32_bf16 v[200:203], a[72:75], v[56:59], v[200:203]
v_exp_f32 v23, v23
v_mfma_f32_16x16x32_bf16 v[204:207], a[76:79], v[56:59], v[204:207]
v_exp_f32 v24, v24
v_mfma_f32_16x16x32_bf16 v[208:211], a[80:83], v[56:59], v[208:211]
v_exp_f32 v25, v25
v_mfma_f32_16x16x32_bf16 v[212:215], a[84:87], v[56:59], v[212:215]
v_exp_f32 v26, v26
v_mfma_f32_16x16x32_bf16 v[216:219], a[88:91], v[56:59], v[216:219]
v_exp_f32 v27, v27
v_mfma_f32_16x16x32_bf16 v[220:223], a[92:95], v[56:59], v[220:223]
v_cvt_pk_bf16_f32 v50, v20, v21
v_mfma_f32_16x16x32_bf16 v[116:119], v[124:127], v[56:59], v[116:119]
v_exp_f32 v28, v28
v_mfma_f32_16x16x32_bf16 v[224:227], a[64:67], v[60:63], v[224:227]
v_exp_f32 v29, v29
v_mfma_f32_16x16x32_bf16 v[228:231], a[68:71], v[60:63], v[228:231]
ds_read_b64_tr_b16 a[64:65], v88 offset:57344
v_cvt_pk_bf16_f32 v51, v22, v23
v_mfma_f32_16x16x32_bf16 v[232:235], a[72:75], v[60:63], v[232:235]
ds_read_b64_tr_b16 a[66:67], v88 offset:61440
v_cvt_pk_bf16_f32 v52, v24, v25
v_mfma_f32_16x16x32_bf16 v[236:239], a[76:79], v[60:63], v[236:239]
ds_read_b64_tr_b16 a[68:69], v89 offset:57344
v_cvt_pk_bf16_f32 v53, v26, v27
v_mfma_f32_16x16x32_bf16 v[240:243], a[80:83], v[60:63], v[240:243]
ds_read_b64_tr_b16 a[70:71], v89 offset:61440
v_cvt_pk_bf16_f32 v54, v28, v29
v_mfma_f32_16x16x32_bf16 v[244:247], a[84:87], v[60:63], v[244:247]
ds_read_b64_tr_b16 a[72:73], v90 offset:57344
v_mfma_f32_16x16x32_bf16 v[248:251], a[88:91], v[60:63], v[248:251]
ds_read_b64_tr_b16 a[74:75], v90 offset:61440
v_mfma_f32_16x16x32_bf16 v[252:255], a[92:95], v[60:63], v[252:255]
ds_read_b64_tr_b16 a[76:77], v91 offset:57344
v_mfma_f32_16x16x32_bf16 v[120:123], v[124:127], v[60:63], v[120:123]
ds_read_b64_tr_b16 a[78:79], v91 offset:61440
v_mfma_f32_16x16x32_bf16 v[32:35], a[0:3], a[96:99], v[72:75]
ds_read_b64_tr_b16 a[80:81], v92 offset:57344
v_mfma_f32_16x16x32_bf16 v[32:35], a[4:7], a[100:103], v[32:35]
ds_read_b64_tr_b16 a[82:83], v92 offset:61440
ds_read_b128 v[80:83], v101
v_mfma_f32_16x16x32_bf16 v[32:35], a[8:11], a[104:107], v[32:35]
ds_read_b64_tr_b16 a[84:85], v93 offset:57344
v_mfma_f32_16x16x32_bf16 v[32:35], a[12:15], a[108:111], v[32:35]
ds_read_b64_tr_b16 a[86:87], v93 offset:61440
v_mfma_f32_16x16x32_bf16 v[36:39], a[16:19], a[96:99], v[72:75]
s_waitcnt lgkmcnt(2)
ds_read_b64_tr_b16 a[88:89], v94 offset:57344
v_min3_u32 v80, v80, v81, v82
v_mfma_f32_16x16x32_bf16 v[36:39], a[20:23], a[100:103], v[36:39]
ds_read_b64_tr_b16 a[90:91], v94 offset:61440
v_min_u32 v80, v80, v83
v_mfma_f32_16x16x32_bf16 v[36:39], a[24:27], a[104:107], v[36:39]
ds_read_b64_tr_b16 a[92:93], v95 offset:57344
v_cmp_gt_u32 vcc, s39, v80
v_mfma_f32_16x16x32_bf16 v[36:39], a[28:31], a[108:111], v[36:39]
s_cbranch_vccnz L_fs39_4
L_fr39_4:
ds_read_b64_tr_b16 a[94:95], v95 offset:61440
v_mfma_f32_16x16x32_bf16 v[40:43], a[0:3], a[112:115], v[76:79]
v_exp_f32 v30, v30
v_mfma_f32_16x16x32_bf16 v[40:43], a[4:7], a[116:119], v[40:43]
v_exp_f32 v31, v31
v_mfma_f32_16x16x32_bf16 v[40:43], a[8:11], a[120:123], v[40:43]
v_exp_f32 v32, v32
v_mfma_f32_16x16x32_bf16 v[40:43], a[12:15], a[124:127], v[40:43]
v_exp_f32 v33, v33
v_mfma_f32_16x16x32_bf16 v[44:47], a[16:19], a[112:115], v[76:79]
v_exp_f32 v34, v34
v_mfma_f32_16x16x32_bf16 v[44:47], a[20:23], a[116:119], v[44:47]
v_exp_f32 v35, v35
v_mfma_f32_16x16x32_bf16 v[44:47], a[24:27], a[120:123], v[44:47]
v_exp_f32 v36, v36
v_mfma_f32_16x16x32_bf16 v[44:47], a[28:31], a[124:127], v[44:47]
s_waitcnt lgkmcnt(0)
v_exp_f32 v37, v37
v_mfma_f32_16x16x32_bf16 v[128:131], a[64:67], v[48:51], v[128:131]
ds_read_b128 a[0:3], v84 offset:0
v_cvt_pk_bf16_f32 v55, v30, v31
v_mfma_f32_16x16x32_bf16 v[132:135], a[68:71], v[48:51], v[132:135]
ds_read_b128 a[4:7], v85 offset:0
v_cvt_pk_bf16_f32 v56, v32, v33
v_mfma_f32_16x16x32_bf16 v[136:139], a[72:75], v[48:51], v[136:139]
ds_read_b128 a[8:11], v86 offset:0
v_cvt_pk_bf16_f32 v57, v34, v35
v_mfma_f32_16x16x32_bf16 v[140:143], a[76:79], v[48:51], v[140:143]
ds_read_b128 a[12:15], v87 offset:0
v_cvt_pk_bf16_f32 v58, v36, v37
v_mfma_f32_16x16x32_bf16 v[144:147], a[80:83], v[48:51], v[144:147]
ds_read_b128 a[16:19], v84 offset:4096
v_mfma_f32_16x16x32_bf16 v[148:151], a[84:87], v[48:51], v[148:151]
ds_read_b128 a[20:23], v85 offset:4096
v_mfma_f32_16x16x32_bf16 v[152:155], a[88:91], v[48:51], v[152:155]
ds_read_b128 a[24:27], v86 offset:4096
v_mfma_f32_16x16x32_bf16 v[156:159], a[92:95], v[48:51], v[156:159]
ds_read_b128 a[28:31], v87 offset:4096
v_mfma_f32_16x16x32_bf16 v[108:111], v[124:127], v[48:51], v[108:111]
v_exp_f32 v38, v38
v_mfma_f32_16x16x32_bf16 v[160:163], a[64:67], v[52:55], v[160:163]
v_exp_f32 v39, v39
v_mfma_f32_16x16x32_bf16 v[164:167], a[68:71], v[52:55], v[164:167]
v_exp_f32 v40, v40
v_mfma_f32_16x16x32_bf16 v[168:171], a[72:75], v[52:55], v[168:171]
v_exp_f32 v41, v41
v_mfma_f32_16x16x32_bf16 v[172:175], a[76:79], v[52:55], v[172:175]
v_exp_f32 v42, v42
v_mfma_f32_16x16x32_bf16 v[176:179], a[80:83], v[52:55], v[176:179]
v_exp_f32 v43, v43
v_mfma_f32_16x16x32_bf16 v[180:183], a[84:87], v[52:55], v[180:183]
v_exp_f32 v44, v44
v_mfma_f32_16x16x32_bf16 v[184:187], a[88:91], v[52:55], v[184:187]
v_exp_f32 v45, v45
v_mfma_f32_16x16x32_bf16 v[188:191], a[92:95], v[52:55], v[188:191]
v_exp_f32 v46, v46
v_mfma_f32_16x16x32_bf16 v[112:115], v[124:127], v[52:55], v[112:115]
s_waitcnt lgkmcnt(0)
v_exp_f32 v47, v47
s_branch L_atin4
L_fin4:
v_mfma_f32_16x16x32_bf16 v[16:19], a[0:3], a[32:35], v[64:67]
v_cvt_pk_bf16_f32 v59, v38, v39
v_cvt_pk_bf16_f32 v60, v40, v41
v_mfma_f32_16x16x32_bf16 v[16:19], a[4:7], a[36:39], v[16:19]
v_cvt_pk_bf16_f32 v61, v42, v43
v_cvt_pk_bf16_f32 v62, v44, v45
v_mfma_f32_16x16x32_bf16 v[16:19], a[8:11], a[40:43], v[16:19]
v_cvt_pk_bf16_f32 v63, v46, v47
v_mfma_f32_16x16x32_bf16 v[16:19], a[12:15], a[44:47], v[16:19]
v_mfma_f32_16x16x32_bf16 v[20:23], a[16:19], a[32:35], v[64:67]
v_mfma_f32_16x16x32_bf16 v[20:23], a[20:23], a[36:39], v[20:23]
v_mfma_f32_16x16x32_bf16 v[20:23], a[24:27], a[40:43], v[20:23]
buffer_load_dword v107, v11, s[48:51], 0 offen sc1
v_mfma_f32_16x16x32_bf16 v[20:23], a[28:31], a[44:47], v[20:23]
v_mfma_f32_16x16x32_bf16 v[24:27], a[0:3], a[48:51], v[68:71]
v_mfma_f32_16x16x32_bf16 v[24:27], a[4:7], a[52:55], v[24:27]
s_nop 0
v_exp_f32 v16, v16
v_mfma_f32_16x16x32_bf16 v[24:27], a[8:11], a[56:59], v[24:27]
v_exp_f32 v17, v17
v_mfma_f32_16x16x32_bf16 v[24:27], a[12:15], a[60:63], v[24:27]
v_cvt_pk_bf16_f32 v48, v16, v17
v_mfma_f32_16x16x32_bf16 v[28:31], a[16:19], a[48:51], v[68:71]
v_exp_f32 v18, v18
v_mfma_f32_16x16x32_bf16 v[28:31], a[20:23], a[52:55], v[28:31]
v_exp_f32 v19, v19
v_mfma_f32_16x16x32_bf16 v[28:31], a[24:27], a[56:59], v[28:31]
v_exp_f32 v20, v20
v_mfma_f32_16x16x32_bf16 v[28:31], a[28:31], a[60:63], v[28:31]
v_exp_f32 v21, v21
v_mfma_f32_16x16x32_bf16 v[192:195], a[64:67], v[56:59], v[192:195]
v_exp_f32 v22, v22
v_mfma_f32_16x16x32_bf16 v[196:199], a[68:71], v[56:59], v[196:199]
v_cvt_pk_bf16_f32 v49, v18, v19
v_mfma_f32_16x16x32_bf16 v[200:203], a[72:75], v[56:59], v[200:203]
v_exp_f32 v23, v23
v_mfma_f32_16x16x32_bf16 v[204:207], a[76:79], v[56:59], v[204:207]
v_exp_f32 v24, v24
v_mfma_f32_16x16x32_bf16 v[208:211], a[80:83], v[56:59], v[208:211]
v_exp_f32 v25, v25
v_mfma_f32_16x16x32_bf16 v[212:215], a[84:87], v[56:59], v[212:215]
v_exp_f32 v26, v26
v_mfma_f32_16x16x32_bf16 v[216:219], a[88:91], v[56:59], v[216:219]
v_exp_f32 v27, v27
v_mfma_f32_16x16x32_bf16 v[220:223], a[92:95], v[56:59], v[220:223]
v_cvt_pk_bf16_f32 v50, v20, v21
v_mfma_f32_16x16x32_bf16 v[116:119], v[124:127], v[56:59], v[116:119]
v_exp_f32 v28, v28
v_mfma_f32_16x16x32_bf16 v[224:227], a[64:67], v[60:63], v[224:227]
v_exp_f32 v29, v29
v_mfma_f32_16x16x32_bf16 v[228:231], a[68:71], v[60:63], v[228:231]
ds_read_b64_tr_b16 a[64:65], v88 offset:0
v_cvt_pk_bf16_f32 v51, v22, v23
v_mfma_f32_16x16x32_bf16 v[232:235], a[72:75], v[60:63], v[232:235]
ds_read_b64_tr_b16 a[66:67], v88 offset:4096
v_cvt_pk_bf16_f32 v52, v24, v25
v_mfma_f32_16x16x32_bf16 v[236:239], a[76:79], v[60:63], v[236:239]
ds_read_b64_tr_b16 a[68:69], v89 offset:0
v_cvt_pk_bf16_f32 v53, v26, v27
v_mfma_f32_16x16x32_bf16 v[240:243], a[80:83], v[60:63], v[240:243]
ds_read_b64_tr_b16 a[70:71], v89 offset:4096
v_cvt_pk_bf16_f32 v54, v28, v29
v_mfma_f32_16x16x32_bf16 v[244:247], a[84:87], v[60:63], v[244:247]
ds_read_b64_tr_b16 a[72:73], v90 offset:0
v_mfma_f32_16x16x32_bf16 v[248:251], a[88:91], v[60:63], v[248:251]
ds_read_b64_tr_b16 a[74:75], v90 offset:4096
v_mfma_f32_16x16x32_bf16 v[252:255], a[92:95], v[60:63], v[252:255]
ds_read_b64_tr_b16 a[76:77], v91 offset:0
v_mfma_f32_16x16x32_bf16 v[120:123], v[124:127], v[60:63], v[120:123]
ds_read_b64_tr_b16 a[78:79], v91 offset:4096
v_mfma_f32_16x16x32_bf16 v[32:35], a[0:3], a[96:99], v[72:75]
ds_read_b64_tr_b16 a[80:81], v92 offset:0
v_mfma_f32_16x16x32_bf16 v[32:35], a[4:7], a[100:103], v[32:35]
ds_read_b64_tr_b16 a[82:83], v92 offset:4096
v_mfma_f32_16x16x32_bf16 v[32:35], a[8:11], a[104:107], v[32:35]
ds_read_b64_tr_b16 a[84:85], v93 offset:0
v_mfma_f32_16x16x32_bf16 v[32:35], a[12:15], a[108:111], v[32:35]
ds_read_b64_tr_b16 a[86:87], v93 offset:4096
v_mfma_f32_16x16x32_bf16 v[36:39], a[16:19], a[96:99], v[72:75]
ds_read_b64_tr_b16 a[88:89], v94 offset:0
v_mfma_f32_16x16x32_bf16 v[36:39], a[20:23], a[100:103], v[36:39]
ds_read_b64_tr_b16 a[90:91], v94 offset:4096
v_mfma_f32_16x16x32_bf16 v[36:39], a[24:27], a[104:107], v[36:39]
ds_read_b64_tr_b16 a[92:93], v95 offset:0
v_mfma_f32_16x16x32_bf16 v[36:39], a[28:31], a[108:111], v[36:39]
ds_read_b64_tr_b16 a[94:95], v95 offset:4096
v_mfma_f32_16x16x32_bf16 v[40:43], a[0:3], a[112:115], v[76:79]
v_exp_f32 v30, v30
v_mfma_f32_16x16x32_bf16 v[40:43], a[4:7], a[116:119], v[40:43]
v_exp_f32 v31, v31
v_mfma_f32_16x16x32_bf16 v[40:43], a[8:11], a[120:123], v[40:43]
v_exp_f32 v32, v32
v_mfma_f32_16x16x32_bf16 v[40:43], a[12:15], a[124:127], v[40:43]
v_exp_f32 v33, v33
v_mfma_f32_16x16x32_bf16 v[44:47], a[16:19], a[112:115], v[76:79]
v_exp_f32 v34, v34
v_mfma_f32_16x16x32_bf16 v[44:47], a[20:23], a[116:119], v[44:47]
v_exp_f32 v35, v35
v_mfma_f32_16x16x32_bf16 v[44:47], a[24:27], a[120:123], v[44:47]
v_exp_f32 v36, v36
v_mfma_f32_16x16x32_bf16 v[44:47], a[28:31], a[124:127], v[44:47]
s_waitcnt lgkmcnt(0)
v_exp_f32 v37, v37
v_mfma_f32_16x16x32_bf16 v[128:131], a[64:67], v[48:51], v[128:131]
ds_read_b128 a[0:3], v84 offset:8192
v_cvt_pk_bf16_f32 v55, v30, v31
v_mfma_f32_16x16x32_bf16 v[132:135], a[68:71], v[48:51], v[132:135]
ds_read_b128 a[4:7], v85 offset:8192
v_cvt_pk_bf16_f32 v56, v32, v33
v_mfma_f32_16x16x32_bf16 v[136:139], a[72:75], v[48:51], v[136:139]
ds_read_b128 a[8:11], v86 offset:8192
v_cvt_pk_bf16_f32 v57, v34, v35
v_mfma_f32_16x16x32_bf16 v[140:143], a[76:79], v[48:51], v[140:143]
ds_read_b128 a[12:15], v87 offset:8192
v_cvt_pk_bf16_f32 v58, v36, v37
v_mfma_f32_16x16x32_bf16 v[144:147], a[80:83], v[48:51], v[144:147]
ds_read_b128 a[16:19], v84 offset:12288
v_mfma_f32_16x16x32_bf16 v[148:151], a[84:87], v[48:51], v[148:151]
ds_read_b128 a[20:23], v85 offset:12288
v_mfma_f32_16x16x32_bf16 v[152:155], a[88:91], v[48:51], v[152:155]
ds_read_b128 a[24:27], v86 offset:12288
v_mfma_f32_16x16x32_bf16 v[156:159], a[92:95], v[48:51], v[156:159]
ds_read_b128 a[28:31], v87 offset:12288
v_mfma_f32_16x16x32_bf16 v[108:111], v[124:127], v[48:51], v[108:111]
v_exp_f32 v38, v38
v_mfma_f32_16x16x32_bf16 v[160:163], a[64:67], v[52:55], v[160:163]
v_exp_f32 v39, v39
v_mfma_f32_16x16x32_bf16 v[164:167], a[68:71], v[52:55], v[164:167]
v_exp_f32 v40, v40
v_mfma_f32_16x16x32_bf16 v[168:171], a[72:75], v[52:55], v[168:171]
v_exp_f32 v41, v41
v_mfma_f32_16x16x32_bf16 v[172:175], a[76:79], v[52:55], v[172:175]
v_exp_f32 v42, v42
v_mfma_f32_16x16x32_bf16 v[176:179], a[80:83], v[52:55], v[176:179]
v_exp_f32 v43, v43
v_mfma_f32_16x16x32_bf16 v[180:183], a[84:87], v[52:55], v[180:183]
v_exp_f32 v44, v44
v_mfma_f32_16x16x32_bf16 v[184:187], a[88:91], v[52:55], v[184:187]
v_exp_f32 v45, v45
v_mfma_f32_16x16x32_bf16 v[188:191], a[92:95], v[52:55], v[188:191]
v_exp_f32 v46, v46
v_mfma_f32_16x16x32_bf16 v[112:115], v[124:127], v[52:55], v[112:115]
s_waitcnt lgkmcnt(0)
v_exp_f32 v47, v47
v_mfma_f32_16x16x32_bf16 v[16:19], a[0:3], a[32:35], v[64:67]
v_cvt_pk_bf16_f32 v59, v38, v39
v_cvt_pk_bf16_f32 v60, v40, v41
v_mfma_f32_16x16x32_bf16 v[16:19], a[4:7], a[36:39], v[16:19]
v_cvt_pk_bf16_f32 v61, v42, v43
v_cvt_pk_bf16_f32 v62, v44, v45
v_mfma_f32_16x16x32_bf16 v[16:19], a[8:11], a[40:43], v[16:19]
v_cvt_pk_bf16_f32 v63, v46, v47
v_mfma_f32_16x16x32_bf16 v[16:19], a[12:15], a[44:47], v[16:19]
v_mfma_f32_16x16x32_bf16 v[20:23], a[16:19], a[32:35], v[64:67]
v_mfma_f32_16x16x32_bf16 v[20:23], a[20:23], a[36:39], v[20:23]
s_add_u32 s39, s39, 1
v_mfma_f32_16x16x32_bf16 v[20:23], a[24:27], a[40:43], v[20:23]
v_mov_b32 v80, s39
v_mfma_f32_16x16x32_bf16 v[20:23], a[28:31], a[44:47], v[20:23]
v_mfma_f32_16x16x32_bf16 v[24:27], a[0:3], a[48:51], v[68:71]
s_waitcnt vmcnt(63)
ds_write_b32 v1, v80
v_mfma_f32_16x16x32_bf16 v[24:27], a[4:7], a[52:55], v[24:27]
v_exp_f32 v16, v16
v_mfma_f32_16x16x32_bf16 v[24:27], a[8:11], a[56:59], v[24:27]
v_exp_f32 v17, v17
v_mfma_f32_16x16x32_bf16 v[24:27], a[12:15], a[60:63], v[24:27]
v_cvt_pk_bf16_f32 v48, v16, v17
v_mfma_f32_16x16x32_bf16 v[28:31], a[16:19], a[48:51], v[68:71]
v_exp_f32 v18, v18
v_mfma_f32_16x16x32_bf16 v[28:31], a[20:23], a[52:55], v[28:31]
v_exp_f32 v19, v19
v_mfma_f32_16x16x32_bf16 v[28:31], a[24:27], a[56:59], v[28:31]
v_exp_f32 v20, v20
v_mfma_f32_16x16x32_bf16 v[28:31], a[28:31], a[60:63], v[28:31]
v_exp_f32 v21, v21
v_mfma_f32_16x16x32_bf16 v[192:195], a[64:67], v[56:59], v[192:195]
v_exp_f32 v22, v22
v_mfma_f32_16x16x32_bf16 v[196:199], a[68:71], v[56:59], v[196:199]
v_cvt_pk_bf16_f32 v49, v18, v19
v_mfma_f32_16x16x32_bf16 v[200:203], a[72:75], v[56:59], v[200:203]
v_exp_f32 v23, v23
v_mfma_f32_16x16x32_bf16 v[204:207], a[76:79], v[56:59], v[204:207]
v_exp_f32 v24, v24
v_mfma_f32_16x16x32_bf16 v[208:211], a[80:83], v[56:59], v[208:211]
v_exp_f32 v25, v25
v_mfma_f32_16x16x32_bf16 v[212:215], a[84:87], v[56:59], v[212:215]
v_exp_f32 v26, v26
v_mfma_f32_16x16x32_bf16 v[216:219], a[88:91], v[56:59], v[216:219]
v_exp_f32 v27, v27
v_mfma_f32_16x16x32_bf16 v[220:223], a[92:95], v[56:59], v[220:223]
v_cvt_pk_bf16_f32 v50, v20, v21
v_mfma_f32_16x16x32_bf16 v[116:119], v[124:127], v[56:59], v[116:119]
v_exp_f32 v28, v28
v_mfma_f32_16x16x32_bf16 v[224:227], a[64:67], v[60:63], v[224:227]
v_exp_f32 v29, v29
v_mfma_f32_16x16x32_bf16 v[228:231], a[68:71], v[60:63], v[228:231]
ds_read_b64_tr_b16 a[64:65], v88 offset:8192
v_cvt_pk_bf16_f32 v51, v22, v23
v_mfma_f32_16x16x32_bf16 v[232:235], a[72:75], v[60:63], v[232:235]
ds_read_b64_tr_b16 a[66:67], v88 offset:12288
v_cvt_pk_bf16_f32 v52, v24, v25
v_mfma_f32_16x16x32_bf16 v[236:239], a[76:79], v[60:63], v[236:239]
ds_read_b64_tr_b16 a[68:69], v89 offset:8192
v_cvt_pk_bf16_f32 v53, v26, v27
v_mfma_f32_16x16x32_bf16 v[240:243], a[80:83], v[60:63], v[240:243]
ds_read_b64_tr_b16 a[70:71], v89 offset:12288
v_cvt_pk_bf16_f32 v54, v28, v29
v_mfma_f32_16x16x32_bf16 v[244:247], a[84:87], v[60:63], v[244:247]
ds_read_b64_tr_b16 a[72:73], v90 offset:8192
v_mfma_f32_16x16x32_bf16 v[248:251], a[88:91], v[60:63], v[248:251]
ds_read_b64_tr_b16 a[74:75], v90 offset:12288
v_mfma_f32_16x16x32_bf16 v[252:255], a[92:95], v[60:63], v[252:255]
ds_read_b64_tr_b16 a[76:77], v91 offset:8192
v_mfma_f32_16x16x32_bf16 v[120:123], v[124:127], v[60:63], v[120:123]
ds_read_b64_tr_b16 a[78:79], v91 offset:12288
v_mfma_f32_16x16x32_bf16 v[32:35], a[0:3], a[96:99], v[72:75]
ds_read_b64_tr_b16 a[80:81], v92 offset:8192
v_mfma_f32_16x16x32_bf16 v[32:35], a[4:7], a[100:103], v[32:35]
ds_read_b64_tr_b16 a[82:83], v92 offset:12288
ds_read_b128 v[80:83], v101
v_mfma_f32_16x16x32_bf16 v[32:35], a[8:11], a[104:107], v[32:35]
ds_read_b64_tr_b16 a[84:85], v93 offset:8192
v_mfma_f32_16x16x32_bf16 v[32:35], a[12:15], a[108:111], v[32:35]
ds_read_b64_tr_b16 a[86:87], v93 offset:12288
v_mfma_f32_16x16x32_bf16 v[36:39], a[16:19], a[96:99], v[72:75]
s_waitcnt lgkmcnt(2)
ds_read_b64_tr_b16 a[88:89], v94 offset:8192
v_min3_u32 v80, v80, v81, v82
v_mfma_f32_16x16x32_bf16 v[36:39], a[20:23], a[100:103], v[36:39]
ds_read_b64_tr_b16 a[90:91], v94 offset:12288
v_min_u32 v80, v80, v83
v_mfma_f32_16x16x32_bf16 v[36:39], a[24:27], a[104:107], v[36:39]
ds_read_b64_tr_b16 a[92:93], v95 offset:8192
v_cmp_gt_u32 vcc, s39, v80
v_mfma_f32_16x16x32_bf16 v[36:39], a[28:31], a[108:111], v[36:39]
s_cbranch_vccnz L_fs57_4
L_fr57_4:
ds_read_b64_tr_b16 a[94:95], v95 offset:12288
v_mfma_f32_16x16x32_bf16 v[40:43], a[0:3], a[112:115], v[76:79]
v_exp_f32 v30, v30
v_mfma_f32_16x16x32_bf16 v[40:43], a[4:7], a[116:119], v[40:43]
v_exp_f32 v31, v31
v_mfma_f32_16x16x32_bf16 v[40:43], a[8:11], a[120:123], v[40:43]
v_exp_f32 v32, v32
v_mfma_f32_16x16x32_bf16 v[40:43], a[12:15], a[124:127], v[40:43]
v_exp_f32 v33, v33
v_mfma_f32_16x16x32_bf16 v[44:47], a[16:19], a[112:115], v[76:79]
v_exp_f32 v34, v34
v_mfma_f32_16x16x32_bf16 v[44:47], a[20:23], a[116:119], v[44:47]
v_exp_f32 v35, v35
v_mfma_f32_16x16x32_bf16 v[44:47], a[24:27], a[120:123], v[44:47]
v_exp_f32 v36, v36
v_mfma_f32_16x16x32_bf16 v[44:47], a[28:31], a[124:127], v[44:47]
s_waitcnt lgkmcnt(0)
v_exp_f32 v37, v37
v_mfma_f32_16x16x32_bf16 v[128:131], a[64:67], v[48:51], v[128:131]
ds_read_b128 a[0:3], v84 offset:16384
v_cvt_pk_bf16_f32 v55, v30, v31
v_mfma_f32_16x16x32_bf16 v[132:135], a[68:71], v[48:51], v[132:135]
ds_read_b128 a[4:7], v85 offset:16384
v_cvt_pk_bf16_f32 v56, v32, v33
v_mfma_f32_16x16x32_bf16 v[136:139], a[72:75], v[48:51], v[136:139]
ds_read_b128 a[8:11], v86 offset:16384
v_cvt_pk_bf16_f32 v57, v34, v35
v_mfma_f32_16x16x32_bf16 v[140:143], a[76:79], v[48:51], v[140:143]
ds_read_b128 a[12:15], v87 offset:16384
v_cvt_pk_bf16_f32 v58, v36, v37
v_mfma_f32_16x16x32_bf16 v[144:147], a[80:83], v[48:51], v[144:147]
ds_read_b128 a[16:19], v84 offset:20480
v_mfma_f32_16x16x32_bf16 v[148:151], a[84:87], v[48:51], v[148:151]
ds_read_b128 a[20:23], v85 offset:20480
v_mfma_f32_16x16x32_bf16 v[152:155], a[88:91], v[48:51], v[152:155]
ds_read_b128 a[24:27], v86 offset:20480
v_mfma_f32_16x16x32_bf16 v[156:159], a[92:95], v[48:51], v[156:159]
ds_read_b128 a[28:31], v87 offset:20480
v_mfma_f32_16x16x32_bf16 v[108:111], v[124:127], v[48:51], v[108:111]
v_exp_f32 v38, v38
v_mfma_f32_16x16x32_bf16 v[160:163], a[64:67], v[52:55], v[160:163]
v_exp_f32 v39, v39
v_mfma_f32_16x16x32_bf16 v[164:167], a[68:71], v[52:55], v[164:167]
v_exp_f32 v40, v40
v_mfma_f32_16x16x32_bf16 v[168:171], a[72:75], v[52:55], v[168:171]
v_exp_f32 v41, v41
v_mfma_f32_16x16x32_bf16 v[172:175], a[76:79], v[52:55], v[172:175]
v_exp_f32 v42, v42
v_mfma_f32_16x16x32_bf16 v[176:179], a[80:83], v[52:55], v[176:179]
v_exp_f32 v43, v43
v_mfma_f32_16x16x32_bf16 v[180:183], a[84:87], v[52:55], v[180:183]
v_exp_f32 v44, v44
v_mfma_f32_16x16x32_bf16 v[184:187], a[88:91], v[52:55], v[184:187]
v_exp_f32 v45, v45
v_mfma_f32_16x16x32_bf16 v[188:191], a[92:95], v[52:55], v[188:191]
v_exp_f32 v46, v46
v_mfma_f32_16x16x32_bf16 v[112:115], v[124:127], v[52:55], v[112:115]
s_waitcnt lgkmcnt(0)
v_exp_f32 v47, v47
v_mfma_f32_16x16x32_bf16 v[16:19], a[0:3], a[32:35], v[64:67]
v_cvt_pk_bf16_f32 v59, v38, v39
v_cvt_pk_bf16_f32 v60, v40, v41
v_mfma_f32_16x16x32_bf16 v[16:19], a[4:7], a[36:39], v[16:19]
v_cvt_pk_bf16_f32 v61, v42, v43
v_cvt_pk_bf16_f32 v62, v44, v45
v_mfma_f32_16x16x32_bf16 v[16:19], a[8:11], a[40:43], v[16:19]
v_cvt_pk_bf16_f32 v63, v46, v47
v_mfma_f32_16x16x32_bf16 v[16:19], a[12:15], a[44:47], v[16:19]
v_mfma_f32_16x16x32_bf16 v[20:23], a[16:19], a[32:35], v[64:67]
v_mfma_f32_16x16x32_bf16 v[20:23], a[20:23], a[36:39], v[20:23]
v_mfma_f32_16x16x32_bf16 v[20:23], a[24:27], a[40:43], v[20:23]
v_mfma_f32_16x16x32_bf16 v[20:23], a[28:31], a[44:47], v[20:23]
v_mfma_f32_16x16x32_bf16 v[24:27], a[0:3], a[48:51], v[68:71]
v_mfma_f32_16x16x32_bf16 v[24:27], a[4:7], a[52:55], v[24:27]
s_nop 1
v_exp_f32 v16, v16
v_mfma_f32_16x16x32_bf16 v[24:27], a[8:11], a[56:59], v[24:27]
v_exp_f32 v17, v17
v_mfma_f32_16x16x32_bf16 v[24:27], a[12:15], a[60:63], v[24:27]
v_cvt_pk_bf16_f32 v48, v16, v17
v_mfma_f32_16x16x32_bf16 v[28:31], a[16:19], a[48:51], v[68:71]
v_exp_f32 v18, v18
v_mfma_f32_16x16x32_bf16 v[28:31], a[20:23], a[52:55], v[28:31]
v_exp_f32 v19, v19
v_mfma_f32_16x16x32_bf16 v[28:31], a[24:27], a[56:59], v[28:31]
v_exp_f32 v20, v20
v_mfma_f32_16x16x32_bf16 v[28:31], a[28:31], a[60:63], v[28:31]
v_exp_f32 v21, v21
v_mfma_f32_16x16x32_bf16 v[192:195], a[64:67], v[56:59], v[192:195]
v_exp_f32 v22, v22
v_mfma_f32_16x16x32_bf16 v[196:199], a[68:71], v[56:59], v[196:199]
v_cvt_pk_bf16_f32 v49, v18, v19
v_mfma_f32_16x16x32_bf16 v[200:203], a[72:75], v[56:59], v[200:203]
v_exp_f32 v23, v23
v_mfma_f32_16x16x32_bf16 v[204:207], a[76:79], v[56:59], v[204:207]
v_exp_f32 v24, v24
v_mfma_f32_16x16x32_bf16 v[208:211], a[80:83], v[56:59], v[208:211]
v_exp_f32 v25, v25
v_mfma_f32_16x16x32_bf16 v[212:215], a[84:87], v[56:59], v[212:215]
v_exp_f32 v26, v26
v_mfma_f32_16x16x32_bf16 v[216:219], a[88:91], v[56:59], v[216:219]
v_exp_f32 v27, v27
v_mfma_f32_16x16x32_bf16 v[220:223], a[92:95], v[56:59], v[220:223]
v_cvt_pk_bf16_f32 v50, v20, v21
v_mfma_f32_16x16x32_bf16 v[116:119], v[124:127], v[56:59], v[116:119]
v_exp_f32 v28, v28
v_mfma_f32_16x16x32_bf16 v[224:227], a[64:67], v[60:63], v[224:227]
v_exp_f32 v29, v29
v_mfma_f32_16x16x32_bf16 v[228:231], a[68:71], v[60:63], v[228:231]
ds_read_b64_tr_b16 a[64:65], v88 offset:16384
v_cvt_pk_bf16_f32 v51, v22, v23
v_mfma_f32_16x16x32_bf16 v[232:235], a[72:75], v[60:63], v[232:235]
ds_read_b64_tr_b16 a[66:67], v88 offset:20480
v_cvt_pk_bf16_f32 v52, v24, v25
v_mfma_f32_16x16x32_bf16 v[236:239], a[76:79], v[60:63], v[236:239]
ds_read_b64_tr_b16 a[68:69], v89 offset:16384
v_cvt_pk_bf16_f32 v53, v26, v27
v_mfma_f32_16x16x32_bf16 v[240:243], a[80:83], v[60:63], v[240:243]
ds_read_b64_tr_b16 a[70:71], v89 offset:20480
v_cvt_pk_bf16_f32 v54, v28, v29
v_mfma_f32_16x16x32_bf16 v[244:247], a[84:87], v[60:63], v[244:247]
ds_read_b64_tr_b16 a[72:73], v90 offset:16384
v_mfma_f32_16x16x32_bf16 v[248:251], a[88:91], v[60:63], v[248:251]
ds_read_b64_tr_b16 a[74:75], v90 offset:20480
v_mfma_f32_16x16x32_bf16 v[252:255], a[92:95], v[60:63], v[252:255]
ds_read_b64_tr_b16 a[76:77], v91 offset:16384
v_mfma_f32_16x16x32_bf16 v[120:123], v[124:127], v[60:63], v[120:123]
ds_read_b64_tr_b16 a[78:79], v91 offset:20480
v_mfma_f32_16x16x32_bf16 v[32:35], a[0:3], a[96:99], v[72:75]
ds_read_b64_tr_b16 a[80:81], v92 offset:16384
v_mfma_f32_16x16x32_bf16 v[32:35], a[4:7], a[100:103], v[32:35]
ds_read_b64_tr_b16 a[82:83], v92 offset:20480
v_mfma_f32_16x16x32_bf16 v[32:35], a[8:11], a[104:107], v[32:35]
ds_read_b64_tr_b16 a[84:85], v93 offset:16384
v_mfma_f32_16x16x32_bf16 v[32:35], a[12:15], a[108:111], v[32:35]
ds_read_b64_tr_b16 a[86:87], v93 offset:20480
v_mfma_f32_16x16x32_bf16 v[36:39], a[16:19], a[96:99], v[72:75]
ds_read_b64_tr_b16 a[88:89], v94 offset:16384
v_mfma_f32_16x16x32_bf16 v[36:39], a[20:23], a[100:103], v[36:39]
ds_read_b64_tr_b16 a[90:91], v94 offset:20480
v_mfma_f32_16x16x32_bf16 v[36:39], a[24:27], a[104:107], v[36:39]
ds_read_b64_tr_b16 a[92:93], v95 offset:16384
v_mfma_f32_16x16x32_bf16 v[36:39], a[28:31], a[108:111], v[36:39]
ds_read_b64_tr_b16 a[94:95], v95 offset:20480
v_mfma_f32_16x16x32_bf16 v[40:43], a[0:3], a[112:115], v[76:79]
v_exp_f32 v30, v30
v_mfma_f32_16x16x32_bf16 v[40:43], a[4:7], a[116:119], v[40:43]
v_exp_f32 v31, v31
v_mfma_f32_16x16x32_bf16 v[40:43], a[8:11], a[120:123], v[40:43]
v_exp_f32 v32, v32
v_mfma_f32_16x16x32_bf16 v[40:43], a[12:15], a[124:127], v[40:43]
v_exp_f32 v33, v33
v_mfma_f32_16x16x32_bf16 v[44:47], a[16:19], a[112:115], v[76:79]
v_exp_f32 v34, v34
v_mfma_f32_16x16x32_bf16 v[44:47], a[20:23], a[116:119], v[44:47]
v_exp_f32 v35, v35
v_mfma_f32_16x16x32_bf16 v[44:47], a[24:27], a[120:123], v[44:47]
v_exp_f32 v36, v36
v_mfma_f32_16x16x32_bf16 v[44:47], a[28:31], a[124:127], v[44:47]
s_waitcnt lgkmcnt(0)
v_exp_f32 v37, v37
v_mfma_f32_16x16x32_bf16 v[128:131], a[64:67], v[48:51], v[128:131]
ds_read_b128 a[0:3], v84 offset:24576
v_cvt_pk_bf16_f32 v55, v30, v31
v_mfma_f32_16x16x32_bf16 v[132:135], a[68:71], v[48:51], v[132:135]
ds_read_b128 a[4:7], v85 offset:24576
v_cvt_pk_bf16_f32 v56, v32, v33
v_mfma_f32_16x16x32_bf16 v[136:139], a[72:75], v[48:51], v[136:139]
ds_read_b128 a[8:11], v86 offset:24576
v_cvt_pk_bf16_f32 v57, v34, v35
v_mfma_f32_16x16x32_bf16 v[140:143], a[76:79], v[48:51], v[140:143]
ds_read_b128 a[12:15], v87 offset:24576
v_cvt_pk_bf16_f32 v58, v36, v37
v_mfma_f32_16x16x32_bf16 v[144:147], a[80:83], v[48:51], v[144:147]
ds_read_b128 a[16:19], v84 offset:28672
v_mfma_f32_16x16x32_bf16 v[148:151], a[84:87], v[48:51], v[148:151]
ds_read_b128 a[20:23], v85 offset:28672
v_mfma_f32_16x16x32_bf16 v[152:155], a[88:91], v[48:51], v[152:155]
ds_read_b128 a[24:27], v86 offset:28672
v_mfma_f32_16x16x32_bf16 v[156:159], a[92:95], v[48:51], v[156:159]
ds_read_b128 a[28:31], v87 offset:28672
v_mfma_f32_16x16x32_bf16 v[108:111], v[124:127], v[48:51], v[108:111]
v_exp_f32 v38, v38
v_mfma_f32_16x16x32_bf16 v[160:163], a[64:67], v[52:55], v[160:163]
v_exp_f32 v39, v39
v_mfma_f32_16x16x32_bf16 v[164:167], a[68:71], v[52:55], v[164:167]
v_exp_f32 v40, v40
v_mfma_f32_16x16x32_bf16 v[168:171], a[72:75], v[52:55], v[168:171]
v_exp_f32 v41, v41
v_mfma_f32_16x16x32_bf16 v[172:175], a[76:79], v[52:55], v[172:175]
v_exp_f32 v42, v42
v_mfma_f32_16x16x32_bf16 v[176:179], a[80:83], v[52:55], v[176:179]
v_exp_f32 v43, v43
v_mfma_f32_16x16x32_bf16 v[180:183], a[84:87], v[52:55], v[180:183]
v_exp_f32 v44, v44
v_mfma_f32_16x16x32_bf16 v[184:187], a[88:91], v[52:55], v[184:187]
v_exp_f32 v45, v45
v_mfma_f32_16x16x32_bf16 v[188:191], a[92:95], v[52:55], v[188:191]
v_exp_f32 v46, v46
v_mfma_f32_16x16x32_bf16 v[112:115], v[124:127], v[52:55], v[112:115]
s_waitcnt lgkmcnt(0)
v_exp_f32 v47, v47
v_mfma_f32_16x16x32_bf16 v[16:19], a[0:3], a[32:35], v[64:67]
v_cvt_pk_bf16_f32 v59, v38, v39
v_cvt_pk_bf16_f32 v60, v40, v41
v_mfma_f32_16x16x32_bf16 v[16:19], a[4:7], a[36:39], v[16:19]
v_cvt_pk_bf16_f32 v61, v42, v43
v_cvt_pk_bf16_f32 v62, v44, v45
v_mfma_f32_16x16x32_bf16 v[16:19], a[8:11], a[40:43], v[16:19]
v_cvt_pk_bf16_f32 v63, v46, v47
v_mfma_f32_16x16x32_bf16 v[16:19], a[12:15], a[44:47], v[16:19]
v_mfma_f32_16x16x32_bf16 v[20:23], a[16:19], a[32:35], v[64:67]
v_mfma_f32_16x16x32_bf16 v[20:23], a[20:23], a[36:39], v[20:23]
s_add_u32 s39, s39, 1
v_mfma_f32_16x16x32_bf16 v[20:23], a[24:27], a[40:43], v[20:23]
v_mov_b32 v80, s39
v_mfma_f32_16x16x32_bf16 v[20:23], a[28:31], a[44:47], v[20:23]
v_mfma_f32_16x16x32_bf16 v[24:27], a[0:3], a[48:51], v[68:71]
s_waitcnt vmcnt(63)
ds_write_b32 v1, v80
v_mfma_f32_16x16x32_bf16 v[24:27], a[4:7], a[52:55], v[24:27]
v_exp_f32 v16, v16
v_mfma_f32_16x16x32_bf16 v[24:27], a[8:11], a[56:59], v[24:27]
v_exp_f32 v17, v17
v_mfma_f32_16x16x32_bf16 v[24:27], a[12:15], a[60:63], v[24:27]
v_cvt_pk_bf16_f32 v48, v16, v17
v_mfma_f32_16x16x32_bf16 v[28:31], a[16:19], a[48:51], v[68:71]
v_exp_f32 v18, v18
v_mfma_f32_16x16x32_bf16 v[28:31], a[20:23], a[52:55], v[28:31]
v_exp_f32 v19, v19
v_mfma_f32_16x16x32_bf16 v[28:31], a[24:27], a[56:59], v[28:31]
v_exp_f32 v20, v20
v_mfma_f32_16x16x32_bf16 v[28:31], a[28:31], a[60:63], v[28:31]
v_exp_f32 v21, v21
v_mfma_f32_16x16x32_bf16 v[192:195], a[64:67], v[56:59], v[192:195]
v_exp_f32 v22, v22
v_mfma_f32_16x16x32_bf16 v[196:199], a[68:71], v[56:59], v[196:199]
v_cvt_pk_bf16_f32 v49, v18, v19
v_mfma_f32_16x16x32_bf16 v[200:203], a[72:75], v[56:59], v[200:203]
v_exp_f32 v23, v23
v_mfma_f32_16x16x32_bf16 v[204:207], a[76:79], v[56:59], v[204:207]
v_exp_f32 v24, v24
v_mfma_f32_16x16x32_bf16 v[208:211], a[80:83], v[56:59], v[208:211]
v_exp_f32 v25, v25
v_mfma_f32_16x16x32_bf16 v[212:215], a[84:87], v[56:59], v[212:215]
v_exp_f32 v26, v26
v_mfma_f32_16x16x32_bf16 v[216:219], a[88:91], v[56:59], v[216:219]
v_exp_f32 v27, v27
v_mfma_f32_16x16x32_bf16 v[220:223], a[92:95], v[56:59], v[220:223]
v_cvt_pk_bf16_f32 v50, v20, v21
v_mfma_f32_16x16x32_bf16 v[116:119], v[124:127], v[56:59], v[116:119]
v_exp_f32 v28, v28
v_mfma_f32_16x16x32_bf16 v[224:227], a[64:67], v[60:63], v[224:227]
v_exp_f32 v29, v29
v_mfma_f32_16x16x32_bf16 v[228:231], a[68:71], v[60:63], v[228:231]
ds_read_b64_tr_b16 a[64:65], v88 offset:24576
v_cvt_pk_bf16_f32 v51, v22, v23
v_mfma_f32_16x16x32_bf16 v[232:235], a[72:75], v[60:63], v[232:235]
ds_read_b64_tr_b16 a[66:67], v88 offset:28672
v_cvt_pk_bf16_f32 v52, v24, v25
v_mfma_f32_16x16x32_bf16 v[236:239], a[76:79], v[60:63], v[236:239]
ds_read_b64_tr_b16 a[68:69], v89 offset:24576
v_cvt_pk_bf16_f32 v53, v26, v27
v_mfma_f32_16x16x32_bf16 v[240:243], a[80:83], v[60:63], v[240:243]
ds_read_b64_tr_b16 a[70:71], v89 offset:28672
v_cvt_pk_bf16_f32 v54, v28, v29
v_mfma_f32_16x16x32_bf16 v[244:247], a[84:87], v[60:63], v[244:247]
ds_read_b64_tr_b16 a[72:73], v90 offset:24576
v_mfma_f32_16x16x32_bf16 v[248:251], a[88:91], v[60:63], v[248:251]
ds_read_b64_tr_b16 a[74:75], v90 offset:28672
v_mfma_f32_16x16x32_bf16 v[252:255], a[92:95], v[60:63], v[252:255]
ds_read_b64_tr_b16 a[76:77], v91 offset:24576
v_mfma_f32_16x16x32_bf16 v[120:123], v[124:127], v[60:63], v[120:123]
ds_read_b64_tr_b16 a[78:79], v91 offset:28672
v_mfma_f32_16x16x32_bf16 v[32:35], a[0:3], a[96:99], v[72:75]
ds_read_b64_tr_b16 a[80:81], v92 offset:24576
v_mfma_f32_16x16x32_bf16 v[32:35], a[4:7], a[100:103], v[32:35]
ds_read_b64_tr_b16 a[82:83], v92 offset:28672
ds_read_b128 v[80:83], v101
v_mfma_f32_16x16x32_bf16 v[32:35], a[8:11], a[104:107], v[32:35]
ds_read_b64_tr_b16 a[84:85], v93 offset:24576
v_mfma_f32_16x16x32_bf16 v[32:35], a[12:15], a[108:111], v[32:35]
ds_read_b64_tr_b16 a[86:87], v93 offset:28672
v_mfma_f32_16x16x32_bf16 v[36:39], a[16:19], a[96:99], v[72:75]
s_waitcnt lgkmcnt(2)
ds_read_b64_tr_b16 a[88:89], v94 offset:24576
v_min3_u32 v80, v80, v81, v82
v_mfma_f32_16x16x32_bf16 v[36:39], a[20:23], a[100:103], v[36:39]
ds_read_b64_tr_b16 a[90:91], v94 offset:28672
v_min_u32 v80, v80, v83
v_mfma_f32_16x16x32_bf16 v[36:39], a[24:27], a[104:107], v[36:39]
ds_read_b64_tr_b16 a[92:93], v95 offset:24576
v_cmp_gt_u32 vcc, s39, v80
v_mfma_f32_16x16x32_bf16 v[36:39], a[28:31], a[108:111], v[36:39]
s_cbranch_vccnz L_fs59_4
L_fr59_4:
ds_read_b64_tr_b16 a[94:95], v95 offset:28672
v_mfma_f32_16x16x32_bf16 v[40:43], a[0:3], a[112:115], v[76:79]
v_exp_f32 v30, v30
v_mfma_f32_16x16x32_bf16 v[40:43], a[4:7], a[116:119], v[40:43]
v_exp_f32 v31, v31
v_mfma_f32_16x16x32_bf16 v[40:43], a[8:11], a[120:123], v[40:43]
v_exp_f32 v32, v32
v_mfma_f32_16x16x32_bf16 v[40:43], a[12:15], a[124:127], v[40:43]
v_exp_f32 v33, v33
v_mfma_f32_16x16x32_bf16 v[44:47], a[16:19], a[112:115], v[76:79]
v_exp_f32 v34, v34
v_mfma_f32_16x16x32_bf16 v[44:47], a[20:23], a[116:119], v[44:47]
v_exp_f32 v35, v35
v_mfma_f32_16x16x32_bf16 v[44:47], a[24:27], a[120:123], v[44:47]
v_exp_f32 v36, v36
v_mfma_f32_16x16x32_bf16 v[44:47], a[28:31], a[124:127], v[44:47]
s_waitcnt lgkmcnt(0)
v_exp_f32 v37, v37
v_mfma_f32_16x16x32_bf16 v[128:131], a[64:67], v[48:51], v[128:131]
ds_read_b128 a[0:3], v84 offset:32768
v_cvt_pk_bf16_f32 v55, v30, v31
v_mfma_f32_16x16x32_bf16 v[132:135], a[68:71], v[48:51], v[132:135]
ds_read_b128 a[4:7], v85 offset:32768
v_cvt_pk_bf16_f32 v56, v32, v33
v_mfma_f32_16x16x32_bf16 v[136:139], a[72:75], v[48:51], v[136:139]
ds_read_b128 a[8:11], v86 offset:32768
v_cvt_pk_bf16_f32 v57, v34, v35
v_mfma_f32_16x16x32_bf16 v[140:143], a[76:79], v[48:51], v[140:143]
ds_read_b128 a[12:15], v87 offset:32768
v_cvt_pk_bf16_f32 v58, v36, v37
v_mfma_f32_16x16x32_bf16 v[144:147], a[80:83], v[48:51], v[144:147]
ds_read_b128 a[16:19], v84 offset:36864
v_mfma_f32_16x16x32_bf16 v[148:151], a[84:87], v[48:51], v[148:151]
ds_read_b128 a[20:23], v85 offset:36864
v_mfma_f32_16x16x32_bf16 v[152:155], a[88:91], v[48:51], v[152:155]
ds_read_b128 a[24:27], v86 offset:36864
v_mfma_f32_16x16x32_bf16 v[156:159], a[92:95], v[48:51], v[156:159]
ds_read_b128 a[28:31], v87 offset:36864
v_mfma_f32_16x16x32_bf16 v[108:111], v[124:127], v[48:51], v[108:111]
v_exp_f32 v38, v38
v_mfma_f32_16x16x32_bf16 v[160:163], a[64:67], v[52:55], v[160:163]
v_exp_f32 v39, v39
v_mfma_f32_16x16x32_bf16 v[164:167], a[68:71], v[52:55], v[164:167]
v_exp_f32 v40, v40
v_mfma_f32_16x16x32_bf16 v[168:171], a[72:75], v[52:55], v[168:171]
v_exp_f32 v41, v41
v_mfma_f32_16x16x32_bf16 v[172:175], a[76:79], v[52:55], v[172:175]
v_exp_f32 v42, v42
v_mfma_f32_16x16x32_bf16 v[176:179], a[80:83], v[52:55], v[176:179]
v_exp_f32 v43, v43
v_mfma_f32_16x16x32_bf16 v[180:183], a[84:87], v[52:55], v[180:183]
v_exp_f32 v44, v44
v_mfma_f32_16x16x32_bf16 v[184:187], a[88:91], v[52:55], v[184:187]
s_waitcnt vmcnt(0)
v_cmp_gt_u32 vcc, v12, v107
s_cbranch_vccnz L_espin4
L_eok4:
v_exp_f32 v45, v45
v_mfma_f32_16x16x32_bf16 v[188:191], a[92:95], v[52:55], v[188:191]
v_exp_f32 v46, v46
v_mfma_f32_16x16x32_bf16 v[112:115], v[124:127], v[52:55], v[112:115]
s_waitcnt lgkmcnt(0)
v_exp_f32 v47, v47
v_mfma_f32_16x16x32_bf16 v[16:19], a[0:3], a[32:35], v[64:67]
v_cvt_pk_bf16_f32 v59, v38, v39
v_cvt_pk_bf16_f32 v60, v40, v41
v_mfma_f32_16x16x32_bf16 v[16:19], a[4:7], a[36:39], v[16:19]
v_cvt_pk_bf16_f32 v61, v42, v43
v_cvt_pk_bf16_f32 v62, v44, v45
v_mfma_f32_16x16x32_bf16 v[16:19], a[8:11], a[40:43], v[16:19]
v_cvt_pk_bf16_f32 v63, v46, v47
v_mfma_f32_16x16x32_bf16 v[16:19], a[12:15], a[44:47], v[16:19]
buffer_load_dwordx4 a[144:147], v2, s[80:83], s99 offen offset:0 sc1
v_mfma_f32_16x16x32_bf16 v[20:23], a[16:19], a[32:35], v[64:67]
v_mfma_f32_16x16x32_bf16 v[20:23], a[20:23], a[36:39], v[20:23]
v_mfma_f32_16x16x32_bf16 v[20:23], a[24:27], a[40:43], v[20:23]
v_mfma_f32_16x16x32_bf16 v[20:23], a[28:31], a[44:47], v[20:23]
buffer_load_dwordx4 a[148:151], v2, s[80:83], s99 offen offset:1024 sc1
v_mfma_f32_16x16x32_bf16 v[24:27], a[0:3], a[48:51], v[68:71]
v_mfma_f32_16x16x32_bf16 v[24:27], a[4:7], a[52:55], v[24:27]
v_exp_f32 v16, v16
v_mfma_f32_16x16x32_bf16 v[24:27], a[8:11], a[56:59], v[24:27]
v_exp_f32 v17, v17
v_mfma_f32_16x16x32_bf16 v[24:27], a[12:15], a[60:63], v[24:27]
buffer_load_dwordx4 a[152:155], v2, s[80:83], s99 offen offset:2048 sc1
v_cvt_pk_bf16_f32 v48, v16, v17
v_mfma_f32_16x16x32_bf16 v[28:31], a[16:19], a[48:51], v[68:71]
v_exp_f32 v18, v18
v_mfma_f32_16x16x32_bf16 v[28:31], a[20:23], a[52:55], v[28:31]
v_exp_f32 v19, v19
v_mfma_f32_16x16x32_bf16 v[28:31], a[24:27], a[56:59], v[28:31]
v_exp_f32 v20, v20
v_mfma_f32_16x16x32_bf16 v[28:31], a[28:31], a[60:63], v[28:31]
v_exp_f32 v21, v21
v_mfma_f32_16x16x32_bf16 v[192:195], a[64:67], v[56:59], v[192:195]
v_exp_f32 v22, v22
v_mfma_f32_16x16x32_bf16 v[196:199], a[68:71], v[56:59], v[196:199]
buffer_load_dwordx4 a[156:159], v3, s[80:83], s99 offen offset:0 sc1
v_cvt_pk_bf16_f32 v49, v18, v19
v_mfma_f32_16x16x32_bf16 v[200:203], a[72:75], v[56:59], v[200:203]
v_exp_f32 v23, v23
v_mfma_f32_16x16x32_bf16 v[204:207], a[76:79], v[56:59], v[204:207]
v_exp_f32 v24, v24
v_mfma_f32_16x16x32_bf16 v[208:211], a[80:83], v[56:59], v[208:211]
v_exp_f32 v25, v25
v_mfma_f32_16x16x32_bf16 v[212:215], a[84:87], v[56:59], v[212:215]
v_exp_f32 v26, v26
v_mfma_f32_16x16x32_bf16 v[216:219], a[88:91], v[56:59], v[216:219]
v_exp_f32 v27, v27
v_mfma_f32_16x16x32_bf16 v[220:223], a[92:95], v[56:59], v[220:223]
buffer_load_dwordx4 a[160:163], v3, s[80:83], s99 offen offset:1024 sc1
v_cvt_pk_bf16_f32 v50, v20, v21
v_mfma_f32_16x16x32_bf16 v[116:119], v[124:127], v[56:59], v[116:119]
v_exp_f32 v28, v28
v_mfma_f32_16x16x32_bf16 v[224:227], a[64:67], v[60:63], v[224:227]
v_exp_f32 v29, v29
v_mfma_f32_16x16x32_bf16 v[228:231], a[68:71], v[60:63], v[228:231]
ds_read_b64_tr_b16 a[64:65], v88 offset:32768
v_cvt_pk_bf16_f32 v51, v22, v23
v_mfma_f32_16x16x32_bf16 v[232:235], a[72:75], v[60:63], v[232:235]
ds_read_b64_tr_b16 a[66:67], v88 offset:36864
v_cvt_pk_bf16_f32 v52, v24, v25
v_mfma_f32_16x16x32_bf16 v[236:239], a[76:79], v[60:63], v[236:239]
ds_read_b64_tr_b16 a[68:69], v89 offset:32768
v_cvt_pk_bf16_f32 v53, v26, v27
v_mfma_f32_16x16x32_bf16 v[240:243], a[80:83], v[60:63], v[240:243]
ds_read_b64_tr_b16 a[70:71], v89 offset:36864
v_cvt_pk_bf16_f32 v54, v28, v29
v_mfma_f32_16x16x32_bf16 v[244:247], a[84:87], v[60:63], v[244:247]
ds_read_b64_tr_b16 a[72:73], v90 offset:32768
v_mfma_f32_16x16x32_bf16 v[248:251], a[88:91], v[60:63], v[248:251]
ds_read_b64_tr_b16 a[74:75], v90 offset:36864
v_mfma_f32_16x16x32_bf16 v[252:255], a[92:95], v[60:63], v[252:255]
ds_read_b64_tr_b16 a[76:77], v91 offset:32768
v_mfma_f32_16x16x32_bf16 v[120:123], v[124:127], v[60:63], v[120:123]
ds_read_b64_tr_b16 a[78:79], v91 offset:36864
buffer_load_dwordx4 a[164:167], v3, s[80:83], s99 offen offset:2048 sc1
v_mfma_f32_16x16x32_bf16 v[32:35], a[0:3], a[96:99], v[72:75]
ds_read_b64_tr_b16 a[80:81], v92 offset:32768
v_mfma_f32_16x16x32_bf16 v[32:35], a[4:7], a[100:103], v[32:35]
ds_read_b64_tr_b16 a[82:83], v92 offset:36864
v_mfma_f32_16x16x32_bf16 v[32:35], a[8:11], a[104:107], v[32:35]
ds_read_b64_tr_b16 a[84:85], v93 offset:32768
v_mfma_f32_16x16x32_bf16 v[32:35], a[12:15], a[108:111], v[32:35]
ds_read_b64_tr_b16 a[86:87], v93 offset:36864
v_mfma_f32_16x16x32_bf16 v[36:39], a[16:19], a[96:99], v[72:75]
ds_read_b64_tr_b16 a[88:89], v94 offset:32768
buffer_load_dwordx4 a[168:171], v8, s[56:59], s98 offen offset:0 sc1
v_mfma_f32_16x16x32_bf16 v[36:39], a[20:23], a[100:103], v[36:39]
ds_read_b64_tr_b16 a[90:91], v94 offset:36864
v_mfma_f32_16x16x32_bf16 v[36:39], a[24:27], a[104:107], v[36:39]
ds_read_b64_tr_b16 a[92:93], v95 offset:32768
v_mfma_f32_16x16x32_bf16 v[36:39], a[28:31], a[108:111], v[36:39]
ds_read_b64_tr_b16 a[94:95], v95 offset:36864
v_mfma_f32_16x16x32_bf16 v[40:43], a[0:3], a[112:115], v[76:79]
v_exp_f32 v30, v30
v_mfma_f32_16x16x32_bf16 v[40:43], a[4:7], a[116:119], v[40:43]
v_exp_f32 v31, v31
v_mfma_f32_16x16x32_bf16 v[40:43], a[8:11], a[120:123], v[40:43]
v_exp_f32 v32, v32
v_mfma_f32_16x16x32_bf16 v[40:43], a[12:15], a[124:127], v[40:43]
v_exp_f32 v33, v33
v_mfma_f32_16x16x32_bf16 v[44:47], a[16:19], a[112:115], v[76:79]
v_exp_f32 v34, v34
v_mfma_f32_16x16x32_bf16 v[44:47], a[20:23], a[116:119], v[44:47]
v_exp_f32 v35, v35
v_mfma_f32_16x16x32_bf16 v[44:47], a[24:27], a[120:123], v[44:47]
v_exp_f32 v36, v36
v_mfma_f32_16x16x32_bf16 v[44:47], a[28:31], a[124:127], v[44:47]
s_waitcnt lgkmcnt(0)
v_exp_f32 v37, v37
v_mfma_f32_16x16x32_bf16 v[128:131], a[64:67], v[48:51], v[128:131]
ds_read_b128 a[0:3], v84 offset:40960
v_cvt_pk_bf16_f32 v55, v30, v31
v_mfma_f32_16x16x32_bf16 v[132:135], a[68:71], v[48:51], v[132:135]
ds_read_b128 a[4:7], v85 offset:40960
v_cvt_pk_bf16_f32 v56, v32, v33
v_mfma_f32_16x16x32_bf16 v[136:139], a[72:75], v[48:51], v[136:139]
ds_read_b128 a[8:11], v86 offset:40960
v_cvt_pk_bf16_f32 v57, v34, v35
v_mfma_f32_16x16x32_bf16 v[140:143], a[76:79], v[48:51], v[140:143]
ds_read_b128 a[12:15], v87 offset:40960
v_cvt_pk_bf16_f32 v58, v36, v37
v_mfma_f32_16x16x32_bf16 v[144:147], a[80:83], v[48:51], v[144:147]
ds_read_b128 a[16:19], v84 offset:45056
v_mfma_f32_16x16x32_bf16 v[148:151], a[84:87], v[48:51], v[148:151]
ds_read_b128 a[20:23], v85 offset:45056
buffer_load_dwordx4 a[172:175], v8, s[56:59], s98 offen offset:1024 sc1
v_mfma_f32_16x16x32_bf16 v[152:155], a[88:91], v[48:51], v[152:155]
ds_read_b128 a[24:27], v86 offset:45056
v_mfma_f32_16x16x32_bf16 v[156:159], a[92:95], v[48:51], v[156:159]
ds_read_b128 a[28:31], v87 offset:45056
v_mfma_f32_16x16x32_bf16 v[108:111], v[124:127], v[48:51], v[108:111]
v_exp_f32 v38, v38
v_mfma_f32_16x16x32_bf16 v[160:163], a[64:67], v[52:55], v[160:163]
v_exp_f32 v39, v39
v_mfma_f32_16x16x32_bf16 v[164:167], a[68:71], v[52:55], v[164:167]
v_exp_f32 v40, v40
v_mfma_f32_16x16x32_bf16 v[168:171], a[72:75], v[52:55], v[168:171]
v_exp_f32 v41, v41
v_mfma_f32_16x16x32_bf16 v[172:175], a[76:79], v[52:55], v[172:175]
v_exp_f32 v42, v42
v_mfma_f32_16x16x32_bf16 v[176:179], a[80:83], v[52:55], v[176:179]
v_exp_f32 v43, v43
v_mfma_f32_16x16x32_bf16 v[180:183], a[84:87], v[52:55], v[180:183]
v_exp_f32 v44, v44
v_mfma_f32_16x16x32_bf16 v[184:187], a[88:91], v[52:55], v[184:187]
v_exp_f32 v45, v45
v_mfma_f32_16x16x32_bf16 v[188:191], a[92:95], v[52:55], v[188:191]
v_exp_f32 v46, v46
v_mfma_f32_16x16x32_bf16 v[112:115], v[124:127], v[52:55], v[112:115]
s_waitcnt lgkmcnt(0)
v_exp_f32 v47, v47
v_mfma_f32_16x16x32_bf16 v[16:19], a[0:3], a[32:35], v[64:67]
v_cvt_pk_bf16_f32 v59, v38, v39
v_cvt_pk_bf16_f32 v60, v40, v41
v_mfma_f32_16x16x32_bf16 v[16:19], a[4:7], a[36:39], v[16:19]
v_cvt_pk_bf16_f32 v61, v42, v43
v_cvt_pk_bf16_f32 v62, v44, v45
v_mfma_f32_16x16x32_bf16 v[16:19], a[8:11], a[40:43], v[16:19]
v_cvt_pk_bf16_f32 v63, v46, v47
v_mfma_f32_16x16x32_bf16 v[16:19], a[12:15], a[44:47], v[16:19]
buffer_load_dwordx4 a[176:179], v8, s[56:59], s98 offen offset:2048 sc1
v_mfma_f32_16x16x32_bf16 v[20:23], a[16:19], a[32:35], v[64:67]
v_mfma_f32_16x16x32_bf16 v[20:23], a[20:23], a[36:39], v[20:23]
s_add_u32 s39, s39, 1
v_mfma_f32_16x16x32_bf16 v[20:23], a[24:27], a[40:43], v[20:23]
v_mov_b32 v80, s39
v_mfma_f32_16x16x32_bf16 v[20:23], a[28:31], a[44:47], v[20:23]
buffer_load_dwordx4 a[180:183], v9, s[56:59], s98 offen offset:0 sc1
v_mfma_f32_16x16x32_bf16 v[24:27], a[0:3], a[48:51], v[68:71]
s_waitcnt vmcnt(63)
ds_write_b32 v1, v80
v_mfma_f32_16x16x32_bf16 v[24:27], a[4:7], a[52:55], v[24:27]
v_exp_f32 v16, v16
v_mfma_f32_16x16x32_bf16 v[24:27], a[8:11], a[56:59], v[24:27]
v_exp_f32 v17, v17
v_mfma_f32_16x16x32_bf16 v[24:27], a[12:15], a[60:63], v[24:27]
buffer_load_dwordx4 a[184:187], v9, s[56:59], s98 offen offset:1024 sc1
v_cvt_pk_bf16_f32 v48, v16, v17
v_mfma_f32_16x16x32_bf16 v[28:31], a[16:19], a[48:51], v[68:71]
v_exp_f32 v18, v18
v_mfma_f32_16x16x32_bf16 v[28:31], a[20:23], a[52:55], v[28:31]
v_exp_f32 v19, v19
v_mfma_f32_16x16x32_bf16 v[28:31], a[24:27], a[56:59], v[28:31]
v_exp_f32 v20, v20
v_mfma_f32_16x16x32_bf16 v[28:31], a[28:31], a[60:63], v[28:31]
v_exp_f32 v21, v21
v_mfma_f32_16x16x32_bf16 v[192:195], a[64:67], v[56:59], v[192:195]
v_exp_f32 v22, v22
v_mfma_f32_16x16x32_bf16 v[196:199], a[68:71], v[56:59], v[196:199]
buffer_load_dwordx4 a[188:191], v9, s[56:59], s98 offen offset:2048 sc1
v_cvt_pk_bf16_f32 v49, v18, v19
v_mfma_f32_16x16x32_bf16 v[200:203], a[72:75], v[56:59], v[200:203]
s_add_u32 s98, s98, 122880
s_add_u32 s99, s99, 36864
v_exp_f32 v23, v23
v_mfma_f32_16x16x32_bf16 v[204:207], a[76:79], v[56:59], v[204:207]
v_exp_f32 v24, v24
v_mfma_f32_16x16x32_bf16 v[208:211], a[80:83], v[56:59], v[208:211]
v_exp_f32 v25, v25
v_mfma_f32_16x16x32_bf16 v[212:215], a[84:87], v[56:59], v[212:215]
v_exp_f32 v26, v26
v_mfma_f32_16x16x32_bf16 v[216:219], a[88:91], v[56:59], v[216:219]
v_exp_f32 v27, v27
v_mfma_f32_16x16x32_bf16 v[220:223], a[92:95], v[56:59], v[220:223]
buffer_load_dwordx4 a[192:195], v2, s[80:83], s99 offen offset:0 sc1
v_cvt_pk_bf16_f32 v50, v20, v21
v_mfma_f32_16x16x32_bf16 v[116:119], v[124:127], v[56:59], v[116:119]
v_exp_f32 v28, v28
v_mfma_f32_16x16x32_bf16 v[224:227], a[64:67], v[60:63], v[224:227]
v_exp_f32 v29, v29
v_mfma_f32_16x16x32_bf16 v[228:231], a[68:71], v[60:63], v[228:231]
ds_read_b64_tr_b16 a[64:65], v88 offset:40960
v_cvt_pk_bf16_f32 v51, v22, v23
v_mfma_f32_16x16x32_bf16 v[232:235], a[72:75], v[60:63], v[232:235]
ds_read_b64_tr_b16 a[66:67], v88 offset:45056
v_cvt_pk_bf16_f32 v52, v24, v25
v_mfma_f32_16x16x32_bf16 v[236:239], a[76:79], v[60:63], v[236:239]
ds_read_b64_tr_b16 a[68:69], v89 offset:40960
v_cvt_pk_bf16_f32 v53, v26, v27
v_mfma_f32_16x16x32_bf16 v[240:243], a[80:83], v[60:63], v[240:243]
ds_read_b64_tr_b16 a[70:71], v89 offset:45056
v_cvt_pk_bf16_f32 v54, v28, v29
v_mfma_f32_16x16x32_bf16 v[244:247], a[84:87], v[60:63], v[244:247]
ds_read_b64_tr_b16 a[72:73], v90 offset:40960
v_mfma_f32_16x16x32_bf16 v[248:251], a[88:91], v[60:63], v[248:251]
ds_read_b64_tr_b16 a[74:75], v90 offset:45056
v_mfma_f32_16x16x32_bf16 v[252:255], a[92:95], v[60:63], v[252:255]
ds_read_b64_tr_b16 a[76:77], v91 offset:40960
v_mfma_f32_16x16x32_bf16 v[120:123], v[124:127], v[60:63], v[120:123]
ds_read_b64_tr_b16 a[78:79], v91 offset:45056
buffer_load_dwordx4 a[196:199], v2, s[80:83], s99 offen offset:1024 sc1
v_mfma_f32_16x16x32_bf16 v[32:35], a[0:3], a[96:99], v[72:75]
ds_read_b64_tr_b16 a[80:81], v92 offset:40960
v_mfma_f32_16x16x32_bf16 v[32:35], a[4:7], a[100:103], v[32:35]
ds_read_b64_tr_b16 a[82:83], v92 offset:45056
ds_read_b128 v[80:83], v101
v_mfma_f32_16x16x32_bf16 v[32:35], a[8:11], a[104:107], v[32:35]
ds_read_b64_tr_b16 a[84:85], v93 offset:40960
v_mfma_f32_16x16x32_bf16 v[32:35], a[12:15], a[108:111], v[32:35]
ds_read_b64_tr_b16 a[86:87], v93 offset:45056
v_mfma_f32_16x16x32_bf16 v[36:39], a[16:19], a[96:99], v[72:75]
s_waitcnt lgkmcnt(2)
ds_read_b64_tr_b16 a[88:89], v94 offset:40960
buffer_load_dwordx4 a[200:203], v2, s[80:83], s99 offen offset:2048 sc1
v_min3_u32 v80, v80, v81, v82
v_mfma_f32_16x16x32_bf16 v[36:39], a[20:23], a[100:103], v[36:39]
ds_read_b64_tr_b16 a[90:91], v94 offset:45056
v_min_u32 v80, v80, v83
v_mfma_f32_16x16x32_bf16 v[36:39], a[24:27], a[104:107], v[36:39]
ds_read_b64_tr_b16 a[92:93], v95 offset:40960
v_cmp_gt_u32 vcc, s39, v80
v_mfma_f32_16x16x32_bf16 v[36:39], a[28:31], a[108:111], v[36:39]
s_cbranch_vccnz L_fs61_4
L_fr61_4:
ds_read_b64_tr_b16 a[94:95], v95 offset:45056
v_mfma_f32_16x16x32_bf16 v[40:43], a[0:3], a[112:115], v[76:79]
v_exp_f32 v30, v30
v_mfma_f32_16x16x32_bf16 v[40:43], a[4:7], a[116:119], v[40:43]
v_exp_f32 v31, v31
v_mfma_f32_16x16x32_bf16 v[40:43], a[8:11], a[120:123], v[40:43]
v_exp_f32 v32, v32
v_mfma_f32_16x16x32_bf16 v[40:43], a[12:15], a[124:127], v[40:43]
v_exp_f32 v33, v33
v_mfma_f32_16x16x32_bf16 v[44:47], a[16:19], a[112:115], v[76:79]
v_exp_f32 v34, v34
v_mfma_f32_16x16x32_bf16 v[44:47], a[20:23], a[116:119], v[44:47]
v_exp_f32 v35, v35
v_mfma_f32_16x16x32_bf16 v[44:47], a[24:27], a[120:123], v[44:47]
v_exp_f32 v36, v36
v_mfma_f32_16x16x32_bf16 v[44:47], a[28:31], a[124:127], v[44:47]
s_waitcnt lgkmcnt(0)
v_exp_f32 v37, v37
v_mfma_f32_16x16x32_bf16 v[128:131], a[64:67], v[48:51], v[128:131]
ds_read_b128 a[0:3], v84 offset:49152
v_cvt_pk_bf16_f32 v55, v30, v31
v_mfma_f32_16x16x32_bf16 v[132:135], a[68:71], v[48:51], v[132:135]
ds_read_b128 a[4:7], v85 offset:49152
v_cvt_pk_bf16_f32 v56, v32, v33
v_mfma_f32_16x16x32_bf16 v[136:139], a[72:75], v[48:51], v[136:139]
ds_read_b128 a[8:11], v86 offset:49152
v_cvt_pk_bf16_f32 v57, v34, v35
v_mfma_f32_16x16x32_bf16 v[140:143], a[76:79], v[48:51], v[140:143]
ds_read_b128 a[12:15], v87 offset:49152
v_cvt_pk_bf16_f32 v58, v36, v37
v_mfma_f32_16x16x32_bf16 v[144:147], a[80:83], v[48:51], v[144:147]
ds_read_b128 a[16:19], v84 offset:53248
v_mfma_f32_16x16x32_bf16 v[148:151], a[84:87], v[48:51], v[148:151]
ds_read_b128 a[20:23], v85 offset:53248
buffer_load_dwordx4 a[204:207], v3, s[80:83], s99 offen offset:0 sc1
v_mfma_f32_16x16x32_bf16 v[152:155], a[88:91], v[48:51], v[152:155]
ds_read_b128 a[24:27], v86 offset:53248
v_mfma_f32_16x16x32_bf16 v[156:159], a[92:95], v[48:51], v[156:159]
ds_read_b128 a[28:31], v87 offset:53248
v_mfma_f32_16x16x32_bf16 v[108:111], v[124:127], v[48:51], v[108:111]
v_exp_f32 v38, v38
v_mfma_f32_16x16x32_bf16 v[160:163], a[64:67], v[52:55], v[160:163]
v_exp_f32 v39, v39
v_mfma_f32_16x16x32_bf16 v[164:167], a[68:71], v[52:55], v[164:167]
v_exp_f32 v40, v40
v_mfma_f32_16x16x32_bf16 v[168:171], a[72:75], v[52:55], v[168:171]
v_exp_f32 v41, v41
v_mfma_f32_16x16x32_bf16 v[172:175], a[76:79], v[52:55], v[172:175]
v_exp_f32 v42, v42
v_mfma_f32_16x16x32_bf16 v[176:179], a[80:83], v[52:55], v[176:179]
v_exp_f32 v43, v43
v_mfma_f32_16x16x32_bf16 v[180:183], a[84:87], v[52:55], v[180:183]
v_exp_f32 v44, v44
v_mfma_f32_16x16x32_bf16 v[184:187], a[88:91], v[52:55], v[184:187]
v_exp_f32 v45, v45
v_mfma_f32_16x16x32_bf16 v[188:191], a[92:95], v[52:55], v[188:191]
v_exp_f32 v46, v46
v_mfma_f32_16x16x32_bf16 v[112:115], v[124:127], v[52:55], v[112:115]
s_waitcnt lgkmcnt(0)
v_exp_f32 v47, v47
v_mfma_f32_16x16x32_bf16 v[16:19], a[0:3], a[32:35], v[64:67]
v_cvt_pk_bf16_f32 v59, v38, v39
v_cvt_pk_bf16_f32 v60, v40, v41
v_mfma_f32_16x16x32_bf16 v[16:19], a[4:7], a[36:39], v[16:19]
v_cvt_pk_bf16_f32 v61, v42, v43
v_cvt_pk_bf16_f32 v62, v44, v45
v_mfma_f32_16x16x32_bf16 v[16:19], a[8:11], a[40:43], v[16:19]
v_cvt_pk_bf16_f32 v63, v46, v47
v_mfma_f32_16x16x32_bf16 v[16:19], a[12:15], a[44:47], v[16:19]
buffer_load_dwordx4 a[208:211], v3, s[80:83], s99 offen offset:1024 sc1
v_mfma_f32_16x16x32_bf16 v[20:23], a[16:19], a[32:35], v[64:67]
v_mfma_f32_16x16x32_bf16 v[20:23], a[20:23], a[36:39], v[20:23]
v_mfma_f32_16x16x32_bf16 v[20:23], a[24:27], a[40:43], v[20:23]
v_mfma_f32_16x16x32_bf16 v[20:23], a[28:31], a[44:47], v[20:23]
buffer_load_dwordx4 a[212:215], v3, s[80:83], s99 offen offset:2048 sc1
v_mfma_f32_16x16x32_bf16 v[24:27], a[0:3], a[48:51], v[68:71]
v_mfma_f32_16x16x32_bf16 v[24:27], a[4:7], a[52:55], v[24:27]
v_exp_f32 v16, v16
v_mfma_f32_16x16x32_bf16 v[24:27], a[8:11], a[56:59], v[24:27]
v_exp_f32 v17, v17
v_mfma_f32_16x16x32_bf16 v[24:27], a[12:15], a[60:63], v[24:27]
buffer_load_dwordx4 a[216:219], v8, s[56:59], s98 offen offset:0 sc1
v_cvt_pk_bf16_f32 v48, v16, v17
v_mfma_f32_16x16x32_bf16 v[28:31], a[16:19], a[48:51], v[68:71]
v_exp_f32 v18, v18
v_mfma_f32_16x16x32_bf16 v[28:31], a[20:23], a[52:55], v[28:31]
v_exp_f32 v19, v19
v_mfma_f32_16x16x32_bf16 v[28:31], a[24:27], a[56:59], v[28:31]
v_exp_f32 v20, v20
v_mfma_f32_16x16x32_bf16 v[28:31], a[28:31], a[60:63], v[28:31]
v_exp_f32 v21, v21
v_mfma_f32_16x16x32_bf16 v[192:195], a[64:67], v[56:59], v[192:195]
v_exp_f32 v22, v22
v_mfma_f32_16x16x32_bf16 v[196:199], a[68:71], v[56:59], v[196:199]
buffer_load_dwordx4 a[220:223], v8, s[56:59], s98 offen offset:1024 sc1
v_cvt_pk_bf16_f32 v49, v18, v19
v_mfma_f32_16x16x32_bf16 v[200:203], a[72:75], v[56:59], v[200:203]
v_exp_f32 v23, v23
v_mfma_f32_16x16x32_bf16 v[204:207], a[76:79], v[56:59], v[204:207]
v_exp_f32 v24, v24
v_mfma_f32_16x16x32_bf16 v[208:211], a[80:83], v[56:59], v[208:211]
v_exp_f32 v25, v25
v_mfma_f32_16x16x32_bf16 v[212:215], a[84:87], v[56:59], v[212:215]
v_exp_f32 v26, v26
v_mfma_f32_16x16x32_bf16 v[216:219], a[88:91], v[56:59], v[216:219]
v_exp_f32 v27, v27
v_mfma_f32_16x16x32_bf16 v[220:223], a[92:95], v[56:59], v[220:223]
buffer_load_dwordx4 a[224:227], v8, s[56:59], s98 offen offset:2048 sc1
v_cvt_pk_bf16_f32 v50, v20, v21
v_mfma_f32_16x16x32_bf16 v[116:119], v[124:127], v[56:59], v[116:119]
v_exp_f32 v28, v28
v_mfma_f32_16x16x32_bf16 v[224:227], a[64:67], v[60:63], v[224:227]
v_exp_f32 v29, v29
v_mfma_f32_16x16x32_bf16 v[228:231], a[68:71], v[60:63], v[228:231]
ds_read_b64_tr_b16 a[64:65], v88 offset:49152
v_cvt_pk_bf16_f32 v51, v22, v23
v_mfma_f32_16x16x32_bf16 v[232:235], a[72:75], v[60:63], v[232:235]
ds_read_b64_tr_b16 a[66:67], v88 offset:53248
v_cvt_pk_bf16_f32 v52, v24, v25
v_mfma_f32_16x16x32_bf16 v[236:239], a[76:79], v[60:63], v[236:239]
ds_read_b64_tr_b16 a[68:69], v89 offset:49152
v_cvt_pk_bf16_f32 v53, v26, v27
v_mfma_f32_16x16x32_bf16 v[240:243], a[80:83], v[60:63], v[240:243]
ds_read_b64_tr_b16 a[70:71], v89 offset:53248
v_cvt_pk_bf16_f32 v54, v28, v29
v_mfma_f32_16x16x32_bf16 v[244:247], a[84:87], v[60:63], v[244:247]
ds_read_b64_tr_b16 a[72:73], v90 offset:49152
v_mfma_f32_16x16x32_bf16 v[248:251], a[88:91], v[60:63], v[248:251]
ds_read_b64_tr_b16 a[74:75], v90 offset:53248
v_mfma_f32_16x16x32_bf16 v[252:255], a[92:95], v[60:63], v[252:255]
ds_read_b64_tr_b16 a[76:77], v91 offset:49152
v_mfma_f32_16x16x32_bf16 v[120:123], v[124:127], v[60:63], v[120:123]
ds_read_b64_tr_b16 a[78:79], v91 offset:53248
buffer_load_dwordx4 a[228:231], v9, s[56:59], s98 offen offset:0 sc1
v_mfma_f32_16x16x32_bf16 v[32:35], a[0:3], a[96:99], v[72:75]
ds_read_b64_tr_b16 a[80:81], v92 offset:49152
v_mfma_f32_16x16x32_bf16 v[32:35], a[4:7], a[100:103], v[32:35]
ds_read_b64_tr_b16 a[82:83], v92 offset:53248
v_mfma_f32_16x16x32_bf16 v[32:35], a[8:11], a[104:107], v[32:35]
ds_read_b64_tr_b16 a[84:85], v93 offset:49152
v_mfma_f32_16x16x32_bf16 v[32:35], a[12:15], a[108:111], v[32:35]
ds_read_b64_tr_b16 a[86:87], v93 offset:53248
v_mfma_f32_16x16x32_bf16 v[36:39], a[16:19], a[96:99], v[72:75]
ds_read_b64_tr_b16 a[88:89], v94 offset:49152
buffer_load_dwordx4 a[232:235], v9, s[56:59], s98 offen offset:1024 sc1
v_mfma_f32_16x16x32_bf16 v[36:39], a[20:23], a[100:103], v[36:39]
ds_read_b64_tr_b16 a[90:91], v94 offset:53248
v_mfma_f32_16x16x32_bf16 v[36:39], a[24:27], a[104:107], v[36:39]
ds_read_b64_tr_b16 a[92:93], v95 offset:49152
v_mfma_f32_16x16x32_bf16 v[36:39], a[28:31], a[108:111], v[36:39]
ds_read_b64_tr_b16 a[94:95], v95 offset:53248
v_mfma_f32_16x16x32_bf16 v[40:43], a[0:3], a[112:115], v[76:79]
v_exp_f32 v30, v30
v_mfma_f32_16x16x32_bf16 v[40:43], a[4:7], a[116:119], v[40:43]
v_exp_f32 v31, v31
v_mfma_f32_16x16x32_bf16 v[40:43], a[8:11], a[120:123], v[40:43]
v_exp_f32 v32, v32
v_mfma_f32_16x16x32_bf16 v[40:43], a[12:15], a[124:127], v[40:43]
v_exp_f32 v33, v33
v_mfma_f32_16x16x32_bf16 v[44:47], a[16:19], a[112:115], v[76:79]
v_exp_f32 v34, v34
v_mfma_f32_16x16x32_bf16 v[44:47], a[20:23], a[116:119], v[44:47]
v_exp_f32 v35, v35
v_mfma_f32_16x16x32_bf16 v[44:47], a[24:27], a[120:123], v[44:47]
v_exp_f32 v36, v36
v_mfma_f32_16x16x32_bf16 v[44:47], a[28:31], a[124:127], v[44:47]
s_waitcnt lgkmcnt(0)
v_exp_f32 v37, v37
v_mfma_f32_16x16x32_bf16 v[128:131], a[64:67], v[48:51], v[128:131]
ds_read_b128 a[0:3], v84 offset:57344
v_cvt_pk_bf16_f32 v55, v30, v31
v_mfma_f32_16x16x32_bf16 v[132:135], a[68:71], v[48:51], v[132:135]
ds_read_b128 a[4:7], v85 offset:57344
v_cvt_pk_bf16_f32 v56, v32, v33
v_mfma_f32_16x16x32_bf16 v[136:139], a[72:75], v[48:51], v[136:139]
ds_read_b128 a[8:11], v86 offset:57344
v_cvt_pk_bf16_f32 v57, v34, v35
v_mfma_f32_16x16x32_bf16 v[140:143], a[76:79], v[48:51], v[140:143]
ds_read_b128 a[12:15], v87 offset:57344
v_cvt_pk_bf16_f32 v58, v36, v37
v_mfma_f32_16x16x32_bf16 v[144:147], a[80:83], v[48:51], v[144:147]
ds_read_b128 a[16:19], v84 offset:61440
v_mfma_f32_16x16x32_bf16 v[148:151], a[84:87], v[48:51], v[148:151]
ds_read_b128 a[20:23], v85 offset:61440
buffer_load_dwordx4 a[236:239], v9, s[56:59], s98 offen offset:2048 sc1
v_mfma_f32_16x16x32_bf16 v[152:155], a[88:91], v[48:51], v[152:155]
ds_read_b128 a[24:27], v86 offset:61440
s_add_u32 s98, s98, 122880
s_add_u32 s99, s99, 36864
v_mfma_f32_16x16x32_bf16 v[156:159], a[92:95], v[48:51], v[156:159]
ds_read_b128 a[28:31], v87 offset:61440
v_mfma_f32_16x16x32_bf16 v[108:111], v[124:127], v[48:51], v[108:111]
v_exp_f32 v38, v38
v_mfma_f32_16x16x32_bf16 v[160:163], a[64:67], v[52:55], v[160:163]
v_exp_f32 v39, v39
v_mfma_f32_16x16x32_bf16 v[164:167], a[68:71], v[52:55], v[164:167]
v_exp_f32 v40, v40
v_mfma_f32_16x16x32_bf16 v[168:171], a[72:75], v[52:55], v[168:171]
v_exp_f32 v41, v41
v_mfma_f32_16x16x32_bf16 v[172:175], a[76:79], v[52:55], v[172:175]
v_exp_f32 v42, v42
v_mfma_f32_16x16x32_bf16 v[176:179], a[80:83], v[52:55], v[176:179]
v_exp_f32 v43, v43
v_mfma_f32_16x16x32_bf16 v[180:183], a[84:87], v[52:55], v[180:183]
v_exp_f32 v44, v44
v_mfma_f32_16x16x32_bf16 v[184:187], a[88:91], v[52:55], v[184:187]
v_exp_f32 v45, v45
v_mfma_f32_16x16x32_bf16 v[188:191], a[92:95], v[52:55], v[188:191]
v_exp_f32 v46, v46
v_mfma_f32_16x16x32_bf16 v[112:115], v[124:127], v[52:55], v[112:115]
s_waitcnt lgkmcnt(0)
v_exp_f32 v47, v47
v_mfma_f32_16x16x32_bf16 v[16:19], a[0:3], a[32:35], v[64:67]
v_cvt_pk_bf16_f32 v59, v38, v39
v_cvt_pk_bf16_f32 v60, v40, v41
v_mfma_f32_16x16x32_bf16 v[16:19], a[4:7], a[36:39], v[16:19]
v_cvt_pk_bf16_f32 v61, v42, v43
v_cvt_pk_bf16_f32 v62, v44, v45
v_mfma_f32_16x16x32_bf16 v[16:19], a[8:11], a[40:43], v[16:19]
v_cvt_pk_bf16_f32 v63, v46, v47
v_mfma_f32_16x16x32_bf16 v[16:19], a[12:15], a[44:47], v[16:19]
buffer_load_dwordx4 a[128:131], v2, s[80:83], s99 offen offset:0 sc1
v_mfma_f32_16x16x32_bf16 v[20:23], a[16:19], a[32:35], v[64:67]
v_mfma_f32_16x16x32_bf16 v[20:23], a[20:23], a[36:39], v[20:23]
v_mfma_f32_16x16x32_bf16 v[20:23], a[24:27], a[40:43], v[20:23]
v_mfma_f32_16x16x32_bf16 v[20:23], a[28:31], a[44:47], v[20:23]
buffer_load_dwordx4 a[132:135], v2, s[80:83], s99 offen offset:1024 sc1
v_mfma_f32_16x16x32_bf16 v[24:27], a[0:3], a[48:51], v[68:71]
v_mfma_f32_16x16x32_bf16 v[24:27], a[4:7], a[52:55], v[24:27]
v_exp_f32 v16, v16
v_mfma_f32_16x16x32_bf16 v[24:27], a[8:11], a[56:59], v[24:27]
v_exp_f32 v17, v17
v_mfma_f32_16x16x32_bf16 v[24:27], a[12:15], a[60:63], v[24:27]
buffer_load_dwordx4 a[136:139], v2, s[80:83], s99 offen offset:2048 sc1
v_cvt_pk_bf16_f32 v48, v16, v17
v_mfma_f32_16x16x32_bf16 v[28:31], a[16:19], a[48:51], v[68:71]
v_exp_f32 v18, v18
v_mfma_f32_16x16x32_bf16 v[28:31], a[20:23], a[52:55], v[28:31]
v_exp_f32 v19, v19
v_mfma_f32_16x16x32_bf16 v[28:31], a[24:27], a[56:59], v[28:31]
v_exp_f32 v20, v20
v_mfma_f32_16x16x32_bf16 v[28:31], a[28:31], a[60:63], v[28:31]
v_exp_f32 v21, v21
v_mfma_f32_16x16x32_bf16 v[192:195], a[64:67], v[56:59], v[192:195]
v_exp_f32 v22, v22
v_mfma_f32_16x16x32_bf16 v[196:199], a[68:71], v[56:59], v[196:199]
buffer_load_dwordx4 a[140:143], v3, s[80:83], s99 offen offset:0 sc1
v_cvt_pk_bf16_f32 v49, v18, v19
v_mfma_f32_16x16x32_bf16 v[200:203], a[72:75], v[56:59], v[200:203]
v_exp_f32 v23, v23
v_mfma_f32_16x16x32_bf16 v[204:207], a[76:79], v[56:59], v[204:207]
v_exp_f32 v24, v24
v_mfma_f32_16x16x32_bf16 v[208:211], a[80:83], v[56:59], v[208:211]
v_exp_f32 v25, v25
v_mfma_f32_16x16x32_bf16 v[212:215], a[84:87], v[56:59], v[212:215]
v_exp_f32 v26, v26
v_mfma_f32_16x16x32_bf16 v[216:219], a[88:91], v[56:59], v[216:219]
v_exp_f32 v27, v27
v_mfma_f32_16x16x32_bf16 v[220:223], a[92:95], v[56:59], v[220:223]
buffer_load_dwordx4 a[240:243], v3, s[80:83], s99 offen offset:1024 sc1
v_cvt_pk_bf16_f32 v50, v20, v21
v_mfma_f32_16x16x32_bf16 v[116:119], v[124:127], v[56:59], v[116:119]
v_exp_f32 v28, v28
v_mfma_f32_16x16x32_bf16 v[224:227], a[64:67], v[60:63], v[224:227]
v_exp_f32 v29, v29
v_mfma_f32_16x16x32_bf16 v[228:231], a[68:71], v[60:63], v[228:231]
ds_read_b64_tr_b16 a[64:65], v88 offset:57344
v_cvt_pk_bf16_f32 v51, v22, v23
v_mfma_f32_16x16x32_bf16 v[232:235], a[72:75], v[60:63], v[232:235]
ds_read_b64_tr_b16 a[66:67], v88 offset:61440
v_cvt_pk_bf16_f32 v52, v24, v25
v_mfma_f32_16x16x32_bf16 v[236:239], a[76:79], v[60:63], v[236:239]
ds_read_b64_tr_b16 a[68:69], v89 offset:57344
v_cvt_pk_bf16_f32 v53, v26, v27
v_mfma_f32_16x16x32_bf16 v[240:243], a[80:83], v[60:63], v[240:243]
ds_read_b64_tr_b16 a[70:71], v89 offset:61440
v_cvt_pk_bf16_f32 v54, v28, v29
v_mfma_f32_16x16x32_bf16 v[244:247], a[84:87], v[60:63], v[244:247]
ds_read_b64_tr_b16 a[72:73], v90 offset:57344
v_mfma_f32_16x16x32_bf16 v[248:251], a[88:91], v[60:63], v[248:251]
ds_read_b64_tr_b16 a[74:75], v90 offset:61440
v_mfma_f32_16x16x32_bf16 v[252:255], a[92:95], v[60:63], v[252:255]
ds_read_b64_tr_b16 a[76:77], v91 offset:57344
v_mfma_f32_16x16x32_bf16 v[120:123], v[124:127], v[60:63], v[120:123]
ds_read_b64_tr_b16 a[78:79], v91 offset:61440
buffer_load_dwordx4 a[244:247], v3, s[80:83], s99 offen offset:2048 sc1
v_mfma_f32_16x16x32_bf16 v[32:35], a[0:3], a[96:99], v[72:75]
ds_read_b64_tr_b16 a[80:81], v92 offset:57344
v_mfma_f32_16x16x32_bf16 v[32:35], a[4:7], a[100:103], v[32:35]
ds_read_b64_tr_b16 a[82:83], v92 offset:61440
v_mfma_f32_16x16x32_bf16 v[32:35], a[8:11], a[104:107], v[32:35]
ds_read_b64_tr_b16 a[84:85], v93 offset:57344
v_mfma_f32_16x16x32_bf16 v[32:35], a[12:15], a[108:111], v[32:35]
ds_read_b64_tr_b16 a[86:87], v93 offset:61440
v_mfma_f32_16x16x32_bf16 v[36:39], a[16:19], a[96:99], v[72:75]
ds_read_b64_tr_b16 a[88:89], v94 offset:57344
buffer_load_dwordx4 a[248:251], v8, s[56:59], s98 offen offset:0 sc1
v_mfma_f32_16x16x32_bf16 v[36:39], a[20:23], a[100:103], v[36:39]
ds_read_b64_tr_b16 a[90:91], v94 offset:61440
v_mfma_f32_16x16x32_bf16 v[36:39], a[24:27], a[104:107], v[36:39]
ds_read_b64_tr_b16 a[92:93], v95 offset:57344
v_mfma_f32_16x16x32_bf16 v[36:39], a[28:31], a[108:111], v[36:39]
ds_read_b64_tr_b16 a[94:95], v95 offset:61440
v_mfma_f32_16x16x32_bf16 v[40:43], a[0:3], a[112:115], v[76:79]
v_exp_f32 v30, v30
v_mfma_f32_16x16x32_bf16 v[40:43], a[4:7], a[116:119], v[40:43]
v_exp_f32 v31, v31
v_mfma_f32_16x16x32_bf16 v[40:43], a[8:11], a[120:123], v[40:43]
v_exp_f32 v32, v32
v_mfma_f32_16x16x32_bf16 v[40:43], a[12:15], a[124:127], v[40:43]
v_exp_f32 v33, v33
v_mfma_f32_16x16x32_bf16 v[44:47], a[16:19], a[112:115], v[76:79]
v_exp_f32 v34, v34
v_mfma_f32_16x16x32_bf16 v[44:47], a[20:23], a[116:119], v[44:47]
v_exp_f32 v35, v35
v_mfma_f32_16x16x32_bf16 v[44:47], a[24:27], a[120:123], v[44:47]
v_exp_f32 v36, v36
v_mfma_f32_16x16x32_bf16 v[44:47], a[28:31], a[124:127], v[44:47]
s_waitcnt lgkmcnt(0)
v_exp_f32 v37, v37
v_mfma_f32_16x16x32_bf16 v[128:131], a[64:67], v[48:51], v[128:131]
v_cvt_pk_bf16_f32 v55, v30, v31
v_mfma_f32_16x16x32_bf16 v[132:135], a[68:71], v[48:51], v[132:135]
v_cvt_pk_bf16_f32 v56, v32, v33
v_mfma_f32_16x16x32_bf16 v[136:139], a[72:75], v[48:51], v[136:139]
v_cvt_pk_bf16_f32 v57, v34, v35
v_mfma_f32_16x16x32_bf16 v[140:143], a[76:79], v[48:51], v[140:143]
v_cvt_pk_bf16_f32 v58, v36, v37
v_mfma_f32_16x16x32_bf16 v[144:147], a[80:83], v[48:51], v[144:147]
v_mfma_f32_16x16x32_bf16 v[148:151], a[84:87], v[48:51], v[148:151]
buffer_load_dwordx4 a[252:255], v8, s[56:59], s98 offen offset:1024 sc1
v_mfma_f32_16x16x32_bf16 v[152:155], a[88:91], v[48:51], v[152:155]
v_mfma_f32_16x16x32_bf16 v[156:159], a[92:95], v[48:51], v[156:159]
v_mfma_f32_16x16x32_bf16 v[108:111], v[124:127], v[48:51], v[108:111]
v_exp_f32 v38, v38
v_mfma_f32_16x16x32_bf16 v[160:163], a[64:67], v[52:55], v[160:163]
v_exp_f32 v39, v39
v_mfma_f32_16x16x32_bf16 v[164:167], a[68:71], v[52:55], v[164:167]
v_exp_f32 v40, v40
v_mfma_f32_16x16x32_bf16 v[168:171], a[72:75], v[52:55], v[168:171]
v_exp_f32 v41, v41
v_mfma_f32_16x16x32_bf16 v[172:175], a[76:79], v[52:55], v[172:175]
v_exp_f32 v42, v42
v_mfma_f32_16x16x32_bf16 v[176:179], a[80:83], v[52:55], v[176:179]
v_exp_f32 v43, v43
v_mfma_f32_16x16x32_bf16 v[180:183], a[84:87], v[52:55], v[180:183]
v_exp_f32 v44, v44
v_mfma_f32_16x16x32_bf16 v[184:187], a[88:91], v[52:55], v[184:187]
v_exp_f32 v45, v45
v_mfma_f32_16x16x32_bf16 v[188:191], a[92:95], v[52:55], v[188:191]
v_exp_f32 v46, v46
v_mfma_f32_16x16x32_bf16 v[112:115], v[124:127], v[52:55], v[112:115]
v_exp_f32 v47, v47
v_cvt_pk_bf16_f32 v59, v38, v39
s_nop 1
v_mfma_f32_16x16x32_bf16 v[192:195], a[64:67], v[56:59], v[192:195]
buffer_load_dwordx4 a[0:3], v8, s[56:59], s98 offen offset:2048 sc1
v_cvt_pk_bf16_f32 v60, v40, v41
v_cvt_pk_bf16_f32 v61, v42, v43
v_mfma_f32_16x16x32_bf16 v[196:199], a[68:71], v[56:59], v[196:199]
buffer_load_dwordx4 a[4:7], v9, s[56:59], s98 offen offset:0 sc1
v_cvt_pk_bf16_f32 v62, v44, v45
v_cvt_pk_bf16_f32 v63, v46, v47
v_mfma_f32_16x16x32_bf16 v[200:203], a[72:75], v[56:59], v[200:203]
buffer_load_dwordx4 a[8:11], v9, s[56:59], s98 offen offset:1024 sc1
v_cmp_ngt_f32 vcc, 1317011456, v108
v_rcp_f32 v80, v108
v_mfma_f32_16x16x32_bf16 v[204:207], a[76:79], v[56:59], v[204:207]
buffer_load_dwordx4 a[12:15], v9, s[56:59], s98 offen offset:2048 sc1
s_add_u32 s98, s98, 122880
s_add_u32 s99, s99, 36864
s_or_b32 s38, s38, vcc_lo
s_or_b32 s38, s38, vcc_hi
v_mfma_f32_16x16x32_bf16 v[208:211], a[80:83], v[56:59], v[208:211]
buffer_load_dwordx4 a[16:19], v2, s[80:83], s99 offen offset:0 sc1
v_cmp_ngt_f32 vcc, 1317011456, v112
v_rcp_f32 v81, v112
v_mfma_f32_16x16x32_bf16 v[212:215], a[84:87], v[56:59], v[212:215]
buffer_load_dwordx4 a[20:23], v2, s[80:83], s99 offen offset:1024 sc1
s_nop 0
s_or_b32 s38, s38, vcc_lo
s_or_b32 s38, s38, vcc_hi
v_mfma_f32_16x16x32_bf16 v[216:219], a[88:91], v[56:59], v[216:219]
buffer_load_dwordx4 a[24:27], v2, s[80:83], s99 offen offset:2048 sc1
v_mul_f32 v128, v128, v80
v_mul_f32 v129, v129, v80
v_mfma_f32_16x16x32_bf16 v[220:223], a[92:95], v[56:59], v[220:223]
buffer_load_dwordx4 a[28:31], v3, s[80:83], s99 offen offset:0 sc1
v_mul_f32 v130, v130, v80
v_mul_f32 v131, v131, v80
v_mfma_f32_16x16x32_bf16 v[116:119], v[124:127], v[56:59], v[116:119]
buffer_load_dwordx4 a[32:35], v3, s[80:83], s99 offen offset:1024 sc1
v_mul_f32 v132, v132, v80
v_mul_f32 v133, v133, v80
v_mfma_f32_16x16x32_bf16 v[224:227], a[64:67], v[60:63], v[224:227]
buffer_load_dwordx4 a[36:39], v3, s[80:83], s99 offen offset:2048 sc1
v_mul_f32 v134, v134, v80
v_mul_f32 v135, v135, v80
v_mfma_f32_16x16x32_bf16 v[228:231], a[68:71], v[60:63], v[228:231]
buffer_load_dwordx4 a[40:43], v8, s[56:59], s98 offen offset:0 sc1
v_cvt_pk_bf16_f32 v48, v128, v129
v_cvt_pk_bf16_f32 v49, v130, v131
v_mfma_f32_16x16x32_bf16 v[232:235], a[72:75], v[60:63], v[232:235]
buffer_load_dwordx4 a[44:47], v8, s[56:59], s98 offen offset:1024 sc1
v_cvt_pk_bf16_f32 v50, v132, v133
v_cvt_pk_bf16_f32 v51, v134, v135
v_mfma_f32_16x16x32_bf16 v[236:239], a[76:79], v[60:63], v[236:239]
buffer_load_dwordx4 a[48:51], v8, s[56:59], s98 offen offset:2048 sc1
s_add_u32 s46, s43, 0
buffer_store_dwordx4 v[48:51], v100, s[20:23], s46 offen offset:0 sc1
v_mfma_f32_16x16x32_bf16 v[240:243], a[80:83], v[60:63], v[240:243]
buffer_load_dwordx4 a[52:55], v9, s[56:59], s98 offen offset:0 sc1
v_mul_f32 v136, v136, v80
v_mul_f32 v137, v137, v80
v_mfma_f32_16x16x32_bf16 v[244:247], a[84:87], v[60:63], v[244:247]
buffer_load_dwordx4 a[56:59], v9, s[56:59], s98 offen offset:1024 sc1
v_mul_f32 v138, v138, v80
v_mul_f32 v139, v139, v80
v_mfma_f32_16x16x32_bf16 v[248:251], a[88:91], v[60:63], v[248:251]
buffer_load_dwordx4 a[60:63], v9, s[56:59], s98 offen offset:2048 sc1
s_add_u32 s98, s98, 614400
s_add_u32 s99, s99, 184320
v_mul_f32 v140, v140, v80
v_mul_f32 v141, v141, v80
v_mfma_f32_16x16x32_bf16 v[252:255], a[92:95], v[60:63], v[252:255]
v_mul_f32 v142, v142, v80
v_mul_f32 v143, v143, v80
v_mfma_f32_16x16x32_bf16 v[120:123], v[124:127], v[60:63], v[120:123]
v_cvt_pk_bf16_f32 v52, v136, v137
v_cvt_pk_bf16_f32 v53, v138, v139
v_cvt_pk_bf16_f32 v54, v140, v141
v_cvt_pk_bf16_f32 v55, v142, v143
s_add_u32 s46, s43, 122880
buffer_store_dwordx4 v[52:55], v100, s[20:23], s46 offen offset:0 sc1
v_mul_f32 v144, v144, v80
v_mul_f32 v145, v145, v80
v_mul_f32 v146, v146, v80
v_mul_f32 v147, v147, v80
v_mul_f32 v148, v148, v80
v_mul_f32 v149, v149, v80
v_mul_f32 v150, v150, v80
v_mul_f32 v151, v151, v80
v_cvt_pk_bf16_f32 v48, v144, v145
v_cvt_pk_bf16_f32 v49, v146, v147
v_cvt_pk_bf16_f32 v50, v148, v149
v_cvt_pk_bf16_f32 v51, v150, v151
s_add_u32 s46, s43, 245760
buffer_store_dwordx4 v[48:51], v100, s[20:23], s46 offen offset:0 sc1
v_mul_f32 v152, v152, v80
v_mul_f32 v153, v153, v80
v_mul_f32 v154, v154, v80
v_mul_f32 v155, v155, v80
v_mul_f32 v156, v156, v80
v_mul_f32 v157, v157, v80
v_mul_f32 v158, v158, v80
v_mul_f32 v159, v159, v80
v_cvt_pk_bf16_f32 v52, v152, v153
v_cvt_pk_bf16_f32 v53, v154, v155
v_cvt_pk_bf16_f32 v54, v156, v157
v_cvt_pk_bf16_f32 v55, v158, v159
s_add_u32 s46, s43, 368640
buffer_store_dwordx4 v[52:55], v100, s[20:23], s46 offen offset:0 sc1
v_pk_mul_f32 v[160:161], v[160:161], v[80:81] op_sel:[0,1] op_sel_hi:[1,1]
v_pk_mul_f32 v[162:163], v[162:163], v[80:81] op_sel:[0,1] op_sel_hi:[1,1]
v_cmp_ngt_f32 vcc, 1317011456, v116
v_pk_mul_f32 v[164:165], v[164:165], v[80:81] op_sel:[0,1] op_sel_hi:[1,1]
v_pk_mul_f32 v[166:167], v[166:167], v[80:81] op_sel:[0,1] op_sel_hi:[1,1]
v_rcp_f32 v82, v116
v_cvt_pk_bf16_f32 v48, v160, v161
v_cvt_pk_bf16_f32 v49, v162, v163
s_or_b32 s38, s38, vcc_lo
v_cvt_pk_bf16_f32 v50, v164, v165
v_cvt_pk_bf16_f32 v51, v166, v167
s_or_b32 s38, s38, vcc_hi
s_add_u32 s46, s43, 0
buffer_store_dwordx4 v[48:51], v100, s[20:23], s46 offen offset:1024 sc1
v_cmp_ngt_f32 vcc, 1317011456, v120
v_pk_mul_f32 v[168:169], v[168:169], v[80:81] op_sel:[0,1] op_sel_hi:[1,1]
v_pk_mul_f32 v[170:171], v[170:171], v[80:81] op_sel:[0,1] op_sel_hi:[1,1]
v_rcp_f32 v83, v120
v_pk_mul_f32 v[172:173], v[172:173], v[80:81] op_sel:[0,1] op_sel_hi:[1,1]
v_pk_mul_f32 v[174:175], v[174:175], v[80:81] op_sel:[0,1] op_sel_hi:[1,1]
s_or_b32 s38, s38, vcc_lo
v_cvt_pk_bf16_f32 v52, v168, v169
v_cvt_pk_bf16_f32 v53, v170, v171
s_or_b32 s38, s38, vcc_hi
v_cvt_pk_bf16_f32 v54, v172, v173
v_cvt_pk_bf16_f32 v55, v174, v175
s_add_u32 s46, s43, 122880
buffer_store_dwordx4 v[52:55], v100, s[20:23], s46 offen offset:1024 sc1
v_pk_mul_f32 v[176:177], v[176:177], v[80:81] op_sel:[0,1] op_sel_hi:[1,1]
v_pk_mul_f32 v[178:179], v[178:179], v[80:81] op_sel:[0,1] op_sel_hi:[1,1]
v_pk_mul_f32 v[180:181], v[180:181], v[80:81] op_sel:[0,1] op_sel_hi:[1,1]
v_pk_mul_f32 v[182:183], v[182:183], v[80:81] op_sel:[0,1] op_sel_hi:[1,1]
v_cvt_pk_bf16_f32 v48, v176, v177
v_cvt_pk_bf16_f32 v49, v178, v179
v_cvt_pk_bf16_f32 v50, v180, v181
v_cvt_pk_bf16_f32 v51, v182, v183
s_add_u32 s46, s43, 245760
buffer_store_dwordx4 v[48:51], v100, s[20:23], s46 offen offset:1024 sc1
v_pk_mul_f32 v[184:185], v[184:185], v[80:81] op_sel:[0,1] op_sel_hi:[1,1]
v_pk_mul_f32 v[186:187], v[186:187], v[80:81] op_sel:[0,1] op_sel_hi:[1,1]
v_pk_mul_f32 v[188:189], v[188:189], v[80:81] op_sel:[0,1] op_sel_hi:[1,1]
v_pk_mul_f32 v[190:191], v[190:191], v[80:81] op_sel:[0,1] op_sel_hi:[1,1]
v_cvt_pk_bf16_f32 v52, v184, v185
v_cvt_pk_bf16_f32 v53, v186, v187
v_cvt_pk_bf16_f32 v54, v188, v189
v_cvt_pk_bf16_f32 v55, v190, v191
s_add_u32 s46, s43, 368640
buffer_store_dwordx4 v[52:55], v100, s[20:23], s46 offen offset:1024 sc1
v_pk_mul_f32 v[192:193], v[192:193], v[82:83] op_sel:[0,0] op_sel_hi:[1,0]
v_pk_mul_f32 v[194:195], v[194:195], v[82:83] op_sel:[0,0] op_sel_hi:[1,0]
v_pk_mul_f32 v[196:197], v[196:197], v[82:83] op_sel:[0,0] op_sel_hi:[1,0]
v_pk_mul_f32 v[198:199], v[198:199], v[82:83] op_sel:[0,0] op_sel_hi:[1,0]
v_cvt_pk_bf16_f32 v48, v192, v193
v_cvt_pk_bf16_f32 v49, v194, v195
v_cvt_pk_bf16_f32 v50, v196, v197
v_cvt_pk_bf16_f32 v51, v198, v199
s_add_u32 s46, s43, 0
buffer_store_dwordx4 v[48:51], v100, s[20:23], s46 offen offset:2048 sc1
v_pk_mul_f32 v[200:201], v[200:201], v[82:83] op_sel:[0,0] op_sel_hi:[1,0]
v_pk_mul_f32 v[202:203], v[202:203], v[82:83] op_sel:[0,0] op_sel_hi:[1,0]
v_pk_mul_f32 v[204:205], v[204:205], v[82:83] op_sel:[0,0] op_sel_hi:[1,0]
v_pk_mul_f32 v[206:207], v[206:207], v[82:83] op_sel:[0,0] op_sel_hi:[1,0]
v_cvt_pk_bf16_f32 v52, v200, v201
v_cvt_pk_bf16_f32 v53, v202, v203
v_cvt_pk_bf16_f32 v54, v204, v205
v_cvt_pk_bf16_f32 v55, v206, v207
s_add_u32 s46, s43, 122880
buffer_store_dwordx4 v[52:55], v100, s[20:23], s46 offen offset:2048 sc1
v_pk_mul_f32 v[208:209], v[208:209], v[82:83] op_sel:[0,0] op_sel_hi:[1,0]
v_pk_mul_f32 v[210:211], v[210:211], v[82:83] op_sel:[0,0] op_sel_hi:[1,0]
v_pk_mul_f32 v[212:213], v[212:213], v[82:83] op_sel:[0,0] op_sel_hi:[1,0]
v_pk_mul_f32 v[214:215], v[214:215], v[82:83] op_sel:[0,0] op_sel_hi:[1,0]
v_cvt_pk_bf16_f32 v48, v208, v209
v_cvt_pk_bf16_f32 v49, v210, v211
v_cvt_pk_bf16_f32 v50, v212, v213
v_cvt_pk_bf16_f32 v51, v214, v215
s_add_u32 s46, s43, 245760
buffer_store_dwordx4 v[48:51], v100, s[20:23], s46 offen offset:2048 sc1
v_pk_mul_f32 v[216:217], v[216:217], v[82:83] op_sel:[0,0] op_sel_hi:[1,0]
v_pk_mul_f32 v[218:219], v[218:219], v[82:83] op_sel:[0,0] op_sel_hi:[1,0]
v_pk_mul_f32 v[220:221], v[220:221], v[82:83] op_sel:[0,0] op_sel_hi:[1,0]
v_pk_mul_f32 v[222:223], v[222:223], v[82:83] op_sel:[0,0] op_sel_hi:[1,0]
v_cvt_pk_bf16_f32 v52, v216, v217
v_cvt_pk_bf16_f32 v53, v218, v219
v_cvt_pk_bf16_f32 v54, v220, v221
v_cvt_pk_bf16_f32 v55, v222, v223
s_add_u32 s46, s43, 368640
buffer_store_dwordx4 v[52:55], v100, s[20:23], s46 offen offset:2048 sc1
v_pk_mul_f32 v[224:225], v[224:225], v[82:83] op_sel:[0,1] op_sel_hi:[1,1]
v_pk_mul_f32 v[226:227], v[226:227], v[82:83] op_sel:[0,1] op_sel_hi:[1,1]
v_pk_mul_f32 v[228:229], v[228:229], v[82:83] op_sel:[0,1] op_sel_hi:[1,1]
v_pk_mul_f32 v[230:231], v[230:231], v[82:83] op_sel:[0,1] op_sel_hi:[1,1]
v_cvt_pk_bf16_f32 v48, v224, v225
v_cvt_pk_bf16_f32 v49, v226, v227
v_cvt_pk_bf16_f32 v50, v228, v229
v_cvt_pk_bf16_f32 v51, v230, v231
s_add_u32 s46, s43, 0
buffer_store_dwordx4 v[48:51], v100, s[20:23], s46 offen offset:3072 sc1
v_pk_mul_f32 v[232:233], v[232:233], v[82:83] op_sel:[0,1] op_sel_hi:[1,1]
v_pk_mul_f32 v[234:235], v[234:235], v[82:83] op_sel:[0,1] op_sel_hi:[1,1]
v_pk_mul_f32 v[236:237], v[236:237], v[82:83] op_sel:[0,1] op_sel_hi:[1,1]
v_pk_mul_f32 v[238:239], v[238:239], v[82:83] op_sel:[0,1] op_sel_hi:[1,1]
v_cvt_pk_bf16_f32 v52, v232, v233
v_cvt_pk_bf16_f32 v53, v234, v235
v_cvt_pk_bf16_f32 v54, v236, v237
v_cvt_pk_bf16_f32 v55, v238, v239
s_add_u32 s46, s43, 122880
buffer_store_dwordx4 v[52:55], v100, s[20:23], s46 offen offset:3072 sc1
v_pk_mul_f32 v[240:241], v[240:241], v[82:83] op_sel:[0,1] op_sel_hi:[1,1]
v_pk_mul_f32 v[242:243], v[242:243], v[82:83] op_sel:[0,1] op_sel_hi:[1,1]
v_pk_mul_f32 v[244:245], v[244:245], v[82:83] op_sel:[0,1] op_sel_hi:[1,1]
v_pk_mul_f32 v[246:247], v[246:247], v[82:83] op_sel:[0,1] op_sel_hi:[1,1]
v_cvt_pk_bf16_f32 v48, v240, v241
v_cvt_pk_bf16_f32 v49, v242, v243
v_cvt_pk_bf16_f32 v50, v244, v245
v_cvt_pk_bf16_f32 v51, v246, v247
s_add_u32 s46, s43, 245760
buffer_store_dwordx4 v[48:51], v100, s[20:23], s46 offen offset:3072 sc1
v_pk_mul_f32 v[248:249], v[248:249], v[82:83] op_sel:[0,1] op_sel_hi:[1,1]
v_pk_mul_f32 v[250:251], v[250:251], v[82:83] op_sel:[0,1] op_sel_hi:[1,1]
v_pk_mul_f32 v[252:253], v[252:253], v[82:83] op_sel:[0,1] op_sel_hi:[1,1]
v_pk_mul_f32 v[254:255], v[254:255], v[82:83] op_sel:[0,1] op_sel_hi:[1,1]
v_cvt_pk_bf16_f32 v52, v248, v249
v_cvt_pk_bf16_f32 v53, v250, v251
v_cvt_pk_bf16_f32 v54, v252, v253
v_cvt_pk_bf16_f32 v55, v254, v255
s_add_u32 s46, s43, 368640
s_waitcnt vmcnt(52)
buffer_store_dwordx4 v[52:55], v100, s[20:23], s46 offen offset:3072 sc1
v_mov_b32 v4, s38
s_lshl_b32 s46, s32, 2
s_add_u32 s46, s46, 138240
v_mov_b32 v5, s46
ds_write_b32 v5, v4
L_p2s4:
s_waitcnt vmcnt(51)
v_mfma_f32_16x16x32_bf16 v[112:115], a[144:147], a[168:171], 0
v_mfma_f32_16x16x32_bf16 v[116:119], a[148:151], a[168:171], 0
v_mfma_f32_16x16x32_bf16 v[120:123], a[152:155], a[168:171], 0
v_mfma_f32_16x16x32_bf16 v[124:127], a[156:159], a[168:171], 0
v_mfma_f32_16x16x32_bf16 v[128:131], a[160:163], a[168:171], 0
v_mfma_f32_16x16x32_bf16 v[132:135], a[164:167], a[168:171], 0
buffer_load_dwordx4 a[168:171], v8, s[56:59], s98 offen offset:0 sc1
v_mfma_f32_16x16x32_bf16 v[136:139], a[144:147], a[172:175], 0
v_mfma_f32_16x16x32_bf16 v[140:143], a[148:151], a[172:175], 0
v_mfma_f32_16x16x32_bf16 v[144:147], a[152:155], a[172:175], 0
v_mfma_f32_16x16x32_bf16 v[148:151], a[156:159], a[172:175], 0
v_mfma_f32_16x16x32_bf16 v[152:155], a[160:163], a[172:175], 0
v_mfma_f32_16x16x32_bf16 v[156:159], a[164:167], a[172:175], 0
buffer_load_dwordx4 a[172:175], v8, s[56:59], s98 offen offset:1024 sc1
v_mfma_f32_16x16x32_bf16 v[160:163], a[144:147], a[176:179], 0
v_mfma_f32_16x16x32_bf16 v[164:167], a[148:151], a[176:179], 0
v_mfma_f32_16x16x32_bf16 v[168:171], a[152:155], a[176:179], 0
v_mfma_f32_16x16x32_bf16 v[172:175], a[156:159], a[176:179], 0
v_mfma_f32_16x16x32_bf16 v[176:179], a[160:163], a[176:179], 0
v_mfma_f32_16x16x32_bf16 v[180:183], a[164:167], a[176:179], 0
buffer_load_dwordx4 a[176:179], v8, s[56:59], s98 offen offset:2048 sc1
v_mfma_f32_16x16x32_bf16 v[184:187], a[144:147], a[180:183], 0
v_mfma_f32_16x16x32_bf16 v[188:191], a[148:151], a[180:183], 0
v_mfma_f32_16x16x32_bf16 v[192:195], a[152:155], a[180:183], 0
v_mfma_f32_16x16x32_bf16 v[196:199], a[156:159], a[180:183], 0
v_mfma_f32_16x16x32_bf16 v[200:203], a[160:163], a[180:183], 0
v_mfma_f32_16x16x32_bf16 v[204:207], a[164:167], a[180:183], 0
buffer_load_dwordx4 a[180:183], v9, s[56:59], s98 offen offset:0 sc1
v_mfma_f32_16x16x32_bf16 v[208:211], a[144:147], a[184:187], 0
v_mfma_f32_16x16x32_bf16 v[212:215], a[148:151], a[184:187], 0
v_mfma_f32_16x16x32_bf16 v[216:219], a[152:155], a[184:187], 0
v_mfma_f32_16x16x32_bf16 v[220:223], a[156:159], a[184:187], 0
v_mfma_f32_16x16x32_bf16 v[224:227], a[160:163], a[184:187], 0
v_mfma_f32_16x16x32_bf16 v[228:231], a[164:167], a[184:187], 0
buffer_load_dwordx4 a[184:187], v9, s[56:59], s98 offen offset:1024 sc1
v_mfma_f32_16x16x32_bf16 v[232:235], a[144:147], a[188:191], 0
buffer_load_dwordx4 a[144:147], v2, s[80:83], s99 offen offset:0 sc1
v_mfma_f32_16x16x32_bf16 v[236:239], a[148:151], a[188:191], 0
buffer_load_dwordx4 a[148:151], v2, s[80:83], s99 offen offset:1024 sc1
v_mfma_f32_16x16x32_bf16 v[240:243], a[152:155], a[188:191], 0
buffer_load_dwordx4 a[152:155], v2, s[80:83], s99 offen offset:2048 sc1
v_mfma_f32_16x16x32_bf16 v[244:247], a[156:159], a[188:191], 0
buffer_load_dwordx4 a[156:159], v3, s[80:83], s99 offen offset:0 sc1
v_mfma_f32_16x16x32_bf16 v[248:251], a[160:163], a[188:191], 0
buffer_load_dwordx4 a[160:163], v3, s[80:83], s99 offen offset:1024 sc1
v_mfma_f32_16x16x32_bf16 v[252:255], a[164:167], a[188:191], 0
buffer_load_dwordx4 a[188:191], v9, s[56:59], s98 offen offset:2048 sc1
buffer_load_dwordx4 a[164:167], v3, s[80:83], s99 offen offset:2048 sc1
s_add_u32 s98, s98, 122880
s_add_u32 s99, s99, 36864
s_waitcnt vmcnt(51)
v_mfma_f32_16x16x32_bf16 v[112:115], a[192:195], a[216:219], v[112:115]
v_mfma_f32_16x16x32_bf16 v[116:119], a[196:199], a[216:219], v[116:119]
v_mfma_f32_16x16x32_bf16 v[120:123], a[200:203], a[216:219], v[120:123]
v_mfma_f32_16x16x32_bf16 v[124:127], a[204:207], a[216:219], v[124:127]
v_mfma_f32_16x16x32_bf16 v[128:131], a[208:211], a[216:219], v[128:131]
v_mfma_f32_16x16x32_bf16 v[132:135], a[212:215], a[216:219], v[132:135]
buffer_load_dwordx4 a[216:219], v8, s[56:59], s98 offen offset:0 sc1
v_mfma_f32_16x16x32_bf16 v[136:139], a[192:195], a[220:223], v[136:139]
v_mfma_f32_16x16x32_bf16 v[140:143], a[196:199], a[220:223], v[140:143]
v_mfma_f32_16x16x32_bf16 v[144:147], a[200:203], a[220:223], v[144:147]
v_mfma_f32_16x16x32_bf16 v[148:151], a[204:207], a[220:223], v[148:151]
v_mfma_f32_16x16x32_bf16 v[152:155], a[208:211], a[220:223], v[152:155]
v_mfma_f32_16x16x32_bf16 v[156:159], a[212:215], a[220:223], v[156:159]
buffer_load_dwordx4 a[220:223], v8, s[56:59], s98 offen offset:1024 sc1
v_mfma_f32_16x16x32_bf16 v[160:163], a[192:195], a[224:227], v[160:163]
v_mfma_f32_16x16x32_bf16 v[164:167], a[196:199], a[224:227], v[164:167]
v_mfma_f32_16x16x32_bf16 v[168:171], a[200:203], a[224:227], v[168:171]
v_mfma_f32_16x16x32_bf16 v[172:175], a[204:207], a[224:227], v[172:175]
v_mfma_f32_16x16x32_bf16 v[176:179], a[208:211], a[224:227], v[176:179]
v_mfma_f32_16x16x32_bf16 v[180:183], a[212:215], a[224:227], v[180:183]
buffer_load_dwordx4 a[224:227], v8, s[56:59], s98 offen offset:2048 sc1
v_mfma_f32_16x16x32_bf16 v[184:187], a[192:195], a[228:231], v[184:187]
v_mfma_f32_16x16x32_bf16 v[188:191], a[196:199], a[228:231], v[188:191]
v_mfma_f32_16x16x32_bf16 v[192:195], a[200:203], a[228:231], v[192:195]
v_mfma_f32_16x16x32_bf16 v[196:199], a[204:207], a[228:231], v[196:199]
v_mfma_f32_16x16x32_bf16 v[200:203], a[208:211], a[228:231], v[200:203]
v_mfma_f32_16x16x32_bf16 v[204:207], a[212:215], a[228:231], v[204:207]
buffer_load_dwordx4 a[228:231], v9, s[56:59], s98 offen offset:0 sc1
v_mfma_f32_16x16x32_bf16 v[208:211], a[192:195], a[232:235], v[208:211]
v_mfma_f32_16x16x32_bf16 v[212:215], a[196:199], a[232:235], v[212:215]
v_mfma_f32_16x16x32_bf16 v[216:219], a[200:203], a[232:235], v[216:219]
v_mfma_f32_16x16x32_bf16 v[220:223], a[204:207], a[232:235], v[220:223]
v_mfma_f32_16x16x32_bf16 v[224:227], a[208:211], a[232:235], v[224:227]
v_mfma_f32_16x16x32_bf16 v[228:231], a[212:215], a[232:235], v[228:231]
buffer_load_dwordx4 a[232:235], v9, s[56:59], s98 offen offset:1024 sc1
v_mfma_f32_16x16x32_bf16 v[232:235], a[192:195], a[236:239], v[232:235]
buffer_load_dwordx4 a[192:195], v2, s[80:83], s99 offen offset:0 sc1
v_mfma_f32_16x16x32_bf16 v[236:239], a[196:199], a[236:239], v[236:239]
buffer_load_dwordx4 a[196:199], v2, s[80:83], s99 offen offset:1024 sc1
v_mfma_f32_16x16x32_bf16 v[240:243], a[200:203], a[236:239], v[240:243]
buffer_load_dwordx4 a[200:203], v2, s[80:83], s99 offen offset:2048 sc1
v_mfma_f32_16x16x32_bf16 v[244:247], a[204:207], a[236:239], v[244:247]
buffer_load_dwordx4 a[204:207], v3, s[80:83], s99 offen offset:0 sc1
v_mfma_f32_16x16x32_bf16 v[248:251], a[208:211], a[236:239], v[248:251]
buffer_load_dwordx4 a[208:211], v3, s[80:83], s99 offen offset:1024 sc1
v_mfma_f32_16x16x32_bf16 v[252:255], a[212:215], a[236:239], v[252:255]
buffer_load_dwordx4 a[236:239], v9, s[56:59], s98 offen offset:2048 sc1
buffer_load_dwordx4 a[212:215], v3, s[80:83], s99 offen offset:2048 sc1
s_add_u32 s98, s98, 122880
s_add_u32 s99, s99, 36864
s_waitcnt vmcnt(51)
v_mfma_f32_16x16x32_bf16 v[112:115], a[128:131], a[248:251], v[112:115]
v_mfma_f32_16x16x32_bf16 v[116:119], a[132:135], a[248:251], v[116:119]
v_mfma_f32_16x16x32_bf16 v[120:123], a[136:139], a[248:251], v[120:123]
v_mfma_f32_16x16x32_bf16 v[124:127], a[140:143], a[248:251], v[124:127]
v_mfma_f32_16x16x32_bf16 v[128:131], a[240:243], a[248:251], v[128:131]
v_mfma_f32_16x16x32_bf16 v[132:135], a[244:247], a[248:251], v[132:135]
buffer_load_dwordx4 a[248:251], v8, s[56:59], s98 offen offset:0 sc1
v_mfma_f32_16x16x32_bf16 v[136:139], a[128:131], a[252:255], v[136:139]
v_mfma_f32_16x16x32_bf16 v[140:143], a[132:135], a[252:255], v[140:143]
v_mfma_f32_16x16x32_bf16 v[144:147], a[136:139], a[252:255], v[144:147]
v_mfma_f32_16x16x32_bf16 v[148:151], a[140:143], a[252:255], v[148:151]
v_mfma_f32_16x16x32_bf16 v[152:155], a[240:243], a[252:255], v[152:155]
v_mfma_f32_16x16x32_bf16 v[156:159], a[244:247], a[252:255], v[156:159]
buffer_load_dwordx4 a[252:255], v8, s[56:59], s98 offen offset:1024 sc1
v_mfma_f32_16x16x32_bf16 v[160:163], a[128:131], a[0:3], v[160:163]
v_mfma_f32_16x16x32_bf16 v[164:167], a[132:135], a[0:3], v[164:167]
v_mfma_f32_16x16x32_bf16 v[168:171], a[136:139], a[0:3], v[168:171]
v_mfma_f32_16x16x32_bf16 v[172:175], a[140:143], a[0:3], v[172:175]
v_mfma_f32_16x16x32_bf16 v[176:179], a[240:243], a[0:3], v[176:179]
v_mfma_f32_16x16x32_bf16 v[180:183], a[244:247], a[0:3], v[180:183]
buffer_load_dwordx4 a[0:3], v8, s[56:59], s98 offen offset:2048 sc1
v_mfma_f32_16x16x32_bf16 v[184:187], a[128:131], a[4:7], v[184:187]
v_mfma_f32_16x16x32_bf16 v[188:191], a[132:135], a[4:7], v[188:191]
v_mfma_f32_16x16x32_bf16 v[192:195], a[136:139], a[4:7], v[192:195]
v_mfma_f32_16x16x32_bf16 v[196:199], a[140:143], a[4:7], v[196:199]
v_mfma_f32_16x16x32_bf16 v[200:203], a[240:243], a[4:7], v[200:203]
v_mfma_f32_16x16x32_bf16 v[204:207], a[244:247], a[4:7], v[204:207]
buffer_load_dwordx4 a[4:7], v9, s[56:59], s98 offen offset:0 sc1
v_mfma_f32_16x16x32_bf16 v[208:211], a[128:131], a[8:11], v[208:211]
v_mfma_f32_16x16x32_bf16 v[212:215], a[132:135], a[8:11], v[212:215]
v_mfma_f32_16x16x32_bf16 v[216:219], a[136:139], a[8:11], v[216:219]
v_mfma_f32_16x16x32_bf16 v[220:223], a[140:143], a[8:11], v[220:223]
v_mfma_f32_16x16x32_bf16 v[224:227], a[240:243], a[8:11], v[224:227]
v_mfma_f32_16x16x32_bf16 v[228:231], a[244:247], a[8:11], v[228:231]
buffer_load_dwordx4 a[8:11], v9, s[56:59], s98 offen offset:1024 sc1
v_mfma_f32_16x16x32_bf16 v[232:235], a[128:131], a[12:15], v[232:235]
buffer_load_dwordx4 a[128:131], v2, s[80:83], s99 offen offset:0 sc1
v_mfma_f32_16x16x32_bf16 v[236:239], a[132:135], a[12:15], v[236:239]
buffer_load_dwordx4 a[132:135], v2, s[80:83], s99 offen offset:1024 sc1
v_mfma_f32_16x16x32_bf16 v[240:243], a[136:139], a[12:15], v[240:243]
buffer_load_dwordx4 a[136:139], v2, s[80:83], s99 offen offset:2048 sc1
v_mfma_f32_16x16x32_bf16 v[244:247], a[140:143], a[12:15], v[244:247]
buffer_load_dwordx4 a[140:143], v3, s[80:83], s99 offen offset:0 sc1
v_mfma_f32_16x16x32_bf16 v[248:251], a[240:243], a[12:15], v[248:251]
buffer_load_dwordx4 a[240:243], v3, s[80:83], s99 offen offset:1024 sc1
v_mfma_f32_16x16x32_bf16 v[252:255], a[244:247], a[12:15], v[252:255]
buffer_load_dwordx4 a[12:15], v9, s[56:59], s98 offen offset:2048 sc1
buffer_load_dwordx4 a[244:247], v3, s[80:83], s99 offen offset:2048 sc1
s_add_u32 s98, s98, 122880
s_add_u32 s99, s99, 36864
s_waitcnt vmcnt(51)
v_mfma_f32_16x16x32_bf16 v[112:115], a[16:19], a[40:43], v[112:115]
v_mfma_f32_16x16x32_bf16 v[116:119], a[20:23], a[40:43], v[116:119]
v_mfma_f32_16x16x32_bf16 v[120:123], a[24:27], a[40:43], v[120:123]
v_mfma_f32_16x16x32_bf16 v[124:127], a[28:31], a[40:43], v[124:127]
v_mfma_f32_16x16x32_bf16 v[128:131], a[32:35], a[40:43], v[128:131]
v_mfma_f32_16x16x32_bf16 v[132:135], a[36:39], a[40:43], v[132:135]
buffer_load_dwordx4 a[40:43], v8, s[56:59], s98 offen offset:0 sc1
v_mfma_f32_16x16x32_bf16 v[136:139], a[16:19], a[44:47], v[136:139]
v_mfma_f32_16x16x32_bf16 v[140:143], a[20:23], a[44:47], v[140:143]
v_mfma_f32_16x16x32_bf16 v[144:147], a[24:27], a[44:47], v[144:147]
v_mfma_f32_16x16x32_bf16 v[148:151], a[28:31], a[44:47], v[148:151]
v_mfma_f32_16x16x32_bf16 v[152:155], a[32:35], a[44:47], v[152:155]
v_mfma_f32_16x16x32_bf16 v[156:159], a[36:39], a[44:47], v[156:159]
buffer_load_dwordx4 a[44:47], v8, s[56:59], s98 offen offset:1024 sc1
v_mfma_f32_16x16x32_bf16 v[160:163], a[16:19], a[48:51], v[160:163]
v_mfma_f32_16x16x32_bf16 v[164:167], a[20:23], a[48:51], v[164:167]
v_mfma_f32_16x16x32_bf16 v[168:171], a[24:27], a[48:51], v[168:171]
v_mfma_f32_16x16x32_bf16 v[172:175], a[28:31], a[48:51], v[172:175]
v_mfma_f32_16x16x32_bf16 v[176:179], a[32:35], a[48:51], v[176:179]
v_mfma_f32_16x16x32_bf16 v[180:183], a[36:39], a[48:51], v[180:183]
buffer_load_dwordx4 a[48:51], v8, s[56:59], s98 offen offset:2048 sc1
v_mfma_f32_16x16x32_bf16 v[184:187], a[16:19], a[52:55], v[184:187]
v_mfma_f32_16x16x32_bf16 v[188:191], a[20:23], a[52:55], v[188:191]
v_mfma_f32_16x16x32_bf16 v[192:195], a[24:27], a[52:55], v[192:195]
v_mfma_f32_16x16x32_bf16 v[196:199], a[28:31], a[52:55], v[196:199]
v_mfma_f32_16x16x32_bf16 v[200:203], a[32:35], a[52:55], v[200:203]
v_mfma_f32_16x16x32_bf16 v[204:207], a[36:39], a[52:55], v[204:207]
buffer_load_dwordx4 a[52:55], v9, s[56:59], s98 offen offset:0 sc1
v_mfma_f32_16x16x32_bf16 v[208:211], a[16:19], a[56:59], v[208:211]
v_mfma_f32_16x16x32_bf16 v[212:215], a[20:23], a[56:59], v[212:215]
v_mfma_f32_16x16x32_bf16 v[216:219], a[24:27], a[56:59], v[216:219]
v_mfma_f32_16x16x32_bf16 v[220:223], a[28:31], a[56:59], v[220:223]
v_mfma_f32_16x16x32_bf16 v[224:227], a[32:35], a[56:59], v[224:227]
v_mfma_f32_16x16x32_bf16 v[228:231], a[36:39], a[56:59], v[228:231]
buffer_load_dwordx4 a[56:59], v9, s[56:59], s98 offen offset:1024 sc1
v_mfma_f32_16x16x32_bf16 v[232:235], a[16:19], a[60:63], v[232:235]
buffer_load_dwordx4 a[16:19], v2, s[80:83], s99 offen offset:0 sc1
v_mfma_f32_16x16x32_bf16 v[236:239], a[20:23], a[60:63], v[236:239]
buffer_load_dwordx4 a[20:23], v2, s[80:83], s99 offen offset:1024 sc1
v_mfma_f32_16x16x32_bf16 v[240:243], a[24:27], a[60:63], v[240:243]
buffer_load_dwordx4 a[24:27], v2, s[80:83], s99 offen offset:2048 sc1
v_mfma_f32_16x16x32_bf16 v[244:247], a[28:31], a[60:63], v[244:247]
buffer_load_dwordx4 a[28:31], v3, s[80:83], s99 offen offset:0 sc1
v_mfma_f32_16x16x32_bf16 v[248:251], a[32:35], a[60:63], v[248:251]
buffer_load_dwordx4 a[32:35], v3, s[80:83], s99 offen offset:1024 sc1
v_mfma_f32_16x16x32_bf16 v[252:255], a[36:39], a[60:63], v[252:255]
buffer_load_dwordx4 a[60:63], v9, s[56:59], s98 offen offset:2048 sc1
buffer_load_dwordx4 a[36:39], v3, s[80:83], s99 offen offset:2048 sc1
s_add_u32 s98, s98, 614400
s_add_u32 s99, s99, 184320
s_waitcnt vmcnt(48) lgkmcnt(0)
s_branch L_vote
L_espin4:
s_mov_b32 s79, 1
s_mov_b32 s58, 0
s_mov_b32 s82, 0
s_branch L_eok4
L_fs1_4:
s_sleep 1
ds_read_b128 v[80:83], v101
s_waitcnt lgkmcnt(0)
v_min3_u32 v80, v80, v81, v82
v_min_u32 v80, v80, v83
v_cmp_gt_u32 vcc, s39, v80
s_cbranch_vccnz L_fs1_4
s_branch L_fr1_4
L_fs3_4:
s_sleep 1
ds_read_b128 v[80:83], v101
s_waitcnt lgkmcnt(0)
v_min3_u32 v80, v80, v81, v82
v_min_u32 v80, v80, v83
v_cmp_gt_u32 vcc, s39, v80
s_cbranch_vccnz L_fs3_4
s_branch L_fr3_4
L_fs5_4:
s_sleep 1
ds_read_b128 v[80:83], v101
s_waitcnt lgkmcnt(0)
v_min3_u32 v80, v80, v81, v82
v_min_u32 v80, v80, v83
v_cmp_gt_u32 vcc, s39, v80
s_cbranch_vccnz L_fs5_4
s_branch L_fr5_4
L_fs7_4:
s_sleep 1
ds_read_b128 v[80:83], v101
s_waitcnt lgkmcnt(0)
v_min3_u32 v80, v80, v81, v82
v_min_u32 v80, v80, v83
v_cmp_gt_u32 vcc, s39, v80
s_cbranch_vccnz L_fs7_4
s_branch L_fr7_4
L_fs9_4:
s_sleep 1
ds_read_b128 v[80:83], v101
s_waitcnt lgkmcnt(0)
v_min3_u32 v80, v80, v81, v82
v_min_u32 v80, v80, v83
v_cmp_gt_u32 vcc, s39, v80
s_cbranch_vccnz L_fs9_4
s_branch L_fr9_4
L_fs11_4:
s_sleep 1
ds_read_b128 v[80:83], v101
s_waitcnt lgkmcnt(0)
v_min3_u32 v80, v80, v81, v82
v_min_u32 v80, v80, v83
v_cmp_gt_u32 vcc, s39, v80
s_cbranch_vccnz L_fs11_4
s_branch L_fr11_4
L_fs13_4:
s_sleep 1
ds_read_b128 v[80:83], v101
s_waitcnt lgkmcnt(0)
v_min3_u32 v80, v80, v81, v82
v_min_u32 v80, v80, v83
v_cmp_gt_u32 vcc, s39, v80
s_cbranch_vccnz L_fs13_4
s_branch L_fr13_4
L_fs15_4:
s_sleep 1
ds_read_b128 v[80:83], v101
s_waitcnt lgkmcnt(0)
v_min3_u32 v80, v80, v81, v82
v_min_u32 v80, v80, v83
v_cmp_gt_u32 vcc, s39, v80
s_cbranch_vccnz L_fs15_4
s_branch L_fr15_4
L_fs33_4:
s_sleep 1
ds_read_b128 v[80:83], v101
s_waitcnt lgkmcnt(0)
v_min3_u32 v80, v80, v81, v82
v_min_u32 v80, v80, v83
v_cmp_gt_u32 vcc, s39, v80
s_cbranch_vccnz L_fs33_4
s_branch L_fr33_4
L_fs35_4:
s_sleep 1
ds_read_b128 v[80:83], v101
s_waitcnt lgkmcnt(0)
v_min3_u32 v80, v80, v81, v82
v_min_u32 v80, v80, v83
v_cmp_gt_u32 vcc, s39, v80
s_cbranch_vccnz L_fs35_4
s_branch L_fr35_4
L_fs37_4:
s_sleep 1
ds_read_b128 v[80:83], v101
s_waitcnt lgkmcnt(0)
v_min3_u32 v80, v80, v81, v82
v_min_u32 v80, v80, v83
v_cmp_gt_u32 vcc, s39, v80
s_cbranch_vccnz L_fs37_4
s_branch L_fr37_4
L_fs39_4:
s_sleep 1
ds_read_b128 v[80:83], v101
s_waitcnt lgkmcnt(0)
v_min3_u32 v80, v80, v81, v82
v_min_u32 v80, v80, v83
v_cmp_gt_u32 vcc, s39, v80
s_cbranch_vccnz L_fs39_4
s_branch L_fr39_4
L_fs57_4:
s_sleep 1
ds_read_b128 v[80:83], v101
s_waitcnt lgkmcnt(0)
v_min3_u32 v80, v80, v81, v82
v_min_u32 v80, v80, v83
v_cmp_gt_u32 vcc, s39, v80
s_cbranch_vccnz L_fs57_4
s_branch L_fr57_4
L_fs59_4:
s_sleep 1
ds_read_b128 v[80:83], v101
s_waitcnt lgkmcnt(0)
v_min3_u32 v80, v80, v81, v82
v_min_u32 v80, v80, v83
v_cmp_gt_u32 vcc, s39, v80
s_cbranch_vccnz L_fs59_4
s_branch L_fr59_4
L_fs61_4:
s_sleep 1
ds_read_b128 v[80:83], v101
s_waitcnt lgkmcnt(0)
v_min3_u32 v80, v80, v81, v82
v_min_u32 v80, v80, v83
v_cmp_gt_u32 vcc, s39, v80
s_cbranch_vccnz L_fs61_4
s_branch L_fr61_4
L_maxpass4:
v_mov_b32 v116, 0xff800000
v_mov_b32 v117, 0xff800000
v_mov_b32 v118, 0xff800000
v_mov_b32 v119, 0xff800000
v_add_u32 v120, 147456, v84
v_add_u32 v121, 147456, v85
v_add_u32 v122, 147456, v86
v_add_u32 v123, 147456, v87
s_lshl_b32 s46, s36, 18
s_mov_b32 s35, 0
L_mp4:
s_barrier
s_add_u32 m0, s69, 147456
s_nop 0
buffer_load_dwordx4 v96, s[12:15], s46 offen offset:0 lds
buffer_load_dwordx4 v97, s[12:15], s46 offen offset:1024 lds
s_waitcnt vmcnt(0)
s_barrier
ds_read_b128 a[64:67], v120 offset:0
ds_read_b128 a[68:71], v121 offset:0
ds_read_b128 a[72:75], v122 offset:0
ds_read_b128 a[76:79], v123 offset:0
ds_read_b128 a[80:83], v120 offset:4096
ds_read_b128 a[84:87], v121 offset:4096
ds_read_b128 a[88:91], v122 offset:4096
ds_read_b128 a[92:95], v123 offset:4096
s_waitcnt lgkmcnt(0)
v_mfma_f32_16x16x32_bf16 v[16:19], a[64:67], a[32:35], 0
v_mfma_f32_16x16x32_bf16 v[16:19], a[68:71], a[36:39], v[16:19]
v_mfma_f32_16x16x32_bf16 v[16:19], a[72:75], a[40:43], v[16:19]
v_mfma_f32_16x16x32_bf16 v[16:19], a[76:79], a[44:47], v[16:19]
v_mfma_f32_16x16x32_bf16 v[20:23], a[80:83], a[32:35], 0
v_mfma_f32_16x16x32_bf16 v[20:23], a[84:87], a[36:39], v[20:23]
v_mfma_f32_16x16x32_bf16 v[20:23], a[88:91], a[40:43], v[20:23]
v_mfma_f32_16x16x32_bf16 v[20:23], a[92:95], a[44:47], v[20:23]
v_mfma_f32_16x16x32_bf16 v[24:27], a[64:67], a[48:51], 0
v_mfma_f32_16x16x32_bf16 v[24:27], a[68:71], a[52:55], v[24:27]
v_mfma_f32_16x16x32_bf16 v[24:27], a[72:75], a[56:59], v[24:27]
v_mfma_f32_16x16x32_bf16 v[24:27], a[76:79], a[60:63], v[24:27]
v_mfma_f32_16x16x32_bf16 v[28:31], a[80:83], a[48:51], 0
v_mfma_f32_16x16x32_bf16 v[28:31], a[84:87], a[52:55], v[28:31]
v_mfma_f32_16x16x32_bf16 v[28:31], a[88:91], a[56:59], v[28:31]
v_mfma_f32_16x16x32_bf16 v[28:31], a[92:95], a[60:63], v[28:31]
v_mfma_f32_16x16x32_bf16 v[32:35], a[64:67], a[96:99], 0
v_mfma_f32_16x16x32_bf16 v[32:35], a[68:71], a[100:103], v[32:35]
v_mfma_f32_16x16x32_bf16 v[32:35], a[72:75], a[104:107], v[32:35]
v_mfma_f32_16x16x32_bf16 v[32:35], a[76:79], a[108:111], v[32:35]
v_mfma_f32_16x16x32_bf16 v[36:39], a[80:83], a[96:99], 0
v_mfma_f32_16x16x32_bf16 v[36:39], a[84:87], a[100:103], v[36:39]
v_mfma_f32_16x16x32_bf16 v[36:39], a[88:91], a[104:107], v[36:39]
v_mfma_f32_16x16x32_bf16 v[36:39], a[92:95], a[108:111], v[36:39]
v_mfma_f32_16x16x32_bf16 v[40:43], a[64:67], a[112:115], 0
v_mfma_f32_16x16x32_bf16 v[40:43], a[68:71], a[116:119], v[40:43]
v_mfma_f32_16x16x32_bf16 v[40:43], a[72:75], a[120:123], v[40:43]
v_mfma_f32_16x16x32_bf16 v[40:43], a[76:79], a[124:127], v[40:43]
v_mfma_f32_16x16x32_bf16 v[44:47], a[80:83], a[112:115], 0
v_mfma_f32_16x16x32_bf16 v[44:47], a[84:87], a[116:119], v[44:47]
v_mfma_f32_16x16x32_bf16 v[44:47], a[88:91], a[120:123], v[44:47]
v_mfma_f32_16x16x32_bf16 v[44:47], a[92:95], a[124:127], v[44:47]
v_max3_f32 v116, v116, v16, v17
v_max3_f32 v116, v116, v18, v19
v_max3_f32 v116, v116, v20, v21
v_max3_f32 v116, v116, v22, v23
v_max3_f32 v117, v117, v24, v25
v_max3_f32 v117, v117, v26, v27
v_max3_f32 v117, v117, v28, v29
v_max3_f32 v117, v117, v30, v31
v_max3_f32 v118, v118, v32, v33
v_max3_f32 v118, v118, v34, v35
v_max3_f32 v118, v118, v36, v37
v_max3_f32 v118, v118, v38, v39
v_max3_f32 v119, v119, v40, v41
v_max3_f32 v119, v119, v42, v43
v_max3_f32 v119, v119, v44, v45
v_max3_f32 v119, v119, v46, v47
s_add_u32 s46, s46, 8192
s_add_u32 s35, s35, 1
s_cmp_lt_u32 s35, 32
s_cbranch_scc1 L_mp4
s_barrier
v_mov_b32 v108, v116
v_mov_b32 v109, v117
v_mov_b32 v110, v118
v_mov_b32 v111, v119
v_permlane32_swap_b32 v116, v108
v_permlane32_swap_b32 v117, v109
v_permlane32_swap_b32 v118, v110
v_permlane32_swap_b32 v119, v111
v_max_f32 v116, v116, v108
v_max_f32 v117, v117, v109
v_max_f32 v118, v118, v110
v_max_f32 v119, v119, v111
v_mov_b32 v108, v116
v_mov_b32 v109, v117
v_mov_b32 v110, v118
v_mov_b32 v111, v119
v_permlane16_swap_b32 v116, v108
v_permlane16_swap_b32 v117, v109
v_permlane16_swap_b32 v118, v110
v_permlane16_swap_b32 v119, v111
v_max_f32 v116, v116, v108
v_max_f32 v117, v117, v109
v_max_f32 v118, v118, v110
v_max_f32 v119, v119, v111
v_sub_f32 v64, 0, v116
v_sub_f32 v65, 0, v116
v_sub_f32 v66, 0, v116
v_sub_f32 v67, 0, v116
v_sub_f32 v68, 0, v117
v_sub_f32 v69, 0, v117
v_sub_f32 v70, 0, v117
v_sub_f32 v71, 0, v117
v_sub_f32 v72, 0, v118
v_sub_f32 v73, 0, v118
v_sub_f32 v74, 0, v118
v_sub_f32 v75, 0, v118
v_sub_f32 v76, 0, v119
v_sub_f32 v77, 0, v119
v_sub_f32 v78, 0, v119
v_sub_f32 v79, 0, v119
s_cmp_eq_u32 s36, 0
s_cbranch_scc1 L_maxdone04
s_branch L_maxdone14
L_tramp:
s_branch L_late
.p2align 6
L_begin3:
v_mov_b32 v106, 0
v_lshlrev_b32 v107, 3, v103
buffer_store_dword v106, v107, s[84:87], 0 offen sc1
s_mov_b32 s46, 8192
buffer_store_dword v106, v107, s[84:87], s46 offen sc1
s_mov_b32 s46, 16384
buffer_store_dword v106, v107, s[84:87], s46 offen sc1
s_waitcnt vmcnt(15)
s_barrier
ds_read_b128 a[0:3], v18 offset:0
ds_read_b128 a[4:7], v19 offset:0
ds_read_b128 a[8:11], v18 offset:2048
ds_read_b128 a[12:15], v19 offset:2048
ds_read_b128 a[16:19], v18 offset:4096
ds_read_b128 a[20:23], v19 offset:4096
ds_read_b64_tr_b16 a[64:65], v28 offset:0
ds_read_b64_tr_b16 a[66:67], v28 offset:512
ds_read_b64_tr_b16 a[68:69], v28 offset:4096
ds_read_b64_tr_b16 a[70:71], v28 offset:4608
ds_read_b64_tr_b16 a[72:73], v28 offset:8
ds_read_b64_tr_b16 a[74:75], v28 offset:520
ds_read_b64_tr_b16 a[76:77], v28 offset:4104
ds_read_b64_tr_b16 a[78:79], v28 offset:4616
ds_read_b64_tr_b16 a[80:81], v29 offset:0
ds_read_b64_tr_b16 a[82:83], v29 offset:512
ds_read_b64_tr_b16 a[84:85], v29 offset:4096
s_waitcnt lgkmcnt(7)
v_mfma_f32_16x16x32_bf16 v[128:131], a[64:67], a[0:3], 0
ds_read_b64_tr_b16 a[86:87], v29 offset:4608
s_add_u32 m0, s33, 131072
v_mfma_f32_16x16x32_bf16 v[128:131], a[68:71], a[4:7], v[128:131]
buffer_load_dwordx4 v24, s[8:11], s41 offen offset:0 lds
v_mfma_f32_16x16x32_bf16 v[160:163], a[64:67], a[8:11], 0
v_mfma_f32_16x16x32_bf16 v[160:163], a[68:71], a[12:15], v[160:163]
buffer_load_dwordx4 v25, s[8:11], s41 offen offset:1024 lds
v_mfma_f32_16x16x32_bf16 v[192:195], a[64:67], a[16:19], 0
v_mfma_f32_16x16x32_bf16 v[192:195], a[68:71], a[20:23], v[192:195]
ds_read_b64_tr_b16 a[88:89], v29 offset:8
buffer_load_dwordx4 v26, s[8:11], s41 offen offset:2048 lds
ds_read_b64_tr_b16 a[90:91], v29 offset:520
ds_read_b64_tr_b16 a[92:93], v29 offset:4104
s_waitcnt lgkmcnt(7)
buffer_load_dwordx4 v27, s[8:11], s41 offen offset:3072 lds
v_mfma_f32_16x16x32_bf16 v[132:135], a[72:75], a[0:3], 0
ds_read_b64_tr_b16 a[94:95], v29 offset:4616
s_add_u32 s41, s41, 256
s_add_u32 m0, s33, 147456
v_mfma_f32_16x16x32_bf16 v[132:135], a[76:79], a[4:7], v[132:135]
buffer_load_dwordx4 v24, s[8:11], s41 offen offset:0 lds
v_mfma_f32_16x16x32_bf16 v[164:167], a[72:75], a[8:11], 0
v_mfma_f32_16x16x32_bf16 v[164:167], a[76:79], a[12:15], v[164:167]
buffer_load_dwordx4 v25, s[8:11], s41 offen offset:1024 lds
v_mfma_f32_16x16x32_bf16 v[196:199], a[72:75], a[16:19], 0
ds_read_b64_tr_b16 a[64:65], v28 offset:8192
v_mfma_f32_16x16x32_bf16 v[196:199], a[76:79], a[20:23], v[196:199]
ds_read_b64_tr_b16 a[66:67], v28 offset:8704
buffer_load_dwordx4 v26, s[8:11], s41 offen offset:2048 lds
ds_read_b64_tr_b16 a[68:69], v28 offset:12288
ds_read_b64_tr_b16 a[70:71], v28 offset:12800
s_waitcnt lgkmcnt(8)
buffer_load_dwordx4 v27, s[8:11], s41 offen offset:3072 lds
v_mfma_f32_16x16x32_bf16 v[136:139], a[80:83], a[0:3], 0
s_add_u32 s41, s41, 524032
s_add_u32 m0, s42, 81920
v_mfma_f32_16x16x32_bf16 v[136:139], a[84:87], a[4:7], v[136:139]
buffer_load_dwordx4 v20, s[4:7], s39 offen offset:0 lds
v_mfma_f32_16x16x32_bf16 v[168:171], a[80:83], a[8:11], 0
v_mfma_f32_16x16x32_bf16 v[168:171], a[84:87], a[12:15], v[168:171]
ds_read_b64_tr_b16 a[72:73], v28 offset:8200
buffer_load_dwordx4 v21, s[4:7], s39 offen offset:1024 lds
v_mfma_f32_16x16x32_bf16 v[200:203], a[80:83], a[16:19], 0
ds_read_b64_tr_b16 a[74:75], v28 offset:8712
v_mfma_f32_16x16x32_bf16 v[200:203], a[84:87], a[20:23], v[200:203]
ds_read_b64_tr_b16 a[76:77], v28 offset:12296
buffer_load_dwordx4 v22, s[4:7], s39 offen offset:2048 lds
ds_read_b64_tr_b16 a[78:79], v28 offset:12808
s_waitcnt lgkmcnt(8)
buffer_load_dwordx4 v23, s[4:7], s39 offen offset:3072 lds
v_mfma_f32_16x16x32_bf16 v[140:143], a[88:91], a[0:3], 0
s_add_u32 m0, s42, 86016
v_mfma_f32_16x16x32_bf16 v[140:143], a[92:95], a[4:7], v[140:143]
buffer_load_dwordx4 v20, s[4:7], s40 offen offset:0 lds
v_mfma_f32_16x16x32_bf16 v[172:175], a[88:91], a[8:11], 0
ds_read_b64_tr_b16 a[80:81], v29 offset:8192
v_mfma_f32_16x16x32_bf16 v[172:175], a[92:95], a[12:15], v[172:175]
ds_read_b64_tr_b16 a[82:83], v29 offset:8704
buffer_load_dwordx4 v21, s[4:7], s40 offen offset:1024 lds
v_mfma_f32_16x16x32_bf16 v[204:207], a[88:91], a[16:19], 0
ds_read_b64_tr_b16 a[84:85], v29 offset:12288
s_add_u32 s39, s39, 128
s_add_u32 s40, s40, 128
v_mfma_f32_16x16x32_bf16 v[204:207], a[92:95], a[20:23], v[204:207]
ds_read_b64_tr_b16 a[86:87], v29 offset:12800
s_waitcnt lgkmcnt(8)
v_mfma_f32_16x16x32_bf16 v[144:147], a[64:67], a[0:3], 0
v_mfma_f32_16x16x32_bf16 v[144:147], a[68:71], a[4:7], v[144:147]
ds_read_b64_tr_b16 a[88:89], v29 offset:8200
v_mfma_f32_16x16x32_bf16 v[176:179], a[64:67], a[8:11], 0
ds_read_b64_tr_b16 a[90:91], v29 offset:8712
v_mfma_f32_16x16x32_bf16 v[176:179], a[68:71], a[12:15], v[176:179]
ds_read_b64_tr_b16 a[92:93], v29 offset:12296
v_mfma_f32_16x16x32_bf16 v[208:211], a[64:67], a[16:19], 0
ds_read_b64_tr_b16 a[94:95], v29 offset:12808
v_mfma_f32_16x16x32_bf16 v[208:211], a[68:71], a[20:23], v[208:211]
s_waitcnt lgkmcnt(8)
v_mfma_f32_16x16x32_bf16 v[148:151], a[72:75], a[0:3], 0
v_mfma_f32_16x16x32_bf16 v[148:151], a[76:79], a[4:7], v[148:151]
v_mfma_f32_16x16x32_bf16 v[180:183], a[72:75], a[8:11], 0
v_mfma_f32_16x16x32_bf16 v[180:183], a[76:79], a[12:15], v[180:183]
s_waitcnt vmcnt(17) lgkmcnt(0)
v_mfma_f32_16x16x32_bf16 v[212:215], a[72:75], a[16:19], 0
s_barrier
v_mfma_f32_16x16x32_bf16 v[212:215], a[76:79], a[20:23], v[212:215]
ds_read_b64_tr_b16 a[64:65], v30 offset:0
s_add_u32 m0, s33, 49152
ds_read_b64_tr_b16 a[66:67], v30 offset:512
buffer_load_dwordx4 v24, s[8:11], s41 offen offset:0 lds
ds_read_b64_tr_b16 a[68:69], v30 offset:4096
v_mfma_f32_16x16x32_bf16 v[152:155], a[80:83], a[0:3], 0
ds_read_b64_tr_b16 a[70:71], v30 offset:4608
v_mfma_f32_16x16x32_bf16 v[152:155], a[84:87], a[4:7], v[152:155]
v_mfma_f32_16x16x32_bf16 v[184:187], a[80:83], a[8:11], 0
v_mfma_f32_16x16x32_bf16 v[184:187], a[84:87], a[12:15], v[184:187]
buffer_load_dwordx4 v25, s[8:11], s41 offen offset:1024 lds
v_mfma_f32_16x16x32_bf16 v[216:219], a[80:83], a[16:19], 0
v_mfma_f32_16x16x32_bf16 v[216:219], a[84:87], a[20:23], v[216:219]
ds_read_b64_tr_b16 a[72:73], v30 offset:8
ds_read_b64_tr_b16 a[74:75], v30 offset:520
ds_read_b64_tr_b16 a[76:77], v30 offset:4104
v_mfma_f32_16x16x32_bf16 v[156:159], a[88:91], a[0:3], 0
ds_read_b64_tr_b16 a[78:79], v30 offset:4616
buffer_load_dwordx4 v26, s[8:11], s41 offen offset:2048 lds
v_mfma_f32_16x16x32_bf16 v[156:159], a[92:95], a[4:7], v[156:159]
v_mfma_f32_16x16x32_bf16 v[188:191], a[88:91], a[8:11], 0
v_mfma_f32_16x16x32_bf16 v[188:191], a[92:95], a[12:15], v[188:191]
v_mfma_f32_16x16x32_bf16 v[220:223], a[88:91], a[16:19], 0
v_mfma_f32_16x16x32_bf16 v[220:223], a[92:95], a[20:23], v[220:223]
ds_read_b64_tr_b16 a[80:81], v31 offset:0
buffer_load_dwordx4 v27, s[8:11], s41 offen offset:3072 lds
ds_read_b64_tr_b16 a[82:83], v31 offset:512
s_add_u32 s41, s41, 256
ds_read_b64_tr_b16 a[84:85], v31 offset:4096
s_waitcnt lgkmcnt(7)
v_mfma_f32_16x16x32_bf16 a[128:131], a[64:67], a[0:3], 0
ds_read_b64_tr_b16 a[86:87], v31 offset:4608
v_mfma_f32_16x16x32_bf16 a[128:131], a[68:71], a[4:7], a[128:131]
v_mfma_f32_16x16x32_bf16 a[160:163], a[64:67], a[8:11], 0
v_mfma_f32_16x16x32_bf16 a[160:163], a[68:71], a[12:15], a[160:163]
v_mfma_f32_16x16x32_bf16 a[192:195], a[64:67], a[16:19], 0
v_mfma_f32_16x16x32_bf16 a[192:195], a[68:71], a[20:23], a[192:195]
ds_read_b64_tr_b16 a[88:89], v31 offset:8
ds_read_b64_tr_b16 a[90:91], v31 offset:520
ds_read_b64_tr_b16 a[92:93], v31 offset:4104
s_waitcnt lgkmcnt(7)
v_mfma_f32_16x16x32_bf16 a[132:135], a[72:75], a[0:3], 0
ds_read_b64_tr_b16 a[94:95], v31 offset:4616
v_mfma_f32_16x16x32_bf16 a[132:135], a[76:79], a[4:7], a[132:135]
ds_read_b128 a[32:35], v16 offset:0
v_mfma_f32_16x16x32_bf16 a[164:167], a[72:75], a[8:11], 0
ds_read_b128 a[36:39], v17 offset:0
v_mfma_f32_16x16x32_bf16 a[164:167], a[76:79], a[12:15], a[164:167]
s_add_u32 m0, s64, 0
s_mov_b32 s46, 0
v_mfma_f32_16x16x32_bf16 a[196:199], a[72:75], a[16:19], 0
ds_read_b64_tr_b16 a[64:65], v30 offset:8192
buffer_load_dwordx4 v101, s[24:27], s46 offen offset:0 lds
v_mfma_f32_16x16x32_bf16 a[196:199], a[76:79], a[20:23], a[196:199]
ds_read_b64_tr_b16 a[66:67], v30 offset:8704
ds_read_b64_tr_b16 a[68:69], v30 offset:12288
ds_read_b64_tr_b16 a[70:71], v30 offset:12800
s_waitcnt lgkmcnt(10)
v_mfma_f32_16x16x32_bf16 a[136:139], a[80:83], a[0:3], 0
ds_read_b128 a[40:43], v16 offset:2048
v_mfma_f32_16x16x32_bf16 a[136:139], a[84:87], a[4:7], a[136:139]
ds_read_b128 a[44:47], v17 offset:2048
v_mfma_f32_16x16x32_bf16 a[168:171], a[80:83], a[8:11], 0
v_mfma_f32_16x16x32_bf16 a[168:171], a[84:87], a[12:15], a[168:171]
ds_read_b64_tr_b16 a[72:73], v30 offset:8200
v_mfma_f32_16x16x32_bf16 a[200:203], a[80:83], a[16:19], 0
ds_read_b64_tr_b16 a[74:75], v30 offset:8712
v_mfma_f32_16x16x32_bf16 a[200:203], a[84:87], a[20:23], a[200:203]
ds_read_b64_tr_b16 a[76:77], v30 offset:12296
ds_read_b64_tr_b16 a[78:79], v30 offset:12808
ds_read_b128 a[48:51], v16 offset:4096
s_waitcnt lgkmcnt(13)
v_mfma_f32_16x16x32_bf16 a[140:143], a[88:91], a[0:3], 0
ds_read_b128 a[52:55], v17 offset:4096
v_mfma_f32_16x16x32_bf16 a[140:143], a[92:95], a[4:7], a[140:143]
v_mfma_f32_16x16x32_bf16 a[172:175], a[88:91], a[8:11], 0
ds_read_b64_tr_b16 a[80:81], v31 offset:8192
v_mfma_f32_16x16x32_bf16 a[172:175], a[92:95], a[12:15], a[172:175]
ds_read_b64_tr_b16 a[82:83], v31 offset:8704
v_mfma_f32_16x16x32_bf16 a[204:207], a[88:91], a[16:19], 0
ds_read_b64_tr_b16 a[84:85], v31 offset:12288
v_mfma_f32_16x16x32_bf16 a[204:207], a[92:95], a[20:23], a[204:207]
ds_read_b64_tr_b16 a[86:87], v31 offset:12800
s_waitcnt lgkmcnt(12)
s_add_u32 m0, s64, 0
s_mov_b32 s46, 8192
v_mfma_f32_16x16x32_bf16 a[144:147], a[64:67], a[0:3], 0
buffer_load_dwordx4 v101, s[24:27], s46 offen offset:1024 lds
v_mfma_f32_16x16x32_bf16 a[144:147], a[68:71], a[4:7], a[144:147]
ds_read_b64_tr_b16 a[88:89], v31 offset:8200
v_mfma_f32_16x16x32_bf16 a[176:179], a[64:67], a[8:11], 0
ds_read_b64_tr_b16 a[90:91], v31 offset:8712
v_mfma_f32_16x16x32_bf16 a[176:179], a[68:71], a[12:15], a[176:179]
ds_read_b64_tr_b16 a[92:93], v31 offset:12296
v_mfma_f32_16x16x32_bf16 a[208:211], a[64:67], a[16:19], 0
ds_read_b64_tr_b16 a[94:95], v31 offset:12808
v_mfma_f32_16x16x32_bf16 a[208:211], a[68:71], a[20:23], a[208:211]
s_waitcnt lgkmcnt(10)
v_mfma_f32_16x16x32_bf16 a[148:151], a[72:75], a[0:3], 0
v_mfma_f32_16x16x32_bf16 a[148:151], a[76:79], a[4:7], a[148:151]
v_mfma_f32_16x16x32_bf16 a[180:183], a[72:75], a[8:11], 0
v_mfma_f32_16x16x32_bf16 a[180:183], a[76:79], a[12:15], a[180:183]
s_waitcnt vmcnt(16) lgkmcnt(0)
v_mfma_f32_16x16x32_bf16 a[212:215], a[72:75], a[16:19], 0
s_barrier
v_mfma_f32_16x16x32_bf16 a[212:215], a[76:79], a[20:23], a[212:215]
ds_read_b64_tr_b16 a[64:65], v30 offset:16384
s_add_u32 m0, s33, 114688
ds_read_b64_tr_b16 a[66:67], v30 offset:16896
buffer_load_dwordx4 v24, s[8:11], s41 offen offset:0 lds
ds_read_b64_tr_b16 a[68:69], v30 offset:20480
v_mfma_f32_16x16x32_bf16 a[152:155], a[80:83], a[0:3], 0
ds_read_b64_tr_b16 a[70:71], v30 offset:20992
v_mfma_f32_16x16x32_bf16 a[152:155], a[84:87], a[4:7], a[152:155]
v_mfma_f32_16x16x32_bf16 a[184:187], a[80:83], a[8:11], 0
v_mfma_f32_16x16x32_bf16 a[184:187], a[84:87], a[12:15], a[184:187]
buffer_load_dwordx4 v25, s[8:11], s41 offen offset:1024 lds
v_mfma_f32_16x16x32_bf16 a[216:219], a[80:83], a[16:19], 0
v_mfma_f32_16x16x32_bf16 a[216:219], a[84:87], a[20:23], a[216:219]
ds_read_b64_tr_b16 a[72:73], v30 offset:16392
ds_read_b64_tr_b16 a[74:75], v30 offset:16904
ds_read_b64_tr_b16 a[76:77], v30 offset:20488
v_mfma_f32_16x16x32_bf16 a[156:159], a[88:91], a[0:3], 0
ds_read_b64_tr_b16 a[78:79], v30 offset:21000
buffer_load_dwordx4 v26, s[8:11], s41 offen offset:2048 lds
v_mfma_f32_16x16x32_bf16 a[156:159], a[92:95], a[4:7], a[156:159]
v_mfma_f32_16x16x32_bf16 a[188:191], a[88:91], a[8:11], 0
v_mfma_f32_16x16x32_bf16 a[188:191], a[92:95], a[12:15], a[188:191]
v_mfma_f32_16x16x32_bf16 a[220:223], a[88:91], a[16:19], 0
v_mfma_f32_16x16x32_bf16 a[220:223], a[92:95], a[20:23], a[220:223]
ds_read_b64_tr_b16 a[80:81], v31 offset:16384
buffer_load_dwordx4 v27, s[8:11], s41 offen offset:3072 lds
ds_read_b64_tr_b16 a[82:83], v31 offset:16896
s_add_u32 s41, s41, 524032
ds_read_b64_tr_b16 a[84:85], v31 offset:20480
s_waitcnt lgkmcnt(7)
v_mfma_f32_16x16x32_bf16 v[128:131], a[64:67], a[32:35], v[128:131]
ds_read_b64_tr_b16 a[86:87], v31 offset:20992
v_mfma_f32_16x16x32_bf16 v[128:131], a[68:71], a[36:39], v[128:131]
s_add_u32 m0, s42, 16384
v_mfma_f32_16x16x32_bf16 v[160:163], a[64:67], a[40:43], v[160:163]
buffer_load_dwordx4 v20, s[4:7], s39 offen offset:0 lds
v_mfma_f32_16x16x32_bf16 v[160:163], a[68:71], a[44:47], v[160:163]
v_mfma_f32_16x16x32_bf16 v[192:195], a[64:67], a[48:51], v[192:195]
v_mfma_f32_16x16x32_bf16 v[192:195], a[68:71], a[52:55], v[192:195]
ds_read_b64_tr_b16 a[88:89], v31 offset:16392
ds_read_b64_tr_b16 a[90:91], v31 offset:16904
ds_read_b64_tr_b16 a[92:93], v31 offset:20488
s_waitcnt lgkmcnt(7)
buffer_load_dwordx4 v21, s[4:7], s39 offen offset:1024 lds
v_mfma_f32_16x16x32_bf16 v[132:135], a[72:75], a[32:35], v[132:135]
ds_read_b64_tr_b16 a[94:95], v31 offset:21000
v_mfma_f32_16x16x32_bf16 v[132:135], a[76:79], a[36:39], v[132:135]
v_mfma_f32_16x16x32_bf16 v[164:167], a[72:75], a[40:43], v[164:167]
v_mfma_f32_16x16x32_bf16 v[164:167], a[76:79], a[44:47], v[164:167]
v_mfma_f32_16x16x32_bf16 v[196:199], a[72:75], a[48:51], v[196:199]
ds_read_b64_tr_b16 a[64:65], v30 offset:24576
buffer_load_dwordx4 v22, s[4:7], s39 offen offset:2048 lds
v_mfma_f32_16x16x32_bf16 v[196:199], a[76:79], a[52:55], v[196:199]
ds_read_b64_tr_b16 a[66:67], v30 offset:25088
ds_read_b64_tr_b16 a[68:69], v30 offset:28672
ds_read_b64_tr_b16 a[70:71], v30 offset:29184
s_waitcnt lgkmcnt(8)
v_mfma_f32_16x16x32_bf16 v[136:139], a[80:83], a[32:35], v[136:139]
v_mfma_f32_16x16x32_bf16 v[136:139], a[84:87], a[36:39], v[136:139]
buffer_load_dwordx4 v23, s[4:7], s39 offen offset:3072 lds
v_mfma_f32_16x16x32_bf16 v[168:171], a[80:83], a[40:43], v[168:171]
v_mfma_f32_16x16x32_bf16 v[168:171], a[84:87], a[44:47], v[168:171]
ds_read_b64_tr_b16 a[72:73], v30 offset:24584
v_mfma_f32_16x16x32_bf16 v[200:203], a[80:83], a[48:51], v[200:203]
ds_read_b64_tr_b16 a[74:75], v30 offset:25096
v_mfma_f32_16x16x32_bf16 v[200:203], a[84:87], a[52:55], v[200:203]
ds_read_b64_tr_b16 a[76:77], v30 offset:28680
s_add_u32 m0, s42, 20480
ds_read_b64_tr_b16 a[78:79], v30 offset:29192
buffer_load_dwordx4 v20, s[4:7], s40 offen offset:0 lds
s_waitcnt lgkmcnt(8)
v_mfma_f32_16x16x32_bf16 v[140:143], a[88:91], a[32:35], v[140:143]
v_mfma_f32_16x16x32_bf16 v[140:143], a[92:95], a[36:39], v[140:143]
v_mfma_f32_16x16x32_bf16 v[172:175], a[88:91], a[40:43], v[172:175]
ds_read_b64_tr_b16 a[80:81], v31 offset:24576
v_mfma_f32_16x16x32_bf16 v[172:175], a[92:95], a[44:47], v[172:175]
ds_read_b64_tr_b16 a[82:83], v31 offset:25088
buffer_load_dwordx4 v21, s[4:7], s40 offen offset:1024 lds
v_mfma_f32_16x16x32_bf16 v[204:207], a[88:91], a[48:51], v[204:207]
ds_read_b64_tr_b16 a[84:85], v31 offset:28672
s_add_u32 s39, s39, 128
s_add_u32 s40, s40, 128
v_mfma_f32_16x16x32_bf16 v[204:207], a[92:95], a[52:55], v[204:207]
ds_read_b64_tr_b16 a[86:87], v31 offset:29184
s_waitcnt lgkmcnt(8)
v_mfma_f32_16x16x32_bf16 v[144:147], a[64:67], a[32:35], v[144:147]
v_mfma_f32_16x16x32_bf16 v[144:147], a[68:71], a[36:39], v[144:147]
ds_read_b64_tr_b16 a[88:89], v31 offset:24584
v_mfma_f32_16x16x32_bf16 v[176:179], a[64:67], a[40:43], v[176:179]
ds_read_b64_tr_b16 a[90:91], v31 offset:25096
v_mfma_f32_16x16x32_bf16 v[176:179], a[68:71], a[44:47], v[176:179]
ds_read_b64_tr_b16 a[92:93], v31 offset:28680
v_mfma_f32_16x16x32_bf16 v[208:211], a[64:67], a[48:51], v[208:211]
ds_read_b64_tr_b16 a[94:95], v31 offset:29192
v_mfma_f32_16x16x32_bf16 v[208:211], a[68:71], a[52:55], v[208:211]
s_add_u32 m0, s64, 0
s_mov_b32 s46, 16384
s_waitcnt lgkmcnt(8)
buffer_load_dwordx4 v101, s[24:27], s46 offen offset:2048 lds
v_mfma_f32_16x16x32_bf16 v[148:151], a[72:75], a[32:35], v[148:151]
v_mfma_f32_16x16x32_bf16 v[148:151], a[76:79], a[36:39], v[148:151]
s_add_u32 m0, s64, 0
s_mov_b32 s46, 24576
v_mfma_f32_16x16x32_bf16 v[180:183], a[72:75], a[40:43], v[180:183]
buffer_load_dwordx4 v101, s[24:27], s46 offen offset:3072 lds
v_mfma_f32_16x16x32_bf16 v[180:183], a[76:79], a[44:47], v[180:183]
s_waitcnt vmcnt(18) lgkmcnt(0)
v_mfma_f32_16x16x32_bf16 v[212:215], a[72:75], a[48:51], v[212:215]
s_barrier
v_mfma_f32_16x16x32_bf16 v[212:215], a[76:79], a[52:55], v[212:215]
ds_read_b64_tr_b16 a[64:65], v30 offset:32768
s_add_u32 m0, s33, 131072
ds_read_b64_tr_b16 a[66:67], v30 offset:33280
buffer_load_dwordx4 v24, s[8:11], s41 offen offset:0 lds
ds_read_b64_tr_b16 a[68:69], v30 offset:36864
v_mfma_f32_16x16x32_bf16 v[152:155], a[80:83], a[32:35], v[152:155]
ds_read_b64_tr_b16 a[70:71], v30 offset:37376
v_mfma_f32_16x16x32_bf16 v[152:155], a[84:87], a[36:39], v[152:155]
v_mfma_f32_16x16x32_bf16 v[184:187], a[80:83], a[40:43], v[184:187]
v_mfma_f32_16x16x32_bf16 v[184:187], a[84:87], a[44:47], v[184:187]
buffer_load_dwordx4 v25, s[8:11], s41 offen offset:1024 lds
v_mfma_f32_16x16x32_bf16 v[216:219], a[80:83], a[48:51], v[216:219]
v_mfma_f32_16x16x32_bf16 v[216:219], a[84:87], a[52:55], v[216:219]
ds_read_b64_tr_b16 a[72:73], v30 offset:32776
ds_read_b64_tr_b16 a[74:75], v30 offset:33288
ds_read_b64_tr_b16 a[76:77], v30 offset:36872
buffer_store_dword v104, v103, s[88:91], 0 offen sc1
v_mfma_f32_16x16x32_bf16 v[156:159], a[88:91], a[32:35], v[156:159]
ds_read_b64_tr_b16 a[78:79], v30 offset:37384
buffer_load_dwordx4 v26, s[8:11], s41 offen offset:2048 lds
v_mfma_f32_16x16x32_bf16 v[156:159], a[92:95], a[36:39], v[156:159]
v_mfma_f32_16x16x32_bf16 v[188:191], a[88:91], a[40:43], v[188:191]
v_mfma_f32_16x16x32_bf16 v[188:191], a[92:95], a[44:47], v[188:191]
v_mfma_f32_16x16x32_bf16 v[220:223], a[88:91], a[48:51], v[220:223]
v_mfma_f32_16x16x32_bf16 v[220:223], a[92:95], a[52:55], v[220:223]
ds_read_b64_tr_b16 a[80:81], v31 offset:32768
buffer_load_dwordx4 v27, s[8:11], s41 offen offset:3072 lds
ds_read_b64_tr_b16 a[82:83], v31 offset:33280
s_add_u32 s41, s41, 256
ds_read_b64_tr_b16 a[84:85], v31 offset:36864
s_waitcnt lgkmcnt(7)
v_mfma_f32_16x16x32_bf16 a[128:131], a[64:67], a[32:35], a[128:131]
ds_read_b64_tr_b16 a[86:87], v31 offset:37376
v_mfma_f32_16x16x32_bf16 a[128:131], a[68:71], a[36:39], a[128:131]
v_mfma_f32_16x16x32_bf16 a[160:163], a[64:67], a[40:43], a[160:163]
v_mfma_f32_16x16x32_bf16 a[160:163], a[68:71], a[44:47], a[160:163]
v_mfma_f32_16x16x32_bf16 a[192:195], a[64:67], a[48:51], a[192:195]
v_mfma_f32_16x16x32_bf16 a[192:195], a[68:71], a[52:55], a[192:195]
ds_read_b64_tr_b16 a[88:89], v31 offset:32776
ds_read_b64_tr_b16 a[90:91], v31 offset:33288
ds_read_b64_tr_b16 a[92:93], v31 offset:36872
s_waitcnt lgkmcnt(7)
v_mfma_f32_16x16x32_bf16 a[132:135], a[72:75], a[32:35], a[132:135]
ds_read_b64_tr_b16 a[94:95], v31 offset:37384
v_mfma_f32_16x16x32_bf16 a[132:135], a[76:79], a[36:39], a[132:135]
ds_read_b128 a[0:3], v18 offset:0
v_mfma_f32_16x16x32_bf16 a[164:167], a[72:75], a[40:43], a[164:167]
ds_read_b128 a[4:7], v19 offset:0
v_mfma_f32_16x16x32_bf16 a[164:167], a[76:79], a[44:47], a[164:167]
s_add_u32 m0, s64, 4096
s_mov_b32 s46, 512
v_mfma_f32_16x16x32_bf16 a[196:199], a[72:75], a[48:51], a[196:199]
ds_read_b64_tr_b16 a[64:65], v30 offset:40960
buffer_load_dwordx4 v101, s[24:27], s46 offen offset:0 lds
v_mfma_f32_16x16x32_bf16 a[196:199], a[76:79], a[52:55], a[196:199]
ds_read_b64_tr_b16 a[66:67], v30 offset:41472
ds_read_b64_tr_b16 a[68:69], v30 offset:45056
ds_read_b64_tr_b16 a[70:71], v30 offset:45568
s_waitcnt lgkmcnt(10)
v_mfma_f32_16x16x32_bf16 a[136:139], a[80:83], a[32:35], a[136:139]
ds_read_b128 a[8:11], v18 offset:2048
v_mfma_f32_16x16x32_bf16 a[136:139], a[84:87], a[36:39], a[136:139]
ds_read_b128 a[12:15], v19 offset:2048
v_mfma_f32_16x16x32_bf16 a[168:171], a[80:83], a[40:43], a[168:171]
v_mfma_f32_16x16x32_bf16 a[168:171], a[84:87], a[44:47], a[168:171]
ds_read_b64_tr_b16 a[72:73], v30 offset:40968
v_mfma_f32_16x16x32_bf16 a[200:203], a[80:83], a[48:51], a[200:203]
ds_read_b64_tr_b16 a[74:75], v30 offset:41480
v_mfma_f32_16x16x32_bf16 a[200:203], a[84:87], a[52:55], a[200:203]
ds_read_b64_tr_b16 a[76:77], v30 offset:45064
ds_read_b64_tr_b16 a[78:79], v30 offset:45576
ds_read_b128 a[16:19], v18 offset:4096
s_waitcnt lgkmcnt(13)
v_mfma_f32_16x16x32_bf16 a[140:143], a[88:91], a[32:35], a[140:143]
ds_read_b128 a[20:23], v19 offset:4096
v_mfma_f32_16x16x32_bf16 a[140:143], a[92:95], a[36:39], a[140:143]
v_mfma_f32_16x16x32_bf16 a[172:175], a[88:91], a[40:43], a[172:175]
ds_read_b64_tr_b16 a[80:81], v31 offset:40960
v_mfma_f32_16x16x32_bf16 a[172:175], a[92:95], a[44:47], a[172:175]
ds_read_b64_tr_b16 a[82:83], v31 offset:41472
v_mfma_f32_16x16x32_bf16 a[204:207], a[88:91], a[48:51], a[204:207]
ds_read_b64_tr_b16 a[84:85], v31 offset:45056
v_mfma_f32_16x16x32_bf16 a[204:207], a[92:95], a[52:55], a[204:207]
ds_read_b64_tr_b16 a[86:87], v31 offset:45568
s_waitcnt lgkmcnt(12)
s_add_u32 m0, s64, 4096
s_mov_b32 s46, 8704
v_mfma_f32_16x16x32_bf16 a[144:147], a[64:67], a[32:35], a[144:147]
buffer_load_dwordx4 v101, s[24:27], s46 offen offset:1024 lds
v_mfma_f32_16x16x32_bf16 a[144:147], a[68:71], a[36:39], a[144:147]
ds_read_b64_tr_b16 a[88:89], v31 offset:40968
v_mfma_f32_16x16x32_bf16 a[176:179], a[64:67], a[40:43], a[176:179]
ds_read_b64_tr_b16 a[90:91], v31 offset:41480
v_mfma_f32_16x16x32_bf16 a[176:179], a[68:71], a[44:47], a[176:179]
ds_read_b64_tr_b16 a[92:93], v31 offset:45064
v_mfma_f32_16x16x32_bf16 a[208:211], a[64:67], a[48:51], a[208:211]
ds_read_b64_tr_b16 a[94:95], v31 offset:45576
v_mfma_f32_16x16x32_bf16 a[208:211], a[68:71], a[52:55], a[208:211]
s_waitcnt lgkmcnt(10)
v_mfma_f32_16x16x32_bf16 a[148:151], a[72:75], a[32:35], a[148:151]
v_mfma_f32_16x16x32_bf16 a[148:151], a[76:79], a[36:39], a[148:151]
v_mfma_f32_16x16x32_bf16 a[180:183], a[72:75], a[40:43], a[180:183]
v_mfma_f32_16x16x32_bf16 a[180:183], a[76:79], a[44:47], a[180:183]
s_waitcnt vmcnt(21) lgkmcnt(0)
v_mfma_f32_16x16x32_bf16 a[212:215], a[72:75], a[48:51], a[212:215]
s_barrier
v_mfma_f32_16x16x32_bf16 a[212:215], a[76:79], a[52:55], a[212:215]
ds_read_b64_tr_b16 a[64:65], v28 offset:0
s_add_u32 m0, s33, 147456
ds_read_b64_tr_b16 a[66:67], v28 offset:512
buffer_load_dwordx4 v24, s[8:11], s41 offen offset:0 lds
ds_read_b64_tr_b16 a[68:69], v28 offset:4096
v_mfma_f32_16x16x32_bf16 a[152:155], a[80:83], a[32:35], a[152:155]
ds_read_b64_tr_b16 a[70:71], v28 offset:4608
v_mfma_f32_16x16x32_bf16 a[152:155], a[84:87], a[36:39], a[152:155]
v_mfma_f32_16x16x32_bf16 a[184:187], a[80:83], a[40:43], a[184:187]
v_mfma_f32_16x16x32_bf16 a[184:187], a[84:87], a[44:47], a[184:187]
buffer_load_dwordx4 v25, s[8:11], s41 offen offset:1024 lds
v_mfma_f32_16x16x32_bf16 a[216:219], a[80:83], a[48:51], a[216:219]
v_mfma_f32_16x16x32_bf16 a[216:219], a[84:87], a[52:55], a[216:219]
ds_read_b64_tr_b16 a[72:73], v28 offset:8
ds_read_b64_tr_b16 a[74:75], v28 offset:520
ds_read_b64_tr_b16 a[76:77], v28 offset:4104
v_mfma_f32_16x16x32_bf16 a[156:159], a[88:91], a[32:35], a[156:159]
ds_read_b64_tr_b16 a[78:79], v28 offset:4616
buffer_load_dwordx4 v26, s[8:11], s41 offen offset:2048 lds
v_mfma_f32_16x16x32_bf16 a[156:159], a[92:95], a[36:39], a[156:159]
v_mfma_f32_16x16x32_bf16 a[188:191], a[88:91], a[40:43], a[188:191]
v_mfma_f32_16x16x32_bf16 a[188:191], a[92:95], a[44:47], a[188:191]
v_mfma_f32_16x16x32_bf16 a[220:223], a[88:91], a[48:51], a[220:223]
v_mfma_f32_16x16x32_bf16 a[220:223], a[92:95], a[52:55], a[220:223]
ds_read_b64_tr_b16 a[80:81], v29 offset:0
buffer_load_dwordx4 v27, s[8:11], s41 offen offset:3072 lds
ds_read_b64_tr_b16 a[82:83], v29 offset:512
s_add_u32 s41, s41, 524032
ds_read_b64_tr_b16 a[84:85], v29 offset:4096
s_waitcnt lgkmcnt(7)
v_mfma_f32_16x16x32_bf16 v[128:131], a[64:67], a[0:3], v[128:131]
ds_read_b64_tr_b16 a[86:87], v29 offset:4608
v_mfma_f32_16x16x32_bf16 v[128:131], a[68:71], a[4:7], v[128:131]
s_add_u32 m0, s42, 81920
v_mfma_f32_16x16x32_bf16 v[160:163], a[64:67], a[8:11], v[160:163]
buffer_load_dwordx4 v20, s[4:7], s39 offen offset:0 lds
v_mfma_f32_16x16x32_bf16 v[160:163], a[68:71], a[12:15], v[160:163]
v_mfma_f32_16x16x32_bf16 v[192:195], a[64:67], a[16:19], v[192:195]
v_mfma_f32_16x16x32_bf16 v[192:195], a[68:71], a[20:23], v[192:195]
ds_read_b64_tr_b16 a[88:89], v29 offset:8
ds_read_b64_tr_b16 a[90:91], v29 offset:520
ds_read_b64_tr_b16 a[92:93], v29 offset:4104
s_waitcnt lgkmcnt(7)
buffer_load_dwordx4 v21, s[4:7], s39 offen offset:1024 lds
v_mfma_f32_16x16x32_bf16 v[132:135], a[72:75], a[0:3], v[132:135]
ds_read_b64_tr_b16 a[94:95], v29 offset:4616
v_mfma_f32_16x16x32_bf16 v[132:135], a[76:79], a[4:7], v[132:135]
v_mfma_f32_16x16x32_bf16 v[164:167], a[72:75], a[8:11], v[164:167]
v_mfma_f32_16x16x32_bf16 v[164:167], a[76:79], a[12:15], v[164:167]
v_mfma_f32_16x16x32_bf16 v[196:199], a[72:75], a[16:19], v[196:199]
ds_read_b64_tr_b16 a[64:65], v28 offset:8192
buffer_load_dwordx4 v22, s[4:7], s39 offen offset:2048 lds
v_mfma_f32_16x16x32_bf16 v[196:199], a[76:79], a[20:23], v[196:199]
ds_read_b64_tr_b16 a[66:67], v28 offset:8704
ds_read_b64_tr_b16 a[68:69], v28 offset:12288
ds_read_b64_tr_b16 a[70:71], v28 offset:12800
s_waitcnt lgkmcnt(8)
v_mfma_f32_16x16x32_bf16 v[136:139], a[80:83], a[0:3], v[136:139]
v_mfma_f32_16x16x32_bf16 v[136:139], a[84:87], a[4:7], v[136:139]
buffer_load_dwordx4 v23, s[4:7], s39 offen offset:3072 lds
v_mfma_f32_16x16x32_bf16 v[168:171], a[80:83], a[8:11], v[168:171]
v_mfma_f32_16x16x32_bf16 v[168:171], a[84:87], a[12:15], v[168:171]
ds_read_b64_tr_b16 a[72:73], v28 offset:8200
v_mfma_f32_16x16x32_bf16 v[200:203], a[80:83], a[16:19], v[200:203]
ds_read_b64_tr_b16 a[74:75], v28 offset:8712
v_mfma_f32_16x16x32_bf16 v[200:203], a[84:87], a[20:23], v[200:203]
ds_read_b64_tr_b16 a[76:77], v28 offset:12296
s_add_u32 m0, s42, 86016
ds_read_b64_tr_b16 a[78:79], v28 offset:12808
buffer_load_dwordx4 v20, s[4:7], s40 offen offset:0 lds
s_waitcnt lgkmcnt(8)
v_mfma_f32_16x16x32_bf16 v[140:143], a[88:91], a[0:3], v[140:143]
v_mfma_f32_16x16x32_bf16 v[140:143], a[92:95], a[4:7], v[140:143]
v_mfma_f32_16x16x32_bf16 v[172:175], a[88:91], a[8:11], v[172:175]
ds_read_b64_tr_b16 a[80:81], v29 offset:8192
v_mfma_f32_16x16x32_bf16 v[172:175], a[92:95], a[12:15], v[172:175]
ds_read_b64_tr_b16 a[82:83], v29 offset:8704
buffer_load_dwordx4 v21, s[4:7], s40 offen offset:1024 lds
v_mfma_f32_16x16x32_bf16 v[204:207], a[88:91], a[16:19], v[204:207]
ds_read_b64_tr_b16 a[84:85], v29 offset:12288
s_add_u32 s39, s39, 128
s_add_u32 s40, s40, 128
v_mfma_f32_16x16x32_bf16 v[204:207], a[92:95], a[20:23], v[204:207]
ds_read_b64_tr_b16 a[86:87], v29 offset:12800
s_waitcnt lgkmcnt(8)
v_mfma_f32_16x16x32_bf16 v[144:147], a[64:67], a[0:3], v[144:147]
v_mfma_f32_16x16x32_bf16 v[144:147], a[68:71], a[4:7], v[144:147]
ds_read_b64_tr_b16 a[88:89], v29 offset:8200
v_mfma_f32_16x16x32_bf16 v[176:179], a[64:67], a[8:11], v[176:179]
ds_read_b64_tr_b16 a[90:91], v29 offset:8712
v_mfma_f32_16x16x32_bf16 v[176:179], a[68:71], a[12:15], v[176:179]
ds_read_b64_tr_b16 a[92:93], v29 offset:12296
v_mfma_f32_16x16x32_bf16 v[208:211], a[64:67], a[16:19], v[208:211]
ds_read_b64_tr_b16 a[94:95], v29 offset:12808
v_mfma_f32_16x16x32_bf16 v[208:211], a[68:71], a[20:23], v[208:211]
s_add_u32 m0, s64, 4096
s_mov_b32 s46, 16896
s_waitcnt lgkmcnt(8)
buffer_load_dwordx4 v101, s[24:27], s46 offen offset:2048 lds
v_mfma_f32_16x16x32_bf16 v[148:151], a[72:75], a[0:3], v[148:151]
v_mfma_f32_16x16x32_bf16 v[148:151], a[76:79], a[4:7], v[148:151]
s_add_u32 m0, s64, 4096
s_mov_b32 s46, 25088
v_mfma_f32_16x16x32_bf16 v[180:183], a[72:75], a[8:11], v[180:183]
buffer_load_dwordx4 v101, s[24:27], s46 offen offset:3072 lds
v_mfma_f32_16x16x32_bf16 v[180:183], a[76:79], a[12:15], v[180:183]
s_waitcnt vmcnt(21) lgkmcnt(0)
v_mfma_f32_16x16x32_bf16 v[212:215], a[72:75], a[16:19], v[212:215]
s_barrier
v_mfma_f32_16x16x32_bf16 v[212:215], a[76:79], a[20:23], v[212:215]
ds_read_b64_tr_b16 a[64:65], v30 offset:0
s_add_u32 m0, s33, 49152
ds_read_b64_tr_b16 a[66:67], v30 offset:512
buffer_load_dwordx4 v24, s[8:11], s41 offen offset:0 lds
ds_read_b64_tr_b16 a[68:69], v30 offset:4096
v_mfma_f32_16x16x32_bf16 v[152:155], a[80:83], a[0:3], v[152:155]
ds_read_b64_tr_b16 a[70:71], v30 offset:4608
v_mfma_f32_16x16x32_bf16 v[152:155], a[84:87], a[4:7], v[152:155]
v_mfma_f32_16x16x32_bf16 v[184:187], a[80:83], a[8:11], v[184:187]
v_mfma_f32_16x16x32_bf16 v[184:187], a[84:87], a[12:15], v[184:187]
buffer_load_dwordx4 v25, s[8:11], s41 offen offset:1024 lds
v_mfma_f32_16x16x32_bf16 v[216:219], a[80:83], a[16:19], v[216:219]
v_mfma_f32_16x16x32_bf16 v[216:219], a[84:87], a[20:23], v[216:219]
ds_read_b64_tr_b16 a[72:73], v30 offset:8
ds_read_b64_tr_b16 a[74:75], v30 offset:520
ds_read_b64_tr_b16 a[76:77], v30 offset:4104
v_mfma_f32_16x16x32_bf16 v[156:159], a[88:91], a[0:3], v[156:159]
ds_read_b64_tr_b16 a[78:79], v30 offset:4616
buffer_load_dwordx4 v26, s[8:11], s41 offen offset:2048 lds
v_mfma_f32_16x16x32_bf16 v[156:159], a[92:95], a[4:7], v[156:159]
v_mfma_f32_16x16x32_bf16 v[188:191], a[88:91], a[8:11], v[188:191]
v_mfma_f32_16x16x32_bf16 v[188:191], a[92:95], a[12:15], v[188:191]
v_mfma_f32_16x16x32_bf16 v[220:223], a[88:91], a[16:19], v[220:223]
v_mfma_f32_16x16x32_bf16 v[220:223], a[92:95], a[20:23], v[220:223]
ds_read_b64_tr_b16 a[80:81], v31 offset:0
buffer_load_dwordx4 v27, s[8:11], s41 offen offset:3072 lds
ds_read_b64_tr_b16 a[82:83], v31 offset:512
s_add_u32 s41, s41, 256
ds_read_b64_tr_b16 a[84:85], v31 offset:4096
s_waitcnt lgkmcnt(7)
v_mfma_f32_16x16x32_bf16 a[128:131], a[64:67], a[0:3], a[128:131]
ds_read_b64_tr_b16 a[86:87], v31 offset:4608
v_mfma_f32_16x16x32_bf16 a[128:131], a[68:71], a[4:7], a[128:131]
v_mfma_f32_16x16x32_bf16 a[160:163], a[64:67], a[8:11], a[160:163]
v_mfma_f32_16x16x32_bf16 a[160:163], a[68:71], a[12:15], a[160:163]
v_mfma_f32_16x16x32_bf16 a[192:195], a[64:67], a[16:19], a[192:195]
v_mfma_f32_16x16x32_bf16 a[192:195], a[68:71], a[20:23], a[192:195]
ds_read_b64_tr_b16 a[88:89], v31 offset:8
ds_read_b64_tr_b16 a[90:91], v31 offset:520
ds_read_b64_tr_b16 a[92:93], v31 offset:4104
s_waitcnt lgkmcnt(7)
v_mfma_f32_16x16x32_bf16 a[132:135], a[72:75], a[0:3], a[132:135]
ds_read_b64_tr_b16 a[94:95], v31 offset:4616
v_mfma_f32_16x16x32_bf16 a[132:135], a[76:79], a[4:7], a[132:135]
ds_read_b128 a[32:35], v16 offset:0
v_mfma_f32_16x16x32_bf16 a[164:167], a[72:75], a[8:11], a[164:167]
ds_read_b128 a[36:39], v17 offset:0
v_mfma_f32_16x16x32_bf16 a[164:167], a[76:79], a[12:15], a[164:167]
s_mov_b32 m0, s65
v_mfma_f32_16x16x32_bf16 a[196:199], a[72:75], a[16:19], a[196:199]
ds_read_b64_tr_b16 a[64:65], v30 offset:8192
buffer_load_dwordx4 v102, s[24:27], 0 offen offset:0 lds
v_mfma_f32_16x16x32_bf16 a[196:199], a[76:79], a[20:23], a[196:199]
ds_read_b64_tr_b16 a[66:67], v30 offset:8704
ds_read_b64_tr_b16 a[68:69], v30 offset:12288
ds_read_b64_tr_b16 a[70:71], v30 offset:12800
s_waitcnt lgkmcnt(10)
v_mfma_f32_16x16x32_bf16 a[136:139], a[80:83], a[0:3], a[136:139]
ds_read_b128 a[40:43], v16 offset:2048
v_mfma_f32_16x16x32_bf16 a[136:139], a[84:87], a[4:7], a[136:139]
ds_read_b128 a[44:47], v17 offset:2048
v_mfma_f32_16x16x32_bf16 a[168:171], a[80:83], a[8:11], a[168:171]
v_mfma_f32_16x16x32_bf16 a[168:171], a[84:87], a[12:15], a[168:171]
ds_read_b64_tr_b16 a[72:73], v30 offset:8200
v_mfma_f32_16x16x32_bf16 a[200:203], a[80:83], a[16:19], a[200:203]
ds_read_b64_tr_b16 a[74:75], v30 offset:8712
v_mfma_f32_16x16x32_bf16 a[200:203], a[84:87], a[20:23], a[200:203]
ds_read_b64_tr_b16 a[76:77], v30 offset:12296
ds_read_b64_tr_b16 a[78:79], v30 offset:12808
ds_read_b128 a[48:51], v16 offset:4096
s_waitcnt lgkmcnt(13)
v_mfma_f32_16x16x32_bf16 a[140:143], a[88:91], a[0:3], a[140:143]
ds_read_b128 a[52:55], v17 offset:4096
v_mfma_f32_16x16x32_bf16 a[140:143], a[92:95], a[4:7], a[140:143]
v_mfma_f32_16x16x32_bf16 a[172:175], a[88:91], a[8:11], a[172:175]
ds_read_b64_tr_b16 a[80:81], v31 offset:8192
v_mfma_f32_16x16x32_bf16 a[172:175], a[92:95], a[12:15], a[172:175]
ds_read_b64_tr_b16 a[82:83], v31 offset:8704
v_mfma_f32_16x16x32_bf16 a[204:207], a[88:91], a[16:19], a[204:207]
ds_read_b64_tr_b16 a[84:85], v31 offset:12288
v_mfma_f32_16x16x32_bf16 a[204:207], a[92:95], a[20:23], a[204:207]
ds_read_b64_tr_b16 a[86:87], v31 offset:12800
s_waitcnt lgkmcnt(12)
v_mfma_f32_16x16x32_bf16 a[144:147], a[64:67], a[0:3], a[144:147]
v_mfma_f32_16x16x32_bf16 a[144:147], a[68:71], a[4:7], a[144:147]
ds_read_b64_tr_b16 a[88:89], v31 offset:8200
v_mfma_f32_16x16x32_bf16 a[176:179], a[64:67], a[8:11], a[176:179]
ds_read_b64_tr_b16 a[90:91], v31 offset:8712
v_mfma_f32_16x16x32_bf16 a[176:179], a[68:71], a[12:15], a[176:179]
ds_read_b64_tr_b16 a[92:93], v31 offset:12296
v_mfma_f32_16x16x32_bf16 a[208:211], a[64:67], a[16:19], a[208:211]
ds_read_b64_tr_b16 a[94:95], v31 offset:12808
v_mfma_f32_16x16x32_bf16 a[208:211], a[68:71], a[20:23], a[208:211]
s_waitcnt lgkmcnt(10)
v_mfma_f32_16x16x32_bf16 a[148:151], a[72:75], a[0:3], a[148:151]
v_mfma_f32_16x16x32_bf16 a[148:151], a[76:79], a[4:7], a[148:151]
v_mfma_f32_16x16x32_bf16 a[180:183], a[72:75], a[8:11], a[180:183]
v_mfma_f32_16x16x32_bf16 a[180:183], a[76:79], a[12:15], a[180:183]
s_waitcnt vmcnt(19) lgkmcnt(0)
v_mfma_f32_16x16x32_bf16 a[212:215], a[72:75], a[16:19], a[212:215]
s_barrier
v_mfma_f32_16x16x32_bf16 a[212:215], a[76:79], a[20:23], a[212:215]
ds_read_b64_tr_b16 a[64:65], v30 offset:16384
s_add_u32 m0, s33, 114688
ds_read_b64_tr_b16 a[66:67], v30 offset:16896
buffer_load_dwordx4 v24, s[8:11], s41 offen offset:0 lds
ds_read_b64_tr_b16 a[68:69], v30 offset:20480
v_mfma_f32_16x16x32_bf16 a[152:155], a[80:83], a[0:3], a[152:155]
ds_read_b64_tr_b16 a[70:71], v30 offset:20992
v_mfma_f32_16x16x32_bf16 a[152:155], a[84:87], a[4:7], a[152:155]
v_mfma_f32_16x16x32_bf16 a[184:187], a[80:83], a[8:11], a[184:187]
v_mfma_f32_16x16x32_bf16 a[184:187], a[84:87], a[12:15], a[184:187]
buffer_load_dwordx4 v25, s[8:11], s41 offen offset:1024 lds
v_mfma_f32_16x16x32_bf16 a[216:219], a[80:83], a[16:19], a[216:219]
v_mfma_f32_16x16x32_bf16 a[216:219], a[84:87], a[20:23], a[216:219]
ds_read_b64_tr_b16 a[72:73], v30 offset:16392
ds_read_b64_tr_b16 a[74:75], v30 offset:16904
ds_read_b64_tr_b16 a[76:77], v30 offset:20488
v_mfma_f32_16x16x32_bf16 a[156:159], a[88:91], a[0:3], a[156:159]
ds_read_b64_tr_b16 a[78:79], v30 offset:21000
buffer_load_dwordx4 v26, s[8:11], s41 offen offset:2048 lds
v_mfma_f32_16x16x32_bf16 a[156:159], a[92:95], a[4:7], a[156:159]
v_mfma_f32_16x16x32_bf16 a[188:191], a[88:91], a[8:11], a[188:191]
v_mfma_f32_16x16x32_bf16 a[188:191], a[92:95], a[12:15], a[188:191]
v_mfma_f32_16x16x32_bf16 a[220:223], a[88:91], a[16:19], a[220:223]
v_mfma_f32_16x16x32_bf16 a[220:223], a[92:95], a[20:23], a[220:223]
ds_read_b64_tr_b16 a[80:81], v31 offset:16384
buffer_load_dwordx4 v27, s[8:11], s41 offen offset:3072 lds
ds_read_b64_tr_b16 a[82:83], v31 offset:16896
s_add_u32 s41, s41, 524032
ds_read_b64_tr_b16 a[84:85], v31 offset:20480
s_waitcnt lgkmcnt(7)
v_mfma_f32_16x16x32_bf16 v[128:131], a[64:67], a[32:35], v[128:131]
ds_read_b64_tr_b16 a[86:87], v31 offset:20992
v_mfma_f32_16x16x32_bf16 v[128:131], a[68:71], a[36:39], v[128:131]
s_add_u32 m0, s42, 16384
v_mfma_f32_16x16x32_bf16 v[160:163], a[64:67], a[40:43], v[160:163]
buffer_load_dwordx4 v20, s[4:7], s39 offen offset:0 lds
v_mfma_f32_16x16x32_bf16 v[160:163], a[68:71], a[44:47], v[160:163]
v_mfma_f32_16x16x32_bf16 v[192:195], a[64:67], a[48:51], v[192:195]
v_mfma_f32_16x16x32_bf16 v[192:195], a[68:71], a[52:55], v[192:195]
ds_read_b64_tr_b16 a[88:89], v31 offset:16392
ds_read_b64_tr_b16 a[90:91], v31 offset:16904
ds_read_b64_tr_b16 a[92:93], v31 offset:20488
s_waitcnt lgkmcnt(7)
buffer_load_dwordx4 v21, s[4:7], s39 offen offset:1024 lds
v_mfma_f32_16x16x32_bf16 v[132:135], a[72:75], a[32:35], v[132:135]
ds_read_b64_tr_b16 a[94:95], v31 offset:21000
v_mfma_f32_16x16x32_bf16 v[132:135], a[76:79], a[36:39], v[132:135]
v_mfma_f32_16x16x32_bf16 v[164:167], a[72:75], a[40:43], v[164:167]
v_mfma_f32_16x16x32_bf16 v[164:167], a[76:79], a[44:47], v[164:167]
v_mfma_f32_16x16x32_bf16 v[196:199], a[72:75], a[48:51], v[196:199]
ds_read_b64_tr_b16 a[64:65], v30 offset:24576
buffer_load_dwordx4 v22, s[4:7], s39 offen offset:2048 lds
v_mfma_f32_16x16x32_bf16 v[196:199], a[76:79], a[52:55], v[196:199]
ds_read_b64_tr_b16 a[66:67], v30 offset:25088
ds_read_b64_tr_b16 a[68:69], v30 offset:28672
ds_read_b64_tr_b16 a[70:71], v30 offset:29184
s_waitcnt lgkmcnt(8)
v_mfma_f32_16x16x32_bf16 v[136:139], a[80:83], a[32:35], v[136:139]
v_mfma_f32_16x16x32_bf16 v[136:139], a[84:87], a[36:39], v[136:139]
buffer_load_dwordx4 v23, s[4:7], s39 offen offset:3072 lds
v_mfma_f32_16x16x32_bf16 v[168:171], a[80:83], a[40:43], v[168:171]
v_mfma_f32_16x16x32_bf16 v[168:171], a[84:87], a[44:47], v[168:171]
ds_read_b64_tr_b16 a[72:73], v30 offset:24584
v_mfma_f32_16x16x32_bf16 v[200:203], a[80:83], a[48:51], v[200:203]
ds_read_b64_tr_b16 a[74:75], v30 offset:25096
v_mfma_f32_16x16x32_bf16 v[200:203], a[84:87], a[52:55], v[200:203]
ds_read_b64_tr_b16 a[76:77], v30 offset:28680
s_add_u32 m0, s42, 20480
ds_read_b64_tr_b16 a[78:79], v30 offset:29192
buffer_load_dwordx4 v20, s[4:7], s40 offen offset:0 lds
s_waitcnt lgkmcnt(8)
v_mfma_f32_16x16x32_bf16 v[140:143], a[88:91], a[32:35], v[140:143]
v_mfma_f32_16x16x32_bf16 v[140:143], a[92:95], a[36:39], v[140:143]
v_mfma_f32_16x16x32_bf16 v[172:175], a[88:91], a[40:43], v[172:175]
ds_read_b64_tr_b16 a[80:81], v31 offset:24576
v_mfma_f32_16x16x32_bf16 v[172:175], a[92:95], a[44:47], v[172:175]
ds_read_b64_tr_b16 a[82:83], v31 offset:25088
buffer_load_dwordx4 v21, s[4:7], s40 offen offset:1024 lds
v_mfma_f32_16x16x32_bf16 v[204:207], a[88:91], a[48:51], v[204:207]
ds_read_b64_tr_b16 a[84:85], v31 offset:28672
s_add_u32 s39, s39, 128
s_add_u32 s40, s40, 128
v_mfma_f32_16x16x32_bf16 v[204:207], a[92:95], a[52:55], v[204:207]
ds_read_b64_tr_b16 a[86:87], v31 offset:29184
s_waitcnt lgkmcnt(8)
v_mfma_f32_16x16x32_bf16 v[144:147], a[64:67], a[32:35], v[144:147]
v_mfma_f32_16x16x32_bf16 v[144:147], a[68:71], a[36:39], v[144:147]
ds_read_b64_tr_b16 a[88:89], v31 offset:24584
v_mfma_f32_16x16x32_bf16 v[176:179], a[64:67], a[40:43], v[176:179]
ds_read_b64_tr_b16 a[90:91], v31 offset:25096
v_mfma_f32_16x16x32_bf16 v[176:179], a[68:71], a[44:47], v[176:179]
ds_read_b64_tr_b16 a[92:93], v31 offset:28680
v_mfma_f32_16x16x32_bf16 v[208:211], a[64:67], a[48:51], v[208:211]
ds_read_b64_tr_b16 a[94:95], v31 offset:29192
v_mfma_f32_16x16x32_bf16 v[208:211], a[68:71], a[52:55], v[208:211]
s_waitcnt lgkmcnt(8)
v_mfma_f32_16x16x32_bf16 v[148:151], a[72:75], a[32:35], v[148:151]
v_mfma_f32_16x16x32_bf16 v[148:151], a[76:79], a[36:39], v[148:151]
v_mfma_f32_16x16x32_bf16 v[180:183], a[72:75], a[40:43], v[180:183]
v_mfma_f32_16x16x32_bf16 v[180:183], a[76:79], a[44:47], v[180:183]
s_waitcnt vmcnt(17) lgkmcnt(0)
v_mfma_f32_16x16x32_bf16 v[212:215], a[72:75], a[48:51], v[212:215]
s_barrier
v_mfma_f32_16x16x32_bf16 v[212:215], a[76:79], a[52:55], v[212:215]
ds_read_b64_tr_b16 a[64:65], v30 offset:32768
s_add_u32 m0, s33, 131072
ds_read_b64_tr_b16 a[66:67], v30 offset:33280
buffer_load_dwordx4 v24, s[8:11], s41 offen offset:0 lds
ds_read_b64_tr_b16 a[68:69], v30 offset:36864
v_mfma_f32_16x16x32_bf16 v[152:155], a[80:83], a[32:35], v[152:155]
ds_read_b64_tr_b16 a[70:71], v30 offset:37376
v_mfma_f32_16x16x32_bf16 v[152:155], a[84:87], a[36:39], v[152:155]
v_mfma_f32_16x16x32_bf16 v[184:187], a[80:83], a[40:43], v[184:187]
v_mfma_f32_16x16x32_bf16 v[184:187], a[84:87], a[44:47], v[184:187]
buffer_load_dwordx4 v25, s[8:11], s41 offen offset:1024 lds
v_mfma_f32_16x16x32_bf16 v[216:219], a[80:83], a[48:51], v[216:219]
v_mfma_f32_16x16x32_bf16 v[216:219], a[84:87], a[52:55], v[216:219]
ds_read_b64_tr_b16 a[72:73], v30 offset:32776
ds_read_b64_tr_b16 a[74:75], v30 offset:33288
ds_read_b64_tr_b16 a[76:77], v30 offset:36872
v_mfma_f32_16x16x32_bf16 v[156:159], a[88:91], a[32:35], v[156:159]
ds_read_b64_tr_b16 a[78:79], v30 offset:37384
buffer_load_dwordx4 v26, s[8:11], s41 offen offset:2048 lds
v_mfma_f32_16x16x32_bf16 v[156:159], a[92:95], a[36:39], v[156:159]
v_mfma_f32_16x16x32_bf16 v[188:191], a[88:91], a[40:43], v[188:191]
v_mfma_f32_16x16x32_bf16 v[188:191], a[92:95], a[44:47], v[188:191]
v_mfma_f32_16x16x32_bf16 v[220:223], a[88:91], a[48:51], v[220:223]
v_mfma_f32_16x16x32_bf16 v[220:223], a[92:95], a[52:55], v[220:223]
ds_read_b64_tr_b16 a[80:81], v31 offset:32768
buffer_load_dwordx4 v27, s[8:11], s41 offen offset:3072 lds
ds_read_b64_tr_b16 a[82:83], v31 offset:33280
s_add_u32 s41, s41, 256
ds_read_b64_tr_b16 a[84:85], v31 offset:36864
s_waitcnt lgkmcnt(7)
v_mfma_f32_16x16x32_bf16 a[128:131], a[64:67], a[32:35], a[128:131]
ds_read_b64_tr_b16 a[86:87], v31 offset:37376
v_mfma_f32_16x16x32_bf16 a[128:131], a[68:71], a[36:39], a[128:131]
v_mfma_f32_16x16x32_bf16 a[160:163], a[64:67], a[40:43], a[160:163]
v_mfma_f32_16x16x32_bf16 a[160:163], a[68:71], a[44:47], a[160:163]
v_mfma_f32_16x16x32_bf16 a[192:195], a[64:67], a[48:51], a[192:195]
v_mfma_f32_16x16x32_bf16 a[192:195], a[68:71], a[52:55], a[192:195]
ds_read_b64_tr_b16 a[88:89], v31 offset:32776
ds_read_b64_tr_b16 a[90:91], v31 offset:33288
ds_read_b64_tr_b16 a[92:93], v31 offset:36872
s_waitcnt lgkmcnt(7)
v_mfma_f32_16x16x32_bf16 a[132:135], a[72:75], a[32:35], a[132:135]
ds_read_b64_tr_b16 a[94:95], v31 offset:37384
v_mfma_f32_16x16x32_bf16 a[132:135], a[76:79], a[36:39], a[132:135]
ds_read_b128 a[0:3], v18 offset:0
v_mfma_f32_16x16x32_bf16 a[164:167], a[72:75], a[40:43], a[164:167]
ds_read_b128 a[4:7], v19 offset:0
v_mfma_f32_16x16x32_bf16 a[164:167], a[76:79], a[44:47], a[164:167]
v_mfma_f32_16x16x32_bf16 a[196:199], a[72:75], a[48:51], a[196:199]
ds_read_b64_tr_b16 a[64:65], v30 offset:40960
v_mfma_f32_16x16x32_bf16 a[196:199], a[76:79], a[52:55], a[196:199]
ds_read_b64_tr_b16 a[66:67], v30 offset:41472
ds_read_b64_tr_b16 a[68:69], v30 offset:45056
ds_read_b64_tr_b16 a[70:71], v30 offset:45568
s_waitcnt lgkmcnt(10)
v_mfma_f32_16x16x32_bf16 a[136:139], a[80:83], a[32:35], a[136:139]
ds_read_b128 a[8:11], v18 offset:2048
v_mfma_f32_16x16x32_bf16 a[136:139], a[84:87], a[36:39], a[136:139]
ds_read_b128 a[12:15], v19 offset:2048
v_mfma_f32_16x16x32_bf16 a[168:171], a[80:83], a[40:43], a[168:171]
v_mfma_f32_16x16x32_bf16 a[168:171], a[84:87], a[44:47], a[168:171]
ds_read_b64_tr_b16 a[72:73], v30 offset:40968
v_mfma_f32_16x16x32_bf16 a[200:203], a[80:83], a[48:51], a[200:203]
ds_read_b64_tr_b16 a[74:75], v30 offset:41480
v_mfma_f32_16x16x32_bf16 a[200:203], a[84:87], a[52:55], a[200:203]
ds_read_b64_tr_b16 a[76:77], v30 offset:45064
ds_read_b64_tr_b16 a[78:79], v30 offset:45576
ds_read_b128 a[16:19], v18 offset:4096
s_waitcnt lgkmcnt(13)
v_mfma_f32_16x16x32_bf16 a[140:143], a[88:91], a[32:35], a[140:143]
ds_read_b128 a[20:23], v19 offset:4096
v_mfma_f32_16x16x32_bf16 a[140:143], a[92:95], a[36:39], a[140:143]
v_mfma_f32_16x16x32_bf16 a[172:175], a[88:91], a[40:43], a[172:175]
ds_read_b64_tr_b16 a[80:81], v31 offset:40960
v_mfma_f32_16x16x32_bf16 a[172:175], a[92:95], a[44:47], a[172:175]
ds_read_b64_tr_b16 a[82:83], v31 offset:41472
v_mfma_f32_16x16x32_bf16 a[204:207], a[88:91], a[48:51], a[204:207]
ds_read_b64_tr_b16 a[84:85], v31 offset:45056
v_mfma_f32_16x16x32_bf16 a[204:207], a[92:95], a[52:55], a[204:207]
ds_read_b64_tr_b16 a[86:87], v31 offset:45568
s_waitcnt lgkmcnt(12)
v_mfma_f32_16x16x32_bf16 a[144:147], a[64:67], a[32:35], a[144:147]
v_mfma_f32_16x16x32_bf16 a[144:147], a[68:71], a[36:39], a[144:147]
ds_read_b64_tr_b16 a[88:89], v31 offset:40968
v_mfma_f32_16x16x32_bf16 a[176:179], a[64:67], a[40:43], a[176:179]
ds_read_b64_tr_b16 a[90:91], v31 offset:41480
v_mfma_f32_16x16x32_bf16 a[176:179], a[68:71], a[44:47], a[176:179]
ds_read_b64_tr_b16 a[92:93], v31 offset:45064
v_mfma_f32_16x16x32_bf16 a[208:211], a[64:67], a[48:51], a[208:211]
ds_read_b64_tr_b16 a[94:95], v31 offset:45576
v_mfma_f32_16x16x32_bf16 a[208:211], a[68:71], a[52:55], a[208:211]
s_waitcnt lgkmcnt(10)
v_mfma_f32_16x16x32_bf16 a[148:151], a[72:75], a[32:35], a[148:151]
v_mfma_f32_16x16x32_bf16 a[148:151], a[76:79], a[36:39], a[148:151]
v_mfma_f32_16x16x32_bf16 a[180:183], a[72:75], a[40:43], a[180:183]
v_mfma_f32_16x16x32_bf16 a[180:183], a[76:79], a[44:47], a[180:183]
s_waitcnt vmcnt(15) lgkmcnt(0)
v_mfma_f32_16x16x32_bf16 a[212:215], a[72:75], a[48:51], a[212:215]
s_barrier
v_mfma_f32_16x16x32_bf16 a[212:215], a[76:79], a[52:55], a[212:215]
ds_read_b64_tr_b16 a[64:65], v28 offset:0
s_add_u32 m0, s33, 147456
ds_read_b64_tr_b16 a[66:67], v28 offset:512
buffer_load_dwordx4 v24, s[8:11], s41 offen offset:0 lds
ds_read_b64_tr_b16 a[68:69], v28 offset:4096
v_mfma_f32_16x16x32_bf16 a[152:155], a[80:83], a[32:35], a[152:155]
ds_read_b64_tr_b16 a[70:71], v28 offset:4608
v_mfma_f32_16x16x32_bf16 a[152:155], a[84:87], a[36:39], a[152:155]
v_mfma_f32_16x16x32_bf16 a[184:187], a[80:83], a[40:43], a[184:187]
v_mfma_f32_16x16x32_bf16 a[184:187], a[84:87], a[44:47], a[184:187]
buffer_load_dwordx4 v25, s[8:11], s41 offen offset:1024 lds
v_mfma_f32_16x16x32_bf16 a[216:219], a[80:83], a[48:51], a[216:219]
v_mfma_f32_16x16x32_bf16 a[216:219], a[84:87], a[52:55], a[216:219]
ds_read_b64_tr_b16 a[72:73], v28 offset:8
ds_read_b64_tr_b16 a[74:75], v28 offset:520
ds_read_b64_tr_b16 a[76:77], v28 offset:4104
v_mfma_f32_16x16x32_bf16 a[156:159], a[88:91], a[32:35], a[156:159]
ds_read_b64_tr_b16 a[78:79], v28 offset:4616
buffer_load_dwordx4 v26, s[8:11], s41 offen offset:2048 lds
v_mfma_f32_16x16x32_bf16 a[156:159], a[92:95], a[36:39], a[156:159]
v_mfma_f32_16x16x32_bf16 a[188:191], a[88:91], a[40:43], a[188:191]
v_mfma_f32_16x16x32_bf16 a[188:191], a[92:95], a[44:47], a[188:191]
v_mfma_f32_16x16x32_bf16 a[220:223], a[88:91], a[48:51], a[220:223]
v_mfma_f32_16x16x32_bf16 a[220:223], a[92:95], a[52:55], a[220:223]
ds_read_b64_tr_b16 a[80:81], v29 offset:0
buffer_load_dwordx4 v27, s[8:11], s41 offen offset:3072 lds
ds_read_b64_tr_b16 a[82:83], v29 offset:512
s_add_u32 s41, s41, 524032
ds_read_b64_tr_b16 a[84:85], v29 offset:4096
s_waitcnt lgkmcnt(7)
v_mfma_f32_16x16x32_bf16 v[128:131], a[64:67], a[0:3], v[128:131]
ds_read_b64_tr_b16 a[86:87], v29 offset:4608
v_mfma_f32_16x16x32_bf16 v[128:131], a[68:71], a[4:7], v[128:131]
s_add_u32 m0, s42, 81920
v_mfma_f32_16x16x32_bf16 v[160:163], a[64:67], a[8:11], v[160:163]
buffer_load_dwordx4 v20, s[4:7], s39 offen offset:0 lds
v_mfma_f32_16x16x32_bf16 v[160:163], a[68:71], a[12:15], v[160:163]
v_mfma_f32_16x16x32_bf16 v[192:195], a[64:67], a[16:19], v[192:195]
v_mfma_f32_16x16x32_bf16 v[192:195], a[68:71], a[20:23], v[192:195]
ds_read_b64_tr_b16 a[88:89], v29 offset:8
ds_read_b64_tr_b16 a[90:91], v29 offset:520
ds_read_b64_tr_b16 a[92:93], v29 offset:4104
s_waitcnt lgkmcnt(7)
buffer_load_dwordx4 v21, s[4:7], s39 offen offset:1024 lds
v_mfma_f32_16x16x32_bf16 v[132:135], a[72:75], a[0:3], v[132:135]
ds_read_b64_tr_b16 a[94:95], v29 offset:4616
v_mfma_f32_16x16x32_bf16 v[132:135], a[76:79], a[4:7], v[132:135]
v_mfma_f32_16x16x32_bf16 v[164:167], a[72:75], a[8:11], v[164:167]
v_mfma_f32_16x16x32_bf16 v[164:167], a[76:79], a[12:15], v[164:167]
v_mfma_f32_16x16x32_bf16 v[196:199], a[72:75], a[16:19], v[196:199]
ds_read_b64_tr_b16 a[64:65], v28 offset:8192
buffer_load_dwordx4 v22, s[4:7], s39 offen offset:2048 lds
v_mfma_f32_16x16x32_bf16 v[196:199], a[76:79], a[20:23], v[196:199]
ds_read_b64_tr_b16 a[66:67], v28 offset:8704
ds_read_b64_tr_b16 a[68:69], v28 offset:12288
ds_read_b64_tr_b16 a[70:71], v28 offset:12800
s_waitcnt lgkmcnt(8)
v_mfma_f32_16x16x32_bf16 v[136:139], a[80:83], a[0:3], v[136:139]
v_mfma_f32_16x16x32_bf16 v[136:139], a[84:87], a[4:7], v[136:139]
buffer_load_dwordx4 v23, s[4:7], s39 offen offset:3072 lds
v_mfma_f32_16x16x32_bf16 v[168:171], a[80:83], a[8:11], v[168:171]
v_mfma_f32_16x16x32_bf16 v[168:171], a[84:87], a[12:15], v[168:171]
ds_read_b64_tr_b16 a[72:73], v28 offset:8200
v_mfma_f32_16x16x32_bf16 v[200:203], a[80:83], a[16:19], v[200:203]
ds_read_b64_tr_b16 a[74:75], v28 offset:8712
v_mfma_f32_16x16x32_bf16 v[200:203], a[84:87], a[20:23], v[200:203]
ds_read_b64_tr_b16 a[76:77], v28 offset:12296
s_add_u32 m0, s42, 86016
ds_read_b64_tr_b16 a[78:79], v28 offset:12808
buffer_load_dwordx4 v20, s[4:7], s40 offen offset:0 lds
s_waitcnt lgkmcnt(8)
v_mfma_f32_16x16x32_bf16 v[140:143], a[88:91], a[0:3], v[140:143]
v_mfma_f32_16x16x32_bf16 v[140:143], a[92:95], a[4:7], v[140:143]
v_mfma_f32_16x16x32_bf16 v[172:175], a[88:91], a[8:11], v[172:175]
ds_read_b64_tr_b16 a[80:81], v29 offset:8192
v_mfma_f32_16x16x32_bf16 v[172:175], a[92:95], a[12:15], v[172:175]
ds_read_b64_tr_b16 a[82:83], v29 offset:8704
buffer_load_dwordx4 v21, s[4:7], s40 offen offset:1024 lds
v_mfma_f32_16x16x32_bf16 v[204:207], a[88:91], a[16:19], v[204:207]
ds_read_b64_tr_b16 a[84:85], v29 offset:12288
s_add_u32 s39, s39, 128
s_add_u32 s40, s40, 128
v_mfma_f32_16x16x32_bf16 v[204:207], a[92:95], a[20:23], v[204:207]
ds_read_b64_tr_b16 a[86:87], v29 offset:12800
s_waitcnt lgkmcnt(8)
v_mfma_f32_16x16x32_bf16 v[144:147], a[64:67], a[0:3], v[144:147]
v_mfma_f32_16x16x32_bf16 v[144:147], a[68:71], a[4:7], v[144:147]
ds_read_b64_tr_b16 a[88:89], v29 offset:8200
v_mfma_f32_16x16x32_bf16 v[176:179], a[64:67], a[8:11], v[176:179]
ds_read_b64_tr_b16 a[90:91], v29 offset:8712
v_mfma_f32_16x16x32_bf16 v[176:179], a[68:71], a[12:15], v[176:179]
ds_read_b64_tr_b16 a[92:93], v29 offset:12296
v_mfma_f32_16x16x32_bf16 v[208:211], a[64:67], a[16:19], v[208:211]
ds_read_b64_tr_b16 a[94:95], v29 offset:12808
v_mfma_f32_16x16x32_bf16 v[208:211], a[68:71], a[20:23], v[208:211]
s_waitcnt lgkmcnt(8)
v_mfma_f32_16x16x32_bf16 v[148:151], a[72:75], a[0:3], v[148:151]
v_mfma_f32_16x16x32_bf16 v[148:151], a[76:79], a[4:7], v[148:151]
v_mfma_f32_16x16x32_bf16 v[180:183], a[72:75], a[8:11], v[180:183]
v_mfma_f32_16x16x32_bf16 v[180:183], a[76:79], a[12:15], v[180:183]
s_waitcnt vmcnt(14) lgkmcnt(0)
v_mfma_f32_16x16x32_bf16 v[212:215], a[72:75], a[16:19], v[212:215]
s_barrier
s_waitcnt vmcnt(24)
v_mfma_f32_16x16x32_bf16 v[212:215], a[76:79], a[20:23], v[212:215]
ds_read_b64_tr_b16 a[64:65], v30 offset:0
s_add_u32 m0, s33, 49152
ds_read_b64_tr_b16 a[66:67], v30 offset:512
buffer_load_dwordx4 v24, s[8:11], s41 offen offset:0 lds
ds_read_b64_tr_b16 a[68:69], v30 offset:4096
v_mfma_f32_16x16x32_bf16 v[152:155], a[80:83], a[0:3], v[152:155]
ds_read_b64_tr_b16 a[70:71], v30 offset:4608
v_mfma_f32_16x16x32_bf16 v[152:155], a[84:87], a[4:7], v[152:155]
ds_read_b64_tr_b16 v[32:33], v105 offset:0
v_mfma_f32_16x16x32_bf16 v[184:187], a[80:83], a[8:11], v[184:187]
ds_read_b64_tr_b16 v[34:35], v105 offset:2048
v_mfma_f32_16x16x32_bf16 v[184:187], a[84:87], a[12:15], v[184:187]
ds_read_b64_tr_b16 v[36:37], v105 offset:32
buffer_load_dwordx4 v25, s[8:11], s41 offen offset:1024 lds
v_mfma_f32_16x16x32_bf16 v[216:219], a[80:83], a[16:19], v[216:219]
ds_read_b64_tr_b16 v[38:39], v105 offset:2080
v_mfma_f32_16x16x32_bf16 v[216:219], a[84:87], a[20:23], v[216:219]
ds_read_b64_tr_b16 a[72:73], v30 offset:8
ds_read_b64_tr_b16 a[74:75], v30 offset:520
ds_read_b64_tr_b16 a[76:77], v30 offset:4104
v_mfma_f32_16x16x32_bf16 v[156:159], a[88:91], a[0:3], v[156:159]
ds_read_b64_tr_b16 a[78:79], v30 offset:4616
buffer_load_dwordx4 v26, s[8:11], s41 offen offset:2048 lds
v_mfma_f32_16x16x32_bf16 v[156:159], a[92:95], a[4:7], v[156:159]
ds_read_b64_tr_b16 v[40:41], v105 offset:64
v_mfma_f32_16x16x32_bf16 v[188:191], a[88:91], a[8:11], v[188:191]
ds_read_b64_tr_b16 v[42:43], v105 offset:2112
v_mfma_f32_16x16x32_bf16 v[188:191], a[92:95], a[12:15], v[188:191]
ds_read_b64_tr_b16 v[44:45], v105 offset:96
v_mfma_f32_16x16x32_bf16 v[220:223], a[88:91], a[16:19], v[220:223]
ds_read_b64_tr_b16 v[46:47], v105 offset:2144
v_mfma_f32_16x16x32_bf16 v[220:223], a[92:95], a[20:23], v[220:223]
ds_read_b64_tr_b16 a[80:81], v31 offset:0
buffer_load_dwordx4 v27, s[8:11], s41 offen offset:3072 lds
ds_read_b64_tr_b16 a[82:83], v31 offset:512
s_add_u32 s41, s41, 256
ds_read_b64_tr_b16 a[84:85], v31 offset:4096
s_waitcnt lgkmcnt(15)
v_mfma_f32_16x16x32_bf16 a[128:131], a[64:67], a[0:3], a[128:131]
ds_read_b64_tr_b16 a[86:87], v31 offset:4608
v_mfma_f32_16x16x32_bf16 a[128:131], a[68:71], a[4:7], a[128:131]
ds_read_b64_tr_b16 v[48:49], v105 offset:4096
v_mfma_f32_16x16x32_bf16 a[160:163], a[64:67], a[8:11], a[160:163]
ds_read_b64_tr_b16 v[50:51], v105 offset:6144
v_mfma_f32_16x16x32_bf16 a[160:163], a[68:71], a[12:15], a[160:163]
ds_read_b64_tr_b16 v[52:53], v105 offset:4128
v_mfma_f32_16x16x32_bf16 a[192:195], a[64:67], a[16:19], a[192:195]
ds_read_b64_tr_b16 v[54:55], v105 offset:6176
v_mfma_f32_16x16x32_bf16 a[192:195], a[68:71], a[20:23], a[192:195]
ds_read_b64_tr_b16 a[88:89], v31 offset:8
ds_read_b64_tr_b16 a[90:91], v31 offset:520
ds_read_b64_tr_b16 a[92:93], v31 offset:4104
s_waitcnt lgkmcnt(15)
v_mfma_f32_16x16x32_bf16 a[132:135], a[72:75], a[0:3], a[132:135]
ds_read_b64_tr_b16 a[94:95], v31 offset:4616
v_mfma_f32_16x16x32_bf16 a[132:135], a[76:79], a[4:7], a[132:135]
ds_read_b128 a[32:35], v16 offset:0
v_mfma_f32_16x16x32_bf16 a[164:167], a[72:75], a[8:11], a[164:167]
ds_read_b128 a[36:39], v17 offset:0
v_mfma_f32_16x16x32_bf16 a[164:167], a[76:79], a[12:15], a[164:167]
ds_read_b64_tr_b16 v[56:57], v105 offset:4160
v_mfma_f32_16x16x32_bf16 a[196:199], a[72:75], a[16:19], a[196:199]
ds_read_b64_tr_b16 a[64:65], v30 offset:8192
v_mfma_f32_16x16x32_bf16 a[196:199], a[76:79], a[20:23], a[196:199]
ds_read_b64_tr_b16 a[66:67], v30 offset:8704
ds_read_b64_tr_b16 a[68:69], v30 offset:12288
ds_read_b64_tr_b16 a[70:71], v30 offset:12800
s_waitcnt lgkmcnt(15)
v_mfma_f32_16x16x32_bf16 a[136:139], a[80:83], a[0:3], a[136:139]
ds_read_b128 a[40:43], v16 offset:2048
v_mfma_f32_16x16x32_bf16 a[136:139], a[84:87], a[4:7], a[136:139]
ds_read_b128 a[44:47], v17 offset:2048
v_mfma_f32_16x16x32_bf16 a[168:171], a[80:83], a[8:11], a[168:171]
ds_read_b64_tr_b16 v[58:59], v105 offset:6208
v_mfma_f32_16x16x32_bf16 a[168:171], a[84:87], a[12:15], a[168:171]
ds_read_b64_tr_b16 a[72:73], v30 offset:8200
v_mfma_f32_16x16x32_bf16 a[200:203], a[80:83], a[16:19], a[200:203]
ds_read_b64_tr_b16 a[74:75], v30 offset:8712
v_mfma_f32_16x16x32_bf16 a[200:203], a[84:87], a[20:23], a[200:203]
ds_read_b64_tr_b16 a[76:77], v30 offset:12296
ds_read_b64_tr_b16 a[78:79], v30 offset:12808
ds_read_b128 a[48:51], v16 offset:4096
s_waitcnt lgkmcnt(15)
v_mfma_f32_16x16x32_bf16 a[140:143], a[88:91], a[0:3], a[140:143]
ds_read_b128 a[52:55], v17 offset:4096
v_mfma_f32_16x16x32_bf16 a[140:143], a[92:95], a[4:7], a[140:143]
ds_read_b64_tr_b16 v[60:61], v105 offset:4192
v_mfma_f32_16x16x32_bf16 a[172:175], a[88:91], a[8:11], a[172:175]
ds_read_b64_tr_b16 a[80:81], v31 offset:8192
v_mfma_f32_16x16x32_bf16 a[172:175], a[92:95], a[12:15], a[172:175]
ds_read_b64_tr_b16 a[82:83], v31 offset:8704
v_mfma_f32_16x16x32_bf16 a[204:207], a[88:91], a[16:19], a[204:207]
ds_read_b64_tr_b16 a[84:85], v31 offset:12288
v_mfma_f32_16x16x32_bf16 a[204:207], a[92:95], a[20:23], a[204:207]
ds_read_b64_tr_b16 a[86:87], v31 offset:12800
s_waitcnt lgkmcnt(14)
v_mfma_f32_16x16x32_bf16 a[144:147], a[64:67], a[0:3], a[144:147]
v_mfma_f32_16x16x32_bf16 a[144:147], a[68:71], a[4:7], a[144:147]
ds_read_b64_tr_b16 a[88:89], v31 offset:8200
v_mfma_f32_16x16x32_bf16 a[176:179], a[64:67], a[8:11], a[176:179]
ds_read_b64_tr_b16 a[90:91], v31 offset:8712
v_mfma_f32_16x16x32_bf16 a[176:179], a[68:71], a[12:15], a[176:179]
ds_read_b64_tr_b16 a[92:93], v31 offset:12296
v_mfma_f32_16x16x32_bf16 a[208:211], a[64:67], a[16:19], a[208:211]
ds_read_b64_tr_b16 a[94:95], v31 offset:12808
v_mfma_f32_16x16x32_bf16 a[208:211], a[68:71], a[20:23], a[208:211]
ds_read_b64_tr_b16 v[62:63], v105 offset:6240
ds_read_b64_tr_b16 v[64:65], v10 offset:0
s_waitcnt lgkmcnt(13)
ds_read_b64_tr_b16 v[66:67], v10 offset:512
v_mfma_f32_16x16x32_bf16 a[148:151], a[72:75], a[0:3], a[148:151]
v_mfma_f32_16x16x32_bf16 a[148:151], a[76:79], a[4:7], a[148:151]
v_mfma_f32_16x16x32_bf16 a[180:183], a[72:75], a[8:11], a[180:183]
v_mfma_f32_16x16x32_bf16 a[180:183], a[76:79], a[12:15], a[180:183]
s_waitcnt vmcnt(14) lgkmcnt(0)
v_mfma_f32_16x16x32_bf16 a[212:215], a[72:75], a[16:19], a[212:215]
s_barrier
v_mfma_f32_16x16x32_bf16 a[212:215], a[76:79], a[20:23], a[212:215]
ds_read_b64_tr_b16 a[64:65], v30 offset:16384
s_add_u32 m0, s33, 114688
ds_read_b64_tr_b16 a[66:67], v30 offset:16896
buffer_load_dwordx4 v24, s[8:11], s41 offen offset:0 lds
ds_read_b64_tr_b16 a[68:69], v30 offset:20480
v_mfma_f32_16x16x32_bf16 a[152:155], a[80:83], a[0:3], a[152:155]
ds_read_b64_tr_b16 a[70:71], v30 offset:20992
v_mfma_f32_16x16x32_bf16 a[152:155], a[84:87], a[4:7], a[152:155]
v_mfma_f32_16x16x32_bf16 a[184:187], a[80:83], a[8:11], a[184:187]
v_mfma_f32_16x16x32_bf16 a[184:187], a[84:87], a[12:15], a[184:187]
buffer_load_dwordx4 v25, s[8:11], s41 offen offset:1024 lds
v_mfma_f32_16x16x32_bf16 a[216:219], a[80:83], a[16:19], a[216:219]
v_mfma_f32_16x16x32_bf16 a[216:219], a[84:87], a[20:23], a[216:219]
ds_read_b64_tr_b16 a[72:73], v30 offset:16392
ds_read_b64_tr_b16 a[74:75], v30 offset:16904
ds_read_b64_tr_b16 a[76:77], v30 offset:20488
v_mfma_f32_16x16x32_bf16 a[156:159], a[88:91], a[0:3], a[156:159]
ds_read_b64_tr_b16 a[78:79], v30 offset:21000
buffer_load_dwordx4 v26, s[8:11], s41 offen offset:2048 lds
v_mfma_f32_16x16x32_bf16 a[156:159], a[92:95], a[4:7], a[156:159]
v_mfma_f32_16x16x32_bf16 a[188:191], a[88:91], a[8:11], a[188:191]
v_mfma_f32_16x16x32_bf16 a[188:191], a[92:95], a[12:15], a[188:191]
v_mfma_f32_16x16x32_bf16 a[220:223], a[88:91], a[16:19], a[220:223]
v_mfma_f32_16x16x32_bf16 a[220:223], a[92:95], a[20:23], a[220:223]
ds_read_b64_tr_b16 a[80:81], v31 offset:16384
buffer_load_dwordx4 v27, s[8:11], s41 offen offset:3072 lds
ds_read_b64_tr_b16 a[82:83], v31 offset:16896
s_add_u32 s41, s41, 524032
ds_read_b64_tr_b16 a[84:85], v31 offset:20480
s_waitcnt lgkmcnt(7)
v_mfma_f32_16x16x32_bf16 v[128:131], a[64:67], a[32:35], v[128:131]
ds_read_b64_tr_b16 a[86:87], v31 offset:20992
v_mfma_f32_16x16x32_bf16 v[128:131], a[68:71], a[36:39], v[128:131]
s_add_u32 m0, s42, 16384
v_mfma_f32_16x16x32_bf16 v[160:163], a[64:67], a[40:43], v[160:163]
buffer_load_dwordx4 v20, s[4:7], s39 offen offset:0 lds
v_mfma_f32_16x16x32_bf16 v[160:163], a[68:71], a[44:47], v[160:163]
v_mfma_f32_16x16x32_bf16 v[192:195], a[64:67], a[48:51], v[192:195]
v_mfma_f32_16x16x32_bf16 v[192:195], a[68:71], a[52:55], v[192:195]
ds_read_b64_tr_b16 a[88:89], v31 offset:16392
ds_read_b64_tr_b16 a[90:91], v31 offset:16904
ds_read_b64_tr_b16 a[92:93], v31 offset:20488
s_waitcnt lgkmcnt(7)
buffer_load_dwordx4 v21, s[4:7], s39 offen offset:1024 lds
v_mfma_f32_16x16x32_bf16 v[132:135], a[72:75], a[32:35], v[132:135]
ds_read_b64_tr_b16 a[94:95], v31 offset:21000
v_mfma_f32_16x16x32_bf16 v[132:135], a[76:79], a[36:39], v[132:135]
v_mfma_f32_16x16x32_bf16 v[164:167], a[72:75], a[40:43], v[164:167]
v_mfma_f32_16x16x32_bf16 v[164:167], a[76:79], a[44:47], v[164:167]
v_mfma_f32_16x16x32_bf16 v[196:199], a[72:75], a[48:51], v[196:199]
ds_read_b64_tr_b16 a[64:65], v30 offset:24576
buffer_load_dwordx4 v22, s[4:7], s39 offen offset:2048 lds
v_mfma_f32_16x16x32_bf16 v[196:199], a[76:79], a[52:55], v[196:199]
ds_read_b64_tr_b16 a[66:67], v30 offset:25088
ds_read_b64_tr_b16 a[68:69], v30 offset:28672
ds_read_b64_tr_b16 a[70:71], v30 offset:29184
s_waitcnt lgkmcnt(8)
v_mfma_f32_16x16x32_bf16 v[136:139], a[80:83], a[32:35], v[136:139]
v_mfma_f32_16x16x32_bf16 v[136:139], a[84:87], a[36:39], v[136:139]
buffer_load_dwordx4 v23, s[4:7], s39 offen offset:3072 lds
v_mfma_f32_16x16x32_bf16 v[168:171], a[80:83], a[40:43], v[168:171]
v_mfma_f32_16x16x32_bf16 v[168:171], a[84:87], a[44:47], v[168:171]
ds_read_b64_tr_b16 a[72:73], v30 offset:24584
v_mfma_f32_16x16x32_bf16 v[200:203], a[80:83], a[48:51], v[200:203]
ds_read_b64_tr_b16 a[74:75], v30 offset:25096
v_mfma_f32_16x16x32_bf16 v[200:203], a[84:87], a[52:55], v[200:203]
ds_read_b64_tr_b16 a[76:77], v30 offset:28680
s_add_u32 m0, s42, 20480
ds_read_b64_tr_b16 a[78:79], v30 offset:29192
buffer_load_dwordx4 v20, s[4:7], s40 offen offset:0 lds
s_waitcnt lgkmcnt(8)
v_mfma_f32_16x16x32_bf16 v[140:143], a[88:91], a[32:35], v[140:143]
v_mfma_f32_16x16x32_bf16 v[140:143], a[92:95], a[36:39], v[140:143]
v_mfma_f32_16x16x32_bf16 v[172:175], a[88:91], a[40:43], v[172:175]
ds_read_b64_tr_b16 a[80:81], v31 offset:24576
v_mfma_f32_16x16x32_bf16 v[172:175], a[92:95], a[44:47], v[172:175]
ds_read_b64_tr_b16 a[82:83], v31 offset:25088
buffer_load_dwordx4 v21, s[4:7], s40 offen offset:1024 lds
v_mfma_f32_16x16x32_bf16 v[204:207], a[88:91], a[48:51], v[204:207]
ds_read_b64_tr_b16 a[84:85], v31 offset:28672
s_add_u32 s39, s39, 128
s_add_u32 s40, s40, 128
v_mfma_f32_16x16x32_bf16 v[204:207], a[92:95], a[52:55], v[204:207]
ds_read_b64_tr_b16 a[86:87], v31 offset:29184
s_waitcnt lgkmcnt(8)
v_mfma_f32_16x16x32_bf16 v[144:147], a[64:67], a[32:35], v[144:147]
v_mfma_f32_16x16x32_bf16 v[144:147], a[68:71], a[36:39], v[144:147]
ds_read_b64_tr_b16 a[88:89], v31 offset:24584
v_mfma_f32_16x16x32_bf16 v[176:179], a[64:67], a[40:43], v[176:179]
ds_read_b64_tr_b16 a[90:91], v31 offset:25096
v_mfma_f32_16x16x32_bf16 v[176:179], a[68:71], a[44:47], v[176:179]
ds_read_b64_tr_b16 a[92:93], v31 offset:28680
v_mfma_f32_16x16x32_bf16 v[208:211], a[64:67], a[48:51], v[208:211]
ds_read_b64_tr_b16 a[94:95], v31 offset:29192
v_mfma_f32_16x16x32_bf16 v[208:211], a[68:71], a[52:55], v[208:211]
s_add_u32 m0, s69, 0
s_mov_b32 s46, 0
s_waitcnt lgkmcnt(8)
buffer_load_dwordx4 v96, s[12:15], s46 offen offset:0 nt lds
v_mfma_f32_16x16x32_bf16 v[148:151], a[72:75], a[32:35], v[148:151]
v_mfma_f32_16x16x32_bf16 v[148:151], a[76:79], a[36:39], v[148:151]
s_add_u32 m0, s69, 0
s_mov_b32 s46, 0
v_mfma_f32_16x16x32_bf16 v[180:183], a[72:75], a[40:43], v[180:183]
buffer_load_dwordx4 v97, s[12:15], s46 offen offset:1024 nt lds
v_mfma_f32_16x16x32_bf16 v[180:183], a[76:79], a[44:47], v[180:183]
s_waitcnt vmcnt(16) lgkmcnt(0)
v_mfma_f32_16x16x32_bf16 v[212:215], a[72:75], a[48:51], v[212:215]
s_barrier
v_mfma_f32_16x16x32_bf16 v[212:215], a[76:79], a[52:55], v[212:215]
ds_read_b64_tr_b16 a[64:65], v30 offset:32768
s_add_u32 m0, s33, 131072
ds_read_b64_tr_b16 a[66:67], v30 offset:33280
buffer_load_dwordx4 v24, s[8:11], s41 offen offset:0 lds
ds_read_b64_tr_b16 a[68:69], v30 offset:36864
v_mfma_f32_16x16x32_bf16 v[152:155], a[80:83], a[32:35], v[152:155]
ds_read_b64_tr_b16 a[70:71], v30 offset:37376
v_mfma_f32_16x16x32_bf16 v[152:155], a[84:87], a[36:39], v[152:155]
v_mfma_f32_16x16x32_bf16 v[184:187], a[80:83], a[40:43], v[184:187]
v_mfma_f32_16x16x32_bf16 v[184:187], a[84:87], a[44:47], v[184:187]
buffer_load_dwordx4 v25, s[8:11], s41 offen offset:1024 lds
v_mfma_f32_16x16x32_bf16 v[216:219], a[80:83], a[48:51], v[216:219]
v_mfma_f32_16x16x32_bf16 v[216:219], a[84:87], a[52:55], v[216:219]
ds_read_b64_tr_b16 a[72:73], v30 offset:32776
ds_read_b64_tr_b16 a[74:75], v30 offset:33288
ds_read_b64_tr_b16 a[76:77], v30 offset:36872
v_mfma_f32_16x16x32_bf16 v[156:159], a[88:91], a[32:35], v[156:159]
ds_read_b64_tr_b16 a[78:79], v30 offset:37384
buffer_load_dwordx4 v26, s[8:11], s41 offen offset:2048 lds
v_mfma_f32_16x16x32_bf16 v[156:159], a[92:95], a[36:39], v[156:159]
v_mfma_f32_16x16x32_bf16 v[188:191], a[88:91], a[40:43], v[188:191]
v_mfma_f32_16x16x32_bf16 v[188:191], a[92:95], a[44:47], v[188:191]
v_mfma_f32_16x16x32_bf16 v[220:223], a[88:91], a[48:51], v[220:223]
v_mfma_f32_16x16x32_bf16 v[220:223], a[92:95], a[52:55], v[220:223]
ds_read_b64_tr_b16 a[80:81], v31 offset:32768
buffer_load_dwordx4 v27, s[8:11], s41 offen offset:3072 lds
ds_read_b64_tr_b16 a[82:83], v31 offset:33280
s_add_u32 s41, s41, 256
ds_read_b64_tr_b16 a[84:85], v31 offset:36864
s_waitcnt lgkmcnt(7)
v_mfma_f32_16x16x32_bf16 a[128:131], a[64:67], a[32:35], a[128:131]
ds_read_b64_tr_b16 a[86:87], v31 offset:37376
v_mfma_f32_16x16x32_bf16 a[128:131], a[68:71], a[36:39], a[128:131]
v_mfma_f32_16x16x32_bf16 a[160:163], a[64:67], a[40:43], a[160:163]
v_mfma_f32_16x16x32_bf16 a[160:163], a[68:71], a[44:47], a[160:163]
v_mfma_f32_16x16x32_bf16 a[192:195], a[64:67], a[48:51], a[192:195]
v_mfma_f32_16x16x32_bf16 a[192:195], a[68:71], a[52:55], a[192:195]
ds_read_b64_tr_b16 a[88:89], v31 offset:32776
ds_read_b64_tr_b16 a[90:91], v31 offset:33288
ds_read_b64_tr_b16 a[92:93], v31 offset:36872
s_waitcnt lgkmcnt(7)
v_mfma_f32_16x16x32_bf16 a[132:135], a[72:75], a[32:35], a[132:135]
ds_read_b64_tr_b16 a[94:95], v31 offset:37384
v_mfma_f32_16x16x32_bf16 a[132:135], a[76:79], a[36:39], a[132:135]
ds_read_b128 a[0:3], v18 offset:0
v_mfma_f32_16x16x32_bf16 a[164:167], a[72:75], a[40:43], a[164:167]
ds_read_b128 a[4:7], v19 offset:0
v_mfma_f32_16x16x32_bf16 a[164:167], a[76:79], a[44:47], a[164:167]
s_add_u32 m0, s69, 65536
s_mov_b32 s46, 0
v_mfma_f32_16x16x32_bf16 a[196:199], a[72:75], a[48:51], a[196:199]
ds_read_b64_tr_b16 a[64:65], v30 offset:40960
buffer_load_dwordx4 v98, s[16:19], s46 offen offset:0 nt lds
v_mfma_f32_16x16x32_bf16 a[196:199], a[76:79], a[52:55], a[196:199]
ds_read_b64_tr_b16 a[66:67], v30 offset:41472
ds_read_b64_tr_b16 a[68:69], v30 offset:45056
ds_read_b64_tr_b16 a[70:71], v30 offset:45568
s_waitcnt lgkmcnt(10)
v_mfma_f32_16x16x32_bf16 a[136:139], a[80:83], a[32:35], a[136:139]
ds_read_b128 a[8:11], v18 offset:2048
v_mfma_f32_16x16x32_bf16 a[136:139], a[84:87], a[36:39], a[136:139]
ds_read_b128 a[12:15], v19 offset:2048
v_mfma_f32_16x16x32_bf16 a[168:171], a[80:83], a[40:43], a[168:171]
v_mfma_f32_16x16x32_bf16 a[168:171], a[84:87], a[44:47], a[168:171]
ds_read_b64_tr_b16 a[72:73], v30 offset:40968
v_mfma_f32_16x16x32_bf16 a[200:203], a[80:83], a[48:51], a[200:203]
ds_read_b64_tr_b16 a[74:75], v30 offset:41480
v_mfma_f32_16x16x32_bf16 a[200:203], a[84:87], a[52:55], a[200:203]
ds_read_b64_tr_b16 a[76:77], v30 offset:45064
ds_read_b64_tr_b16 a[78:79], v30 offset:45576
ds_read_b128 a[16:19], v18 offset:4096
s_waitcnt lgkmcnt(13)
v_mfma_f32_16x16x32_bf16 a[140:143], a[88:91], a[32:35], a[140:143]
ds_read_b128 a[20:23], v19 offset:4096
v_mfma_f32_16x16x32_bf16 a[140:143], a[92:95], a[36:39], a[140:143]
v_mfma_f32_16x16x32_bf16 a[172:175], a[88:91], a[40:43], a[172:175]
ds_read_b64_tr_b16 a[80:81], v31 offset:40960
v_mfma_f32_16x16x32_bf16 a[172:175], a[92:95], a[44:47], a[172:175]
ds_read_b64_tr_b16 a[82:83], v31 offset:41472
v_mfma_f32_16x16x32_bf16 a[204:207], a[88:91], a[48:51], a[204:207]
ds_read_b64_tr_b16 a[84:85], v31 offset:45056
v_mfma_f32_16x16x32_bf16 a[204:207], a[92:95], a[52:55], a[204:207]
ds_read_b64_tr_b16 a[86:87], v31 offset:45568
s_waitcnt lgkmcnt(12)
s_add_u32 m0, s69, 65536
s_mov_b32 s46, 0
v_mfma_f32_16x16x32_bf16 a[144:147], a[64:67], a[32:35], a[144:147]
buffer_load_dwordx4 v99, s[16:19], s46 offen offset:1024 nt lds
v_mfma_f32_16x16x32_bf16 a[144:147], a[68:71], a[36:39], a[144:147]
ds_read_b64_tr_b16 a[88:89], v31 offset:40968
v_mfma_f32_16x16x32_bf16 a[176:179], a[64:67], a[40:43], a[176:179]
ds_read_b64_tr_b16 a[90:91], v31 offset:41480
v_mfma_f32_16x16x32_bf16 a[176:179], a[68:71], a[44:47], a[176:179]
ds_read_b64_tr_b16 a[92:93], v31 offset:45064
v_mfma_f32_16x16x32_bf16 a[208:211], a[64:67], a[48:51], a[208:211]
ds_read_b64_tr_b16 a[94:95], v31 offset:45576
v_mfma_f32_16x16x32_bf16 a[208:211], a[68:71], a[52:55], a[208:211]
s_waitcnt lgkmcnt(10)
v_mfma_f32_16x16x32_bf16 a[148:151], a[72:75], a[32:35], a[148:151]
v_mfma_f32_16x16x32_bf16 a[148:151], a[76:79], a[36:39], a[148:151]
v_mfma_f32_16x16x32_bf16 a[180:183], a[72:75], a[40:43], a[180:183]
v_mfma_f32_16x16x32_bf16 a[180:183], a[76:79], a[44:47], a[180:183]
s_waitcnt vmcnt(18) lgkmcnt(0)
v_mfma_f32_16x16x32_bf16 a[212:215], a[72:75], a[48:51], a[212:215]
s_barrier
v_mfma_f32_16x16x32_bf16 a[212:215], a[76:79], a[52:55], a[212:215]
ds_read_b64_tr_b16 a[64:65], v28 offset:0
s_add_u32 m0, s33, 147456
ds_read_b64_tr_b16 a[66:67], v28 offset:512
buffer_load_dwordx4 v24, s[8:11], s41 offen offset:0 lds
ds_read_b64_tr_b16 a[68:69], v28 offset:4096
v_mfma_f32_16x16x32_bf16 a[152:155], a[80:83], a[32:35], a[152:155]
ds_read_b64_tr_b16 a[70:71], v28 offset:4608
v_mfma_f32_16x16x32_bf16 a[152:155], a[84:87], a[36:39], a[152:155]
v_mfma_f32_16x16x32_bf16 a[184:187], a[80:83], a[40:43], a[184:187]
v_mfma_f32_16x16x32_bf16 a[184:187], a[84:87], a[44:47], a[184:187]
buffer_load_dwordx4 v25, s[8:11], s41 offen offset:1024 lds
v_mfma_f32_16x16x32_bf16 a[216:219], a[80:83], a[48:51], a[216:219]
v_mfma_f32_16x16x32_bf16 a[216:219], a[84:87], a[52:55], a[216:219]
ds_read_b64_tr_b16 a[72:73], v28 offset:8
ds_read_b64_tr_b16 a[74:75], v28 offset:520
ds_read_b64_tr_b16 a[76:77], v28 offset:4104
v_mfma_f32_16x16x32_bf16 a[156:159], a[88:91], a[32:35], a[156:159]
ds_read_b64_tr_b16 a[78:79], v28 offset:4616
buffer_load_dwordx4 v26, s[8:11], s41 offen offset:2048 lds
v_mfma_f32_16x16x32_bf16 a[156:159], a[92:95], a[36:39], a[156:159]
v_mfma_f32_16x16x32_bf16 a[188:191], a[88:91], a[40:43], a[188:191]
v_mfma_f32_16x16x32_bf16 a[188:191], a[92:95], a[44:47], a[188:191]
v_mfma_f32_16x16x32_bf16 a[220:223], a[88:91], a[48:51], a[220:223]
v_mfma_f32_16x16x32_bf16 a[220:223], a[92:95], a[52:55], a[220:223]
ds_read_b64_tr_b16 a[80:81], v29 offset:0
buffer_load_dwordx4 v27, s[8:11], s41 offen offset:3072 lds
ds_read_b64_tr_b16 a[82:83], v29 offset:512
s_add_u32 s41, s41, 524032
ds_read_b64_tr_b16 a[84:85], v29 offset:4096
s_waitcnt lgkmcnt(7)
v_mfma_f32_16x16x32_bf16 v[128:131], a[64:67], a[0:3], v[128:131]
ds_read_b64_tr_b16 a[86:87], v29 offset:4608
v_mfma_f32_16x16x32_bf16 v[128:131], a[68:71], a[4:7], v[128:131]
s_add_u32 m0, s42, 81920
v_mfma_f32_16x16x32_bf16 v[160:163], a[64:67], a[8:11], v[160:163]
buffer_load_dwordx4 v20, s[4:7], s39 offen offset:0 lds
v_mfma_f32_16x16x32_bf16 v[160:163], a[68:71], a[12:15], v[160:163]
v_mfma_f32_16x16x32_bf16 v[192:195], a[64:67], a[16:19], v[192:195]
v_mfma_f32_16x16x32_bf16 v[192:195], a[68:71], a[20:23], v[192:195]
ds_read_b64_tr_b16 a[88:89], v29 offset:8
ds_read_b64_tr_b16 a[90:91], v29 offset:520
ds_read_b64_tr_b16 a[92:93], v29 offset:4104
s_waitcnt lgkmcnt(7)
buffer_load_dwordx4 v21, s[4:7], s39 offen offset:1024 lds
v_mfma_f32_16x16x32_bf16 v[132:135], a[72:75], a[0:3], v[132:135]
ds_read_b64_tr_b16 a[94:95], v29 offset:4616
v_mfma_f32_16x16x32_bf16 v[132:135], a[76:79], a[4:7], v[132:135]
v_mfma_f32_16x16x32_bf16 v[164:167], a[72:75], a[8:11], v[164:167]
v_mfma_f32_16x16x32_bf16 v[164:167], a[76:79], a[12:15], v[164:167]
v_mfma_f32_16x16x32_bf16 v[196:199], a[72:75], a[16:19], v[196:199]
ds_read_b64_tr_b16 a[64:65], v28 offset:8192
buffer_load_dwordx4 v22, s[4:7], s39 offen offset:2048 lds
v_mfma_f32_16x16x32_bf16 v[196:199], a[76:79], a[20:23], v[196:199]
ds_read_b64_tr_b16 a[66:67], v28 offset:8704
ds_read_b64_tr_b16 a[68:69], v28 offset:12288
ds_read_b64_tr_b16 a[70:71], v28 offset:12800
s_waitcnt lgkmcnt(8)
v_mfma_f32_16x16x32_bf16 v[136:139], a[80:83], a[0:3], v[136:139]
v_mfma_f32_16x16x32_bf16 v[136:139], a[84:87], a[4:7], v[136:139]
buffer_load_dwordx4 v23, s[4:7], s39 offen offset:3072 lds
v_mfma_f32_16x16x32_bf16 v[168:171], a[80:83], a[8:11], v[168:171]
v_mfma_f32_16x16x32_bf16 v[168:171], a[84:87], a[12:15], v[168:171]
ds_read_b64_tr_b16 a[72:73], v28 offset:8200
v_mfma_f32_16x16x32_bf16 v[200:203], a[80:83], a[16:19], v[200:203]
ds_read_b64_tr_b16 a[74:75], v28 offset:8712
v_mfma_f32_16x16x32_bf16 v[200:203], a[84:87], a[20:23], v[200:203]
ds_read_b64_tr_b16 a[76:77], v28 offset:12296
s_add_u32 m0, s42, 86016
ds_read_b64_tr_b16 a[78:79], v28 offset:12808
buffer_load_dwordx4 v20, s[4:7], s40 offen offset:0 lds
s_waitcnt lgkmcnt(8)
v_mfma_f32_16x16x32_bf16 v[140:143], a[88:91], a[0:3], v[140:143]
v_mfma_f32_16x16x32_bf16 v[140:143], a[92:95], a[4:7], v[140:143]
v_mfma_f32_16x16x32_bf16 v[172:175], a[88:91], a[8:11], v[172:175]
ds_read_b64_tr_b16 a[80:81], v29 offset:8192
v_mfma_f32_16x16x32_bf16 v[172:175], a[92:95], a[12:15], v[172:175]
ds_read_b64_tr_b16 a[82:83], v29 offset:8704
buffer_load_dwordx4 v21, s[4:7], s40 offen offset:1024 lds
v_mfma_f32_16x16x32_bf16 v[204:207], a[88:91], a[16:19], v[204:207]
ds_read_b64_tr_b16 a[84:85], v29 offset:12288
s_add_u32 s39, s39, 128
s_add_u32 s40, s40, 128
v_mfma_f32_16x16x32_bf16 v[204:207], a[92:95], a[20:23], v[204:207]
ds_read_b64_tr_b16 a[86:87], v29 offset:12800
s_waitcnt lgkmcnt(8)
v_mfma_f32_16x16x32_bf16 v[144:147], a[64:67], a[0:3], v[144:147]
v_mfma_f32_16x16x32_bf16 v[144:147], a[68:71], a[4:7], v[144:147]
ds_read_b64_tr_b16 a[88:89], v29 offset:8200
v_mfma_f32_16x16x32_bf16 v[176:179], a[64:67], a[8:11], v[176:179]
ds_read_b64_tr_b16 a[90:91], v29 offset:8712
v_mfma_f32_16x16x32_bf16 v[176:179], a[68:71], a[12:15], v[176:179]
ds_read_b64_tr_b16 a[92:93], v29 offset:12296
v_mfma_f32_16x16x32_bf16 v[208:211], a[64:67], a[16:19], v[208:211]
ds_read_b64_tr_b16 a[94:95], v29 offset:12808
v_mfma_f32_16x16x32_bf16 v[208:211], a[68:71], a[20:23], v[208:211]
s_add_u32 m0, s69, 8192
s_mov_b32 s46, 8192
s_waitcnt lgkmcnt(8)
buffer_load_dwordx4 v96, s[12:15], s46 offen offset:0 nt lds
v_mfma_f32_16x16x32_bf16 v[148:151], a[72:75], a[0:3], v[148:151]
v_mfma_f32_16x16x32_bf16 v[148:151], a[76:79], a[4:7], v[148:151]
s_add_u32 m0, s69, 8192
s_mov_b32 s46, 8192
v_mfma_f32_16x16x32_bf16 v[180:183], a[72:75], a[8:11], v[180:183]
buffer_load_dwordx4 v97, s[12:15], s46 offen offset:1024 nt lds
v_mfma_f32_16x16x32_bf16 v[180:183], a[76:79], a[12:15], v[180:183]
s_waitcnt vmcnt(20) lgkmcnt(0)
v_mfma_f32_16x16x32_bf16 v[212:215], a[72:75], a[16:19], v[212:215]
s_barrier
v_mfma_f32_16x16x32_bf16 v[212:215], a[76:79], a[20:23], v[212:215]
ds_read_b64_tr_b16 a[64:65], v30 offset:0
buffer_load_dword v106, off, s[52:55], 0
s_add_u32 m0, s33, 49152
ds_read_b64_tr_b16 a[66:67], v30 offset:512
buffer_load_dwordx4 v24, s[8:11], s41 offen offset:0 lds
ds_read_b64_tr_b16 a[68:69], v30 offset:4096
v_mfma_f32_16x16x32_bf16 v[152:155], a[80:83], a[0:3], v[152:155]
ds_read_b64_tr_b16 a[70:71], v30 offset:4608
v_mfma_f32_16x16x32_bf16 v[152:155], a[84:87], a[4:7], v[152:155]
v_mfma_f32_16x16x32_bf16 v[184:187], a[80:83], a[8:11], v[184:187]
v_mfma_f32_16x16x32_bf16 v[184:187], a[84:87], a[12:15], v[184:187]
buffer_load_dwordx4 v25, s[8:11], s41 offen offset:1024 lds
v_mfma_f32_16x16x32_bf16 v[216:219], a[80:83], a[16:19], v[216:219]
v_mfma_f32_16x16x32_bf16 v[216:219], a[84:87], a[20:23], v[216:219]
ds_read_b64_tr_b16 a[72:73], v30 offset:8
ds_read_b64_tr_b16 a[74:75], v30 offset:520
ds_read_b64_tr_b16 a[76:77], v30 offset:4104
v_mfma_f32_16x16x32_bf16 v[156:159], a[88:91], a[0:3], v[156:159]
ds_read_b64_tr_b16 a[78:79], v30 offset:4616
buffer_load_dwordx4 v26, s[8:11], s41 offen offset:2048 lds
v_mfma_f32_16x16x32_bf16 v[156:159], a[92:95], a[4:7], v[156:159]
v_mfma_f32_16x16x32_bf16 v[188:191], a[88:91], a[8:11], v[188:191]
v_mfma_f32_16x16x32_bf16 v[188:191], a[92:95], a[12:15], v[188:191]
v_mfma_f32_16x16x32_bf16 v[220:223], a[88:91], a[16:19], v[220:223]
v_mfma_f32_16x16x32_bf16 v[220:223], a[92:95], a[20:23], v[220:223]
ds_read_b64_tr_b16 a[80:81], v31 offset:0
buffer_load_dwordx4 v27, s[8:11], s41 offen offset:3072 lds
ds_read_b64_tr_b16 a[82:83], v31 offset:512
s_add_u32 s41, s41, 256
ds_read_b64_tr_b16 a[84:85], v31 offset:4096
s_waitcnt lgkmcnt(7)
v_mfma_f32_16x16x32_bf16 a[128:131], a[64:67], a[0:3], a[128:131]
ds_read_b64_tr_b16 a[86:87], v31 offset:4608
v_mfma_f32_16x16x32_bf16 a[128:131], a[68:71], a[4:7], a[128:131]
v_mfma_f32_16x16x32_bf16 a[160:163], a[64:67], a[8:11], a[160:163]
v_mfma_f32_16x16x32_bf16 a[160:163], a[68:71], a[12:15], a[160:163]
v_mfma_f32_16x16x32_bf16 a[192:195], a[64:67], a[16:19], a[192:195]
v_mfma_f32_16x16x32_bf16 a[192:195], a[68:71], a[20:23], a[192:195]
ds_read_b64_tr_b16 a[88:89], v31 offset:8
ds_read_b64_tr_b16 a[90:91], v31 offset:520
ds_read_b64_tr_b16 a[92:93], v31 offset:4104
s_waitcnt lgkmcnt(7)
v_mfma_f32_16x16x32_bf16 a[132:135], a[72:75], a[0:3], a[132:135]
ds_read_b64_tr_b16 a[94:95], v31 offset:4616
v_mfma_f32_16x16x32_bf16 a[132:135], a[76:79], a[4:7], a[132:135]
ds_read_b128 a[32:35], v16 offset:0
v_mfma_f32_16x16x32_bf16 a[164:167], a[72:75], a[8:11], a[164:167]
ds_read_b128 a[36:39], v17 offset:0
v_mfma_f32_16x16x32_bf16 a[164:167], a[76:79], a[12:15], a[164:167]
s_add_u32 m0, s69, 73728
s_mov_b32 s46, 8192
v_mfma_f32_16x16x32_bf16 a[196:199], a[72:75], a[16:19], a[196:199]
ds_read_b64_tr_b16 a[64:65], v30 offset:8192
buffer_load_dwordx4 v98, s[16:19], s46 offen offset:0 nt lds
v_mfma_f32_16x16x32_bf16 a[196:199], a[76:79], a[20:23], a[196:199]
ds_read_b64_tr_b16 a[66:67], v30 offset:8704
ds_read_b64_tr_b16 a[68:69], v30 offset:12288
ds_read_b64_tr_b16 a[70:71], v30 offset:12800
s_waitcnt lgkmcnt(10)
v_mfma_f32_16x16x32_bf16 a[136:139], a[80:83], a[0:3], a[136:139]
ds_read_b128 a[40:43], v16 offset:2048
v_mfma_f32_16x16x32_bf16 a[136:139], a[84:87], a[4:7], a[136:139]
ds_read_b128 a[44:47], v17 offset:2048
v_mfma_f32_16x16x32_bf16 a[168:171], a[80:83], a[8:11], a[168:171]
v_mfma_f32_16x16x32_bf16 a[168:171], a[84:87], a[12:15], a[168:171]
ds_read_b64_tr_b16 a[72:73], v30 offset:8200
v_mfma_f32_16x16x32_bf16 a[200:203], a[80:83], a[16:19], a[200:203]
ds_read_b64_tr_b16 a[74:75], v30 offset:8712
v_mfma_f32_16x16x32_bf16 a[200:203], a[84:87], a[20:23], a[200:203]
ds_read_b64_tr_b16 a[76:77], v30 offset:12296
ds_read_b64_tr_b16 a[78:79], v30 offset:12808
ds_read_b128 a[48:51], v16 offset:4096
s_waitcnt lgkmcnt(13)
v_mfma_f32_16x16x32_bf16 a[140:143], a[88:91], a[0:3], a[140:143]
ds_read_b128 a[52:55], v17 offset:4096
v_mfma_f32_16x16x32_bf16 a[140:143], a[92:95], a[4:7], a[140:143]
v_mfma_f32_16x16x32_bf16 a[172:175], a[88:91], a[8:11], a[172:175]
ds_read_b64_tr_b16 a[80:81], v31 offset:8192
v_mfma_f32_16x16x32_bf16 a[172:175], a[92:95], a[12:15], a[172:175]
ds_read_b64_tr_b16 a[82:83], v31 offset:8704
v_mfma_f32_16x16x32_bf16 a[204:207], a[88:91], a[16:19], a[204:207]
ds_read_b64_tr_b16 a[84:85], v31 offset:12288
v_mfma_f32_16x16x32_bf16 a[204:207], a[92:95], a[20:23], a[204:207]
ds_read_b64_tr_b16 a[86:87], v31 offset:12800
s_waitcnt lgkmcnt(12)
s_add_u32 m0, s69, 73728
s_mov_b32 s46, 8192
v_mfma_f32_16x16x32_bf16 a[144:147], a[64:67], a[0:3], a[144:147]
buffer_load_dwordx4 v99, s[16:19], s46 offen offset:1024 nt lds
v_mfma_f32_16x16x32_bf16 a[144:147], a[68:71], a[4:7], a[144:147]
ds_read_b64_tr_b16 a[88:89], v31 offset:8200
v_mfma_f32_16x16x32_bf16 a[176:179], a[64:67], a[8:11], a[176:179]
ds_read_b64_tr_b16 a[90:91], v31 offset:8712
v_mfma_f32_16x16x32_bf16 a[176:179], a[68:71], a[12:15], a[176:179]
ds_read_b64_tr_b16 a[92:93], v31 offset:12296
v_mfma_f32_16x16x32_bf16 a[208:211], a[64:67], a[16:19], a[208:211]
ds_read_b64_tr_b16 a[94:95], v31 offset:12808
v_mfma_f32_16x16x32_bf16 a[208:211], a[68:71], a[20:23], a[208:211]
s_waitcnt lgkmcnt(10)
v_mfma_f32_16x16x32_bf16 a[148:151], a[72:75], a[0:3], a[148:151]
v_mfma_f32_16x16x32_bf16 a[148:151], a[76:79], a[4:7], a[148:151]
global_load_dword v1, v[76:77], off
v_mfma_f32_16x16x32_bf16 a[180:183], a[72:75], a[8:11], a[180:183]
v_mfma_f32_16x16x32_bf16 a[180:183], a[76:79], a[12:15], a[180:183]
s_waitcnt vmcnt(22) lgkmcnt(0)
v_mfma_f32_16x16x32_bf16 a[212:215], a[72:75], a[16:19], a[212:215]
s_barrier
v_mfma_f32_16x16x32_bf16 a[212:215], a[76:79], a[20:23], a[212:215]
ds_read_b64_tr_b16 a[64:65], v30 offset:16384
s_add_u32 m0, s33, 114688
ds_read_b64_tr_b16 a[66:67], v30 offset:16896
buffer_load_dwordx4 v24, s[8:11], s41 offen offset:0 lds
ds_read_b64_tr_b16 a[68:69], v30 offset:20480
v_mfma_f32_16x16x32_bf16 a[152:155], a[80:83], a[0:3], a[152:155]
ds_read_b64_tr_b16 a[70:71], v30 offset:20992
v_mfma_f32_16x16x32_bf16 a[152:155], a[84:87], a[4:7], a[152:155]
v_mfma_f32_16x16x32_bf16 a[184:187], a[80:83], a[8:11], a[184:187]
v_mfma_f32_16x16x32_bf16 a[184:187], a[84:87], a[12:15], a[184:187]
buffer_load_dwordx4 v25, s[8:11], s41 offen offset:1024 lds
v_mfma_f32_16x16x32_bf16 a[216:219], a[80:83], a[16:19], a[216:219]
v_mfma_f32_16x16x32_bf16 a[216:219], a[84:87], a[20:23], a[216:219]
ds_read_b64_tr_b16 a[72:73], v30 offset:16392
ds_read_b64_tr_b16 a[74:75], v30 offset:16904
ds_read_b64_tr_b16 a[76:77], v30 offset:20488
v_mfma_f32_16x16x32_bf16 a[156:159], a[88:91], a[0:3], a[156:159]
ds_read_b64_tr_b16 a[78:79], v30 offset:21000
buffer_load_dwordx4 v26, s[8:11], s41 offen offset:2048 lds
v_mfma_f32_16x16x32_bf16 a[156:159], a[92:95], a[4:7], a[156:159]
v_mfma_f32_16x16x32_bf16 a[188:191], a[88:91], a[8:11], a[188:191]
v_mfma_f32_16x16x32_bf16 a[188:191], a[92:95], a[12:15], a[188:191]
v_mfma_f32_16x16x32_bf16 a[220:223], a[88:91], a[16:19], a[220:223]
v_mfma_f32_16x16x32_bf16 a[220:223], a[92:95], a[20:23], a[220:223]
ds_read_b64_tr_b16 a[80:81], v31 offset:16384
buffer_load_dwordx4 v27, s[8:11], s41 offen offset:3072 lds
ds_read_b64_tr_b16 a[82:83], v31 offset:16896
s_mov_b32 s34, 16384
s_add_u32 s41, s41, 524032
ds_read_b64_tr_b16 a[84:85], v31 offset:20480
s_waitcnt lgkmcnt(7)
v_mfma_f32_16x16x32_bf16 v[128:131], a[64:67], a[32:35], v[128:131]
ds_read_b64_tr_b16 a[86:87], v31 offset:20992
v_mfma_f32_16x16x32_bf16 v[128:131], a[68:71], a[36:39], v[128:131]
s_add_u32 s46, s34, 0
s_add_u32 m0, s69, 16384
v_mfma_f32_16x16x32_bf16 v[160:163], a[64:67], a[40:43], v[160:163]
buffer_load_dwordx4 v96, s[12:15], s46 offen offset:0 nt lds
v_mfma_f32_16x16x32_bf16 v[160:163], a[68:71], a[44:47], v[160:163]
v_mfma_f32_16x16x32_bf16 v[192:195], a[64:67], a[48:51], v[192:195]
v_mfma_f32_16x16x32_bf16 v[192:195], a[68:71], a[52:55], v[192:195]
ds_read_b64_tr_b16 a[88:89], v31 offset:16392
ds_read_b64_tr_b16 a[90:91], v31 offset:16904
ds_read_b64_tr_b16 a[92:93], v31 offset:20488
s_waitcnt lgkmcnt(7)
buffer_load_dwordx4 v97, s[12:15], s46 offen offset:1024 nt lds
v_mfma_f32_16x16x32_bf16 v[132:135], a[72:75], a[32:35], v[132:135]
ds_read_b64_tr_b16 a[94:95], v31 offset:21000
v_mfma_f32_16x16x32_bf16 v[132:135], a[76:79], a[36:39], v[132:135]
v_mfma_f32_16x16x32_bf16 v[164:167], a[72:75], a[40:43], v[164:167]
v_mfma_f32_16x16x32_bf16 v[164:167], a[76:79], a[44:47], v[164:167]
s_add_u32 s46, s34, 8192
s_add_u32 m0, s69, 24576
v_mfma_f32_16x16x32_bf16 v[196:199], a[72:75], a[48:51], v[196:199]
ds_read_b64_tr_b16 a[64:65], v30 offset:24576
buffer_load_dwordx4 v96, s[12:15], s46 offen offset:0 nt lds
v_mfma_f32_16x16x32_bf16 v[196:199], a[76:79], a[52:55], v[196:199]
ds_read_b64_tr_b16 a[66:67], v30 offset:25088
ds_read_b64_tr_b16 a[68:69], v30 offset:28672
ds_read_b64_tr_b16 a[70:71], v30 offset:29184
s_waitcnt lgkmcnt(8)
v_mfma_f32_16x16x32_bf16 v[136:139], a[80:83], a[32:35], v[136:139]
v_mfma_f32_16x16x32_bf16 v[136:139], a[84:87], a[36:39], v[136:139]
buffer_load_dwordx4 v97, s[12:15], s46 offen offset:1024 nt lds
v_mfma_f32_16x16x32_bf16 v[168:171], a[80:83], a[40:43], v[168:171]
v_mfma_f32_16x16x32_bf16 v[168:171], a[84:87], a[44:47], v[168:171]
ds_read_b64_tr_b16 a[72:73], v30 offset:24584
v_mfma_f32_16x16x32_bf16 v[200:203], a[80:83], a[48:51], v[200:203]
ds_read_b64_tr_b16 a[74:75], v30 offset:25096
v_mfma_f32_16x16x32_bf16 v[200:203], a[84:87], a[52:55], v[200:203]
ds_read_b64_tr_b16 a[76:77], v30 offset:28680
s_add_u32 s46, s34, 16384
s_add_u32 m0, s69, 32768
ds_read_b64_tr_b16 a[78:79], v30 offset:29192
buffer_load_dwordx4 v96, s[12:15], s46 offen offset:0 nt lds
s_waitcnt lgkmcnt(8)
v_mfma_f32_16x16x32_bf16 v[140:143], a[88:91], a[32:35], v[140:143]
v_mfma_f32_16x16x32_bf16 v[140:143], a[92:95], a[36:39], v[140:143]
v_mfma_f32_16x16x32_bf16 v[172:175], a[88:91], a[40:43], v[172:175]
ds_read_b64_tr_b16 a[80:81], v31 offset:24576
v_mfma_f32_16x16x32_bf16 v[172:175], a[92:95], a[44:47], v[172:175]
ds_read_b64_tr_b16 a[82:83], v31 offset:25088
buffer_load_dwordx4 v97, s[12:15], s46 offen offset:1024 nt lds
v_mfma_f32_16x16x32_bf16 v[204:207], a[88:91], a[48:51], v[204:207]
ds_read_b64_tr_b16 a[84:85], v31 offset:28672
v_mfma_f32_16x16x32_bf16 v[204:207], a[92:95], a[52:55], v[204:207]
ds_read_b64_tr_b16 a[86:87], v31 offset:29184
s_waitcnt lgkmcnt(8)
s_add_u32 s46, s34, 24576
s_add_u32 m0, s69, 40960
v_mfma_f32_16x16x32_bf16 v[144:147], a[64:67], a[32:35], v[144:147]
buffer_load_dwordx4 v96, s[12:15], s46 offen offset:0 nt lds
v_mfma_f32_16x16x32_bf16 v[144:147], a[68:71], a[36:39], v[144:147]
ds_read_b64_tr_b16 a[88:89], v31 offset:24584
v_mfma_f32_16x16x32_bf16 v[176:179], a[64:67], a[40:43], v[176:179]
ds_read_b64_tr_b16 a[90:91], v31 offset:25096
v_mfma_f32_16x16x32_bf16 v[176:179], a[68:71], a[44:47], v[176:179]
ds_read_b64_tr_b16 a[92:93], v31 offset:28680
v_mfma_f32_16x16x32_bf16 v[208:211], a[64:67], a[48:51], v[208:211]
ds_read_b64_tr_b16 a[94:95], v31 offset:29192
v_mfma_f32_16x16x32_bf16 v[208:211], a[68:71], a[52:55], v[208:211]
buffer_load_dwordx4 v97, s[12:15], s46 offen offset:1024 nt lds
s_waitcnt lgkmcnt(8)
v_mfma_f32_16x16x32_bf16 v[148:151], a[72:75], a[32:35], v[148:151]
v_mfma_f32_16x16x32_bf16 v[148:151], a[76:79], a[36:39], v[148:151]
v_mfma_f32_16x16x32_bf16 v[180:183], a[72:75], a[40:43], v[180:183]
v_mfma_f32_16x16x32_bf16 v[180:183], a[76:79], a[44:47], v[180:183]
s_waitcnt vmcnt(22) lgkmcnt(0)
v_mfma_f32_16x16x32_bf16 v[212:215], a[72:75], a[48:51], v[212:215]
s_barrier
v_mfma_f32_16x16x32_bf16 v[212:215], a[76:79], a[52:55], v[212:215]
ds_read_b64_tr_b16 a[64:65], v30 offset:32768
ds_read_b64_tr_b16 a[66:67], v30 offset:33280
ds_read_b64_tr_b16 a[68:69], v30 offset:36864
v_mfma_f32_16x16x32_bf16 v[152:155], a[80:83], a[32:35], v[152:155]
ds_read_b64_tr_b16 a[70:71], v30 offset:37376
v_mfma_f32_16x16x32_bf16 v[152:155], a[84:87], a[36:39], v[152:155]
v_mfma_f32_16x16x32_bf16 v[184:187], a[80:83], a[40:43], v[184:187]
v_mfma_f32_16x16x32_bf16 v[184:187], a[84:87], a[44:47], v[184:187]
v_mfma_f32_16x16x32_bf16 v[216:219], a[80:83], a[48:51], v[216:219]
v_mfma_f32_16x16x32_bf16 v[216:219], a[84:87], a[52:55], v[216:219]
ds_read_b64_tr_b16 a[72:73], v30 offset:32776
ds_read_b64_tr_b16 a[74:75], v30 offset:33288
ds_read_b64_tr_b16 a[76:77], v30 offset:36872
v_mfma_f32_16x16x32_bf16 v[156:159], a[88:91], a[32:35], v[156:159]
ds_read_b64_tr_b16 a[78:79], v30 offset:37384
v_mfma_f32_16x16x32_bf16 v[156:159], a[92:95], a[36:39], v[156:159]
v_mfma_f32_16x16x32_bf16 v[188:191], a[88:91], a[40:43], v[188:191]
v_mfma_f32_16x16x32_bf16 v[188:191], a[92:95], a[44:47], v[188:191]
v_mfma_f32_16x16x32_bf16 v[220:223], a[88:91], a[48:51], v[220:223]
v_mfma_f32_16x16x32_bf16 v[220:223], a[92:95], a[52:55], v[220:223]
ds_read_b64_tr_b16 a[80:81], v31 offset:32768
ds_read_b64_tr_b16 a[82:83], v31 offset:33280
ds_read_b64_tr_b16 a[84:85], v31 offset:36864
s_waitcnt lgkmcnt(7)
v_mfma_f32_16x16x32_bf16 a[128:131], a[64:67], a[32:35], a[128:131]
ds_read_b64_tr_b16 a[86:87], v31 offset:37376
v_mfma_f32_16x16x32_bf16 a[128:131], a[68:71], a[36:39], a[128:131]
v_mfma_f32_16x16x32_bf16 a[160:163], a[64:67], a[40:43], a[160:163]
v_mfma_f32_16x16x32_bf16 a[160:163], a[68:71], a[44:47], a[160:163]
v_mfma_f32_16x16x32_bf16 a[192:195], a[64:67], a[48:51], a[192:195]
v_mfma_f32_16x16x32_bf16 a[192:195], a[68:71], a[52:55], a[192:195]
ds_read_b64_tr_b16 a[88:89], v31 offset:32776
ds_read_b64_tr_b16 a[90:91], v31 offset:33288
ds_read_b64_tr_b16 a[92:93], v31 offset:36872
s_waitcnt lgkmcnt(7)
v_mfma_f32_16x16x32_bf16 a[132:135], a[72:75], a[32:35], a[132:135]
ds_read_b64_tr_b16 a[94:95], v31 offset:37384
v_mfma_f32_16x16x32_bf16 a[132:135], a[76:79], a[36:39], a[132:135]
ds_read_b128 a[0:3], v18 offset:0
v_mfma_f32_16x16x32_bf16 a[164:167], a[72:75], a[40:43], a[164:167]
ds_read_b128 a[4:7], v19 offset:0
v_mfma_f32_16x16x32_bf16 a[164:167], a[76:79], a[44:47], a[164:167]
v_mfma_f32_16x16x32_bf16 a[196:199], a[72:75], a[48:51], a[196:199]
ds_read_b64_tr_b16 a[64:65], v30 offset:40960
v_mfma_f32_16x16x32_bf16 a[196:199], a[76:79], a[52:55], a[196:199]
ds_read_b64_tr_b16 a[66:67], v30 offset:41472
ds_read_b64_tr_b16 a[68:69], v30 offset:45056
ds_read_b64_tr_b16 a[70:71], v30 offset:45568
s_waitcnt lgkmcnt(10)
v_mfma_f32_16x16x32_bf16 a[136:139], a[80:83], a[32:35], a[136:139]
ds_read_b128 a[8:11], v18 offset:2048
v_mfma_f32_16x16x32_bf16 a[136:139], a[84:87], a[36:39], a[136:139]
ds_read_b128 a[12:15], v19 offset:2048
v_mfma_f32_16x16x32_bf16 a[168:171], a[80:83], a[40:43], a[168:171]
v_mfma_f32_16x16x32_bf16 a[168:171], a[84:87], a[44:47], a[168:171]
ds_read_b64_tr_b16 a[72:73], v30 offset:40968
v_mfma_f32_16x16x32_bf16 a[200:203], a[80:83], a[48:51], a[200:203]
ds_read_b64_tr_b16 a[74:75], v30 offset:41480
v_mfma_f32_16x16x32_bf16 a[200:203], a[84:87], a[52:55], a[200:203]
ds_read_b64_tr_b16 a[76:77], v30 offset:45064
ds_read_b64_tr_b16 a[78:79], v30 offset:45576
ds_read_b128 a[16:19], v18 offset:4096
s_waitcnt lgkmcnt(13)
v_mfma_f32_16x16x32_bf16 a[140:143], a[88:91], a[32:35], a[140:143]
ds_read_b128 a[20:23], v19 offset:4096
v_mfma_f32_16x16x32_bf16 a[140:143], a[92:95], a[36:39], a[140:143]
v_mfma_f32_16x16x32_bf16 a[172:175], a[88:91], a[40:43], a[172:175]
ds_read_b64_tr_b16 a[80:81], v31 offset:40960
v_mfma_f32_16x16x32_bf16 a[172:175], a[92:95], a[44:47], a[172:175]
ds_read_b64_tr_b16 a[82:83], v31 offset:41472
v_mfma_f32_16x16x32_bf16 a[204:207], a[88:91], a[48:51], a[204:207]
ds_read_b64_tr_b16 a[84:85], v31 offset:45056
v_mfma_f32_16x16x32_bf16 a[204:207], a[92:95], a[52:55], a[204:207]
ds_read_b64_tr_b16 a[86:87], v31 offset:45568
s_waitcnt lgkmcnt(12)
v_mfma_f32_16x16x32_bf16 a[144:147], a[64:67], a[32:35], a[144:147]
v_mfma_f32_16x16x32_bf16 a[144:147], a[68:71], a[36:39], a[144:147]
ds_read_b64_tr_b16 a[88:89], v31 offset:40968
v_mfma_f32_16x16x32_bf16 a[176:179], a[64:67], a[40:43], a[176:179]
ds_read_b64_tr_b16 a[90:91], v31 offset:41480
v_mfma_f32_16x16x32_bf16 a[176:179], a[68:71], a[44:47], a[176:179]
ds_read_b64_tr_b16 a[92:93], v31 offset:45064
v_mfma_f32_16x16x32_bf16 a[208:211], a[64:67], a[48:51], a[208:211]
ds_read_b64_tr_b16 a[94:95], v31 offset:45576
v_mfma_f32_16x16x32_bf16 a[208:211], a[68:71], a[52:55], a[208:211]
s_waitcnt lgkmcnt(10)
v_mfma_f32_16x16x32_bf16 a[148:151], a[72:75], a[32:35], a[148:151]
v_mfma_f32_16x16x32_bf16 a[148:151], a[76:79], a[36:39], a[148:151]
v_mfma_f32_16x16x32_bf16 a[180:183], a[72:75], a[40:43], a[180:183]
v_mfma_f32_16x16x32_bf16 a[180:183], a[76:79], a[44:47], a[180:183]
s_waitcnt vmcnt(15) lgkmcnt(0)
v_mfma_f32_16x16x32_bf16 a[212:215], a[72:75], a[48:51], a[212:215]
s_barrier
v_mfma_f32_16x16x32_bf16 a[212:215], a[76:79], a[52:55], a[212:215]
ds_read_b64_tr_b16 a[64:65], v28 offset:0
ds_read_b64_tr_b16 a[66:67], v28 offset:512
ds_read_b64_tr_b16 a[68:69], v28 offset:4096
v_mfma_f32_16x16x32_bf16 a[152:155], a[80:83], a[32:35], a[152:155]
ds_read_b64_tr_b16 a[70:71], v28 offset:4608
v_mfma_f32_16x16x32_bf16 a[152:155], a[84:87], a[36:39], a[152:155]
v_mfma_f32_16x16x32_bf16 a[184:187], a[80:83], a[40:43], a[184:187]
v_mfma_f32_16x16x32_bf16 a[184:187], a[84:87], a[44:47], a[184:187]
v_mfma_f32_16x16x32_bf16 a[216:219], a[80:83], a[48:51], a[216:219]
v_mfma_f32_16x16x32_bf16 a[216:219], a[84:87], a[52:55], a[216:219]
ds_read_b64_tr_b16 a[72:73], v28 offset:8
ds_read_b64_tr_b16 a[74:75], v28 offset:520
ds_read_b64_tr_b16 a[76:77], v28 offset:4104
v_mfma_f32_16x16x32_bf16 a[156:159], a[88:91], a[32:35], a[156:159]
ds_read_b64_tr_b16 a[78:79], v28 offset:4616
v_mfma_f32_16x16x32_bf16 a[156:159], a[92:95], a[36:39], a[156:159]
v_mfma_f32_16x16x32_bf16 a[188:191], a[88:91], a[40:43], a[188:191]
v_mfma_f32_16x16x32_bf16 a[188:191], a[92:95], a[44:47], a[188:191]
v_mfma_f32_16x16x32_bf16 a[220:223], a[88:91], a[48:51], a[220:223]
v_mfma_f32_16x16x32_bf16 a[220:223], a[92:95], a[52:55], a[220:223]
ds_read_b64_tr_b16 a[80:81], v29 offset:0
ds_read_b64_tr_b16 a[82:83], v29 offset:512
ds_read_b64_tr_b16 a[84:85], v29 offset:4096
s_waitcnt lgkmcnt(7)
v_mfma_f32_16x16x32_bf16 v[128:131], a[64:67], a[0:3], v[128:131]
ds_read_b64_tr_b16 a[86:87], v29 offset:4608
v_mfma_f32_16x16x32_bf16 v[128:131], a[68:71], a[4:7], v[128:131]
s_add_u32 s46, s34, 0
s_add_u32 m0, s69, 81920
v_mfma_f32_16x16x32_bf16 v[160:163], a[64:67], a[8:11], v[160:163]
buffer_load_dwordx4 v98, s[16:19], s46 offen offset:0 nt lds
v_mfma_f32_16x16x32_bf16 v[160:163], a[68:71], a[12:15], v[160:163]
v_mfma_f32_16x16x32_bf16 v[192:195], a[64:67], a[16:19], v[192:195]
v_mfma_f32_16x16x32_bf16 v[192:195], a[68:71], a[20:23], v[192:195]
ds_read_b64_tr_b16 a[88:89], v29 offset:8
ds_read_b64_tr_b16 a[90:91], v29 offset:520
ds_read_b64_tr_b16 a[92:93], v29 offset:4104
s_waitcnt lgkmcnt(7)
buffer_load_dwordx4 v99, s[16:19], s46 offen offset:1024 nt lds
v_mfma_f32_16x16x32_bf16 v[132:135], a[72:75], a[0:3], v[132:135]
ds_read_b64_tr_b16 a[94:95], v29 offset:4616
v_mfma_f32_16x16x32_bf16 v[132:135], a[76:79], a[4:7], v[132:135]
v_mfma_f32_16x16x32_bf16 v[164:167], a[72:75], a[8:11], v[164:167]
v_mfma_f32_16x16x32_bf16 v[164:167], a[76:79], a[12:15], v[164:167]
s_add_u32 s46, s34, 8192
s_add_u32 m0, s69, 90112
v_mfma_f32_16x16x32_bf16 v[196:199], a[72:75], a[16:19], v[196:199]
ds_read_b64_tr_b16 a[64:65], v28 offset:8192
buffer_load_dwordx4 v98, s[16:19], s46 offen offset:0 nt lds
v_mfma_f32_16x16x32_bf16 v[196:199], a[76:79], a[20:23], v[196:199]
ds_read_b64_tr_b16 a[66:67], v28 offset:8704
ds_read_b64_tr_b16 a[68:69], v28 offset:12288
ds_read_b64_tr_b16 a[70:71], v28 offset:12800
s_waitcnt lgkmcnt(8)
v_mfma_f32_16x16x32_bf16 v[136:139], a[80:83], a[0:3], v[136:139]
v_mfma_f32_16x16x32_bf16 v[136:139], a[84:87], a[4:7], v[136:139]
buffer_load_dwordx4 v99, s[16:19], s46 offen offset:1024 nt lds
v_mfma_f32_16x16x32_bf16 v[168:171], a[80:83], a[8:11], v[168:171]
v_mfma_f32_16x16x32_bf16 v[168:171], a[84:87], a[12:15], v[168:171]
ds_read_b64_tr_b16 a[72:73], v28 offset:8200
v_mfma_f32_16x16x32_bf16 v[200:203], a[80:83], a[16:19], v[200:203]
ds_read_b64_tr_b16 a[74:75], v28 offset:8712
v_mul_f32 v128, s44, v128
v_mul_f32 v129, s44, v129
v_mfma_f32_16x16x32_bf16 v[200:203], a[84:87], a[20:23], v[200:203]
ds_read_b64_tr_b16 a[76:77], v28 offset:12296
s_add_u32 s46, s34, 16384
s_add_u32 m0, s69, 98304
v_mul_f32 v130, s44, v130
v_mul_f32 v131, s44, v131
ds_read_b64_tr_b16 a[78:79], v28 offset:12808
buffer_load_dwordx4 v98, s[16:19], s46 offen offset:0 nt lds
s_waitcnt lgkmcnt(8)
v_mfma_f32_16x16x32_bf16 v[140:143], a[88:91], a[0:3], v[140:143]
v_mul_f32 v132, s44, v132
v_mul_f32 v133, s44, v133
v_mfma_f32_16x16x32_bf16 v[140:143], a[92:95], a[4:7], v[140:143]
v_mul_f32 v134, s44, v134
v_mul_f32 v135, s44, v135
v_mfma_f32_16x16x32_bf16 v[172:175], a[88:91], a[8:11], v[172:175]
ds_read_b64_tr_b16 a[80:81], v29 offset:8192
v_cvt_pk_bf16_f32 v128, v128, v129
v_cvt_pk_bf16_f32 v130, v130, v131
v_mfma_f32_16x16x32_bf16 v[172:175], a[92:95], a[12:15], v[172:175]
ds_read_b64_tr_b16 a[82:83], v29 offset:8704
buffer_load_dwordx4 v99, s[16:19], s46 offen offset:1024 nt lds
v_cvt_pk_bf16_f32 v132, v132, v133
v_cvt_pk_bf16_f32 v134, v134, v135
v_mfma_f32_16x16x32_bf16 v[204:207], a[88:91], a[16:19], v[204:207]
ds_read_b64_tr_b16 a[84:85], v29 offset:12288
v_accvgpr_write_b32 a32, v128
v_accvgpr_write_b32 a33, v130
v_mfma_f32_16x16x32_bf16 v[204:207], a[92:95], a[20:23], v[204:207]
ds_read_b64_tr_b16 a[86:87], v29 offset:12800
v_accvgpr_write_b32 a34, v132
v_accvgpr_write_b32 a35, v134
s_waitcnt lgkmcnt(8)
s_add_u32 s46, s34, 24576
s_add_u32 m0, s69, 106496
v_mfma_f32_16x16x32_bf16 v[144:147], a[64:67], a[0:3], v[144:147]
buffer_load_dwordx4 v98, s[16:19], s46 offen offset:0 nt lds
v_mul_f32 v160, s44, v160
v_mul_f32 v161, s44, v161
v_mfma_f32_16x16x32_bf16 v[144:147], a[68:71], a[4:7], v[144:147]
ds_read_b64_tr_b16 a[88:89], v29 offset:8200
v_mul_f32 v162, s44, v162
v_mul_f32 v163, s44, v163
v_mfma_f32_16x16x32_bf16 v[176:179], a[64:67], a[8:11], v[176:179]
ds_read_b64_tr_b16 a[90:91], v29 offset:8712
v_mul_f32 v164, s44, v164
v_mul_f32 v165, s44, v165
v_mfma_f32_16x16x32_bf16 v[176:179], a[68:71], a[12:15], v[176:179]
ds_read_b64_tr_b16 a[92:93], v29 offset:12296
v_mul_f32 v166, s44, v166
v_mul_f32 v167, s44, v167
v_mfma_f32_16x16x32_bf16 v[208:211], a[64:67], a[16:19], v[208:211]
ds_read_b64_tr_b16 a[94:95], v29 offset:12808
v_cvt_pk_bf16_f32 v160, v160, v161
v_cvt_pk_bf16_f32 v162, v162, v163
v_mfma_f32_16x16x32_bf16 v[208:211], a[68:71], a[20:23], v[208:211]
buffer_load_dwordx4 v99, s[16:19], s46 offen offset:1024 nt lds
v_cvt_pk_bf16_f32 v164, v164, v165
v_cvt_pk_bf16_f32 v166, v166, v167
s_add_u32 s34, s34, 32768
s_waitcnt lgkmcnt(8)
v_mfma_f32_16x16x32_bf16 v[148:151], a[72:75], a[0:3], v[148:151]
v_accvgpr_write_b32 a48, v160
v_accvgpr_write_b32 a49, v162
v_mfma_f32_16x16x32_bf16 v[148:151], a[76:79], a[4:7], v[148:151]
v_accvgpr_write_b32 a50, v164
v_accvgpr_write_b32 a51, v166
v_mfma_f32_16x16x32_bf16 v[180:183], a[72:75], a[8:11], v[180:183]
v_mul_f32 v192, s44, v192
v_mul_f32 v193, s44, v193
v_mfma_f32_16x16x32_bf16 v[180:183], a[76:79], a[12:15], v[180:183]
s_waitcnt vmcnt(16) lgkmcnt(0)
v_mul_f32 v194, s44, v194
v_mul_f32 v195, s44, v195
v_mfma_f32_16x16x32_bf16 v[212:215], a[72:75], a[16:19], v[212:215]
s_barrier
v_mul_f32 v196, s44, v196
v_mul_f32 v197, s44, v197
v_mfma_f32_16x16x32_bf16 v[212:215], a[76:79], a[20:23], v[212:215]
ds_read_b64_tr_b16 a[64:65], v30 offset:0
v_mul_f32 v198, s44, v198
v_mul_f32 v199, s44, v199
ds_read_b64_tr_b16 a[66:67], v30 offset:512
ds_read_b64_tr_b16 a[68:69], v30 offset:4096
v_mfma_f32_16x16x32_bf16 v[152:155], a[80:83], a[0:3], v[152:155]
ds_read_b64_tr_b16 a[70:71], v30 offset:4608
v_cvt_pk_bf16_f32 v192, v192, v193
v_cvt_pk_bf16_f32 v194, v194, v195
v_mfma_f32_16x16x32_bf16 v[152:155], a[84:87], a[4:7], v[152:155]
v_cvt_pk_bf16_f32 v196, v196, v197
v_cvt_pk_bf16_f32 v198, v198, v199
v_mfma_f32_16x16x32_bf16 v[184:187], a[80:83], a[8:11], v[184:187]
v_accvgpr_write_b32 a96, v192
v_accvgpr_write_b32 a97, v194
v_mfma_f32_16x16x32_bf16 v[184:187], a[84:87], a[12:15], v[184:187]
v_accvgpr_write_b32 a98, v196
v_accvgpr_write_b32 a99, v198
v_mfma_f32_16x16x32_bf16 v[216:219], a[80:83], a[16:19], v[216:219]
v_mul_f32 v136, s44, v136
v_mul_f32 v137, s44, v137
v_mfma_f32_16x16x32_bf16 v[216:219], a[84:87], a[20:23], v[216:219]
ds_read_b64_tr_b16 a[72:73], v30 offset:8
v_mul_f32 v138, s44, v138
v_mul_f32 v139, s44, v139
ds_read_b64_tr_b16 a[74:75], v30 offset:520
ds_read_b64_tr_b16 a[76:77], v30 offset:4104
v_mfma_f32_16x16x32_bf16 v[156:159], a[88:91], a[0:3], v[156:159]
ds_read_b64_tr_b16 a[78:79], v30 offset:4616
v_mul_f32 v140, s44, v140
v_mul_f32 v141, s44, v141
v_mfma_f32_16x16x32_bf16 v[156:159], a[92:95], a[4:7], v[156:159]
v_mul_f32 v142, s44, v142
v_mul_f32 v143, s44, v143
v_mfma_f32_16x16x32_bf16 v[188:191], a[88:91], a[8:11], v[188:191]
v_cvt_pk_bf16_f32 v136, v136, v137
v_cvt_pk_bf16_f32 v138, v138, v139
v_mfma_f32_16x16x32_bf16 v[188:191], a[92:95], a[12:15], v[188:191]
v_cvt_pk_bf16_f32 v140, v140, v141
v_cvt_pk_bf16_f32 v142, v142, v143
v_mfma_f32_16x16x32_bf16 v[220:223], a[88:91], a[16:19], v[220:223]
v_accvgpr_write_b32 a36, v136
v_accvgpr_write_b32 a37, v138
v_mfma_f32_16x16x32_bf16 v[220:223], a[92:95], a[20:23], v[220:223]
ds_read_b64_tr_b16 a[80:81], v31 offset:0
v_accvgpr_write_b32 a38, v140
v_accvgpr_write_b32 a39, v142
ds_read_b64_tr_b16 a[82:83], v31 offset:512
ds_read_b64_tr_b16 a[84:85], v31 offset:4096
s_waitcnt lgkmcnt(7)
v_mfma_f32_16x16x32_bf16 a[128:131], a[64:67], a[0:3], a[128:131]
ds_read_b64_tr_b16 a[86:87], v31 offset:4608
v_mul_f32 v168, s44, v168
v_mul_f32 v169, s44, v169
v_mfma_f32_16x16x32_bf16 a[128:131], a[68:71], a[4:7], a[128:131]
v_mul_f32 v170, s44, v170
v_mul_f32 v171, s44, v171
v_mfma_f32_16x16x32_bf16 a[160:163], a[64:67], a[8:11], a[160:163]
v_mul_f32 v172, s44, v172
v_mul_f32 v173, s44, v173
v_mfma_f32_16x16x32_bf16 a[160:163], a[68:71], a[12:15], a[160:163]
s_add_u32 m0, s69, 49152
v_mul_f32 v174, s44, v174
v_mul_f32 v175, s44, v175
v_mfma_f32_16x16x32_bf16 a[192:195], a[64:67], a[16:19], a[192:195]
buffer_load_dwordx4 v96, s[12:15], s34 offen offset:0 nt lds
v_cvt_pk_bf16_f32 v168, v168, v169
v_cvt_pk_bf16_f32 v170, v170, v171
v_mfma_f32_16x16x32_bf16 a[192:195], a[68:71], a[20:23], a[192:195]
ds_read_b64_tr_b16 a[88:89], v31 offset:8
v_cvt_pk_bf16_f32 v172, v172, v173
v_cvt_pk_bf16_f32 v174, v174, v175
ds_read_b64_tr_b16 a[90:91], v31 offset:520
ds_read_b64_tr_b16 a[92:93], v31 offset:4104
s_waitcnt lgkmcnt(7)
v_mfma_f32_16x16x32_bf16 a[132:135], a[72:75], a[0:3], a[132:135]
ds_read_b64_tr_b16 a[94:95], v31 offset:4616
v_accvgpr_write_b32 a52, v168
v_accvgpr_write_b32 a53, v170
v_mfma_f32_16x16x32_bf16 a[132:135], a[76:79], a[4:7], a[132:135]
v_accvgpr_write_b32 a54, v172
v_accvgpr_write_b32 a55, v174
v_mfma_f32_16x16x32_bf16 a[164:167], a[72:75], a[8:11], a[164:167]
v_mul_f32 v200, s44, v200
v_mul_f32 v201, s44, v201
v_mfma_f32_16x16x32_bf16 a[164:167], a[76:79], a[12:15], a[164:167]
v_mul_f32 v202, s44, v202
v_mul_f32 v203, s44, v203
v_mfma_f32_16x16x32_bf16 a[196:199], a[72:75], a[16:19], a[196:199]
ds_read_b64_tr_b16 a[64:65], v30 offset:8192
v_mul_f32 v204, s44, v204
v_mul_f32 v205, s44, v205
v_mfma_f32_16x16x32_bf16 a[196:199], a[76:79], a[20:23], a[196:199]
ds_read_b64_tr_b16 a[66:67], v30 offset:8704
buffer_load_dwordx4 v97, s[12:15], s34 offen offset:1024 nt lds
v_mul_f32 v206, s44, v206
v_mul_f32 v207, s44, v207
ds_read_b64_tr_b16 a[68:69], v30 offset:12288
ds_read_b64_tr_b16 a[70:71], v30 offset:12800
s_waitcnt lgkmcnt(8)
v_mfma_f32_16x16x32_bf16 a[136:139], a[80:83], a[0:3], a[136:139]
v_cvt_pk_bf16_f32 v200, v200, v201
v_cvt_pk_bf16_f32 v202, v202, v203
v_mfma_f32_16x16x32_bf16 a[136:139], a[84:87], a[4:7], a[136:139]
v_cvt_pk_bf16_f32 v204, v204, v205
v_cvt_pk_bf16_f32 v206, v206, v207
v_mfma_f32_16x16x32_bf16 a[168:171], a[80:83], a[8:11], a[168:171]
v_accvgpr_write_b32 a100, v200
v_accvgpr_write_b32 a101, v202
v_mfma_f32_16x16x32_bf16 a[168:171], a[84:87], a[12:15], a[168:171]
ds_read_b64_tr_b16 a[72:73], v30 offset:8200
v_accvgpr_write_b32 a102, v204
v_accvgpr_write_b32 a103, v206
v_mfma_f32_16x16x32_bf16 a[200:203], a[80:83], a[16:19], a[200:203]
ds_read_b64_tr_b16 a[74:75], v30 offset:8712
v_mul_f32 v144, s44, v144
v_mul_f32 v145, s44, v145
v_mfma_f32_16x16x32_bf16 a[200:203], a[84:87], a[20:23], a[200:203]
ds_read_b64_tr_b16 a[76:77], v30 offset:12296
s_add_u32 s46, s34, 8192
s_add_u32 m0, s69, 57344
v_mul_f32 v146, s44, v146
v_mul_f32 v147, s44, v147
ds_read_b64_tr_b16 a[78:79], v30 offset:12808
buffer_load_dwordx4 v96, s[12:15], s46 offen offset:0 nt lds
s_waitcnt lgkmcnt(8)
v_mfma_f32_16x16x32_bf16 a[140:143], a[88:91], a[0:3], a[140:143]
v_mul_f32 v148, s44, v148
v_mul_f32 v149, s44, v149
v_mfma_f32_16x16x32_bf16 a[140:143], a[92:95], a[4:7], a[140:143]
v_mul_f32 v150, s44, v150
v_mul_f32 v151, s44, v151
v_mfma_f32_16x16x32_bf16 a[172:175], a[88:91], a[8:11], a[172:175]
ds_read_b64_tr_b16 a[80:81], v31 offset:8192
v_cvt_pk_bf16_f32 v144, v144, v145
v_cvt_pk_bf16_f32 v146, v146, v147
v_mfma_f32_16x16x32_bf16 a[172:175], a[92:95], a[12:15], a[172:175]
ds_read_b64_tr_b16 a[82:83], v31 offset:8704
v_cvt_pk_bf16_f32 v148, v148, v149
v_cvt_pk_bf16_f32 v150, v150, v151
v_mfma_f32_16x16x32_bf16 a[204:207], a[88:91], a[16:19], a[204:207]
ds_read_b64_tr_b16 a[84:85], v31 offset:12288
v_accvgpr_write_b32 a40, v144
v_accvgpr_write_b32 a41, v146
v_mfma_f32_16x16x32_bf16 a[204:207], a[92:95], a[20:23], a[204:207]
ds_read_b64_tr_b16 a[86:87], v31 offset:12800
v_accvgpr_write_b32 a42, v148
v_accvgpr_write_b32 a43, v150
s_waitcnt lgkmcnt(8)
buffer_load_dwordx4 v97, s[12:15], s46 offen offset:1024 nt lds
v_mfma_f32_16x16x32_bf16 a[144:147], a[64:67], a[0:3], a[144:147]
v_mul_f32 v176, s44, v176
v_mul_f32 v177, s44, v177
v_mfma_f32_16x16x32_bf16 a[144:147], a[68:71], a[4:7], a[144:147]
ds_read_b64_tr_b16 a[88:89], v31 offset:8200
v_mul_f32 v178, s44, v178
v_mul_f32 v179, s44, v179
v_mfma_f32_16x16x32_bf16 a[176:179], a[64:67], a[8:11], a[176:179]
ds_read_b64_tr_b16 a[90:91], v31 offset:8712
v_mul_f32 v180, s44, v180
v_mul_f32 v181, s44, v181
v_mfma_f32_16x16x32_bf16 a[176:179], a[68:71], a[12:15], a[176:179]
ds_read_b64_tr_b16 a[92:93], v31 offset:12296
v_mul_f32 v182, s44, v182
v_mul_f32 v183, s44, v183
v_mfma_f32_16x16x32_bf16 a[208:211], a[64:67], a[16:19], a[208:211]
ds_read_b64_tr_b16 a[94:95], v31 offset:12808
s_mov_b32 s39, 0
v_mov_b32 v101, 138272
v_mov_b32 v80, 0
v_cvt_pk_bf16_f32 v176, v176, v177
v_cvt_pk_bf16_f32 v178, v178, v179
v_mfma_f32_16x16x32_bf16 a[208:211], a[68:71], a[20:23], a[208:211]
v_lshl_add_u32 v1, s32, 2, v101
v_cvt_pk_bf16_f32 v180, v180, v181
v_cvt_pk_bf16_f32 v182, v182, v183
s_waitcnt lgkmcnt(8)
ds_write_b32 v1, v80
v_mfma_f32_16x16x32_bf16 a[148:151], a[72:75], a[0:3], a[148:151]
v_accvgpr_write_b32 a56, v176
v_accvgpr_write_b32 a57, v178
v_mfma_f32_16x16x32_bf16 a[148:151], a[76:79], a[4:7], a[148:151]
v_accvgpr_write_b32 a58, v180
v_accvgpr_write_b32 a59, v182
v_mfma_f32_16x16x32_bf16 a[180:183], a[72:75], a[8:11], a[180:183]
v_mul_f32 v208, s44, v208
v_mul_f32 v209, s44, v209
v_mfma_f32_16x16x32_bf16 a[180:183], a[76:79], a[12:15], a[180:183]
s_waitcnt vmcnt(25) lgkmcnt(0)
v_mul_f32 v210, s44, v210
v_mul_f32 v211, s44, v211
v_mfma_f32_16x16x32_bf16 a[212:215], a[72:75], a[16:19], a[212:215]
s_barrier
v_mul_f32 v212, s44, v212
v_mul_f32 v213, s44, v213
v_mfma_f32_16x16x32_bf16 a[212:215], a[76:79], a[20:23], a[212:215]
v_mul_f32 v214, s44, v214
v_mul_f32 v215, s44, v215
s_add_u32 m0, s69, 114688
s_nop 0
buffer_load_dwordx4 v98, s[16:19], s34 offen offset:0 nt lds
v_mfma_f32_16x16x32_bf16 a[152:155], a[80:83], a[0:3], a[152:155]
v_cvt_pk_bf16_f32 v208, v208, v209
v_cvt_pk_bf16_f32 v210, v210, v211
v_mfma_f32_16x16x32_bf16 a[152:155], a[84:87], a[4:7], a[152:155]
v_cvt_pk_bf16_f32 v212, v212, v213
v_cvt_pk_bf16_f32 v214, v214, v215
v_mfma_f32_16x16x32_bf16 a[184:187], a[80:83], a[8:11], a[184:187]
v_accvgpr_write_b32 a104, v208
v_accvgpr_write_b32 a105, v210
v_mfma_f32_16x16x32_bf16 a[184:187], a[84:87], a[12:15], a[184:187]
buffer_load_dwordx4 v99, s[16:19], s34 offen offset:1024 nt lds
v_accvgpr_write_b32 a106, v212
v_accvgpr_write_b32 a107, v214
v_mfma_f32_16x16x32_bf16 a[216:219], a[80:83], a[16:19], a[216:219]
v_mul_f32 v152, s44, v152
v_mul_f32 v153, s44, v153
v_mfma_f32_16x16x32_bf16 a[216:219], a[84:87], a[20:23], a[216:219]
v_mul_f32 v154, s44, v154
v_mul_f32 v155, s44, v155
s_add_u32 m0, s69, 122880
s_nop 0
buffer_load_dwordx4 v98, s[16:19], s46 offen offset:0 nt lds
v_mfma_f32_16x16x32_bf16 a[156:159], a[88:91], a[0:3], a[156:159]
v_mul_f32 v156, s44, v156
v_mul_f32 v157, s44, v157
v_mfma_f32_16x16x32_bf16 a[156:159], a[92:95], a[4:7], a[156:159]
v_mul_f32 v158, s44, v158
v_mul_f32 v159, s44, v159
v_mfma_f32_16x16x32_bf16 a[188:191], a[88:91], a[8:11], a[188:191]
v_cvt_pk_bf16_f32 v152, v152, v153
v_cvt_pk_bf16_f32 v154, v154, v155
v_mfma_f32_16x16x32_bf16 a[188:191], a[92:95], a[12:15], a[188:191]
buffer_load_dwordx4 v99, s[16:19], s46 offen offset:1024 nt lds
v_cvt_pk_bf16_f32 v156, v156, v157
v_cvt_pk_bf16_f32 v158, v158, v159
v_mfma_f32_16x16x32_bf16 a[220:223], a[88:91], a[16:19], a[220:223]
s_add_u32 s34, s34, 16384
v_accvgpr_write_b32 a44, v152
v_accvgpr_write_b32 a45, v154
v_mfma_f32_16x16x32_bf16 a[220:223], a[92:95], a[20:23], a[220:223]
v_accvgpr_write_b32 a46, v156
v_accvgpr_write_b32 a47, v158
ds_read_b128 a[0:3], v84 offset:0
ds_read_b128 a[4:7], v85 offset:0
ds_read_b128 a[8:11], v86 offset:0
ds_read_b128 a[12:15], v87 offset:0
ds_read_b128 a[16:19], v84 offset:4096
ds_read_b128 a[20:23], v85 offset:4096
ds_read_b128 a[24:27], v86 offset:4096
ds_read_b128 a[28:31], v87 offset:4096
v_mul_f32 v184, s44, v184
v_mul_f32 v185, s44, v185
v_mul_f32 v186, s44, v186
v_mul_f32 v187, s44, v187
v_mul_f32 v188, s44, v188
v_mul_f32 v189, s44, v189
v_mul_f32 v190, s44, v190
v_mul_f32 v191, s44, v191
v_cvt_pk_bf16_f32 v184, v184, v185
v_cvt_pk_bf16_f32 v186, v186, v187
v_cvt_pk_bf16_f32 v188, v188, v189
v_cvt_pk_bf16_f32 v190, v190, v191
v_accvgpr_write_b32 a60, v184
v_accvgpr_write_b32 a61, v186
v_accvgpr_write_b32 a62, v188
v_accvgpr_write_b32 a63, v190
v_mul_f32 v216, s44, v216
v_mul_f32 v217, s44, v217
v_mul_f32 v218, s44, v218
v_mul_f32 v219, s44, v219
v_mul_f32 v220, s44, v220
v_mul_f32 v221, s44, v221
v_mul_f32 v222, s44, v222
v_mul_f32 v223, s44, v223
v_cvt_pk_bf16_f32 v216, v216, v217
v_cvt_pk_bf16_f32 v218, v218, v219
v_cvt_pk_bf16_f32 v220, v220, v221
v_cvt_pk_bf16_f32 v222, v222, v223
v_accvgpr_write_b32 a108, v216
v_accvgpr_write_b32 a109, v218
v_accvgpr_write_b32 a110, v220
v_accvgpr_write_b32 a111, v222
v_and_b32 v4, 3, v0
v_mov_b32 v5, 0x3f803f80
v_cmp_eq_u32 vcc, 0, v4
s_nop 1
v_cndmask_b32 v124, 0, v5, vcc
v_cndmask_b32 v125, 0, v5, vcc
v_cndmask_b32 v126, 0, v5, vcc
v_cndmask_b32 v127, 0, v5, vcc
s_waitcnt lgkmcnt(0)
v_mov_b32 v192, v32
v_mov_b32 v193, v33
v_mov_b32 v194, v34
v_mov_b32 v195, v35
v_mov_b32 v196, v36
v_mov_b32 v197, v37
v_mov_b32 v198, v38
v_mov_b32 v199, v39
v_mfma_f32_16x16x32_bf16 v[16:19], a[0:3], a[32:35], 0
v_mov_b32 v200, v40
v_mov_b32 v201, v41
v_mov_b32 v202, v42
v_mov_b32 v203, v43
v_mfma_f32_16x16x32_bf16 v[16:19], a[4:7], a[36:39], v[16:19]
v_mov_b32 v204, v44
v_mov_b32 v205, v45
v_mov_b32 v206, v46
v_mov_b32 v207, v47
v_mfma_f32_16x16x32_bf16 v[16:19], a[8:11], a[40:43], v[16:19]
v_mov_b32 v208, v48
v_mov_b32 v209, v49
v_mov_b32 v210, v50
v_mov_b32 v211, v51
v_mfma_f32_16x16x32_bf16 v[16:19], a[12:15], a[44:47], v[16:19]
v_mov_b32 v212, v52
v_mov_b32 v213, v53
v_mov_b32 v214, v54
v_mov_b32 v215, v55
v_mfma_f32_16x16x32_bf16 v[24:27], a[0:3], a[48:51], 0
v_mov_b32 v216, v56
v_mov_b32 v217, v57
v_mov_b32 v218, v58
v_mov_b32 v219, v59
v_mfma_f32_16x16x32_bf16 v[24:27], a[4:7], a[52:55], v[24:27]
v_mov_b32 v220, v60
v_mov_b32 v221, v61
v_mov_b32 v222, v62
v_mov_b32 v223, v63
v_mfma_f32_16x16x32_bf16 v[24:27], a[8:11], a[56:59], v[24:27]
v_mov_b32 v224, v64
v_mov_b32 v225, v65
v_mov_b32 v226, v66
v_mov_b32 v227, v67
v_mfma_f32_16x16x32_bf16 v[24:27], a[12:15], a[60:63], v[24:27]
v_mfma_f32_16x16x32_bf16 v[32:35], a[0:3], a[96:99], 0
v_mfma_f32_16x16x32_bf16 v[32:35], a[4:7], a[100:103], v[32:35]
v_mfma_f32_16x16x32_bf16 v[32:35], a[8:11], a[104:107], v[32:35]
v_mfma_f32_16x16x32_bf16 v[32:35], a[12:15], a[108:111], v[32:35]
v_max3_f32 v16, v16, v17, v18
s_nop 2
v_max3_f32 v24, v24, v25, v26
s_nop 2
v_max3_f32 v32, v32, v33, v34
v_max_f32 v16, v16, v19
v_max_f32 v24, v24, v27
v_max_f32 v32, v32, v35
v_mov_b32 v108, v16
v_mov_b32 v109, v24
v_mov_b32 v110, v32
v_permlane32_swap_b32 v16, v108
v_permlane32_swap_b32 v24, v109
v_permlane32_swap_b32 v32, v110
v_max_f32 v16, v16, v108
v_max_f32 v24, v24, v109
v_max_f32 v32, v32, v110
v_mov_b32 v108, v16
v_mov_b32 v109, v24
v_mov_b32 v110, v32
v_permlane16_swap_b32 v16, v108
v_permlane16_swap_b32 v24, v109
v_permlane16_swap_b32 v32, v110
v_max_f32 v16, v16, v108
v_max_f32 v24, v24, v109
v_max_f32 v32, v32, v110
v_sub_f32 v64, 0, v16
v_sub_f32 v65, 0, v16
v_sub_f32 v66, 0, v16
v_sub_f32 v67, 0, v16
v_sub_f32 v68, 0, v24
v_sub_f32 v69, 0, v24
v_sub_f32 v70, 0, v24
v_sub_f32 v71, 0, v24
v_sub_f32 v72, 0, v32
v_sub_f32 v73, 0, v32
v_sub_f32 v74, 0, v32
v_sub_f32 v75, 0, v32
v_subrev_u32 v232, 6144, v96
v_subrev_u32 v233, 6144, v97
v_xor_b32 v234, 128, v232
v_xor_b32 v235, 128, v233
v_subrev_u32 v236, 6144, v98
v_subrev_u32 v237, 6144, v99
s_cmp_lg_u32 s37, 0
s_cbranch_scc1 L_maxpass3
L_maxdone03:
v_mfma_f32_16x16x32_bf16 v[16:19], a[0:3], a[32:35], v[64:67]
v_accvgpr_read_b32 v4, a128
v_accvgpr_read_b32 v5, a129
v_mfma_f32_16x16x32_bf16 v[16:19], a[4:7], a[36:39], v[16:19]
v_accvgpr_read_b32 v6, a130
v_accvgpr_read_b32 v7, a131
v_mfma_f32_16x16x32_bf16 v[16:19], a[8:11], a[40:43], v[16:19]
v_mul_f32 v4, s44, v4
v_mul_f32 v5, s44, v5
v_mfma_f32_16x16x32_bf16 v[16:19], a[12:15], a[44:47], v[16:19]
v_mul_f32 v6, s44, v6
v_mul_f32 v7, s44, v7
v_mfma_f32_16x16x32_bf16 v[20:23], a[16:19], a[32:35], v[64:67]
v_cvt_pk_bf16_f32 v4, v4, v5
v_cvt_pk_bf16_f32 v6, v6, v7
v_mfma_f32_16x16x32_bf16 v[20:23], a[20:23], a[36:39], v[20:23]
v_accvgpr_write_b32 a128, v4
v_accvgpr_write_b32 a129, v6
v_mfma_f32_16x16x32_bf16 v[20:23], a[24:27], a[40:43], v[20:23]
v_accvgpr_read_b32 v4, a132
v_accvgpr_read_b32 v5, a133
v_mfma_f32_16x16x32_bf16 v[20:23], a[28:31], a[44:47], v[20:23]
v_accvgpr_read_b32 v6, a134
v_accvgpr_read_b32 v7, a135
v_mfma_f32_16x16x32_bf16 v[24:27], a[0:3], a[48:51], v[68:71]
v_mul_f32 v4, s44, v4
v_mul_f32 v5, s44, v5
v_mfma_f32_16x16x32_bf16 v[24:27], a[4:7], a[52:55], v[24:27]
v_exp_f32 v16, v16
v_mfma_f32_16x16x32_bf16 v[24:27], a[8:11], a[56:59], v[24:27]
v_exp_f32 v17, v17
v_mfma_f32_16x16x32_bf16 v[24:27], a[12:15], a[60:63], v[24:27]
v_cvt_pk_bf16_f32 v48, v16, v17
v_mul_f32 v6, s44, v6
v_mfma_f32_16x16x32_bf16 v[28:31], a[16:19], a[48:51], v[68:71]
v_exp_f32 v18, v18
v_mfma_f32_16x16x32_bf16 v[28:31], a[20:23], a[52:55], v[28:31]
v_exp_f32 v19, v19
v_mfma_f32_16x16x32_bf16 v[28:31], a[24:27], a[56:59], v[28:31]
v_exp_f32 v20, v20
v_mfma_f32_16x16x32_bf16 v[28:31], a[28:31], a[60:63], v[28:31]
v_exp_f32 v21, v21
v_exp_f32 v22, v22
v_cvt_pk_bf16_f32 v49, v18, v19
v_exp_f32 v23, v23
v_exp_f32 v24, v24
v_exp_f32 v25, v25
v_exp_f32 v26, v26
v_exp_f32 v27, v27
v_cvt_pk_bf16_f32 v50, v20, v21
v_exp_f32 v28, v28
v_exp_f32 v29, v29
ds_read_b64_tr_b16 a[64:65], v88 offset:0
v_cvt_pk_bf16_f32 v51, v22, v23
ds_read_b64_tr_b16 a[66:67], v88 offset:4096
v_cvt_pk_bf16_f32 v52, v24, v25
ds_read_b64_tr_b16 a[68:69], v89 offset:0
v_cvt_pk_bf16_f32 v53, v26, v27
ds_read_b64_tr_b16 a[70:71], v89 offset:4096
v_cvt_pk_bf16_f32 v54, v28, v29
ds_read_b64_tr_b16 a[72:73], v90 offset:0
ds_read_b64_tr_b16 a[74:75], v90 offset:4096
ds_read_b64_tr_b16 a[76:77], v91 offset:0
ds_read_b64_tr_b16 a[78:79], v91 offset:4096
v_mfma_f32_16x16x32_bf16 v[32:35], a[0:3], a[96:99], v[72:75]
ds_read_b64_tr_b16 a[80:81], v92 offset:0
v_mul_f32 v7, s44, v7
v_mfma_f32_16x16x32_bf16 v[32:35], a[4:7], a[100:103], v[32:35]
ds_read_b64_tr_b16 a[82:83], v92 offset:4096
v_cvt_pk_bf16_f32 v4, v4, v5
v_mfma_f32_16x16x32_bf16 v[32:35], a[8:11], a[104:107], v[32:35]
ds_read_b64_tr_b16 a[84:85], v93 offset:0
v_cvt_pk_bf16_f32 v6, v6, v7
v_mfma_f32_16x16x32_bf16 v[32:35], a[12:15], a[108:111], v[32:35]
ds_read_b64_tr_b16 a[86:87], v93 offset:4096
s_add_u32 s47, s33, 0
v_accvgpr_write_b32 a130, v4
v_mfma_f32_16x16x32_bf16 v[36:39], a[16:19], a[96:99], v[72:75]
ds_read_b64_tr_b16 a[88:89], v94 offset:0
buffer_store_dwordx4 v[192:195], v103, s[28:31], s47 offen offset:0 sc1
v_mfma_f32_16x16x32_bf16 v[36:39], a[20:23], a[100:103], v[36:39]
ds_read_b64_tr_b16 a[90:91], v94 offset:4096
v_accvgpr_write_b32 a131, v6
v_mfma_f32_16x16x32_bf16 v[36:39], a[24:27], a[104:107], v[36:39]
ds_read_b64_tr_b16 a[92:93], v95 offset:0
v_accvgpr_read_b32 v4, a136
v_mfma_f32_16x16x32_bf16 v[36:39], a[28:31], a[108:111], v[36:39]
ds_read_b64_tr_b16 a[94:95], v95 offset:4096
v_accvgpr_read_b32 v5, a137
v_exp_f32 v30, v30
s_add_u32 s47, s33, 0
v_exp_f32 v31, v31
buffer_store_dwordx4 v[196:199], v103, s[28:31], s47 offen offset:1024 sc1
v_exp_f32 v32, v32
v_exp_f32 v33, v33
v_exp_f32 v34, v34
v_exp_f32 v35, v35
v_exp_f32 v36, v36
s_waitcnt lgkmcnt(0)
s_add_u32 s47, s33, 0
v_exp_f32 v37, v37
v_mfma_f32_16x16x32_bf16 v[128:131], a[64:67], v[48:51], 0
ds_read_b128 a[0:3], v84 offset:8192
buffer_store_dwordx4 v[200:203], v103, s[28:31], s47 offen offset:2048 sc1
v_cvt_pk_bf16_f32 v55, v30, v31
v_mfma_f32_16x16x32_bf16 v[132:135], a[68:71], v[48:51], 0
ds_read_b128 a[4:7], v85 offset:8192
v_cvt_pk_bf16_f32 v56, v32, v33
v_mfma_f32_16x16x32_bf16 v[136:139], a[72:75], v[48:51], 0
ds_read_b128 a[8:11], v86 offset:8192
v_cvt_pk_bf16_f32 v57, v34, v35
v_mfma_f32_16x16x32_bf16 v[140:143], a[76:79], v[48:51], 0
ds_read_b128 a[12:15], v87 offset:8192
v_cvt_pk_bf16_f32 v58, v36, v37
v_mfma_f32_16x16x32_bf16 v[144:147], a[80:83], v[48:51], 0
ds_read_b128 a[16:19], v84 offset:12288
v_accvgpr_read_b32 v6, a138
v_mfma_f32_16x16x32_bf16 v[148:151], a[84:87], v[48:51], 0
ds_read_b128 a[20:23], v85 offset:12288
s_add_u32 s47, s33, 0
v_accvgpr_read_b32 v7, a139
v_mfma_f32_16x16x32_bf16 v[152:155], a[88:91], v[48:51], 0
ds_read_b128 a[24:27], v86 offset:12288
buffer_store_dwordx4 v[204:207], v103, s[28:31], s47 offen offset:3072 sc1
v_mfma_f32_16x16x32_bf16 v[156:159], a[92:95], v[48:51], 0
ds_read_b128 a[28:31], v87 offset:12288
v_mul_f32 v4, s44, v4
v_mfma_f32_16x16x32_bf16 v[108:111], v[124:127], v[48:51], 0
v_exp_f32 v38, v38
v_mfma_f32_16x16x32_bf16 v[160:163], a[64:67], v[52:55], 0
v_exp_f32 v39, v39
v_mfma_f32_16x16x32_bf16 v[164:167], a[68:71], v[52:55], 0
v_mul_f32 v5, s44, v5
v_mul_f32 v6, s44, v6
v_mfma_f32_16x16x32_bf16 v[168:171], a[72:75], v[52:55], 0
s_add_u32 s47, s33, 16384
v_mul_f32 v7, s44, v7
v_cvt_pk_bf16_f32 v4, v4, v5
v_mfma_f32_16x16x32_bf16 v[172:175], a[76:79], v[52:55], 0
buffer_store_dwordx4 v[208:211], v103, s[28:31], s47 offen offset:0 sc1
v_cvt_pk_bf16_f32 v6, v6, v7
v_mfma_f32_16x16x32_bf16 v[176:179], a[80:83], v[52:55], 0
v_accvgpr_write_b32 a132, v4
v_accvgpr_write_b32 a133, v6
v_mfma_f32_16x16x32_bf16 v[180:183], a[84:87], v[52:55], 0
v_mfma_f32_16x16x32_bf16 v[184:187], a[88:91], v[52:55], 0
v_mfma_f32_16x16x32_bf16 v[188:191], a[92:95], v[52:55], 0
v_mfma_f32_16x16x32_bf16 v[112:115], v[124:127], v[52:55], 0
s_waitcnt lgkmcnt(0)
v_mfma_f32_16x16x32_bf16 v[16:19], a[0:3], a[32:35], v[64:67]
v_cvt_pk_bf16_f32 v59, v38, v39
v_accvgpr_read_b32 v4, a140
v_mfma_f32_16x16x32_bf16 v[16:19], a[4:7], a[36:39], v[16:19]
s_add_u32 s47, s33, 16384
v_accvgpr_read_b32 v5, a141
v_accvgpr_read_b32 v6, a142
v_mfma_f32_16x16x32_bf16 v[16:19], a[8:11], a[40:43], v[16:19]
buffer_store_dwordx4 v[212:215], v103, s[28:31], s47 offen offset:1024 sc1
v_accvgpr_read_b32 v7, a143
v_mfma_f32_16x16x32_bf16 v[16:19], a[12:15], a[44:47], v[16:19]
v_mul_f32 v4, s44, v4
v_mul_f32 v5, s44, v5
v_mfma_f32_16x16x32_bf16 v[20:23], a[16:19], a[32:35], v[64:67]
v_mul_f32 v6, s44, v6
v_mul_f32 v7, s44, v7
v_mfma_f32_16x16x32_bf16 v[20:23], a[20:23], a[36:39], v[20:23]
s_add_u32 s39, s39, 1
s_add_u32 s47, s33, 16384
v_cvt_pk_bf16_f32 v4, v4, v5
v_cvt_pk_bf16_f32 v6, v6, v7
v_mfma_f32_16x16x32_bf16 v[20:23], a[24:27], a[40:43], v[20:23]
buffer_store_dwordx4 v[216:219], v103, s[28:31], s47 offen offset:2048 sc1
v_mov_b32 v80, s39
v_mfma_f32_16x16x32_bf16 v[20:23], a[28:31], a[44:47], v[20:23]
v_accvgpr_write_b32 a134, v4
v_accvgpr_write_b32 a135, v6
v_mfma_f32_16x16x32_bf16 v[24:27], a[0:3], a[48:51], v[68:71]
s_waitcnt vmcnt(19)
ds_write_b32 v1, v80
v_accvgpr_read_b32 v4, a144
v_mfma_f32_16x16x32_bf16 v[24:27], a[4:7], a[52:55], v[24:27]
s_add_u32 s47, s33, 16384
v_exp_f32 v16, v16
v_mfma_f32_16x16x32_bf16 v[24:27], a[8:11], a[56:59], v[24:27]
buffer_store_dwordx4 v[220:223], v103, s[28:31], s47 offen offset:3072 sc1
v_exp_f32 v17, v17
v_mfma_f32_16x16x32_bf16 v[24:27], a[12:15], a[60:63], v[24:27]
v_cvt_pk_bf16_f32 v48, v16, v17
v_accvgpr_read_b32 v5, a145
v_mfma_f32_16x16x32_bf16 v[28:31], a[16:19], a[48:51], v[68:71]
v_exp_f32 v18, v18
v_mfma_f32_16x16x32_bf16 v[28:31], a[20:23], a[52:55], v[28:31]
v_exp_f32 v19, v19
v_mfma_f32_16x16x32_bf16 v[28:31], a[24:27], a[56:59], v[28:31]
s_lshl_b32 s47, s32, 10
v_exp_f32 v20, v20
v_mfma_f32_16x16x32_bf16 v[28:31], a[28:31], a[60:63], v[28:31]
s_add_u32 s47, s47, 32768
v_exp_f32 v21, v21
v_mfma_f32_16x16x32_bf16 v[192:195], a[64:67], v[56:59], 0
buffer_store_dwordx4 v[224:227], v103, s[28:31], s47 offen offset:0 sc1
v_exp_f32 v22, v22
v_mfma_f32_16x16x32_bf16 v[196:199], a[68:71], v[56:59], 0
v_cvt_pk_bf16_f32 v49, v18, v19
v_accvgpr_read_b32 v6, a146
v_mfma_f32_16x16x32_bf16 v[200:203], a[72:75], v[56:59], 0
v_exp_f32 v23, v23
v_mfma_f32_16x16x32_bf16 v[204:207], a[76:79], v[56:59], 0
v_exp_f32 v24, v24
v_mfma_f32_16x16x32_bf16 v[208:211], a[80:83], v[56:59], 0
v_exp_f32 v25, v25
v_mfma_f32_16x16x32_bf16 v[212:215], a[84:87], v[56:59], 0
v_exp_f32 v26, v26
v_mfma_f32_16x16x32_bf16 v[216:219], a[88:91], v[56:59], 0
v_exp_f32 v27, v27
v_mfma_f32_16x16x32_bf16 v[220:223], a[92:95], v[56:59], 0
v_cvt_pk_bf16_f32 v50, v20, v21
v_accvgpr_read_b32 v7, a147
v_mfma_f32_16x16x32_bf16 v[116:119], v[124:127], v[56:59], 0
v_exp_f32 v28, v28
v_exp_f32 v29, v29
ds_read_b64_tr_b16 a[64:65], v88 offset:8192
v_cvt_pk_bf16_f32 v51, v22, v23
ds_read_b64_tr_b16 a[66:67], v88 offset:12288
v_cvt_pk_bf16_f32 v52, v24, v25
ds_read_b64_tr_b16 a[68:69], v89 offset:8192
v_cvt_pk_bf16_f32 v53, v26, v27
ds_read_b64_tr_b16 a[70:71], v89 offset:12288
v_cvt_pk_bf16_f32 v54, v28, v29
ds_read_b64_tr_b16 a[72:73], v90 offset:8192
ds_read_b64_tr_b16 a[74:75], v90 offset:12288
ds_read_b64_tr_b16 a[76:77], v91 offset:8192
ds_read_b64_tr_b16 a[78:79], v91 offset:12288
v_mfma_f32_16x16x32_bf16 v[32:35], a[0:3], a[96:99], v[72:75]
ds_read_b64_tr_b16 a[80:81], v92 offset:8192
v_mul_f32 v4, s44, v4
v_mfma_f32_16x16x32_bf16 v[32:35], a[4:7], a[100:103], v[32:35]
ds_read_b64_tr_b16 a[82:83], v92 offset:12288
ds_read_b128 v[80:83], v101
v_mfma_f32_16x16x32_bf16 v[32:35], a[8:11], a[104:107], v[32:35]
ds_read_b64_tr_b16 a[84:85], v93 offset:8192
v_mul_f32 v5, s44, v5
v_mfma_f32_16x16x32_bf16 v[32:35], a[12:15], a[108:111], v[32:35]
ds_read_b64_tr_b16 a[86:87], v93 offset:12288
v_mul_f32 v6, s44, v6
v_mfma_f32_16x16x32_bf16 v[36:39], a[16:19], a[96:99], v[72:75]
s_waitcnt lgkmcnt(2)
ds_read_b64_tr_b16 a[88:89], v94 offset:8192
v_min3_u32 v80, v80, v81, v82
v_mfma_f32_16x16x32_bf16 v[36:39], a[20:23], a[100:103], v[36:39]
ds_read_b64_tr_b16 a[90:91], v94 offset:12288
v_min_u32 v80, v80, v83
v_mfma_f32_16x16x32_bf16 v[36:39], a[24:27], a[104:107], v[36:39]
ds_read_b64_tr_b16 a[92:93], v95 offset:8192
v_cmp_gt_u32 vcc, s39, v80
v_mfma_f32_16x16x32_bf16 v[36:39], a[28:31], a[108:111], v[36:39]
s_cbranch_vccnz L_fs1_3
L_fr1_3:
ds_read_b64_tr_b16 a[94:95], v95 offset:12288
v_mul_f32 v7, s44, v7
v_exp_f32 v30, v30
v_exp_f32 v31, v31
v_exp_f32 v32, v32
v_exp_f32 v33, v33
v_exp_f32 v34, v34
v_exp_f32 v35, v35
v_exp_f32 v36, v36
s_waitcnt lgkmcnt(0)
v_exp_f32 v37, v37
v_mfma_f32_16x16x32_bf16 v[128:131], a[64:67], v[48:51], v[128:131]
ds_read_b128 a[0:3], v84 offset:16384
v_cvt_pk_bf16_f32 v55, v30, v31
v_mfma_f32_16x16x32_bf16 v[132:135], a[68:71], v[48:51], v[132:135]
ds_read_b128 a[4:7], v85 offset:16384
v_cvt_pk_bf16_f32 v56, v32, v33
v_mfma_f32_16x16x32_bf16 v[136:139], a[72:75], v[48:51], v[136:139]
ds_read_b128 a[8:11], v86 offset:16384
v_cvt_pk_bf16_f32 v57, v34, v35
v_mfma_f32_16x16x32_bf16 v[140:143], a[76:79], v[48:51], v[140:143]
ds_read_b128 a[12:15], v87 offset:16384
v_cvt_pk_bf16_f32 v58, v36, v37
v_mfma_f32_16x16x32_bf16 v[144:147], a[80:83], v[48:51], v[144:147]
ds_read_b128 a[16:19], v84 offset:20480
v_cvt_pk_bf16_f32 v4, v4, v5
v_mfma_f32_16x16x32_bf16 v[148:151], a[84:87], v[48:51], v[148:151]
ds_read_b128 a[20:23], v85 offset:20480
v_cvt_pk_bf16_f32 v6, v6, v7
v_mfma_f32_16x16x32_bf16 v[152:155], a[88:91], v[48:51], v[152:155]
ds_read_b128 a[24:27], v86 offset:20480
v_accvgpr_write_b32 a136, v4
v_mfma_f32_16x16x32_bf16 v[156:159], a[92:95], v[48:51], v[156:159]
ds_read_b128 a[28:31], v87 offset:20480
v_accvgpr_write_b32 a137, v6
v_mfma_f32_16x16x32_bf16 v[108:111], v[124:127], v[48:51], v[108:111]
v_exp_f32 v38, v38
v_mfma_f32_16x16x32_bf16 v[160:163], a[64:67], v[52:55], v[160:163]
v_exp_f32 v39, v39
v_mfma_f32_16x16x32_bf16 v[164:167], a[68:71], v[52:55], v[164:167]
v_accvgpr_read_b32 v4, a148
v_accvgpr_read_b32 v5, a149
v_mfma_f32_16x16x32_bf16 v[168:171], a[72:75], v[52:55], v[168:171]
v_accvgpr_read_b32 v6, a150
v_accvgpr_read_b32 v7, a151
v_mfma_f32_16x16x32_bf16 v[172:175], a[76:79], v[52:55], v[172:175]
v_mul_f32 v4, s44, v4
v_mul_f32 v5, s44, v5
v_mfma_f32_16x16x32_bf16 v[176:179], a[80:83], v[52:55], v[176:179]
v_mul_f32 v6, s44, v6
v_mul_f32 v7, s44, v7
v_mfma_f32_16x16x32_bf16 v[180:183], a[84:87], v[52:55], v[180:183]
v_cvt_pk_bf16_f32 v4, v4, v5
v_cvt_pk_bf16_f32 v6, v6, v7
v_mfma_f32_16x16x32_bf16 v[184:187], a[88:91], v[52:55], v[184:187]
v_accvgpr_write_b32 a138, v4
v_accvgpr_write_b32 a139, v6
v_mfma_f32_16x16x32_bf16 v[188:191], a[92:95], v[52:55], v[188:191]
v_mfma_f32_16x16x32_bf16 v[112:115], v[124:127], v[52:55], v[112:115]
s_waitcnt lgkmcnt(0)
v_mfma_f32_16x16x32_bf16 v[16:19], a[0:3], a[32:35], v[64:67]
v_cvt_pk_bf16_f32 v59, v38, v39
v_accvgpr_read_b32 v4, a152
v_mfma_f32_16x16x32_bf16 v[16:19], a[4:7], a[36:39], v[16:19]
v_accvgpr_read_b32 v5, a153
v_accvgpr_read_b32 v6, a154
v_mfma_f32_16x16x32_bf16 v[16:19], a[8:11], a[40:43], v[16:19]
v_accvgpr_read_b32 v7, a155
v_mul_f32 v4, s44, v4
v_mfma_f32_16x16x32_bf16 v[16:19], a[12:15], a[44:47], v[16:19]
v_mul_f32 v5, s44, v5
v_mul_f32 v6, s44, v6
v_mfma_f32_16x16x32_bf16 v[20:23], a[16:19], a[32:35], v[64:67]
v_mul_f32 v7, s44, v7
v_cvt_pk_bf16_f32 v4, v4, v5
v_mfma_f32_16x16x32_bf16 v[20:23], a[20:23], a[36:39], v[20:23]
v_cvt_pk_bf16_f32 v6, v6, v7
v_accvgpr_write_b32 a140, v4
v_mfma_f32_16x16x32_bf16 v[20:23], a[24:27], a[40:43], v[20:23]
v_accvgpr_write_b32 a141, v6
v_accvgpr_read_b32 v4, a156
v_mfma_f32_16x16x32_bf16 v[20:23], a[28:31], a[44:47], v[20:23]
v_accvgpr_read_b32 v5, a157
v_accvgpr_read_b32 v6, a158
v_mfma_f32_16x16x32_bf16 v[24:27], a[0:3], a[48:51], v[68:71]
v_accvgpr_read_b32 v7, a159
v_mul_f32 v4, s44, v4
v_mfma_f32_16x16x32_bf16 v[24:27], a[4:7], a[52:55], v[24:27]
v_exp_f32 v16, v16
v_mfma_f32_16x16x32_bf16 v[24:27], a[8:11], a[56:59], v[24:27]
v_exp_f32 v17, v17
v_mfma_f32_16x16x32_bf16 v[24:27], a[12:15], a[60:63], v[24:27]
v_cvt_pk_bf16_f32 v48, v16, v17
v_mul_f32 v5, s44, v5
v_mfma_f32_16x16x32_bf16 v[28:31], a[16:19], a[48:51], v[68:71]
v_exp_f32 v18, v18
v_mfma_f32_16x16x32_bf16 v[28:31], a[20:23], a[52:55], v[28:31]
v_exp_f32 v19, v19
v_mfma_f32_16x16x32_bf16 v[28:31], a[24:27], a[56:59], v[28:31]
v_exp_f32 v20, v20
v_mfma_f32_16x16x32_bf16 v[28:31], a[28:31], a[60:63], v[28:31]
v_exp_f32 v21, v21
v_mfma_f32_16x16x32_bf16 v[192:195], a[64:67], v[56:59], v[192:195]
v_exp_f32 v22, v22
v_mfma_f32_16x16x32_bf16 v[196:199], a[68:71], v[56:59], v[196:199]
v_cvt_pk_bf16_f32 v49, v18, v19
v_mul_f32 v6, s44, v6
v_mfma_f32_16x16x32_bf16 v[200:203], a[72:75], v[56:59], v[200:203]
v_exp_f32 v23, v23
v_mfma_f32_16x16x32_bf16 v[204:207], a[76:79], v[56:59], v[204:207]
v_exp_f32 v24, v24
v_mfma_f32_16x16x32_bf16 v[208:211], a[80:83], v[56:59], v[208:211]
v_exp_f32 v25, v25
v_mfma_f32_16x16x32_bf16 v[212:215], a[84:87], v[56:59], v[212:215]
v_exp_f32 v26, v26
v_mfma_f32_16x16x32_bf16 v[216:219], a[88:91], v[56:59], v[216:219]
v_exp_f32 v27, v27
v_mfma_f32_16x16x32_bf16 v[220:223], a[92:95], v[56:59], v[220:223]
v_cvt_pk_bf16_f32 v50, v20, v21
v_mul_f32 v7, s44, v7
v_mfma_f32_16x16x32_bf16 v[116:119], v[124:127], v[56:59], v[116:119]
v_exp_f32 v28, v28
v_exp_f32 v29, v29
ds_read_b64_tr_b16 a[64:65], v88 offset:16384
v_cvt_pk_bf16_f32 v51, v22, v23
ds_read_b64_tr_b16 a[66:67], v88 offset:20480
v_cvt_pk_bf16_f32 v52, v24, v25
ds_read_b64_tr_b16 a[68:69], v89 offset:16384
v_cvt_pk_bf16_f32 v53, v26, v27
ds_read_b64_tr_b16 a[70:71], v89 offset:20480
v_cvt_pk_bf16_f32 v54, v28, v29
ds_read_b64_tr_b16 a[72:73], v90 offset:16384
ds_read_b64_tr_b16 a[74:75], v90 offset:20480
ds_read_b64_tr_b16 a[76:77], v91 offset:16384
ds_read_b64_tr_b16 a[78:79], v91 offset:20480
v_mfma_f32_16x16x32_bf16 v[32:35], a[0:3], a[96:99], v[72:75]
ds_read_b64_tr_b16 a[80:81], v92 offset:16384
v_cvt_pk_bf16_f32 v4, v4, v5
v_mfma_f32_16x16x32_bf16 v[32:35], a[4:7], a[100:103], v[32:35]
ds_read_b64_tr_b16 a[82:83], v92 offset:20480
v_cvt_pk_bf16_f32 v6, v6, v7
v_mfma_f32_16x16x32_bf16 v[32:35], a[8:11], a[104:107], v[32:35]
ds_read_b64_tr_b16 a[84:85], v93 offset:16384
v_accvgpr_write_b32 a142, v4
v_mfma_f32_16x16x32_bf16 v[32:35], a[12:15], a[108:111], v[32:35]
ds_read_b64_tr_b16 a[86:87], v93 offset:20480
v_accvgpr_write_b32 a143, v6
v_mfma_f32_16x16x32_bf16 v[36:39], a[16:19], a[96:99], v[72:75]
ds_read_b64_tr_b16 a[88:89], v94 offset:16384
v_accvgpr_read_b32 v4, a160
v_mfma_f32_16x16x32_bf16 v[36:39], a[20:23], a[100:103], v[36:39]
ds_read_b64_tr_b16 a[90:91], v94 offset:20480
v_accvgpr_read_b32 v5, a161
v_mfma_f32_16x16x32_bf16 v[36:39], a[24:27], a[104:107], v[36:39]
ds_read_b64_tr_b16 a[92:93], v95 offset:16384
v_accvgpr_read_b32 v6, a162
v_mfma_f32_16x16x32_bf16 v[36:39], a[28:31], a[108:111], v[36:39]
ds_read_b64_tr_b16 a[94:95], v95 offset:20480
v_accvgpr_read_b32 v7, a163
v_exp_f32 v30, v30
v_exp_f32 v31, v31
v_exp_f32 v32, v32
v_exp_f32 v33, v33
v_exp_f32 v34, v34
v_exp_f32 v35, v35
v_exp_f32 v36, v36
s_waitcnt lgkmcnt(0)
v_exp_f32 v37, v37
v_mfma_f32_16x16x32_bf16 v[128:131], a[64:67], v[48:51], v[128:131]
ds_read_b128 a[0:3], v84 offset:24576
v_cvt_pk_bf16_f32 v55, v30, v31
v_mfma_f32_16x16x32_bf16 v[132:135], a[68:71], v[48:51], v[132:135]
ds_read_b128 a[4:7], v85 offset:24576
v_cvt_pk_bf16_f32 v56, v32, v33
v_mfma_f32_16x16x32_bf16 v[136:139], a[72:75], v[48:51], v[136:139]
ds_read_b128 a[8:11], v86 offset:24576
v_cvt_pk_bf16_f32 v57, v34, v35
v_mfma_f32_16x16x32_bf16 v[140:143], a[76:79], v[48:51], v[140:143]
ds_read_b128 a[12:15], v87 offset:24576
v_cvt_pk_bf16_f32 v58, v36, v37
v_mfma_f32_16x16x32_bf16 v[144:147], a[80:83], v[48:51], v[144:147]
ds_read_b128 a[16:19], v84 offset:28672
v_mul_f32 v4, s44, v4
v_mfma_f32_16x16x32_bf16 v[148:151], a[84:87], v[48:51], v[148:151]
ds_read_b128 a[20:23], v85 offset:28672
v_mul_f32 v5, s44, v5
v_mfma_f32_16x16x32_bf16 v[152:155], a[88:91], v[48:51], v[152:155]
ds_read_b128 a[24:27], v86 offset:28672
v_mul_f32 v6, s44, v6
v_mfma_f32_16x16x32_bf16 v[156:159], a[92:95], v[48:51], v[156:159]
ds_read_b128 a[28:31], v87 offset:28672
v_mul_f32 v7, s44, v7
v_mfma_f32_16x16x32_bf16 v[108:111], v[124:127], v[48:51], v[108:111]
v_exp_f32 v38, v38
v_mfma_f32_16x16x32_bf16 v[160:163], a[64:67], v[52:55], v[160:163]
v_exp_f32 v39, v39
v_mfma_f32_16x16x32_bf16 v[164:167], a[68:71], v[52:55], v[164:167]
v_cvt_pk_bf16_f32 v4, v4, v5
v_cvt_pk_bf16_f32 v6, v6, v7
v_mfma_f32_16x16x32_bf16 v[168:171], a[72:75], v[52:55], v[168:171]
v_accvgpr_write_b32 a144, v4
v_accvgpr_write_b32 a145, v6
v_mfma_f32_16x16x32_bf16 v[172:175], a[76:79], v[52:55], v[172:175]
v_mfma_f32_16x16x32_bf16 v[176:179], a[80:83], v[52:55], v[176:179]
v_mfma_f32_16x16x32_bf16 v[180:183], a[84:87], v[52:55], v[180:183]
v_mfma_f32_16x16x32_bf16 v[184:187], a[88:91], v[52:55], v[184:187]
v_mfma_f32_16x16x32_bf16 v[188:191], a[92:95], v[52:55], v[188:191]
v_mfma_f32_16x16x32_bf16 v[112:115], v[124:127], v[52:55], v[112:115]
s_waitcnt lgkmcnt(0)
v_mfma_f32_16x16x32_bf16 v[16:19], a[0:3], a[32:35], v[64:67]
v_cvt_pk_bf16_f32 v59, v38, v39
v_accvgpr_read_b32 v4, a164
v_accvgpr_read_b32 v5, a165
v_mfma_f32_16x16x32_bf16 v[16:19], a[4:7], a[36:39], v[16:19]
s_mov_b32 m0, 0
v_accvgpr_read_b32 v6, a166
v_accvgpr_read_b32 v7, a167
v_mfma_f32_16x16x32_bf16 v[16:19], a[8:11], a[40:43], v[16:19]
buffer_load_dwordx4 v234, s[12:15], s34 offen offset:0 nt lds
v_mul_f32 v4, s44, v4
v_mfma_f32_16x16x32_bf16 v[16:19], a[12:15], a[44:47], v[16:19]
v_mul_f32 v5, s44, v5
v_mul_f32 v6, s44, v6
v_mfma_f32_16x16x32_bf16 v[20:23], a[16:19], a[32:35], v[64:67]
v_mul_f32 v7, s44, v7
v_cvt_pk_bf16_f32 v4, v4, v5
v_mfma_f32_16x16x32_bf16 v[20:23], a[20:23], a[36:39], v[20:23]
s_add_u32 s39, s39, 1
buffer_load_dwordx4 v235, s[12:15], s34 offen offset:1024 nt lds
v_cvt_pk_bf16_f32 v6, v6, v7
v_mfma_f32_16x16x32_bf16 v[20:23], a[24:27], a[40:43], v[20:23]
v_mov_b32 v80, s39
v_accvgpr_write_b32 a146, v4
v_mfma_f32_16x16x32_bf16 v[20:23], a[28:31], a[44:47], v[20:23]
v_accvgpr_write_b32 a147, v6
v_accvgpr_read_b32 v4, a168
v_mfma_f32_16x16x32_bf16 v[24:27], a[0:3], a[48:51], v[68:71]
s_waitcnt vmcnt(19)
ds_write_b32 v1, v80
buffer_load_dwordx4 v232, s[12:15], s34 offen offset:2048 nt lds
v_mfma_f32_16x16x32_bf16 v[24:27], a[4:7], a[52:55], v[24:27]
v_exp_f32 v16, v16
v_mfma_f32_16x16x32_bf16 v[24:27], a[8:11], a[56:59], v[24:27]
v_exp_f32 v17, v17
v_mfma_f32_16x16x32_bf16 v[24:27], a[12:15], a[60:63], v[24:27]
buffer_load_dwordx4 v233, s[12:15], s34 offen offset:3072 nt lds
v_cvt_pk_bf16_f32 v48, v16, v17
v_mfma_f32_16x16x32_bf16 v[28:31], a[16:19], a[48:51], v[68:71]
v_exp_f32 v18, v18
v_accvgpr_read_b32 v5, a169
v_mfma_f32_16x16x32_bf16 v[28:31], a[20:23], a[52:55], v[28:31]
s_mov_b32 m0, 4096
s_add_u32 s92, s34, 4096
v_exp_f32 v19, v19
v_mfma_f32_16x16x32_bf16 v[28:31], a[24:27], a[56:59], v[28:31]
buffer_load_dwordx4 v234, s[12:15], s92 offen offset:0 nt lds
v_exp_f32 v20, v20
v_mfma_f32_16x16x32_bf16 v[28:31], a[28:31], a[60:63], v[28:31]
v_exp_f32 v21, v21
v_mfma_f32_16x16x32_bf16 v[192:195], a[64:67], v[56:59], v[192:195]
v_exp_f32 v22, v22
v_mfma_f32_16x16x32_bf16 v[196:199], a[68:71], v[56:59], v[196:199]
buffer_load_dwordx4 v235, s[12:15], s92 offen offset:1024 nt lds
v_cvt_pk_bf16_f32 v49, v18, v19
v_mfma_f32_16x16x32_bf16 v[200:203], a[72:75], v[56:59], v[200:203]
v_exp_f32 v23, v23
v_mfma_f32_16x16x32_bf16 v[204:207], a[76:79], v[56:59], v[204:207]
v_exp_f32 v24, v24
v_mfma_f32_16x16x32_bf16 v[208:211], a[80:83], v[56:59], v[208:211]
buffer_load_dwordx4 v232, s[12:15], s92 offen offset:2048 nt lds
v_exp_f32 v25, v25
v_mfma_f32_16x16x32_bf16 v[212:215], a[84:87], v[56:59], v[212:215]
v_exp_f32 v26, v26
v_mfma_f32_16x16x32_bf16 v[216:219], a[88:91], v[56:59], v[216:219]
v_exp_f32 v27, v27
v_mfma_f32_16x16x32_bf16 v[220:223], a[92:95], v[56:59], v[220:223]
buffer_load_dwordx4 v233, s[12:15], s92 offen offset:3072 nt lds
v_cvt_pk_bf16_f32 v50, v20, v21
v_mfma_f32_16x16x32_bf16 v[116:119], v[124:127], v[56:59], v[116:119]
v_exp_f32 v28, v28
v_exp_f32 v29, v29
ds_read_b64_tr_b16 a[64:65], v88 offset:24576
v_cvt_pk_bf16_f32 v51, v22, v23
ds_read_b64_tr_b16 a[66:67], v88 offset:28672
v_cvt_pk_bf16_f32 v52, v24, v25
ds_read_b64_tr_b16 a[68:69], v89 offset:24576
v_cvt_pk_bf16_f32 v53, v26, v27
ds_read_b64_tr_b16 a[70:71], v89 offset:28672
v_cvt_pk_bf16_f32 v54, v28, v29
ds_read_b64_tr_b16 a[72:73], v90 offset:24576
ds_read_b64_tr_b16 a[74:75], v90 offset:28672
ds_read_b64_tr_b16 a[76:77], v91 offset:24576
ds_read_b64_tr_b16 a[78:79], v91 offset:28672
v_mfma_f32_16x16x32_bf16 v[32:35], a[0:3], a[96:99], v[72:75]
ds_read_b64_tr_b16 a[80:81], v92 offset:24576
s_mov_b32 m0, 8192
s_add_u32 s92, s34, 8192
v_accvgpr_read_b32 v6, a170
v_accvgpr_read_b32 v7, a171
v_mfma_f32_16x16x32_bf16 v[32:35], a[4:7], a[100:103], v[32:35]
ds_read_b64_tr_b16 a[82:83], v92 offset:28672
ds_read_b128 v[80:83], v101
buffer_load_dwordx4 v234, s[12:15], s92 offen offset:0 nt lds
v_mfma_f32_16x16x32_bf16 v[32:35], a[8:11], a[104:107], v[32:35]
ds_read_b64_tr_b16 a[84:85], v93 offset:24576
v_mul_f32 v4, s44, v4
v_mfma_f32_16x16x32_bf16 v[32:35], a[12:15], a[108:111], v[32:35]
ds_read_b64_tr_b16 a[86:87], v93 offset:28672
v_mul_f32 v5, s44, v5
v_mfma_f32_16x16x32_bf16 v[36:39], a[16:19], a[96:99], v[72:75]
s_waitcnt lgkmcnt(2)
ds_read_b64_tr_b16 a[88:89], v94 offset:24576
buffer_load_dwordx4 v235, s[12:15], s92 offen offset:1024 nt lds
v_min3_u32 v80, v80, v81, v82
v_mfma_f32_16x16x32_bf16 v[36:39], a[20:23], a[100:103], v[36:39]
ds_read_b64_tr_b16 a[90:91], v94 offset:28672
v_min_u32 v80, v80, v83
v_mfma_f32_16x16x32_bf16 v[36:39], a[24:27], a[104:107], v[36:39]
ds_read_b64_tr_b16 a[92:93], v95 offset:24576
v_cmp_gt_u32 vcc, s39, v80
v_mfma_f32_16x16x32_bf16 v[36:39], a[28:31], a[108:111], v[36:39]
s_cbranch_vccnz L_fs3_3
L_fr3_3:
ds_read_b64_tr_b16 a[94:95], v95 offset:28672
buffer_load_dwordx4 v232, s[12:15], s92 offen offset:2048 nt lds
v_exp_f32 v30, v30
v_exp_f32 v31, v31
v_exp_f32 v32, v32
v_exp_f32 v33, v33
v_exp_f32 v34, v34
v_exp_f32 v35, v35
v_exp_f32 v36, v36
s_waitcnt lgkmcnt(0)
v_exp_f32 v37, v37
v_mfma_f32_16x16x32_bf16 v[128:131], a[64:67], v[48:51], v[128:131]
ds_read_b128 a[0:3], v84 offset:32768
v_cvt_pk_bf16_f32 v55, v30, v31
v_mfma_f32_16x16x32_bf16 v[132:135], a[68:71], v[48:51], v[132:135]
ds_read_b128 a[4:7], v85 offset:32768
v_cvt_pk_bf16_f32 v56, v32, v33
v_mfma_f32_16x16x32_bf16 v[136:139], a[72:75], v[48:51], v[136:139]
ds_read_b128 a[8:11], v86 offset:32768
buffer_load_dwordx4 v233, s[12:15], s92 offen offset:3072 nt lds
v_cvt_pk_bf16_f32 v57, v34, v35
v_mfma_f32_16x16x32_bf16 v[140:143], a[76:79], v[48:51], v[140:143]
ds_read_b128 a[12:15], v87 offset:32768
v_cvt_pk_bf16_f32 v58, v36, v37
v_mfma_f32_16x16x32_bf16 v[144:147], a[80:83], v[48:51], v[144:147]
ds_read_b128 a[16:19], v84 offset:36864
s_mov_b32 m0, 12288
s_add_u32 s92, s34, 12288
v_mul_f32 v6, s44, v6
v_mfma_f32_16x16x32_bf16 v[148:151], a[84:87], v[48:51], v[148:151]
ds_read_b128 a[20:23], v85 offset:36864
buffer_load_dwordx4 v234, s[12:15], s92 offen offset:0 nt lds
v_mul_f32 v7, s44, v7
v_mfma_f32_16x16x32_bf16 v[152:155], a[88:91], v[48:51], v[152:155]
ds_read_b128 a[24:27], v86 offset:36864
v_cvt_pk_bf16_f32 v4, v4, v5
v_mfma_f32_16x16x32_bf16 v[156:159], a[92:95], v[48:51], v[156:159]
ds_read_b128 a[28:31], v87 offset:36864
v_cvt_pk_bf16_f32 v6, v6, v7
v_mfma_f32_16x16x32_bf16 v[108:111], v[124:127], v[48:51], v[108:111]
buffer_load_dwordx4 v235, s[12:15], s92 offen offset:1024 nt lds
v_exp_f32 v38, v38
v_mfma_f32_16x16x32_bf16 v[160:163], a[64:67], v[52:55], v[160:163]
v_exp_f32 v39, v39
v_mfma_f32_16x16x32_bf16 v[164:167], a[68:71], v[52:55], v[164:167]
v_accvgpr_write_b32 a148, v4
v_accvgpr_write_b32 a149, v6
v_mfma_f32_16x16x32_bf16 v[168:171], a[72:75], v[52:55], v[168:171]
buffer_load_dwordx4 v232, s[12:15], s92 offen offset:2048 nt lds
v_accvgpr_read_b32 v4, a172
v_mfma_f32_16x16x32_bf16 v[172:175], a[76:79], v[52:55], v[172:175]
v_accvgpr_read_b32 v5, a173
v_accvgpr_read_b32 v6, a174
v_mfma_f32_16x16x32_bf16 v[176:179], a[80:83], v[52:55], v[176:179]
v_accvgpr_read_b32 v7, a175
v_mul_f32 v4, s44, v4
v_mfma_f32_16x16x32_bf16 v[180:183], a[84:87], v[52:55], v[180:183]
buffer_load_dwordx4 v233, s[12:15], s92 offen offset:3072 nt lds
v_mul_f32 v5, s44, v5
v_mfma_f32_16x16x32_bf16 v[184:187], a[88:91], v[52:55], v[184:187]
v_mul_f32 v6, s44, v6
v_mul_f32 v7, s44, v7
v_mfma_f32_16x16x32_bf16 v[188:191], a[92:95], v[52:55], v[188:191]
v_cvt_pk_bf16_f32 v4, v4, v5
v_cvt_pk_bf16_f32 v6, v6, v7
v_mfma_f32_16x16x32_bf16 v[112:115], v[124:127], v[52:55], v[112:115]
s_waitcnt lgkmcnt(0)
v_accvgpr_write_b32 a150, v4
v_accvgpr_write_b32 a151, v6
v_mfma_f32_16x16x32_bf16 v[16:19], a[0:3], a[32:35], v[64:67]
s_waitcnt vmcnt(44)
v_cvt_pk_bf16_f32 v59, v38, v39
v_accvgpr_read_b32 v4, a176
v_mfma_f32_16x16x32_bf16 v[16:19], a[4:7], a[36:39], v[16:19]
s_mov_b32 m0, 65536
v_accvgpr_read_b32 v5, a177
v_accvgpr_read_b32 v6, a178
v_mfma_f32_16x16x32_bf16 v[16:19], a[8:11], a[40:43], v[16:19]
buffer_load_dwordx4 v236, s[16:19], s34 offen offset:0 nt lds
v_accvgpr_read_b32 v7, a179
v_mfma_f32_16x16x32_bf16 v[16:19], a[12:15], a[44:47], v[16:19]
v_mul_f32 v4, s44, v4
v_mul_f32 v5, s44, v5
v_mfma_f32_16x16x32_bf16 v[20:23], a[16:19], a[32:35], v[64:67]
v_mul_f32 v6, s44, v6
v_mul_f32 v7, s44, v7
v_mfma_f32_16x16x32_bf16 v[20:23], a[20:23], a[36:39], v[20:23]
buffer_load_dwordx4 v237, s[16:19], s34 offen offset:1024 nt lds
v_cvt_pk_bf16_f32 v4, v4, v5
v_mfma_f32_16x16x32_bf16 v[20:23], a[24:27], a[40:43], v[20:23]
v_cvt_pk_bf16_f32 v6, v6, v7
v_accvgpr_write_b32 a152, v4
v_mfma_f32_16x16x32_bf16 v[20:23], a[28:31], a[44:47], v[20:23]
v_accvgpr_write_b32 a153, v6
v_accvgpr_read_b32 v4, a180
v_mfma_f32_16x16x32_bf16 v[24:27], a[0:3], a[48:51], v[68:71]
buffer_load_dwordx4 v236, s[16:19], s34 offen offset:2048 nt lds
v_accvgpr_read_b32 v5, a181
v_mfma_f32_16x16x32_bf16 v[24:27], a[4:7], a[52:55], v[24:27]
v_exp_f32 v16, v16
v_mfma_f32_16x16x32_bf16 v[24:27], a[8:11], a[56:59], v[24:27]
v_exp_f32 v17, v17
v_mfma_f32_16x16x32_bf16 v[24:27], a[12:15], a[60:63], v[24:27]
buffer_load_dwordx4 v237, s[16:19], s34 offen offset:3072 nt lds
v_cvt_pk_bf16_f32 v48, v16, v17
v_mfma_f32_16x16x32_bf16 v[28:31], a[16:19], a[48:51], v[68:71]
v_exp_f32 v18, v18
v_mfma_f32_16x16x32_bf16 v[28:31], a[20:23], a[52:55], v[28:31]
s_mov_b32 m0, 69632
s_add_u32 s92, s34, 4096
v_exp_f32 v19, v19
v_mfma_f32_16x16x32_bf16 v[28:31], a[24:27], a[56:59], v[28:31]
buffer_load_dwordx4 v236, s[16:19], s92 offen offset:0 nt lds
v_exp_f32 v20, v20
v_mfma_f32_16x16x32_bf16 v[28:31], a[28:31], a[60:63], v[28:31]
v_exp_f32 v21, v21
v_mfma_f32_16x16x32_bf16 v[192:195], a[64:67], v[56:59], v[192:195]
v_exp_f32 v22, v22
v_mfma_f32_16x16x32_bf16 v[196:199], a[68:71], v[56:59], v[196:199]
buffer_load_dwordx4 v237, s[16:19], s92 offen offset:1024 nt lds
v_cvt_pk_bf16_f32 v49, v18, v19
v_mfma_f32_16x16x32_bf16 v[200:203], a[72:75], v[56:59], v[200:203]
v_exp_f32 v23, v23
v_mfma_f32_16x16x32_bf16 v[204:207], a[76:79], v[56:59], v[204:207]
v_exp_f32 v24, v24
v_mfma_f32_16x16x32_bf16 v[208:211], a[80:83], v[56:59], v[208:211]
buffer_load_dwordx4 v236, s[16:19], s92 offen offset:2048 nt lds
v_exp_f32 v25, v25
v_mfma_f32_16x16x32_bf16 v[212:215], a[84:87], v[56:59], v[212:215]
v_exp_f32 v26, v26
v_mfma_f32_16x16x32_bf16 v[216:219], a[88:91], v[56:59], v[216:219]
v_exp_f32 v27, v27
v_mfma_f32_16x16x32_bf16 v[220:223], a[92:95], v[56:59], v[220:223]
buffer_load_dwordx4 v237, s[16:19], s92 offen offset:3072 nt lds
v_cvt_pk_bf16_f32 v50, v20, v21
v_mfma_f32_16x16x32_bf16 v[116:119], v[124:127], v[56:59], v[116:119]
v_exp_f32 v28, v28
v_exp_f32 v29, v29
ds_read_b64_tr_b16 a[64:65], v88 offset:32768
v_cvt_pk_bf16_f32 v51, v22, v23
ds_read_b64_tr_b16 a[66:67], v88 offset:36864
v_cvt_pk_bf16_f32 v52, v24, v25
ds_read_b64_tr_b16 a[68:69], v89 offset:32768
v_cvt_pk_bf16_f32 v53, v26, v27
ds_read_b64_tr_b16 a[70:71], v89 offset:36864
v_cvt_pk_bf16_f32 v54, v28, v29
ds_read_b64_tr_b16 a[72:73], v90 offset:32768
ds_read_b64_tr_b16 a[74:75], v90 offset:36864
ds_read_b64_tr_b16 a[76:77], v91 offset:32768
ds_read_b64_tr_b16 a[78:79], v91 offset:36864
v_mfma_f32_16x16x32_bf16 v[32:35], a[0:3], a[96:99], v[72:75]
ds_read_b64_tr_b16 a[80:81], v92 offset:32768
s_mov_b32 m0, 73728
s_add_u32 s92, s34, 8192
v_accvgpr_read_b32 v6, a182
v_mfma_f32_16x16x32_bf16 v[32:35], a[4:7], a[100:103], v[32:35]
ds_read_b64_tr_b16 a[82:83], v92 offset:36864
buffer_load_dwordx4 v236, s[16:19], s92 offen offset:0 nt lds
v_mfma_f32_16x16x32_bf16 v[32:35], a[8:11], a[104:107], v[32:35]
ds_read_b64_tr_b16 a[84:85], v93 offset:32768
v_accvgpr_read_b32 v7, a183
v_mfma_f32_16x16x32_bf16 v[32:35], a[12:15], a[108:111], v[32:35]
ds_read_b64_tr_b16 a[86:87], v93 offset:36864
v_mul_f32 v4, s44, v4
v_mfma_f32_16x16x32_bf16 v[36:39], a[16:19], a[96:99], v[72:75]
ds_read_b64_tr_b16 a[88:89], v94 offset:32768
buffer_load_dwordx4 v237, s[16:19], s92 offen offset:1024 nt lds
v_mfma_f32_16x16x32_bf16 v[36:39], a[20:23], a[100:103], v[36:39]
ds_read_b64_tr_b16 a[90:91], v94 offset:36864
v_mul_f32 v5, s44, v5
v_mfma_f32_16x16x32_bf16 v[36:39], a[24:27], a[104:107], v[36:39]
ds_read_b64_tr_b16 a[92:93], v95 offset:32768
v_mul_f32 v6, s44, v6
v_mfma_f32_16x16x32_bf16 v[36:39], a[28:31], a[108:111], v[36:39]
ds_read_b64_tr_b16 a[94:95], v95 offset:36864
buffer_load_dwordx4 v236, s[16:19], s92 offen offset:2048 nt lds
v_exp_f32 v30, v30
v_exp_f32 v31, v31
v_exp_f32 v32, v32
v_exp_f32 v33, v33
v_exp_f32 v34, v34
v_exp_f32 v35, v35
v_exp_f32 v36, v36
s_waitcnt lgkmcnt(0)
v_exp_f32 v37, v37
v_mfma_f32_16x16x32_bf16 v[128:131], a[64:67], v[48:51], v[128:131]
ds_read_b128 a[0:3], v84 offset:40960
v_cvt_pk_bf16_f32 v55, v30, v31
v_mfma_f32_16x16x32_bf16 v[132:135], a[68:71], v[48:51], v[132:135]
ds_read_b128 a[4:7], v85 offset:40960
v_cvt_pk_bf16_f32 v56, v32, v33
v_mfma_f32_16x16x32_bf16 v[136:139], a[72:75], v[48:51], v[136:139]
ds_read_b128 a[8:11], v86 offset:40960
buffer_load_dwordx4 v237, s[16:19], s92 offen offset:3072 nt lds
v_cvt_pk_bf16_f32 v57, v34, v35
v_mfma_f32_16x16x32_bf16 v[140:143], a[76:79], v[48:51], v[140:143]
ds_read_b128 a[12:15], v87 offset:40960
v_cvt_pk_bf16_f32 v58, v36, v37
v_mfma_f32_16x16x32_bf16 v[144:147], a[80:83], v[48:51], v[144:147]
ds_read_b128 a[16:19], v84 offset:45056
s_mov_b32 m0, 77824
s_add_u32 s92, s34, 12288
v_mul_f32 v7, s44, v7
v_mfma_f32_16x16x32_bf16 v[148:151], a[84:87], v[48:51], v[148:151]
ds_read_b128 a[20:23], v85 offset:45056
buffer_load_dwordx4 v236, s[16:19], s92 offen offset:0 nt lds
v_mfma_f32_16x16x32_bf16 v[152:155], a[88:91], v[48:51], v[152:155]
ds_read_b128 a[24:27], v86 offset:45056
v_cvt_pk_bf16_f32 v4, v4, v5
v_mfma_f32_16x16x32_bf16 v[156:159], a[92:95], v[48:51], v[156:159]
ds_read_b128 a[28:31], v87 offset:45056
v_cvt_pk_bf16_f32 v6, v6, v7
v_mfma_f32_16x16x32_bf16 v[108:111], v[124:127], v[48:51], v[108:111]
buffer_load_dwordx4 v237, s[16:19], s92 offen offset:1024 nt lds
v_exp_f32 v38, v38
v_mfma_f32_16x16x32_bf16 v[160:163], a[64:67], v[52:55], v[160:163]
v_exp_f32 v39, v39
v_mfma_f32_16x16x32_bf16 v[164:167], a[68:71], v[52:55], v[164:167]
v_accvgpr_write_b32 a154, v4
v_accvgpr_write_b32 a155, v6
v_mfma_f32_16x16x32_bf16 v[168:171], a[72:75], v[52:55], v[168:171]
buffer_load_dwordx4 v236, s[16:19], s92 offen offset:2048 nt lds
v_accvgpr_read_b32 v4, a184
v_mfma_f32_16x16x32_bf16 v[172:175], a[76:79], v[52:55], v[172:175]
v_accvgpr_read_b32 v5, a185
v_accvgpr_read_b32 v6, a186
v_mfma_f32_16x16x32_bf16 v[176:179], a[80:83], v[52:55], v[176:179]
s_add_u32 s34, s34, 16384
v_accvgpr_read_b32 v7, a187
v_mul_f32 v4, s44, v4
v_mfma_f32_16x16x32_bf16 v[180:183], a[84:87], v[52:55], v[180:183]
buffer_load_dwordx4 v237, s[16:19], s92 offen offset:3072 nt lds
v_mul_f32 v5, s44, v5
v_mfma_f32_16x16x32_bf16 v[184:187], a[88:91], v[52:55], v[184:187]
v_mul_f32 v6, s44, v6
v_mul_f32 v7, s44, v7
v_mfma_f32_16x16x32_bf16 v[188:191], a[92:95], v[52:55], v[188:191]
v_cvt_pk_bf16_f32 v4, v4, v5
v_cvt_pk_bf16_f32 v6, v6, v7
v_mfma_f32_16x16x32_bf16 v[112:115], v[124:127], v[52:55], v[112:115]
s_waitcnt lgkmcnt(0)
v_accvgpr_write_b32 a156, v4
v_accvgpr_write_b32 a157, v6
v_mfma_f32_16x16x32_bf16 v[16:19], a[0:3], a[32:35], v[64:67]
v_cvt_pk_bf16_f32 v59, v38, v39
v_accvgpr_read_b32 v4, a188
v_accvgpr_read_b32 v5, a189
v_mfma_f32_16x16x32_bf16 v[16:19], a[4:7], a[36:39], v[16:19]
s_mov_b32 m0, 16384
v_accvgpr_read_b32 v6, a190
v_accvgpr_read_b32 v7, a191
v_mfma_f32_16x16x32_bf16 v[16:19], a[8:11], a[40:43], v[16:19]
buffer_load_dwordx4 v234, s[12:15], s34 offen offset:0 nt lds
v_mul_f32 v4, s44, v4
v_mfma_f32_16x16x32_bf16 v[16:19], a[12:15], a[44:47], v[16:19]
v_mul_f32 v5, s44, v5
v_mul_f32 v6, s44, v6
v_mfma_f32_16x16x32_bf16 v[20:23], a[16:19], a[32:35], v[64:67]
v_mul_f32 v7, s44, v7
v_cvt_pk_bf16_f32 v4, v4, v5
v_mfma_f32_16x16x32_bf16 v[20:23], a[20:23], a[36:39], v[20:23]
s_add_u32 s39, s39, 1
buffer_load_dwordx4 v235, s[12:15], s34 offen offset:1024 nt lds
v_cvt_pk_bf16_f32 v6, v6, v7
v_mfma_f32_16x16x32_bf16 v[20:23], a[24:27], a[40:43], v[20:23]
v_mov_b32 v80, s39
v_accvgpr_write_b32 a158, v4
v_mfma_f32_16x16x32_bf16 v[20:23], a[28:31], a[44:47], v[20:23]
v_accvgpr_write_b32 a159, v6
v_accvgpr_read_b32 v4, a192
v_mfma_f32_16x16x32_bf16 v[24:27], a[0:3], a[48:51], v[68:71]
s_waitcnt vmcnt(43)
ds_write_b32 v1, v80
buffer_load_dwordx4 v232, s[12:15], s34 offen offset:2048 nt lds
v_mfma_f32_16x16x32_bf16 v[24:27], a[4:7], a[52:55], v[24:27]
v_exp_f32 v16, v16
v_mfma_f32_16x16x32_bf16 v[24:27], a[8:11], a[56:59], v[24:27]
v_exp_f32 v17, v17
v_mfma_f32_16x16x32_bf16 v[24:27], a[12:15], a[60:63], v[24:27]
buffer_load_dwordx4 v233, s[12:15], s34 offen offset:3072 nt lds
v_cvt_pk_bf16_f32 v48, v16, v17
v_mfma_f32_16x16x32_bf16 v[28:31], a[16:19], a[48:51], v[68:71]
v_exp_f32 v18, v18
v_accvgpr_read_b32 v5, a193
v_mfma_f32_16x16x32_bf16 v[28:31], a[20:23], a[52:55], v[28:31]
s_mov_b32 m0, 20480
s_add_u32 s92, s34, 4096
v_exp_f32 v19, v19
v_mfma_f32_16x16x32_bf16 v[28:31], a[24:27], a[56:59], v[28:31]
buffer_load_dwordx4 v234, s[12:15], s92 offen offset:0 nt lds
v_exp_f32 v20, v20
v_mfma_f32_16x16x32_bf16 v[28:31], a[28:31], a[60:63], v[28:31]
v_exp_f32 v21, v21
v_mfma_f32_16x16x32_bf16 v[192:195], a[64:67], v[56:59], v[192:195]
v_exp_f32 v22, v22
v_mfma_f32_16x16x32_bf16 v[196:199], a[68:71], v[56:59], v[196:199]
buffer_load_dwordx4 v235, s[12:15], s92 offen offset:1024 nt lds
v_cvt_pk_bf16_f32 v49, v18, v19
v_mfma_f32_16x16x32_bf16 v[200:203], a[72:75], v[56:59], v[200:203]
v_exp_f32 v23, v23
v_mfma_f32_16x16x32_bf16 v[204:207], a[76:79], v[56:59], v[204:207]
v_exp_f32 v24, v24
v_mfma_f32_16x16x32_bf16 v[208:211], a[80:83], v[56:59], v[208:211]
buffer_load_dwordx4 v232, s[12:15], s92 offen offset:2048 nt lds
v_exp_f32 v25, v25
v_mfma_f32_16x16x32_bf16 v[212:215], a[84:87], v[56:59], v[212:215]
v_exp_f32 v26, v26
v_mfma_f32_16x16x32_bf16 v[216:219], a[88:91], v[56:59], v[216:219]
v_exp_f32 v27, v27
v_mfma_f32_16x16x32_bf16 v[220:223], a[92:95], v[56:59], v[220:223]
buffer_load_dwordx4 v233, s[12:15], s92 offen offset:3072 nt lds
v_cvt_pk_bf16_f32 v50, v20, v21
v_mfma_f32_16x16x32_bf16 v[116:119], v[124:127], v[56:59], v[116:119]
v_exp_f32 v28, v28
v_exp_f32 v29, v29
ds_read_b64_tr_b16 a[64:65], v88 offset:40960
v_cvt_pk_bf16_f32 v51, v22, v23
ds_read_b64_tr_b16 a[66:67], v88 offset:45056
v_cvt_pk_bf16_f32 v52, v24, v25
ds_read_b64_tr_b16 a[68:69], v89 offset:40960
v_cvt_pk_bf16_f32 v53, v26, v27
ds_read_b64_tr_b16 a[70:71], v89 offset:45056
v_cvt_pk_bf16_f32 v54, v28, v29
ds_read_b64_tr_b16 a[72:73], v90 offset:40960
ds_read_b64_tr_b16 a[74:75], v90 offset:45056
ds_read_b64_tr_b16 a[76:77], v91 offset:40960
ds_read_b64_tr_b16 a[78:79], v91 offset:45056
v_mfma_f32_16x16x32_bf16 v[32:35], a[0:3], a[96:99], v[72:75]
ds_read_b64_tr_b16 a[80:81], v92 offset:40960
s_mov_b32 m0, 24576
s_add_u32 s92, s34, 8192
v_accvgpr_read_b32 v6, a194
v_accvgpr_read_b32 v7, a195
v_mfma_f32_16x16x32_bf16 v[32:35], a[4:7], a[100:103], v[32:35]
ds_read_b64_tr_b16 a[82:83], v92 offset:45056
ds_read_b128 v[80:83], v101
buffer_load_dwordx4 v234, s[12:15], s92 offen offset:0 nt lds
v_mfma_f32_16x16x32_bf16 v[32:35], a[8:11], a[104:107], v[32:35]
ds_read_b64_tr_b16 a[84:85], v93 offset:40960
v_mul_f32 v4, s44, v4
v_mfma_f32_16x16x32_bf16 v[32:35], a[12:15], a[108:111], v[32:35]
ds_read_b64_tr_b16 a[86:87], v93 offset:45056
v_mul_f32 v5, s44, v5
v_mfma_f32_16x16x32_bf16 v[36:39], a[16:19], a[96:99], v[72:75]
s_waitcnt lgkmcnt(2)
ds_read_b64_tr_b16 a[88:89], v94 offset:40960
buffer_load_dwordx4 v235, s[12:15], s92 offen offset:1024 nt lds
v_min3_u32 v80, v80, v81, v82
v_mfma_f32_16x16x32_bf16 v[36:39], a[20:23], a[100:103], v[36:39]
ds_read_b64_tr_b16 a[90:91], v94 offset:45056
v_min_u32 v80, v80, v83
v_mfma_f32_16x16x32_bf16 v[36:39], a[24:27], a[104:107], v[36:39]
ds_read_b64_tr_b16 a[92:93], v95 offset:40960
v_cmp_gt_u32 vcc, s39, v80
v_mfma_f32_16x16x32_bf16 v[36:39], a[28:31], a[108:111], v[36:39]
s_cbranch_vccnz L_fs5_3
L_fr5_3:
ds_read_b64_tr_b16 a[94:95], v95 offset:45056
buffer_load_dwordx4 v232, s[12:15], s92 offen offset:2048 nt lds
v_exp_f32 v30, v30
v_exp_f32 v31, v31
v_exp_f32 v32, v32
v_exp_f32 v33, v33
v_exp_f32 v34, v34
v_exp_f32 v35, v35
v_exp_f32 v36, v36
s_waitcnt lgkmcnt(0)
v_exp_f32 v37, v37
v_mfma_f32_16x16x32_bf16 v[128:131], a[64:67], v[48:51], v[128:131]
ds_read_b128 a[0:3], v84 offset:49152
v_cvt_pk_bf16_f32 v55, v30, v31
v_mfma_f32_16x16x32_bf16 v[132:135], a[68:71], v[48:51], v[132:135]
ds_read_b128 a[4:7], v85 offset:49152
v_cvt_pk_bf16_f32 v56, v32, v33
v_mfma_f32_16x16x32_bf16 v[136:139], a[72:75], v[48:51], v[136:139]
ds_read_b128 a[8:11], v86 offset:49152
buffer_load_dwordx4 v233, s[12:15], s92 offen offset:3072 nt lds
v_cvt_pk_bf16_f32 v57, v34, v35
v_mfma_f32_16x16x32_bf16 v[140:143], a[76:79], v[48:51], v[140:143]
ds_read_b128 a[12:15], v87 offset:49152
v_cvt_pk_bf16_f32 v58, v36, v37
v_mfma_f32_16x16x32_bf16 v[144:147], a[80:83], v[48:51], v[144:147]
ds_read_b128 a[16:19], v84 offset:53248
s_mov_b32 m0, 28672
s_add_u32 s92, s34, 12288
v_mul_f32 v6, s44, v6
v_mfma_f32_16x16x32_bf16 v[148:151], a[84:87], v[48:51], v[148:151]
ds_read_b128 a[20:23], v85 offset:53248
buffer_load_dwordx4 v234, s[12:15], s92 offen offset:0 nt lds
v_mul_f32 v7, s44, v7
v_mfma_f32_16x16x32_bf16 v[152:155], a[88:91], v[48:51], v[152:155]
ds_read_b128 a[24:27], v86 offset:53248
v_cvt_pk_bf16_f32 v4, v4, v5
v_mfma_f32_16x16x32_bf16 v[156:159], a[92:95], v[48:51], v[156:159]
ds_read_b128 a[28:31], v87 offset:53248
v_cvt_pk_bf16_f32 v6, v6, v7
v_mfma_f32_16x16x32_bf16 v[108:111], v[124:127], v[48:51], v[108:111]
buffer_load_dwordx4 v235, s[12:15], s92 offen offset:1024 nt lds
v_exp_f32 v38, v38
v_mfma_f32_16x16x32_bf16 v[160:163], a[64:67], v[52:55], v[160:163]
v_exp_f32 v39, v39
v_mfma_f32_16x16x32_bf16 v[164:167], a[68:71], v[52:55], v[164:167]
v_accvgpr_write_b32 a160, v4
v_accvgpr_write_b32 a161, v6
v_mfma_f32_16x16x32_bf16 v[168:171], a[72:75], v[52:55], v[168:171]
buffer_load_dwordx4 v232, s[12:15], s92 offen offset:2048 nt lds
v_accvgpr_read_b32 v4, a196
v_mfma_f32_16x16x32_bf16 v[172:175], a[76:79], v[52:55], v[172:175]
v_accvgpr_read_b32 v5, a197
v_accvgpr_read_b32 v6, a198
v_mfma_f32_16x16x32_bf16 v[176:179], a[80:83], v[52:55], v[176:179]
v_accvgpr_read_b32 v7, a199
v_mul_f32 v4, s44, v4
v_mfma_f32_16x16x32_bf16 v[180:183], a[84:87], v[52:55], v[180:183]
buffer_load_dwordx4 v233, s[12:15], s92 offen offset:3072 nt lds
v_mul_f32 v5, s44, v5
v_mfma_f32_16x16x32_bf16 v[184:187], a[88:91], v[52:55], v[184:187]
v_mul_f32 v6, s44, v6
v_mul_f32 v7, s44, v7
v_mfma_f32_16x16x32_bf16 v[188:191], a[92:95], v[52:55], v[188:191]
v_cvt_pk_bf16_f32 v4, v4, v5
v_cvt_pk_bf16_f32 v6, v6, v7
v_mfma_f32_16x16x32_bf16 v[112:115], v[124:127], v[52:55], v[112:115]
s_waitcnt lgkmcnt(0)
v_accvgpr_write_b32 a162, v4
v_accvgpr_write_b32 a163, v6
v_mfma_f32_16x16x32_bf16 v[16:19], a[0:3], a[32:35], v[64:67]
s_waitcnt vmcnt(44)
v_cvt_pk_bf16_f32 v59, v38, v39
v_accvgpr_read_b32 v4, a200
v_mfma_f32_16x16x32_bf16 v[16:19], a[4:7], a[36:39], v[16:19]
s_mov_b32 m0, 81920
v_accvgpr_read_b32 v5, a201
v_accvgpr_read_b32 v6, a202
v_mfma_f32_16x16x32_bf16 v[16:19], a[8:11], a[40:43], v[16:19]
buffer_load_dwordx4 v236, s[16:19], s34 offen offset:0 nt lds
v_accvgpr_read_b32 v7, a203
v_mfma_f32_16x16x32_bf16 v[16:19], a[12:15], a[44:47], v[16:19]
v_mul_f32 v4, s44, v4
v_mul_f32 v5, s44, v5
v_mfma_f32_16x16x32_bf16 v[20:23], a[16:19], a[32:35], v[64:67]
v_mul_f32 v6, s44, v6
v_mul_f32 v7, s44, v7
v_mfma_f32_16x16x32_bf16 v[20:23], a[20:23], a[36:39], v[20:23]
buffer_load_dwordx4 v237, s[16:19], s34 offen offset:1024 nt lds
v_cvt_pk_bf16_f32 v4, v4, v5
v_mfma_f32_16x16x32_bf16 v[20:23], a[24:27], a[40:43], v[20:23]
v_cvt_pk_bf16_f32 v6, v6, v7
v_accvgpr_write_b32 a164, v4
v_mfma_f32_16x16x32_bf16 v[20:23], a[28:31], a[44:47], v[20:23]
v_accvgpr_write_b32 a165, v6
v_accvgpr_read_b32 v4, a204
v_mfma_f32_16x16x32_bf16 v[24:27], a[0:3], a[48:51], v[68:71]
buffer_load_dwordx4 v236, s[16:19], s34 offen offset:2048 nt lds
v_accvgpr_read_b32 v5, a205
v_mfma_f32_16x16x32_bf16 v[24:27], a[4:7], a[52:55], v[24:27]
v_exp_f32 v16, v16
v_mfma_f32_16x16x32_bf16 v[24:27], a[8:11], a[56:59], v[24:27]
v_exp_f32 v17, v17
v_mfma_f32_16x16x32_bf16 v[24:27], a[12:15], a[60:63], v[24:27]
buffer_load_dwordx4 v237, s[16:19], s34 offen offset:3072 nt lds
v_cvt_pk_bf16_f32 v48, v16, v17
v_mfma_f32_16x16x32_bf16 v[28:31], a[16:19], a[48:51], v[68:71]
v_exp_f32 v18, v18
v_mfma_f32_16x16x32_bf16 v[28:31], a[20:23], a[52:55], v[28:31]
s_mov_b32 m0, 86016
s_add_u32 s92, s34, 4096
v_exp_f32 v19, v19
v_mfma_f32_16x16x32_bf16 v[28:31], a[24:27], a[56:59], v[28:31]
buffer_load_dwordx4 v236, s[16:19], s92 offen offset:0 nt lds
v_exp_f32 v20, v20
v_mfma_f32_16x16x32_bf16 v[28:31], a[28:31], a[60:63], v[28:31]
v_exp_f32 v21, v21
v_mfma_f32_16x16x32_bf16 v[192:195], a[64:67], v[56:59], v[192:195]
v_exp_f32 v22, v22
v_mfma_f32_16x16x32_bf16 v[196:199], a[68:71], v[56:59], v[196:199]
buffer_load_dwordx4 v237, s[16:19], s92 offen offset:1024 nt lds
v_cvt_pk_bf16_f32 v49, v18, v19
v_mfma_f32_16x16x32_bf16 v[200:203], a[72:75], v[56:59], v[200:203]
v_exp_f32 v23, v23
v_mfma_f32_16x16x32_bf16 v[204:207], a[76:79], v[56:59], v[204:207]
v_exp_f32 v24, v24
v_mfma_f32_16x16x32_bf16 v[208:211], a[80:83], v[56:59], v[208:211]
buffer_load_dwordx4 v236, s[16:19], s92 offen offset:2048 nt lds
v_exp_f32 v25, v25
v_mfma_f32_16x16x32_bf16 v[212:215], a[84:87], v[56:59], v[212:215]
v_exp_f32 v26, v26
v_mfma_f32_16x16x32_bf16 v[216:219], a[88:91], v[56:59], v[216:219]
v_exp_f32 v27, v27
v_mfma_f32_16x16x32_bf16 v[220:223], a[92:95], v[56:59], v[220:223]
buffer_load_dwordx4 v237, s[16:19], s92 offen offset:3072 nt lds
v_cvt_pk_bf16_f32 v50, v20, v21
v_mfma_f32_16x16x32_bf16 v[116:119], v[124:127], v[56:59], v[116:119]
v_exp_f32 v28, v28
v_exp_f32 v29, v29
ds_read_b64_tr_b16 a[64:65], v88 offset:49152
v_cvt_pk_bf16_f32 v51, v22, v23
ds_read_b64_tr_b16 a[66:67], v88 offset:53248
v_cvt_pk_bf16_f32 v52, v24, v25
ds_read_b64_tr_b16 a[68:69], v89 offset:49152
v_cvt_pk_bf16_f32 v53, v26, v27
ds_read_b64_tr_b16 a[70:71], v89 offset:53248
v_cvt_pk_bf16_f32 v54, v28, v29
ds_read_b64_tr_b16 a[72:73], v90 offset:49152
ds_read_b64_tr_b16 a[74:75], v90 offset:53248
ds_read_b64_tr_b16 a[76:77], v91 offset:49152
ds_read_b64_tr_b16 a[78:79], v91 offset:53248
v_mfma_f32_16x16x32_bf16 v[32:35], a[0:3], a[96:99], v[72:75]
ds_read_b64_tr_b16 a[80:81], v92 offset:49152
s_mov_b32 m0, 90112
s_add_u32 s92, s34, 8192
v_accvgpr_read_b32 v6, a206
v_mfma_f32_16x16x32_bf16 v[32:35], a[4:7], a[100:103], v[32:35]
ds_read_b64_tr_b16 a[82:83], v92 offset:53248
buffer_load_dwordx4 v236, s[16:19], s92 offen offset:0 nt lds
v_mfma_f32_16x16x32_bf16 v[32:35], a[8:11], a[104:107], v[32:35]
ds_read_b64_tr_b16 a[84:85], v93 offset:49152
v_accvgpr_read_b32 v7, a207
v_mfma_f32_16x16x32_bf16 v[32:35], a[12:15], a[108:111], v[32:35]
ds_read_b64_tr_b16 a[86:87], v93 offset:53248
v_mul_f32 v4, s44, v4
v_mfma_f32_16x16x32_bf16 v[36:39], a[16:19], a[96:99], v[72:75]
ds_read_b64_tr_b16 a[88:89], v94 offset:49152
buffer_load_dwordx4 v237, s[16:19], s92 offen offset:1024 nt lds
v_mfma_f32_16x16x32_bf16 v[36:39], a[20:23], a[100:103], v[36:39]
ds_read_b64_tr_b16 a[90:91], v94 offset:53248
v_mul_f32 v5, s44, v5
v_mfma_f32_16x16x32_bf16 v[36:39], a[24:27], a[104:107], v[36:39]
ds_read_b64_tr_b16 a[92:93], v95 offset:49152
v_mul_f32 v6, s44, v6
v_mfma_f32_16x16x32_bf16 v[36:39], a[28:31], a[108:111], v[36:39]
ds_read_b64_tr_b16 a[94:95], v95 offset:53248
buffer_load_dwordx4 v236, s[16:19], s92 offen offset:2048 nt lds
v_exp_f32 v30, v30
v_exp_f32 v31, v31
v_exp_f32 v32, v32
v_exp_f32 v33, v33
s_waitcnt vmcnt(63)
v_exp_f32 v34, v34
v_exp_f32 v35, v35
v_readfirstlane_b32 s46, v106
s_nop 3
s_cmp_eq_u32 s46, 0
s_cbranch_scc1 L_hspin
L_hsok:
v_exp_f32 v36, v36
s_waitcnt lgkmcnt(0)
v_exp_f32 v37, v37
v_mfma_f32_16x16x32_bf16 v[128:131], a[64:67], v[48:51], v[128:131]
ds_read_b128 a[0:3], v84 offset:57344
v_cvt_pk_bf16_f32 v55, v30, v31
v_mfma_f32_16x16x32_bf16 v[132:135], a[68:71], v[48:51], v[132:135]
ds_read_b128 a[4:7], v85 offset:57344
v_cvt_pk_bf16_f32 v56, v32, v33
v_mfma_f32_16x16x32_bf16 v[136:139], a[72:75], v[48:51], v[136:139]
ds_read_b128 a[8:11], v86 offset:57344
buffer_load_dwordx4 v237, s[16:19], s92 offen offset:3072 nt lds
v_cvt_pk_bf16_f32 v57, v34, v35
v_mfma_f32_16x16x32_bf16 v[140:143], a[76:79], v[48:51], v[140:143]
ds_read_b128 a[12:15], v87 offset:57344
v_cvt_pk_bf16_f32 v58, v36, v37
v_mfma_f32_16x16x32_bf16 v[144:147], a[80:83], v[48:51], v[144:147]
ds_read_b128 a[16:19], v84 offset:61440
s_mov_b32 m0, 94208
s_add_u32 s92, s34, 12288
v_mul_f32 v7, s44, v7
v_mfma_f32_16x16x32_bf16 v[148:151], a[84:87], v[48:51], v[148:151]
ds_read_b128 a[20:23], v85 offset:61440
buffer_load_dwordx4 v236, s[16:19], s92 offen offset:0 nt lds
v_mfma_f32_16x16x32_bf16 v[152:155], a[88:91], v[48:51], v[152:155]
ds_read_b128 a[24:27], v86 offset:61440
v_cvt_pk_bf16_f32 v4, v4, v5
v_mfma_f32_16x16x32_bf16 v[156:159], a[92:95], v[48:51], v[156:159]
ds_read_b128 a[28:31], v87 offset:61440
v_cvt_pk_bf16_f32 v6, v6, v7
v_mfma_f32_16x16x32_bf16 v[108:111], v[124:127], v[48:51], v[108:111]
buffer_load_dwordx4 v237, s[16:19], s92 offen offset:1024 nt lds
v_exp_f32 v38, v38
v_mfma_f32_16x16x32_bf16 v[160:163], a[64:67], v[52:55], v[160:163]
v_exp_f32 v39, v39
v_mfma_f32_16x16x32_bf16 v[164:167], a[68:71], v[52:55], v[164:167]
v_accvgpr_write_b32 a166, v4
v_accvgpr_write_b32 a167, v6
v_mfma_f32_16x16x32_bf16 v[168:171], a[72:75], v[52:55], v[168:171]
buffer_load_dwordx4 v236, s[16:19], s92 offen offset:2048 nt lds
v_accvgpr_read_b32 v4, a208
v_mfma_f32_16x16x32_bf16 v[172:175], a[76:79], v[52:55], v[172:175]
v_accvgpr_read_b32 v5, a209
v_accvgpr_read_b32 v6, a210
v_mfma_f32_16x16x32_bf16 v[176:179], a[80:83], v[52:55], v[176:179]
s_add_u32 s34, s34, 16384
v_accvgpr_read_b32 v7, a211
v_mul_f32 v4, s44, v4
v_mfma_f32_16x16x32_bf16 v[180:183], a[84:87], v[52:55], v[180:183]
buffer_load_dwordx4 v237, s[16:19], s92 offen offset:3072 nt lds
v_mul_f32 v5, s44, v5
v_mfma_f32_16x16x32_bf16 v[184:187], a[88:91], v[52:55], v[184:187]
v_mul_f32 v6, s44, v6
v_mul_f32 v7, s44, v7
v_mfma_f32_16x16x32_bf16 v[188:191], a[92:95], v[52:55], v[188:191]
v_cvt_pk_bf16_f32 v4, v4, v5
v_cvt_pk_bf16_f32 v6, v6, v7
v_mfma_f32_16x16x32_bf16 v[112:115], v[124:127], v[52:55], v[112:115]
s_waitcnt lgkmcnt(0)
v_accvgpr_write_b32 a168, v4
v_accvgpr_write_b32 a169, v6
v_mfma_f32_16x16x32_bf16 v[16:19], a[0:3], a[32:35], v[64:67]
v_cvt_pk_bf16_f32 v59, v38, v39
v_accvgpr_read_b32 v4, a212
v_accvgpr_read_b32 v5, a213
v_mfma_f32_16x16x32_bf16 v[16:19], a[4:7], a[36:39], v[16:19]
s_mov_b32 m0, 32768
v_accvgpr_read_b32 v6, a214
v_accvgpr_read_b32 v7, a215
v_mfma_f32_16x16x32_bf16 v[16:19], a[8:11], a[40:43], v[16:19]
buffer_load_dwordx4 v234, s[12:15], s34 offen offset:0 nt lds
v_mul_f32 v4, s44, v4
v_mfma_f32_16x16x32_bf16 v[16:19], a[12:15], a[44:47], v[16:19]
v_mul_f32 v5, s44, v5
v_mul_f32 v6, s44, v6
v_mfma_f32_16x16x32_bf16 v[20:23], a[16:19], a[32:35], v[64:67]
v_mul_f32 v7, s44, v7
v_cvt_pk_bf16_f32 v4, v4, v5
v_mfma_f32_16x16x32_bf16 v[20:23], a[20:23], a[36:39], v[20:23]
s_add_u32 s39, s39, 1
buffer_load_dwordx4 v235, s[12:15], s34 offen offset:1024 nt lds
v_cvt_pk_bf16_f32 v6, v6, v7
v_mfma_f32_16x16x32_bf16 v[20:23], a[24:27], a[40:43], v[20:23]
v_mov_b32 v80, s39
v_accvgpr_write_b32 a170, v4
v_mfma_f32_16x16x32_bf16 v[20:23], a[28:31], a[44:47], v[20:23]
v_accvgpr_write_b32 a171, v6
v_accvgpr_read_b32 v4, a216
v_mfma_f32_16x16x32_bf16 v[24:27], a[0:3], a[48:51], v[68:71]
s_waitcnt vmcnt(34)
ds_write_b32 v1, v80
buffer_load_dwordx4 v232, s[12:15], s34 offen offset:2048 nt lds
v_mfma_f32_16x16x32_bf16 v[24:27], a[4:7], a[52:55], v[24:27]
v_exp_f32 v16, v16
v_mfma_f32_16x16x32_bf16 v[24:27], a[8:11], a[56:59], v[24:27]
v_exp_f32 v17, v17
v_mfma_f32_16x16x32_bf16 v[24:27], a[12:15], a[60:63], v[24:27]
buffer_load_dwordx4 v233, s[12:15], s34 offen offset:3072 nt lds
v_cvt_pk_bf16_f32 v48, v16, v17
v_mfma_f32_16x16x32_bf16 v[28:31], a[16:19], a[48:51], v[68:71]
v_exp_f32 v18, v18
v_accvgpr_read_b32 v5, a217
v_mfma_f32_16x16x32_bf16 v[28:31], a[20:23], a[52:55], v[28:31]
s_mov_b32 m0, 36864
s_add_u32 s92, s34, 4096
v_exp_f32 v19, v19
v_mfma_f32_16x16x32_bf16 v[28:31], a[24:27], a[56:59], v[28:31]
buffer_load_dwordx4 v234, s[12:15], s92 offen offset:0 nt lds
v_exp_f32 v20, v20
v_mfma_f32_16x16x32_bf16 v[28:31], a[28:31], a[60:63], v[28:31]
v_exp_f32 v21, v21
v_mfma_f32_16x16x32_bf16 v[192:195], a[64:67], v[56:59], v[192:195]
v_exp_f32 v22, v22
v_mfma_f32_16x16x32_bf16 v[196:199], a[68:71], v[56:59], v[196:199]
buffer_load_dwordx4 v235, s[12:15], s92 offen offset:1024 nt lds
v_cvt_pk_bf16_f32 v49, v18, v19
v_mfma_f32_16x16x32_bf16 v[200:203], a[72:75], v[56:59], v[200:203]
v_exp_f32 v23, v23
v_mfma_f32_16x16x32_bf16 v[204:207], a[76:79], v[56:59], v[204:207]
v_exp_f32 v24, v24
v_mfma_f32_16x16x32_bf16 v[208:211], a[80:83], v[56:59], v[208:211]
buffer_load_dwordx4 v232, s[12:15], s92 offen offset:2048 nt lds
v_exp_f32 v25, v25
v_mfma_f32_16x16x32_bf16 v[212:215], a[84:87], v[56:59], v[212:215]
v_exp_f32 v26, v26
v_mfma_f32_16x16x32_bf16 v[216:219], a[88:91], v[56:59], v[216:219]
v_exp_f32 v27, v27
v_mfma_f32_16x16x32_bf16 v[220:223], a[92:95], v[56:59], v[220:223]
buffer_load_dwordx4 v233, s[12:15], s92 offen offset:3072 nt lds
v_cvt_pk_bf16_f32 v50, v20, v21
v_mfma_f32_16x16x32_bf16 v[116:119], v[124:127], v[56:59], v[116:119]
v_exp_f32 v28, v28
v_exp_f32 v29, v29
ds_read_b64_tr_b16 a[64:65], v88 offset:57344
v_cvt_pk_bf16_f32 v51, v22, v23
ds_read_b64_tr_b16 a[66:67], v88 offset:61440
v_cvt_pk_bf16_f32 v52, v24, v25
ds_read_b64_tr_b16 a[68:69], v89 offset:57344
v_cvt_pk_bf16_f32 v53, v26, v27
ds_read_b64_tr_b16 a[70:71], v89 offset:61440
v_cvt_pk_bf16_f32 v54, v28, v29
ds_read_b64_tr_b16 a[72:73], v90 offset:57344
ds_read_b64_tr_b16 a[74:75], v90 offset:61440
ds_read_b64_tr_b16 a[76:77], v91 offset:57344
ds_read_b64_tr_b16 a[78:79], v91 offset:61440
v_mfma_f32_16x16x32_bf16 v[32:35], a[0:3], a[96:99], v[72:75]
ds_read_b64_tr_b16 a[80:81], v92 offset:57344
s_mov_b32 m0, 40960
s_add_u32 s92, s34, 8192
v_accvgpr_read_b32 v6, a218
v_accvgpr_read_b32 v7, a219
v_mfma_f32_16x16x32_bf16 v[32:35], a[4:7], a[100:103], v[32:35]
ds_read_b64_tr_b16 a[82:83], v92 offset:61440
ds_read_b128 v[80:83], v101
buffer_load_dwordx4 v234, s[12:15], s92 offen offset:0 nt lds
v_mfma_f32_16x16x32_bf16 v[32:35], a[8:11], a[104:107], v[32:35]
ds_read_b64_tr_b16 a[84:85], v93 offset:57344
v_mul_f32 v4, s44, v4
v_mfma_f32_16x16x32_bf16 v[32:35], a[12:15], a[108:111], v[32:35]
ds_read_b64_tr_b16 a[86:87], v93 offset:61440
v_mul_f32 v5, s44, v5
v_mfma_f32_16x16x32_bf16 v[36:39], a[16:19], a[96:99], v[72:75]
s_waitcnt lgkmcnt(2)
ds_read_b64_tr_b16 a[88:89], v94 offset:57344
buffer_load_dwordx4 v235, s[12:15], s92 offen offset:1024 nt lds
v_min3_u32 v80, v80, v81, v82
v_mfma_f32_16x16x32_bf16 v[36:39], a[20:23], a[100:103], v[36:39]
ds_read_b64_tr_b16 a[90:91], v94 offset:61440
v_min_u32 v80, v80, v83
v_mfma_f32_16x16x32_bf16 v[36:39], a[24:27], a[104:107], v[36:39]
ds_read_b64_tr_b16 a[92:93], v95 offset:57344
v_cmp_gt_u32 vcc, s39, v80
v_mfma_f32_16x16x32_bf16 v[36:39], a[28:31], a[108:111], v[36:39]
s_cbranch_vccnz L_fs7_3
L_fr7_3:
ds_read_b64_tr_b16 a[94:95], v95 offset:61440
buffer_load_dwordx4 v232, s[12:15], s92 offen offset:2048 nt lds
v_exp_f32 v30, v30
v_exp_f32 v31, v31
v_exp_f32 v32, v32
v_exp_f32 v33, v33
v_exp_f32 v34, v34
v_exp_f32 v35, v35
v_exp_f32 v36, v36
s_waitcnt lgkmcnt(0)
v_exp_f32 v37, v37
v_mfma_f32_16x16x32_bf16 v[128:131], a[64:67], v[48:51], v[128:131]
ds_read_b128 a[0:3], v84 offset:0
v_cvt_pk_bf16_f32 v55, v30, v31
v_mfma_f32_16x16x32_bf16 v[132:135], a[68:71], v[48:51], v[132:135]
ds_read_b128 a[4:7], v85 offset:0
v_cvt_pk_bf16_f32 v56, v32, v33
v_mfma_f32_16x16x32_bf16 v[136:139], a[72:75], v[48:51], v[136:139]
ds_read_b128 a[8:11], v86 offset:0
buffer_load_dwordx4 v233, s[12:15], s92 offen offset:3072 nt lds
v_cvt_pk_bf16_f32 v57, v34, v35
v_mfma_f32_16x16x32_bf16 v[140:143], a[76:79], v[48:51], v[140:143]
ds_read_b128 a[12:15], v87 offset:0
v_cvt_pk_bf16_f32 v58, v36, v37
v_mfma_f32_16x16x32_bf16 v[144:147], a[80:83], v[48:51], v[144:147]
ds_read_b128 a[16:19], v84 offset:4096
s_mov_b32 m0, 45056
s_add_u32 s92, s34, 12288
v_mul_f32 v6, s44, v6
v_mfma_f32_16x16x32_bf16 v[148:151], a[84:87], v[48:51], v[148:151]
ds_read_b128 a[20:23], v85 offset:4096
buffer_load_dwordx4 v234, s[12:15], s92 offen offset:0 nt lds
v_mul_f32 v7, s44, v7
v_mfma_f32_16x16x32_bf16 v[152:155], a[88:91], v[48:51], v[152:155]
ds_read_b128 a[24:27], v86 offset:4096
v_cvt_pk_bf16_f32 v4, v4, v5
v_mfma_f32_16x16x32_bf16 v[156:159], a[92:95], v[48:51], v[156:159]
ds_read_b128 a[28:31], v87 offset:4096
v_cvt_pk_bf16_f32 v6, v6, v7
v_mfma_f32_16x16x32_bf16 v[108:111], v[124:127], v[48:51], v[108:111]
buffer_load_dwordx4 v235, s[12:15], s92 offen offset:1024 nt lds
v_exp_f32 v38, v38
v_mfma_f32_16x16x32_bf16 v[160:163], a[64:67], v[52:55], v[160:163]
v_exp_f32 v39, v39
v_mfma_f32_16x16x32_bf16 v[164:167], a[68:71], v[52:55], v[164:167]
v_accvgpr_write_b32 a172, v4
v_accvgpr_write_b32 a173, v6
v_mfma_f32_16x16x32_bf16 v[168:171], a[72:75], v[52:55], v[168:171]
buffer_load_dwordx4 v232, s[12:15], s92 offen offset:2048 nt lds
v_accvgpr_read_b32 v4, a220
v_mfma_f32_16x16x32_bf16 v[172:175], a[76:79], v[52:55], v[172:175]
v_accvgpr_read_b32 v5, a221
v_accvgpr_read_b32 v6, a222
v_mfma_f32_16x16x32_bf16 v[176:179], a[80:83], v[52:55], v[176:179]
v_accvgpr_read_b32 v7, a223
v_mul_f32 v4, s44, v4
v_mfma_f32_16x16x32_bf16 v[180:183], a[84:87], v[52:55], v[180:183]
buffer_load_dwordx4 v233, s[12:15], s92 offen offset:3072 nt lds
v_mul_f32 v5, s44, v5
v_mfma_f32_16x16x32_bf16 v[184:187], a[88:91], v[52:55], v[184:187]
v_mul_f32 v6, s44, v6
v_mul_f32 v7, s44, v7
v_mfma_f32_16x16x32_bf16 v[188:191], a[92:95], v[52:55], v[188:191]
v_cvt_pk_bf16_f32 v4, v4, v5
v_cvt_pk_bf16_f32 v6, v6, v7
v_mfma_f32_16x16x32_bf16 v[112:115], v[124:127], v[52:55], v[112:115]
s_waitcnt lgkmcnt(0)
v_accvgpr_write_b32 a174, v4
v_accvgpr_write_b32 a175, v6
L_atin3:
s_mov_b32 s35, 0
.p2align 3
L_at3:
v_mfma_f32_16x16x32_bf16 v[16:19], a[0:3], a[32:35], v[64:67]
s_waitcnt vmcnt(44)
v_cvt_pk_bf16_f32 v59, v38, v39
v_mfma_f32_16x16x32_bf16 v[16:19], a[4:7], a[36:39], v[16:19]
s_mov_b32 m0, 98304
v_mfma_f32_16x16x32_bf16 v[16:19], a[8:11], a[40:43], v[16:19]
buffer_load_dwordx4 v236, s[16:19], s34 offen offset:0 nt lds
v_mfma_f32_16x16x32_bf16 v[16:19], a[12:15], a[44:47], v[16:19]
v_mfma_f32_16x16x32_bf16 v[20:23], a[16:19], a[32:35], v[64:67]
v_mfma_f32_16x16x32_bf16 v[20:23], a[20:23], a[36:39], v[20:23]
buffer_load_dwordx4 v237, s[16:19], s34 offen offset:1024 nt lds
v_mfma_f32_16x16x32_bf16 v[20:23], a[24:27], a[40:43], v[20:23]
v_mfma_f32_16x16x32_bf16 v[20:23], a[28:31], a[44:47], v[20:23]
v_mfma_f32_16x16x32_bf16 v[24:27], a[0:3], a[48:51], v[68:71]
buffer_load_dwordx4 v236, s[16:19], s34 offen offset:2048 nt lds
v_mfma_f32_16x16x32_bf16 v[24:27], a[4:7], a[52:55], v[24:27]
v_exp_f32 v16, v16
v_mfma_f32_16x16x32_bf16 v[24:27], a[8:11], a[56:59], v[24:27]
v_exp_f32 v17, v17
v_mfma_f32_16x16x32_bf16 v[24:27], a[12:15], a[60:63], v[24:27]
buffer_load_dwordx4 v237, s[16:19], s34 offen offset:3072 nt lds
v_cvt_pk_bf16_f32 v48, v16, v17
v_mfma_f32_16x16x32_bf16 v[28:31], a[16:19], a[48:51], v[68:71]
v_exp_f32 v18, v18
v_mfma_f32_16x16x32_bf16 v[28:31], a[20:23], a[52:55], v[28:31]
s_mov_b32 m0, 102400
s_add_u32 s92, s34, 4096
v_exp_f32 v19, v19
v_mfma_f32_16x16x32_bf16 v[28:31], a[24:27], a[56:59], v[28:31]
buffer_load_dwordx4 v236, s[16:19], s92 offen offset:0 nt lds
v_exp_f32 v20, v20
v_mfma_f32_16x16x32_bf16 v[28:31], a[28:31], a[60:63], v[28:31]
v_exp_f32 v21, v21
v_mfma_f32_16x16x32_bf16 v[192:195], a[64:67], v[56:59], v[192:195]
v_exp_f32 v22, v22
v_mfma_f32_16x16x32_bf16 v[196:199], a[68:71], v[56:59], v[196:199]
buffer_load_dwordx4 v237, s[16:19], s92 offen offset:1024 nt lds
v_cvt_pk_bf16_f32 v49, v18, v19
v_mfma_f32_16x16x32_bf16 v[200:203], a[72:75], v[56:59], v[200:203]
v_exp_f32 v23, v23
v_mfma_f32_16x16x32_bf16 v[204:207], a[76:79], v[56:59], v[204:207]
v_exp_f32 v24, v24
v_mfma_f32_16x16x32_bf16 v[208:211], a[80:83], v[56:59], v[208:211]
buffer_load_dwordx4 v236, s[16:19], s92 offen offset:2048 nt lds
v_exp_f32 v25, v25
v_mfma_f32_16x16x32_bf16 v[212:215], a[84:87], v[56:59], v[212:215]
v_exp_f32 v26, v26
v_mfma_f32_16x16x32_bf16 v[216:219], a[88:91], v[56:59], v[216:219]
v_exp_f32 v27, v27
v_mfma_f32_16x16x32_bf16 v[220:223], a[92:95], v[56:59], v[220:223]
buffer_load_dwordx4 v237, s[16:19], s92 offen offset:3072 nt lds
v_cvt_pk_bf16_f32 v50, v20, v21
v_mfma_f32_16x16x32_bf16 v[116:119], v[124:127], v[56:59], v[116:119]
v_exp_f32 v28, v28
v_exp_f32 v29, v29
ds_read_b64_tr_b16 a[64:65], v88 offset:0
v_cvt_pk_bf16_f32 v51, v22, v23
ds_read_b64_tr_b16 a[66:67], v88 offset:4096
v_cvt_pk_bf16_f32 v52, v24, v25
ds_read_b64_tr_b16 a[68:69], v89 offset:0
v_cvt_pk_bf16_f32 v53, v26, v27
ds_read_b64_tr_b16 a[70:71], v89 offset:4096
v_cvt_pk_bf16_f32 v54, v28, v29
ds_read_b64_tr_b16 a[72:73], v90 offset:0
ds_read_b64_tr_b16 a[74:75], v90 offset:4096
ds_read_b64_tr_b16 a[76:77], v91 offset:0
ds_read_b64_tr_b16 a[78:79], v91 offset:4096
v_mfma_f32_16x16x32_bf16 v[32:35], a[0:3], a[96:99], v[72:75]
ds_read_b64_tr_b16 a[80:81], v92 offset:0
s_mov_b32 m0, 106496
s_add_u32 s92, s34, 8192
v_mfma_f32_16x16x32_bf16 v[32:35], a[4:7], a[100:103], v[32:35]
ds_read_b64_tr_b16 a[82:83], v92 offset:4096
buffer_load_dwordx4 v236, s[16:19], s92 offen offset:0 nt lds
v_mfma_f32_16x16x32_bf16 v[32:35], a[8:11], a[104:107], v[32:35]
ds_read_b64_tr_b16 a[84:85], v93 offset:0
v_mfma_f32_16x16x32_bf16 v[32:35], a[12:15], a[108:111], v[32:35]
ds_read_b64_tr_b16 a[86:87], v93 offset:4096
v_mfma_f32_16x16x32_bf16 v[36:39], a[16:19], a[96:99], v[72:75]
ds_read_b64_tr_b16 a[88:89], v94 offset:0
buffer_load_dwordx4 v237, s[16:19], s92 offen offset:1024 nt lds
v_mfma_f32_16x16x32_bf16 v[36:39], a[20:23], a[100:103], v[36:39]
ds_read_b64_tr_b16 a[90:91], v94 offset:4096
v_mfma_f32_16x16x32_bf16 v[36:39], a[24:27], a[104:107], v[36:39]
ds_read_b64_tr_b16 a[92:93], v95 offset:0
v_mfma_f32_16x16x32_bf16 v[36:39], a[28:31], a[108:111], v[36:39]
ds_read_b64_tr_b16 a[94:95], v95 offset:4096
buffer_load_dwordx4 v236, s[16:19], s92 offen offset:2048 nt lds
v_exp_f32 v30, v30
v_exp_f32 v31, v31
v_exp_f32 v32, v32
v_exp_f32 v33, v33
v_exp_f32 v34, v34
v_exp_f32 v35, v35
v_exp_f32 v36, v36
s_waitcnt lgkmcnt(0)
v_exp_f32 v37, v37
v_mfma_f32_16x16x32_bf16 v[128:131], a[64:67], v[48:51], v[128:131]
ds_read_b128 a[0:3], v84 offset:8192
v_cvt_pk_bf16_f32 v55, v30, v31
v_mfma_f32_16x16x32_bf16 v[132:135], a[68:71], v[48:51], v[132:135]
ds_read_b128 a[4:7], v85 offset:8192
v_cvt_pk_bf16_f32 v56, v32, v33
v_mfma_f32_16x16x32_bf16 v[136:139], a[72:75], v[48:51], v[136:139]
ds_read_b128 a[8:11], v86 offset:8192
buffer_load_dwordx4 v237, s[16:19], s92 offen offset:3072 nt lds
v_cvt_pk_bf16_f32 v57, v34, v35
v_mfma_f32_16x16x32_bf16 v[140:143], a[76:79], v[48:51], v[140:143]
ds_read_b128 a[12:15], v87 offset:8192
v_cvt_pk_bf16_f32 v58, v36, v37
v_mfma_f32_16x16x32_bf16 v[144:147], a[80:83], v[48:51], v[144:147]
ds_read_b128 a[16:19], v84 offset:12288
s_mov_b32 m0, 110592
s_add_u32 s92, s34, 12288
v_mfma_f32_16x16x32_bf16 v[148:151], a[84:87], v[48:51], v[148:151]
ds_read_b128 a[20:23], v85 offset:12288
buffer_load_dwordx4 v236, s[16:19], s92 offen offset:0 nt lds
v_mfma_f32_16x16x32_bf16 v[152:155], a[88:91], v[48:51], v[152:155]
ds_read_b128 a[24:27], v86 offset:12288
v_mfma_f32_16x16x32_bf16 v[156:159], a[92:95], v[48:51], v[156:159]
ds_read_b128 a[28:31], v87 offset:12288
v_mfma_f32_16x16x32_bf16 v[108:111], v[124:127], v[48:51], v[108:111]
buffer_load_dwordx4 v237, s[16:19], s92 offen offset:1024 nt lds
v_exp_f32 v38, v38
v_mfma_f32_16x16x32_bf16 v[160:163], a[64:67], v[52:55], v[160:163]
v_exp_f32 v39, v39
v_mfma_f32_16x16x32_bf16 v[164:167], a[68:71], v[52:55], v[164:167]
v_mfma_f32_16x16x32_bf16 v[168:171], a[72:75], v[52:55], v[168:171]
buffer_load_dwordx4 v236, s[16:19], s92 offen offset:2048 nt lds
v_mfma_f32_16x16x32_bf16 v[172:175], a[76:79], v[52:55], v[172:175]
v_mfma_f32_16x16x32_bf16 v[176:179], a[80:83], v[52:55], v[176:179]
s_add_u32 s34, s34, 16384
v_mfma_f32_16x16x32_bf16 v[180:183], a[84:87], v[52:55], v[180:183]
buffer_load_dwordx4 v237, s[16:19], s92 offen offset:3072 nt lds
v_mfma_f32_16x16x32_bf16 v[184:187], a[88:91], v[52:55], v[184:187]
v_mfma_f32_16x16x32_bf16 v[188:191], a[92:95], v[52:55], v[188:191]
v_mfma_f32_16x16x32_bf16 v[112:115], v[124:127], v[52:55], v[112:115]
s_waitcnt lgkmcnt(0)
v_mfma_f32_16x16x32_bf16 v[16:19], a[0:3], a[32:35], v[64:67]
v_cvt_pk_bf16_f32 v59, v38, v39
v_mfma_f32_16x16x32_bf16 v[16:19], a[4:7], a[36:39], v[16:19]
s_mov_b32 m0, 49152
v_mfma_f32_16x16x32_bf16 v[16:19], a[8:11], a[40:43], v[16:19]
buffer_load_dwordx4 v234, s[12:15], s34 offen offset:0 nt lds
v_mfma_f32_16x16x32_bf16 v[16:19], a[12:15], a[44:47], v[16:19]
v_mfma_f32_16x16x32_bf16 v[20:23], a[16:19], a[32:35], v[64:67]
v_mfma_f32_16x16x32_bf16 v[20:23], a[20:23], a[36:39], v[20:23]
s_add_u32 s39, s39, 1
buffer_load_dwordx4 v235, s[12:15], s34 offen offset:1024 nt lds
v_mfma_f32_16x16x32_bf16 v[20:23], a[24:27], a[40:43], v[20:23]
v_mov_b32 v80, s39
v_mfma_f32_16x16x32_bf16 v[20:23], a[28:31], a[44:47], v[20:23]
v_mfma_f32_16x16x32_bf16 v[24:27], a[0:3], a[48:51], v[68:71]
s_waitcnt vmcnt(34)
ds_write_b32 v1, v80
buffer_load_dwordx4 v232, s[12:15], s34 offen offset:2048 nt lds
v_mfma_f32_16x16x32_bf16 v[24:27], a[4:7], a[52:55], v[24:27]
v_exp_f32 v16, v16
v_mfma_f32_16x16x32_bf16 v[24:27], a[8:11], a[56:59], v[24:27]
v_exp_f32 v17, v17
v_mfma_f32_16x16x32_bf16 v[24:27], a[12:15], a[60:63], v[24:27]
buffer_load_dwordx4 v233, s[12:15], s34 offen offset:3072 nt lds
v_cvt_pk_bf16_f32 v48, v16, v17
v_mfma_f32_16x16x32_bf16 v[28:31], a[16:19], a[48:51], v[68:71]
v_exp_f32 v18, v18
v_mfma_f32_16x16x32_bf16 v[28:31], a[20:23], a[52:55], v[28:31]
s_mov_b32 m0, 53248
s_add_u32 s92, s34, 4096
v_exp_f32 v19, v19
v_mfma_f32_16x16x32_bf16 v[28:31], a[24:27], a[56:59], v[28:31]
buffer_load_dwordx4 v234, s[12:15], s92 offen offset:0 nt lds
v_exp_f32 v20, v20
v_mfma_f32_16x16x32_bf16 v[28:31], a[28:31], a[60:63], v[28:31]
v_exp_f32 v21, v21
v_mfma_f32_16x16x32_bf16 v[192:195], a[64:67], v[56:59], v[192:195]
v_exp_f32 v22, v22
v_mfma_f32_16x16x32_bf16 v[196:199], a[68:71], v[56:59], v[196:199]
buffer_load_dwordx4 v235, s[12:15], s92 offen offset:1024 nt lds
v_cvt_pk_bf16_f32 v49, v18, v19
v_mfma_f32_16x16x32_bf16 v[200:203], a[72:75], v[56:59], v[200:203]
v_exp_f32 v23, v23
v_mfma_f32_16x16x32_bf16 v[204:207], a[76:79], v[56:59], v[204:207]
v_exp_f32 v24, v24
v_mfma_f32_16x16x32_bf16 v[208:211], a[80:83], v[56:59], v[208:211]
buffer_load_dwordx4 v232, s[12:15], s92 offen offset:2048 nt lds
v_exp_f32 v25, v25
v_mfma_f32_16x16x32_bf16 v[212:215], a[84:87], v[56:59], v[212:215]
v_exp_f32 v26, v26
v_mfma_f32_16x16x32_bf16 v[216:219], a[88:91], v[56:59], v[216:219]
v_exp_f32 v27, v27
v_mfma_f32_16x16x32_bf16 v[220:223], a[92:95], v[56:59], v[220:223]
buffer_load_dwordx4 v233, s[12:15], s92 offen offset:3072 nt lds
v_cvt_pk_bf16_f32 v50, v20, v21
v_mfma_f32_16x16x32_bf16 v[116:119], v[124:127], v[56:59], v[116:119]
v_exp_f32 v28, v28
v_exp_f32 v29, v29
ds_read_b64_tr_b16 a[64:65], v88 offset:8192
v_cvt_pk_bf16_f32 v51, v22, v23
ds_read_b64_tr_b16 a[66:67], v88 offset:12288
v_cvt_pk_bf16_f32 v52, v24, v25
ds_read_b64_tr_b16 a[68:69], v89 offset:8192
v_cvt_pk_bf16_f32 v53, v26, v27
ds_read_b64_tr_b16 a[70:71], v89 offset:12288
v_cvt_pk_bf16_f32 v54, v28, v29
ds_read_b64_tr_b16 a[72:73], v90 offset:8192
ds_read_b64_tr_b16 a[74:75], v90 offset:12288
ds_read_b64_tr_b16 a[76:77], v91 offset:8192
ds_read_b64_tr_b16 a[78:79], v91 offset:12288
v_mfma_f32_16x16x32_bf16 v[32:35], a[0:3], a[96:99], v[72:75]
ds_read_b64_tr_b16 a[80:81], v92 offset:8192
s_mov_b32 m0, 57344
s_add_u32 s92, s34, 8192
v_mfma_f32_16x16x32_bf16 v[32:35], a[4:7], a[100:103], v[32:35]
ds_read_b64_tr_b16 a[82:83], v92 offset:12288
ds_read_b128 v[80:83], v101
buffer_load_dwordx4 v234, s[12:15], s92 offen offset:0 nt lds
v_mfma_f32_16x16x32_bf16 v[32:35], a[8:11], a[104:107], v[32:35]
ds_read_b64_tr_b16 a[84:85], v93 offset:8192
v_mfma_f32_16x16x32_bf16 v[32:35], a[12:15], a[108:111], v[32:35]
ds_read_b64_tr_b16 a[86:87], v93 offset:12288
v_mfma_f32_16x16x32_bf16 v[36:39], a[16:19], a[96:99], v[72:75]
s_waitcnt lgkmcnt(2)
ds_read_b64_tr_b16 a[88:89], v94 offset:8192
buffer_load_dwordx4 v235, s[12:15], s92 offen offset:1024 nt lds
v_min3_u32 v80, v80, v81, v82
v_mfma_f32_16x16x32_bf16 v[36:39], a[20:23], a[100:103], v[36:39]
ds_read_b64_tr_b16 a[90:91], v94 offset:12288
v_min_u32 v80, v80, v83
v_mfma_f32_16x16x32_bf16 v[36:39], a[24:27], a[104:107], v[36:39]
ds_read_b64_tr_b16 a[92:93], v95 offset:8192
v_cmp_gt_u32 vcc, s39, v80
v_mfma_f32_16x16x32_bf16 v[36:39], a[28:31], a[108:111], v[36:39]
s_cbranch_vccnz L_fs9_3
L_fr9_3:
ds_read_b64_tr_b16 a[94:95], v95 offset:12288
buffer_load_dwordx4 v232, s[12:15], s92 offen offset:2048 nt lds
v_exp_f32 v30, v30
v_exp_f32 v31, v31
v_exp_f32 v32, v32
v_exp_f32 v33, v33
v_exp_f32 v34, v34
v_exp_f32 v35, v35
v_exp_f32 v36, v36
s_waitcnt lgkmcnt(0)
v_exp_f32 v37, v37
v_mfma_f32_16x16x32_bf16 v[128:131], a[64:67], v[48:51], v[128:131]
ds_read_b128 a[0:3], v84 offset:16384
v_cvt_pk_bf16_f32 v55, v30, v31
v_mfma_f32_16x16x32_bf16 v[132:135], a[68:71], v[48:51], v[132:135]
ds_read_b128 a[4:7], v85 offset:16384
v_cvt_pk_bf16_f32 v56, v32, v33
v_mfma_f32_16x16x32_bf16 v[136:139], a[72:75], v[48:51], v[136:139]
ds_read_b128 a[8:11], v86 offset:16384
buffer_load_dwordx4 v233, s[12:15], s92 offen offset:3072 nt lds
v_cvt_pk_bf16_f32 v57, v34, v35
v_mfma_f32_16x16x32_bf16 v[140:143], a[76:79], v[48:51], v[140:143]
ds_read_b128 a[12:15], v87 offset:16384
v_cvt_pk_bf16_f32 v58, v36, v37
v_mfma_f32_16x16x32_bf16 v[144:147], a[80:83], v[48:51], v[144:147]
ds_read_b128 a[16:19], v84 offset:20480
s_mov_b32 m0, 61440
s_add_u32 s92, s34, 12288
v_mfma_f32_16x16x32_bf16 v[148:151], a[84:87], v[48:51], v[148:151]
ds_read_b128 a[20:23], v85 offset:20480
buffer_load_dwordx4 v234, s[12:15], s92 offen offset:0 nt lds
v_mfma_f32_16x16x32_bf16 v[152:155], a[88:91], v[48:51], v[152:155]
ds_read_b128 a[24:27], v86 offset:20480
v_mfma_f32_16x16x32_bf16 v[156:159], a[92:95], v[48:51], v[156:159]
ds_read_b128 a[28:31], v87 offset:20480
v_mfma_f32_16x16x32_bf16 v[108:111], v[124:127], v[48:51], v[108:111]
buffer_load_dwordx4 v235, s[12:15], s92 offen offset:1024 nt lds
v_exp_f32 v38, v38
v_mfma_f32_16x16x32_bf16 v[160:163], a[64:67], v[52:55], v[160:163]
v_exp_f32 v39, v39
v_mfma_f32_16x16x32_bf16 v[164:167], a[68:71], v[52:55], v[164:167]
v_mfma_f32_16x16x32_bf16 v[168:171], a[72:75], v[52:55], v[168:171]
buffer_load_dwordx4 v232, s[12:15], s92 offen offset:2048 nt lds
v_mfma_f32_16x16x32_bf16 v[172:175], a[76:79], v[52:55], v[172:175]
v_mfma_f32_16x16x32_bf16 v[176:179], a[80:83], v[52:55], v[176:179]
v_mfma_f32_16x16x32_bf16 v[180:183], a[84:87], v[52:55], v[180:183]
buffer_load_dwordx4 v233, s[12:15], s92 offen offset:3072 nt lds
v_mfma_f32_16x16x32_bf16 v[184:187], a[88:91], v[52:55], v[184:187]
v_mfma_f32_16x16x32_bf16 v[188:191], a[92:95], v[52:55], v[188:191]
v_mfma_f32_16x16x32_bf16 v[112:115], v[124:127], v[52:55], v[112:115]
s_waitcnt lgkmcnt(0)
v_mfma_f32_16x16x32_bf16 v[16:19], a[0:3], a[32:35], v[64:67]
s_waitcnt vmcnt(44)
v_cvt_pk_bf16_f32 v59, v38, v39
v_mfma_f32_16x16x32_bf16 v[16:19], a[4:7], a[36:39], v[16:19]
s_mov_b32 m0, 114688
v_mfma_f32_16x16x32_bf16 v[16:19], a[8:11], a[40:43], v[16:19]
buffer_load_dwordx4 v236, s[16:19], s34 offen offset:0 nt lds
v_mfma_f32_16x16x32_bf16 v[16:19], a[12:15], a[44:47], v[16:19]
v_mfma_f32_16x16x32_bf16 v[20:23], a[16:19], a[32:35], v[64:67]
v_mfma_f32_16x16x32_bf16 v[20:23], a[20:23], a[36:39], v[20:23]
buffer_load_dwordx4 v237, s[16:19], s34 offen offset:1024 nt lds
v_mfma_f32_16x16x32_bf16 v[20:23], a[24:27], a[40:43], v[20:23]
v_mfma_f32_16x16x32_bf16 v[20:23], a[28:31], a[44:47], v[20:23]
v_mfma_f32_16x16x32_bf16 v[24:27], a[0:3], a[48:51], v[68:71]
buffer_load_dwordx4 v236, s[16:19], s34 offen offset:2048 nt lds
v_mfma_f32_16x16x32_bf16 v[24:27], a[4:7], a[52:55], v[24:27]
v_exp_f32 v16, v16
v_mfma_f32_16x16x32_bf16 v[24:27], a[8:11], a[56:59], v[24:27]
v_exp_f32 v17, v17
v_mfma_f32_16x16x32_bf16 v[24:27], a[12:15], a[60:63], v[24:27]
buffer_load_dwordx4 v237, s[16:19], s34 offen offset:3072 nt lds
v_cvt_pk_bf16_f32 v48, v16, v17
v_mfma_f32_16x16x32_bf16 v[28:31], a[16:19], a[48:51], v[68:71]
v_exp_f32 v18, v18
v_mfma_f32_16x16x32_bf16 v[28:31], a[20:23], a[52:55], v[28:31]
s_mov_b32 m0, 118784
s_add_u32 s92, s34, 4096
v_exp_f32 v19, v19
v_mfma_f32_16x16x32_bf16 v[28:31], a[24:27], a[56:59], v[28:31]
buffer_load_dwordx4 v236, s[16:19], s92 offen offset:0 nt lds
v_exp_f32 v20, v20
v_mfma_f32_16x16x32_bf16 v[28:31], a[28:31], a[60:63], v[28:31]
v_exp_f32 v21, v21
v_mfma_f32_16x16x32_bf16 v[192:195], a[64:67], v[56:59], v[192:195]
v_exp_f32 v22, v22
v_mfma_f32_16x16x32_bf16 v[196:199], a[68:71], v[56:59], v[196:199]
buffer_load_dwordx4 v237, s[16:19], s92 offen offset:1024 nt lds
v_cvt_pk_bf16_f32 v49, v18, v19
v_mfma_f32_16x16x32_bf16 v[200:203], a[72:75], v[56:59], v[200:203]
v_exp_f32 v23, v23
v_mfma_f32_16x16x32_bf16 v[204:207], a[76:79], v[56:59], v[204:207]
v_exp_f32 v24, v24
v_mfma_f32_16x16x32_bf16 v[208:211], a[80:83], v[56:59], v[208:211]
buffer_load_dwordx4 v236, s[16:19], s92 offen offset:2048 nt lds
v_exp_f32 v25, v25
v_mfma_f32_16x16x32_bf16 v[212:215], a[84:87], v[56:59], v[212:215]
v_exp_f32 v26, v26
v_mfma_f32_16x16x32_bf16 v[216:219], a[88:91], v[56:59], v[216:219]
v_exp_f32 v27, v27
v_mfma_f32_16x16x32_bf16 v[220:223], a[92:95], v[56:59], v[220:223]
buffer_load_dwordx4 v237, s[16:19], s92 offen offset:3072 nt lds
v_cvt_pk_bf16_f32 v50, v20, v21
v_mfma_f32_16x16x32_bf16 v[116:119], v[124:127], v[56:59], v[116:119]
v_exp_f32 v28, v28
v_exp_f32 v29, v29
ds_read_b64_tr_b16 a[64:65], v88 offset:16384
v_cvt_pk_bf16_f32 v51, v22, v23
ds_read_b64_tr_b16 a[66:67], v88 offset:20480
v_cvt_pk_bf16_f32 v52, v24, v25
ds_read_b64_tr_b16 a[68:69], v89 offset:16384
v_cvt_pk_bf16_f32 v53, v26, v27
ds_read_b64_tr_b16 a[70:71], v89 offset:20480
v_cvt_pk_bf16_f32 v54, v28, v29
ds_read_b64_tr_b16 a[72:73], v90 offset:16384
ds_read_b64_tr_b16 a[74:75], v90 offset:20480
ds_read_b64_tr_b16 a[76:77], v91 offset:16384
ds_read_b64_tr_b16 a[78:79], v91 offset:20480
v_mfma_f32_16x16x32_bf16 v[32:35], a[0:3], a[96:99], v[72:75]
ds_read_b64_tr_b16 a[80:81], v92 offset:16384
s_mov_b32 m0, 122880
s_add_u32 s92, s34, 8192
v_mfma_f32_16x16x32_bf16 v[32:35], a[4:7], a[100:103], v[32:35]
ds_read_b64_tr_b16 a[82:83], v92 offset:20480
buffer_load_dwordx4 v236, s[16:19], s92 offen offset:0 nt lds
v_mfma_f32_16x16x32_bf16 v[32:35], a[8:11], a[104:107], v[32:35]
ds_read_b64_tr_b16 a[84:85], v93 offset:16384
v_mfma_f32_16x16x32_bf16 v[32:35], a[12:15], a[108:111], v[32:35]
ds_read_b64_tr_b16 a[86:87], v93 offset:20480
v_mfma_f32_16x16x32_bf16 v[36:39], a[16:19], a[96:99], v[72:75]
ds_read_b64_tr_b16 a[88:89], v94 offset:16384
buffer_load_dwordx4 v237, s[16:19], s92 offen offset:1024 nt lds
v_mfma_f32_16x16x32_bf16 v[36:39], a[20:23], a[100:103], v[36:39]
ds_read_b64_tr_b16 a[90:91], v94 offset:20480
v_mfma_f32_16x16x32_bf16 v[36:39], a[24:27], a[104:107], v[36:39]
ds_read_b64_tr_b16 a[92:93], v95 offset:16384
v_mfma_f32_16x16x32_bf16 v[36:39], a[28:31], a[108:111], v[36:39]
ds_read_b64_tr_b16 a[94:95], v95 offset:20480
buffer_load_dwordx4 v236, s[16:19], s92 offen offset:2048 nt lds
v_exp_f32 v30, v30
v_exp_f32 v31, v31
v_exp_f32 v32, v32
v_exp_f32 v33, v33
v_exp_f32 v34, v34
v_exp_f32 v35, v35
v_exp_f32 v36, v36
s_waitcnt lgkmcnt(0)
v_exp_f32 v37, v37
v_mfma_f32_16x16x32_bf16 v[128:131], a[64:67], v[48:51], v[128:131]
ds_read_b128 a[0:3], v84 offset:24576
v_cvt_pk_bf16_f32 v55, v30, v31
v_mfma_f32_16x16x32_bf16 v[132:135], a[68:71], v[48:51], v[132:135]
ds_read_b128 a[4:7], v85 offset:24576
v_cvt_pk_bf16_f32 v56, v32, v33
v_mfma_f32_16x16x32_bf16 v[136:139], a[72:75], v[48:51], v[136:139]
ds_read_b128 a[8:11], v86 offset:24576
buffer_load_dwordx4 v237, s[16:19], s92 offen offset:3072 nt lds
v_cvt_pk_bf16_f32 v57, v34, v35
v_mfma_f32_16x16x32_bf16 v[140:143], a[76:79], v[48:51], v[140:143]
ds_read_b128 a[12:15], v87 offset:24576
v_cvt_pk_bf16_f32 v58, v36, v37
v_mfma_f32_16x16x32_bf16 v[144:147], a[80:83], v[48:51], v[144:147]
ds_read_b128 a[16:19], v84 offset:28672
s_mov_b32 m0, 126976
s_add_u32 s92, s34, 12288
v_mfma_f32_16x16x32_bf16 v[148:151], a[84:87], v[48:51], v[148:151]
ds_read_b128 a[20:23], v85 offset:28672
buffer_load_dwordx4 v236, s[16:19], s92 offen offset:0 nt lds
v_mfma_f32_16x16x32_bf16 v[152:155], a[88:91], v[48:51], v[152:155]
ds_read_b128 a[24:27], v86 offset:28672
v_mfma_f32_16x16x32_bf16 v[156:159], a[92:95], v[48:51], v[156:159]
ds_read_b128 a[28:31], v87 offset:28672
v_mfma_f32_16x16x32_bf16 v[108:111], v[124:127], v[48:51], v[108:111]
buffer_load_dwordx4 v237, s[16:19], s92 offen offset:1024 nt lds
v_exp_f32 v38, v38
v_mfma_f32_16x16x32_bf16 v[160:163], a[64:67], v[52:55], v[160:163]
v_exp_f32 v39, v39
v_mfma_f32_16x16x32_bf16 v[164:167], a[68:71], v[52:55], v[164:167]
v_mfma_f32_16x16x32_bf16 v[168:171], a[72:75], v[52:55], v[168:171]
buffer_load_dwordx4 v236, s[16:19], s92 offen offset:2048 nt lds
v_mfma_f32_16x16x32_bf16 v[172:175], a[76:79], v[52:55], v[172:175]
v_mfma_f32_16x16x32_bf16 v[176:179], a[80:83], v[52:55], v[176:179]
s_add_u32 s34, s34, 16384
v_mfma_f32_16x16x32_bf16 v[180:183], a[84:87], v[52:55], v[180:183]
buffer_load_dwordx4 v237, s[16:19], s92 offen offset:3072 nt lds
v_mfma_f32_16x16x32_bf16 v[184:187], a[88:91], v[52:55], v[184:187]
v_mfma_f32_16x16x32_bf16 v[188:191], a[92:95], v[52:55], v[188:191]
v_mfma_f32_16x16x32_bf16 v[112:115], v[124:127], v[52:55], v[112:115]
s_waitcnt lgkmcnt(0)
v_mfma_f32_16x16x32_bf16 v[16:19], a[0:3], a[32:35], v[64:67]
v_cvt_pk_bf16_f32 v59, v38, v39
v_mfma_f32_16x16x32_bf16 v[16:19], a[4:7], a[36:39], v[16:19]
s_mov_b32 m0, 0
v_mfma_f32_16x16x32_bf16 v[16:19], a[8:11], a[40:43], v[16:19]
buffer_load_dwordx4 v234, s[12:15], s34 offen offset:0 nt lds
v_mfma_f32_16x16x32_bf16 v[16:19], a[12:15], a[44:47], v[16:19]
v_mfma_f32_16x16x32_bf16 v[20:23], a[16:19], a[32:35], v[64:67]
v_mfma_f32_16x16x32_bf16 v[20:23], a[20:23], a[36:39], v[20:23]
s_add_u32 s39, s39, 1
buffer_load_dwordx4 v235, s[12:15], s34 offen offset:1024 nt lds
v_mfma_f32_16x16x32_bf16 v[20:23], a[24:27], a[40:43], v[20:23]
v_mov_b32 v80, s39
v_mfma_f32_16x16x32_bf16 v[20:23], a[28:31], a[44:47], v[20:23]
v_mfma_f32_16x16x32_bf16 v[24:27], a[0:3], a[48:51], v[68:71]
s_waitcnt vmcnt(34)
ds_write_b32 v1, v80
buffer_load_dwordx4 v232, s[12:15], s34 offen offset:2048 nt lds
v_mfma_f32_16x16x32_bf16 v[24:27], a[4:7], a[52:55], v[24:27]
v_exp_f32 v16, v16
v_mfma_f32_16x16x32_bf16 v[24:27], a[8:11], a[56:59], v[24:27]
v_exp_f32 v17, v17
v_mfma_f32_16x16x32_bf16 v[24:27], a[12:15], a[60:63], v[24:27]
buffer_load_dwordx4 v233, s[12:15], s34 offen offset:3072 nt lds
v_cvt_pk_bf16_f32 v48, v16, v17
v_mfma_f32_16x16x32_bf16 v[28:31], a[16:19], a[48:51], v[68:71]
v_exp_f32 v18, v18
v_mfma_f32_16x16x32_bf16 v[28:31], a[20:23], a[52:55], v[28:31]
s_mov_b32 m0, 4096
s_add_u32 s92, s34, 4096
v_exp_f32 v19, v19
v_mfma_f32_16x16x32_bf16 v[28:31], a[24:27], a[56:59], v[28:31]
buffer_load_dwordx4 v234, s[12:15], s92 offen offset:0 nt lds
v_exp_f32 v20, v20
v_mfma_f32_16x16x32_bf16 v[28:31], a[28:31], a[60:63], v[28:31]
v_exp_f32 v21, v21
v_mfma_f32_16x16x32_bf16 v[192:195], a[64:67], v[56:59], v[192:195]
v_exp_f32 v22, v22
v_mfma_f32_16x16x32_bf16 v[196:199], a[68:71], v[56:59], v[196:199]
buffer_load_dwordx4 v235, s[12:15], s92 offen offset:1024 nt lds
v_cvt_pk_bf16_f32 v49, v18, v19
v_mfma_f32_16x16x32_bf16 v[200:203], a[72:75], v[56:59], v[200:203]
v_exp_f32 v23, v23
v_mfma_f32_16x16x32_bf16 v[204:207], a[76:79], v[56:59], v[204:207]
v_exp_f32 v24, v24
v_mfma_f32_16x16x32_bf16 v[208:211], a[80:83], v[56:59], v[208:211]
buffer_load_dwordx4 v232, s[12:15], s92 offen offset:2048 nt lds
v_exp_f32 v25, v25
v_mfma_f32_16x16x32_bf16 v[212:215], a[84:87], v[56:59], v[212:215]
v_exp_f32 v26, v26
v_mfma_f32_16x16x32_bf16 v[216:219], a[88:91], v[56:59], v[216:219]
v_exp_f32 v27, v27
v_mfma_f32_16x16x32_bf16 v[220:223], a[92:95], v[56:59], v[220:223]
buffer_load_dwordx4 v233, s[12:15], s92 offen offset:3072 nt lds
v_cvt_pk_bf16_f32 v50, v20, v21
v_mfma_f32_16x16x32_bf16 v[116:119], v[124:127], v[56:59], v[116:119]
v_exp_f32 v28, v28
v_exp_f32 v29, v29
ds_read_b64_tr_b16 a[64:65], v88 offset:24576
v_cvt_pk_bf16_f32 v51, v22, v23
ds_read_b64_tr_b16 a[66:67], v88 offset:28672
v_cvt_pk_bf16_f32 v52, v24, v25
ds_read_b64_tr_b16 a[68:69], v89 offset:24576
v_cvt_pk_bf16_f32 v53, v26, v27
ds_read_b64_tr_b16 a[70:71], v89 offset:28672
v_cvt_pk_bf16_f32 v54, v28, v29
ds_read_b64_tr_b16 a[72:73], v90 offset:24576
ds_read_b64_tr_b16 a[74:75], v90 offset:28672
ds_read_b64_tr_b16 a[76:77], v91 offset:24576
ds_read_b64_tr_b16 a[78:79], v91 offset:28672
v_mfma_f32_16x16x32_bf16 v[32:35], a[0:3], a[96:99], v[72:75]
ds_read_b64_tr_b16 a[80:81], v92 offset:24576
s_mov_b32 m0, 8192
s_add_u32 s92, s34, 8192
v_mfma_f32_16x16x32_bf16 v[32:35], a[4:7], a[100:103], v[32:35]
ds_read_b64_tr_b16 a[82:83], v92 offset:28672
ds_read_b128 v[80:83], v101
buffer_load_dwordx4 v234, s[12:15], s92 offen offset:0 nt lds
v_mfma_f32_16x16x32_bf16 v[32:35], a[8:11], a[104:107], v[32:35]
ds_read_b64_tr_b16 a[84:85], v93 offset:24576
v_mfma_f32_16x16x32_bf16 v[32:35], a[12:15], a[108:111], v[32:35]
ds_read_b64_tr_b16 a[86:87], v93 offset:28672
v_mfma_f32_16x16x32_bf16 v[36:39], a[16:19], a[96:99], v[72:75]
s_waitcnt lgkmcnt(2)
ds_read_b64_tr_b16 a[88:89], v94 offset:24576
buffer_load_dwordx4 v235, s[12:15], s92 offen offset:1024 nt lds
v_min3_u32 v80, v80, v81, v82
v_mfma_f32_16x16x32_bf16 v[36:39], a[20:23], a[100:103], v[36:39]
ds_read_b64_tr_b16 a[90:91], v94 offset:28672
v_min_u32 v80, v80, v83
v_mfma_f32_16x16x32_bf16 v[36:39], a[24:27], a[104:107], v[36:39]
ds_read_b64_tr_b16 a[92:93], v95 offset:24576
v_cmp_gt_u32 vcc, s39, v80
v_mfma_f32_16x16x32_bf16 v[36:39], a[28:31], a[108:111], v[36:39]
s_cbranch_vccnz L_fs11_3
L_fr11_3:
ds_read_b64_tr_b16 a[94:95], v95 offset:28672
buffer_load_dwordx4 v232, s[12:15], s92 offen offset:2048 nt lds
v_exp_f32 v30, v30
v_exp_f32 v31, v31
v_exp_f32 v32, v32
v_exp_f32 v33, v33
v_exp_f32 v34, v34
v_exp_f32 v35, v35
v_exp_f32 v36, v36
s_waitcnt lgkmcnt(0)
v_exp_f32 v37, v37
v_mfma_f32_16x16x32_bf16 v[128:131], a[64:67], v[48:51], v[128:131]
ds_read_b128 a[0:3], v84 offset:32768
v_cvt_pk_bf16_f32 v55, v30, v31
v_mfma_f32_16x16x32_bf16 v[132:135], a[68:71], v[48:51], v[132:135]
ds_read_b128 a[4:7], v85 offset:32768
v_cvt_pk_bf16_f32 v56, v32, v33
v_mfma_f32_16x16x32_bf16 v[136:139], a[72:75], v[48:51], v[136:139]
ds_read_b128 a[8:11], v86 offset:32768
buffer_load_dwordx4 v233, s[12:15], s92 offen offset:3072 nt lds
v_cvt_pk_bf16_f32 v57, v34, v35
v_mfma_f32_16x16x32_bf16 v[140:143], a[76:79], v[48:51], v[140:143]
ds_read_b128 a[12:15], v87 offset:32768
v_cvt_pk_bf16_f32 v58, v36, v37
v_mfma_f32_16x16x32_bf16 v[144:147], a[80:83], v[48:51], v[144:147]
ds_read_b128 a[16:19], v84 offset:36864
s_mov_b32 m0, 12288
s_add_u32 s92, s34, 12288
v_mfma_f32_16x16x32_bf16 v[148:151], a[84:87], v[48:51], v[148:151]
ds_read_b128 a[20:23], v85 offset:36864
buffer_load_dwordx4 v234, s[12:15], s92 offen offset:0 nt lds
v_mfma_f32_16x16x32_bf16 v[152:155], a[88:91], v[48:51], v[152:155]
ds_read_b128 a[24:27], v86 offset:36864
v_mfma_f32_16x16x32_bf16 v[156:159], a[92:95], v[48:51], v[156:159]
ds_read_b128 a[28:31], v87 offset:36864
v_mfma_f32_16x16x32_bf16 v[108:111], v[124:127], v[48:51], v[108:111]
buffer_load_dwordx4 v235, s[12:15], s92 offen offset:1024 nt lds
v_exp_f32 v38, v38
v_mfma_f32_16x16x32_bf16 v[160:163], a[64:67], v[52:55], v[160:163]
s_xor_b32 s47, s36, 1
s_or_b32 s46, s35, s47
s_cbranch_scc0 L_sig
L_nosig:
v_exp_f32 v39, v39
v_mfma_f32_16x16x32_bf16 v[164:167], a[68:71], v[52:55], v[164:167]
v_mfma_f32_16x16x32_bf16 v[168:171], a[72:75], v[52:55], v[168:171]
buffer_load_dwordx4 v232, s[12:15], s92 offen offset:2048 nt lds
v_mfma_f32_16x16x32_bf16 v[172:175], a[76:79], v[52:55], v[172:175]
v_mfma_f32_16x16x32_bf16 v[176:179], a[80:83], v[52:55], v[176:179]
v_mfma_f32_16x16x32_bf16 v[180:183], a[84:87], v[52:55], v[180:183]
buffer_load_dwordx4 v233, s[12:15], s92 offen offset:3072 nt lds
v_mfma_f32_16x16x32_bf16 v[184:187], a[88:91], v[52:55], v[184:187]
v_mfma_f32_16x16x32_bf16 v[188:191], a[92:95], v[52:55], v[188:191]
v_mfma_f32_16x16x32_bf16 v[112:115], v[124:127], v[52:55], v[112:115]
s_waitcnt lgkmcnt(0)
v_mfma_f32_16x16x32_bf16 v[16:19], a[0:3], a[32:35], v[64:67]
s_waitcnt vmcnt(44)
v_cvt_pk_bf16_f32 v59, v38, v39
v_mfma_f32_16x16x32_bf16 v[16:19], a[4:7], a[36:39], v[16:19]
s_mov_b32 m0, 65536
v_mfma_f32_16x16x32_bf16 v[16:19], a[8:11], a[40:43], v[16:19]
buffer_load_dwordx4 v236, s[16:19], s34 offen offset:0 nt lds
v_mfma_f32_16x16x32_bf16 v[16:19], a[12:15], a[44:47], v[16:19]
v_mfma_f32_16x16x32_bf16 v[20:23], a[16:19], a[32:35], v[64:67]
v_mfma_f32_16x16x32_bf16 v[20:23], a[20:23], a[36:39], v[20:23]
buffer_load_dwordx4 v237, s[16:19], s34 offen offset:1024 nt lds
v_mfma_f32_16x16x32_bf16 v[20:23], a[24:27], a[40:43], v[20:23]
v_mfma_f32_16x16x32_bf16 v[20:23], a[28:31], a[44:47], v[20:23]
v_mfma_f32_16x16x32_bf16 v[24:27], a[0:3], a[48:51], v[68:71]
buffer_load_dwordx4 v236, s[16:19], s34 offen offset:2048 nt lds
v_mfma_f32_16x16x32_bf16 v[24:27], a[4:7], a[52:55], v[24:27]
v_exp_f32 v16, v16
v_mfma_f32_16x16x32_bf16 v[24:27], a[8:11], a[56:59], v[24:27]
v_exp_f32 v17, v17
v_mfma_f32_16x16x32_bf16 v[24:27], a[12:15], a[60:63], v[24:27]
buffer_load_dwordx4 v237, s[16:19], s34 offen offset:3072 nt lds
v_cvt_pk_bf16_f32 v48, v16, v17
v_mfma_f32_16x16x32_bf16 v[28:31], a[16:19], a[48:51], v[68:71]
v_exp_f32 v18, v18
v_mfma_f32_16x16x32_bf16 v[28:31], a[20:23], a[52:55], v[28:31]
s_mov_b32 m0, 69632
s_add_u32 s92, s34, 4096
v_exp_f32 v19, v19
v_mfma_f32_16x16x32_bf16 v[28:31], a[24:27], a[56:59], v[28:31]
buffer_load_dwordx4 v236, s[16:19], s92 offen offset:0 nt lds
v_exp_f32 v20, v20
v_mfma_f32_16x16x32_bf16 v[28:31], a[28:31], a[60:63], v[28:31]
v_exp_f32 v21, v21
v_mfma_f32_16x16x32_bf16 v[192:195], a[64:67], v[56:59], v[192:195]
v_exp_f32 v22, v22
v_mfma_f32_16x16x32_bf16 v[196:199], a[68:71], v[56:59], v[196:199]
buffer_load_dwordx4 v237, s[16:19], s92 offen offset:1024 nt lds
v_cvt_pk_bf16_f32 v49, v18, v19
v_mfma_f32_16x16x32_bf16 v[200:203], a[72:75], v[56:59], v[200:203]
v_exp_f32 v23, v23
v_mfma_f32_16x16x32_bf16 v[204:207], a[76:79], v[56:59], v[204:207]
v_exp_f32 v24, v24
v_mfma_f32_16x16x32_bf16 v[208:211], a[80:83], v[56:59], v[208:211]
buffer_load_dwordx4 v236, s[16:19], s92 offen offset:2048 nt lds
v_exp_f32 v25, v25
v_mfma_f32_16x16x32_bf16 v[212:215], a[84:87], v[56:59], v[212:215]
v_exp_f32 v26, v26
v_mfma_f32_16x16x32_bf16 v[216:219], a[88:91], v[56:59], v[216:219]
v_exp_f32 v27, v27
v_mfma_f32_16x16x32_bf16 v[220:223], a[92:95], v[56:59], v[220:223]
buffer_load_dwordx4 v237, s[16:19], s92 offen offset:3072 nt lds
v_cvt_pk_bf16_f32 v50, v20, v21
v_mfma_f32_16x16x32_bf16 v[116:119], v[124:127], v[56:59], v[116:119]
v_exp_f32 v28, v28
v_exp_f32 v29, v29
ds_read_b64_tr_b16 a[64:65], v88 offset:32768
v_cvt_pk_bf16_f32 v51, v22, v23
ds_read_b64_tr_b16 a[66:67], v88 offset:36864
v_cvt_pk_bf16_f32 v52, v24, v25
ds_read_b64_tr_b16 a[68:69], v89 offset:32768
v_cvt_pk_bf16_f32 v53, v26, v27
ds_read_b64_tr_b16 a[70:71], v89 offset:36864
v_cvt_pk_bf16_f32 v54, v28, v29
ds_read_b64_tr_b16 a[72:73], v90 offset:32768
ds_read_b64_tr_b16 a[74:75], v90 offset:36864
ds_read_b64_tr_b16 a[76:77], v91 offset:32768
ds_read_b64_tr_b16 a[78:79], v91 offset:36864
v_mfma_f32_16x16x32_bf16 v[32:35], a[0:3], a[96:99], v[72:75]
ds_read_b64_tr_b16 a[80:81], v92 offset:32768
s_mov_b32 m0, 73728
s_add_u32 s92, s34, 8192
v_mfma_f32_16x16x32_bf16 v[32:35], a[4:7], a[100:103], v[32:35]
ds_read_b64_tr_b16 a[82:83], v92 offset:36864
buffer_load_dwordx4 v236, s[16:19], s92 offen offset:0 nt lds
v_mfma_f32_16x16x32_bf16 v[32:35], a[8:11], a[104:107], v[32:35]
ds_read_b64_tr_b16 a[84:85], v93 offset:32768
v_mfma_f32_16x16x32_bf16 v[32:35], a[12:15], a[108:111], v[32:35]
ds_read_b64_tr_b16 a[86:87], v93 offset:36864
v_mfma_f32_16x16x32_bf16 v[36:39], a[16:19], a[96:99], v[72:75]
ds_read_b64_tr_b16 a[88:89], v94 offset:32768
buffer_load_dwordx4 v237, s[16:19], s92 offen offset:1024 nt lds
v_mfma_f32_16x16x32_bf16 v[36:39], a[20:23], a[100:103], v[36:39]
ds_read_b64_tr_b16 a[90:91], v94 offset:36864
v_mfma_f32_16x16x32_bf16 v[36:39], a[24:27], a[104:107], v[36:39]
ds_read_b64_tr_b16 a[92:93], v95 offset:32768
v_mfma_f32_16x16x32_bf16 v[36:39], a[28:31], a[108:111], v[36:39]
ds_read_b64_tr_b16 a[94:95], v95 offset:36864
buffer_load_dwordx4 v236, s[16:19], s92 offen offset:2048 nt lds
v_exp_f32 v30, v30
v_exp_f32 v31, v31
v_exp_f32 v32, v32
v_exp_f32 v33, v33
v_exp_f32 v34, v34
v_exp_f32 v35, v35
v_exp_f32 v36, v36
s_waitcnt lgkmcnt(0)
v_exp_f32 v37, v37
v_mfma_f32_16x16x32_bf16 v[128:131], a[64:67], v[48:51], v[128:131]
ds_read_b128 a[0:3], v84 offset:40960
v_cvt_pk_bf16_f32 v55, v30, v31
v_mfma_f32_16x16x32_bf16 v[132:135], a[68:71], v[48:51], v[132:135]
ds_read_b128 a[4:7], v85 offset:40960
v_cvt_pk_bf16_f32 v56, v32, v33
v_mfma_f32_16x16x32_bf16 v[136:139], a[72:75], v[48:51], v[136:139]
ds_read_b128 a[8:11], v86 offset:40960
buffer_load_dwordx4 v237, s[16:19], s92 offen offset:3072 nt lds
v_cvt_pk_bf16_f32 v57, v34, v35
v_mfma_f32_16x16x32_bf16 v[140:143], a[76:79], v[48:51], v[140:143]
ds_read_b128 a[12:15], v87 offset:40960
v_cvt_pk_bf16_f32 v58, v36, v37
v_mfma_f32_16x16x32_bf16 v[144:147], a[80:83], v[48:51], v[144:147]
ds_read_b128 a[16:19], v84 offset:45056
s_mov_b32 m0, 77824
s_add_u32 s92, s34, 12288
v_mfma_f32_16x16x32_bf16 v[148:151], a[84:87], v[48:51], v[148:151]
ds_read_b128 a[20:23], v85 offset:45056
buffer_load_dwordx4 v236, s[16:19], s92 offen offset:0 nt lds
v_mfma_f32_16x16x32_bf16 v[152:155], a[88:91], v[48:51], v[152:155]
ds_read_b128 a[24:27], v86 offset:45056
v_mfma_f32_16x16x32_bf16 v[156:159], a[92:95], v[48:51], v[156:159]
ds_read_b128 a[28:31], v87 offset:45056
v_mfma_f32_16x16x32_bf16 v[108:111], v[124:127], v[48:51], v[108:111]
buffer_load_dwordx4 v237, s[16:19], s92 offen offset:1024 nt lds
v_exp_f32 v38, v38
v_mfma_f32_16x16x32_bf16 v[160:163], a[64:67], v[52:55], v[160:163]
v_exp_f32 v39, v39
v_mfma_f32_16x16x32_bf16 v[164:167], a[68:71], v[52:55], v[164:167]
v_mfma_f32_16x16x32_bf16 v[168:171], a[72:75], v[52:55], v[168:171]
buffer_load_dwordx4 v236, s[16:19], s92 offen offset:2048 nt lds
v_mfma_f32_16x16x32_bf16 v[172:175], a[76:79], v[52:55], v[172:175]
v_mfma_f32_16x16x32_bf16 v[176:179], a[80:83], v[52:55], v[176:179]
s_add_u32 s34, s34, 16384
v_mfma_f32_16x16x32_bf16 v[180:183], a[84:87], v[52:55], v[180:183]
buffer_load_dwordx4 v237, s[16:19], s92 offen offset:3072 nt lds
v_mfma_f32_16x16x32_bf16 v[184:187], a[88:91], v[52:55], v[184:187]
v_mfma_f32_16x16x32_bf16 v[188:191], a[92:95], v[52:55], v[188:191]
v_mfma_f32_16x16x32_bf16 v[112:115], v[124:127], v[52:55], v[112:115]
s_waitcnt lgkmcnt(0)
v_mfma_f32_16x16x32_bf16 v[16:19], a[0:3], a[32:35], v[64:67]
v_cvt_pk_bf16_f32 v59, v38, v39
v_mfma_f32_16x16x32_bf16 v[16:19], a[4:7], a[36:39], v[16:19]
s_mov_b32 m0, 16384
v_mfma_f32_16x16x32_bf16 v[16:19], a[8:11], a[40:43], v[16:19]
buffer_load_dwordx4 v234, s[12:15], s34 offen offset:0 nt lds
v_mfma_f32_16x16x32_bf16 v[16:19], a[12:15], a[44:47], v[16:19]
v_mfma_f32_16x16x32_bf16 v[20:23], a[16:19], a[32:35], v[64:67]
v_mfma_f32_16x16x32_bf16 v[20:23], a[20:23], a[36:39], v[20:23]
s_add_u32 s39, s39, 1
buffer_load_dwordx4 v235, s[12:15], s34 offen offset:1024 nt lds
v_mfma_f32_16x16x32_bf16 v[20:23], a[24:27], a[40:43], v[20:23]
v_mov_b32 v80, s39
v_mfma_f32_16x16x32_bf16 v[20:23], a[28:31], a[44:47], v[20:23]
v_mfma_f32_16x16x32_bf16 v[24:27], a[0:3], a[48:51], v[68:71]
s_waitcnt vmcnt(34)
ds_write_b32 v1, v80
buffer_load_dwordx4 v232, s[12:15], s34 offen offset:2048 nt lds
v_mfma_f32_16x16x32_bf16 v[24:27], a[4:7], a[52:55], v[24:27]
v_exp_f32 v16, v16
v_mfma_f32_16x16x32_bf16 v[24:27], a[8:11], a[56:59], v[24:27]
v_exp_f32 v17, v17
v_mfma_f32_16x16x32_bf16 v[24:27], a[12:15], a[60:63], v[24:27]
buffer_load_dwordx4 v233, s[12:15], s34 offen offset:3072 nt lds
v_cvt_pk_bf16_f32 v48, v16, v17
v_mfma_f32_16x16x32_bf16 v[28:31], a[16:19], a[48:51], v[68:71]
v_exp_f32 v18, v18
v_mfma_f32_16x16x32_bf16 v[28:31], a[20:23], a[52:55], v[28:31]
s_mov_b32 m0, 20480
s_add_u32 s92, s34, 4096
v_exp_f32 v19, v19
v_mfma_f32_16x16x32_bf16 v[28:31], a[24:27], a[56:59], v[28:31]
buffer_load_dwordx4 v234, s[12:15], s92 offen offset:0 nt lds
v_exp_f32 v20, v20
v_mfma_f32_16x16x32_bf16 v[28:31], a[28:31], a[60:63], v[28:31]
v_exp_f32 v21, v21
v_mfma_f32_16x16x32_bf16 v[192:195], a[64:67], v[56:59], v[192:195]
v_exp_f32 v22, v22
v_mfma_f32_16x16x32_bf16 v[196:199], a[68:71], v[56:59], v[196:199]
buffer_load_dwordx4 v235, s[12:15], s92 offen offset:1024 nt lds
v_cvt_pk_bf16_f32 v49, v18, v19
v_mfma_f32_16x16x32_bf16 v[200:203], a[72:75], v[56:59], v[200:203]
v_exp_f32 v23, v23
v_mfma_f32_16x16x32_bf16 v[204:207], a[76:79], v[56:59], v[204:207]
v_exp_f32 v24, v24
v_mfma_f32_16x16x32_bf16 v[208:211], a[80:83], v[56:59], v[208:211]
buffer_load_dwordx4 v232, s[12:15], s92 offen offset:2048 nt lds
v_exp_f32 v25, v25
v_mfma_f32_16x16x32_bf16 v[212:215], a[84:87], v[56:59], v[212:215]
v_exp_f32 v26, v26
v_mfma_f32_16x16x32_bf16 v[216:219], a[88:91], v[56:59], v[216:219]
v_exp_f32 v27, v27
v_mfma_f32_16x16x32_bf16 v[220:223], a[92:95], v[56:59], v[220:223]
buffer_load_dwordx4 v233, s[12:15], s92 offen offset:3072 nt lds
v_cvt_pk_bf16_f32 v50, v20, v21
v_mfma_f32_16x16x32_bf16 v[116:119], v[124:127], v[56:59], v[116:119]
v_exp_f32 v28, v28
v_exp_f32 v29, v29
ds_read_b64_tr_b16 a[64:65], v88 offset:40960
v_cvt_pk_bf16_f32 v51, v22, v23
ds_read_b64_tr_b16 a[66:67], v88 offset:45056
v_cvt_pk_bf16_f32 v52, v24, v25
ds_read_b64_tr_b16 a[68:69], v89 offset:40960
v_cvt_pk_bf16_f32 v53, v26, v27
ds_read_b64_tr_b16 a[70:71], v89 offset:45056
v_cvt_pk_bf16_f32 v54, v28, v29
ds_read_b64_tr_b16 a[72:73], v90 offset:40960
ds_read_b64_tr_b16 a[74:75], v90 offset:45056
ds_read_b64_tr_b16 a[76:77], v91 offset:40960
ds_read_b64_tr_b16 a[78:79], v91 offset:45056
v_mfma_f32_16x16x32_bf16 v[32:35], a[0:3], a[96:99], v[72:75]
ds_read_b64_tr_b16 a[80:81], v92 offset:40960
s_mov_b32 m0, 24576
s_add_u32 s92, s34, 8192
v_mfma_f32_16x16x32_bf16 v[32:35], a[4:7], a[100:103], v[32:35]
ds_read_b64_tr_b16 a[82:83], v92 offset:45056
ds_read_b128 v[80:83], v101
buffer_load_dwordx4 v234, s[12:15], s92 offen offset:0 nt lds
v_mfma_f32_16x16x32_bf16 v[32:35], a[8:11], a[104:107], v[32:35]
ds_read_b64_tr_b16 a[84:85], v93 offset:40960
v_mfma_f32_16x16x32_bf16 v[32:35], a[12:15], a[108:111], v[32:35]
ds_read_b64_tr_b16 a[86:87], v93 offset:45056
v_mfma_f32_16x16x32_bf16 v[36:39], a[16:19], a[96:99], v[72:75]
s_waitcnt lgkmcnt(2)
ds_read_b64_tr_b16 a[88:89], v94 offset:40960
buffer_load_dwordx4 v235, s[12:15], s92 offen offset:1024 nt lds
v_min3_u32 v80, v80, v81, v82
v_mfma_f32_16x16x32_bf16 v[36:39], a[20:23], a[100:103], v[36:39]
ds_read_b64_tr_b16 a[90:91], v94 offset:45056
v_min_u32 v80, v80, v83
v_mfma_f32_16x16x32_bf16 v[36:39], a[24:27], a[104:107], v[36:39]
ds_read_b64_tr_b16 a[92:93], v95 offset:40960
v_cmp_gt_u32 vcc, s39, v80
v_mfma_f32_16x16x32_bf16 v[36:39], a[28:31], a[108:111], v[36:39]
s_cbranch_vccnz L_fs13_3
L_fr13_3:
ds_read_b64_tr_b16 a[94:95], v95 offset:45056
buffer_load_dwordx4 v232, s[12:15], s92 offen offset:2048 nt lds
v_exp_f32 v30, v30
v_exp_f32 v31, v31
v_exp_f32 v32, v32
v_exp_f32 v33, v33
v_exp_f32 v34, v34
v_exp_f32 v35, v35
v_exp_f32 v36, v36
s_waitcnt lgkmcnt(0)
v_exp_f32 v37, v37
v_mfma_f32_16x16x32_bf16 v[128:131], a[64:67], v[48:51], v[128:131]
ds_read_b128 a[0:3], v84 offset:49152
v_cvt_pk_bf16_f32 v55, v30, v31
v_mfma_f32_16x16x32_bf16 v[132:135], a[68:71], v[48:51], v[132:135]
ds_read_b128 a[4:7], v85 offset:49152
v_cvt_pk_bf16_f32 v56, v32, v33
v_mfma_f32_16x16x32_bf16 v[136:139], a[72:75], v[48:51], v[136:139]
ds_read_b128 a[8:11], v86 offset:49152
buffer_load_dwordx4 v233, s[12:15], s92 offen offset:3072 nt lds
v_cvt_pk_bf16_f32 v57, v34, v35
v_mfma_f32_16x16x32_bf16 v[140:143], a[76:79], v[48:51], v[140:143]
ds_read_b128 a[12:15], v87 offset:49152
v_cvt_pk_bf16_f32 v58, v36, v37
v_mfma_f32_16x16x32_bf16 v[144:147], a[80:83], v[48:51], v[144:147]
ds_read_b128 a[16:19], v84 offset:53248
s_mov_b32 m0, 28672
s_add_u32 s92, s34, 12288
v_mfma_f32_16x16x32_bf16 v[148:151], a[84:87], v[48:51], v[148:151]
ds_read_b128 a[20:23], v85 offset:53248
buffer_load_dwordx4 v234, s[12:15], s92 offen offset:0 nt lds
v_mfma_f32_16x16x32_bf16 v[152:155], a[88:91], v[48:51], v[152:155]
ds_read_b128 a[24:27], v86 offset:53248
v_mfma_f32_16x16x32_bf16 v[156:159], a[92:95], v[48:51], v[156:159]
ds_read_b128 a[28:31], v87 offset:53248
v_mfma_f32_16x16x32_bf16 v[108:111], v[124:127], v[48:51], v[108:111]
buffer_load_dwordx4 v235, s[12:15], s92 offen offset:1024 nt lds
v_exp_f32 v38, v38
v_mfma_f32_16x16x32_bf16 v[160:163], a[64:67], v[52:55], v[160:163]
v_exp_f32 v39, v39
v_mfma_f32_16x16x32_bf16 v[164:167], a[68:71], v[52:55], v[164:167]
v_mfma_f32_16x16x32_bf16 v[168:171], a[72:75], v[52:55], v[168:171]
buffer_load_dwordx4 v232, s[12:15], s92 offen offset:2048 nt lds
v_mfma_f32_16x16x32_bf16 v[172:175], a[76:79], v[52:55], v[172:175]
v_mfma_f32_16x16x32_bf16 v[176:179], a[80:83], v[52:55], v[176:179]
v_mfma_f32_16x16x32_bf16 v[180:183], a[84:87], v[52:55], v[180:183]
buffer_load_dwordx4 v233, s[12:15], s92 offen offset:3072 nt lds
v_mfma_f32_16x16x32_bf16 v[184:187], a[88:91], v[52:55], v[184:187]
v_mfma_f32_16x16x32_bf16 v[188:191], a[92:95], v[52:55], v[188:191]
v_mfma_f32_16x16x32_bf16 v[112:115], v[124:127], v[52:55], v[112:115]
s_waitcnt lgkmcnt(0)
v_mfma_f32_16x16x32_bf16 v[16:19], a[0:3], a[32:35], v[64:67]
s_waitcnt vmcnt(44)
v_cvt_pk_bf16_f32 v59, v38, v39
v_mfma_f32_16x16x32_bf16 v[16:19], a[4:7], a[36:39], v[16:19]
s_mov_b32 m0, 81920
v_mfma_f32_16x16x32_bf16 v[16:19], a[8:11], a[40:43], v[16:19]
buffer_load_dwordx4 v236, s[16:19], s34 offen offset:0 nt lds
v_mfma_f32_16x16x32_bf16 v[16:19], a[12:15], a[44:47], v[16:19]
v_mfma_f32_16x16x32_bf16 v[20:23], a[16:19], a[32:35], v[64:67]
v_mfma_f32_16x16x32_bf16 v[20:23], a[20:23], a[36:39], v[20:23]
buffer_load_dwordx4 v237, s[16:19], s34 offen offset:1024 nt lds
v_mfma_f32_16x16x32_bf16 v[20:23], a[24:27], a[40:43], v[20:23]
v_mfma_f32_16x16x32_bf16 v[20:23], a[28:31], a[44:47], v[20:23]
v_mfma_f32_16x16x32_bf16 v[24:27], a[0:3], a[48:51], v[68:71]
buffer_load_dwordx4 v236, s[16:19], s34 offen offset:2048 nt lds
v_mfma_f32_16x16x32_bf16 v[24:27], a[4:7], a[52:55], v[24:27]
v_exp_f32 v16, v16
v_mfma_f32_16x16x32_bf16 v[24:27], a[8:11], a[56:59], v[24:27]
v_exp_f32 v17, v17
v_mfma_f32_16x16x32_bf16 v[24:27], a[12:15], a[60:63], v[24:27]
buffer_load_dwordx4 v237, s[16:19], s34 offen offset:3072 nt lds
v_cvt_pk_bf16_f32 v48, v16, v17
v_mfma_f32_16x16x32_bf16 v[28:31], a[16:19], a[48:51], v[68:71]
v_exp_f32 v18, v18
v_mfma_f32_16x16x32_bf16 v[28:31], a[20:23], a[52:55], v[28:31]
s_mov_b32 m0, 86016
s_add_u32 s92, s34, 4096
v_exp_f32 v19, v19
v_mfma_f32_16x16x32_bf16 v[28:31], a[24:27], a[56:59], v[28:31]
buffer_load_dwordx4 v236, s[16:19], s92 offen offset:0 nt lds
v_exp_f32 v20, v20
v_mfma_f32_16x16x32_bf16 v[28:31], a[28:31], a[60:63], v[28:31]
v_exp_f32 v21, v21
v_mfma_f32_16x16x32_bf16 v[192:195], a[64:67], v[56:59], v[192:195]
v_exp_f32 v22, v22
v_mfma_f32_16x16x32_bf16 v[196:199], a[68:71], v[56:59], v[196:199]
buffer_load_dwordx4 v237, s[16:19], s92 offen offset:1024 nt lds
v_cvt_pk_bf16_f32 v49, v18, v19
v_mfma_f32_16x16x32_bf16 v[200:203], a[72:75], v[56:59], v[200:203]
v_exp_f32 v23, v23
v_mfma_f32_16x16x32_bf16 v[204:207], a[76:79], v[56:59], v[204:207]
v_exp_f32 v24, v24
v_mfma_f32_16x16x32_bf16 v[208:211], a[80:83], v[56:59], v[208:211]
buffer_load_dwordx4 v236, s[16:19], s92 offen offset:2048 nt lds
v_exp_f32 v25, v25
v_mfma_f32_16x16x32_bf16 v[212:215], a[84:87], v[56:59], v[212:215]
v_exp_f32 v26, v26
v_mfma_f32_16x16x32_bf16 v[216:219], a[88:91], v[56:59], v[216:219]
v_exp_f32 v27, v27
v_mfma_f32_16x16x32_bf16 v[220:223], a[92:95], v[56:59], v[220:223]
buffer_load_dwordx4 v237, s[16:19], s92 offen offset:3072 nt lds
v_cvt_pk_bf16_f32 v50, v20, v21
v_mfma_f32_16x16x32_bf16 v[116:119], v[124:127], v[56:59], v[116:119]
v_exp_f32 v28, v28
v_exp_f32 v29, v29
ds_read_b64_tr_b16 a[64:65], v88 offset:49152
v_cvt_pk_bf16_f32 v51, v22, v23
ds_read_b64_tr_b16 a[66:67], v88 offset:53248
v_cvt_pk_bf16_f32 v52, v24, v25
ds_read_b64_tr_b16 a[68:69], v89 offset:49152
v_cvt_pk_bf16_f32 v53, v26, v27
ds_read_b64_tr_b16 a[70:71], v89 offset:53248
v_cvt_pk_bf16_f32 v54, v28, v29
ds_read_b64_tr_b16 a[72:73], v90 offset:49152
ds_read_b64_tr_b16 a[74:75], v90 offset:53248
ds_read_b64_tr_b16 a[76:77], v91 offset:49152
ds_read_b64_tr_b16 a[78:79], v91 offset:53248
v_mfma_f32_16x16x32_bf16 v[32:35], a[0:3], a[96:99], v[72:75]
ds_read_b64_tr_b16 a[80:81], v92 offset:49152
s_mov_b32 m0, 90112
s_add_u32 s92, s34, 8192
v_mfma_f32_16x16x32_bf16 v[32:35], a[4:7], a[100:103], v[32:35]
ds_read_b64_tr_b16 a[82:83], v92 offset:53248
buffer_load_dwordx4 v236, s[16:19], s92 offen offset:0 nt lds
v_mfma_f32_16x16x32_bf16 v[32:35], a[8:11], a[104:107], v[32:35]
ds_read_b64_tr_b16 a[84:85], v93 offset:49152
v_mfma_f32_16x16x32_bf16 v[32:35], a[12:15], a[108:111], v[32:35]
ds_read_b64_tr_b16 a[86:87], v93 offset:53248
v_mfma_f32_16x16x32_bf16 v[36:39], a[16:19], a[96:99], v[72:75]
ds_read_b64_tr_b16 a[88:89], v94 offset:49152
buffer_load_dwordx4 v237, s[16:19], s92 offen offset:1024 nt lds
v_mfma_f32_16x16x32_bf16 v[36:39], a[20:23], a[100:103], v[36:39]
ds_read_b64_tr_b16 a[90:91], v94 offset:53248
v_mfma_f32_16x16x32_bf16 v[36:39], a[24:27], a[104:107], v[36:39]
ds_read_b64_tr_b16 a[92:93], v95 offset:49152
v_mfma_f32_16x16x32_bf16 v[36:39], a[28:31], a[108:111], v[36:39]
ds_read_b64_tr_b16 a[94:95], v95 offset:53248
buffer_load_dwordx4 v236, s[16:19], s92 offen offset:2048 nt lds
v_exp_f32 v30, v30
v_exp_f32 v31, v31
v_exp_f32 v32, v32
v_exp_f32 v33, v33
v_exp_f32 v34, v34
v_exp_f32 v35, v35
v_exp_f32 v36, v36
s_waitcnt lgkmcnt(0)
v_exp_f32 v37, v37
v_mfma_f32_16x16x32_bf16 v[128:131], a[64:67], v[48:51], v[128:131]
ds_read_b128 a[0:3], v84 offset:57344
v_cvt_pk_bf16_f32 v55, v30, v31
v_mfma_f32_16x16x32_bf16 v[132:135], a[68:71], v[48:51], v[132:135]
ds_read_b128 a[4:7], v85 offset:57344
v_cvt_pk_bf16_f32 v56, v32, v33
v_mfma_f32_16x16x32_bf16 v[136:139], a[72:75], v[48:51], v[136:139]
ds_read_b128 a[8:11], v86 offset:57344
buffer_load_dwordx4 v237, s[16:19], s92 offen offset:3072 nt lds
v_cvt_pk_bf16_f32 v57, v34, v35
v_mfma_f32_16x16x32_bf16 v[140:143], a[76:79], v[48:51], v[140:143]
ds_read_b128 a[12:15], v87 offset:57344
v_cvt_pk_bf16_f32 v58, v36, v37
v_mfma_f32_16x16x32_bf16 v[144:147], a[80:83], v[48:51], v[144:147]
ds_read_b128 a[16:19], v84 offset:61440
s_mov_b32 m0, 94208
s_add_u32 s92, s34, 12288
v_mfma_f32_16x16x32_bf16 v[148:151], a[84:87], v[48:51], v[148:151]
ds_read_b128 a[20:23], v85 offset:61440
buffer_load_dwordx4 v236, s[16:19], s92 offen offset:0 nt lds
v_mfma_f32_16x16x32_bf16 v[152:155], a[88:91], v[48:51], v[152:155]
ds_read_b128 a[24:27], v86 offset:61440
v_mfma_f32_16x16x32_bf16 v[156:159], a[92:95], v[48:51], v[156:159]
ds_read_b128 a[28:31], v87 offset:61440
v_mfma_f32_16x16x32_bf16 v[108:111], v[124:127], v[48:51], v[108:111]
buffer_load_dwordx4 v237, s[16:19], s92 offen offset:1024 nt lds
v_exp_f32 v38, v38
v_mfma_f32_16x16x32_bf16 v[160:163], a[64:67], v[52:55], v[160:163]
v_exp_f32 v39, v39
v_mfma_f32_16x16x32_bf16 v[164:167], a[68:71], v[52:55], v[164:167]
v_mfma_f32_16x16x32_bf16 v[168:171], a[72:75], v[52:55], v[168:171]
buffer_load_dwordx4 v236, s[16:19], s92 offen offset:2048 nt lds
v_mfma_f32_16x16x32_bf16 v[172:175], a[76:79], v[52:55], v[172:175]
v_mfma_f32_16x16x32_bf16 v[176:179], a[80:83], v[52:55], v[176:179]
s_add_u32 s34, s34, 16384
v_mfma_f32_16x16x32_bf16 v[180:183], a[84:87], v[52:55], v[180:183]
buffer_load_dwordx4 v237, s[16:19], s92 offen offset:3072 nt lds
v_mfma_f32_16x16x32_bf16 v[184:187], a[88:91], v[52:55], v[184:187]
v_mfma_f32_16x16x32_bf16 v[188:191], a[92:95], v[52:55], v[188:191]
v_mfma_f32_16x16x32_bf16 v[112:115], v[124:127], v[52:55], v[112:115]
s_waitcnt lgkmcnt(0)
v_mfma_f32_16x16x32_bf16 v[16:19], a[0:3], a[32:35], v[64:67]
v_cvt_pk_bf16_f32 v59, v38, v39
v_mfma_f32_16x16x32_bf16 v[16:19], a[4:7], a[36:39], v[16:19]
s_mov_b32 m0, 32768
v_mfma_f32_16x16x32_bf16 v[16:19], a[8:11], a[40:43], v[16:19]
buffer_load_dwordx4 v234, s[12:15], s34 offen offset:0 nt lds
v_mfma_f32_16x16x32_bf16 v[16:19], a[12:15], a[44:47], v[16:19]
v_mfma_f32_16x16x32_bf16 v[20:23], a[16:19], a[32:35], v[64:67]
v_mfma_f32_16x16x32_bf16 v[20:23], a[20:23], a[36:39], v[20:23]
s_add_u32 s39, s39, 1
buffer_load_dwordx4 v235, s[12:15], s34 offen offset:1024 nt lds
v_mfma_f32_16x16x32_bf16 v[20:23], a[24:27], a[40:43], v[20:23]
v_mov_b32 v80, s39
v_mfma_f32_16x16x32_bf16 v[20:23], a[28:31], a[44:47], v[20:23]
v_mfma_f32_16x16x32_bf16 v[24:27], a[0:3], a[48:51], v[68:71]
s_waitcnt vmcnt(34)
ds_write_b32 v1, v80
buffer_load_dwordx4 v232, s[12:15], s34 offen offset:2048 nt lds
v_mfma_f32_16x16x32_bf16 v[24:27], a[4:7], a[52:55], v[24:27]
v_exp_f32 v16, v16
v_mfma_f32_16x16x32_bf16 v[24:27], a[8:11], a[56:59], v[24:27]
v_exp_f32 v17, v17
v_mfma_f32_16x16x32_bf16 v[24:27], a[12:15], a[60:63], v[24:27]
buffer_load_dwordx4 v233, s[12:15], s34 offen offset:3072 nt lds
v_cvt_pk_bf16_f32 v48, v16, v17
v_mfma_f32_16x16x32_bf16 v[28:31], a[16:19], a[48:51], v[68:71]
v_exp_f32 v18, v18
v_mfma_f32_16x16x32_bf16 v[28:31], a[20:23], a[52:55], v[28:31]
s_mov_b32 m0, 36864
s_add_u32 s92, s34, 4096
v_exp_f32 v19, v19
v_mfma_f32_16x16x32_bf16 v[28:31], a[24:27], a[56:59], v[28:31]
buffer_load_dwordx4 v234, s[12:15], s92 offen offset:0 nt lds
v_exp_f32 v20, v20
v_mfma_f32_16x16x32_bf16 v[28:31], a[28:31], a[60:63], v[28:31]
v_exp_f32 v21, v21
v_mfma_f32_16x16x32_bf16 v[192:195], a[64:67], v[56:59], v[192:195]
v_exp_f32 v22, v22
v_mfma_f32_16x16x32_bf16 v[196:199], a[68:71], v[56:59], v[196:199]
buffer_load_dwordx4 v235, s[12:15], s92 offen offset:1024 nt lds
v_cvt_pk_bf16_f32 v49, v18, v19
v_mfma_f32_16x16x32_bf16 v[200:203], a[72:75], v[56:59], v[200:203]
v_exp_f32 v23, v23
v_mfma_f32_16x16x32_bf16 v[204:207], a[76:79], v[56:59], v[204:207]
v_exp_f32 v24, v24
v_mfma_f32_16x16x32_bf16 v[208:211], a[80:83], v[56:59], v[208:211]
buffer_load_dwordx4 v232, s[12:15], s92 offen offset:2048 nt lds
v_exp_f32 v25, v25
v_mfma_f32_16x16x32_bf16 v[212:215], a[84:87], v[56:59], v[212:215]
v_exp_f32 v26, v26
v_mfma_f32_16x16x32_bf16 v[216:219], a[88:91], v[56:59], v[216:219]
v_exp_f32 v27, v27
v_mfma_f32_16x16x32_bf16 v[220:223], a[92:95], v[56:59], v[220:223]
buffer_load_dwordx4 v233, s[12:15], s92 offen offset:3072 nt lds
v_cvt_pk_bf16_f32 v50, v20, v21
v_mfma_f32_16x16x32_bf16 v[116:119], v[124:127], v[56:59], v[116:119]
v_exp_f32 v28, v28
v_exp_f32 v29, v29
ds_read_b64_tr_b16 a[64:65], v88 offset:57344
v_cvt_pk_bf16_f32 v51, v22, v23
ds_read_b64_tr_b16 a[66:67], v88 offset:61440
v_cvt_pk_bf16_f32 v52, v24, v25
ds_read_b64_tr_b16 a[68:69], v89 offset:57344
v_cvt_pk_bf16_f32 v53, v26, v27
ds_read_b64_tr_b16 a[70:71], v89 offset:61440
v_cvt_pk_bf16_f32 v54, v28, v29
ds_read_b64_tr_b16 a[72:73], v90 offset:57344
ds_read_b64_tr_b16 a[74:75], v90 offset:61440
ds_read_b64_tr_b16 a[76:77], v91 offset:57344
ds_read_b64_tr_b16 a[78:79], v91 offset:61440
v_mfma_f32_16x16x32_bf16 v[32:35], a[0:3], a[96:99], v[72:75]
ds_read_b64_tr_b16 a[80:81], v92 offset:57344
s_mov_b32 m0, 40960
s_add_u32 s92, s34, 8192
v_mfma_f32_16x16x32_bf16 v[32:35], a[4:7], a[100:103], v[32:35]
ds_read_b64_tr_b16 a[82:83], v92 offset:61440
ds_read_b128 v[80:83], v101
buffer_load_dwordx4 v234, s[12:15], s92 offen offset:0 nt lds
v_mfma_f32_16x16x32_bf16 v[32:35], a[8:11], a[104:107], v[32:35]
ds_read_b64_tr_b16 a[84:85], v93 offset:57344
v_mfma_f32_16x16x32_bf16 v[32:35], a[12:15], a[108:111], v[32:35]
ds_read_b64_tr_b16 a[86:87], v93 offset:61440
v_mfma_f32_16x16x32_bf16 v[36:39], a[16:19], a[96:99], v[72:75]
s_waitcnt lgkmcnt(2)
ds_read_b64_tr_b16 a[88:89], v94 offset:57344
buffer_load_dwordx4 v235, s[12:15], s92 offen offset:1024 nt lds
v_min3_u32 v80, v80, v81, v82
v_mfma_f32_16x16x32_bf16 v[36:39], a[20:23], a[100:103], v[36:39]
ds_read_b64_tr_b16 a[90:91], v94 offset:61440
v_min_u32 v80, v80, v83
v_mfma_f32_16x16x32_bf16 v[36:39], a[24:27], a[104:107], v[36:39]
ds_read_b64_tr_b16 a[92:93], v95 offset:57344
v_cmp_gt_u32 vcc, s39, v80
v_mfma_f32_16x16x32_bf16 v[36:39], a[28:31], a[108:111], v[36:39]
s_cbranch_vccnz L_fs15_3
L_fr15_3:
ds_read_b64_tr_b16 a[94:95], v95 offset:61440
buffer_load_dwordx4 v232, s[12:15], s92 offen offset:2048 nt lds
v_exp_f32 v30, v30
v_exp_f32 v31, v31
v_exp_f32 v32, v32
v_exp_f32 v33, v33
v_exp_f32 v34, v34
v_exp_f32 v35, v35
v_exp_f32 v36, v36
s_waitcnt lgkmcnt(0)
v_exp_f32 v37, v37
v_mfma_f32_16x16x32_bf16 v[128:131], a[64:67], v[48:51], v[128:131]
ds_read_b128 a[0:3], v84 offset:0
v_cvt_pk_bf16_f32 v55, v30, v31
v_mfma_f32_16x16x32_bf16 v[132:135], a[68:71], v[48:51], v[132:135]
ds_read_b128 a[4:7], v85 offset:0
v_cvt_pk_bf16_f32 v56, v32, v33
v_mfma_f32_16x16x32_bf16 v[136:139], a[72:75], v[48:51], v[136:139]
ds_read_b128 a[8:11], v86 offset:0
buffer_load_dwordx4 v233, s[12:15], s92 offen offset:3072 nt lds
v_cvt_pk_bf16_f32 v57, v34, v35
v_mfma_f32_16x16x32_bf16 v[140:143], a[76:79], v[48:51], v[140:143]
ds_read_b128 a[12:15], v87 offset:0
v_cvt_pk_bf16_f32 v58, v36, v37
v_mfma_f32_16x16x32_bf16 v[144:147], a[80:83], v[48:51], v[144:147]
ds_read_b128 a[16:19], v84 offset:4096
s_mov_b32 m0, 45056
s_add_u32 s92, s34, 12288
v_mfma_f32_16x16x32_bf16 v[148:151], a[84:87], v[48:51], v[148:151]
ds_read_b128 a[20:23], v85 offset:4096
buffer_load_dwordx4 v234, s[12:15], s92 offen offset:0 nt lds
v_mfma_f32_16x16x32_bf16 v[152:155], a[88:91], v[48:51], v[152:155]
ds_read_b128 a[24:27], v86 offset:4096
v_mfma_f32_16x16x32_bf16 v[156:159], a[92:95], v[48:51], v[156:159]
ds_read_b128 a[28:31], v87 offset:4096
v_mfma_f32_16x16x32_bf16 v[108:111], v[124:127], v[48:51], v[108:111]
buffer_load_dwordx4 v235, s[12:15], s92 offen offset:1024 nt lds
v_exp_f32 v38, v38
v_mfma_f32_16x16x32_bf16 v[160:163], a[64:67], v[52:55], v[160:163]
v_exp_f32 v39, v39
v_mfma_f32_16x16x32_bf16 v[164:167], a[68:71], v[52:55], v[164:167]
v_mfma_f32_16x16x32_bf16 v[168:171], a[72:75], v[52:55], v[168:171]
buffer_load_dwordx4 v232, s[12:15], s92 offen offset:2048 nt lds
v_mfma_f32_16x16x32_bf16 v[172:175], a[76:79], v[52:55], v[172:175]
s_add_u32 s35, s35, 1
v_mfma_f32_16x16x32_bf16 v[176:179], a[80:83], v[52:55], v[176:179]
v_mfma_f32_16x16x32_bf16 v[180:183], a[84:87], v[52:55], v[180:183]
buffer_load_dwordx4 v233, s[12:15], s92 offen offset:3072 nt lds
s_add_u32 s46, s35, s36
v_mfma_f32_16x16x32_bf16 v[184:187], a[88:91], v[52:55], v[184:187]
v_mfma_f32_16x16x32_bf16 v[188:191], a[92:95], v[52:55], v[188:191]
s_cmp_lt_u32 s46, 3
v_mfma_f32_16x16x32_bf16 v[112:115], v[124:127], v[52:55], v[112:115]
s_waitcnt lgkmcnt(0)
s_cbranch_scc1 L_at3
L_atx3:
s_cmp_lg_u32 s36, 0
s_cbranch_scc1 L_fin3
s_add_u32 s47, s34, 8192
s_mov_b32 m0, 98304
v_cvt_pk_bf16_f32 v59, v38, v39
s_nop 1
v_mfma_f32_16x16x32_bf16 v[192:195], a[64:67], v[56:59], v[192:195]
buffer_load_dwordx4 v236, s[16:19], s34 offen offset:0 nt lds
v_cmp_ngt_f32 vcc, 1317011456, v108
v_rcp_f32 v80, v108
v_mfma_f32_16x16x32_bf16 v[196:199], a[68:71], v[56:59], v[196:199]
buffer_load_dwordx4 v237, s[16:19], s34 offen offset:1024 nt lds
s_nop 0
s_or_b32 s38, s38, vcc_lo
s_or_b32 s38, s38, vcc_hi
v_mfma_f32_16x16x32_bf16 v[200:203], a[72:75], v[56:59], v[200:203]
buffer_load_dwordx4 v236, s[16:19], s34 offen offset:2048 nt lds
v_cmp_ngt_f32 vcc, 1317011456, v112
v_rcp_f32 v81, v112
v_mfma_f32_16x16x32_bf16 v[204:207], a[76:79], v[56:59], v[204:207]
buffer_load_dwordx4 v237, s[16:19], s34 offen offset:3072 nt lds
s_mov_b32 m0, 102400
s_add_u32 s92, s34, 4096
s_or_b32 s38, s38, vcc_lo
s_or_b32 s38, s38, vcc_hi
v_mfma_f32_16x16x32_bf16 v[208:211], a[80:83], v[56:59], v[208:211]
buffer_load_dwordx4 v236, s[16:19], s92 offen offset:0 nt lds
v_mul_f32 v128, v128, v80
v_mul_f32 v129, v129, v80
v_mfma_f32_16x16x32_bf16 v[212:215], a[84:87], v[56:59], v[212:215]
buffer_load_dwordx4 v237, s[16:19], s92 offen offset:1024 nt lds
v_mul_f32 v130, v130, v80
v_mul_f32 v131, v131, v80
v_mfma_f32_16x16x32_bf16 v[216:219], a[88:91], v[56:59], v[216:219]
buffer_load_dwordx4 v236, s[16:19], s92 offen offset:2048 nt lds
v_mul_f32 v132, v132, v80
v_mul_f32 v133, v133, v80
v_mfma_f32_16x16x32_bf16 v[220:223], a[92:95], v[56:59], v[220:223]
buffer_load_dwordx4 v237, s[16:19], s92 offen offset:3072 nt lds
s_mov_b32 m0, 106496
s_add_u32 s92, s34, 8192
v_mul_f32 v134, v134, v80
v_mul_f32 v135, v135, v80
v_mfma_f32_16x16x32_bf16 v[116:119], v[124:127], v[56:59], v[116:119]
buffer_load_dwordx4 v236, s[16:19], s92 offen offset:0 nt lds
v_cvt_pk_bf16_f32 v48, v128, v129
v_cvt_pk_bf16_f32 v49, v130, v131
s_waitcnt vmcnt(24)
v_cvt_pk_bf16_f32 v50, v132, v133
s_nop 2
v_cmp_ngt_f32 vcc, 1317011456, v116
v_cvt_pk_bf16_f32 v51, v134, v135
s_add_u32 s46, s43, 0
v_rcp_f32 v82, v116
buffer_load_dwordx4 v237, s[16:19], s92 offen offset:1024 nt lds
buffer_store_dwordx4 v[48:51], v100, s[20:23], s46 offen offset:0 sc1
s_or_b32 s38, s38, vcc_lo
v_mul_f32 v136, v136, v80
v_mul_f32 v137, v137, v80
s_or_b32 s38, s38, vcc_hi
buffer_load_dwordx4 v236, s[16:19], s92 offen offset:2048 nt lds
v_mul_f32 v138, v138, v80
v_mul_f32 v139, v139, v80
v_mul_f32 v140, v140, v80
buffer_load_dwordx4 v237, s[16:19], s92 offen offset:3072 nt lds
v_mul_f32 v141, v141, v80
v_mul_f32 v142, v142, v80
v_mul_f32 v143, v143, v80
s_mov_b32 m0, 110592
v_cvt_pk_bf16_f32 v52, v136, v137
v_cvt_pk_bf16_f32 v53, v138, v139
v_cvt_pk_bf16_f32 v54, v140, v141
s_add_u32 s92, s34, 12288
v_cvt_pk_bf16_f32 v55, v142, v143
s_add_u32 s46, s43, 122880
buffer_store_dwordx4 v[52:55], v100, s[20:23], s46 offen offset:0 sc1
buffer_load_dwordx4 v236, s[16:19], s92 offen offset:0 nt lds
v_mul_f32 v144, v144, v80
v_mul_f32 v145, v145, v80
v_mul_f32 v146, v146, v80
buffer_load_dwordx4 v237, s[16:19], s92 offen offset:1024 nt lds
v_mul_f32 v147, v147, v80
v_mul_f32 v148, v148, v80
v_mul_f32 v149, v149, v80
buffer_load_dwordx4 v236, s[16:19], s92 offen offset:2048 nt lds
v_mul_f32 v150, v150, v80
v_mul_f32 v151, v151, v80
v_cvt_pk_bf16_f32 v48, v144, v145
buffer_load_dwordx4 v237, s[16:19], s92 offen offset:3072 nt lds
v_cvt_pk_bf16_f32 v49, v146, v147
v_cvt_pk_bf16_f32 v50, v148, v149
v_cvt_pk_bf16_f32 v51, v150, v151
s_add_u32 s34, s34, 16384
s_add_u32 s46, s43, 245760
buffer_store_dwordx4 v[48:51], v100, s[20:23], s46 offen offset:0 sc1
v_mul_f32 v152, v152, v80
s_mov_b32 m0, 49152
v_mul_f32 v153, v153, v80
v_mul_f32 v154, v154, v80
v_mul_f32 v155, v155, v80
buffer_load_dwordx4 v234, s[12:15], s34 offen offset:0 nt lds
v_mul_f32 v156, v156, v80
v_mul_f32 v157, v157, v80
v_mul_f32 v158, v158, v80
buffer_load_dwordx4 v235, s[12:15], s34 offen offset:1024 nt lds
v_mul_f32 v159, v159, v80
v_cvt_pk_bf16_f32 v52, v152, v153
v_cvt_pk_bf16_f32 v53, v154, v155
buffer_load_dwordx4 v232, s[12:15], s34 offen offset:2048 nt lds
v_cvt_pk_bf16_f32 v54, v156, v157
v_cvt_pk_bf16_f32 v55, v158, v159
s_add_u32 s46, s43, 368640
buffer_load_dwordx4 v233, s[12:15], s34 offen offset:3072 nt lds
buffer_store_dwordx4 v[52:55], v100, s[20:23], s46 offen offset:0 sc1
s_mov_b32 m0, 53248
s_add_u32 s92, s34, 4096
buffer_load_dwordx4 v234, s[12:15], s92 offen offset:0 nt lds
buffer_load_dwordx4 v235, s[12:15], s92 offen offset:1024 nt lds
buffer_load_dwordx4 v232, s[12:15], s92 offen offset:2048 nt lds
buffer_load_dwordx4 v233, s[12:15], s92 offen offset:3072 nt lds
s_mov_b32 m0, 57344
s_add_u32 s92, s34, 8192
buffer_load_dwordx4 v234, s[12:15], s92 offen offset:0 nt lds
buffer_load_dwordx4 v235, s[12:15], s92 offen offset:1024 nt lds
buffer_load_dwordx4 v232, s[12:15], s92 offen offset:2048 nt lds
buffer_load_dwordx4 v233, s[12:15], s92 offen offset:3072 nt lds
s_mov_b32 m0, 61440
s_add_u32 s92, s34, 12288
buffer_load_dwordx4 v234, s[12:15], s92 offen offset:0 nt lds
buffer_load_dwordx4 v235, s[12:15], s92 offen offset:1024 nt lds
buffer_load_dwordx4 v232, s[12:15], s92 offen offset:2048 nt lds
buffer_load_dwordx4 v233, s[12:15], s92 offen offset:3072 nt lds
v_accvgpr_mov_b32 a32, a128
v_accvgpr_mov_b32 a33, a129
v_accvgpr_mov_b32 a34, a130
v_accvgpr_mov_b32 a35, a131
v_accvgpr_mov_b32 a36, a132
v_accvgpr_mov_b32 a37, a133
v_accvgpr_mov_b32 a38, a134
v_accvgpr_mov_b32 a39, a135
v_accvgpr_mov_b32 a40, a136
v_accvgpr_mov_b32 a41, a137
v_accvgpr_mov_b32 a42, a138
v_accvgpr_mov_b32 a43, a139
v_accvgpr_mov_b32 a44, a140
v_accvgpr_mov_b32 a45, a141
v_accvgpr_mov_b32 a46, a142
v_accvgpr_mov_b32 a47, a143
v_accvgpr_mov_b32 a48, a144
v_accvgpr_mov_b32 a49, a145
v_accvgpr_mov_b32 a50, a146
v_accvgpr_mov_b32 a51, a147
v_accvgpr_mov_b32 a52, a148
v_accvgpr_mov_b32 a53, a149
v_accvgpr_mov_b32 a54, a150
v_accvgpr_mov_b32 a55, a151
v_accvgpr_mov_b32 a56, a152
v_accvgpr_mov_b32 a57, a153
v_accvgpr_mov_b32 a58, a154
v_accvgpr_mov_b32 a59, a155
v_accvgpr_mov_b32 a60, a156
v_accvgpr_mov_b32 a61, a157
v_accvgpr_mov_b32 a62, a158
v_accvgpr_mov_b32 a63, a159
v_accvgpr_mov_b32 a96, a160
v_accvgpr_mov_b32 a97, a161
v_accvgpr_mov_b32 a98, a162
v_accvgpr_mov_b32 a99, a163
v_accvgpr_mov_b32 a100, a164
v_accvgpr_mov_b32 a101, a165
v_accvgpr_mov_b32 a102, a166
v_accvgpr_mov_b32 a103, a167
v_accvgpr_mov_b32 a104, a168
v_accvgpr_mov_b32 a105, a169
v_accvgpr_mov_b32 a106, a170
v_accvgpr_mov_b32 a107, a171
v_accvgpr_mov_b32 a108, a172
v_accvgpr_mov_b32 a109, a173
v_accvgpr_mov_b32 a110, a174
v_accvgpr_mov_b32 a111, a175
v_mfma_f32_16x16x32_bf16 v[16:19], a[0:3], a[32:35], 0
v_mul_f32 v160, v160, v81
v_mul_f32 v161, v161, v81
v_mul_f32 v162, v162, v81
v_mul_f32 v163, v163, v81
v_mfma_f32_16x16x32_bf16 v[16:19], a[4:7], a[36:39], v[16:19]
v_mul_f32 v164, v164, v81
v_mul_f32 v165, v165, v81
v_mul_f32 v166, v166, v81
v_mul_f32 v167, v167, v81
v_mfma_f32_16x16x32_bf16 v[16:19], a[8:11], a[40:43], v[16:19]
v_cvt_pk_bf16_f32 v48, v160, v161
v_cvt_pk_bf16_f32 v49, v162, v163
v_cvt_pk_bf16_f32 v50, v164, v165
v_cvt_pk_bf16_f32 v51, v166, v167
v_mfma_f32_16x16x32_bf16 v[16:19], a[12:15], a[44:47], v[16:19]
s_add_u32 s46, s43, 0
buffer_store_dwordx4 v[48:51], v100, s[20:23], s46 offen offset:1024 sc1
v_mul_f32 v168, v168, v81
v_mul_f32 v169, v169, v81
v_mfma_f32_16x16x32_bf16 v[24:27], a[0:3], a[48:51], 0
v_mul_f32 v170, v170, v81
v_mul_f32 v171, v171, v81
v_mul_f32 v172, v172, v81
v_mul_f32 v173, v173, v81
v_mfma_f32_16x16x32_bf16 v[24:27], a[4:7], a[52:55], v[24:27]
v_mul_f32 v174, v174, v81
v_mul_f32 v175, v175, v81
v_cvt_pk_bf16_f32 v52, v168, v169
v_cvt_pk_bf16_f32 v53, v170, v171
v_mfma_f32_16x16x32_bf16 v[24:27], a[8:11], a[56:59], v[24:27]
v_cvt_pk_bf16_f32 v54, v172, v173
v_cvt_pk_bf16_f32 v55, v174, v175
s_add_u32 s46, s43, 122880
buffer_store_dwordx4 v[52:55], v100, s[20:23], s46 offen offset:1024 sc1
v_mfma_f32_16x16x32_bf16 v[24:27], a[12:15], a[60:63], v[24:27]
v_mul_f32 v176, v176, v81
v_mul_f32 v177, v177, v81
v_mul_f32 v178, v178, v81
v_mul_f32 v179, v179, v81
v_mfma_f32_16x16x32_bf16 v[32:35], a[0:3], a[96:99], 0
v_mul_f32 v180, v180, v81
v_mul_f32 v181, v181, v81
v_mul_f32 v182, v182, v81
v_mul_f32 v183, v183, v81
v_mfma_f32_16x16x32_bf16 v[32:35], a[4:7], a[100:103], v[32:35]
v_cvt_pk_bf16_f32 v48, v176, v177
v_cvt_pk_bf16_f32 v49, v178, v179
v_cvt_pk_bf16_f32 v50, v180, v181
v_cvt_pk_bf16_f32 v51, v182, v183
v_mfma_f32_16x16x32_bf16 v[32:35], a[8:11], a[104:107], v[32:35]
s_add_u32 s46, s43, 245760
buffer_store_dwordx4 v[48:51], v100, s[20:23], s46 offen offset:1024 sc1
v_mul_f32 v184, v184, v81
v_mul_f32 v185, v185, v81
v_mfma_f32_16x16x32_bf16 v[32:35], a[12:15], a[108:111], v[32:35]
v_mul_f32 v186, v186, v81
v_mul_f32 v187, v187, v81
v_mul_f32 v188, v188, v81
v_mul_f32 v189, v189, v81
v_mul_f32 v190, v190, v81
v_mul_f32 v191, v191, v81
v_cvt_pk_bf16_f32 v52, v184, v185
v_cvt_pk_bf16_f32 v53, v186, v187
v_cvt_pk_bf16_f32 v54, v188, v189
v_cvt_pk_bf16_f32 v55, v190, v191
s_add_u32 s46, s43, 368640
buffer_store_dwordx4 v[52:55], v100, s[20:23], s46 offen offset:1024 sc1
v_max3_f32 v16, v16, v17, v18
v_max3_f32 v24, v24, v25, v26
v_max3_f32 v32, v32, v33, v34
v_max_f32 v16, v16, v19
v_max_f32 v24, v24, v27
v_max_f32 v32, v32, v35
v_mov_b32 v108, v16
v_mov_b32 v109, v24
v_mov_b32 v110, v32
v_permlane32_swap_b32 v16, v108
v_permlane32_swap_b32 v24, v109
v_permlane32_swap_b32 v32, v110
v_max_f32 v16, v16, v108
v_max_f32 v24, v24, v109
v_max_f32 v32, v32, v110
v_mov_b32 v108, v16
v_mov_b32 v109, v24
v_mov_b32 v110, v32
v_permlane16_swap_b32 v16, v108
v_permlane16_swap_b32 v24, v109
v_permlane16_swap_b32 v32, v110
v_max_f32 v16, v16, v108
v_max_f32 v24, v24, v109
v_max_f32 v32, v32, v110
v_sub_f32 v64, 0, v16
v_sub_f32 v65, 0, v16
v_sub_f32 v66, 0, v16
v_sub_f32 v67, 0, v16
v_sub_f32 v68, 0, v24
v_sub_f32 v69, 0, v24
v_sub_f32 v70, 0, v24
v_sub_f32 v71, 0, v24
v_sub_f32 v72, 0, v32
v_sub_f32 v73, 0, v32
v_sub_f32 v74, 0, v32
v_sub_f32 v75, 0, v32
v_mov_b32 v4, s38
s_lshl_b32 s46, s32, 2
s_add_u32 s46, s46, 138240
v_mov_b32 v5, s46
ds_write_b32 v5, v4
s_mov_b32 s41, s43
s_add_u32 s43, s43, 491520
s_mov_b32 s36, 1
s_cmp_lg_u32 s37, 0
s_cbranch_scc1 L_maxpass3
L_maxdone13:
v_mfma_f32_16x16x32_bf16 v[16:19], a[0:3], a[32:35], v[64:67]
v_mul_f32 v192, v192, v82
v_mul_f32 v193, v193, v82
v_mul_f32 v194, v194, v82
v_mfma_f32_16x16x32_bf16 v[16:19], a[4:7], a[36:39], v[16:19]
v_mul_f32 v195, v195, v82
v_mul_f32 v196, v196, v82
v_mfma_f32_16x16x32_bf16 v[16:19], a[8:11], a[40:43], v[16:19]
v_mul_f32 v197, v197, v82
v_mul_f32 v198, v198, v82
v_mfma_f32_16x16x32_bf16 v[16:19], a[12:15], a[44:47], v[16:19]
v_mul_f32 v199, v199, v82
v_cvt_pk_bf16_f32 v192, v192, v193
v_mfma_f32_16x16x32_bf16 v[20:23], a[16:19], a[32:35], v[64:67]
v_cvt_pk_bf16_f32 v193, v194, v195
v_cvt_pk_bf16_f32 v194, v196, v197
v_mfma_f32_16x16x32_bf16 v[20:23], a[20:23], a[36:39], v[20:23]
v_cvt_pk_bf16_f32 v195, v198, v199
s_add_u32 s47, s41, 0
buffer_store_dwordx4 v[192:195], v100, s[20:23], s47 offen offset:2048 sc1
v_mul_f32 v200, v200, v82
v_mfma_f32_16x16x32_bf16 v[20:23], a[24:27], a[40:43], v[20:23]
v_mul_f32 v201, v201, v82
v_mul_f32 v202, v202, v82
v_mfma_f32_16x16x32_bf16 v[20:23], a[28:31], a[44:47], v[20:23]
v_mul_f32 v203, v203, v82
v_mul_f32 v204, v204, v82
v_mfma_f32_16x16x32_bf16 v[24:27], a[0:3], a[48:51], v[68:71]
v_mul_f32 v205, v205, v82
v_mul_f32 v206, v206, v82
v_mfma_f32_16x16x32_bf16 v[24:27], a[4:7], a[52:55], v[24:27]
v_exp_f32 v16, v16
v_mfma_f32_16x16x32_bf16 v[24:27], a[8:11], a[56:59], v[24:27]
v_exp_f32 v17, v17
v_mfma_f32_16x16x32_bf16 v[24:27], a[12:15], a[60:63], v[24:27]
v_cvt_pk_bf16_f32 v48, v16, v17
v_mul_f32 v207, v207, v82
v_mfma_f32_16x16x32_bf16 v[28:31], a[16:19], a[48:51], v[68:71]
v_exp_f32 v18, v18
v_mfma_f32_16x16x32_bf16 v[28:31], a[20:23], a[52:55], v[28:31]
v_exp_f32 v19, v19
v_mfma_f32_16x16x32_bf16 v[28:31], a[24:27], a[56:59], v[28:31]
v_exp_f32 v20, v20
v_mfma_f32_16x16x32_bf16 v[28:31], a[28:31], a[60:63], v[28:31]
v_exp_f32 v21, v21
v_exp_f32 v22, v22
v_cvt_pk_bf16_f32 v49, v18, v19
v_exp_f32 v23, v23
v_exp_f32 v24, v24
v_exp_f32 v25, v25
v_exp_f32 v26, v26
v_exp_f32 v27, v27
v_cvt_pk_bf16_f32 v50, v20, v21
v_exp_f32 v28, v28
v_exp_f32 v29, v29
ds_read_b64_tr_b16 a[64:65], v88 offset:0
v_cvt_pk_bf16_f32 v51, v22, v23
ds_read_b64_tr_b16 a[66:67], v88 offset:4096
v_cvt_pk_bf16_f32 v52, v24, v25
ds_read_b64_tr_b16 a[68:69], v89 offset:0
v_cvt_pk_bf16_f32 v53, v26, v27
ds_read_b64_tr_b16 a[70:71], v89 offset:4096
v_cvt_pk_bf16_f32 v54, v28, v29
ds_read_b64_tr_b16 a[72:73], v90 offset:0
ds_read_b64_tr_b16 a[74:75], v90 offset:4096
ds_read_b64_tr_b16 a[76:77], v91 offset:0
ds_read_b64_tr_b16 a[78:79], v91 offset:4096
v_mfma_f32_16x16x32_bf16 v[32:35], a[0:3], a[96:99], v[72:75]
ds_read_b64_tr_b16 a[80:81], v92 offset:0
v_cvt_pk_bf16_f32 v200, v200, v201
v_mfma_f32_16x16x32_bf16 v[32:35], a[4:7], a[100:103], v[32:35]
ds_read_b64_tr_b16 a[82:83], v92 offset:4096
v_cvt_pk_bf16_f32 v201, v202, v203
v_mfma_f32_16x16x32_bf16 v[32:35], a[8:11], a[104:107], v[32:35]
ds_read_b64_tr_b16 a[84:85], v93 offset:0
v_cvt_pk_bf16_f32 v202, v204, v205
v_mfma_f32_16x16x32_bf16 v[32:35], a[12:15], a[108:111], v[32:35]
ds_read_b64_tr_b16 a[86:87], v93 offset:4096
v_cvt_pk_bf16_f32 v203, v206, v207
s_add_u32 s47, s41, 122880
buffer_store_dwordx4 v[200:203], v100, s[20:23], s47 offen offset:2048 sc1
v_mfma_f32_16x16x32_bf16 v[36:39], a[16:19], a[96:99], v[72:75]
ds_read_b64_tr_b16 a[88:89], v94 offset:0
v_mul_f32 v208, v208, v82
v_mfma_f32_16x16x32_bf16 v[36:39], a[20:23], a[100:103], v[36:39]
ds_read_b64_tr_b16 a[90:91], v94 offset:4096
v_mul_f32 v209, v209, v82
v_mfma_f32_16x16x32_bf16 v[36:39], a[24:27], a[104:107], v[36:39]
ds_read_b64_tr_b16 a[92:93], v95 offset:0
v_mul_f32 v210, v210, v82
v_mfma_f32_16x16x32_bf16 v[36:39], a[28:31], a[108:111], v[36:39]
ds_read_b64_tr_b16 a[94:95], v95 offset:4096
v_mul_f32 v211, v211, v82
v_exp_f32 v30, v30
v_exp_f32 v31, v31
v_exp_f32 v32, v32
v_exp_f32 v33, v33
v_exp_f32 v34, v34
v_exp_f32 v35, v35
v_exp_f32 v36, v36
s_waitcnt lgkmcnt(0)
v_exp_f32 v37, v37
v_mfma_f32_16x16x32_bf16 v[128:131], a[64:67], v[48:51], 0
ds_read_b128 a[0:3], v84 offset:8192
v_cvt_pk_bf16_f32 v55, v30, v31
v_mfma_f32_16x16x32_bf16 v[132:135], a[68:71], v[48:51], 0
ds_read_b128 a[4:7], v85 offset:8192
v_cvt_pk_bf16_f32 v56, v32, v33
v_mfma_f32_16x16x32_bf16 v[136:139], a[72:75], v[48:51], 0
ds_read_b128 a[8:11], v86 offset:8192
v_cvt_pk_bf16_f32 v57, v34, v35
v_mfma_f32_16x16x32_bf16 v[140:143], a[76:79], v[48:51], 0
ds_read_b128 a[12:15], v87 offset:8192
v_cvt_pk_bf16_f32 v58, v36, v37
v_mfma_f32_16x16x32_bf16 v[144:147], a[80:83], v[48:51], 0
ds_read_b128 a[16:19], v84 offset:12288
v_mul_f32 v212, v212, v82
v_mfma_f32_16x16x32_bf16 v[148:151], a[84:87], v[48:51], 0
ds_read_b128 a[20:23], v85 offset:12288
v_mul_f32 v213, v213, v82
v_mfma_f32_16x16x32_bf16 v[152:155], a[88:91], v[48:51], 0
ds_read_b128 a[24:27], v86 offset:12288
v_mul_f32 v214, v214, v82
v_mfma_f32_16x16x32_bf16 v[156:159], a[92:95], v[48:51], 0
ds_read_b128 a[28:31], v87 offset:12288
v_mul_f32 v215, v215, v82
v_mfma_f32_16x16x32_bf16 v[108:111], v[124:127], v[48:51], 0
v_exp_f32 v38, v38
v_mfma_f32_16x16x32_bf16 v[160:163], a[64:67], v[52:55], 0
v_exp_f32 v39, v39
v_mfma_f32_16x16x32_bf16 v[164:167], a[68:71], v[52:55], 0
v_cvt_pk_bf16_f32 v208, v208, v209
v_cvt_pk_bf16_f32 v209, v210, v211
v_mfma_f32_16x16x32_bf16 v[168:171], a[72:75], v[52:55], 0
v_cvt_pk_bf16_f32 v210, v212, v213
v_cvt_pk_bf16_f32 v211, v214, v215
s_add_u32 s47, s41, 245760
buffer_store_dwordx4 v[208:211], v100, s[20:23], s47 offen offset:2048 sc1
v_mfma_f32_16x16x32_bf16 v[172:175], a[76:79], v[52:55], 0
v_mul_f32 v216, v216, v82
v_mul_f32 v217, v217, v82
v_mfma_f32_16x16x32_bf16 v[176:179], a[80:83], v[52:55], 0
v_mul_f32 v218, v218, v82
v_mul_f32 v219, v219, v82
v_mfma_f32_16x16x32_bf16 v[180:183], a[84:87], v[52:55], 0
v_mul_f32 v220, v220, v82
v_mul_f32 v221, v221, v82
v_mfma_f32_16x16x32_bf16 v[184:187], a[88:91], v[52:55], 0
v_mul_f32 v222, v222, v82
v_mul_f32 v223, v223, v82
v_mfma_f32_16x16x32_bf16 v[188:191], a[92:95], v[52:55], 0
v_cvt_pk_bf16_f32 v216, v216, v217
v_cvt_pk_bf16_f32 v217, v218, v219
v_mfma_f32_16x16x32_bf16 v[112:115], v[124:127], v[52:55], 0
s_waitcnt lgkmcnt(0)
v_cvt_pk_bf16_f32 v218, v220, v221
v_cvt_pk_bf16_f32 v219, v222, v223
s_add_u32 s47, s41, 368640
buffer_store_dwordx4 v[216:219], v100, s[20:23], s47 offen offset:2048 sc1
v_mfma_f32_16x16x32_bf16 v[16:19], a[0:3], a[32:35], v[64:67]
v_cvt_pk_bf16_f32 v59, v38, v39
v_mfma_f32_16x16x32_bf16 v[16:19], a[4:7], a[36:39], v[16:19]
v_mfma_f32_16x16x32_bf16 v[16:19], a[8:11], a[40:43], v[16:19]
v_mfma_f32_16x16x32_bf16 v[16:19], a[12:15], a[44:47], v[16:19]
v_mfma_f32_16x16x32_bf16 v[20:23], a[16:19], a[32:35], v[64:67]
v_mfma_f32_16x16x32_bf16 v[20:23], a[20:23], a[36:39], v[20:23]
s_add_u32 s39, s39, 1
v_mfma_f32_16x16x32_bf16 v[20:23], a[24:27], a[40:43], v[20:23]
v_mov_b32 v80, s39
v_mfma_f32_16x16x32_bf16 v[20:23], a[28:31], a[44:47], v[20:23]
v_mfma_f32_16x16x32_bf16 v[24:27], a[0:3], a[48:51], v[68:71]
s_waitcnt vmcnt(60)
ds_write_b32 v1, v80
v_mfma_f32_16x16x32_bf16 v[24:27], a[4:7], a[52:55], v[24:27]
v_exp_f32 v16, v16
v_mfma_f32_16x16x32_bf16 v[24:27], a[8:11], a[56:59], v[24:27]
v_exp_f32 v17, v17
v_mfma_f32_16x16x32_bf16 v[24:27], a[12:15], a[60:63], v[24:27]
v_cvt_pk_bf16_f32 v48, v16, v17
v_mfma_f32_16x16x32_bf16 v[28:31], a[16:19], a[48:51], v[68:71]
v_exp_f32 v18, v18
v_mfma_f32_16x16x32_bf16 v[28:31], a[20:23], a[52:55], v[28:31]
v_exp_f32 v19, v19
v_mfma_f32_16x16x32_bf16 v[28:31], a[24:27], a[56:59], v[28:31]
v_exp_f32 v20, v20
v_mfma_f32_16x16x32_bf16 v[28:31], a[28:31], a[60:63], v[28:31]
v_exp_f32 v21, v21
v_mfma_f32_16x16x32_bf16 v[192:195], a[64:67], v[56:59], 0
v_exp_f32 v22, v22
v_mfma_f32_16x16x32_bf16 v[196:199], a[68:71], v[56:59], 0
v_cvt_pk_bf16_f32 v49, v18, v19
v_mfma_f32_16x16x32_bf16 v[200:203], a[72:75], v[56:59], 0
v_exp_f32 v23, v23
v_mfma_f32_16x16x32_bf16 v[204:207], a[76:79], v[56:59], 0
v_exp_f32 v24, v24
v_mfma_f32_16x16x32_bf16 v[208:211], a[80:83], v[56:59], 0
v_exp_f32 v25, v25
v_mfma_f32_16x16x32_bf16 v[212:215], a[84:87], v[56:59], 0
v_exp_f32 v26, v26
v_mfma_f32_16x16x32_bf16 v[216:219], a[88:91], v[56:59], 0
v_exp_f32 v27, v27
v_mfma_f32_16x16x32_bf16 v[220:223], a[92:95], v[56:59], 0
v_cvt_pk_bf16_f32 v50, v20, v21
v_mfma_f32_16x16x32_bf16 v[116:119], v[124:127], v[56:59], 0
v_exp_f32 v28, v28
v_exp_f32 v29, v29
ds_read_b64_tr_b16 a[64:65], v88 offset:8192
v_cvt_pk_bf16_f32 v51, v22, v23
ds_read_b64_tr_b16 a[66:67], v88 offset:12288
v_cvt_pk_bf16_f32 v52, v24, v25
ds_read_b64_tr_b16 a[68:69], v89 offset:8192
v_cvt_pk_bf16_f32 v53, v26, v27
ds_read_b64_tr_b16 a[70:71], v89 offset:12288
v_cvt_pk_bf16_f32 v54, v28, v29
ds_read_b64_tr_b16 a[72:73], v90 offset:8192
ds_read_b64_tr_b16 a[74:75], v90 offset:12288
ds_read_b64_tr_b16 a[76:77], v91 offset:8192
ds_read_b64_tr_b16 a[78:79], v91 offset:12288
v_mfma_f32_16x16x32_bf16 v[32:35], a[0:3], a[96:99], v[72:75]
ds_read_b64_tr_b16 a[80:81], v92 offset:8192
v_mfma_f32_16x16x32_bf16 v[32:35], a[4:7], a[100:103], v[32:35]
ds_read_b64_tr_b16 a[82:83], v92 offset:12288
ds_read_b128 v[80:83], v101
v_mfma_f32_16x16x32_bf16 v[32:35], a[8:11], a[104:107], v[32:35]
ds_read_b64_tr_b16 a[84:85], v93 offset:8192
v_mfma_f32_16x16x32_bf16 v[32:35], a[12:15], a[108:111], v[32:35]
ds_read_b64_tr_b16 a[86:87], v93 offset:12288
v_mfma_f32_16x16x32_bf16 v[36:39], a[16:19], a[96:99], v[72:75]
s_waitcnt lgkmcnt(2)
ds_read_b64_tr_b16 a[88:89], v94 offset:8192
v_min3_u32 v80, v80, v81, v82
v_mfma_f32_16x16x32_bf16 v[36:39], a[20:23], a[100:103], v[36:39]
ds_read_b64_tr_b16 a[90:91], v94 offset:12288
v_min_u32 v80, v80, v83
v_mfma_f32_16x16x32_bf16 v[36:39], a[24:27], a[104:107], v[36:39]
ds_read_b64_tr_b16 a[92:93], v95 offset:8192
v_cmp_gt_u32 vcc, s39, v80
v_mfma_f32_16x16x32_bf16 v[36:39], a[28:31], a[108:111], v[36:39]
s_cbranch_vccnz L_fs33_3
L_fr33_3:
ds_read_b64_tr_b16 a[94:95], v95 offset:12288
v_exp_f32 v30, v30
v_exp_f32 v31, v31
v_exp_f32 v32, v32
v_exp_f32 v33, v33
v_exp_f32 v34, v34
v_exp_f32 v35, v35
v_exp_f32 v36, v36
s_waitcnt lgkmcnt(0)
v_exp_f32 v37, v37
v_mfma_f32_16x16x32_bf16 v[128:131], a[64:67], v[48:51], v[128:131]
ds_read_b128 a[0:3], v84 offset:16384
v_cvt_pk_bf16_f32 v55, v30, v31
v_mfma_f32_16x16x32_bf16 v[132:135], a[68:71], v[48:51], v[132:135]
ds_read_b128 a[4:7], v85 offset:16384
v_cvt_pk_bf16_f32 v56, v32, v33
v_mfma_f32_16x16x32_bf16 v[136:139], a[72:75], v[48:51], v[136:139]
ds_read_b128 a[8:11], v86 offset:16384
v_cvt_pk_bf16_f32 v57, v34, v35
v_mfma_f32_16x16x32_bf16 v[140:143], a[76:79], v[48:51], v[140:143]
ds_read_b128 a[12:15], v87 offset:16384
v_cvt_pk_bf16_f32 v58, v36, v37
v_mfma_f32_16x16x32_bf16 v[144:147], a[80:83], v[48:51], v[144:147]
ds_read_b128 a[16:19], v84 offset:20480
v_mfma_f32_16x16x32_bf16 v[148:151], a[84:87], v[48:51], v[148:151]
ds_read_b128 a[20:23], v85 offset:20480
v_mfma_f32_16x16x32_bf16 v[152:155], a[88:91], v[48:51], v[152:155]
ds_read_b128 a[24:27], v86 offset:20480
v_mfma_f32_16x16x32_bf16 v[156:159], a[92:95], v[48:51], v[156:159]
ds_read_b128 a[28:31], v87 offset:20480
v_mfma_f32_16x16x32_bf16 v[108:111], v[124:127], v[48:51], v[108:111]
v_exp_f32 v38, v38
v_mfma_f32_16x16x32_bf16 v[160:163], a[64:67], v[52:55], v[160:163]
v_exp_f32 v39, v39
v_mfma_f32_16x16x32_bf16 v[164:167], a[68:71], v[52:55], v[164:167]
v_mfma_f32_16x16x32_bf16 v[168:171], a[72:75], v[52:55], v[168:171]
v_mfma_f32_16x16x32_bf16 v[172:175], a[76:79], v[52:55], v[172:175]
v_mfma_f32_16x16x32_bf16 v[176:179], a[80:83], v[52:55], v[176:179]
v_mfma_f32_16x16x32_bf16 v[180:183], a[84:87], v[52:55], v[180:183]
v_mfma_f32_16x16x32_bf16 v[184:187], a[88:91], v[52:55], v[184:187]
v_mfma_f32_16x16x32_bf16 v[188:191], a[92:95], v[52:55], v[188:191]
v_mfma_f32_16x16x32_bf16 v[112:115], v[124:127], v[52:55], v[112:115]
s_waitcnt lgkmcnt(0)
v_mfma_f32_16x16x32_bf16 v[16:19], a[0:3], a[32:35], v[64:67]
s_waitcnt vmcnt(36)
v_cvt_pk_bf16_f32 v59, v38, v39
v_mfma_f32_16x16x32_bf16 v[16:19], a[4:7], a[36:39], v[16:19]
s_mov_b32 m0, 114688
v_mfma_f32_16x16x32_bf16 v[16:19], a[8:11], a[40:43], v[16:19]
buffer_load_dwordx4 v236, s[16:19], s34 offen offset:0 nt lds
v_mfma_f32_16x16x32_bf16 v[16:19], a[12:15], a[44:47], v[16:19]
v_mfma_f32_16x16x32_bf16 v[20:23], a[16:19], a[32:35], v[64:67]
v_mfma_f32_16x16x32_bf16 v[20:23], a[20:23], a[36:39], v[20:23]
buffer_load_dwordx4 v237, s[16:19], s34 offen offset:1024 nt lds
v_mfma_f32_16x16x32_bf16 v[20:23], a[24:27], a[40:43], v[20:23]
v_mfma_f32_16x16x32_bf16 v[20:23], a[28:31], a[44:47], v[20:23]
v_mfma_f32_16x16x32_bf16 v[24:27], a[0:3], a[48:51], v[68:71]
buffer_load_dwordx4 v236, s[16:19], s34 offen offset:2048 nt lds
v_mfma_f32_16x16x32_bf16 v[24:27], a[4:7], a[52:55], v[24:27]
v_exp_f32 v16, v16
v_mfma_f32_16x16x32_bf16 v[24:27], a[8:11], a[56:59], v[24:27]
v_exp_f32 v17, v17
v_mfma_f32_16x16x32_bf16 v[24:27], a[12:15], a[60:63], v[24:27]
buffer_load_dwordx4 v237, s[16:19], s34 offen offset:3072 nt lds
v_cvt_pk_bf16_f32 v48, v16, v17
v_mfma_f32_16x16x32_bf16 v[28:31], a[16:19], a[48:51], v[68:71]
v_exp_f32 v18, v18
v_mfma_f32_16x16x32_bf16 v[28:31], a[20:23], a[52:55], v[28:31]
s_mov_b32 m0, 118784
s_add_u32 s92, s34, 4096
v_exp_f32 v19, v19
v_mfma_f32_16x16x32_bf16 v[28:31], a[24:27], a[56:59], v[28:31]
buffer_load_dwordx4 v236, s[16:19], s92 offen offset:0 nt lds
v_exp_f32 v20, v20
v_mfma_f32_16x16x32_bf16 v[28:31], a[28:31], a[60:63], v[28:31]
v_exp_f32 v21, v21
v_mfma_f32_16x16x32_bf16 v[192:195], a[64:67], v[56:59], v[192:195]
v_exp_f32 v22, v22
v_mfma_f32_16x16x32_bf16 v[196:199], a[68:71], v[56:59], v[196:199]
buffer_load_dwordx4 v237, s[16:19], s92 offen offset:1024 nt lds
v_cvt_pk_bf16_f32 v49, v18, v19
v_mfma_f32_16x16x32_bf16 v[200:203], a[72:75], v[56:59], v[200:203]
v_exp_f32 v23, v23
v_mfma_f32_16x16x32_bf16 v[204:207], a[76:79], v[56:59], v[204:207]
v_exp_f32 v24, v24
v_mfma_f32_16x16x32_bf16 v[208:211], a[80:83], v[56:59], v[208:211]
buffer_load_dwordx4 v236, s[16:19], s92 offen offset:2048 nt lds
v_exp_f32 v25, v25
v_mfma_f32_16x16x32_bf16 v[212:215], a[84:87], v[56:59], v[212:215]
v_exp_f32 v26, v26
v_mfma_f32_16x16x32_bf16 v[216:219], a[88:91], v[56:59], v[216:219]
v_exp_f32 v27, v27
v_mfma_f32_16x16x32_bf16 v[220:223], a[92:95], v[56:59], v[220:223]
buffer_load_dwordx4 v237, s[16:19], s92 offen offset:3072 nt lds
v_cvt_pk_bf16_f32 v50, v20, v21
v_mfma_f32_16x16x32_bf16 v[116:119], v[124:127], v[56:59], v[116:119]
v_exp_f32 v28, v28
v_exp_f32 v29, v29
ds_read_b64_tr_b16 a[64:65], v88 offset:16384
v_cvt_pk_bf16_f32 v51, v22, v23
ds_read_b64_tr_b16 a[66:67], v88 offset:20480
v_cvt_pk_bf16_f32 v52, v24, v25
ds_read_b64_tr_b16 a[68:69], v89 offset:16384
v_cvt_pk_bf16_f32 v53, v26, v27
ds_read_b64_tr_b16 a[70:71], v89 offset:20480
v_cvt_pk_bf16_f32 v54, v28, v29
ds_read_b64_tr_b16 a[72:73], v90 offset:16384
ds_read_b64_tr_b16 a[74:75], v90 offset:20480
ds_read_b64_tr_b16 a[76:77], v91 offset:16384
ds_read_b64_tr_b16 a[78:79], v91 offset:20480
v_mfma_f32_16x16x32_bf16 v[32:35], a[0:3], a[96:99], v[72:75]
ds_read_b64_tr_b16 a[80:81], v92 offset:16384
s_mov_b32 m0, 122880
s_add_u32 s92, s34, 8192
v_mfma_f32_16x16x32_bf16 v[32:35], a[4:7], a[100:103], v[32:35]
ds_read_b64_tr_b16 a[82:83], v92 offset:20480
buffer_load_dwordx4 v236, s[16:19], s92 offen offset:0 nt lds
v_mfma_f32_16x16x32_bf16 v[32:35], a[8:11], a[104:107], v[32:35]
ds_read_b64_tr_b16 a[84:85], v93 offset:16384
v_mfma_f32_16x16x32_bf16 v[32:35], a[12:15], a[108:111], v[32:35]
ds_read_b64_tr_b16 a[86:87], v93 offset:20480
v_mfma_f32_16x16x32_bf16 v[36:39], a[16:19], a[96:99], v[72:75]
ds_read_b64_tr_b16 a[88:89], v94 offset:16384
buffer_load_dwordx4 v237, s[16:19], s92 offen offset:1024 nt lds
v_mfma_f32_16x16x32_bf16 v[36:39], a[20:23], a[100:103], v[36:39]
ds_read_b64_tr_b16 a[90:91], v94 offset:20480
v_mfma_f32_16x16x32_bf16 v[36:39], a[24:27], a[104:107], v[36:39]
ds_read_b64_tr_b16 a[92:93], v95 offset:16384
v_mfma_f32_16x16x32_bf16 v[36:39], a[28:31], a[108:111], v[36:39]
ds_read_b64_tr_b16 a[94:95], v95 offset:20480
buffer_load_dwordx4 v236, s[16:19], s92 offen offset:2048 nt lds
v_exp_f32 v30, v30
v_exp_f32 v31, v31
v_exp_f32 v32, v32
v_exp_f32 v33, v33
v_exp_f32 v34, v34
v_exp_f32 v35, v35
v_exp_f32 v36, v36
s_waitcnt lgkmcnt(0)
v_exp_f32 v37, v37
v_mfma_f32_16x16x32_bf16 v[128:131], a[64:67], v[48:51], v[128:131]
ds_read_b128 a[0:3], v84 offset:24576
v_cvt_pk_bf16_f32 v55, v30, v31
v_mfma_f32_16x16x32_bf16 v[132:135], a[68:71], v[48:51], v[132:135]
ds_read_b128 a[4:7], v85 offset:24576
v_cvt_pk_bf16_f32 v56, v32, v33
v_mfma_f32_16x16x32_bf16 v[136:139], a[72:75], v[48:51], v[136:139]
ds_read_b128 a[8:11], v86 offset:24576
buffer_load_dwordx4 v237, s[16:19], s92 offen offset:3072 nt lds
v_cvt_pk_bf16_f32 v57, v34, v35
v_mfma_f32_16x16x32_bf16 v[140:143], a[76:79], v[48:51], v[140:143]
ds_read_b128 a[12:15], v87 offset:24576
v_cvt_pk_bf16_f32 v58, v36, v37
v_mfma_f32_16x16x32_bf16 v[144:147], a[80:83], v[48:51], v[144:147]
ds_read_b128 a[16:19], v84 offset:28672
s_mov_b32 m0, 126976
s_add_u32 s92, s34, 12288
v_mfma_f32_16x16x32_bf16 v[148:151], a[84:87], v[48:51], v[148:151]
ds_read_b128 a[20:23], v85 offset:28672
buffer_load_dwordx4 v236, s[16:19], s92 offen offset:0 nt lds
v_mfma_f32_16x16x32_bf16 v[152:155], a[88:91], v[48:51], v[152:155]
ds_read_b128 a[24:27], v86 offset:28672
v_mfma_f32_16x16x32_bf16 v[156:159], a[92:95], v[48:51], v[156:159]
ds_read_b128 a[28:31], v87 offset:28672
v_mfma_f32_16x16x32_bf16 v[108:111], v[124:127], v[48:51], v[108:111]
buffer_load_dwordx4 v237, s[16:19], s92 offen offset:1024 nt lds
v_exp_f32 v38, v38
v_mfma_f32_16x16x32_bf16 v[160:163], a[64:67], v[52:55], v[160:163]
v_exp_f32 v39, v39
v_mfma_f32_16x16x32_bf16 v[164:167], a[68:71], v[52:55], v[164:167]
v_mfma_f32_16x16x32_bf16 v[168:171], a[72:75], v[52:55], v[168:171]
buffer_load_dwordx4 v236, s[16:19], s92 offen offset:2048 nt lds
v_mfma_f32_16x16x32_bf16 v[172:175], a[76:79], v[52:55], v[172:175]
v_mfma_f32_16x16x32_bf16 v[176:179], a[80:83], v[52:55], v[176:179]
s_add_u32 s34, s34, 16384
v_mfma_f32_16x16x32_bf16 v[180:183], a[84:87], v[52:55], v[180:183]
buffer_load_dwordx4 v237, s[16:19], s92 offen offset:3072 nt lds
v_mfma_f32_16x16x32_bf16 v[184:187], a[88:91], v[52:55], v[184:187]
v_mfma_f32_16x16x32_bf16 v[188:191], a[92:95], v[52:55], v[188:191]
v_mfma_f32_16x16x32_bf16 v[112:115], v[124:127], v[52:55], v[112:115]
s_waitcnt lgkmcnt(0)
v_mfma_f32_16x16x32_bf16 v[16:19], a[0:3], a[32:35], v[64:67]
v_cvt_pk_bf16_f32 v59, v38, v39
v_mfma_f32_16x16x32_bf16 v[16:19], a[4:7], a[36:39], v[16:19]
s_mov_b32 m0, 0
v_mfma_f32_16x16x32_bf16 v[16:19], a[8:11], a[40:43], v[16:19]
buffer_load_dwordx4 v234, s[12:15], s34 offen offset:0 nt lds
v_mfma_f32_16x16x32_bf16 v[16:19], a[12:15], a[44:47], v[16:19]
v_mfma_f32_16x16x32_bf16 v[20:23], a[16:19], a[32:35], v[64:67]
v_mfma_f32_16x16x32_bf16 v[20:23], a[20:23], a[36:39], v[20:23]
s_add_u32 s39, s39, 1
buffer_load_dwordx4 v235, s[12:15], s34 offen offset:1024 nt lds
v_mfma_f32_16x16x32_bf16 v[20:23], a[24:27], a[40:43], v[20:23]
v_mov_b32 v80, s39
v_mfma_f32_16x16x32_bf16 v[20:23], a[28:31], a[44:47], v[20:23]
v_mfma_f32_16x16x32_bf16 v[24:27], a[0:3], a[48:51], v[68:71]
s_waitcnt vmcnt(44)
ds_write_b32 v1, v80
buffer_load_dwordx4 v232, s[12:15], s34 offen offset:2048 nt lds
v_mfma_f32_16x16x32_bf16 v[24:27], a[4:7], a[52:55], v[24:27]
v_exp_f32 v16, v16
v_mfma_f32_16x16x32_bf16 v[24:27], a[8:11], a[56:59], v[24:27]
v_exp_f32 v17, v17
v_mfma_f32_16x16x32_bf16 v[24:27], a[12:15], a[60:63], v[24:27]
buffer_load_dwordx4 v233, s[12:15], s34 offen offset:3072 nt lds
v_cvt_pk_bf16_f32 v48, v16, v17
v_mfma_f32_16x16x32_bf16 v[28:31], a[16:19], a[48:51], v[68:71]
v_exp_f32 v18, v18
v_mfma_f32_16x16x32_bf16 v[28:31], a[20:23], a[52:55], v[28:31]
s_mov_b32 m0, 4096
s_add_u32 s92, s34, 4096
v_exp_f32 v19, v19
v_mfma_f32_16x16x32_bf16 v[28:31], a[24:27], a[56:59], v[28:31]
buffer_load_dwordx4 v234, s[12:15], s92 offen offset:0 nt lds
v_exp_f32 v20, v20
v_mfma_f32_16x16x32_bf16 v[28:31], a[28:31], a[60:63], v[28:31]
v_exp_f32 v21, v21
v_mfma_f32_16x16x32_bf16 v[192:195], a[64:67], v[56:59], v[192:195]
v_exp_f32 v22, v22
v_mfma_f32_16x16x32_bf16 v[196:199], a[68:71], v[56:59], v[196:199]
buffer_load_dwordx4 v235, s[12:15], s92 offen offset:1024 nt lds
v_cvt_pk_bf16_f32 v49, v18, v19
v_mfma_f32_16x16x32_bf16 v[200:203], a[72:75], v[56:59], v[200:203]
v_exp_f32 v23, v23
v_mfma_f32_16x16x32_bf16 v[204:207], a[76:79], v[56:59], v[204:207]
v_exp_f32 v24, v24
v_mfma_f32_16x16x32_bf16 v[208:211], a[80:83], v[56:59], v[208:211]
buffer_load_dwordx4 v232, s[12:15], s92 offen offset:2048 nt lds
v_exp_f32 v25, v25
v_mfma_f32_16x16x32_bf16 v[212:215], a[84:87], v[56:59], v[212:215]
v_exp_f32 v26, v26
v_mfma_f32_16x16x32_bf16 v[216:219], a[88:91], v[56:59], v[216:219]
v_exp_f32 v27, v27
v_mfma_f32_16x16x32_bf16 v[220:223], a[92:95], v[56:59], v[220:223]
buffer_load_dwordx4 v233, s[12:15], s92 offen offset:3072 nt lds
v_cvt_pk_bf16_f32 v50, v20, v21
v_mfma_f32_16x16x32_bf16 v[116:119], v[124:127], v[56:59], v[116:119]
v_exp_f32 v28, v28
v_exp_f32 v29, v29
ds_read_b64_tr_b16 a[64:65], v88 offset:24576
v_cvt_pk_bf16_f32 v51, v22, v23
ds_read_b64_tr_b16 a[66:67], v88 offset:28672
v_cvt_pk_bf16_f32 v52, v24, v25
ds_read_b64_tr_b16 a[68:69], v89 offset:24576
v_cvt_pk_bf16_f32 v53, v26, v27
ds_read_b64_tr_b16 a[70:71], v89 offset:28672
v_cvt_pk_bf16_f32 v54, v28, v29
ds_read_b64_tr_b16 a[72:73], v90 offset:24576
ds_read_b64_tr_b16 a[74:75], v90 offset:28672
ds_read_b64_tr_b16 a[76:77], v91 offset:24576
ds_read_b64_tr_b16 a[78:79], v91 offset:28672
v_mfma_f32_16x16x32_bf16 v[32:35], a[0:3], a[96:99], v[72:75]
ds_read_b64_tr_b16 a[80:81], v92 offset:24576
s_mov_b32 m0, 8192
s_add_u32 s92, s34, 8192
v_mfma_f32_16x16x32_bf16 v[32:35], a[4:7], a[100:103], v[32:35]
ds_read_b64_tr_b16 a[82:83], v92 offset:28672
ds_read_b128 v[80:83], v101
buffer_load_dwordx4 v234, s[12:15], s92 offen offset:0 nt lds
v_mfma_f32_16x16x32_bf16 v[32:35], a[8:11], a[104:107], v[32:35]
ds_read_b64_tr_b16 a[84:85], v93 offset:24576
v_mfma_f32_16x16x32_bf16 v[32:35], a[12:15], a[108:111], v[32:35]
ds_read_b64_tr_b16 a[86:87], v93 offset:28672
v_mfma_f32_16x16x32_bf16 v[36:39], a[16:19], a[96:99], v[72:75]
s_waitcnt lgkmcnt(2)
ds_read_b64_tr_b16 a[88:89], v94 offset:24576
buffer_load_dwordx4 v235, s[12:15], s92 offen offset:1024 nt lds
v_min3_u32 v80, v80, v81, v82
v_mfma_f32_16x16x32_bf16 v[36:39], a[20:23], a[100:103], v[36:39]
ds_read_b64_tr_b16 a[90:91], v94 offset:28672
v_min_u32 v80, v80, v83
v_mfma_f32_16x16x32_bf16 v[36:39], a[24:27], a[104:107], v[36:39]
ds_read_b64_tr_b16 a[92:93], v95 offset:24576
v_cmp_gt_u32 vcc, s39, v80
v_mfma_f32_16x16x32_bf16 v[36:39], a[28:31], a[108:111], v[36:39]
s_cbranch_vccnz L_fs35_3
L_fr35_3:
ds_read_b64_tr_b16 a[94:95], v95 offset:28672
buffer_load_dwordx4 v232, s[12:15], s92 offen offset:2048 nt lds
v_exp_f32 v30, v30
v_exp_f32 v31, v31
v_exp_f32 v32, v32
v_exp_f32 v33, v33
v_exp_f32 v34, v34
v_exp_f32 v35, v35
v_exp_f32 v36, v36
s_waitcnt lgkmcnt(0)
v_exp_f32 v37, v37
v_mfma_f32_16x16x32_bf16 v[128:131], a[64:67], v[48:51], v[128:131]
ds_read_b128 a[0:3], v84 offset:32768
v_cvt_pk_bf16_f32 v55, v30, v31
v_mfma_f32_16x16x32_bf16 v[132:135], a[68:71], v[48:51], v[132:135]
ds_read_b128 a[4:7], v85 offset:32768
v_cvt_pk_bf16_f32 v56, v32, v33
v_mfma_f32_16x16x32_bf16 v[136:139], a[72:75], v[48:51], v[136:139]
ds_read_b128 a[8:11], v86 offset:32768
buffer_load_dwordx4 v233, s[12:15], s92 offen offset:3072 nt lds
v_cvt_pk_bf16_f32 v57, v34, v35
v_mfma_f32_16x16x32_bf16 v[140:143], a[76:79], v[48:51], v[140:143]
ds_read_b128 a[12:15], v87 offset:32768
v_cvt_pk_bf16_f32 v58, v36, v37
v_mfma_f32_16x16x32_bf16 v[144:147], a[80:83], v[48:51], v[144:147]
ds_read_b128 a[16:19], v84 offset:36864
s_mov_b32 m0, 12288
s_add_u32 s92, s34, 12288
v_mfma_f32_16x16x32_bf16 v[148:151], a[84:87], v[48:51], v[148:151]
ds_read_b128 a[20:23], v85 offset:36864
buffer_load_dwordx4 v234, s[12:15], s92 offen offset:0 nt lds
v_mfma_f32_16x16x32_bf16 v[152:155], a[88:91], v[48:51], v[152:155]
ds_read_b128 a[24:27], v86 offset:36864
v_mfma_f32_16x16x32_bf16 v[156:159], a[92:95], v[48:51], v[156:159]
ds_read_b128 a[28:31], v87 offset:36864
v_mfma_f32_16x16x32_bf16 v[108:111], v[124:127], v[48:51], v[108:111]
buffer_load_dwordx4 v235, s[12:15], s92 offen offset:1024 nt lds
v_exp_f32 v38, v38
v_mfma_f32_16x16x32_bf16 v[160:163], a[64:67], v[52:55], v[160:163]
v_exp_f32 v39, v39
v_mfma_f32_16x16x32_bf16 v[164:167], a[68:71], v[52:55], v[164:167]
v_mfma_f32_16x16x32_bf16 v[168:171], a[72:75], v[52:55], v[168:171]
buffer_load_dwordx4 v232, s[12:15], s92 offen offset:2048 nt lds
v_mfma_f32_16x16x32_bf16 v[172:175], a[76:79], v[52:55], v[172:175]
v_mfma_f32_16x16x32_bf16 v[176:179], a[80:83], v[52:55], v[176:179]
v_mfma_f32_16x16x32_bf16 v[180:183], a[84:87], v[52:55], v[180:183]
buffer_load_dwordx4 v233, s[12:15], s92 offen offset:3072 nt lds
v_mfma_f32_16x16x32_bf16 v[184:187], a[88:91], v[52:55], v[184:187]
v_mfma_f32_16x16x32_bf16 v[188:191], a[92:95], v[52:55], v[188:191]
v_mfma_f32_16x16x32_bf16 v[112:115], v[124:127], v[52:55], v[112:115]
s_waitcnt lgkmcnt(0)
v_mfma_f32_16x16x32_bf16 v[16:19], a[0:3], a[32:35], v[64:67]
s_waitcnt vmcnt(36)
v_cvt_pk_bf16_f32 v59, v38, v39
v_mfma_f32_16x16x32_bf16 v[16:19], a[4:7], a[36:39], v[16:19]
s_mov_b32 m0, 65536
v_mfma_f32_16x16x32_bf16 v[16:19], a[8:11], a[40:43], v[16:19]
buffer_load_dwordx4 v236, s[16:19], s34 offen offset:0 nt lds
v_mfma_f32_16x16x32_bf16 v[16:19], a[12:15], a[44:47], v[16:19]
v_mfma_f32_16x16x32_bf16 v[20:23], a[16:19], a[32:35], v[64:67]
v_mfma_f32_16x16x32_bf16 v[20:23], a[20:23], a[36:39], v[20:23]
buffer_load_dwordx4 v237, s[16:19], s34 offen offset:1024 nt lds
v_mfma_f32_16x16x32_bf16 v[20:23], a[24:27], a[40:43], v[20:23]
v_mfma_f32_16x16x32_bf16 v[20:23], a[28:31], a[44:47], v[20:23]
v_mfma_f32_16x16x32_bf16 v[24:27], a[0:3], a[48:51], v[68:71]
buffer_load_dwordx4 v236, s[16:19], s34 offen offset:2048 nt lds
v_mfma_f32_16x16x32_bf16 v[24:27], a[4:7], a[52:55], v[24:27]
v_exp_f32 v16, v16
v_mfma_f32_16x16x32_bf16 v[24:27], a[8:11], a[56:59], v[24:27]
v_exp_f32 v17, v17
v_mfma_f32_16x16x32_bf16 v[24:27], a[12:15], a[60:63], v[24:27]
buffer_load_dwordx4 v237, s[16:19], s34 offen offset:3072 nt lds
v_cvt_pk_bf16_f32 v48, v16, v17
v_mfma_f32_16x16x32_bf16 v[28:31], a[16:19], a[48:51], v[68:71]
v_exp_f32 v18, v18
v_mfma_f32_16x16x32_bf16 v[28:31], a[20:23], a[52:55], v[28:31]
s_mov_b32 m0, 69632
s_add_u32 s92, s34, 4096
v_exp_f32 v19, v19
v_mfma_f32_16x16x32_bf16 v[28:31], a[24:27], a[56:59], v[28:31]
buffer_load_dwordx4 v236, s[16:19], s92 offen offset:0 nt lds
v_exp_f32 v20, v20
v_mfma_f32_16x16x32_bf16 v[28:31], a[28:31], a[60:63], v[28:31]
v_exp_f32 v21, v21
v_mfma_f32_16x16x32_bf16 v[192:195], a[64:67], v[56:59], v[192:195]
v_exp_f32 v22, v22
v_mfma_f32_16x16x32_bf16 v[196:199], a[68:71], v[56:59], v[196:199]
buffer_load_dwordx4 v237, s[16:19], s92 offen offset:1024 nt lds
v_cvt_pk_bf16_f32 v49, v18, v19
v_mfma_f32_16x16x32_bf16 v[200:203], a[72:75], v[56:59], v[200:203]
v_exp_f32 v23, v23
v_mfma_f32_16x16x32_bf16 v[204:207], a[76:79], v[56:59], v[204:207]
v_exp_f32 v24, v24
v_mfma_f32_16x16x32_bf16 v[208:211], a[80:83], v[56:59], v[208:211]
buffer_load_dwordx4 v236, s[16:19], s92 offen offset:2048 nt lds
v_exp_f32 v25, v25
v_mfma_f32_16x16x32_bf16 v[212:215], a[84:87], v[56:59], v[212:215]
v_exp_f32 v26, v26
v_mfma_f32_16x16x32_bf16 v[216:219], a[88:91], v[56:59], v[216:219]
v_exp_f32 v27, v27
v_mfma_f32_16x16x32_bf16 v[220:223], a[92:95], v[56:59], v[220:223]
buffer_load_dwordx4 v237, s[16:19], s92 offen offset:3072 nt lds
v_cvt_pk_bf16_f32 v50, v20, v21
v_mfma_f32_16x16x32_bf16 v[116:119], v[124:127], v[56:59], v[116:119]
v_exp_f32 v28, v28
v_exp_f32 v29, v29
ds_read_b64_tr_b16 a[64:65], v88 offset:32768
v_cvt_pk_bf16_f32 v51, v22, v23
ds_read_b64_tr_b16 a[66:67], v88 offset:36864
v_cvt_pk_bf16_f32 v52, v24, v25
ds_read_b64_tr_b16 a[68:69], v89 offset:32768
v_cvt_pk_bf16_f32 v53, v26, v27
ds_read_b64_tr_b16 a[70:71], v89 offset:36864
v_cvt_pk_bf16_f32 v54, v28, v29
ds_read_b64_tr_b16 a[72:73], v90 offset:32768
ds_read_b64_tr_b16 a[74:75], v90 offset:36864
ds_read_b64_tr_b16 a[76:77], v91 offset:32768
ds_read_b64_tr_b16 a[78:79], v91 offset:36864
v_mfma_f32_16x16x32_bf16 v[32:35], a[0:3], a[96:99], v[72:75]
ds_read_b64_tr_b16 a[80:81], v92 offset:32768
s_mov_b32 m0, 73728
s_add_u32 s92, s34, 8192
v_mfma_f32_16x16x32_bf16 v[32:35], a[4:7], a[100:103], v[32:35]
ds_read_b64_tr_b16 a[82:83], v92 offset:36864
buffer_load_dwordx4 v236, s[16:19], s92 offen offset:0 nt lds
v_mfma_f32_16x16x32_bf16 v[32:35], a[8:11], a[104:107], v[32:35]
ds_read_b64_tr_b16 a[84:85], v93 offset:32768
v_mfma_f32_16x16x32_bf16 v[32:35], a[12:15], a[108:111], v[32:35]
ds_read_b64_tr_b16 a[86:87], v93 offset:36864
v_mfma_f32_16x16x32_bf16 v[36:39], a[16:19], a[96:99], v[72:75]
ds_read_b64_tr_b16 a[88:89], v94 offset:32768
buffer_load_dwordx4 v237, s[16:19], s92 offen offset:1024 nt lds
v_mfma_f32_16x16x32_bf16 v[36:39], a[20:23], a[100:103], v[36:39]
ds_read_b64_tr_b16 a[90:91], v94 offset:36864
v_mfma_f32_16x16x32_bf16 v[36:39], a[24:27], a[104:107], v[36:39]
ds_read_b64_tr_b16 a[92:93], v95 offset:32768
v_mfma_f32_16x16x32_bf16 v[36:39], a[28:31], a[108:111], v[36:39]
ds_read_b64_tr_b16 a[94:95], v95 offset:36864
buffer_load_dwordx4 v236, s[16:19], s92 offen offset:2048 nt lds
v_exp_f32 v30, v30
v_exp_f32 v31, v31
v_exp_f32 v32, v32
v_exp_f32 v33, v33
v_exp_f32 v34, v34
v_exp_f32 v35, v35
v_exp_f32 v36, v36
s_waitcnt lgkmcnt(0)
v_exp_f32 v37, v37
v_mfma_f32_16x16x32_bf16 v[128:131], a[64:67], v[48:51], v[128:131]
ds_read_b128 a[0:3], v84 offset:40960
v_cvt_pk_bf16_f32 v55, v30, v31
v_mfma_f32_16x16x32_bf16 v[132:135], a[68:71], v[48:51], v[132:135]
ds_read_b128 a[4:7], v85 offset:40960
v_cvt_pk_bf16_f32 v56, v32, v33
v_mfma_f32_16x16x32_bf16 v[136:139], a[72:75], v[48:51], v[136:139]
ds_read_b128 a[8:11], v86 offset:40960
buffer_load_dwordx4 v237, s[16:19], s92 offen offset:3072 nt lds
v_cvt_pk_bf16_f32 v57, v34, v35
v_mfma_f32_16x16x32_bf16 v[140:143], a[76:79], v[48:51], v[140:143]
ds_read_b128 a[12:15], v87 offset:40960
v_cvt_pk_bf16_f32 v58, v36, v37
v_mfma_f32_16x16x32_bf16 v[144:147], a[80:83], v[48:51], v[144:147]
ds_read_b128 a[16:19], v84 offset:45056
s_mov_b32 m0, 77824
s_add_u32 s92, s34, 12288
v_mfma_f32_16x16x32_bf16 v[148:151], a[84:87], v[48:51], v[148:151]
ds_read_b128 a[20:23], v85 offset:45056
buffer_load_dwordx4 v236, s[16:19], s92 offen offset:0 nt lds
v_mfma_f32_16x16x32_bf16 v[152:155], a[88:91], v[48:51], v[152:155]
ds_read_b128 a[24:27], v86 offset:45056
v_mfma_f32_16x16x32_bf16 v[156:159], a[92:95], v[48:51], v[156:159]
ds_read_b128 a[28:31], v87 offset:45056
v_mfma_f32_16x16x32_bf16 v[108:111], v[124:127], v[48:51], v[108:111]
buffer_load_dwordx4 v237, s[16:19], s92 offen offset:1024 nt lds
v_exp_f32 v38, v38
v_mfma_f32_16x16x32_bf16 v[160:163], a[64:67], v[52:55], v[160:163]
v_exp_f32 v39, v39
v_mfma_f32_16x16x32_bf16 v[164:167], a[68:71], v[52:55], v[164:167]
v_mfma_f32_16x16x32_bf16 v[168:171], a[72:75], v[52:55], v[168:171]
buffer_load_dwordx4 v236, s[16:19], s92 offen offset:2048 nt lds
v_mfma_f32_16x16x32_bf16 v[172:175], a[76:79], v[52:55], v[172:175]
v_mfma_f32_16x16x32_bf16 v[176:179], a[80:83], v[52:55], v[176:179]
s_add_u32 s34, s34, 16384
v_mfma_f32_16x16x32_bf16 v[180:183], a[84:87], v[52:55], v[180:183]
buffer_load_dwordx4 v237, s[16:19], s92 offen offset:3072 nt lds
v_mfma_f32_16x16x32_bf16 v[184:187], a[88:91], v[52:55], v[184:187]
v_mfma_f32_16x16x32_bf16 v[188:191], a[92:95], v[52:55], v[188:191]
v_mfma_f32_16x16x32_bf16 v[112:115], v[124:127], v[52:55], v[112:115]
s_waitcnt lgkmcnt(0)
v_mfma_f32_16x16x32_bf16 v[16:19], a[0:3], a[32:35], v[64:67]
v_cvt_pk_bf16_f32 v59, v38, v39
v_mfma_f32_16x16x32_bf16 v[16:19], a[4:7], a[36:39], v[16:19]
s_mov_b32 m0, 16384
v_mfma_f32_16x16x32_bf16 v[16:19], a[8:11], a[40:43], v[16:19]
buffer_load_dwordx4 v234, s[12:15], s34 offen offset:0 nt lds
v_mfma_f32_16x16x32_bf16 v[16:19], a[12:15], a[44:47], v[16:19]
v_mfma_f32_16x16x32_bf16 v[20:23], a[16:19], a[32:35], v[64:67]
v_mfma_f32_16x16x32_bf16 v[20:23], a[20:23], a[36:39], v[20:23]
s_add_u32 s39, s39, 1
buffer_load_dwordx4 v235, s[12:15], s34 offen offset:1024 nt lds
v_mfma_f32_16x16x32_bf16 v[20:23], a[24:27], a[40:43], v[20:23]
v_mov_b32 v80, s39
v_mfma_f32_16x16x32_bf16 v[20:23], a[28:31], a[44:47], v[20:23]
v_mfma_f32_16x16x32_bf16 v[24:27], a[0:3], a[48:51], v[68:71]
s_waitcnt vmcnt(34)
ds_write_b32 v1, v80
buffer_load_dwordx4 v232, s[12:15], s34 offen offset:2048 nt lds
v_mfma_f32_16x16x32_bf16 v[24:27], a[4:7], a[52:55], v[24:27]
v_exp_f32 v16, v16
v_mfma_f32_16x16x32_bf16 v[24:27], a[8:11], a[56:59], v[24:27]
v_exp_f32 v17, v17
v_mfma_f32_16x16x32_bf16 v[24:27], a[12:15], a[60:63], v[24:27]
buffer_load_dwordx4 v233, s[12:15], s34 offen offset:3072 nt lds
v_cvt_pk_bf16_f32 v48, v16, v17
v_mfma_f32_16x16x32_bf16 v[28:31], a[16:19], a[48:51], v[68:71]
v_exp_f32 v18, v18
v_mfma_f32_16x16x32_bf16 v[28:31], a[20:23], a[52:55], v[28:31]
s_mov_b32 m0, 20480
s_add_u32 s92, s34, 4096
v_exp_f32 v19, v19
v_mfma_f32_16x16x32_bf16 v[28:31], a[24:27], a[56:59], v[28:31]
buffer_load_dwordx4 v234, s[12:15], s92 offen offset:0 nt lds
v_exp_f32 v20, v20
v_mfma_f32_16x16x32_bf16 v[28:31], a[28:31], a[60:63], v[28:31]
v_exp_f32 v21, v21
v_mfma_f32_16x16x32_bf16 v[192:195], a[64:67], v[56:59], v[192:195]
v_exp_f32 v22, v22
v_mfma_f32_16x16x32_bf16 v[196:199], a[68:71], v[56:59], v[196:199]
buffer_load_dwordx4 v235, s[12:15], s92 offen offset:1024 nt lds
v_cvt_pk_bf16_f32 v49, v18, v19
v_mfma_f32_16x16x32_bf16 v[200:203], a[72:75], v[56:59], v[200:203]
v_exp_f32 v23, v23
v_mfma_f32_16x16x32_bf16 v[204:207], a[76:79], v[56:59], v[204:207]
v_exp_f32 v24, v24
v_mfma_f32_16x16x32_bf16 v[208:211], a[80:83], v[56:59], v[208:211]
buffer_load_dwordx4 v232, s[12:15], s92 offen offset:2048 nt lds
v_exp_f32 v25, v25
v_mfma_f32_16x16x32_bf16 v[212:215], a[84:87], v[56:59], v[212:215]
v_exp_f32 v26, v26
v_mfma_f32_16x16x32_bf16 v[216:219], a[88:91], v[56:59], v[216:219]
v_exp_f32 v27, v27
v_mfma_f32_16x16x32_bf16 v[220:223], a[92:95], v[56:59], v[220:223]
buffer_load_dwordx4 v233, s[12:15], s92 offen offset:3072 nt lds
v_cvt_pk_bf16_f32 v50, v20, v21
v_mfma_f32_16x16x32_bf16 v[116:119], v[124:127], v[56:59], v[116:119]
v_exp_f32 v28, v28
v_exp_f32 v29, v29
ds_read_b64_tr_b16 a[64:65], v88 offset:40960
v_cvt_pk_bf16_f32 v51, v22, v23
ds_read_b64_tr_b16 a[66:67], v88 offset:45056
v_cvt_pk_bf16_f32 v52, v24, v25
ds_read_b64_tr_b16 a[68:69], v89 offset:40960
v_cvt_pk_bf16_f32 v53, v26, v27
ds_read_b64_tr_b16 a[70:71], v89 offset:45056
v_cvt_pk_bf16_f32 v54, v28, v29
ds_read_b64_tr_b16 a[72:73], v90 offset:40960
ds_read_b64_tr_b16 a[74:75], v90 offset:45056
ds_read_b64_tr_b16 a[76:77], v91 offset:40960
ds_read_b64_tr_b16 a[78:79], v91 offset:45056
v_mfma_f32_16x16x32_bf16 v[32:35], a[0:3], a[96:99], v[72:75]
ds_read_b64_tr_b16 a[80:81], v92 offset:40960
s_mov_b32 m0, 24576
s_add_u32 s92, s34, 8192
v_mfma_f32_16x16x32_bf16 v[32:35], a[4:7], a[100:103], v[32:35]
ds_read_b64_tr_b16 a[82:83], v92 offset:45056
ds_read_b128 v[80:83], v101
buffer_load_dwordx4 v234, s[12:15], s92 offen offset:0 nt lds
v_mfma_f32_16x16x32_bf16 v[32:35], a[8:11], a[104:107], v[32:35]
ds_read_b64_tr_b16 a[84:85], v93 offset:40960
v_mfma_f32_16x16x32_bf16 v[32:35], a[12:15], a[108:111], v[32:35]
ds_read_b64_tr_b16 a[86:87], v93 offset:45056
v_mfma_f32_16x16x32_bf16 v[36:39], a[16:19], a[96:99], v[72:75]
s_waitcnt lgkmcnt(2)
ds_read_b64_tr_b16 a[88:89], v94 offset:40960
buffer_load_dwordx4 v235, s[12:15], s92 offen offset:1024 nt lds
v_min3_u32 v80, v80, v81, v82
v_mfma_f32_16x16x32_bf16 v[36:39], a[20:23], a[100:103], v[36:39]
ds_read_b64_tr_b16 a[90:91], v94 offset:45056
v_min_u32 v80, v80, v83
v_mfma_f32_16x16x32_bf16 v[36:39], a[24:27], a[104:107], v[36:39]
ds_read_b64_tr_b16 a[92:93], v95 offset:40960
v_cmp_gt_u32 vcc, s39, v80
v_mfma_f32_16x16x32_bf16 v[36:39], a[28:31], a[108:111], v[36:39]
s_cbranch_vccnz L_fs37_3
L_fr37_3:
ds_read_b64_tr_b16 a[94:95], v95 offset:45056
buffer_load_dwordx4 v232, s[12:15], s92 offen offset:2048 nt lds
v_exp_f32 v30, v30
v_exp_f32 v31, v31
v_exp_f32 v32, v32
v_exp_f32 v33, v33
v_exp_f32 v34, v34
v_exp_f32 v35, v35
v_exp_f32 v36, v36
s_waitcnt lgkmcnt(0)
v_exp_f32 v37, v37
v_mfma_f32_16x16x32_bf16 v[128:131], a[64:67], v[48:51], v[128:131]
ds_read_b128 a[0:3], v84 offset:49152
v_cvt_pk_bf16_f32 v55, v30, v31
v_mfma_f32_16x16x32_bf16 v[132:135], a[68:71], v[48:51], v[132:135]
ds_read_b128 a[4:7], v85 offset:49152
v_cvt_pk_bf16_f32 v56, v32, v33
v_mfma_f32_16x16x32_bf16 v[136:139], a[72:75], v[48:51], v[136:139]
ds_read_b128 a[8:11], v86 offset:49152
buffer_load_dwordx4 v233, s[12:15], s92 offen offset:3072 nt lds
v_cvt_pk_bf16_f32 v57, v34, v35
v_mfma_f32_16x16x32_bf16 v[140:143], a[76:79], v[48:51], v[140:143]
ds_read_b128 a[12:15], v87 offset:49152
v_cvt_pk_bf16_f32 v58, v36, v37
v_mfma_f32_16x16x32_bf16 v[144:147], a[80:83], v[48:51], v[144:147]
ds_read_b128 a[16:19], v84 offset:53248
s_mov_b32 m0, 28672
s_add_u32 s92, s34, 12288
v_mfma_f32_16x16x32_bf16 v[148:151], a[84:87], v[48:51], v[148:151]
ds_read_b128 a[20:23], v85 offset:53248
buffer_load_dwordx4 v234, s[12:15], s92 offen offset:0 nt lds
v_mfma_f32_16x16x32_bf16 v[152:155], a[88:91], v[48:51], v[152:155]
ds_read_b128 a[24:27], v86 offset:53248
v_mfma_f32_16x16x32_bf16 v[156:159], a[92:95], v[48:51], v[156:159]
ds_read_b128 a[28:31], v87 offset:53248
v_mfma_f32_16x16x32_bf16 v[108:111], v[124:127], v[48:51], v[108:111]
buffer_load_dwordx4 v235, s[12:15], s92 offen offset:1024 nt lds
v_exp_f32 v38, v38
v_mfma_f32_16x16x32_bf16 v[160:163], a[64:67], v[52:55], v[160:163]
v_exp_f32 v39, v39
v_mfma_f32_16x16x32_bf16 v[164:167], a[68:71], v[52:55], v[164:167]
v_mfma_f32_16x16x32_bf16 v[168:171], a[72:75], v[52:55], v[168:171]
buffer_load_dwordx4 v232, s[12:15], s92 offen offset:2048 nt lds
v_mfma_f32_16x16x32_bf16 v[172:175], a[76:79], v[52:55], v[172:175]
v_mfma_f32_16x16x32_bf16 v[176:179], a[80:83], v[52:55], v[176:179]
v_mfma_f32_16x16x32_bf16 v[180:183], a[84:87], v[52:55], v[180:183]
buffer_load_dwordx4 v233, s[12:15], s92 offen offset:3072 nt lds
v_mfma_f32_16x16x32_bf16 v[184:187], a[88:91], v[52:55], v[184:187]
v_mfma_f32_16x16x32_bf16 v[188:191], a[92:95], v[52:55], v[188:191]
v_mfma_f32_16x16x32_bf16 v[112:115], v[124:127], v[52:55], v[112:115]
s_waitcnt lgkmcnt(0)
v_mfma_f32_16x16x32_bf16 v[16:19], a[0:3], a[32:35], v[64:67]
s_waitcnt vmcnt(36)
v_cvt_pk_bf16_f32 v59, v38, v39
v_mfma_f32_16x16x32_bf16 v[16:19], a[4:7], a[36:39], v[16:19]
s_mov_b32 m0, 81920
v_mfma_f32_16x16x32_bf16 v[16:19], a[8:11], a[40:43], v[16:19]
buffer_load_dwordx4 v236, s[16:19], s34 offen offset:0 nt lds
v_mfma_f32_16x16x32_bf16 v[16:19], a[12:15], a[44:47], v[16:19]
v_mfma_f32_16x16x32_bf16 v[20:23], a[16:19], a[32:35], v[64:67]
v_mfma_f32_16x16x32_bf16 v[20:23], a[20:23], a[36:39], v[20:23]
buffer_load_dwordx4 v237, s[16:19], s34 offen offset:1024 nt lds
v_mfma_f32_16x16x32_bf16 v[20:23], a[24:27], a[40:43], v[20:23]
v_mfma_f32_16x16x32_bf16 v[20:23], a[28:31], a[44:47], v[20:23]
v_mfma_f32_16x16x32_bf16 v[24:27], a[0:3], a[48:51], v[68:71]
buffer_load_dwordx4 v236, s[16:19], s34 offen offset:2048 nt lds
v_mfma_f32_16x16x32_bf16 v[24:27], a[4:7], a[52:55], v[24:27]
v_exp_f32 v16, v16
v_mfma_f32_16x16x32_bf16 v[24:27], a[8:11], a[56:59], v[24:27]
v_exp_f32 v17, v17
v_mfma_f32_16x16x32_bf16 v[24:27], a[12:15], a[60:63], v[24:27]
buffer_load_dwordx4 v237, s[16:19], s34 offen offset:3072 nt lds
v_cvt_pk_bf16_f32 v48, v16, v17
v_mfma_f32_16x16x32_bf16 v[28:31], a[16:19], a[48:51], v[68:71]
v_exp_f32 v18, v18
v_mfma_f32_16x16x32_bf16 v[28:31], a[20:23], a[52:55], v[28:31]
s_mov_b32 m0, 86016
s_add_u32 s92, s34, 4096
v_exp_f32 v19, v19
v_mfma_f32_16x16x32_bf16 v[28:31], a[24:27], a[56:59], v[28:31]
buffer_load_dwordx4 v236, s[16:19], s92 offen offset:0 nt lds
v_exp_f32 v20, v20
v_mfma_f32_16x16x32_bf16 v[28:31], a[28:31], a[60:63], v[28:31]
v_exp_f32 v21, v21
v_mfma_f32_16x16x32_bf16 v[192:195], a[64:67], v[56:59], v[192:195]
v_exp_f32 v22, v22
v_mfma_f32_16x16x32_bf16 v[196:199], a[68:71], v[56:59], v[196:199]
buffer_load_dwordx4 v237, s[16:19], s92 offen offset:1024 nt lds
v_cvt_pk_bf16_f32 v49, v18, v19
v_mfma_f32_16x16x32_bf16 v[200:203], a[72:75], v[56:59], v[200:203]
v_exp_f32 v23, v23
v_mfma_f32_16x16x32_bf16 v[204:207], a[76:79], v[56:59], v[204:207]
v_exp_f32 v24, v24
v_mfma_f32_16x16x32_bf16 v[208:211], a[80:83], v[56:59], v[208:211]
buffer_load_dwordx4 v236, s[16:19], s92 offen offset:2048 nt lds
v_exp_f32 v25, v25
v_mfma_f32_16x16x32_bf16 v[212:215], a[84:87], v[56:59], v[212:215]
v_exp_f32 v26, v26
v_mfma_f32_16x16x32_bf16 v[216:219], a[88:91], v[56:59], v[216:219]
v_exp_f32 v27, v27
v_mfma_f32_16x16x32_bf16 v[220:223], a[92:95], v[56:59], v[220:223]
buffer_load_dwordx4 v237, s[16:19], s92 offen offset:3072 nt lds
v_cvt_pk_bf16_f32 v50, v20, v21
v_mfma_f32_16x16x32_bf16 v[116:119], v[124:127], v[56:59], v[116:119]
v_exp_f32 v28, v28
v_exp_f32 v29, v29
ds_read_b64_tr_b16 a[64:65], v88 offset:49152
v_cvt_pk_bf16_f32 v51, v22, v23
ds_read_b64_tr_b16 a[66:67], v88 offset:53248
v_cvt_pk_bf16_f32 v52, v24, v25
ds_read_b64_tr_b16 a[68:69], v89 offset:49152
v_cvt_pk_bf16_f32 v53, v26, v27
ds_read_b64_tr_b16 a[70:71], v89 offset:53248
v_cvt_pk_bf16_f32 v54, v28, v29
ds_read_b64_tr_b16 a[72:73], v90 offset:49152
ds_read_b64_tr_b16 a[74:75], v90 offset:53248
ds_read_b64_tr_b16 a[76:77], v91 offset:49152
ds_read_b64_tr_b16 a[78:79], v91 offset:53248
v_mfma_f32_16x16x32_bf16 v[32:35], a[0:3], a[96:99], v[72:75]
ds_read_b64_tr_b16 a[80:81], v92 offset:49152
s_mov_b32 m0, 90112
s_add_u32 s92, s34, 8192
v_mfma_f32_16x16x32_bf16 v[32:35], a[4:7], a[100:103], v[32:35]
ds_read_b64_tr_b16 a[82:83], v92 offset:53248
buffer_load_dwordx4 v236, s[16:19], s92 offen offset:0 nt lds
v_mfma_f32_16x16x32_bf16 v[32:35], a[8:11], a[104:107], v[32:35]
ds_read_b64_tr_b16 a[84:85], v93 offset:49152
v_mfma_f32_16x16x32_bf16 v[32:35], a[12:15], a[108:111], v[32:35]
ds_read_b64_tr_b16 a[86:87], v93 offset:53248
v_mfma_f32_16x16x32_bf16 v[36:39], a[16:19], a[96:99], v[72:75]
ds_read_b64_tr_b16 a[88:89], v94 offset:49152
buffer_load_dwordx4 v237, s[16:19], s92 offen offset:1024 nt lds
v_mfma_f32_16x16x32_bf16 v[36:39], a[20:23], a[100:103], v[36:39]
ds_read_b64_tr_b16 a[90:91], v94 offset:53248
v_mfma_f32_16x16x32_bf16 v[36:39], a[24:27], a[104:107], v[36:39]
ds_read_b64_tr_b16 a[92:93], v95 offset:49152
v_mfma_f32_16x16x32_bf16 v[36:39], a[28:31], a[108:111], v[36:39]
ds_read_b64_tr_b16 a[94:95], v95 offset:53248
buffer_load_dwordx4 v236, s[16:19], s92 offen offset:2048 nt lds
v_exp_f32 v30, v30
v_exp_f32 v31, v31
v_exp_f32 v32, v32
v_exp_f32 v33, v33
v_exp_f32 v34, v34
v_exp_f32 v35, v35
v_exp_f32 v36, v36
s_waitcnt lgkmcnt(0)
v_exp_f32 v37, v37
v_mfma_f32_16x16x32_bf16 v[128:131], a[64:67], v[48:51], v[128:131]
ds_read_b128 a[0:3], v84 offset:57344
v_cvt_pk_bf16_f32 v55, v30, v31
v_mfma_f32_16x16x32_bf16 v[132:135], a[68:71], v[48:51], v[132:135]
ds_read_b128 a[4:7], v85 offset:57344
v_cvt_pk_bf16_f32 v56, v32, v33
v_mfma_f32_16x16x32_bf16 v[136:139], a[72:75], v[48:51], v[136:139]
ds_read_b128 a[8:11], v86 offset:57344
buffer_load_dwordx4 v237, s[16:19], s92 offen offset:3072 nt lds
v_cvt_pk_bf16_f32 v57, v34, v35
v_mfma_f32_16x16x32_bf16 v[140:143], a[76:79], v[48:51], v[140:143]
ds_read_b128 a[12:15], v87 offset:57344
v_cvt_pk_bf16_f32 v58, v36, v37
v_mfma_f32_16x16x32_bf16 v[144:147], a[80:83], v[48:51], v[144:147]
ds_read_b128 a[16:19], v84 offset:61440
s_mov_b32 m0, 94208
s_add_u32 s92, s34, 12288
v_mfma_f32_16x16x32_bf16 v[148:151], a[84:87], v[48:51], v[148:151]
ds_read_b128 a[20:23], v85 offset:61440
buffer_load_dwordx4 v236, s[16:19], s92 offen offset:0 nt lds
v_mfma_f32_16x16x32_bf16 v[152:155], a[88:91], v[48:51], v[152:155]
ds_read_b128 a[24:27], v86 offset:61440
v_mfma_f32_16x16x32_bf16 v[156:159], a[92:95], v[48:51], v[156:159]
ds_read_b128 a[28:31], v87 offset:61440
v_mfma_f32_16x16x32_bf16 v[108:111], v[124:127], v[48:51], v[108:111]
buffer_load_dwordx4 v237, s[16:19], s92 offen offset:1024 nt lds
v_exp_f32 v38, v38
v_mfma_f32_16x16x32_bf16 v[160:163], a[64:67], v[52:55], v[160:163]
v_exp_f32 v39, v39
v_mfma_f32_16x16x32_bf16 v[164:167], a[68:71], v[52:55], v[164:167]
v_mfma_f32_16x16x32_bf16 v[168:171], a[72:75], v[52:55], v[168:171]
buffer_load_dwordx4 v236, s[16:19], s92 offen offset:2048 nt lds
v_mfma_f32_16x16x32_bf16 v[172:175], a[76:79], v[52:55], v[172:175]
v_mfma_f32_16x16x32_bf16 v[176:179], a[80:83], v[52:55], v[176:179]
s_add_u32 s34, s34, 16384
v_mfma_f32_16x16x32_bf16 v[180:183], a[84:87], v[52:55], v[180:183]
buffer_load_dwordx4 v237, s[16:19], s92 offen offset:3072 nt lds
v_mfma_f32_16x16x32_bf16 v[184:187], a[88:91], v[52:55], v[184:187]
v_mfma_f32_16x16x32_bf16 v[188:191], a[92:95], v[52:55], v[188:191]
v_mfma_f32_16x16x32_bf16 v[112:115], v[124:127], v[52:55], v[112:115]
s_waitcnt lgkmcnt(0)
v_mfma_f32_16x16x32_bf16 v[16:19], a[0:3], a[32:35], v[64:67]
v_cvt_pk_bf16_f32 v59, v38, v39
v_mfma_f32_16x16x32_bf16 v[16:19], a[4:7], a[36:39], v[16:19]
s_mov_b32 m0, 32768
v_mfma_f32_16x16x32_bf16 v[16:19], a[8:11], a[40:43], v[16:19]
buffer_load_dwordx4 v234, s[12:15], s34 offen offset:0 nt lds
v_mfma_f32_16x16x32_bf16 v[16:19], a[12:15], a[44:47], v[16:19]
v_mfma_f32_16x16x32_bf16 v[20:23], a[16:19], a[32:35], v[64:67]
v_mfma_f32_16x16x32_bf16 v[20:23], a[20:23], a[36:39], v[20:23]
s_add_u32 s39, s39, 1
buffer_load_dwordx4 v235, s[12:15], s34 offen offset:1024 nt lds
v_mfma_f32_16x16x32_bf16 v[20:23], a[24:27], a[40:43], v[20:23]
v_mov_b32 v80, s39
v_mfma_f32_16x16x32_bf16 v[20:23], a[28:31], a[44:47], v[20:23]
v_mfma_f32_16x16x32_bf16 v[24:27], a[0:3], a[48:51], v[68:71]
s_waitcnt vmcnt(34)
ds_write_b32 v1, v80
buffer_load_dwordx4 v232, s[12:15], s34 offen offset:2048 nt lds
v_mfma_f32_16x16x32_bf16 v[24:27], a[4:7], a[52:55], v[24:27]
v_exp_f32 v16, v16
v_mfma_f32_16x16x32_bf16 v[24:27], a[8:11], a[56:59], v[24:27]
v_exp_f32 v17, v17
v_mfma_f32_16x16x32_bf16 v[24:27], a[12:15], a[60:63], v[24:27]
buffer_load_dwordx4 v233, s[12:15], s34 offen offset:3072 nt lds
v_cvt_pk_bf16_f32 v48, v16, v17
v_mfma_f32_16x16x32_bf16 v[28:31], a[16:19], a[48:51], v[68:71]
v_exp_f32 v18, v18
v_mfma_f32_16x16x32_bf16 v[28:31], a[20:23], a[52:55], v[28:31]
s_mov_b32 m0, 36864
s_add_u32 s92, s34, 4096
v_exp_f32 v19, v19
v_mfma_f32_16x16x32_bf16 v[28:31], a[24:27], a[56:59], v[28:31]
buffer_load_dwordx4 v234, s[12:15], s92 offen offset:0 nt lds
v_exp_f32 v20, v20
v_mfma_f32_16x16x32_bf16 v[28:31], a[28:31], a[60:63], v[28:31]
v_exp_f32 v21, v21
v_mfma_f32_16x16x32_bf16 v[192:195], a[64:67], v[56:59], v[192:195]
v_exp_f32 v22, v22
v_mfma_f32_16x16x32_bf16 v[196:199], a[68:71], v[56:59], v[196:199]
buffer_load_dwordx4 v235, s[12:15], s92 offen offset:1024 nt lds
v_cvt_pk_bf16_f32 v49, v18, v19
v_mfma_f32_16x16x32_bf16 v[200:203], a[72:75], v[56:59], v[200:203]
v_exp_f32 v23, v23
v_mfma_f32_16x16x32_bf16 v[204:207], a[76:79], v[56:59], v[204:207]
v_exp_f32 v24, v24
v_mfma_f32_16x16x32_bf16 v[208:211], a[80:83], v[56:59], v[208:211]
buffer_load_dwordx4 v232, s[12:15], s92 offen offset:2048 nt lds
v_exp_f32 v25, v25
v_mfma_f32_16x16x32_bf16 v[212:215], a[84:87], v[56:59], v[212:215]
v_exp_f32 v26, v26
v_mfma_f32_16x16x32_bf16 v[216:219], a[88:91], v[56:59], v[216:219]
v_exp_f32 v27, v27
v_mfma_f32_16x16x32_bf16 v[220:223], a[92:95], v[56:59], v[220:223]
buffer_load_dwordx4 v233, s[12:15], s92 offen offset:3072 nt lds
v_cvt_pk_bf16_f32 v50, v20, v21
v_mfma_f32_16x16x32_bf16 v[116:119], v[124:127], v[56:59], v[116:119]
v_exp_f32 v28, v28
v_exp_f32 v29, v29
ds_read_b64_tr_b16 a[64:65], v88 offset:57344
v_cvt_pk_bf16_f32 v51, v22, v23
ds_read_b64_tr_b16 a[66:67], v88 offset:61440
v_cvt_pk_bf16_f32 v52, v24, v25
ds_read_b64_tr_b16 a[68:69], v89 offset:57344
v_cvt_pk_bf16_f32 v53, v26, v27
ds_read_b64_tr_b16 a[70:71], v89 offset:61440
v_cvt_pk_bf16_f32 v54, v28, v29
ds_read_b64_tr_b16 a[72:73], v90 offset:57344
ds_read_b64_tr_b16 a[74:75], v90 offset:61440
ds_read_b64_tr_b16 a[76:77], v91 offset:57344
ds_read_b64_tr_b16 a[78:79], v91 offset:61440
v_mfma_f32_16x16x32_bf16 v[32:35], a[0:3], a[96:99], v[72:75]
ds_read_b64_tr_b16 a[80:81], v92 offset:57344
s_mov_b32 m0, 40960
s_add_u32 s92, s34, 8192
v_mfma_f32_16x16x32_bf16 v[32:35], a[4:7], a[100:103], v[32:35]
ds_read_b64_tr_b16 a[82:83], v92 offset:61440
ds_read_b128 v[80:83], v101
buffer_load_dwordx4 v234, s[12:15], s92 offen offset:0 nt lds
v_mfma_f32_16x16x32_bf16 v[32:35], a[8:11], a[104:107], v[32:35]
ds_read_b64_tr_b16 a[84:85], v93 offset:57344
v_mfma_f32_16x16x32_bf16 v[32:35], a[12:15], a[108:111], v[32:35]
ds_read_b64_tr_b16 a[86:87], v93 offset:61440
v_mfma_f32_16x16x32_bf16 v[36:39], a[16:19], a[96:99], v[72:75]
s_waitcnt lgkmcnt(2)
ds_read_b64_tr_b16 a[88:89], v94 offset:57344
buffer_load_dwordx4 v235, s[12:15], s92 offen offset:1024 nt lds
v_min3_u32 v80, v80, v81, v82
v_mfma_f32_16x16x32_bf16 v[36:39], a[20:23], a[100:103], v[36:39]
ds_read_b64_tr_b16 a[90:91], v94 offset:61440
v_min_u32 v80, v80, v83
v_mfma_f32_16x16x32_bf16 v[36:39], a[24:27], a[104:107], v[36:39]
ds_read_b64_tr_b16 a[92:93], v95 offset:57344
v_cmp_gt_u32 vcc, s39, v80
v_mfma_f32_16x16x32_bf16 v[36:39], a[28:31], a[108:111], v[36:39]
s_cbranch_vccnz L_fs39_3
L_fr39_3:
ds_read_b64_tr_b16 a[94:95], v95 offset:61440
buffer_load_dwordx4 v232, s[12:15], s92 offen offset:2048 nt lds
v_exp_f32 v30, v30
v_exp_f32 v31, v31
v_exp_f32 v32, v32
v_exp_f32 v33, v33
v_exp_f32 v34, v34
v_exp_f32 v35, v35
v_exp_f32 v36, v36
s_waitcnt lgkmcnt(0)
v_exp_f32 v37, v37
v_mfma_f32_16x16x32_bf16 v[128:131], a[64:67], v[48:51], v[128:131]
ds_read_b128 a[0:3], v84 offset:0
v_cvt_pk_bf16_f32 v55, v30, v31
v_mfma_f32_16x16x32_bf16 v[132:135], a[68:71], v[48:51], v[132:135]
ds_read_b128 a[4:7], v85 offset:0
v_cvt_pk_bf16_f32 v56, v32, v33
v_mfma_f32_16x16x32_bf16 v[136:139], a[72:75], v[48:51], v[136:139]
ds_read_b128 a[8:11], v86 offset:0
buffer_load_dwordx4 v233, s[12:15], s92 offen offset:3072 nt lds
v_cvt_pk_bf16_f32 v57, v34, v35
v_mfma_f32_16x16x32_bf16 v[140:143], a[76:79], v[48:51], v[140:143]
ds_read_b128 a[12:15], v87 offset:0
v_cvt_pk_bf16_f32 v58, v36, v37
v_mfma_f32_16x16x32_bf16 v[144:147], a[80:83], v[48:51], v[144:147]
ds_read_b128 a[16:19], v84 offset:4096
s_mov_b32 m0, 45056
s_add_u32 s92, s34, 12288
v_mfma_f32_16x16x32_bf16 v[148:151], a[84:87], v[48:51], v[148:151]
ds_read_b128 a[20:23], v85 offset:4096
buffer_load_dwordx4 v234, s[12:15], s92 offen offset:0 nt lds
v_mfma_f32_16x16x32_bf16 v[152:155], a[88:91], v[48:51], v[152:155]
ds_read_b128 a[24:27], v86 offset:4096
v_mfma_f32_16x16x32_bf16 v[156:159], a[92:95], v[48:51], v[156:159]
ds_read_b128 a[28:31], v87 offset:4096
v_mfma_f32_16x16x32_bf16 v[108:111], v[124:127], v[48:51], v[108:111]
buffer_load_dwordx4 v235, s[12:15], s92 offen offset:1024 nt lds
v_exp_f32 v38, v38
v_mfma_f32_16x16x32_bf16 v[160:163], a[64:67], v[52:55], v[160:163]
v_exp_f32 v39, v39
v_mfma_f32_16x16x32_bf16 v[164:167], a[68:71], v[52:55], v[164:167]
v_mfma_f32_16x16x32_bf16 v[168:171], a[72:75], v[52:55], v[168:171]
buffer_load_dwordx4 v232, s[12:15], s92 offen offset:2048 nt lds
v_mfma_f32_16x16x32_bf16 v[172:175], a[76:79], v[52:55], v[172:175]
v_mfma_f32_16x16x32_bf16 v[176:179], a[80:83], v[52:55], v[176:179]
v_mfma_f32_16x16x32_bf16 v[180:183], a[84:87], v[52:55], v[180:183]
buffer_load_dwordx4 v233, s[12:15], s92 offen offset:3072 nt lds
v_mfma_f32_16x16x32_bf16 v[184:187], a[88:91], v[52:55], v[184:187]
v_mfma_f32_16x16x32_bf16 v[188:191], a[92:95], v[52:55], v[188:191]
v_mfma_f32_16x16x32_bf16 v[112:115], v[124:127], v[52:55], v[112:115]
s_waitcnt lgkmcnt(0)
s_branch L_atin3
L_fin3:
v_mfma_f32_16x16x32_bf16 v[16:19], a[0:3], a[32:35], v[64:67]
s_waitcnt vmcnt(44)
v_cvt_pk_bf16_f32 v59, v38, v39
v_mfma_f32_16x16x32_bf16 v[16:19], a[4:7], a[36:39], v[16:19]
s_mov_b32 m0, 98304
v_mfma_f32_16x16x32_bf16 v[16:19], a[8:11], a[40:43], v[16:19]
buffer_load_dwordx4 v236, s[16:19], s34 offen offset:0 nt lds
v_mfma_f32_16x16x32_bf16 v[16:19], a[12:15], a[44:47], v[16:19]
v_mfma_f32_16x16x32_bf16 v[20:23], a[16:19], a[32:35], v[64:67]
v_mfma_f32_16x16x32_bf16 v[20:23], a[20:23], a[36:39], v[20:23]
buffer_load_dwordx4 v237, s[16:19], s34 offen offset:1024 nt lds
v_mfma_f32_16x16x32_bf16 v[20:23], a[24:27], a[40:43], v[20:23]
buffer_load_dword v107, v11, s[48:51], 0 offen sc1
v_mfma_f32_16x16x32_bf16 v[20:23], a[28:31], a[44:47], v[20:23]
v_mfma_f32_16x16x32_bf16 v[24:27], a[0:3], a[48:51], v[68:71]
buffer_load_dwordx4 v236, s[16:19], s34 offen offset:2048 nt lds
v_mfma_f32_16x16x32_bf16 v[24:27], a[4:7], a[52:55], v[24:27]
v_exp_f32 v16, v16
v_mfma_f32_16x16x32_bf16 v[24:27], a[8:11], a[56:59], v[24:27]
v_exp_f32 v17, v17
v_mfma_f32_16x16x32_bf16 v[24:27], a[12:15], a[60:63], v[24:27]
buffer_load_dwordx4 v237, s[16:19], s34 offen offset:3072 nt lds
v_cvt_pk_bf16_f32 v48, v16, v17
v_mfma_f32_16x16x32_bf16 v[28:31], a[16:19], a[48:51], v[68:71]
v_exp_f32 v18, v18
v_mfma_f32_16x16x32_bf16 v[28:31], a[20:23], a[52:55], v[28:31]
s_mov_b32 m0, 102400
s_add_u32 s92, s34, 4096
v_exp_f32 v19, v19
v_mfma_f32_16x16x32_bf16 v[28:31], a[24:27], a[56:59], v[28:31]
buffer_load_dwordx4 v236, s[16:19], s92 offen offset:0 nt lds
v_exp_f32 v20, v20
v_mfma_f32_16x16x32_bf16 v[28:31], a[28:31], a[60:63], v[28:31]
v_exp_f32 v21, v21
v_mfma_f32_16x16x32_bf16 v[192:195], a[64:67], v[56:59], v[192:195]
v_exp_f32 v22, v22
v_mfma_f32_16x16x32_bf16 v[196:199], a[68:71], v[56:59], v[196:199]
buffer_load_dwordx4 v237, s[16:19], s92 offen offset:1024 nt lds
v_cvt_pk_bf16_f32 v49, v18, v19
v_mfma_f32_16x16x32_bf16 v[200:203], a[72:75], v[56:59], v[200:203]
v_exp_f32 v23, v23
v_mfma_f32_16x16x32_bf16 v[204:207], a[76:79], v[56:59], v[204:207]
v_exp_f32 v24, v24
v_mfma_f32_16x16x32_bf16 v[208:211], a[80:83], v[56:59], v[208:211]
buffer_load_dwordx4 v236, s[16:19], s92 offen offset:2048 nt lds
v_exp_f32 v25, v25
v_mfma_f32_16x16x32_bf16 v[212:215], a[84:87], v[56:59], v[212:215]
v_exp_f32 v26, v26
v_mfma_f32_16x16x32_bf16 v[216:219], a[88:91], v[56:59], v[216:219]
v_exp_f32 v27, v27
v_mfma_f32_16x16x32_bf16 v[220:223], a[92:95], v[56:59], v[220:223]
buffer_load_dwordx4 v237, s[16:19], s92 offen offset:3072 nt lds
v_cvt_pk_bf16_f32 v50, v20, v21
v_mfma_f32_16x16x32_bf16 v[116:119], v[124:127], v[56:59], v[116:119]
v_exp_f32 v28, v28
v_exp_f32 v29, v29
ds_read_b64_tr_b16 a[64:65], v88 offset:0
v_cvt_pk_bf16_f32 v51, v22, v23
ds_read_b64_tr_b16 a[66:67], v88 offset:4096
v_cvt_pk_bf16_f32 v52, v24, v25
ds_read_b64_tr_b16 a[68:69], v89 offset:0
v_cvt_pk_bf16_f32 v53, v26, v27
ds_read_b64_tr_b16 a[70:71], v89 offset:4096
v_cvt_pk_bf16_f32 v54, v28, v29
ds_read_b64_tr_b16 a[72:73], v90 offset:0
ds_read_b64_tr_b16 a[74:75], v90 offset:4096
ds_read_b64_tr_b16 a[76:77], v91 offset:0
ds_read_b64_tr_b16 a[78:79], v91 offset:4096
v_mfma_f32_16x16x32_bf16 v[32:35], a[0:3], a[96:99], v[72:75]
ds_read_b64_tr_b16 a[80:81], v92 offset:0
s_mov_b32 m0, 106496
s_add_u32 s92, s34, 8192
v_mfma_f32_16x16x32_bf16 v[32:35], a[4:7], a[100:103], v[32:35]
ds_read_b64_tr_b16 a[82:83], v92 offset:4096
buffer_load_dwordx4 v236, s[16:19], s92 offen offset:0 nt lds
v_mfma_f32_16x16x32_bf16 v[32:35], a[8:11], a[104:107], v[32:35]
ds_read_b64_tr_b16 a[84:85], v93 offset:0
v_mfma_f32_16x16x32_bf16 v[32:35], a[12:15], a[108:111], v[32:35]
ds_read_b64_tr_b16 a[86:87], v93 offset:4096
v_mfma_f32_16x16x32_bf16 v[36:39], a[16:19], a[96:99], v[72:75]
ds_read_b64_tr_b16 a[88:89], v94 offset:0
buffer_load_dwordx4 v237, s[16:19], s92 offen offset:1024 nt lds
v_mfma_f32_16x16x32_bf16 v[36:39], a[20:23], a[100:103], v[36:39]
ds_read_b64_tr_b16 a[90:91], v94 offset:4096
v_mfma_f32_16x16x32_bf16 v[36:39], a[24:27], a[104:107], v[36:39]
ds_read_b64_tr_b16 a[92:93], v95 offset:0
v_mfma_f32_16x16x32_bf16 v[36:39], a[28:31], a[108:111], v[36:39]
ds_read_b64_tr_b16 a[94:95], v95 offset:4096
buffer_load_dwordx4 v236, s[16:19], s92 offen offset:2048 nt lds
v_exp_f32 v30, v30
v_exp_f32 v31, v31
v_exp_f32 v32, v32
v_exp_f32 v33, v33
v_exp_f32 v34, v34
v_exp_f32 v35, v35
v_exp_f32 v36, v36
s_waitcnt lgkmcnt(0)
v_exp_f32 v37, v37
v_mfma_f32_16x16x32_bf16 v[128:131], a[64:67], v[48:51], v[128:131]
ds_read_b128 a[0:3], v84 offset:8192
v_cvt_pk_bf16_f32 v55, v30, v31
v_mfma_f32_16x16x32_bf16 v[132:135], a[68:71], v[48:51], v[132:135]
ds_read_b128 a[4:7], v85 offset:8192
v_cvt_pk_bf16_f32 v56, v32, v33
v_mfma_f32_16x16x32_bf16 v[136:139], a[72:75], v[48:51], v[136:139]
ds_read_b128 a[8:11], v86 offset:8192
buffer_load_dwordx4 v237, s[16:19], s92 offen offset:3072 nt lds
v_cvt_pk_bf16_f32 v57, v34, v35
v_mfma_f32_16x16x32_bf16 v[140:143], a[76:79], v[48:51], v[140:143]
ds_read_b128 a[12:15], v87 offset:8192
v_cvt_pk_bf16_f32 v58, v36, v37
v_mfma_f32_16x16x32_bf16 v[144:147], a[80:83], v[48:51], v[144:147]
ds_read_b128 a[16:19], v84 offset:12288
s_mov_b32 m0, 110592
s_add_u32 s92, s34, 12288
v_mfma_f32_16x16x32_bf16 v[148:151], a[84:87], v[48:51], v[148:151]
ds_read_b128 a[20:23], v85 offset:12288
buffer_load_dwordx4 v236, s[16:19], s92 offen offset:0 nt lds
v_mfma_f32_16x16x32_bf16 v[152:155], a[88:91], v[48:51], v[152:155]
ds_read_b128 a[24:27], v86 offset:12288
v_mfma_f32_16x16x32_bf16 v[156:159], a[92:95], v[48:51], v[156:159]
ds_read_b128 a[28:31], v87 offset:12288
v_mfma_f32_16x16x32_bf16 v[108:111], v[124:127], v[48:51], v[108:111]
buffer_load_dwordx4 v237, s[16:19], s92 offen offset:1024 nt lds
v_exp_f32 v38, v38
v_mfma_f32_16x16x32_bf16 v[160:163], a[64:67], v[52:55], v[160:163]
v_exp_f32 v39, v39
v_mfma_f32_16x16x32_bf16 v[164:167], a[68:71], v[52:55], v[164:167]
v_mfma_f32_16x16x32_bf16 v[168:171], a[72:75], v[52:55], v[168:171]
buffer_load_dwordx4 v236, s[16:19], s92 offen offset:2048 nt lds
v_mfma_f32_16x16x32_bf16 v[172:175], a[76:79], v[52:55], v[172:175]
v_mfma_f32_16x16x32_bf16 v[176:179], a[80:83], v[52:55], v[176:179]
s_add_u32 s34, s34, 16384
v_mfma_f32_16x16x32_bf16 v[180:183], a[84:87], v[52:55], v[180:183]
buffer_load_dwordx4 v237, s[16:19], s92 offen offset:3072 nt lds
v_mfma_f32_16x16x32_bf16 v[184:187], a[88:91], v[52:55], v[184:187]
v_mfma_f32_16x16x32_bf16 v[188:191], a[92:95], v[52:55], v[188:191]
v_mfma_f32_16x16x32_bf16 v[112:115], v[124:127], v[52:55], v[112:115]
s_waitcnt lgkmcnt(0)
v_mfma_f32_16x16x32_bf16 v[16:19], a[0:3], a[32:35], v[64:67]
v_cvt_pk_bf16_f32 v59, v38, v39
v_mfma_f32_16x16x32_bf16 v[16:19], a[4:7], a[36:39], v[16:19]
s_mov_b32 m0, 49152
v_mfma_f32_16x16x32_bf16 v[16:19], a[8:11], a[40:43], v[16:19]
buffer_load_dwordx4 v234, s[12:15], s34 offen offset:0 nt lds
v_mfma_f32_16x16x32_bf16 v[16:19], a[12:15], a[44:47], v[16:19]
v_mfma_f32_16x16x32_bf16 v[20:23], a[16:19], a[32:35], v[64:67]
v_mfma_f32_16x16x32_bf16 v[20:23], a[20:23], a[36:39], v[20:23]
s_add_u32 s39, s39, 1
buffer_load_dwordx4 v235, s[12:15], s34 offen offset:1024 nt lds
v_mfma_f32_16x16x32_bf16 v[20:23], a[24:27], a[40:43], v[20:23]
v_mov_b32 v80, s39
v_mfma_f32_16x16x32_bf16 v[20:23], a[28:31], a[44:47], v[20:23]
v_mfma_f32_16x16x32_bf16 v[24:27], a[0:3], a[48:51], v[68:71]
s_waitcnt vmcnt(35)
ds_write_b32 v1, v80
buffer_load_dwordx4 v232, s[12:15], s34 offen offset:2048 nt lds
v_mfma_f32_16x16x32_bf16 v[24:27], a[4:7], a[52:55], v[24:27]
v_exp_f32 v16, v16
v_mfma_f32_16x16x32_bf16 v[24:27], a[8:11], a[56:59], v[24:27]
v_exp_f32 v17, v17
v_mfma_f32_16x16x32_bf16 v[24:27], a[12:15], a[60:63], v[24:27]
buffer_load_dwordx4 v233, s[12:15], s34 offen offset:3072 nt lds
v_cvt_pk_bf16_f32 v48, v16, v17
v_mfma_f32_16x16x32_bf16 v[28:31], a[16:19], a[48:51], v[68:71]
v_exp_f32 v18, v18
v_mfma_f32_16x16x32_bf16 v[28:31], a[20:23], a[52:55], v[28:31]
s_mov_b32 m0, 53248
s_add_u32 s92, s34, 4096
v_exp_f32 v19, v19
v_mfma_f32_16x16x32_bf16 v[28:31], a[24:27], a[56:59], v[28:31]
buffer_load_dwordx4 v234, s[12:15], s92 offen offset:0 nt lds
v_exp_f32 v20, v20
v_mfma_f32_16x16x32_bf16 v[28:31], a[28:31], a[60:63], v[28:31]
v_exp_f32 v21, v21
v_mfma_f32_16x16x32_bf16 v[192:195], a[64:67], v[56:59], v[192:195]
v_exp_f32 v22, v22
v_mfma_f32_16x16x32_bf16 v[196:199], a[68:71], v[56:59], v[196:199]
buffer_load_dwordx4 v235, s[12:15], s92 offen offset:1024 nt lds
v_cvt_pk_bf16_f32 v49, v18, v19
v_mfma_f32_16x16x32_bf16 v[200:203], a[72:75], v[56:59], v[200:203]
v_exp_f32 v23, v23
v_mfma_f32_16x16x32_bf16 v[204:207], a[76:79], v[56:59], v[204:207]
v_exp_f32 v24, v24
v_mfma_f32_16x16x32_bf16 v[208:211], a[80:83], v[56:59], v[208:211]
buffer_load_dwordx4 v232, s[12:15], s92 offen offset:2048 nt lds
v_exp_f32 v25, v25
v_mfma_f32_16x16x32_bf16 v[212:215], a[84:87], v[56:59], v[212:215]
v_exp_f32 v26, v26
v_mfma_f32_16x16x32_bf16 v[216:219], a[88:91], v[56:59], v[216:219]
v_exp_f32 v27, v27
v_mfma_f32_16x16x32_bf16 v[220:223], a[92:95], v[56:59], v[220:223]
buffer_load_dwordx4 v233, s[12:15], s92 offen offset:3072 nt lds
v_cvt_pk_bf16_f32 v50, v20, v21
v_mfma_f32_16x16x32_bf16 v[116:119], v[124:127], v[56:59], v[116:119]
v_exp_f32 v28, v28
v_exp_f32 v29, v29
ds_read_b64_tr_b16 a[64:65], v88 offset:8192
v_cvt_pk_bf16_f32 v51, v22, v23
ds_read_b64_tr_b16 a[66:67], v88 offset:12288
v_cvt_pk_bf16_f32 v52, v24, v25
ds_read_b64_tr_b16 a[68:69], v89 offset:8192
v_cvt_pk_bf16_f32 v53, v26, v27
ds_read_b64_tr_b16 a[70:71], v89 offset:12288
v_cvt_pk_bf16_f32 v54, v28, v29
ds_read_b64_tr_b16 a[72:73], v90 offset:8192
ds_read_b64_tr_b16 a[74:75], v90 offset:12288
ds_read_b64_tr_b16 a[76:77], v91 offset:8192
ds_read_b64_tr_b16 a[78:79], v91 offset:12288
v_mfma_f32_16x16x32_bf16 v[32:35], a[0:3], a[96:99], v[72:75]
ds_read_b64_tr_b16 a[80:81], v92 offset:8192
s_mov_b32 m0, 57344
s_add_u32 s92, s34, 8192
v_mfma_f32_16x16x32_bf16 v[32:35], a[4:7], a[100:103], v[32:35]
ds_read_b64_tr_b16 a[82:83], v92 offset:12288
ds_read_b128 v[80:83], v101
buffer_load_dwordx4 v234, s[12:15], s92 offen offset:0 nt lds
v_mfma_f32_16x16x32_bf16 v[32:35], a[8:11], a[104:107], v[32:35]
ds_read_b64_tr_b16 a[84:85], v93 offset:8192
v_mfma_f32_16x16x32_bf16 v[32:35], a[12:15], a[108:111], v[32:35]
ds_read_b64_tr_b16 a[86:87], v93 offset:12288
v_mfma_f32_16x16x32_bf16 v[36:39], a[16:19], a[96:99], v[72:75]
s_waitcnt lgkmcnt(2)
ds_read_b64_tr_b16 a[88:89], v94 offset:8192
buffer_load_dwordx4 v235, s[12:15], s92 offen offset:1024 nt lds
v_min3_u32 v80, v80, v81, v82
v_mfma_f32_16x16x32_bf16 v[36:39], a[20:23], a[100:103], v[36:39]
ds_read_b64_tr_b16 a[90:91], v94 offset:12288
v_min_u32 v80, v80, v83
v_mfma_f32_16x16x32_bf16 v[36:39], a[24:27], a[104:107], v[36:39]
ds_read_b64_tr_b16 a[92:93], v95 offset:8192
v_cmp_gt_u32 vcc, s39, v80
v_mfma_f32_16x16x32_bf16 v[36:39], a[28:31], a[108:111], v[36:39]
s_cbranch_vccnz L_fs57_3
L_fr57_3:
ds_read_b64_tr_b16 a[94:95], v95 offset:12288
buffer_load_dwordx4 v232, s[12:15], s92 offen offset:2048 nt lds
v_exp_f32 v30, v30
v_exp_f32 v31, v31
v_exp_f32 v32, v32
v_exp_f32 v33, v33
v_exp_f32 v34, v34
v_exp_f32 v35, v35
v_exp_f32 v36, v36
s_waitcnt lgkmcnt(0)
v_exp_f32 v37, v37
v_mfma_f32_16x16x32_bf16 v[128:131], a[64:67], v[48:51], v[128:131]
ds_read_b128 a[0:3], v84 offset:16384
v_cvt_pk_bf16_f32 v55, v30, v31
v_mfma_f32_16x16x32_bf16 v[132:135], a[68:71], v[48:51], v[132:135]
ds_read_b128 a[4:7], v85 offset:16384
v_cvt_pk_bf16_f32 v56, v32, v33
v_mfma_f32_16x16x32_bf16 v[136:139], a[72:75], v[48:51], v[136:139]
ds_read_b128 a[8:11], v86 offset:16384
buffer_load_dwordx4 v233, s[12:15], s92 offen offset:3072 nt lds
v_cvt_pk_bf16_f32 v57, v34, v35
v_mfma_f32_16x16x32_bf16 v[140:143], a[76:79], v[48:51], v[140:143]
ds_read_b128 a[12:15], v87 offset:16384
v_cvt_pk_bf16_f32 v58, v36, v37
v_mfma_f32_16x16x32_bf16 v[144:147], a[80:83], v[48:51], v[144:147]
ds_read_b128 a[16:19], v84 offset:20480
s_mov_b32 m0, 61440
s_add_u32 s92, s34, 12288
v_mfma_f32_16x16x32_bf16 v[148:151], a[84:87], v[48:51], v[148:151]
ds_read_b128 a[20:23], v85 offset:20480
buffer_load_dwordx4 v234, s[12:15], s92 offen offset:0 nt lds
v_mfma_f32_16x16x32_bf16 v[152:155], a[88:91], v[48:51], v[152:155]
ds_read_b128 a[24:27], v86 offset:20480
v_mfma_f32_16x16x32_bf16 v[156:159], a[92:95], v[48:51], v[156:159]
ds_read_b128 a[28:31], v87 offset:20480
v_mfma_f32_16x16x32_bf16 v[108:111], v[124:127], v[48:51], v[108:111]
buffer_load_dwordx4 v235, s[12:15], s92 offen offset:1024 nt lds
v_exp_f32 v38, v38
v_mfma_f32_16x16x32_bf16 v[160:163], a[64:67], v[52:55], v[160:163]
v_exp_f32 v39, v39
v_mfma_f32_16x16x32_bf16 v[164:167], a[68:71], v[52:55], v[164:167]
v_mfma_f32_16x16x32_bf16 v[168:171], a[72:75], v[52:55], v[168:171]
buffer_load_dwordx4 v232, s[12:15], s92 offen offset:2048 nt lds
v_mfma_f32_16x16x32_bf16 v[172:175], a[76:79], v[52:55], v[172:175]
v_mfma_f32_16x16x32_bf16 v[176:179], a[80:83], v[52:55], v[176:179]
v_mfma_f32_16x16x32_bf16 v[180:183], a[84:87], v[52:55], v[180:183]
buffer_load_dwordx4 v233, s[12:15], s92 offen offset:3072 nt lds
v_mfma_f32_16x16x32_bf16 v[184:187], a[88:91], v[52:55], v[184:187]
v_mfma_f32_16x16x32_bf16 v[188:191], a[92:95], v[52:55], v[188:191]
v_mfma_f32_16x16x32_bf16 v[112:115], v[124:127], v[52:55], v[112:115]
s_waitcnt lgkmcnt(0)
v_mfma_f32_16x16x32_bf16 v[16:19], a[0:3], a[32:35], v[64:67]
s_waitcnt vmcnt(44)
v_cvt_pk_bf16_f32 v59, v38, v39
v_mfma_f32_16x16x32_bf16 v[16:19], a[4:7], a[36:39], v[16:19]
s_mov_b32 m0, 114688
v_mfma_f32_16x16x32_bf16 v[16:19], a[8:11], a[40:43], v[16:19]
buffer_load_dwordx4 v236, s[16:19], s34 offen offset:0 nt lds
v_mfma_f32_16x16x32_bf16 v[16:19], a[12:15], a[44:47], v[16:19]
v_mfma_f32_16x16x32_bf16 v[20:23], a[16:19], a[32:35], v[64:67]
v_mfma_f32_16x16x32_bf16 v[20:23], a[20:23], a[36:39], v[20:23]
buffer_load_dwordx4 v237, s[16:19], s34 offen offset:1024 nt lds
v_mfma_f32_16x16x32_bf16 v[20:23], a[24:27], a[40:43], v[20:23]
v_mfma_f32_16x16x32_bf16 v[20:23], a[28:31], a[44:47], v[20:23]
v_mfma_f32_16x16x32_bf16 v[24:27], a[0:3], a[48:51], v[68:71]
buffer_load_dwordx4 v236, s[16:19], s34 offen offset:2048 nt lds
v_mfma_f32_16x16x32_bf16 v[24:27], a[4:7], a[52:55], v[24:27]
v_exp_f32 v16, v16
v_mfma_f32_16x16x32_bf16 v[24:27], a[8:11], a[56:59], v[24:27]
v_exp_f32 v17, v17
v_mfma_f32_16x16x32_bf16 v[24:27], a[12:15], a[60:63], v[24:27]
buffer_load_dwordx4 v237, s[16:19], s34 offen offset:3072 nt lds
v_cvt_pk_bf16_f32 v48, v16, v17
v_mfma_f32_16x16x32_bf16 v[28:31], a[16:19], a[48:51], v[68:71]
v_exp_f32 v18, v18
v_mfma_f32_16x16x32_bf16 v[28:31], a[20:23], a[52:55], v[28:31]
s_mov_b32 m0, 118784
s_add_u32 s92, s34, 4096
v_exp_f32 v19, v19
v_mfma_f32_16x16x32_bf16 v[28:31], a[24:27], a[56:59], v[28:31]
buffer_load_dwordx4 v236, s[16:19], s92 offen offset:0 nt lds
v_exp_f32 v20, v20
v_mfma_f32_16x16x32_bf16 v[28:31], a[28:31], a[60:63], v[28:31]
v_exp_f32 v21, v21
v_mfma_f32_16x16x32_bf16 v[192:195], a[64:67], v[56:59], v[192:195]
v_exp_f32 v22, v22
v_mfma_f32_16x16x32_bf16 v[196:199], a[68:71], v[56:59], v[196:199]
buffer_load_dwordx4 v237, s[16:19], s92 offen offset:1024 nt lds
v_cvt_pk_bf16_f32 v49, v18, v19
v_mfma_f32_16x16x32_bf16 v[200:203], a[72:75], v[56:59], v[200:203]
v_exp_f32 v23, v23
v_mfma_f32_16x16x32_bf16 v[204:207], a[76:79], v[56:59], v[204:207]
v_exp_f32 v24, v24
v_mfma_f32_16x16x32_bf16 v[208:211], a[80:83], v[56:59], v[208:211]
buffer_load_dwordx4 v236, s[16:19], s92 offen offset:2048 nt lds
v_exp_f32 v25, v25
v_mfma_f32_16x16x32_bf16 v[212:215], a[84:87], v[56:59], v[212:215]
v_exp_f32 v26, v26
v_mfma_f32_16x16x32_bf16 v[216:219], a[88:91], v[56:59], v[216:219]
v_exp_f32 v27, v27
v_mfma_f32_16x16x32_bf16 v[220:223], a[92:95], v[56:59], v[220:223]
buffer_load_dwordx4 v237, s[16:19], s92 offen offset:3072 nt lds
v_cvt_pk_bf16_f32 v50, v20, v21
v_mfma_f32_16x16x32_bf16 v[116:119], v[124:127], v[56:59], v[116:119]
v_exp_f32 v28, v28
v_exp_f32 v29, v29
ds_read_b64_tr_b16 a[64:65], v88 offset:16384
v_cvt_pk_bf16_f32 v51, v22, v23
ds_read_b64_tr_b16 a[66:67], v88 offset:20480
v_cvt_pk_bf16_f32 v52, v24, v25
ds_read_b64_tr_b16 a[68:69], v89 offset:16384
v_cvt_pk_bf16_f32 v53, v26, v27
ds_read_b64_tr_b16 a[70:71], v89 offset:20480
v_cvt_pk_bf16_f32 v54, v28, v29
ds_read_b64_tr_b16 a[72:73], v90 offset:16384
ds_read_b64_tr_b16 a[74:75], v90 offset:20480
ds_read_b64_tr_b16 a[76:77], v91 offset:16384
ds_read_b64_tr_b16 a[78:79], v91 offset:20480
v_mfma_f32_16x16x32_bf16 v[32:35], a[0:3], a[96:99], v[72:75]
ds_read_b64_tr_b16 a[80:81], v92 offset:16384
s_mov_b32 m0, 122880
s_add_u32 s92, s34, 8192
v_mfma_f32_16x16x32_bf16 v[32:35], a[4:7], a[100:103], v[32:35]
ds_read_b64_tr_b16 a[82:83], v92 offset:20480
buffer_load_dwordx4 v236, s[16:19], s92 offen offset:0 nt lds
v_mfma_f32_16x16x32_bf16 v[32:35], a[8:11], a[104:107], v[32:35]
ds_read_b64_tr_b16 a[84:85], v93 offset:16384
v_mfma_f32_16x16x32_bf16 v[32:35], a[12:15], a[108:111], v[32:35]
ds_read_b64_tr_b16 a[86:87], v93 offset:20480
v_mfma_f32_16x16x32_bf16 v[36:39], a[16:19], a[96:99], v[72:75]
ds_read_b64_tr_b16 a[88:89], v94 offset:16384
buffer_load_dwordx4 v237, s[16:19], s92 offen offset:1024 nt lds
v_mfma_f32_16x16x32_bf16 v[36:39], a[20:23], a[100:103], v[36:39]
ds_read_b64_tr_b16 a[90:91], v94 offset:20480
v_mfma_f32_16x16x32_bf16 v[36:39], a[24:27], a[104:107], v[36:39]
ds_read_b64_tr_b16 a[92:93], v95 offset:16384
v_mfma_f32_16x16x32_bf16 v[36:39], a[28:31], a[108:111], v[36:39]
ds_read_b64_tr_b16 a[94:95], v95 offset:20480
buffer_load_dwordx4 v236, s[16:19], s92 offen offset:2048 nt lds
v_exp_f32 v30, v30
v_exp_f32 v31, v31
v_exp_f32 v32, v32
v_exp_f32 v33, v33
v_exp_f32 v34, v34
v_exp_f32 v35, v35
v_exp_f32 v36, v36
s_waitcnt lgkmcnt(0)
v_exp_f32 v37, v37
v_mfma_f32_16x16x32_bf16 v[128:131], a[64:67], v[48:51], v[128:131]
ds_read_b128 a[0:3], v84 offset:24576
v_cvt_pk_bf16_f32 v55, v30, v31
v_mfma_f32_16x16x32_bf16 v[132:135], a[68:71], v[48:51], v[132:135]
ds_read_b128 a[4:7], v85 offset:24576
v_cvt_pk_bf16_f32 v56, v32, v33
v_mfma_f32_16x16x32_bf16 v[136:139], a[72:75], v[48:51], v[136:139]
ds_read_b128 a[8:11], v86 offset:24576
buffer_load_dwordx4 v237, s[16:19], s92 offen offset:3072 nt lds
v_cvt_pk_bf16_f32 v57, v34, v35
v_mfma_f32_16x16x32_bf16 v[140:143], a[76:79], v[48:51], v[140:143]
ds_read_b128 a[12:15], v87 offset:24576
v_cvt_pk_bf16_f32 v58, v36, v37
v_mfma_f32_16x16x32_bf16 v[144:147], a[80:83], v[48:51], v[144:147]
ds_read_b128 a[16:19], v84 offset:28672
s_mov_b32 m0, 126976
s_add_u32 s92, s34, 12288
v_mfma_f32_16x16x32_bf16 v[148:151], a[84:87], v[48:51], v[148:151]
ds_read_b128 a[20:23], v85 offset:28672
buffer_load_dwordx4 v236, s[16:19], s92 offen offset:0 nt lds
v_mfma_f32_16x16x32_bf16 v[152:155], a[88:91], v[48:51], v[152:155]
ds_read_b128 a[24:27], v86 offset:28672
v_mfma_f32_16x16x32_bf16 v[156:159], a[92:95], v[48:51], v[156:159]
ds_read_b128 a[28:31], v87 offset:28672
v_mfma_f32_16x16x32_bf16 v[108:111], v[124:127], v[48:51], v[108:111]
buffer_load_dwordx4 v237, s[16:19], s92 offen offset:1024 nt lds
v_exp_f32 v38, v38
v_mfma_f32_16x16x32_bf16 v[160:163], a[64:67], v[52:55], v[160:163]
v_exp_f32 v39, v39
v_mfma_f32_16x16x32_bf16 v[164:167], a[68:71], v[52:55], v[164:167]
v_mfma_f32_16x16x32_bf16 v[168:171], a[72:75], v[52:55], v[168:171]
buffer_load_dwordx4 v236, s[16:19], s92 offen offset:2048 nt lds
v_mfma_f32_16x16x32_bf16 v[172:175], a[76:79], v[52:55], v[172:175]
v_mfma_f32_16x16x32_bf16 v[176:179], a[80:83], v[52:55], v[176:179]
s_add_u32 s34, s34, 16384
v_mfma_f32_16x16x32_bf16 v[180:183], a[84:87], v[52:55], v[180:183]
buffer_load_dwordx4 v237, s[16:19], s92 offen offset:3072 nt lds
v_mfma_f32_16x16x32_bf16 v[184:187], a[88:91], v[52:55], v[184:187]
v_mfma_f32_16x16x32_bf16 v[188:191], a[92:95], v[52:55], v[188:191]
v_mfma_f32_16x16x32_bf16 v[112:115], v[124:127], v[52:55], v[112:115]
s_waitcnt lgkmcnt(0)
v_mfma_f32_16x16x32_bf16 v[16:19], a[0:3], a[32:35], v[64:67]
v_cvt_pk_bf16_f32 v59, v38, v39
v_mfma_f32_16x16x32_bf16 v[16:19], a[4:7], a[36:39], v[16:19]
v_mfma_f32_16x16x32_bf16 v[16:19], a[8:11], a[40:43], v[16:19]
v_mfma_f32_16x16x32_bf16 v[16:19], a[12:15], a[44:47], v[16:19]
v_mfma_f32_16x16x32_bf16 v[20:23], a[16:19], a[32:35], v[64:67]
v_mfma_f32_16x16x32_bf16 v[20:23], a[20:23], a[36:39], v[20:23]
s_add_u32 s39, s39, 1
v_mfma_f32_16x16x32_bf16 v[20:23], a[24:27], a[40:43], v[20:23]
v_mov_b32 v80, s39
v_mfma_f32_16x16x32_bf16 v[20:23], a[28:31], a[44:47], v[20:23]
v_mfma_f32_16x16x32_bf16 v[24:27], a[0:3], a[48:51], v[68:71]
s_waitcnt vmcnt(32)
ds_write_b32 v1, v80
v_mfma_f32_16x16x32_bf16 v[24:27], a[4:7], a[52:55], v[24:27]
v_exp_f32 v16, v16
v_mfma_f32_16x16x32_bf16 v[24:27], a[8:11], a[56:59], v[24:27]
v_exp_f32 v17, v17
v_mfma_f32_16x16x32_bf16 v[24:27], a[12:15], a[60:63], v[24:27]
v_cvt_pk_bf16_f32 v48, v16, v17
v_mfma_f32_16x16x32_bf16 v[28:31], a[16:19], a[48:51], v[68:71]
v_exp_f32 v18, v18
v_mfma_f32_16x16x32_bf16 v[28:31], a[20:23], a[52:55], v[28:31]
v_exp_f32 v19, v19
v_mfma_f32_16x16x32_bf16 v[28:31], a[24:27], a[56:59], v[28:31]
v_exp_f32 v20, v20
v_mfma_f32_16x16x32_bf16 v[28:31], a[28:31], a[60:63], v[28:31]
v_exp_f32 v21, v21
v_mfma_f32_16x16x32_bf16 v[192:195], a[64:67], v[56:59], v[192:195]
v_exp_f32 v22, v22
v_mfma_f32_16x16x32_bf16 v[196:199], a[68:71], v[56:59], v[196:199]
v_cvt_pk_bf16_f32 v49, v18, v19
v_mfma_f32_16x16x32_bf16 v[200:203], a[72:75], v[56:59], v[200:203]
v_exp_f32 v23, v23
v_mfma_f32_16x16x32_bf16 v[204:207], a[76:79], v[56:59], v[204:207]
v_exp_f32 v24, v24
v_mfma_f32_16x16x32_bf16 v[208:211], a[80:83], v[56:59], v[208:211]
v_exp_f32 v25, v25
v_mfma_f32_16x16x32_bf16 v[212:215], a[84:87], v[56:59], v[212:215]
v_exp_f32 v26, v26
v_mfma_f32_16x16x32_bf16 v[216:219], a[88:91], v[56:59], v[216:219]
v_exp_f32 v27, v27
v_mfma_f32_16x16x32_bf16 v[220:223], a[92:95], v[56:59], v[220:223]
v_cvt_pk_bf16_f32 v50, v20, v21
v_mfma_f32_16x16x32_bf16 v[116:119], v[124:127], v[56:59], v[116:119]
v_exp_f32 v28, v28
v_exp_f32 v29, v29
ds_read_b64_tr_b16 a[64:65], v88 offset:24576
v_cvt_pk_bf16_f32 v51, v22, v23
ds_read_b64_tr_b16 a[66:67], v88 offset:28672
v_cvt_pk_bf16_f32 v52, v24, v25
ds_read_b64_tr_b16 a[68:69], v89 offset:24576
v_cvt_pk_bf16_f32 v53, v26, v27
ds_read_b64_tr_b16 a[70:71], v89 offset:28672
v_cvt_pk_bf16_f32 v54, v28, v29
ds_read_b64_tr_b16 a[72:73], v90 offset:24576
ds_read_b64_tr_b16 a[74:75], v90 offset:28672
ds_read_b64_tr_b16 a[76:77], v91 offset:24576
ds_read_b64_tr_b16 a[78:79], v91 offset:28672
v_mfma_f32_16x16x32_bf16 v[32:35], a[0:3], a[96:99], v[72:75]
ds_read_b64_tr_b16 a[80:81], v92 offset:24576
v_mfma_f32_16x16x32_bf16 v[32:35], a[4:7], a[100:103], v[32:35]
ds_read_b64_tr_b16 a[82:83], v92 offset:28672
ds_read_b128 v[80:83], v101
v_mfma_f32_16x16x32_bf16 v[32:35], a[8:11], a[104:107], v[32:35]
ds_read_b64_tr_b16 a[84:85], v93 offset:24576
v_mfma_f32_16x16x32_bf16 v[32:35], a[12:15], a[108:111], v[32:35]
ds_read_b64_tr_b16 a[86:87], v93 offset:28672
v_mfma_f32_16x16x32_bf16 v[36:39], a[16:19], a[96:99], v[72:75]
s_waitcnt lgkmcnt(2)
ds_read_b64_tr_b16 a[88:89], v94 offset:24576
v_min3_u32 v80, v80, v81, v82
v_mfma_f32_16x16x32_bf16 v[36:39], a[20:23], a[100:103], v[36:39]
ds_read_b64_tr_b16 a[90:91], v94 offset:28672
v_min_u32 v80, v80, v83
v_mfma_f32_16x16x32_bf16 v[36:39], a[24:27], a[104:107], v[36:39]
ds_read_b64_tr_b16 a[92:93], v95 offset:24576
v_cmp_gt_u32 vcc, s39, v80
v_mfma_f32_16x16x32_bf16 v[36:39], a[28:31], a[108:111], v[36:39]
s_cbranch_vccnz L_fs59_3
L_fr59_3:
ds_read_b64_tr_b16 a[94:95], v95 offset:28672
v_exp_f32 v30, v30
v_exp_f32 v31, v31
v_exp_f32 v32, v32
v_exp_f32 v33, v33
v_exp_f32 v34, v34
v_exp_f32 v35, v35
v_exp_f32 v36, v36
s_waitcnt lgkmcnt(0)
v_exp_f32 v37, v37
v_mfma_f32_16x16x32_bf16 v[128:131], a[64:67], v[48:51], v[128:131]
ds_read_b128 a[0:3], v84 offset:32768
v_cvt_pk_bf16_f32 v55, v30, v31
v_mfma_f32_16x16x32_bf16 v[132:135], a[68:71], v[48:51], v[132:135]
ds_read_b128 a[4:7], v85 offset:32768
v_cvt_pk_bf16_f32 v56, v32, v33
v_mfma_f32_16x16x32_bf16 v[136:139], a[72:75], v[48:51], v[136:139]
ds_read_b128 a[8:11], v86 offset:32768
v_cvt_pk_bf16_f32 v57, v34, v35
v_mfma_f32_16x16x32_bf16 v[140:143], a[76:79], v[48:51], v[140:143]
ds_read_b128 a[12:15], v87 offset:32768
v_cvt_pk_bf16_f32 v58, v36, v37
v_mfma_f32_16x16x32_bf16 v[144:147], a[80:83], v[48:51], v[144:147]
ds_read_b128 a[16:19], v84 offset:36864
v_mfma_f32_16x16x32_bf16 v[148:151], a[84:87], v[48:51], v[148:151]
ds_read_b128 a[20:23], v85 offset:36864
v_mfma_f32_16x16x32_bf16 v[152:155], a[88:91], v[48:51], v[152:155]
ds_read_b128 a[24:27], v86 offset:36864
v_mfma_f32_16x16x32_bf16 v[156:159], a[92:95], v[48:51], v[156:159]
ds_read_b128 a[28:31], v87 offset:36864
v_mfma_f32_16x16x32_bf16 v[108:111], v[124:127], v[48:51], v[108:111]
v_exp_f32 v38, v38
v_mfma_f32_16x16x32_bf16 v[160:163], a[64:67], v[52:55], v[160:163]
v_exp_f32 v39, v39
v_mfma_f32_16x16x32_bf16 v[164:167], a[68:71], v[52:55], v[164:167]
v_mfma_f32_16x16x32_bf16 v[168:171], a[72:75], v[52:55], v[168:171]
v_mfma_f32_16x16x32_bf16 v[172:175], a[76:79], v[52:55], v[172:175]
v_mfma_f32_16x16x32_bf16 v[176:179], a[80:83], v[52:55], v[176:179]
v_mfma_f32_16x16x32_bf16 v[180:183], a[84:87], v[52:55], v[180:183]
v_mfma_f32_16x16x32_bf16 v[184:187], a[88:91], v[52:55], v[184:187]
s_waitcnt vmcnt(46)
v_cmp_gt_u32 vcc, v12, v107
s_cbranch_vccnz L_espin3
L_eok3:
v_mfma_f32_16x16x32_bf16 v[188:191], a[92:95], v[52:55], v[188:191]
v_mfma_f32_16x16x32_bf16 v[112:115], v[124:127], v[52:55], v[112:115]
s_waitcnt lgkmcnt(0)
v_mfma_f32_16x16x32_bf16 v[16:19], a[0:3], a[32:35], v[64:67]
v_cvt_pk_bf16_f32 v59, v38, v39
v_mfma_f32_16x16x32_bf16 v[16:19], a[4:7], a[36:39], v[16:19]
v_mfma_f32_16x16x32_bf16 v[16:19], a[8:11], a[40:43], v[16:19]
v_mfma_f32_16x16x32_bf16 v[16:19], a[12:15], a[44:47], v[16:19]
buffer_load_dwordx4 a[144:147], v2, s[80:83], s99 offen offset:0 sc1
v_mfma_f32_16x16x32_bf16 v[20:23], a[16:19], a[32:35], v[64:67]
v_mfma_f32_16x16x32_bf16 v[20:23], a[20:23], a[36:39], v[20:23]
v_mfma_f32_16x16x32_bf16 v[20:23], a[24:27], a[40:43], v[20:23]
v_mfma_f32_16x16x32_bf16 v[20:23], a[28:31], a[44:47], v[20:23]
buffer_load_dwordx4 a[148:151], v2, s[80:83], s99 offen offset:1024 sc1
v_mfma_f32_16x16x32_bf16 v[24:27], a[0:3], a[48:51], v[68:71]
v_mfma_f32_16x16x32_bf16 v[24:27], a[4:7], a[52:55], v[24:27]
v_exp_f32 v16, v16
v_mfma_f32_16x16x32_bf16 v[24:27], a[8:11], a[56:59], v[24:27]
v_exp_f32 v17, v17
v_mfma_f32_16x16x32_bf16 v[24:27], a[12:15], a[60:63], v[24:27]
buffer_load_dwordx4 a[152:155], v2, s[80:83], s99 offen offset:2048 sc1
v_cvt_pk_bf16_f32 v48, v16, v17
v_mfma_f32_16x16x32_bf16 v[28:31], a[16:19], a[48:51], v[68:71]
v_exp_f32 v18, v18
v_mfma_f32_16x16x32_bf16 v[28:31], a[20:23], a[52:55], v[28:31]
v_exp_f32 v19, v19
v_mfma_f32_16x16x32_bf16 v[28:31], a[24:27], a[56:59], v[28:31]
v_exp_f32 v20, v20
v_mfma_f32_16x16x32_bf16 v[28:31], a[28:31], a[60:63], v[28:31]
v_exp_f32 v21, v21
v_mfma_f32_16x16x32_bf16 v[192:195], a[64:67], v[56:59], v[192:195]
v_exp_f32 v22, v22
v_mfma_f32_16x16x32_bf16 v[196:199], a[68:71], v[56:59], v[196:199]
buffer_load_dwordx4 a[156:159], v3, s[80:83], s99 offen offset:0 sc1
v_cvt_pk_bf16_f32 v49, v18, v19
v_mfma_f32_16x16x32_bf16 v[200:203], a[72:75], v[56:59], v[200:203]
v_exp_f32 v23, v23
v_mfma_f32_16x16x32_bf16 v[204:207], a[76:79], v[56:59], v[204:207]
v_exp_f32 v24, v24
v_mfma_f32_16x16x32_bf16 v[208:211], a[80:83], v[56:59], v[208:211]
v_exp_f32 v25, v25
v_mfma_f32_16x16x32_bf16 v[212:215], a[84:87], v[56:59], v[212:215]
v_exp_f32 v26, v26
v_mfma_f32_16x16x32_bf16 v[216:219], a[88:91], v[56:59], v[216:219]
v_exp_f32 v27, v27
v_mfma_f32_16x16x32_bf16 v[220:223], a[92:95], v[56:59], v[220:223]
buffer_load_dwordx4 a[160:163], v3, s[80:83], s99 offen offset:1024 sc1
v_cvt_pk_bf16_f32 v50, v20, v21
v_mfma_f32_16x16x32_bf16 v[116:119], v[124:127], v[56:59], v[116:119]
v_exp_f32 v28, v28
v_exp_f32 v29, v29
ds_read_b64_tr_b16 a[64:65], v88 offset:32768
v_cvt_pk_bf16_f32 v51, v22, v23
ds_read_b64_tr_b16 a[66:67], v88 offset:36864
v_cvt_pk_bf16_f32 v52, v24, v25
ds_read_b64_tr_b16 a[68:69], v89 offset:32768
v_cvt_pk_bf16_f32 v53, v26, v27
ds_read_b64_tr_b16 a[70:71], v89 offset:36864
v_cvt_pk_bf16_f32 v54, v28, v29
ds_read_b64_tr_b16 a[72:73], v90 offset:32768
ds_read_b64_tr_b16 a[74:75], v90 offset:36864
ds_read_b64_tr_b16 a[76:77], v91 offset:32768
ds_read_b64_tr_b16 a[78:79], v91 offset:36864
buffer_load_dwordx4 a[164:167], v3, s[80:83], s99 offen offset:2048 sc1
v_mfma_f32_16x16x32_bf16 v[32:35], a[0:3], a[96:99], v[72:75]
ds_read_b64_tr_b16 a[80:81], v92 offset:32768
v_mfma_f32_16x16x32_bf16 v[32:35], a[4:7], a[100:103], v[32:35]
ds_read_b64_tr_b16 a[82:83], v92 offset:36864
v_mfma_f32_16x16x32_bf16 v[32:35], a[8:11], a[104:107], v[32:35]
ds_read_b64_tr_b16 a[84:85], v93 offset:32768
v_mfma_f32_16x16x32_bf16 v[32:35], a[12:15], a[108:111], v[32:35]
ds_read_b64_tr_b16 a[86:87], v93 offset:36864
v_mfma_f32_16x16x32_bf16 v[36:39], a[16:19], a[96:99], v[72:75]
ds_read_b64_tr_b16 a[88:89], v94 offset:32768
buffer_load_dwordx4 a[168:171], v8, s[56:59], s98 offen offset:0 sc1
v_mfma_f32_16x16x32_bf16 v[36:39], a[20:23], a[100:103], v[36:39]
ds_read_b64_tr_b16 a[90:91], v94 offset:36864
v_mfma_f32_16x16x32_bf16 v[36:39], a[24:27], a[104:107], v[36:39]
ds_read_b64_tr_b16 a[92:93], v95 offset:32768
v_mfma_f32_16x16x32_bf16 v[36:39], a[28:31], a[108:111], v[36:39]
ds_read_b64_tr_b16 a[94:95], v95 offset:36864
v_exp_f32 v30, v30
v_exp_f32 v31, v31
v_exp_f32 v32, v32
v_exp_f32 v33, v33
v_exp_f32 v34, v34
v_exp_f32 v35, v35
s_nop 0
v_exp_f32 v36, v36
s_waitcnt lgkmcnt(0)
v_exp_f32 v37, v37
v_mfma_f32_16x16x32_bf16 v[128:131], a[64:67], v[48:51], v[128:131]
ds_read_b128 a[0:3], v84 offset:40960
v_cvt_pk_bf16_f32 v55, v30, v31
v_mfma_f32_16x16x32_bf16 v[132:135], a[68:71], v[48:51], v[132:135]
ds_read_b128 a[4:7], v85 offset:40960
v_cvt_pk_bf16_f32 v56, v32, v33
v_mfma_f32_16x16x32_bf16 v[136:139], a[72:75], v[48:51], v[136:139]
ds_read_b128 a[8:11], v86 offset:40960
v_cvt_pk_bf16_f32 v57, v34, v35
v_mfma_f32_16x16x32_bf16 v[140:143], a[76:79], v[48:51], v[140:143]
ds_read_b128 a[12:15], v87 offset:40960
v_cvt_pk_bf16_f32 v58, v36, v37
v_mfma_f32_16x16x32_bf16 v[144:147], a[80:83], v[48:51], v[144:147]
ds_read_b128 a[16:19], v84 offset:45056
v_mfma_f32_16x16x32_bf16 v[148:151], a[84:87], v[48:51], v[148:151]
ds_read_b128 a[20:23], v85 offset:45056
buffer_load_dwordx4 a[172:175], v8, s[56:59], s98 offen offset:1024 sc1
v_mfma_f32_16x16x32_bf16 v[152:155], a[88:91], v[48:51], v[152:155]
ds_read_b128 a[24:27], v86 offset:45056
v_mfma_f32_16x16x32_bf16 v[156:159], a[92:95], v[48:51], v[156:159]
ds_read_b128 a[28:31], v87 offset:45056
v_mfma_f32_16x16x32_bf16 v[108:111], v[124:127], v[48:51], v[108:111]
v_exp_f32 v38, v38
v_mfma_f32_16x16x32_bf16 v[160:163], a[64:67], v[52:55], v[160:163]
v_exp_f32 v39, v39
v_mfma_f32_16x16x32_bf16 v[164:167], a[68:71], v[52:55], v[164:167]
v_mfma_f32_16x16x32_bf16 v[168:171], a[72:75], v[52:55], v[168:171]
v_mfma_f32_16x16x32_bf16 v[172:175], a[76:79], v[52:55], v[172:175]
v_mfma_f32_16x16x32_bf16 v[176:179], a[80:83], v[52:55], v[176:179]
v_mfma_f32_16x16x32_bf16 v[180:183], a[84:87], v[52:55], v[180:183]
v_mfma_f32_16x16x32_bf16 v[184:187], a[88:91], v[52:55], v[184:187]
v_mfma_f32_16x16x32_bf16 v[188:191], a[92:95], v[52:55], v[188:191]
v_mfma_f32_16x16x32_bf16 v[112:115], v[124:127], v[52:55], v[112:115]
s_waitcnt lgkmcnt(0)
v_mfma_f32_16x16x32_bf16 v[16:19], a[0:3], a[32:35], v[64:67]
v_cvt_pk_bf16_f32 v59, v38, v39
v_mfma_f32_16x16x32_bf16 v[16:19], a[4:7], a[36:39], v[16:19]
v_mfma_f32_16x16x32_bf16 v[16:19], a[8:11], a[40:43], v[16:19]
v_mfma_f32_16x16x32_bf16 v[16:19], a[12:15], a[44:47], v[16:19]
buffer_load_dwordx4 a[176:179], v8, s[56:59], s98 offen offset:2048 sc1
v_mfma_f32_16x16x32_bf16 v[20:23], a[16:19], a[32:35], v[64:67]
v_mfma_f32_16x16x32_bf16 v[20:23], a[20:23], a[36:39], v[20:23]
s_add_u32 s39, s39, 1
v_mfma_f32_16x16x32_bf16 v[20:23], a[24:27], a[40:43], v[20:23]
v_mov_b32 v80, s39
v_mfma_f32_16x16x32_bf16 v[20:23], a[28:31], a[44:47], v[20:23]
buffer_load_dwordx4 a[180:183], v9, s[56:59], s98 offen offset:0 sc1
v_mfma_f32_16x16x32_bf16 v[24:27], a[0:3], a[48:51], v[68:71]
s_waitcnt vmcnt(10)
ds_write_b32 v1, v80
v_mfma_f32_16x16x32_bf16 v[24:27], a[4:7], a[52:55], v[24:27]
v_exp_f32 v16, v16
v_mfma_f32_16x16x32_bf16 v[24:27], a[8:11], a[56:59], v[24:27]
v_exp_f32 v17, v17
v_mfma_f32_16x16x32_bf16 v[24:27], a[12:15], a[60:63], v[24:27]
buffer_load_dwordx4 a[184:187], v9, s[56:59], s98 offen offset:1024 sc1
v_cvt_pk_bf16_f32 v48, v16, v17
v_mfma_f32_16x16x32_bf16 v[28:31], a[16:19], a[48:51], v[68:71]
v_exp_f32 v18, v18
v_mfma_f32_16x16x32_bf16 v[28:31], a[20:23], a[52:55], v[28:31]
v_exp_f32 v19, v19
v_mfma_f32_16x16x32_bf16 v[28:31], a[24:27], a[56:59], v[28:31]
v_exp_f32 v20, v20
v_mfma_f32_16x16x32_bf16 v[28:31], a[28:31], a[60:63], v[28:31]
v_exp_f32 v21, v21
v_mfma_f32_16x16x32_bf16 v[192:195], a[64:67], v[56:59], v[192:195]
v_exp_f32 v22, v22
v_mfma_f32_16x16x32_bf16 v[196:199], a[68:71], v[56:59], v[196:199]
buffer_load_dwordx4 a[188:191], v9, s[56:59], s98 offen offset:2048 sc1
v_cvt_pk_bf16_f32 v49, v18, v19
v_mfma_f32_16x16x32_bf16 v[200:203], a[72:75], v[56:59], v[200:203]
s_add_u32 s98, s98, 122880
s_add_u32 s99, s99, 36864
v_exp_f32 v23, v23
v_mfma_f32_16x16x32_bf16 v[204:207], a[76:79], v[56:59], v[204:207]
v_exp_f32 v24, v24
v_mfma_f32_16x16x32_bf16 v[208:211], a[80:83], v[56:59], v[208:211]
v_exp_f32 v25, v25
v_mfma_f32_16x16x32_bf16 v[212:215], a[84:87], v[56:59], v[212:215]
v_exp_f32 v26, v26
v_mfma_f32_16x16x32_bf16 v[216:219], a[88:91], v[56:59], v[216:219]
v_exp_f32 v27, v27
v_mfma_f32_16x16x32_bf16 v[220:223], a[92:95], v[56:59], v[220:223]
buffer_load_dwordx4 a[192:195], v2, s[80:83], s99 offen offset:0 sc1
v_cvt_pk_bf16_f32 v50, v20, v21
v_mfma_f32_16x16x32_bf16 v[116:119], v[124:127], v[56:59], v[116:119]
v_exp_f32 v28, v28
v_exp_f32 v29, v29
ds_read_b64_tr_b16 a[64:65], v88 offset:40960
v_cvt_pk_bf16_f32 v51, v22, v23
ds_read_b64_tr_b16 a[66:67], v88 offset:45056
v_cvt_pk_bf16_f32 v52, v24, v25
ds_read_b64_tr_b16 a[68:69], v89 offset:40960
v_cvt_pk_bf16_f32 v53, v26, v27
ds_read_b64_tr_b16 a[70:71], v89 offset:45056
v_cvt_pk_bf16_f32 v54, v28, v29
ds_read_b64_tr_b16 a[72:73], v90 offset:40960
ds_read_b64_tr_b16 a[74:75], v90 offset:45056
ds_read_b64_tr_b16 a[76:77], v91 offset:40960
ds_read_b64_tr_b16 a[78:79], v91 offset:45056
buffer_load_dwordx4 a[196:199], v2, s[80:83], s99 offen offset:1024 sc1
v_mfma_f32_16x16x32_bf16 v[32:35], a[0:3], a[96:99], v[72:75]
ds_read_b64_tr_b16 a[80:81], v92 offset:40960
v_mfma_f32_16x16x32_bf16 v[32:35], a[4:7], a[100:103], v[32:35]
ds_read_b64_tr_b16 a[82:83], v92 offset:45056
ds_read_b128 v[80:83], v101
v_mfma_f32_16x16x32_bf16 v[32:35], a[8:11], a[104:107], v[32:35]
ds_read_b64_tr_b16 a[84:85], v93 offset:40960
v_mfma_f32_16x16x32_bf16 v[32:35], a[12:15], a[108:111], v[32:35]
ds_read_b64_tr_b16 a[86:87], v93 offset:45056
v_mfma_f32_16x16x32_bf16 v[36:39], a[16:19], a[96:99], v[72:75]
s_waitcnt lgkmcnt(2)
ds_read_b64_tr_b16 a[88:89], v94 offset:40960
buffer_load_dwordx4 a[200:203], v2, s[80:83], s99 offen offset:2048 sc1
v_min3_u32 v80, v80, v81, v82
v_mfma_f32_16x16x32_bf16 v[36:39], a[20:23], a[100:103], v[36:39]
ds_read_b64_tr_b16 a[90:91], v94 offset:45056
v_min_u32 v80, v80, v83
v_mfma_f32_16x16x32_bf16 v[36:39], a[24:27], a[104:107], v[36:39]
ds_read_b64_tr_b16 a[92:93], v95 offset:40960
v_cmp_gt_u32 vcc, s39, v80
v_mfma_f32_16x16x32_bf16 v[36:39], a[28:31], a[108:111], v[36:39]
s_cbranch_vccnz L_fs61_3
L_fr61_3:
ds_read_b64_tr_b16 a[94:95], v95 offset:45056
v_exp_f32 v30, v30
v_exp_f32 v31, v31
v_exp_f32 v32, v32
v_exp_f32 v33, v33
v_exp_f32 v34, v34
v_exp_f32 v35, v35
v_exp_f32 v36, v36
s_waitcnt lgkmcnt(0)
v_exp_f32 v37, v37
v_mfma_f32_16x16x32_bf16 v[128:131], a[64:67], v[48:51], v[128:131]
ds_read_b128 a[0:3], v84 offset:49152
v_cvt_pk_bf16_f32 v55, v30, v31
v_mfma_f32_16x16x32_bf16 v[132:135], a[68:71], v[48:51], v[132:135]
ds_read_b128 a[4:7], v85 offset:49152
v_cvt_pk_bf16_f32 v56, v32, v33
v_mfma_f32_16x16x32_bf16 v[136:139], a[72:75], v[48:51], v[136:139]
ds_read_b128 a[8:11], v86 offset:49152
v_cvt_pk_bf16_f32 v57, v34, v35
v_mfma_f32_16x16x32_bf16 v[140:143], a[76:79], v[48:51], v[140:143]
ds_read_b128 a[12:15], v87 offset:49152
v_cvt_pk_bf16_f32 v58, v36, v37
v_mfma_f32_16x16x32_bf16 v[144:147], a[80:83], v[48:51], v[144:147]
ds_read_b128 a[16:19], v84 offset:53248
v_mfma_f32_16x16x32_bf16 v[148:151], a[84:87], v[48:51], v[148:151]
ds_read_b128 a[20:23], v85 offset:53248
buffer_load_dwordx4 a[204:207], v3, s[80:83], s99 offen offset:0 sc1
v_mfma_f32_16x16x32_bf16 v[152:155], a[88:91], v[48:51], v[152:155]
ds_read_b128 a[24:27], v86 offset:53248
v_mfma_f32_16x16x32_bf16 v[156:159], a[92:95], v[48:51], v[156:159]
ds_read_b128 a[28:31], v87 offset:53248
v_mfma_f32_16x16x32_bf16 v[108:111], v[124:127], v[48:51], v[108:111]
v_exp_f32 v38, v38
v_mfma_f32_16x16x32_bf16 v[160:163], a[64:67], v[52:55], v[160:163]
v_exp_f32 v39, v39
v_mfma_f32_16x16x32_bf16 v[164:167], a[68:71], v[52:55], v[164:167]
v_mfma_f32_16x16x32_bf16 v[168:171], a[72:75], v[52:55], v[168:171]
v_mfma_f32_16x16x32_bf16 v[172:175], a[76:79], v[52:55], v[172:175]
v_mfma_f32_16x16x32_bf16 v[176:179], a[80:83], v[52:55], v[176:179]
v_mfma_f32_16x16x32_bf16 v[180:183], a[84:87], v[52:55], v[180:183]
v_mfma_f32_16x16x32_bf16 v[184:187], a[88:91], v[52:55], v[184:187]
v_mfma_f32_16x16x32_bf16 v[188:191], a[92:95], v[52:55], v[188:191]
v_mfma_f32_16x16x32_bf16 v[112:115], v[124:127], v[52:55], v[112:115]
s_waitcnt lgkmcnt(0)
v_mfma_f32_16x16x32_bf16 v[16:19], a[0:3], a[32:35], v[64:67]
v_cvt_pk_bf16_f32 v59, v38, v39
v_mfma_f32_16x16x32_bf16 v[16:19], a[4:7], a[36:39], v[16:19]
v_mfma_f32_16x16x32_bf16 v[16:19], a[8:11], a[40:43], v[16:19]
v_mfma_f32_16x16x32_bf16 v[16:19], a[12:15], a[44:47], v[16:19]
buffer_load_dwordx4 a[208:211], v3, s[80:83], s99 offen offset:1024 sc1
v_mfma_f32_16x16x32_bf16 v[20:23], a[16:19], a[32:35], v[64:67]
v_mfma_f32_16x16x32_bf16 v[20:23], a[20:23], a[36:39], v[20:23]
v_mfma_f32_16x16x32_bf16 v[20:23], a[24:27], a[40:43], v[20:23]
v_mfma_f32_16x16x32_bf16 v[20:23], a[28:31], a[44:47], v[20:23]
buffer_load_dwordx4 a[212:215], v3, s[80:83], s99 offen offset:2048 sc1
v_mfma_f32_16x16x32_bf16 v[24:27], a[0:3], a[48:51], v[68:71]
v_mfma_f32_16x16x32_bf16 v[24:27], a[4:7], a[52:55], v[24:27]
v_exp_f32 v16, v16
v_mfma_f32_16x16x32_bf16 v[24:27], a[8:11], a[56:59], v[24:27]
v_exp_f32 v17, v17
v_mfma_f32_16x16x32_bf16 v[24:27], a[12:15], a[60:63], v[24:27]
buffer_load_dwordx4 a[216:219], v8, s[56:59], s98 offen offset:0 sc1
v_cvt_pk_bf16_f32 v48, v16, v17
v_mfma_f32_16x16x32_bf16 v[28:31], a[16:19], a[48:51], v[68:71]
v_exp_f32 v18, v18
v_mfma_f32_16x16x32_bf16 v[28:31], a[20:23], a[52:55], v[28:31]
v_exp_f32 v19, v19
v_mfma_f32_16x16x32_bf16 v[28:31], a[24:27], a[56:59], v[28:31]
v_exp_f32 v20, v20
v_mfma_f32_16x16x32_bf16 v[28:31], a[28:31], a[60:63], v[28:31]
v_exp_f32 v21, v21
v_mfma_f32_16x16x32_bf16 v[192:195], a[64:67], v[56:59], v[192:195]
v_exp_f32 v22, v22
v_mfma_f32_16x16x32_bf16 v[196:199], a[68:71], v[56:59], v[196:199]
buffer_load_dwordx4 a[220:223], v8, s[56:59], s98 offen offset:1024 sc1
v_cvt_pk_bf16_f32 v49, v18, v19
v_mfma_f32_16x16x32_bf16 v[200:203], a[72:75], v[56:59], v[200:203]
v_exp_f32 v23, v23
v_mfma_f32_16x16x32_bf16 v[204:207], a[76:79], v[56:59], v[204:207]
v_exp_f32 v24, v24
v_mfma_f32_16x16x32_bf16 v[208:211], a[80:83], v[56:59], v[208:211]
v_exp_f32 v25, v25
v_mfma_f32_16x16x32_bf16 v[212:215], a[84:87], v[56:59], v[212:215]
v_exp_f32 v26, v26
v_mfma_f32_16x16x32_bf16 v[216:219], a[88:91], v[56:59], v[216:219]
v_exp_f32 v27, v27
v_mfma_f32_16x16x32_bf16 v[220:223], a[92:95], v[56:59], v[220:223]
buffer_load_dwordx4 a[224:227], v8, s[56:59], s98 offen offset:2048 sc1
v_cvt_pk_bf16_f32 v50, v20, v21
v_mfma_f32_16x16x32_bf16 v[116:119], v[124:127], v[56:59], v[116:119]
v_exp_f32 v28, v28
v_exp_f32 v29, v29
ds_read_b64_tr_b16 a[64:65], v88 offset:49152
v_cvt_pk_bf16_f32 v51, v22, v23
ds_read_b64_tr_b16 a[66:67], v88 offset:53248
v_cvt_pk_bf16_f32 v52, v24, v25
ds_read_b64_tr_b16 a[68:69], v89 offset:49152
v_cvt_pk_bf16_f32 v53, v26, v27
ds_read_b64_tr_b16 a[70:71], v89 offset:53248
v_cvt_pk_bf16_f32 v54, v28, v29
ds_read_b64_tr_b16 a[72:73], v90 offset:49152
ds_read_b64_tr_b16 a[74:75], v90 offset:53248
ds_read_b64_tr_b16 a[76:77], v91 offset:49152
ds_read_b64_tr_b16 a[78:79], v91 offset:53248
buffer_load_dwordx4 a[228:231], v9, s[56:59], s98 offen offset:0 sc1
v_mfma_f32_16x16x32_bf16 v[32:35], a[0:3], a[96:99], v[72:75]
ds_read_b64_tr_b16 a[80:81], v92 offset:49152
v_mfma_f32_16x16x32_bf16 v[32:35], a[4:7], a[100:103], v[32:35]
ds_read_b64_tr_b16 a[82:83], v92 offset:53248
v_mfma_f32_16x16x32_bf16 v[32:35], a[8:11], a[104:107], v[32:35]
ds_read_b64_tr_b16 a[84:85], v93 offset:49152
v_mfma_f32_16x16x32_bf16 v[32:35], a[12:15], a[108:111], v[32:35]
ds_read_b64_tr_b16 a[86:87], v93 offset:53248
v_mfma_f32_16x16x32_bf16 v[36:39], a[16:19], a[96:99], v[72:75]
ds_read_b64_tr_b16 a[88:89], v94 offset:49152
buffer_load_dwordx4 a[232:235], v9, s[56:59], s98 offen offset:1024 sc1
v_mfma_f32_16x16x32_bf16 v[36:39], a[20:23], a[100:103], v[36:39]
ds_read_b64_tr_b16 a[90:91], v94 offset:53248
v_mfma_f32_16x16x32_bf16 v[36:39], a[24:27], a[104:107], v[36:39]
ds_read_b64_tr_b16 a[92:93], v95 offset:49152
v_mfma_f32_16x16x32_bf16 v[36:39], a[28:31], a[108:111], v[36:39]
ds_read_b64_tr_b16 a[94:95], v95 offset:53248
v_exp_f32 v30, v30
v_exp_f32 v31, v31
v_exp_f32 v32, v32
v_exp_f32 v33, v33
v_exp_f32 v34, v34
v_exp_f32 v35, v35
s_nop 0
v_exp_f32 v36, v36
s_waitcnt lgkmcnt(0)
v_exp_f32 v37, v37
v_mfma_f32_16x16x32_bf16 v[128:131], a[64:67], v[48:51], v[128:131]
ds_read_b128 a[0:3], v84 offset:57344
v_cvt_pk_bf16_f32 v55, v30, v31
v_mfma_f32_16x16x32_bf16 v[132:135], a[68:71], v[48:51], v[132:135]
ds_read_b128 a[4:7], v85 offset:57344
v_cvt_pk_bf16_f32 v56, v32, v33
v_mfma_f32_16x16x32_bf16 v[136:139], a[72:75], v[48:51], v[136:139]
ds_read_b128 a[8:11], v86 offset:57344
v_cvt_pk_bf16_f32 v57, v34, v35
v_mfma_f32_16x16x32_bf16 v[140:143], a[76:79], v[48:51], v[140:143]
ds_read_b128 a[12:15], v87 offset:57344
v_cvt_pk_bf16_f32 v58, v36, v37
v_mfma_f32_16x16x32_bf16 v[144:147], a[80:83], v[48:51], v[144:147]
ds_read_b128 a[16:19], v84 offset:61440
v_mfma_f32_16x16x32_bf16 v[148:151], a[84:87], v[48:51], v[148:151]
ds_read_b128 a[20:23], v85 offset:61440
buffer_load_dwordx4 a[236:239], v9, s[56:59], s98 offen offset:2048 sc1
v_mfma_f32_16x16x32_bf16 v[152:155], a[88:91], v[48:51], v[152:155]
ds_read_b128 a[24:27], v86 offset:61440
s_add_u32 s98, s98, 122880
s_add_u32 s99, s99, 36864
v_mfma_f32_16x16x32_bf16 v[156:159], a[92:95], v[48:51], v[156:159]
ds_read_b128 a[28:31], v87 offset:61440
v_mfma_f32_16x16x32_bf16 v[108:111], v[124:127], v[48:51], v[108:111]
v_exp_f32 v38, v38
v_mfma_f32_16x16x32_bf16 v[160:163], a[64:67], v[52:55], v[160:163]
v_exp_f32 v39, v39
v_mfma_f32_16x16x32_bf16 v[164:167], a[68:71], v[52:55], v[164:167]
v_mfma_f32_16x16x32_bf16 v[168:171], a[72:75], v[52:55], v[168:171]
v_mfma_f32_16x16x32_bf16 v[172:175], a[76:79], v[52:55], v[172:175]
v_mfma_f32_16x16x32_bf16 v[176:179], a[80:83], v[52:55], v[176:179]
v_mfma_f32_16x16x32_bf16 v[180:183], a[84:87], v[52:55], v[180:183]
v_mfma_f32_16x16x32_bf16 v[184:187], a[88:91], v[52:55], v[184:187]
v_mfma_f32_16x16x32_bf16 v[188:191], a[92:95], v[52:55], v[188:191]
v_mfma_f32_16x16x32_bf16 v[112:115], v[124:127], v[52:55], v[112:115]
s_waitcnt lgkmcnt(0)
v_mfma_f32_16x16x32_bf16 v[16:19], a[0:3], a[32:35], v[64:67]
v_cvt_pk_bf16_f32 v59, v38, v39
v_mfma_f32_16x16x32_bf16 v[16:19], a[4:7], a[36:39], v[16:19]
v_mfma_f32_16x16x32_bf16 v[16:19], a[8:11], a[40:43], v[16:19]
v_mfma_f32_16x16x32_bf16 v[16:19], a[12:15], a[44:47], v[16:19]
buffer_load_dwordx4 a[128:131], v2, s[80:83], s99 offen offset:0 sc1
v_mfma_f32_16x16x32_bf16 v[20:23], a[16:19], a[32:35], v[64:67]
v_mfma_f32_16x16x32_bf16 v[20:23], a[20:23], a[36:39], v[20:23]
v_mfma_f32_16x16x32_bf16 v[20:23], a[24:27], a[40:43], v[20:23]
v_mfma_f32_16x16x32_bf16 v[20:23], a[28:31], a[44:47], v[20:23]
buffer_load_dwordx4 a[132:135], v2, s[80:83], s99 offen offset:1024 sc1
v_mfma_f32_16x16x32_bf16 v[24:27], a[0:3], a[48:51], v[68:71]
v_mfma_f32_16x16x32_bf16 v[24:27], a[4:7], a[52:55], v[24:27]
v_exp_f32 v16, v16
v_mfma_f32_16x16x32_bf16 v[24:27], a[8:11], a[56:59], v[24:27]
v_exp_f32 v17, v17
v_mfma_f32_16x16x32_bf16 v[24:27], a[12:15], a[60:63], v[24:27]
buffer_load_dwordx4 a[136:139], v2, s[80:83], s99 offen offset:2048 sc1
v_cvt_pk_bf16_f32 v48, v16, v17
v_mfma_f32_16x16x32_bf16 v[28:31], a[16:19], a[48:51], v[68:71]
v_exp_f32 v18, v18
v_mfma_f32_16x16x32_bf16 v[28:31], a[20:23], a[52:55], v[28:31]
v_exp_f32 v19, v19
v_mfma_f32_16x16x32_bf16 v[28:31], a[24:27], a[56:59], v[28:31]
v_exp_f32 v20, v20
v_mfma_f32_16x16x32_bf16 v[28:31], a[28:31], a[60:63], v[28:31]
v_exp_f32 v21, v21
v_mfma_f32_16x16x32_bf16 v[192:195], a[64:67], v[56:59], v[192:195]
v_exp_f32 v22, v22
v_mfma_f32_16x16x32_bf16 v[196:199], a[68:71], v[56:59], v[196:199]
buffer_load_dwordx4 a[140:143], v3, s[80:83], s99 offen offset:0 sc1
v_cvt_pk_bf16_f32 v49, v18, v19
v_mfma_f32_16x16x32_bf16 v[200:203], a[72:75], v[56:59], v[200:203]
v_exp_f32 v23, v23
v_mfma_f32_16x16x32_bf16 v[204:207], a[76:79], v[56:59], v[204:207]
v_exp_f32 v24, v24
v_mfma_f32_16x16x32_bf16 v[208:211], a[80:83], v[56:59], v[208:211]
v_exp_f32 v25, v25
v_mfma_f32_16x16x32_bf16 v[212:215], a[84:87], v[56:59], v[212:215]
v_exp_f32 v26, v26
v_mfma_f32_16x16x32_bf16 v[216:219], a[88:91], v[56:59], v[216:219]
v_exp_f32 v27, v27
v_mfma_f32_16x16x32_bf16 v[220:223], a[92:95], v[56:59], v[220:223]
buffer_load_dwordx4 a[240:243], v3, s[80:83], s99 offen offset:1024 sc1
v_cvt_pk_bf16_f32 v50, v20, v21
v_mfma_f32_16x16x32_bf16 v[116:119], v[124:127], v[56:59], v[116:119]
v_exp_f32 v28, v28
v_exp_f32 v29, v29
ds_read_b64_tr_b16 a[64:65], v88 offset:57344
v_cvt_pk_bf16_f32 v51, v22, v23
ds_read_b64_tr_b16 a[66:67], v88 offset:61440
v_cvt_pk_bf16_f32 v52, v24, v25
ds_read_b64_tr_b16 a[68:69], v89 offset:57344
v_cvt_pk_bf16_f32 v53, v26, v27
ds_read_b64_tr_b16 a[70:71], v89 offset:61440
v_cvt_pk_bf16_f32 v54, v28, v29
ds_read_b64_tr_b16 a[72:73], v90 offset:57344
ds_read_b64_tr_b16 a[74:75], v90 offset:61440
ds_read_b64_tr_b16 a[76:77], v91 offset:57344
ds_read_b64_tr_b16 a[78:79], v91 offset:61440
buffer_load_dwordx4 a[244:247], v3, s[80:83], s99 offen offset:2048 sc1
v_mfma_f32_16x16x32_bf16 v[32:35], a[0:3], a[96:99], v[72:75]
ds_read_b64_tr_b16 a[80:81], v92 offset:57344
v_mfma_f32_16x16x32_bf16 v[32:35], a[4:7], a[100:103], v[32:35]
ds_read_b64_tr_b16 a[82:83], v92 offset:61440
v_mfma_f32_16x16x32_bf16 v[32:35], a[8:11], a[104:107], v[32:35]
ds_read_b64_tr_b16 a[84:85], v93 offset:57344
v_mfma_f32_16x16x32_bf16 v[32:35], a[12:15], a[108:111], v[32:35]
ds_read_b64_tr_b16 a[86:87], v93 offset:61440
v_mfma_f32_16x16x32_bf16 v[36:39], a[16:19], a[96:99], v[72:75]
ds_read_b64_tr_b16 a[88:89], v94 offset:57344
buffer_load_dwordx4 a[248:251], v8, s[56:59], s98 offen offset:0 sc1
v_mfma_f32_16x16x32_bf16 v[36:39], a[20:23], a[100:103], v[36:39]
ds_read_b64_tr_b16 a[90:91], v94 offset:61440
v_mfma_f32_16x16x32_bf16 v[36:39], a[24:27], a[104:107], v[36:39]
ds_read_b64_tr_b16 a[92:93], v95 offset:57344
v_mfma_f32_16x16x32_bf16 v[36:39], a[28:31], a[108:111], v[36:39]
ds_read_b64_tr_b16 a[94:95], v95 offset:61440
v_exp_f32 v30, v30
v_exp_f32 v31, v31
v_exp_f32 v32, v32
v_exp_f32 v33, v33
v_exp_f32 v34, v34
v_exp_f32 v35, v35
s_nop 0
v_exp_f32 v36, v36
s_waitcnt lgkmcnt(0)
v_exp_f32 v37, v37
v_mfma_f32_16x16x32_bf16 v[128:131], a[64:67], v[48:51], v[128:131]
v_cvt_pk_bf16_f32 v55, v30, v31
v_mfma_f32_16x16x32_bf16 v[132:135], a[68:71], v[48:51], v[132:135]
v_cvt_pk_bf16_f32 v56, v32, v33
v_mfma_f32_16x16x32_bf16 v[136:139], a[72:75], v[48:51], v[136:139]
v_cvt_pk_bf16_f32 v57, v34, v35
v_mfma_f32_16x16x32_bf16 v[140:143], a[76:79], v[48:51], v[140:143]
v_cvt_pk_bf16_f32 v58, v36, v37
v_mfma_f32_16x16x32_bf16 v[144:147], a[80:83], v[48:51], v[144:147]
v_mfma_f32_16x16x32_bf16 v[148:151], a[84:87], v[48:51], v[148:151]
buffer_load_dwordx4 a[252:255], v8, s[56:59], s98 offen offset:1024 sc1
v_mfma_f32_16x16x32_bf16 v[152:155], a[88:91], v[48:51], v[152:155]
v_mfma_f32_16x16x32_bf16 v[156:159], a[92:95], v[48:51], v[156:159]
v_mfma_f32_16x16x32_bf16 v[108:111], v[124:127], v[48:51], v[108:111]
v_exp_f32 v38, v38
v_mfma_f32_16x16x32_bf16 v[160:163], a[64:67], v[52:55], v[160:163]
v_exp_f32 v39, v39
v_mfma_f32_16x16x32_bf16 v[164:167], a[68:71], v[52:55], v[164:167]
v_mfma_f32_16x16x32_bf16 v[168:171], a[72:75], v[52:55], v[168:171]
v_mfma_f32_16x16x32_bf16 v[172:175], a[76:79], v[52:55], v[172:175]
v_mfma_f32_16x16x32_bf16 v[176:179], a[80:83], v[52:55], v[176:179]
v_mfma_f32_16x16x32_bf16 v[180:183], a[84:87], v[52:55], v[180:183]
v_mfma_f32_16x16x32_bf16 v[184:187], a[88:91], v[52:55], v[184:187]
v_mfma_f32_16x16x32_bf16 v[188:191], a[92:95], v[52:55], v[188:191]
v_mfma_f32_16x16x32_bf16 v[112:115], v[124:127], v[52:55], v[112:115]
v_cvt_pk_bf16_f32 v59, v38, v39
s_nop 1
v_mfma_f32_16x16x32_bf16 v[192:195], a[64:67], v[56:59], v[192:195]
buffer_load_dwordx4 a[0:3], v8, s[56:59], s98 offen offset:2048 sc1
v_cmp_ngt_f32 vcc, 1317011456, v108
v_rcp_f32 v80, v108
v_mfma_f32_16x16x32_bf16 v[196:199], a[68:71], v[56:59], v[196:199]
buffer_load_dwordx4 a[4:7], v9, s[56:59], s98 offen offset:0 sc1
s_nop 0
s_or_b32 s38, s38, vcc_lo
s_or_b32 s38, s38, vcc_hi
v_mfma_f32_16x16x32_bf16 v[200:203], a[72:75], v[56:59], v[200:203]
buffer_load_dwordx4 a[8:11], v9, s[56:59], s98 offen offset:1024 sc1
v_cmp_ngt_f32 vcc, 1317011456, v112
v_rcp_f32 v81, v112
v_mfma_f32_16x16x32_bf16 v[204:207], a[76:79], v[56:59], v[204:207]
buffer_load_dwordx4 a[12:15], v9, s[56:59], s98 offen offset:2048 sc1
s_add_u32 s98, s98, 122880
s_add_u32 s99, s99, 36864
s_or_b32 s38, s38, vcc_lo
s_or_b32 s38, s38, vcc_hi
v_mfma_f32_16x16x32_bf16 v[208:211], a[80:83], v[56:59], v[208:211]
buffer_load_dwordx4 a[16:19], v2, s[80:83], s99 offen offset:0 sc1
v_mul_f32 v128, v128, v80
v_mul_f32 v129, v129, v80
v_mfma_f32_16x16x32_bf16 v[212:215], a[84:87], v[56:59], v[212:215]
buffer_load_dwordx4 a[20:23], v2, s[80:83], s99 offen offset:1024 sc1
v_mul_f32 v130, v130, v80
v_mul_f32 v131, v131, v80
v_mfma_f32_16x16x32_bf16 v[216:219], a[88:91], v[56:59], v[216:219]
buffer_load_dwordx4 a[24:27], v2, s[80:83], s99 offen offset:2048 sc1
v_mul_f32 v132, v132, v80
v_mul_f32 v133, v133, v80
v_mfma_f32_16x16x32_bf16 v[220:223], a[92:95], v[56:59], v[220:223]
buffer_load_dwordx4 a[28:31], v3, s[80:83], s99 offen offset:0 sc1
v_mul_f32 v134, v134, v80
v_mul_f32 v135, v135, v80
v_mfma_f32_16x16x32_bf16 v[116:119], v[124:127], v[56:59], v[116:119]
buffer_load_dwordx4 a[32:35], v3, s[80:83], s99 offen offset:1024 sc1
v_cvt_pk_bf16_f32 v48, v128, v129
v_cvt_pk_bf16_f32 v49, v130, v131
buffer_load_dwordx4 a[36:39], v3, s[80:83], s99 offen offset:2048 sc1
v_cvt_pk_bf16_f32 v50, v132, v133
v_cvt_pk_bf16_f32 v51, v134, v135
s_add_u32 s46, s43, 0
buffer_store_dwordx4 v[48:51], v100, s[20:23], s46 offen offset:0 sc1
v_mul_f32 v136, v136, v80
v_mul_f32 v137, v137, v80
v_mul_f32 v138, v138, v80
v_mul_f32 v139, v139, v80
v_mul_f32 v140, v140, v80
v_mul_f32 v141, v141, v80
v_mul_f32 v142, v142, v80
v_mul_f32 v143, v143, v80
v_cvt_pk_bf16_f32 v52, v136, v137
v_cvt_pk_bf16_f32 v53, v138, v139
buffer_load_dwordx4 a[40:43], v8, s[56:59], s98 offen offset:0 sc1
v_cvt_pk_bf16_f32 v54, v140, v141
v_cvt_pk_bf16_f32 v55, v142, v143
s_add_u32 s46, s43, 122880
buffer_store_dwordx4 v[52:55], v100, s[20:23], s46 offen offset:0 sc1
v_mul_f32 v144, v144, v80
v_mul_f32 v145, v145, v80
v_mul_f32 v146, v146, v80
v_mul_f32 v147, v147, v80
v_mul_f32 v148, v148, v80
v_mul_f32 v149, v149, v80
v_mul_f32 v150, v150, v80
v_mul_f32 v151, v151, v80
v_cvt_pk_bf16_f32 v48, v144, v145
v_cvt_pk_bf16_f32 v49, v146, v147
buffer_load_dwordx4 a[44:47], v8, s[56:59], s98 offen offset:1024 sc1
v_cvt_pk_bf16_f32 v50, v148, v149
v_cvt_pk_bf16_f32 v51, v150, v151
s_add_u32 s46, s43, 245760
buffer_store_dwordx4 v[48:51], v100, s[20:23], s46 offen offset:0 sc1
v_mul_f32 v152, v152, v80
v_mul_f32 v153, v153, v80
v_mul_f32 v154, v154, v80
v_mul_f32 v155, v155, v80
v_mul_f32 v156, v156, v80
v_mul_f32 v157, v157, v80
v_mul_f32 v158, v158, v80
v_mul_f32 v159, v159, v80
v_cvt_pk_bf16_f32 v52, v152, v153
v_cvt_pk_bf16_f32 v53, v154, v155
buffer_load_dwordx4 a[48:51], v8, s[56:59], s98 offen offset:2048 sc1
v_cvt_pk_bf16_f32 v54, v156, v157
v_cvt_pk_bf16_f32 v55, v158, v159
s_add_u32 s46, s43, 368640
buffer_store_dwordx4 v[52:55], v100, s[20:23], s46 offen offset:0 sc1
v_pk_mul_f32 v[160:161], v[160:161], v[80:81] op_sel:[0,1] op_sel_hi:[1,1]
v_pk_mul_f32 v[162:163], v[162:163], v[80:81] op_sel:[0,1] op_sel_hi:[1,1]
v_cmp_ngt_f32 vcc, 1317011456, v116
v_pk_mul_f32 v[164:165], v[164:165], v[80:81] op_sel:[0,1] op_sel_hi:[1,1]
v_pk_mul_f32 v[166:167], v[166:167], v[80:81] op_sel:[0,1] op_sel_hi:[1,1]
v_rcp_f32 v82, v116
v_cvt_pk_bf16_f32 v48, v160, v161
v_cvt_pk_bf16_f32 v49, v162, v163
s_or_b32 s38, s38, vcc_lo
v_cvt_pk_bf16_f32 v50, v164, v165
buffer_load_dwordx4 a[52:55], v9, s[56:59], s98 offen offset:0 sc1
v_cvt_pk_bf16_f32 v51, v166, v167
s_or_b32 s38, s38, vcc_hi
s_add_u32 s46, s43, 0
buffer_store_dwordx4 v[48:51], v100, s[20:23], s46 offen offset:1024 sc1
v_pk_mul_f32 v[168:169], v[168:169], v[80:81] op_sel:[0,1] op_sel_hi:[1,1]
v_pk_mul_f32 v[170:171], v[170:171], v[80:81] op_sel:[0,1] op_sel_hi:[1,1]
v_pk_mul_f32 v[172:173], v[172:173], v[80:81] op_sel:[0,1] op_sel_hi:[1,1]
v_pk_mul_f32 v[174:175], v[174:175], v[80:81] op_sel:[0,1] op_sel_hi:[1,1]
v_cvt_pk_bf16_f32 v52, v168, v169
v_cvt_pk_bf16_f32 v53, v170, v171
v_cvt_pk_bf16_f32 v54, v172, v173
v_cvt_pk_bf16_f32 v55, v174, v175
s_add_u32 s46, s43, 122880
buffer_store_dwordx4 v[52:55], v100, s[20:23], s46 offen offset:1024 sc1
buffer_load_dwordx4 a[56:59], v9, s[56:59], s98 offen offset:1024 sc1
v_pk_mul_f32 v[176:177], v[176:177], v[80:81] op_sel:[0,1] op_sel_hi:[1,1]
v_pk_mul_f32 v[178:179], v[178:179], v[80:81] op_sel:[0,1] op_sel_hi:[1,1]
v_pk_mul_f32 v[180:181], v[180:181], v[80:81] op_sel:[0,1] op_sel_hi:[1,1]
v_pk_mul_f32 v[182:183], v[182:183], v[80:81] op_sel:[0,1] op_sel_hi:[1,1]
v_cvt_pk_bf16_f32 v48, v176, v177
v_cvt_pk_bf16_f32 v49, v178, v179
v_cvt_pk_bf16_f32 v50, v180, v181
v_cvt_pk_bf16_f32 v51, v182, v183
s_add_u32 s46, s43, 245760
buffer_store_dwordx4 v[48:51], v100, s[20:23], s46 offen offset:1024 sc1
v_pk_mul_f32 v[184:185], v[184:185], v[80:81] op_sel:[0,1] op_sel_hi:[1,1]
v_pk_mul_f32 v[186:187], v[186:187], v[80:81] op_sel:[0,1] op_sel_hi:[1,1]
v_pk_mul_f32 v[188:189], v[188:189], v[80:81] op_sel:[0,1] op_sel_hi:[1,1]
v_pk_mul_f32 v[190:191], v[190:191], v[80:81] op_sel:[0,1] op_sel_hi:[1,1]
buffer_load_dwordx4 a[60:63], v9, s[56:59], s98 offen offset:2048 sc1
s_add_u32 s98, s98, 614400
s_add_u32 s99, s99, 184320
v_cvt_pk_bf16_f32 v52, v184, v185
v_cvt_pk_bf16_f32 v53, v186, v187
v_cvt_pk_bf16_f32 v54, v188, v189
v_cvt_pk_bf16_f32 v55, v190, v191
s_add_u32 s46, s43, 368640
buffer_store_dwordx4 v[52:55], v100, s[20:23], s46 offen offset:1024 sc1
v_pk_mul_f32 v[192:193], v[192:193], v[82:83] op_sel:[0,0] op_sel_hi:[1,0]
v_pk_mul_f32 v[194:195], v[194:195], v[82:83] op_sel:[0,0] op_sel_hi:[1,0]
v_pk_mul_f32 v[196:197], v[196:197], v[82:83] op_sel:[0,0] op_sel_hi:[1,0]
v_pk_mul_f32 v[198:199], v[198:199], v[82:83] op_sel:[0,0] op_sel_hi:[1,0]
v_cvt_pk_bf16_f32 v48, v192, v193
v_cvt_pk_bf16_f32 v49, v194, v195
v_cvt_pk_bf16_f32 v50, v196, v197
v_cvt_pk_bf16_f32 v51, v198, v199
s_add_u32 s46, s43, 0
buffer_store_dwordx4 v[48:51], v100, s[20:23], s46 offen offset:2048 sc1
v_pk_mul_f32 v[200:201], v[200:201], v[82:83] op_sel:[0,0] op_sel_hi:[1,0]
v_pk_mul_f32 v[202:203], v[202:203], v[82:83] op_sel:[0,0] op_sel_hi:[1,0]
v_pk_mul_f32 v[204:205], v[204:205], v[82:83] op_sel:[0,0] op_sel_hi:[1,0]
v_pk_mul_f32 v[206:207], v[206:207], v[82:83] op_sel:[0,0] op_sel_hi:[1,0]
v_cvt_pk_bf16_f32 v52, v200, v201
v_cvt_pk_bf16_f32 v53, v202, v203
v_cvt_pk_bf16_f32 v54, v204, v205
v_cvt_pk_bf16_f32 v55, v206, v207
s_add_u32 s46, s43, 122880
buffer_store_dwordx4 v[52:55], v100, s[20:23], s46 offen offset:2048 sc1
v_pk_mul_f32 v[208:209], v[208:209], v[82:83] op_sel:[0,0] op_sel_hi:[1,0]
v_pk_mul_f32 v[210:211], v[210:211], v[82:83] op_sel:[0,0] op_sel_hi:[1,0]
v_pk_mul_f32 v[212:213], v[212:213], v[82:83] op_sel:[0,0] op_sel_hi:[1,0]
v_pk_mul_f32 v[214:215], v[214:215], v[82:83] op_sel:[0,0] op_sel_hi:[1,0]
v_cvt_pk_bf16_f32 v48, v208, v209
v_cvt_pk_bf16_f32 v49, v210, v211
v_cvt_pk_bf16_f32 v50, v212, v213
v_cvt_pk_bf16_f32 v51, v214, v215
s_add_u32 s46, s43, 245760
buffer_store_dwordx4 v[48:51], v100, s[20:23], s46 offen offset:2048 sc1
v_pk_mul_f32 v[216:217], v[216:217], v[82:83] op_sel:[0,0] op_sel_hi:[1,0]
v_pk_mul_f32 v[218:219], v[218:219], v[82:83] op_sel:[0,0] op_sel_hi:[1,0]
v_pk_mul_f32 v[220:221], v[220:221], v[82:83] op_sel:[0,0] op_sel_hi:[1,0]
v_pk_mul_f32 v[222:223], v[222:223], v[82:83] op_sel:[0,0] op_sel_hi:[1,0]
v_cvt_pk_bf16_f32 v52, v216, v217
v_cvt_pk_bf16_f32 v53, v218, v219
v_cvt_pk_bf16_f32 v54, v220, v221
v_cvt_pk_bf16_f32 v55, v222, v223
s_add_u32 s46, s43, 368640
buffer_store_dwordx4 v[52:55], v100, s[20:23], s46 offen offset:2048 sc1
v_mov_b32 v4, s38
s_lshl_b32 s46, s32, 2
s_add_u32 s46, s46, 138240
v_mov_b32 v5, s46
ds_write_b32 v5, v4
L_p2s3:
s_waitcnt vmcnt(48)
v_mfma_f32_16x16x32_bf16 v[112:115], a[144:147], a[168:171], 0
v_mfma_f32_16x16x32_bf16 v[116:119], a[148:151], a[168:171], 0
v_mfma_f32_16x16x32_bf16 v[120:123], a[152:155], a[168:171], 0
v_mfma_f32_16x16x32_bf16 v[124:127], a[156:159], a[168:171], 0
v_mfma_f32_16x16x32_bf16 v[128:131], a[160:163], a[168:171], 0
v_mfma_f32_16x16x32_bf16 v[132:135], a[164:167], a[168:171], 0
buffer_load_dwordx4 a[168:171], v8, s[56:59], s98 offen offset:0 sc1
v_mfma_f32_16x16x32_bf16 v[136:139], a[144:147], a[172:175], 0
v_mfma_f32_16x16x32_bf16 v[140:143], a[148:151], a[172:175], 0
v_mfma_f32_16x16x32_bf16 v[144:147], a[152:155], a[172:175], 0
v_mfma_f32_16x16x32_bf16 v[148:151], a[156:159], a[172:175], 0
v_mfma_f32_16x16x32_bf16 v[152:155], a[160:163], a[172:175], 0
v_mfma_f32_16x16x32_bf16 v[156:159], a[164:167], a[172:175], 0
buffer_load_dwordx4 a[172:175], v8, s[56:59], s98 offen offset:1024 sc1
v_mfma_f32_16x16x32_bf16 v[160:163], a[144:147], a[176:179], 0
v_mfma_f32_16x16x32_bf16 v[164:167], a[148:151], a[176:179], 0
v_mfma_f32_16x16x32_bf16 v[168:171], a[152:155], a[176:179], 0
v_mfma_f32_16x16x32_bf16 v[172:175], a[156:159], a[176:179], 0
v_mfma_f32_16x16x32_bf16 v[176:179], a[160:163], a[176:179], 0
v_mfma_f32_16x16x32_bf16 v[180:183], a[164:167], a[176:179], 0
buffer_load_dwordx4 a[176:179], v8, s[56:59], s98 offen offset:2048 sc1
v_mfma_f32_16x16x32_bf16 v[184:187], a[144:147], a[180:183], 0
v_mfma_f32_16x16x32_bf16 v[188:191], a[148:151], a[180:183], 0
v_mfma_f32_16x16x32_bf16 v[192:195], a[152:155], a[180:183], 0
v_mfma_f32_16x16x32_bf16 v[196:199], a[156:159], a[180:183], 0
v_mfma_f32_16x16x32_bf16 v[200:203], a[160:163], a[180:183], 0
v_mfma_f32_16x16x32_bf16 v[204:207], a[164:167], a[180:183], 0
buffer_load_dwordx4 a[180:183], v9, s[56:59], s98 offen offset:0 sc1
v_mfma_f32_16x16x32_bf16 v[208:211], a[144:147], a[184:187], 0
v_mfma_f32_16x16x32_bf16 v[212:215], a[148:151], a[184:187], 0
v_mfma_f32_16x16x32_bf16 v[216:219], a[152:155], a[184:187], 0
v_mfma_f32_16x16x32_bf16 v[220:223], a[156:159], a[184:187], 0
v_mfma_f32_16x16x32_bf16 v[224:227], a[160:163], a[184:187], 0
v_mfma_f32_16x16x32_bf16 v[228:231], a[164:167], a[184:187], 0
buffer_load_dwordx4 a[184:187], v9, s[56:59], s98 offen offset:1024 sc1
v_mfma_f32_16x16x32_bf16 v[232:235], a[144:147], a[188:191], 0
buffer_load_dwordx4 a[144:147], v2, s[80:83], s99 offen offset:0 sc1
v_mfma_f32_16x16x32_bf16 v[236:239], a[148:151], a[188:191], 0
buffer_load_dwordx4 a[148:151], v2, s[80:83], s99 offen offset:1024 sc1
v_mfma_f32_16x16x32_bf16 v[240:243], a[152:155], a[188:191], 0
buffer_load_dwordx4 a[152:155], v2, s[80:83], s99 offen offset:2048 sc1
v_mfma_f32_16x16x32_bf16 v[244:247], a[156:159], a[188:191], 0
buffer_load_dwordx4 a[156:159], v3, s[80:83], s99 offen offset:0 sc1
v_mfma_f32_16x16x32_bf16 v[248:251], a[160:163], a[188:191], 0
buffer_load_dwordx4 a[160:163], v3, s[80:83], s99 offen offset:1024 sc1
v_mfma_f32_16x16x32_bf16 v[252:255], a[164:167], a[188:191], 0
buffer_load_dwordx4 a[188:191], v9, s[56:59], s98 offen offset:2048 sc1
buffer_load_dwordx4 a[164:167], v3, s[80:83], s99 offen offset:2048 sc1
s_add_u32 s98, s98, 122880
s_add_u32 s99, s99, 36864
s_waitcnt vmcnt(48)
v_mfma_f32_16x16x32_bf16 v[112:115], a[192:195], a[216:219], v[112:115]
v_mfma_f32_16x16x32_bf16 v[116:119], a[196:199], a[216:219], v[116:119]
v_mfma_f32_16x16x32_bf16 v[120:123], a[200:203], a[216:219], v[120:123]
v_mfma_f32_16x16x32_bf16 v[124:127], a[204:207], a[216:219], v[124:127]
v_mfma_f32_16x16x32_bf16 v[128:131], a[208:211], a[216:219], v[128:131]
v_mfma_f32_16x16x32_bf16 v[132:135], a[212:215], a[216:219], v[132:135]
buffer_load_dwordx4 a[216:219], v8, s[56:59], s98 offen offset:0 sc1
v_mfma_f32_16x16x32_bf16 v[136:139], a[192:195], a[220:223], v[136:139]
v_mfma_f32_16x16x32_bf16 v[140:143], a[196:199], a[220:223], v[140:143]
v_mfma_f32_16x16x32_bf16 v[144:147], a[200:203], a[220:223], v[144:147]
v_mfma_f32_16x16x32_bf16 v[148:151], a[204:207], a[220:223], v[148:151]
v_mfma_f32_16x16x32_bf16 v[152:155], a[208:211], a[220:223], v[152:155]
v_mfma_f32_16x16x32_bf16 v[156:159], a[212:215], a[220:223], v[156:159]
buffer_load_dwordx4 a[220:223], v8, s[56:59], s98 offen offset:1024 sc1
v_mfma_f32_16x16x32_bf16 v[160:163], a[192:195], a[224:227], v[160:163]
v_mfma_f32_16x16x32_bf16 v[164:167], a[196:199], a[224:227], v[164:167]
v_mfma_f32_16x16x32_bf16 v[168:171], a[200:203], a[224:227], v[168:171]
v_mfma_f32_16x16x32_bf16 v[172:175], a[204:207], a[224:227], v[172:175]
v_mfma_f32_16x16x32_bf16 v[176:179], a[208:211], a[224:227], v[176:179]
v_mfma_f32_16x16x32_bf16 v[180:183], a[212:215], a[224:227], v[180:183]
buffer_load_dwordx4 a[224:227], v8, s[56:59], s98 offen offset:2048 sc1
v_mfma_f32_16x16x32_bf16 v[184:187], a[192:195], a[228:231], v[184:187]
v_mfma_f32_16x16x32_bf16 v[188:191], a[196:199], a[228:231], v[188:191]
v_mfma_f32_16x16x32_bf16 v[192:195], a[200:203], a[228:231], v[192:195]
v_mfma_f32_16x16x32_bf16 v[196:199], a[204:207], a[228:231], v[196:199]
v_mfma_f32_16x16x32_bf16 v[200:203], a[208:211], a[228:231], v[200:203]
v_mfma_f32_16x16x32_bf16 v[204:207], a[212:215], a[228:231], v[204:207]
buffer_load_dwordx4 a[228:231], v9, s[56:59], s98 offen offset:0 sc1
v_mfma_f32_16x16x32_bf16 v[208:211], a[192:195], a[232:235], v[208:211]
v_mfma_f32_16x16x32_bf16 v[212:215], a[196:199], a[232:235], v[212:215]
v_mfma_f32_16x16x32_bf16 v[216:219], a[200:203], a[232:235], v[216:219]
v_mfma_f32_16x16x32_bf16 v[220:223], a[204:207], a[232:235], v[220:223]
v_mfma_f32_16x16x32_bf16 v[224:227], a[208:211], a[232:235], v[224:227]
v_mfma_f32_16x16x32_bf16 v[228:231], a[212:215], a[232:235], v[228:231]
buffer_load_dwordx4 a[232:235], v9, s[56:59], s98 offen offset:1024 sc1
v_mfma_f32_16x16x32_bf16 v[232:235], a[192:195], a[236:239], v[232:235]
buffer_load_dwordx4 a[192:195], v2, s[80:83], s99 offen offset:0 sc1
v_mfma_f32_16x16x32_bf16 v[236:239], a[196:199], a[236:239], v[236:239]
buffer_load_dwordx4 a[196:199], v2, s[80:83], s99 offen offset:1024 sc1
v_mfma_f32_16x16x32_bf16 v[240:243], a[200:203], a[236:239], v[240:243]
buffer_load_dwordx4 a[200:203], v2, s[80:83], s99 offen offset:2048 sc1
v_mfma_f32_16x16x32_bf16 v[244:247], a[204:207], a[236:239], v[244:247]
buffer_load_dwordx4 a[204:207], v3, s[80:83], s99 offen offset:0 sc1
v_mfma_f32_16x16x32_bf16 v[248:251], a[208:211], a[236:239], v[248:251]
buffer_load_dwordx4 a[208:211], v3, s[80:83], s99 offen offset:1024 sc1
v_mfma_f32_16x16x32_bf16 v[252:255], a[212:215], a[236:239], v[252:255]
buffer_load_dwordx4 a[236:239], v9, s[56:59], s98 offen offset:2048 sc1
buffer_load_dwordx4 a[212:215], v3, s[80:83], s99 offen offset:2048 sc1
s_add_u32 s98, s98, 122880
s_add_u32 s99, s99, 36864
s_waitcnt vmcnt(48)
v_mfma_f32_16x16x32_bf16 v[112:115], a[128:131], a[248:251], v[112:115]
v_mfma_f32_16x16x32_bf16 v[116:119], a[132:135], a[248:251], v[116:119]
v_mfma_f32_16x16x32_bf16 v[120:123], a[136:139], a[248:251], v[120:123]
v_mfma_f32_16x16x32_bf16 v[124:127], a[140:143], a[248:251], v[124:127]
v_mfma_f32_16x16x32_bf16 v[128:131], a[240:243], a[248:251], v[128:131]
v_mfma_f32_16x16x32_bf16 v[132:135], a[244:247], a[248:251], v[132:135]
buffer_load_dwordx4 a[248:251], v8, s[56:59], s98 offen offset:0 sc1
v_mfma_f32_16x16x32_bf16 v[136:139], a[128:131], a[252:255], v[136:139]
v_mfma_f32_16x16x32_bf16 v[140:143], a[132:135], a[252:255], v[140:143]
v_mfma_f32_16x16x32_bf16 v[144:147], a[136:139], a[252:255], v[144:147]
v_mfma_f32_16x16x32_bf16 v[148:151], a[140:143], a[252:255], v[148:151]
v_mfma_f32_16x16x32_bf16 v[152:155], a[240:243], a[252:255], v[152:155]
v_mfma_f32_16x16x32_bf16 v[156:159], a[244:247], a[252:255], v[156:159]
buffer_load_dwordx4 a[252:255], v8, s[56:59], s98 offen offset:1024 sc1
v_mfma_f32_16x16x32_bf16 v[160:163], a[128:131], a[0:3], v[160:163]
v_mfma_f32_16x16x32_bf16 v[164:167], a[132:135], a[0:3], v[164:167]
v_mfma_f32_16x16x32_bf16 v[168:171], a[136:139], a[0:3], v[168:171]
v_mfma_f32_16x16x32_bf16 v[172:175], a[140:143], a[0:3], v[172:175]
v_mfma_f32_16x16x32_bf16 v[176:179], a[240:243], a[0:3], v[176:179]
v_mfma_f32_16x16x32_bf16 v[180:183], a[244:247], a[0:3], v[180:183]
buffer_load_dwordx4 a[0:3], v8, s[56:59], s98 offen offset:2048 sc1
v_mfma_f32_16x16x32_bf16 v[184:187], a[128:131], a[4:7], v[184:187]
v_mfma_f32_16x16x32_bf16 v[188:191], a[132:135], a[4:7], v[188:191]
v_mfma_f32_16x16x32_bf16 v[192:195], a[136:139], a[4:7], v[192:195]
v_mfma_f32_16x16x32_bf16 v[196:199], a[140:143], a[4:7], v[196:199]
v_mfma_f32_16x16x32_bf16 v[200:203], a[240:243], a[4:7], v[200:203]
v_mfma_f32_16x16x32_bf16 v[204:207], a[244:247], a[4:7], v[204:207]
buffer_load_dwordx4 a[4:7], v9, s[56:59], s98 offen offset:0 sc1
v_mfma_f32_16x16x32_bf16 v[208:211], a[128:131], a[8:11], v[208:211]
v_mfma_f32_16x16x32_bf16 v[212:215], a[132:135], a[8:11], v[212:215]
v_mfma_f32_16x16x32_bf16 v[216:219], a[136:139], a[8:11], v[216:219]
v_mfma_f32_16x16x32_bf16 v[220:223], a[140:143], a[8:11], v[220:223]
v_mfma_f32_16x16x32_bf16 v[224:227], a[240:243], a[8:11], v[224:227]
v_mfma_f32_16x16x32_bf16 v[228:231], a[244:247], a[8:11], v[228:231]
buffer_load_dwordx4 a[8:11], v9, s[56:59], s98 offen offset:1024 sc1
v_mfma_f32_16x16x32_bf16 v[232:235], a[128:131], a[12:15], v[232:235]
buffer_load_dwordx4 a[128:131], v2, s[80:83], s99 offen offset:0 sc1
v_mfma_f32_16x16x32_bf16 v[236:239], a[132:135], a[12:15], v[236:239]
buffer_load_dwordx4 a[132:135], v2, s[80:83], s99 offen offset:1024 sc1
v_mfma_f32_16x16x32_bf16 v[240:243], a[136:139], a[12:15], v[240:243]
buffer_load_dwordx4 a[136:139], v2, s[80:83], s99 offen offset:2048 sc1
v_mfma_f32_16x16x32_bf16 v[244:247], a[140:143], a[12:15], v[244:247]
buffer_load_dwordx4 a[140:143], v3, s[80:83], s99 offen offset:0 sc1
v_mfma_f32_16x16x32_bf16 v[248:251], a[240:243], a[12:15], v[248:251]
buffer_load_dwordx4 a[240:243], v3, s[80:83], s99 offen offset:1024 sc1
v_mfma_f32_16x16x32_bf16 v[252:255], a[244:247], a[12:15], v[252:255]
buffer_load_dwordx4 a[12:15], v9, s[56:59], s98 offen offset:2048 sc1
buffer_load_dwordx4 a[244:247], v3, s[80:83], s99 offen offset:2048 sc1
s_add_u32 s98, s98, 122880
s_add_u32 s99, s99, 36864
s_waitcnt vmcnt(41)
v_mfma_f32_16x16x32_bf16 v[112:115], a[16:19], a[40:43], v[112:115]
v_mfma_f32_16x16x32_bf16 v[116:119], a[20:23], a[40:43], v[116:119]
v_mfma_f32_16x16x32_bf16 v[120:123], a[24:27], a[40:43], v[120:123]
v_mfma_f32_16x16x32_bf16 v[124:127], a[28:31], a[40:43], v[124:127]
v_mfma_f32_16x16x32_bf16 v[128:131], a[32:35], a[40:43], v[128:131]
v_mfma_f32_16x16x32_bf16 v[132:135], a[36:39], a[40:43], v[132:135]
buffer_load_dwordx4 a[40:43], v8, s[56:59], s98 offen offset:0 sc1
v_mfma_f32_16x16x32_bf16 v[136:139], a[16:19], a[44:47], v[136:139]
v_mfma_f32_16x16x32_bf16 v[140:143], a[20:23], a[44:47], v[140:143]
v_mfma_f32_16x16x32_bf16 v[144:147], a[24:27], a[44:47], v[144:147]
v_mfma_f32_16x16x32_bf16 v[148:151], a[28:31], a[44:47], v[148:151]
v_mfma_f32_16x16x32_bf16 v[152:155], a[32:35], a[44:47], v[152:155]
v_mfma_f32_16x16x32_bf16 v[156:159], a[36:39], a[44:47], v[156:159]
buffer_load_dwordx4 a[44:47], v8, s[56:59], s98 offen offset:1024 sc1
v_mfma_f32_16x16x32_bf16 v[160:163], a[16:19], a[48:51], v[160:163]
v_mfma_f32_16x16x32_bf16 v[164:167], a[20:23], a[48:51], v[164:167]
v_mfma_f32_16x16x32_bf16 v[168:171], a[24:27], a[48:51], v[168:171]
v_mfma_f32_16x16x32_bf16 v[172:175], a[28:31], a[48:51], v[172:175]
v_mfma_f32_16x16x32_bf16 v[176:179], a[32:35], a[48:51], v[176:179]
v_mfma_f32_16x16x32_bf16 v[180:183], a[36:39], a[48:51], v[180:183]
buffer_load_dwordx4 a[48:51], v8, s[56:59], s98 offen offset:2048 sc1
v_mfma_f32_16x16x32_bf16 v[184:187], a[16:19], a[52:55], v[184:187]
v_mfma_f32_16x16x32_bf16 v[188:191], a[20:23], a[52:55], v[188:191]
v_mfma_f32_16x16x32_bf16 v[192:195], a[24:27], a[52:55], v[192:195]
v_mfma_f32_16x16x32_bf16 v[196:199], a[28:31], a[52:55], v[196:199]
v_mfma_f32_16x16x32_bf16 v[200:203], a[32:35], a[52:55], v[200:203]
v_mfma_f32_16x16x32_bf16 v[204:207], a[36:39], a[52:55], v[204:207]
buffer_load_dwordx4 a[52:55], v9, s[56:59], s98 offen offset:0 sc1
v_mfma_f32_16x16x32_bf16 v[208:211], a[16:19], a[56:59], v[208:211]
v_mfma_f32_16x16x32_bf16 v[212:215], a[20:23], a[56:59], v[212:215]
v_mfma_f32_16x16x32_bf16 v[216:219], a[24:27], a[56:59], v[216:219]
v_mfma_f32_16x16x32_bf16 v[220:223], a[28:31], a[56:59], v[220:223]
v_mfma_f32_16x16x32_bf16 v[224:227], a[32:35], a[56:59], v[224:227]
v_mfma_f32_16x16x32_bf16 v[228:231], a[36:39], a[56:59], v[228:231]
buffer_load_dwordx4 a[56:59], v9, s[56:59], s98 offen offset:1024 sc1
v_mfma_f32_16x16x32_bf16 v[232:235], a[16:19], a[60:63], v[232:235]
buffer_load_dwordx4 a[16:19], v2, s[80:83], s99 offen offset:0 sc1
v_mfma_f32_16x16x32_bf16 v[236:239], a[20:23], a[60:63], v[236:239]
buffer_load_dwordx4 a[20:23], v2, s[80:83], s99 offen offset:1024 sc1
v_mfma_f32_16x16x32_bf16 v[240:243], a[24:27], a[60:63], v[240:243]
buffer_load_dwordx4 a[24:27], v2, s[80:83], s99 offen offset:2048 sc1
v_mfma_f32_16x16x32_bf16 v[244:247], a[28:31], a[60:63], v[244:247]
buffer_load_dwordx4 a[28:31], v3, s[80:83], s99 offen offset:0 sc1
v_mfma_f32_16x16x32_bf16 v[248:251], a[32:35], a[60:63], v[248:251]
buffer_load_dwordx4 a[32:35], v3, s[80:83], s99 offen offset:1024 sc1
v_mfma_f32_16x16x32_bf16 v[252:255], a[36:39], a[60:63], v[252:255]
buffer_load_dwordx4 a[60:63], v9, s[56:59], s98 offen offset:2048 sc1
buffer_load_dwordx4 a[36:39], v3, s[80:83], s99 offen offset:2048 sc1
s_add_u32 s98, s98, 614400
s_add_u32 s99, s99, 184320
s_waitcnt vmcnt(48) lgkmcnt(0)
s_branch L_vote
L_espin3:
s_mov_b32 s79, 1
s_mov_b32 s58, 0
s_mov_b32 s82, 0
s_branch L_eok3
L_sig:
v_mov_b32 v4, 138240
ds_read_b128 v[4:7], v4
s_waitcnt lgkmcnt(0)
v_or_b32 v4, v4, v5
v_or3_b32 v4, v4, v6, v7
s_nop 0
v_readfirstlane_b32 s46, v4
s_mov_b64 exec, 1
s_cmp_lg_u32 s37, 0
s_nop 1
s_cselect_b32 s46, 0, s46
s_cbranch_scc1 L_sig1
buffer_atomic_add v104, off, s[48:51], s61 sc1
L_sig1:
s_or_b32 s46, s46, s78
s_cbranch_scc1 L_sig2
s_add_u32 s46, s60, 16384
s_mov_b32 s78, 1
buffer_atomic_add v104, off, s[48:51], s46 sc1
L_sig2:
s_mov_b64 exec, -1
s_branch L_nosig
L_hspin:
s_mov_b32 s35, 0
L_hsp:
s_sleep 8
buffer_load_dword v106, off, s[52:55], 0 sc1
s_waitcnt vmcnt(0)
v_readfirstlane_b32 s46, v106
s_add_u32 s35, s35, 1
s_lshr_b32 s47, s35, 17
s_nop 1
s_or_b32 s46, s46, s47
s_cmp_eq_u32 s46, 0
s_cbranch_scc1 L_hsp
s_branch L_hsok
L_fs1_3:
s_sleep 1
ds_read_b128 v[80:83], v101
s_waitcnt lgkmcnt(0)
v_min3_u32 v80, v80, v81, v82
v_min_u32 v80, v80, v83
v_cmp_gt_u32 vcc, s39, v80
s_cbranch_vccnz L_fs1_3
s_branch L_fr1_3
L_fs3_3:
s_sleep 1
ds_read_b128 v[80:83], v101
s_waitcnt lgkmcnt(0)
v_min3_u32 v80, v80, v81, v82
v_min_u32 v80, v80, v83
v_cmp_gt_u32 vcc, s39, v80
s_cbranch_vccnz L_fs3_3
s_branch L_fr3_3
L_fs5_3:
s_sleep 1
ds_read_b128 v[80:83], v101
s_waitcnt lgkmcnt(0)
v_min3_u32 v80, v80, v81, v82
v_min_u32 v80, v80, v83
v_cmp_gt_u32 vcc, s39, v80
s_cbranch_vccnz L_fs5_3
s_branch L_fr5_3
L_fs7_3:
s_sleep 1
ds_read_b128 v[80:83], v101
s_waitcnt lgkmcnt(0)
v_min3_u32 v80, v80, v81, v82
v_min_u32 v80, v80, v83
v_cmp_gt_u32 vcc, s39, v80
s_cbranch_vccnz L_fs7_3
s_branch L_fr7_3
L_fs9_3:
s_sleep 1
ds_read_b128 v[80:83], v101
s_waitcnt lgkmcnt(0)
v_min3_u32 v80, v80, v81, v82
v_min_u32 v80, v80, v83
v_cmp_gt_u32 vcc, s39, v80
s_cbranch_vccnz L_fs9_3
s_branch L_fr9_3
L_fs11_3:
s_sleep 1
ds_read_b128 v[80:83], v101
s_waitcnt lgkmcnt(0)
v_min3_u32 v80, v80, v81, v82
v_min_u32 v80, v80, v83
v_cmp_gt_u32 vcc, s39, v80
s_cbranch_vccnz L_fs11_3
s_branch L_fr11_3
L_fs13_3:
s_sleep 1
ds_read_b128 v[80:83], v101
s_waitcnt lgkmcnt(0)
v_min3_u32 v80, v80, v81, v82
v_min_u32 v80, v80, v83
v_cmp_gt_u32 vcc, s39, v80
s_cbranch_vccnz L_fs13_3
s_branch L_fr13_3
L_fs15_3:
s_sleep 1
ds_read_b128 v[80:83], v101
s_waitcnt lgkmcnt(0)
v_min3_u32 v80, v80, v81, v82
v_min_u32 v80, v80, v83
v_cmp_gt_u32 vcc, s39, v80
s_cbranch_vccnz L_fs15_3
s_branch L_fr15_3
L_fs33_3:
s_sleep 1
ds_read_b128 v[80:83], v101
s_waitcnt lgkmcnt(0)
v_min3_u32 v80, v80, v81, v82
v_min_u32 v80, v80, v83
v_cmp_gt_u32 vcc, s39, v80
s_cbranch_vccnz L_fs33_3
s_branch L_fr33_3
L_fs35_3:
s_sleep 1
ds_read_b128 v[80:83], v101
s_waitcnt lgkmcnt(0)
v_min3_u32 v80, v80, v81, v82
v_min_u32 v80, v80, v83
v_cmp_gt_u32 vcc, s39, v80
s_cbranch_vccnz L_fs35_3
s_branch L_fr35_3
L_fs37_3:
s_sleep 1
ds_read_b128 v[80:83], v101
s_waitcnt lgkmcnt(0)
v_min3_u32 v80, v80, v81, v82
v_min_u32 v80, v80, v83
v_cmp_gt_u32 vcc, s39, v80
s_cbranch_vccnz L_fs37_3
s_branch L_fr37_3
L_fs39_3:
s_sleep 1
ds_read_b128 v[80:83], v101
s_waitcnt lgkmcnt(0)
v_min3_u32 v80, v80, v81, v82
v_min_u32 v80, v80, v83
v_cmp_gt_u32 vcc, s39, v80
s_cbranch_vccnz L_fs39_3
s_branch L_fr39_3
L_fs57_3:
s_sleep 1
ds_read_b128 v[80:83], v101
s_waitcnt lgkmcnt(0)
v_min3_u32 v80, v80, v81, v82
v_min_u32 v80, v80, v83
v_cmp_gt_u32 vcc, s39, v80
s_cbranch_vccnz L_fs57_3
s_branch L_fr57_3
L_fs59_3:
s_sleep 1
ds_read_b128 v[80:83], v101
s_waitcnt lgkmcnt(0)
v_min3_u32 v80, v80, v81, v82
v_min_u32 v80, v80, v83
v_cmp_gt_u32 vcc, s39, v80
s_cbranch_vccnz L_fs59_3
s_branch L_fr59_3
L_fs61_3:
s_sleep 1
ds_read_b128 v[80:83], v101
s_waitcnt lgkmcnt(0)
v_min3_u32 v80, v80, v81, v82
v_min_u32 v80, v80, v83
v_cmp_gt_u32 vcc, s39, v80
s_cbranch_vccnz L_fs61_3
s_branch L_fr61_3
L_maxpass3:
v_mov_b32 v116, 0xff800000
v_mov_b32 v117, 0xff800000
v_mov_b32 v118, 0xff800000
v_add_u32 v120, 147456, v84
v_add_u32 v121, 147456, v85
v_add_u32 v122, 147456, v86
v_add_u32 v123, 147456, v87
s_lshl_b32 s46, s36, 18
s_mov_b32 s35, 0
L_mp3:
s_barrier
s_add_u32 m0, s69, 147456
s_nop 0
buffer_load_dwordx4 v96, s[12:15], s46 offen offset:0 lds
buffer_load_dwordx4 v97, s[12:15], s46 offen offset:1024 lds
s_waitcnt vmcnt(0)
s_barrier
ds_read_b128 a[64:67], v120 offset:0
ds_read_b128 a[68:71], v121 offset:0
ds_read_b128 a[72:75], v122 offset:0
ds_read_b128 a[76:79], v123 offset:0
ds_read_b128 a[80:83], v120 offset:4096
ds_read_b128 a[84:87], v121 offset:4096
ds_read_b128 a[88:91], v122 offset:4096
ds_read_b128 a[92:95], v123 offset:4096
s_waitcnt lgkmcnt(0)
v_mfma_f32_16x16x32_bf16 v[16:19], a[64:67], a[32:35], 0
v_mfma_f32_16x16x32_bf16 v[16:19], a[68:71], a[36:39], v[16:19]
v_mfma_f32_16x16x32_bf16 v[16:19], a[72:75], a[40:43], v[16:19]
v_mfma_f32_16x16x32_bf16 v[16:19], a[76:79], a[44:47], v[16:19]
v_mfma_f32_16x16x32_bf16 v[20:23], a[80:83], a[32:35], 0
v_mfma_f32_16x16x32_bf16 v[20:23], a[84:87], a[36:39], v[20:23]
v_mfma_f32_16x16x32_bf16 v[20:23], a[88:91], a[40:43], v[20:23]
v_mfma_f32_16x16x32_bf16 v[20:23], a[92:95], a[44:47], v[20:23]
v_mfma_f32_16x16x32_bf16 v[24:27], a[64:67], a[48:51], 0
v_mfma_f32_16x16x32_bf16 v[24:27], a[68:71], a[52:55], v[24:27]
v_mfma_f32_16x16x32_bf16 v[24:27], a[72:75], a[56:59], v[24:27]
v_mfma_f32_16x16x32_bf16 v[24:27], a[76:79], a[60:63], v[24:27]
v_mfma_f32_16x16x32_bf16 v[28:31], a[80:83], a[48:51], 0
v_mfma_f32_16x16x32_bf16 v[28:31], a[84:87], a[52:55], v[28:31]
v_mfma_f32_16x16x32_bf16 v[28:31], a[88:91], a[56:59], v[28:31]
v_mfma_f32_16x16x32_bf16 v[28:31], a[92:95], a[60:63], v[28:31]
v_mfma_f32_16x16x32_bf16 v[32:35], a[64:67], a[96:99], 0
v_mfma_f32_16x16x32_bf16 v[32:35], a[68:71], a[100:103], v[32:35]
v_mfma_f32_16x16x32_bf16 v[32:35], a[72:75], a[104:107], v[32:35]
v_mfma_f32_16x16x32_bf16 v[32:35], a[76:79], a[108:111], v[32:35]
v_mfma_f32_16x16x32_bf16 v[36:39], a[80:83], a[96:99], 0
v_mfma_f32_16x16x32_bf16 v[36:39], a[84:87], a[100:103], v[36:39]
v_mfma_f32_16x16x32_bf16 v[36:39], a[88:91], a[104:107], v[36:39]
v_mfma_f32_16x16x32_bf16 v[36:39], a[92:95], a[108:111], v[36:39]
v_max3_f32 v116, v116, v16, v17
v_max3_f32 v116, v116, v18, v19
v_max3_f32 v116, v116, v20, v21
v_max3_f32 v116, v116, v22, v23
v_max3_f32 v117, v117, v24, v25
v_max3_f32 v117, v117, v26, v27
v_max3_f32 v117, v117, v28, v29
v_max3_f32 v117, v117, v30, v31
v_max3_f32 v118, v118, v32, v33
v_max3_f32 v118, v118, v34, v35
v_max3_f32 v118, v118, v36, v37
v_max3_f32 v118, v118, v38, v39
s_add_u32 s46, s46, 8192
s_add_u32 s35, s35, 1
s_cmp_lt_u32 s35, 32
s_cbranch_scc1 L_mp3
s_barrier
v_mov_b32 v108, v116
v_mov_b32 v109, v117
v_mov_b32 v110, v118
v_permlane32_swap_b32 v116, v108
v_permlane32_swap_b32 v117, v109
v_permlane32_swap_b32 v118, v110
v_max_f32 v116, v116, v108
v_max_f32 v117, v117, v109
v_max_f32 v118, v118, v110
v_mov_b32 v108, v116
v_mov_b32 v109, v117
v_mov_b32 v110, v118
v_permlane16_swap_b32 v116, v108
v_permlane16_swap_b32 v117, v109
v_permlane16_swap_b32 v118, v110
v_max_f32 v116, v116, v108
v_max_f32 v117, v117, v109
v_max_f32 v118, v118, v110
v_sub_f32 v64, 0, v116
v_sub_f32 v65, 0, v116
v_sub_f32 v66, 0, v116
v_sub_f32 v67, 0, v116
v_sub_f32 v68, 0, v117
v_sub_f32 v69, 0, v117
v_sub_f32 v70, 0, v117
v_sub_f32 v71, 0, v117
v_sub_f32 v72, 0, v118
v_sub_f32 v73, 0, v118
v_sub_f32 v74, 0, v118
v_sub_f32 v75, 0, v118
s_cmp_eq_u32 s36, 0
s_cbranch_scc1 L_maxdone03
s_branch L_maxdone13
L_phase2:
L_vote:
s_cmp_eq_u32 s79, 2
s_cbranch_scc1 L_go
v_mov_b32 v5, 138240
s_barrier
ds_read_b128 v[16:19], v5
s_waitcnt lgkmcnt(0)
v_or_b32 v16, v16, v17
v_or3_b32 v16, v16, v18, v19
s_nop 0
v_readfirstlane_b32 s46, v16
s_cmp_lg_u32 s37, 0
s_nop 2
s_cselect_b32 s46, 0, s46
s_cmp_lg_u32 s46, 0
s_cbranch_scc1 L_redo
s_cmp_eq_u32 s32, 3
s_cbranch_scc0 L_nosig2
s_mov_b64 exec, 1
buffer_atomic_add v104, off, s[48:51], s60 sc1
s_mov_b64 exec, -1
L_nosig2:
s_cmp_eq_u32 s67, 1
s_cbranch_scc1 L_fini
s_cmp_eq_u32 s79, 1
s_cbranch_scc1 L_lateld
L_go:
s_xor_b32 s70, s32, 1
s_mul_i32 s70, s70, 27648
v_add_u32 v16, s70, v103
s_xor_b32 s70, s32, 2
s_mul_i32 s70, s70, 27648
s_add_u32 s70, s70, 9216
v_add_u32 v17, s70, v103
s_xor_b32 s70, s32, 3
s_mul_i32 s70, s70, 27648
s_add_u32 s70, s70, 18432
v_add_u32 v18, s70, v103
s_mul_i32 s70, s32, 27648
v_add_u32 v19, s70, v103
v_and_b32 v20, 15, v0
v_mul_u32_u24 v20, 112, v20
v_bfe_u32 v21, v0, 4, 2
v_lshl_add_u32 v20, v21, 3, v20
v_add_u32 v20, s70, v20
v_and_b32 v21, 63, v0
s_mov_b32 s71, 0x2aab
v_add_u32 v22, 0, v21
v_mul_u32_u24 v23, s71, v22
v_lshrrev_b32 v23, 16, v23
v_mul_u32_u24 v42, 2208, v23
v_lshl_add_u32 v42, v22, 4, v42
v_add_u32 v23, v23, v22
v_lshlrev_b32 v23, 4, v23
v_add_u32 v68, s70, v23
v_add_u32 v22, 64, v21
v_mul_u32_u24 v23, s71, v22
v_lshrrev_b32 v23, 16, v23
v_mul_u32_u24 v43, 2208, v23
v_lshl_add_u32 v43, v22, 4, v43
v_add_u32 v23, v23, v22
v_lshlrev_b32 v23, 4, v23
v_add_u32 v69, s70, v23
v_add_u32 v22, 128, v21
v_mul_u32_u24 v23, s71, v22
v_lshrrev_b32 v23, 16, v23
v_mul_u32_u24 v44, 2208, v23
v_lshl_add_u32 v44, v22, 4, v44
v_add_u32 v23, v23, v22
v_lshlrev_b32 v23, 4, v23
v_add_u32 v70, s70, v23
v_add_u32 v22, 192, v21
v_mul_u32_u24 v23, s71, v22
v_lshrrev_b32 v23, 16, v23
v_mul_u32_u24 v45, 2208, v23
v_lshl_add_u32 v45, v22, 4, v45
v_add_u32 v23, v23, v22
v_lshlrev_b32 v23, 4, v23
v_add_u32 v71, s70, v23
v_add_u32 v22, 256, v21
v_mul_u32_u24 v23, s71, v22
v_lshrrev_b32 v23, 16, v23
v_mul_u32_u24 v46, 2208, v23
v_lshl_add_u32 v46, v22, 4, v46
v_add_u32 v23, v23, v22
v_lshlrev_b32 v23, 4, v23
v_add_u32 v72, s70, v23
v_cmp_gt_u32 vcc, 32, v21
v_mov_b32 v22, 0x7f000000
s_nop 0
v_cndmask_b32 v46, v22, v46, vcc
s_mov_b32 s88, s76
s_mov_b32 s89, s77
s_mov_b32 s90, 4423680
s_mov_b32 s91, 0x20000
v_lshlrev_b32 v76, 3, v103
v_min_u32 v76, L_fini-L_tail, v76
v_add_u32 v76, L_tail-concat_heads__mha_block_cached__mha_block_cached__near_ridge_kernel, v76
v_mov_b32 v77, s95
v_add_co_u32 v76, vcc, s94, v76
s_nop 1
v_addc_co_u32 v77, vcc, 0, v77, vcc
s_mov_b32 s36, 0
.p2align 3
L_k2:
s_waitcnt vmcnt(36)
v_mfma_f32_16x16x32_bf16 v[112:115], a[144:147], a[168:171], v[112:115]
buffer_load_dword v6, v13, s[48:51], 0 offen sc1
v_mfma_f32_16x16x32_bf16 v[116:119], a[148:151], a[168:171], v[116:119]
v_mfma_f32_16x16x32_bf16 v[120:123], a[152:155], a[168:171], v[120:123]
v_mfma_f32_16x16x32_bf16 v[124:127], a[156:159], a[168:171], v[124:127]
v_mfma_f32_16x16x32_bf16 v[128:131], a[160:163], a[168:171], v[128:131]
v_mfma_f32_16x16x32_bf16 v[132:135], a[164:167], a[168:171], v[132:135]
buffer_load_dwordx4 a[168:171], v8, s[56:59], s98 offen offset:0 sc1
v_mfma_f32_16x16x32_bf16 v[136:139], a[144:147], a[172:175], v[136:139]
v_mfma_f32_16x16x32_bf16 v[140:143], a[148:151], a[172:175], v[140:143]
v_mfma_f32_16x16x32_bf16 v[144:147], a[152:155], a[172:175], v[144:147]
v_mfma_f32_16x16x32_bf16 v[148:151], a[156:159], a[172:175], v[148:151]
v_mfma_f32_16x16x32_bf16 v[152:155], a[160:163], a[172:175], v[152:155]
v_mfma_f32_16x16x32_bf16 v[156:159], a[164:167], a[172:175], v[156:159]
buffer_load_dwordx4 a[172:175], v8, s[56:59], s98 offen offset:1024 sc1
v_mfma_f32_16x16x32_bf16 v[160:163], a[144:147], a[176:179], v[160:163]
v_mfma_f32_16x16x32_bf16 v[164:167], a[148:151], a[176:179], v[164:167]
v_mfma_f32_16x16x32_bf16 v[168:171], a[152:155], a[176:179], v[168:171]
v_mfma_f32_16x16x32_bf16 v[172:175], a[156:159], a[176:179], v[172:175]
v_mfma_f32_16x16x32_bf16 v[176:179], a[160:163], a[176:179], v[176:179]
v_mfma_f32_16x16x32_bf16 v[180:183], a[164:167], a[176:179], v[180:183]
buffer_load_dwordx4 a[176:179], v8, s[56:59], s98 offen offset:2048 sc1
v_mfma_f32_16x16x32_bf16 v[184:187], a[144:147], a[180:183], v[184:187]
v_mfma_f32_16x16x32_bf16 v[188:191], a[148:151], a[180:183], v[188:191]
v_mfma_f32_16x16x32_bf16 v[192:195], a[152:155], a[180:183], v[192:195]
v_mfma_f32_16x16x32_bf16 v[196:199], a[156:159], a[180:183], v[196:199]
v_mfma_f32_16x16x32_bf16 v[200:203], a[160:163], a[180:183], v[200:203]
v_mfma_f32_16x16x32_bf16 v[204:207], a[164:167], a[180:183], v[204:207]
buffer_load_dwordx4 a[180:183], v9, s[56:59], s98 offen offset:0 sc1
v_mfma_f32_16x16x32_bf16 v[208:211], a[144:147], a[184:187], v[208:211]
v_mfma_f32_16x16x32_bf16 v[212:215], a[148:151], a[184:187], v[212:215]
v_mfma_f32_16x16x32_bf16 v[216:219], a[152:155], a[184:187], v[216:219]
v_mfma_f32_16x16x32_bf16 v[220:223], a[156:159], a[184:187], v[220:223]
v_mfma_f32_16x16x32_bf16 v[224:227], a[160:163], a[184:187], v[224:227]
v_mfma_f32_16x16x32_bf16 v[228:231], a[164:167], a[184:187], v[228:231]
buffer_load_dwordx4 a[184:187], v9, s[56:59], s98 offen offset:1024 sc1
v_mfma_f32_16x16x32_bf16 v[232:235], a[144:147], a[188:191], v[232:235]
buffer_load_dwordx4 a[144:147], v2, s[80:83], s99 offen offset:0 sc1
v_mfma_f32_16x16x32_bf16 v[236:239], a[148:151], a[188:191], v[236:239]
buffer_load_dwordx4 a[148:151], v2, s[80:83], s99 offen offset:1024 sc1
v_mfma_f32_16x16x32_bf16 v[240:243], a[152:155], a[188:191], v[240:243]
buffer_load_dwordx4 a[152:155], v2, s[80:83], s99 offen offset:2048 sc1
v_mfma_f32_16x16x32_bf16 v[244:247], a[156:159], a[188:191], v[244:247]
buffer_load_dwordx4 a[156:159], v3, s[80:83], s99 offen offset:0 sc1
v_mfma_f32_16x16x32_bf16 v[248:251], a[160:163], a[188:191], v[248:251]
buffer_load_dwordx4 a[160:163], v3, s[80:83], s99 offen offset:1024 sc1
v_mfma_f32_16x16x32_bf16 v[252:255], a[164:167], a[188:191], v[252:255]
buffer_load_dwordx4 a[188:191], v9, s[56:59], s98 offen offset:2048 sc1
buffer_load_dwordx4 a[164:167], v3, s[80:83], s99 offen offset:2048 sc1
s_add_u32 s98, s98, 122880
s_add_u32 s99, s99, 36864
s_waitcnt vmcnt(36)
v_mfma_f32_16x16x32_bf16 v[112:115], a[192:195], a[216:219], v[112:115]
v_mfma_f32_16x16x32_bf16 v[116:119], a[196:199], a[216:219], v[116:119]
v_mfma_f32_16x16x32_bf16 v[120:123], a[200:203], a[216:219], v[120:123]
v_mfma_f32_16x16x32_bf16 v[124:127], a[204:207], a[216:219], v[124:127]
v_mfma_f32_16x16x32_bf16 v[128:131], a[208:211], a[216:219], v[128:131]
v_mfma_f32_16x16x32_bf16 v[132:135], a[212:215], a[216:219], v[132:135]
buffer_load_dwordx4 a[216:219], v8, s[56:59], s98 offen offset:0 sc1
v_mfma_f32_16x16x32_bf16 v[136:139], a[192:195], a[220:223], v[136:139]
v_mfma_f32_16x16x32_bf16 v[140:143], a[196:199], a[220:223], v[140:143]
v_mfma_f32_16x16x32_bf16 v[144:147], a[200:203], a[220:223], v[144:147]
v_mfma_f32_16x16x32_bf16 v[148:151], a[204:207], a[220:223], v[148:151]
v_mfma_f32_16x16x32_bf16 v[152:155], a[208:211], a[220:223], v[152:155]
v_mfma_f32_16x16x32_bf16 v[156:159], a[212:215], a[220:223], v[156:159]
buffer_load_dwordx4 a[220:223], v8, s[56:59], s98 offen offset:1024 sc1
v_mfma_f32_16x16x32_bf16 v[160:163], a[192:195], a[224:227], v[160:163]
v_mfma_f32_16x16x32_bf16 v[164:167], a[196:199], a[224:227], v[164:167]
v_mfma_f32_16x16x32_bf16 v[168:171], a[200:203], a[224:227], v[168:171]
v_mfma_f32_16x16x32_bf16 v[172:175], a[204:207], a[224:227], v[172:175]
v_mfma_f32_16x16x32_bf16 v[176:179], a[208:211], a[224:227], v[176:179]
v_mfma_f32_16x16x32_bf16 v[180:183], a[212:215], a[224:227], v[180:183]
buffer_load_dwordx4 a[224:227], v8, s[56:59], s98 offen offset:2048 sc1
v_mfma_f32_16x16x32_bf16 v[184:187], a[192:195], a[228:231], v[184:187]
v_mfma_f32_16x16x32_bf16 v[188:191], a[196:199], a[228:231], v[188:191]
v_mfma_f32_16x16x32_bf16 v[192:195], a[200:203], a[228:231], v[192:195]
v_mfma_f32_16x16x32_bf16 v[196:199], a[204:207], a[228:231], v[196:199]
v_mfma_f32_16x16x32_bf16 v[200:203], a[208:211], a[228:231], v[200:203]
v_mfma_f32_16x16x32_bf16 v[204:207], a[212:215], a[228:231], v[204:207]
buffer_load_dwordx4 a[228:231], v9, s[56:59], s98 offen offset:0 sc1
v_mfma_f32_16x16x32_bf16 v[208:211], a[192:195], a[232:235], v[208:211]
v_mfma_f32_16x16x32_bf16 v[212:215], a[196:199], a[232:235], v[212:215]
v_mfma_f32_16x16x32_bf16 v[216:219], a[200:203], a[232:235], v[216:219]
v_mfma_f32_16x16x32_bf16 v[220:223], a[204:207], a[232:235], v[220:223]
v_mfma_f32_16x16x32_bf16 v[224:227], a[208:211], a[232:235], v[224:227]
v_mfma_f32_16x16x32_bf16 v[228:231], a[212:215], a[232:235], v[228:231]
buffer_load_dwordx4 a[232:235], v9, s[56:59], s98 offen offset:1024 sc1
v_mfma_f32_16x16x32_bf16 v[232:235], a[192:195], a[236:239], v[232:235]
buffer_load_dwordx4 a[192:195], v2, s[80:83], s99 offen offset:0 sc1
v_mfma_f32_16x16x32_bf16 v[236:239], a[196:199], a[236:239], v[236:239]
buffer_load_dwordx4 a[196:199], v2, s[80:83], s99 offen offset:1024 sc1
v_mfma_f32_16x16x32_bf16 v[240:243], a[200:203], a[236:239], v[240:243]
buffer_load_dwordx4 a[200:203], v2, s[80:83], s99 offen offset:2048 sc1
v_mfma_f32_16x16x32_bf16 v[244:247], a[204:207], a[236:239], v[244:247]
buffer_load_dwordx4 a[204:207], v3, s[80:83], s99 offen offset:0 sc1
v_mfma_f32_16x16x32_bf16 v[248:251], a[208:211], a[236:239], v[248:251]
buffer_load_dwordx4 a[208:211], v3, s[80:83], s99 offen offset:1024 sc1
v_mfma_f32_16x16x32_bf16 v[252:255], a[212:215], a[236:239], v[252:255]
buffer_load_dwordx4 a[236:239], v9, s[56:59], s98 offen offset:2048 sc1
buffer_load_dwordx4 a[212:215], v3, s[80:83], s99 offen offset:2048 sc1
s_add_u32 s98, s98, 122880
s_add_u32 s99, s99, 36864
s_waitcnt vmcnt(36)
v_mfma_f32_16x16x32_bf16 v[112:115], a[128:131], a[248:251], v[112:115]
v_mfma_f32_16x16x32_bf16 v[116:119], a[132:135], a[248:251], v[116:119]
v_mfma_f32_16x16x32_bf16 v[120:123], a[136:139], a[248:251], v[120:123]
v_mfma_f32_16x16x32_bf16 v[124:127], a[140:143], a[248:251], v[124:127]
v_mfma_f32_16x16x32_bf16 v[128:131], a[240:243], a[248:251], v[128:131]
v_mfma_f32_16x16x32_bf16 v[132:135], a[244:247], a[248:251], v[132:135]
buffer_load_dwordx4 a[248:251], v8, s[56:59], s98 offen offset:0 sc1
v_mfma_f32_16x16x32_bf16 v[136:139], a[128:131], a[252:255], v[136:139]
v_mfma_f32_16x16x32_bf16 v[140:143], a[132:135], a[252:255], v[140:143]
v_mfma_f32_16x16x32_bf16 v[144:147], a[136:139], a[252:255], v[144:147]
v_mfma_f32_16x16x32_bf16 v[148:151], a[140:143], a[252:255], v[148:151]
v_mfma_f32_16x16x32_bf16 v[152:155], a[240:243], a[252:255], v[152:155]
v_mfma_f32_16x16x32_bf16 v[156:159], a[244:247], a[252:255], v[156:159]
buffer_load_dwordx4 a[252:255], v8, s[56:59], s98 offen offset:1024 sc1
v_mfma_f32_16x16x32_bf16 v[160:163], a[128:131], a[0:3], v[160:163]
v_mfma_f32_16x16x32_bf16 v[164:167], a[132:135], a[0:3], v[164:167]
v_mfma_f32_16x16x32_bf16 v[168:171], a[136:139], a[0:3], v[168:171]
v_mfma_f32_16x16x32_bf16 v[172:175], a[140:143], a[0:3], v[172:175]
v_mfma_f32_16x16x32_bf16 v[176:179], a[240:243], a[0:3], v[176:179]
v_mfma_f32_16x16x32_bf16 v[180:183], a[244:247], a[0:3], v[180:183]
buffer_load_dwordx4 a[0:3], v8, s[56:59], s98 offen offset:2048 sc1
v_mfma_f32_16x16x32_bf16 v[184:187], a[128:131], a[4:7], v[184:187]
v_mfma_f32_16x16x32_bf16 v[188:191], a[132:135], a[4:7], v[188:191]
v_mfma_f32_16x16x32_bf16 v[192:195], a[136:139], a[4:7], v[192:195]
v_mfma_f32_16x16x32_bf16 v[196:199], a[140:143], a[4:7], v[196:199]
v_mfma_f32_16x16x32_bf16 v[200:203], a[240:243], a[4:7], v[200:203]
v_mfma_f32_16x16x32_bf16 v[204:207], a[244:247], a[4:7], v[204:207]
buffer_load_dwordx4 a[4:7], v9, s[56:59], s98 offen offset:0 sc1
v_mfma_f32_16x16x32_bf16 v[208:211], a[128:131], a[8:11], v[208:211]
v_mfma_f32_16x16x32_bf16 v[212:215], a[132:135], a[8:11], v[212:215]
v_mfma_f32_16x16x32_bf16 v[216:219], a[136:139], a[8:11], v[216:219]
v_mfma_f32_16x16x32_bf16 v[220:223], a[140:143], a[8:11], v[220:223]
v_mfma_f32_16x16x32_bf16 v[224:227], a[240:243], a[8:11], v[224:227]
v_mfma_f32_16x16x32_bf16 v[228:231], a[244:247], a[8:11], v[228:231]
buffer_load_dwordx4 a[8:11], v9, s[56:59], s98 offen offset:1024 sc1
v_mfma_f32_16x16x32_bf16 v[232:235], a[128:131], a[12:15], v[232:235]
buffer_load_dwordx4 a[128:131], v2, s[80:83], s99 offen offset:0 sc1
v_mfma_f32_16x16x32_bf16 v[236:239], a[132:135], a[12:15], v[236:239]
buffer_load_dwordx4 a[132:135], v2, s[80:83], s99 offen offset:1024 sc1
v_mfma_f32_16x16x32_bf16 v[240:243], a[136:139], a[12:15], v[240:243]
buffer_load_dwordx4 a[136:139], v2, s[80:83], s99 offen offset:2048 sc1
v_mfma_f32_16x16x32_bf16 v[244:247], a[140:143], a[12:15], v[244:247]
buffer_load_dwordx4 a[140:143], v3, s[80:83], s99 offen offset:0 sc1
v_mfma_f32_16x16x32_bf16 v[248:251], a[240:243], a[12:15], v[248:251]
buffer_load_dwordx4 a[240:243], v3, s[80:83], s99 offen offset:1024 sc1
v_mfma_f32_16x16x32_bf16 v[252:255], a[244:247], a[12:15], v[252:255]
buffer_load_dwordx4 a[12:15], v9, s[56:59], s98 offen offset:2048 sc1
buffer_load_dwordx4 a[244:247], v3, s[80:83], s99 offen offset:2048 sc1
s_add_u32 s98, s98, 122880
s_add_u32 s99, s99, 36864
s_waitcnt vmcnt(36)
v_mfma_f32_16x16x32_bf16 v[112:115], a[16:19], a[40:43], v[112:115]
v_mfma_f32_16x16x32_bf16 v[116:119], a[20:23], a[40:43], v[116:119]
v_mfma_f32_16x16x32_bf16 v[120:123], a[24:27], a[40:43], v[120:123]
v_mfma_f32_16x16x32_bf16 v[124:127], a[28:31], a[40:43], v[124:127]
v_mfma_f32_16x16x32_bf16 v[128:131], a[32:35], a[40:43], v[128:131]
v_mfma_f32_16x16x32_bf16 v[132:135], a[36:39], a[40:43], v[132:135]
buffer_load_dwordx4 a[40:43], v8, s[56:59], s98 offen offset:0 sc1
v_mfma_f32_16x16x32_bf16 v[136:139], a[16:19], a[44:47], v[136:139]
v_mfma_f32_16x16x32_bf16 v[140:143], a[20:23], a[44:47], v[140:143]
v_mfma_f32_16x16x32_bf16 v[144:147], a[24:27], a[44:47], v[144:147]
v_mfma_f32_16x16x32_bf16 v[148:151], a[28:31], a[44:47], v[148:151]
v_mfma_f32_16x16x32_bf16 v[152:155], a[32:35], a[44:47], v[152:155]
v_mfma_f32_16x16x32_bf16 v[156:159], a[36:39], a[44:47], v[156:159]
buffer_load_dwordx4 a[44:47], v8, s[56:59], s98 offen offset:1024 sc1
v_mfma_f32_16x16x32_bf16 v[160:163], a[16:19], a[48:51], v[160:163]
v_mfma_f32_16x16x32_bf16 v[164:167], a[20:23], a[48:51], v[164:167]
v_mfma_f32_16x16x32_bf16 v[168:171], a[24:27], a[48:51], v[168:171]
v_mfma_f32_16x16x32_bf16 v[172:175], a[28:31], a[48:51], v[172:175]
v_mfma_f32_16x16x32_bf16 v[176:179], a[32:35], a[48:51], v[176:179]
v_mfma_f32_16x16x32_bf16 v[180:183], a[36:39], a[48:51], v[180:183]
buffer_load_dwordx4 a[48:51], v8, s[56:59], s98 offen offset:2048 sc1
v_mfma_f32_16x16x32_bf16 v[184:187], a[16:19], a[52:55], v[184:187]
v_mfma_f32_16x16x32_bf16 v[188:191], a[20:23], a[52:55], v[188:191]
v_mfma_f32_16x16x32_bf16 v[192:195], a[24:27], a[52:55], v[192:195]
v_mfma_f32_16x16x32_bf16 v[196:199], a[28:31], a[52:55], v[196:199]
v_mfma_f32_16x16x32_bf16 v[200:203], a[32:35], a[52:55], v[200:203]
v_mfma_f32_16x16x32_bf16 v[204:207], a[36:39], a[52:55], v[204:207]
buffer_load_dwordx4 a[52:55], v9, s[56:59], s98 offen offset:0 sc1
v_mfma_f32_16x16x32_bf16 v[208:211], a[16:19], a[56:59], v[208:211]
v_mfma_f32_16x16x32_bf16 v[212:215], a[20:23], a[56:59], v[212:215]
v_mfma_f32_16x16x32_bf16 v[216:219], a[24:27], a[56:59], v[216:219]
v_mfma_f32_16x16x32_bf16 v[220:223], a[28:31], a[56:59], v[220:223]
v_mfma_f32_16x16x32_bf16 v[224:227], a[32:35], a[56:59], v[224:227]
v_mfma_f32_16x16x32_bf16 v[228:231], a[36:39], a[56:59], v[228:231]
buffer_load_dwordx4 a[56:59], v9, s[56:59], s98 offen offset:1024 sc1
v_mfma_f32_16x16x32_bf16 v[232:235], a[16:19], a[60:63], v[232:235]
buffer_load_dwordx4 a[16:19], v2, s[80:83], s99 offen offset:0 sc1
v_mfma_f32_16x16x32_bf16 v[236:239], a[20:23], a[60:63], v[236:239]
buffer_load_dwordx4 a[20:23], v2, s[80:83], s99 offen offset:1024 sc1
v_mfma_f32_16x16x32_bf16 v[240:243], a[24:27], a[60:63], v[240:243]
buffer_load_dwordx4 a[24:27], v2, s[80:83], s99 offen offset:2048 sc1
v_mfma_f32_16x16x32_bf16 v[244:247], a[28:31], a[60:63], v[244:247]
buffer_load_dwordx4 a[28:31], v3, s[80:83], s99 offen offset:0 sc1
v_mfma_f32_16x16x32_bf16 v[248:251], a[32:35], a[60:63], v[248:251]
buffer_load_dwordx4 a[32:35], v3, s[80:83], s99 offen offset:1024 sc1
v_mfma_f32_16x16x32_bf16 v[252:255], a[36:39], a[60:63], v[252:255]
buffer_load_dwordx4 a[60:63], v9, s[56:59], s98 offen offset:2048 sc1
buffer_load_dwordx4 a[36:39], v3, s[80:83], s99 offen offset:2048 sc1
s_add_u32 s98, s98, 614400
s_add_u32 s99, s99, 184320
s_add_u32 s36, s36, 1
s_cmp_eq_u32 s36, 2
s_cbranch_scc1 L_chk
L_chkd:
s_cmp_lt_u32 s36, 6
s_cbranch_scc1 L_k2
L_tail:
s_waitcnt vmcnt(36)
v_mfma_f32_16x16x32_bf16 v[112:115], a[144:147], a[168:171], v[112:115]
v_mfma_f32_16x16x32_bf16 v[116:119], a[148:151], a[168:171], v[116:119]
v_mfma_f32_16x16x32_bf16 v[120:123], a[152:155], a[168:171], v[120:123]
v_mfma_f32_16x16x32_bf16 v[124:127], a[156:159], a[168:171], v[124:127]
v_mfma_f32_16x16x32_bf16 v[128:131], a[160:163], a[168:171], v[128:131]
v_mfma_f32_16x16x32_bf16 v[132:135], a[164:167], a[168:171], v[132:135]
v_mfma_f32_16x16x32_bf16 v[136:139], a[144:147], a[172:175], v[136:139]
v_mfma_f32_16x16x32_bf16 v[140:143], a[148:151], a[172:175], v[140:143]
v_mfma_f32_16x16x32_bf16 v[144:147], a[152:155], a[172:175], v[144:147]
v_mfma_f32_16x16x32_bf16 v[148:151], a[156:159], a[172:175], v[148:151]
v_mfma_f32_16x16x32_bf16 v[152:155], a[160:163], a[172:175], v[152:155]
v_mfma_f32_16x16x32_bf16 v[156:159], a[164:167], a[172:175], v[156:159]
v_mfma_f32_16x16x32_bf16 v[160:163], a[144:147], a[176:179], v[160:163]
v_mfma_f32_16x16x32_bf16 v[164:167], a[148:151], a[176:179], v[164:167]
v_mfma_f32_16x16x32_bf16 v[168:171], a[152:155], a[176:179], v[168:171]
v_mfma_f32_16x16x32_bf16 v[172:175], a[156:159], a[176:179], v[172:175]
v_mfma_f32_16x16x32_bf16 v[176:179], a[160:163], a[176:179], v[176:179]
v_mfma_f32_16x16x32_bf16 v[180:183], a[164:167], a[176:179], v[180:183]
v_mfma_f32_16x16x32_bf16 v[184:187], a[144:147], a[180:183], v[184:187]
v_mfma_f32_16x16x32_bf16 v[188:191], a[148:151], a[180:183], v[188:191]
v_mfma_f32_16x16x32_bf16 v[192:195], a[152:155], a[180:183], v[192:195]
v_mfma_f32_16x16x32_bf16 v[196:199], a[156:159], a[180:183], v[196:199]
v_mfma_f32_16x16x32_bf16 v[200:203], a[160:163], a[180:183], v[200:203]
v_mfma_f32_16x16x32_bf16 v[204:207], a[164:167], a[180:183], v[204:207]
v_mfma_f32_16x16x32_bf16 v[208:211], a[144:147], a[184:187], v[208:211]
v_mfma_f32_16x16x32_bf16 v[212:215], a[148:151], a[184:187], v[212:215]
v_mfma_f32_16x16x32_bf16 v[216:219], a[152:155], a[184:187], v[216:219]
v_mfma_f32_16x16x32_bf16 v[220:223], a[156:159], a[184:187], v[220:223]
v_mfma_f32_16x16x32_bf16 v[224:227], a[160:163], a[184:187], v[224:227]
v_mfma_f32_16x16x32_bf16 v[228:231], a[164:167], a[184:187], v[228:231]
v_mfma_f32_16x16x32_bf16 v[232:235], a[144:147], a[188:191], v[232:235]
v_mfma_f32_16x16x32_bf16 v[236:239], a[148:151], a[188:191], v[236:239]
v_mfma_f32_16x16x32_bf16 v[240:243], a[152:155], a[188:191], v[240:243]
v_mfma_f32_16x16x32_bf16 v[244:247], a[156:159], a[188:191], v[244:247]
v_mfma_f32_16x16x32_bf16 v[248:251], a[160:163], a[188:191], v[248:251]
v_mfma_f32_16x16x32_bf16 v[252:255], a[164:167], a[188:191], v[252:255]
s_waitcnt vmcnt(24)
v_mfma_f32_16x16x32_bf16 v[112:115], a[192:195], a[216:219], v[112:115]
v_mfma_f32_16x16x32_bf16 v[116:119], a[196:199], a[216:219], v[116:119]
v_mfma_f32_16x16x32_bf16 v[120:123], a[200:203], a[216:219], v[120:123]
v_mfma_f32_16x16x32_bf16 v[124:127], a[204:207], a[216:219], v[124:127]
v_mfma_f32_16x16x32_bf16 v[128:131], a[208:211], a[216:219], v[128:131]
v_mfma_f32_16x16x32_bf16 v[132:135], a[212:215], a[216:219], v[132:135]
v_mfma_f32_16x16x32_bf16 v[136:139], a[192:195], a[220:223], v[136:139]
v_mfma_f32_16x16x32_bf16 v[140:143], a[196:199], a[220:223], v[140:143]
v_mfma_f32_16x16x32_bf16 v[144:147], a[200:203], a[220:223], v[144:147]
v_mfma_f32_16x16x32_bf16 v[148:151], a[204:207], a[220:223], v[148:151]
v_mfma_f32_16x16x32_bf16 v[152:155], a[208:211], a[220:223], v[152:155]
v_mfma_f32_16x16x32_bf16 v[156:159], a[212:215], a[220:223], v[156:159]
v_mfma_f32_16x16x32_bf16 v[160:163], a[192:195], a[224:227], v[160:163]
v_mfma_f32_16x16x32_bf16 v[164:167], a[196:199], a[224:227], v[164:167]
v_mfma_f32_16x16x32_bf16 v[168:171], a[200:203], a[224:227], v[168:171]
v_mfma_f32_16x16x32_bf16 v[172:175], a[204:207], a[224:227], v[172:175]
v_mfma_f32_16x16x32_bf16 v[176:179], a[208:211], a[224:227], v[176:179]
v_mfma_f32_16x16x32_bf16 v[180:183], a[212:215], a[224:227], v[180:183]
v_mfma_f32_16x16x32_bf16 v[184:187], a[192:195], a[228:231], v[184:187]
v_mfma_f32_16x16x32_bf16 v[188:191], a[196:199], a[228:231], v[188:191]
v_mfma_f32_16x16x32_bf16 v[192:195], a[200:203], a[228:231], v[192:195]
v_mfma_f32_16x16x32_bf16 v[196:199], a[204:207], a[228:231], v[196:199]
v_mfma_f32_16x16x32_bf16 v[200:203], a[208:211], a[228:231], v[200:203]
v_mfma_f32_16x16x32_bf16 v[204:207], a[212:215], a[228:231], v[204:207]
v_mfma_f32_16x16x32_bf16 v[208:211], a[192:195], a[232:235], v[208:211]
v_mfma_f32_16x16x32_bf16 v[212:215], a[196:199], a[232:235], v[212:215]
v_mfma_f32_16x16x32_bf16 v[216:219], a[200:203], a[232:235], v[216:219]
v_mfma_f32_16x16x32_bf16 v[220:223], a[204:207], a[232:235], v[220:223]
v_mfma_f32_16x16x32_bf16 v[224:227], a[208:211], a[232:235], v[224:227]
v_mfma_f32_16x16x32_bf16 v[228:231], a[212:215], a[232:235], v[228:231]
v_mfma_f32_16x16x32_bf16 v[232:235], a[192:195], a[236:239], v[232:235]
v_mfma_f32_16x16x32_bf16 v[236:239], a[196:199], a[236:239], v[236:239]
v_mfma_f32_16x16x32_bf16 v[240:243], a[200:203], a[236:239], v[240:243]
v_mfma_f32_16x16x32_bf16 v[244:247], a[204:207], a[236:239], v[244:247]
v_mfma_f32_16x16x32_bf16 v[248:251], a[208:211], a[236:239], v[248:251]
v_mfma_f32_16x16x32_bf16 v[252:255], a[212:215], a[236:239], v[252:255]
s_waitcnt vmcnt(12)
v_mfma_f32_16x16x32_bf16 v[112:115], a[128:131], a[248:251], v[112:115]
v_mfma_f32_16x16x32_bf16 v[116:119], a[132:135], a[248:251], v[116:119]
v_mfma_f32_16x16x32_bf16 v[120:123], a[136:139], a[248:251], v[120:123]
v_mfma_f32_16x16x32_bf16 v[124:127], a[140:143], a[248:251], v[124:127]
v_mfma_f32_16x16x32_bf16 v[128:131], a[240:243], a[248:251], v[128:131]
v_mfma_f32_16x16x32_bf16 v[132:135], a[244:247], a[248:251], v[132:135]
v_mfma_f32_16x16x32_bf16 v[136:139], a[128:131], a[252:255], v[136:139]
v_mfma_f32_16x16x32_bf16 v[140:143], a[132:135], a[252:255], v[140:143]
v_mfma_f32_16x16x32_bf16 v[144:147], a[136:139], a[252:255], v[144:147]
v_mfma_f32_16x16x32_bf16 v[148:151], a[140:143], a[252:255], v[148:151]
v_mfma_f32_16x16x32_bf16 v[152:155], a[240:243], a[252:255], v[152:155]
v_mfma_f32_16x16x32_bf16 v[156:159], a[244:247], a[252:255], v[156:159]
v_mfma_f32_16x16x32_bf16 v[160:163], a[128:131], a[0:3], v[160:163]
v_mfma_f32_16x16x32_bf16 v[164:167], a[132:135], a[0:3], v[164:167]
v_mfma_f32_16x16x32_bf16 v[168:171], a[136:139], a[0:3], v[168:171]
v_mfma_f32_16x16x32_bf16 v[172:175], a[140:143], a[0:3], v[172:175]
v_mfma_f32_16x16x32_bf16 v[176:179], a[240:243], a[0:3], v[176:179]
v_mfma_f32_16x16x32_bf16 v[180:183], a[244:247], a[0:3], v[180:183]
v_mfma_f32_16x16x32_bf16 v[184:187], a[128:131], a[4:7], v[184:187]
v_mfma_f32_16x16x32_bf16 v[188:191], a[132:135], a[4:7], v[188:191]
v_mfma_f32_16x16x32_bf16 v[192:195], a[136:139], a[4:7], v[192:195]
v_mfma_f32_16x16x32_bf16 v[196:199], a[140:143], a[4:7], v[196:199]
v_mfma_f32_16x16x32_bf16 v[200:203], a[240:243], a[4:7], v[200:203]
v_mfma_f32_16x16x32_bf16 v[204:207], a[244:247], a[4:7], v[204:207]
v_mfma_f32_16x16x32_bf16 v[208:211], a[128:131], a[8:11], v[208:211]
v_mfma_f32_16x16x32_bf16 v[212:215], a[132:135], a[8:11], v[212:215]
v_mfma_f32_16x16x32_bf16 v[216:219], a[136:139], a[8:11], v[216:219]
v_mfma_f32_16x16x32_bf16 v[220:223], a[140:143], a[8:11], v[220:223]
v_mfma_f32_16x16x32_bf16 v[224:227], a[240:243], a[8:11], v[224:227]
v_mfma_f32_16x16x32_bf16 v[228:231], a[244:247], a[8:11], v[228:231]
v_mfma_f32_16x16x32_bf16 v[232:235], a[128:131], a[12:15], v[232:235]
v_mfma_f32_16x16x32_bf16 v[236:239], a[132:135], a[12:15], v[236:239]
v_mfma_f32_16x16x32_bf16 v[240:243], a[136:139], a[12:15], v[240:243]
v_mfma_f32_16x16x32_bf16 v[244:247], a[140:143], a[12:15], v[244:247]
v_mfma_f32_16x16x32_bf16 v[248:251], a[240:243], a[12:15], v[248:251]
v_mfma_f32_16x16x32_bf16 v[252:255], a[244:247], a[12:15], v[252:255]
s_waitcnt vmcnt(0)
v_mfma_f32_16x16x32_bf16 v[124:127], a[28:31], a[40:43], v[124:127]
v_mfma_f32_16x16x32_bf16 v[128:131], a[32:35], a[40:43], v[128:131]
v_mfma_f32_16x16x32_bf16 v[132:135], a[36:39], a[40:43], v[132:135]
v_mfma_f32_16x16x32_bf16 v[148:151], a[28:31], a[44:47], v[148:151]
v_mfma_f32_16x16x32_bf16 v[152:155], a[32:35], a[44:47], v[152:155]
v_mfma_f32_16x16x32_bf16 v[156:159], a[36:39], a[44:47], v[156:159]
s_nop 2
ds_write_b128 v16, v[124:127] offset:0
v_mfma_f32_16x16x32_bf16 v[172:175], a[28:31], a[48:51], v[172:175]
ds_write_b128 v16, v[128:131] offset:1024
v_mfma_f32_16x16x32_bf16 v[176:179], a[32:35], a[48:51], v[176:179]
ds_write_b128 v16, v[132:135] offset:2048
v_mfma_f32_16x16x32_bf16 v[180:183], a[36:39], a[48:51], v[180:183]
ds_write_b128 v16, v[148:151] offset:3072
v_mfma_f32_16x16x32_bf16 v[184:187], a[16:19], a[52:55], v[184:187]
ds_write_b128 v16, v[152:155] offset:4096
v_mfma_f32_16x16x32_bf16 v[188:191], a[20:23], a[52:55], v[188:191]
ds_write_b128 v16, v[156:159] offset:5120
v_mfma_f32_16x16x32_bf16 v[192:195], a[24:27], a[52:55], v[192:195]
ds_write_b128 v16, v[172:175] offset:6144
v_mfma_f32_16x16x32_bf16 v[208:211], a[16:19], a[56:59], v[208:211]
ds_write_b128 v16, v[176:179] offset:7168
v_mfma_f32_16x16x32_bf16 v[212:215], a[20:23], a[56:59], v[212:215]
ds_write_b128 v16, v[180:183] offset:8192
v_mfma_f32_16x16x32_bf16 v[216:219], a[24:27], a[56:59], v[216:219]
ds_write_b128 v17, v[184:187] offset:0
v_mfma_f32_16x16x32_bf16 v[232:235], a[16:19], a[60:63], v[232:235]
ds_write_b128 v17, v[188:191] offset:1024
v_mfma_f32_16x16x32_bf16 v[236:239], a[20:23], a[60:63], v[236:239]
ds_write_b128 v17, v[192:195] offset:2048
v_mfma_f32_16x16x32_bf16 v[240:243], a[24:27], a[60:63], v[240:243]
ds_write_b128 v17, v[208:211] offset:3072
v_mfma_f32_16x16x32_bf16 v[196:199], a[28:31], a[52:55], v[196:199]
ds_write_b128 v17, v[212:215] offset:4096
v_mfma_f32_16x16x32_bf16 v[200:203], a[32:35], a[52:55], v[200:203]
ds_write_b128 v17, v[216:219] offset:5120
v_mfma_f32_16x16x32_bf16 v[204:207], a[36:39], a[52:55], v[204:207]
ds_write_b128 v17, v[232:235] offset:6144
v_mfma_f32_16x16x32_bf16 v[220:223], a[28:31], a[56:59], v[220:223]
ds_write_b128 v17, v[236:239] offset:7168
v_mfma_f32_16x16x32_bf16 v[224:227], a[32:35], a[56:59], v[224:227]
ds_write_b128 v17, v[240:243] offset:8192
v_mfma_f32_16x16x32_bf16 v[228:231], a[36:39], a[56:59], v[228:231]
ds_write_b128 v18, v[196:199] offset:0
v_mfma_f32_16x16x32_bf16 v[244:247], a[28:31], a[60:63], v[244:247]
ds_write_b128 v18, v[200:203] offset:1024
v_mfma_f32_16x16x32_bf16 v[248:251], a[32:35], a[60:63], v[248:251]
ds_write_b128 v18, v[204:207] offset:2048
v_mfma_f32_16x16x32_bf16 v[252:255], a[36:39], a[60:63], v[252:255]
ds_write_b128 v18, v[220:223] offset:3072
v_mfma_f32_16x16x32_bf16 v[112:115], a[16:19], a[40:43], v[112:115]
ds_write_b128 v18, v[224:227] offset:4096
v_mfma_f32_16x16x32_bf16 v[116:119], a[20:23], a[40:43], v[116:119]
ds_write_b128 v18, v[228:231] offset:5120
v_mfma_f32_16x16x32_bf16 v[120:123], a[24:27], a[40:43], v[120:123]
ds_write_b128 v18, v[244:247] offset:6144
v_mfma_f32_16x16x32_bf16 v[136:139], a[16:19], a[44:47], v[136:139]
ds_write_b128 v18, v[248:251] offset:7168
v_mfma_f32_16x16x32_bf16 v[140:143], a[20:23], a[44:47], v[140:143]
ds_write_b128 v18, v[252:255] offset:8192
v_mfma_f32_16x16x32_bf16 v[144:147], a[24:27], a[44:47], v[144:147]
v_mfma_f32_16x16x32_bf16 v[160:163], a[16:19], a[48:51], v[160:163]
v_mfma_f32_16x16x32_bf16 v[164:167], a[20:23], a[48:51], v[164:167]
v_mfma_f32_16x16x32_bf16 v[168:171], a[24:27], a[48:51], v[168:171]
s_waitcnt lgkmcnt(0)
s_barrier
ds_read_b128 v[124:127], v19 offset:0
ds_read_b128 v[128:131], v19 offset:9216
ds_read_b128 v[132:135], v19 offset:18432
ds_read_b128 v[148:151], v19 offset:1024
ds_read_b128 v[152:155], v19 offset:10240
ds_read_b128 v[156:159], v19 offset:19456
ds_read_b128 v[172:175], v19 offset:2048
ds_read_b128 v[176:179], v19 offset:11264
ds_read_b128 v[180:183], v19 offset:20480
ds_read_b128 v[184:187], v19 offset:3072
ds_read_b128 v[188:191], v19 offset:12288
ds_read_b128 v[192:195], v19 offset:21504
ds_read_b128 v[208:211], v19 offset:4096
ds_read_b128 v[212:215], v19 offset:13312
ds_read_b128 v[216:219], v19 offset:22528
ds_read_b128 v[232:235], v19 offset:5120
ds_read_b128 v[236:239], v19 offset:14336
ds_read_b128 v[240:243], v19 offset:23552
ds_read_b128 v[196:199], v19 offset:6144
ds_read_b128 v[200:203], v19 offset:15360
ds_read_b128 v[204:207], v19 offset:24576
ds_read_b128 v[220:223], v19 offset:7168
ds_read_b128 v[224:227], v19 offset:16384
ds_read_b128 v[228:231], v19 offset:25600
ds_read_b128 v[244:247], v19 offset:8192
ds_read_b128 v[248:251], v19 offset:17408
ds_read_b128 v[252:255], v19 offset:26624
s_waitcnt lgkmcnt(15)
v_pk_add_f32 v[124:125], v[124:125], v[128:129]
v_pk_add_f32 v[126:127], v[126:127], v[130:131]
v_pk_add_f32 v[148:149], v[148:149], v[152:153]
v_pk_add_f32 v[150:151], v[150:151], v[154:155]
v_pk_add_f32 v[172:173], v[172:173], v[176:177]
v_pk_add_f32 v[174:175], v[174:175], v[178:179]
v_pk_add_f32 v[112:113], v[112:113], v[132:133]
v_pk_add_f32 v[114:115], v[114:115], v[134:135]
v_pk_add_f32 v[116:117], v[116:117], v[156:157]
v_pk_add_f32 v[118:119], v[118:119], v[158:159]
v_pk_add_f32 v[120:121], v[120:121], v[180:181]
v_pk_add_f32 v[122:123], v[122:123], v[182:183]
v_pk_add_f32 v[112:113], v[112:113], v[124:125]
v_pk_add_f32 v[114:115], v[114:115], v[126:127]
v_pk_add_f32 v[116:117], v[116:117], v[148:149]
v_pk_add_f32 v[118:119], v[118:119], v[150:151]
v_pk_add_f32 v[120:121], v[120:121], v[172:173]
v_pk_add_f32 v[122:123], v[122:123], v[174:175]
v_cvt_pk_bf16_f32 v24, v112, v113
v_cvt_pk_bf16_f32 v25, v114, v115
v_cvt_pk_bf16_f32 v26, v116, v117
v_cvt_pk_bf16_f32 v27, v118, v119
v_cvt_pk_bf16_f32 v28, v120, v121
v_cvt_pk_bf16_f32 v29, v122, v123
ds_write_b64 v20, v[24:25] offset:0
ds_write_b64 v20, v[26:27] offset:32
ds_write_b64 v20, v[28:29] offset:64
s_waitcnt lgkmcnt(12)
v_pk_add_f32 v[184:185], v[184:185], v[188:189]
v_pk_add_f32 v[186:187], v[186:187], v[190:191]
v_pk_add_f32 v[208:209], v[208:209], v[212:213]
v_pk_add_f32 v[210:211], v[210:211], v[214:215]
v_pk_add_f32 v[232:233], v[232:233], v[236:237]
v_pk_add_f32 v[234:235], v[234:235], v[238:239]
v_pk_add_f32 v[136:137], v[136:137], v[192:193]
v_pk_add_f32 v[138:139], v[138:139], v[194:195]
v_pk_add_f32 v[140:141], v[140:141], v[216:217]
v_pk_add_f32 v[142:143], v[142:143], v[218:219]
v_pk_add_f32 v[144:145], v[144:145], v[240:241]
v_pk_add_f32 v[146:147], v[146:147], v[242:243]
v_pk_add_f32 v[136:137], v[136:137], v[184:185]
v_pk_add_f32 v[138:139], v[138:139], v[186:187]
v_pk_add_f32 v[140:141], v[140:141], v[208:209]
v_pk_add_f32 v[142:143], v[142:143], v[210:211]
v_pk_add_f32 v[144:145], v[144:145], v[232:233]
v_pk_add_f32 v[146:147], v[146:147], v[234:235]
v_cvt_pk_bf16_f32 v30, v136, v137
v_cvt_pk_bf16_f32 v31, v138, v139
v_cvt_pk_bf16_f32 v32, v140, v141
v_cvt_pk_bf16_f32 v33, v142, v143
v_cvt_pk_bf16_f32 v34, v144, v145
v_cvt_pk_bf16_f32 v35, v146, v147
ds_write_b64 v20, v[30:31] offset:1792
ds_write_b64 v20, v[32:33] offset:1824
ds_write_b64 v20, v[34:35] offset:1856
s_waitcnt lgkmcnt(6)
v_pk_add_f32 v[196:197], v[196:197], v[200:201]
v_pk_add_f32 v[198:199], v[198:199], v[202:203]
v_pk_add_f32 v[220:221], v[220:221], v[224:225]
v_pk_add_f32 v[222:223], v[222:223], v[226:227]
v_pk_add_f32 v[244:245], v[244:245], v[248:249]
v_pk_add_f32 v[246:247], v[246:247], v[250:251]
v_pk_add_f32 v[160:161], v[160:161], v[204:205]
v_pk_add_f32 v[162:163], v[162:163], v[206:207]
v_pk_add_f32 v[164:165], v[164:165], v[228:229]
v_pk_add_f32 v[166:167], v[166:167], v[230:231]
v_pk_add_f32 v[168:169], v[168:169], v[252:253]
v_pk_add_f32 v[170:171], v[170:171], v[254:255]
v_pk_add_f32 v[160:161], v[160:161], v[196:197]
v_pk_add_f32 v[162:163], v[162:163], v[198:199]
v_pk_add_f32 v[164:165], v[164:165], v[220:221]
v_pk_add_f32 v[166:167], v[166:167], v[222:223]
v_pk_add_f32 v[168:169], v[168:169], v[244:245]
v_pk_add_f32 v[170:171], v[170:171], v[246:247]
v_cvt_pk_bf16_f32 v36, v160, v161
v_cvt_pk_bf16_f32 v37, v162, v163
v_cvt_pk_bf16_f32 v38, v164, v165
v_cvt_pk_bf16_f32 v39, v166, v167
v_cvt_pk_bf16_f32 v40, v168, v169
v_cvt_pk_bf16_f32 v41, v170, v171
ds_write_b64 v20, v[36:37] offset:3584
ds_write_b64 v20, v[38:39] offset:3616
ds_write_b64 v20, v[40:41] offset:3648
ds_read_b128 v[48:51], v68
ds_read_b128 v[52:55], v69
ds_read_b128 v[56:59], v70
ds_read_b128 v[60:63], v71
ds_read_b128 v[64:67], v72
s_waitcnt lgkmcnt(4)
buffer_store_dwordx4 v[48:51], v42, s[88:91], s66 offen
s_waitcnt lgkmcnt(3)
buffer_store_dwordx4 v[52:55], v43, s[88:91], s66 offen
s_waitcnt lgkmcnt(2)
buffer_store_dwordx4 v[56:59], v44, s[88:91], s66 offen
s_waitcnt lgkmcnt(1)
buffer_store_dwordx4 v[60:63], v45, s[88:91], s66 offen
s_waitcnt lgkmcnt(0)
buffer_store_dwordx4 v[64:67], v46, s[88:91], s66 offen
L_fini:
s_endpgm
L_chk:
s_waitcnt vmcnt(48)
s_sub_u32 s98, s98, 3440640
s_sub_u32 s99, s99, 1032192
v_cmp_gt_u32 vcc, 4, v6
s_cbranch_vccz L_chkd
s_mov_b32 s37, 0
L_poll:
s_sleep 4
buffer_load_dword v6, v13, s[48:51], 0 offen sc1
s_add_u32 s37, s37, 1
s_waitcnt vmcnt(0)
v_cmp_gt_u32 vcc, 4, v6
s_cbranch_vccz L_chkd
s_cmp_lt_u32 s37, 0x20000
s_cbranch_scc1 L_poll
s_branch L_chkd
L_lateld:
s_mov_b32 s58, s100
s_mov_b32 s82, s101
s_mul_i32 s98, s32, 3932160
s_mul_i32 s99, s32, 1179648
s_mov_b32 s79, 2
s_mov_b32 s37, 0
L_esp:
s_sleep 4
buffer_load_dword v107, v11, s[48:51], 0 offen sc1
s_add_u32 s37, s37, 1
s_waitcnt vmcnt(0)
v_cmp_gt_u32 vcc, v12, v107
s_cbranch_vccz L_espd
s_cmp_lt_u32 s37, 0x20000
s_cbranch_scc1 L_esp
L_espd:
buffer_load_dwordx4 a[144:147], v2, s[80:83], s99 offen offset:0 sc1
buffer_load_dwordx4 a[148:151], v2, s[80:83], s99 offen offset:1024 sc1
buffer_load_dwordx4 a[152:155], v2, s[80:83], s99 offen offset:2048 sc1
buffer_load_dwordx4 a[156:159], v3, s[80:83], s99 offen offset:0 sc1
buffer_load_dwordx4 a[160:163], v3, s[80:83], s99 offen offset:1024 sc1
buffer_load_dwordx4 a[164:167], v3, s[80:83], s99 offen offset:2048 sc1
buffer_load_dwordx4 a[168:171], v8, s[56:59], s98 offen offset:0 sc1
buffer_load_dwordx4 a[172:175], v8, s[56:59], s98 offen offset:1024 sc1
buffer_load_dwordx4 a[176:179], v8, s[56:59], s98 offen offset:2048 sc1
buffer_load_dwordx4 a[180:183], v9, s[56:59], s98 offen offset:0 sc1
buffer_load_dwordx4 a[184:187], v9, s[56:59], s98 offen offset:1024 sc1
buffer_load_dwordx4 a[188:191], v9, s[56:59], s98 offen offset:2048 sc1
s_add_u32 s98, s98, 122880
s_add_u32 s99, s99, 36864
buffer_load_dwordx4 a[192:195], v2, s[80:83], s99 offen offset:0 sc1
buffer_load_dwordx4 a[196:199], v2, s[80:83], s99 offen offset:1024 sc1
buffer_load_dwordx4 a[200:203], v2, s[80:83], s99 offen offset:2048 sc1
buffer_load_dwordx4 a[204:207], v3, s[80:83], s99 offen offset:0 sc1
buffer_load_dwordx4 a[208:211], v3, s[80:83], s99 offen offset:1024 sc1
buffer_load_dwordx4 a[212:215], v3, s[80:83], s99 offen offset:2048 sc1
buffer_load_dwordx4 a[216:219], v8, s[56:59], s98 offen offset:0 sc1
buffer_load_dwordx4 a[220:223], v8, s[56:59], s98 offen offset:1024 sc1
buffer_load_dwordx4 a[224:227], v8, s[56:59], s98 offen offset:2048 sc1
buffer_load_dwordx4 a[228:231], v9, s[56:59], s98 offen offset:0 sc1
buffer_load_dwordx4 a[232:235], v9, s[56:59], s98 offen offset:1024 sc1
buffer_load_dwordx4 a[236:239], v9, s[56:59], s98 offen offset:2048 sc1
s_add_u32 s98, s98, 122880
s_add_u32 s99, s99, 36864
buffer_load_dwordx4 a[128:131], v2, s[80:83], s99 offen offset:0 sc1
buffer_load_dwordx4 a[132:135], v2, s[80:83], s99 offen offset:1024 sc1
buffer_load_dwordx4 a[136:139], v2, s[80:83], s99 offen offset:2048 sc1
buffer_load_dwordx4 a[140:143], v3, s[80:83], s99 offen offset:0 sc1
buffer_load_dwordx4 a[240:243], v3, s[80:83], s99 offen offset:1024 sc1
buffer_load_dwordx4 a[244:247], v3, s[80:83], s99 offen offset:2048 sc1
buffer_load_dwordx4 a[248:251], v8, s[56:59], s98 offen offset:0 sc1
buffer_load_dwordx4 a[252:255], v8, s[56:59], s98 offen offset:1024 sc1
buffer_load_dwordx4 a[0:3], v8, s[56:59], s98 offen offset:2048 sc1
buffer_load_dwordx4 a[4:7], v9, s[56:59], s98 offen offset:0 sc1
buffer_load_dwordx4 a[8:11], v9, s[56:59], s98 offen offset:1024 sc1
buffer_load_dwordx4 a[12:15], v9, s[56:59], s98 offen offset:2048 sc1
s_add_u32 s98, s98, 122880
s_add_u32 s99, s99, 36864
buffer_load_dwordx4 a[16:19], v2, s[80:83], s99 offen offset:0 sc1
buffer_load_dwordx4 a[20:23], v2, s[80:83], s99 offen offset:1024 sc1
buffer_load_dwordx4 a[24:27], v2, s[80:83], s99 offen offset:2048 sc1
buffer_load_dwordx4 a[28:31], v3, s[80:83], s99 offen offset:0 sc1
buffer_load_dwordx4 a[32:35], v3, s[80:83], s99 offen offset:1024 sc1
buffer_load_dwordx4 a[36:39], v3, s[80:83], s99 offen offset:2048 sc1
buffer_load_dwordx4 a[40:43], v8, s[56:59], s98 offen offset:0 sc1
buffer_load_dwordx4 a[44:47], v8, s[56:59], s98 offen offset:1024 sc1
buffer_load_dwordx4 a[48:51], v8, s[56:59], s98 offen offset:2048 sc1
buffer_load_dwordx4 a[52:55], v9, s[56:59], s98 offen offset:0 sc1
buffer_load_dwordx4 a[56:59], v9, s[56:59], s98 offen offset:1024 sc1
buffer_load_dwordx4 a[60:63], v9, s[56:59], s98 offen offset:2048 sc1
s_add_u32 s98, s98, 614400
s_add_u32 s99, s99, 184320
s_waitcnt vmcnt(0)
s_cmp_eq_u32 s32, 3
s_cbranch_scc1 L_p2s3
s_branch L_p2s4
L_redo:
s_mov_b32 s37, 1
s_waitcnt vmcnt(0)
s_barrier
v_mul_u32_u24 v76, 40, v0
v_lshrrev_b32 v76, 8, v76
s_lshr_b32 s70, s97, 3
s_mul_i32 s70, s70, 40
v_add_u32 v76, s70, v76
v_lshlrev_b32 v76, 7, v76
v_min_u32 v76, L_codeend-concat_heads__mha_block_cached__mha_block_cached__near_ridge_kernel-4, v76
v_mov_b32 v77, s95
v_add_co_u32 v76, vcc, s94, v76
s_nop 1
v_addc_co_u32 v77, vcc, 0, v77, vcc
v_and_b32 v108, 63, v0
v_lshrrev_b32 v112, 4, v108
v_lshrrev_b32 v113, 3, v108
v_and_b32 v114, 7, v108
s_lshl_b32 s46, s32, 6
v_add_u32 v109, s46, v113
v_mul_u32_u24 v109, 1152, v109
v_xor_b32 v110, 0, v112
v_xor_b32 v110, v110, v114
v_lshl_add_u32 v110, v110, 4, v109
v_add_u32 v20, 0, v110
v_xor_b32 v110, 4, v112
v_xor_b32 v110, v110, v114
v_lshl_add_u32 v110, v110, 4, v109
v_add_u32 v21, 8192, v110
v_xor_b32 v110, 0, v112
v_xor_b32 v110, v110, v114
v_lshl_add_u32 v110, v110, 4, v109
v_add_u32 v22, 16384, v110
v_xor_b32 v110, 4, v112
v_xor_b32 v110, v110, v114
v_lshl_add_u32 v110, v110, 4, v109
v_add_u32 v23, 24576, v110
s_and_b32 s46, s32, 1
s_lshl_b32 s46, s46, 18
s_lshr_b32 s47, s32, 1
s_lshl_b32 s47, s47, 7
s_add_u32 s46, s46, s47
v_lshlrev_b32 v109, 13, v113
v_add_u32 v109, s46, v109
v_lshrrev_b32 v110, 2, v114
v_xor_b32 v110, v110, v112
v_and_b32 v110, 1, v110
v_lshl_add_u32 v109, v110, 6, v109
v_and_b32 v110, 3, v114
v_lshl_add_u32 v109, v110, 4, v109
v_add_u32 v24, 0, v109
v_add_u32 v25, 64512, v109
v_add_u32 v26, 129024, v109
v_add_u32 v27, 193536, v109
s_mov_b32 s39, 0
s_mov_b32 s40, 36864
s_mov_b32 s41, 0
s_mov_b32 s34, 0
s_mov_b32 s36, 0
s_add_u32 m0, s42, 81920
s_nop 0
buffer_load_dwordx4 v20, s[4:7], s39 offen offset:0 lds
buffer_load_dwordx4 v21, s[4:7], s39 offen offset:1024 lds
buffer_load_dwordx4 v22, s[4:7], s39 offen offset:2048 lds
buffer_load_dwordx4 v23, s[4:7], s39 offen offset:3072 lds
s_add_u32 m0, s42, 86016
s_nop 0
buffer_load_dwordx4 v20, s[4:7], s40 offen offset:0 lds
buffer_load_dwordx4 v21, s[4:7], s40 offen offset:1024 lds
buffer_load_dwordx4 v22, s[4:7], s40 offen offset:2048 lds
buffer_load_dwordx4 v23, s[4:7], s40 offen offset:3072 lds
s_add_u32 s39, s39, 128
s_add_u32 s40, s40, 128
s_add_u32 m0, s33, 49152
s_nop 0
buffer_load_dwordx4 v24, s[8:11], s41 offen offset:0 lds
buffer_load_dwordx4 v25, s[8:11], s41 offen offset:1024 lds
buffer_load_dwordx4 v26, s[8:11], s41 offen offset:2048 lds
buffer_load_dwordx4 v27, s[8:11], s41 offen offset:3072 lds
s_add_u32 s41, s41, 256
s_branch L_tramp
L_end1:
s_endpgm
L_codeend:
.section .rodata,"a"
.p2align 6
.amdhsa_kernel concat_heads__mha_block_cached__mha_block_cached__near_ridge_kernel
  .amdhsa_next_free_vgpr 512
  .amdhsa_next_free_sgpr 102
  .amdhsa_accum_offset 256
  .amdhsa_group_segment_fixed_size 0
  .amdhsa_kernarg_size 104
  .amdhsa_user_sgpr_count 2
  .amdhsa_user_sgpr_kernarg_segment_ptr 1
  .amdhsa_system_sgpr_workgroup_id_x 1
  .amdhsa_float_denorm_mode_32 3
.end_amdhsa_kernel
```
